```python
import torch

def _softmax(x, axis=-1):
    return torch.softmax(x, dim=axis)
def _gelu(x):
    return torch.nn.functional.gelu(x, approximate="tanh")
def _silu(x):
    return torch.nn.functional.silu(x)
def _sigmoid(x):
    return torch.sigmoid(x)
def _layernorm(x, axis=-1, eps=1e-5):
    m = x.mean(dim=axis, keepdim=True)
    v = x.var(dim=axis, keepdim=True, unbiased=False)
    return (x - m) / torch.sqrt(v + eps)
def _scatter_add(tgt, idx, src, axis=0):
    return tgt.clone().index_add_(axis, idx, src)
def _segment_sum(src, seg, n):
    out = torch.zeros((n,) + src.shape[1:], dtype=src.dtype)
    return out.index_add_(0, seg, src)
def _pad(x, pw):
    flat = tuple(v for pair in reversed(pw) for v in pair)
    return torch.nn.functional.pad(x, flat)

kernel_name = 'parallel_sum__ssm_conv_s4d__moe_arch_mod__prompt'

def setup_inputs():

    _w = (lambda a: (lambda t: t.to(torch.bfloat16) if t.is_floating_point() else t)(torch.as_tensor(a)))
    def _A_setup():
        Bsz, L, D, N = 1, 2048, 1024, 128
        return {
            "u": _w((lambda *s: torch.randn(*s, dtype=torch.bfloat16) * 0.05)(Bsz, L, D)),
            "log_A_real": _w((lambda *s: torch.randn(*s, dtype=torch.bfloat16) * 3.2)(D, N) * 0.5),
            "A_imag": _w((lambda *s: torch.randn(*s, dtype=torch.bfloat16) * 0.2)(D, N) * 3.14),
            "C_real": _w((lambda *s: torch.randn(*s, dtype=torch.bfloat16) * 3.2)(D, N) / N ** 0.5),
            "C_imag": _w((lambda *s: torch.randn(*s, dtype=torch.bfloat16) * 3.2)(D, N) / N ** 0.5),
            "log_dt": _w((lambda *s: torch.randn(*s, dtype=torch.bfloat16) * 0.2)(D) * 0.5 - 4.0),
            "D_skip": _w((lambda *s: torch.randn(*s, dtype=torch.bfloat16) * 0.4)(D)),
        }
    _A_in = _A_setup()

    def _B_setup():
        B, S, D, F, C = 1, 2048, 1024, 3584, 8
        return {
            "x": _w((lambda *s: torch.randn(*s, dtype=torch.bfloat16) * 0.05)(B, S, D)),
            "w_r": _w((lambda *s: torch.randn(*s, dtype=torch.bfloat16) * 0.05)(D)),
            "w_gate": _w((lambda *s: torch.randn(*s, dtype=torch.bfloat16) * 0.05)(D, F)),
            "w_up": _w((lambda *s: torch.randn(*s, dtype=torch.bfloat16) * 0.05)(D, F)),
            "w_down": _w((lambda *s: torch.randn(*s, dtype=torch.bfloat16) * 0.05)(F, D)),
        }
    _B_in = _B_setup()

    return {
        "A_u": _A_in["u"],
        "A_log_A_real": _A_in["log_A_real"],
        "A_A_imag": _A_in["A_imag"],
        "A_C_real": _A_in["C_real"],
        "A_C_imag": _A_in["C_imag"],
        "A_log_dt": _A_in["log_dt"],
        "A_D_skip": _A_in["D_skip"],
        "B_x": _B_in["x"],
        "B_w_r": _B_in["w_r"],
        "B_w_gate": _B_in["w_gate"],
        "B_w_up": _B_in["w_up"],
        "B_w_down": _B_in["w_down"],
    }

def reference(A_u, A_log_A_real, A_A_imag, A_C_real, A_C_imag, A_log_dt, A_D_skip, B_x, B_w_r, B_w_gate, B_w_up, B_w_down):
    def _A_ref(u, log_A_real, A_imag, C_real, C_imag, log_dt, D_skip):
        L = u.shape[1]
        dt = torch.exp(log_dt)
        A = -torch.exp(log_A_real) + 1j * A_imag
        C = (C_real + 1j * C_imag) * dt[:, None]
        pos = (lambda x, dt: x.to(dt))(torch.arange(L), log_dt.dtype)
        P = torch.exp((A * dt[:, None])[:, :, None] * pos[None, None, :])
        K = 2.0 * torch.einsum("dn,dnl->dl", C, P).real
        L2 = 2 * L
        u_t = (lambda x, *d: x.permute(*d))(u, 0, 2, 1)
        Kf = (lambda x, *a, **k: torch.fft.rfft(x.float(), *a, **k))(K, L2)
        Uf = (lambda x, *a, **k: torch.fft.rfft(x.float(), *a, **k))(u_t, L2)
        y = (lambda x, *a, **k: torch.fft.irfft(x, *a, **k).to(torch.bfloat16))(Uf * Kf[None, :, :], L2)[:, :, :L]
        y = (lambda x, *d: x.permute(*d))(y, 0, 2, 1)
        return y + u * D_skip[None, None, :]

    def _B_ref(x, w_r, w_gate, w_up, w_down):
        B, S, D = x.shape
        C = 8
        r = x @ w_r
        idx = torch.argsort(-r, axis=-1)[:, :C]
        idx_e = (lambda x, n, axis: torch.repeat_interleave(x, n, dim=axis))(idx.reshape(B, C, 1), D, axis=2)
        x_sel = (lambda x, i, axis: torch.take_along_dim(x, i, dim=axis))(x, idx_e, axis=1)
        g = _silu(x_sel @ w_gate)
        u = x_sel @ w_up
        y = (g * u) @ w_down
        r_sel = _sigmoid((lambda x, i, axis: torch.take_along_dim(x, i, dim=axis))(r, idx, axis=1))
        y = y * r_sel.reshape(B, C, 1)
        b_off = (torch.arange(B) * S).reshape(B, 1)
        flat_idx = (idx + b_off).reshape(B * C)
        zero = (x * 0.0).reshape(B * S, D)
        upd = _scatter_add(zero, flat_idx, y.reshape(B * C, D), axis=0)
        return x + upd.reshape(B, S, D)

    x = A_u
    xn = _layernorm(x, axis=-1)
    return x + _A_ref(xn, A_log_A_real, A_A_imag, A_C_real, A_C_imag, A_log_dt, A_D_skip) + _B_ref(xn, B_w_r, B_w_gate, B_w_up, B_w_down)
```

```asm
; @launch grid=(256,1,1) block=(512,1,1) lds=160768
.amdgcn_target "amdgcn-amd-amdhsa--gfx950"
.text
.globl parallel_sum__ssm_conv_s4d__moe_arch_mod__prompt_kernel
.p2align 8
.type parallel_sum__ssm_conv_s4d__moe_arch_mod__prompt_kernel,@function
parallel_sum__ssm_conv_s4d__moe_arch_mod__prompt_kernel:
    s_cmp_ge_u32 s2, 256
    s_cbranch_scc1 L_END
    s_load_dwordx16 s[16:31], s[0:1], 0
    s_load_dwordx8 s[32:39], s[0:1], 64
    s_load_dwordx2 s[40:41], s[0:1], 96
    s_load_dwordx2 s[42:43], s[0:1], 112
    s_getpc_b64 s[14:15]
    v_lshrrev_b32_e64 v1, 6, v0
    v_and_b32 v10, 255, v0
    v_and_b32 v0, 63, v0
    v_readfirstlane_b32 s3, v1
    v_lshlrev_b32 v1, 2, v0
    v_mov_b32 v2, 0
    ds_write2st64_b32 v1, v2, v2 offset0:0 offset1:2
    s_and_b32 s5, s2, 7
    s_lshr_b32 s6, s2, 3
    s_lshl_b32 s57, s5, 5
    s_add_u32 s57, s57, s6
    s_and_b32 s58, s3, 3
    s_lshl_b32 s7, s57, 2
    s_add_u32 s7, s7, s58
    s_lshl_b32 s7, s7, 8
    v_add_u32 v15, s7, v1
    s_mov_b32 s60, 0
    s_lshl_b32 s4, s57, 3
    s_cmp_lt_u32 s3, 4
    s_cbranch_scc1 L_F0
    v_lshlrev_b32 v2, 7, v10
    v_min_u32 v2, L_END-parallel_sum__ssm_conv_s4d__moe_arch_mod__prompt_kernel-128, v2
    global_load_dword v16, v2, s[14:15]
    v_lshlrev_b32 v3, 12, v10
    v_add_u32 v3, s4, v3
    s_lshr_b32 s8, s6, 2
    s_add_u32 s9, s5, 3
    s_and_b32 s9, s9, 7
    s_min_u32 s9, s9, 6
    s_cmp_lt_u32 s6, 28
    s_cselect_b32 s8, s8, s9
    s_mul_i32 s9, s5, 7
    s_add_u32 s8, s8, s9
    s_lshl_b32 s8, s8, 7
    s_and_b32 s9, s6, 3
    s_lshl_b32 s9, s9, 8
    v_add_u32 v17, s9, v10
    s_movk_i32 s9, 7168
    v_mul_u32_u24 v17, s9, v17
    v_add_u32 v17, s8, v17
    s_waitcnt lgkmcnt(0)
    s_add_u32 s6, s26, s4
    s_addc_u32 s7, s27, 0
    s_load_dwordx2 s[64:65], s[6:7], 0
    global_load_dword v224, v15, s[18:19]
    global_load_dword v225, v15, s[20:21]
    global_load_dword v226, v15, s[22:23]
    global_load_dword v227, v15, s[24:25]
    s_add_u32 s6, s28, s4
    s_addc_u32 s7, s29, 0
    s_load_dwordx2 s[66:67], s[6:7], 0
    s_barrier
    s_mov_b32 s61, 0x100000
    s_mov_b32 s62, 0x200000
    s_mov_b32 s63, 0x300000
    s_mov_b32 s44, s42
    s_and_b32 s45, s43, 0xffff
    s_mov_b32 s46, 0x1000000
    s_mov_b32 s47, 0x20000
    s_mov_b32 s48, s16
    s_and_b32 s49, s17, 0xffff
    s_mov_b32 s50, 0x400000
    s_mov_b32 s51, 0x20000
    s_mov_b32 s52, s40
    s_and_b32 s53, s41, 0xffff
    s_mov_b32 s54, 0x400000
    s_mov_b32 s55, 0x20000
    s_setprio 2
    s_nop 0
    s_mul_i32 s8, s58, 14336
    s_add_u32 s8, s8, 35840
    s_mul_i32 s10, s58, 4608
    s_add_u32 s10, s10, 17408
    s_mul_i32 s11, s58, 16896
    s_add_u32 s11, s11, 93184
    s_movk_i32 s9, 528
    v_lshl_add_u32 v11, v0, 3, s8
    v_and_b32 v1, 15, v0
    v_lshrrev_b32 v2, 4, v0
    v_lshlrev_b32 v7, 4, v2
    v_mad_u32_u24 v14, v1, s9, v7
    v_add_u32 v14, s11, v14
    v_add_u32 v7, s8, v7
    v_lshrrev_b32 v8, 2, v1
    v_lshlrev_b32 v9, 3, v8
    s_mov_b32 s4, 0x01030000
    v_lshrrev_b32 v12, v9, s4
    v_and_b32 v12, 0xff, v12
    v_add_u32_e64 v12, v12, v1
    v_mad_u32_u24 v12, v12, s9, v7
    s_mov_b32 s4, 0x14110804
    v_lshrrev_b32 v13, v9, s4
    v_and_b32 v13, 0xff, v13
    v_and_b32 v9, 3, v1
    v_add_u32 v13, v13, v9
    v_add_u32 v8, 23, v8
    v_cmp_eq_u32 vcc, 3, v9
    s_nop 1
    v_cndmask_b32 v13, v13, v8, vcc
    v_mad_u32_u24 v13, v13, s9, v7
    s_lshl_b32 s4, s58, 2
    v_mov_b32 v4, s4
    v_mov_b32 v5, 1
    v_lshlrev_b32 v6, 2, v9
    s_movk_i32 s9, 2368
    v_lshrrev_b32 v7, 2, v0
    v_lshl_add_u32 v8, v9, 3, s8
    v_mad_u32_u24 v196, v7, s9, v8
    s_movk_i32 s4, 160
    v_mad_u32_u24 v198, v7, s4, v8
    v_lshrrev_b32 v7, 3, v0
    v_and_b32_e64 v8, 7, v0
    v_lshl_add_u32 v8, v8, 3, s8
    v_mad_u32_u24 v197, v7, s9, v8
    v_lshrrev_b32 v7, 5, v0
    v_lshlrev_b32 v7, 8, v7
    v_lshl_add_u32 v7, v1, 4, v7
    v_add_u32 v7, s8, v7
    v_and_b32 v8, 1, v2
    v_lshl_add_u32 v199, v8, 3, v7
    v_lshl_add_u32 v200, v8, 9, v7
    v_and_b32 v7, 1, v1
    s_movk_i32 s4, 640
    v_mul_u32_u24_e64 v7, s4, v7
    v_lshl_add_u32 v7, v2, 5, v7
    v_and_b32_e64 v8, 14, v1
    v_add3_u32 v201, v7, v8, s8
    v_mov_b32 v202, s8
    v_mov_b32 v8, 0
    v_mov_b32 v9, 0
    s_waitcnt lgkmcnt(0)
    s_lshl_b32 s4, s58, 4
    s_lshr_b64 s[6:7], s[64:65], s4
    s_lshl_b32 s6, s6, 16
    v_mov_b32 v228, s6
    v_mul_f32 v228, 0x3fb8aa3b, v228
    v_exp_f32 v228, v228
    s_nop 0
    v_cvt_pk_bf16_f32 v228, v228, v228
    v_and_b32 v228, 0xffff0000, v228
    s_waitcnt vmcnt(0)
    v_lshlrev_b32 v244, 16, v224
    v_and_b32 v245, 0xffff0000, v224
    v_lshlrev_b32_e64 v246, 16, v225
    v_and_b32 v247, 0xffff0000, v225
    v_mul_f32 v244, 0x3fb8aa3b, v244
    v_mul_f32 v245, 0x3fb8aa3b, v245
    v_exp_f32 v244, v244
    v_exp_f32 v245, v245
    v_mul_f32 v246, v246, v228
    v_mul_f32 v247, v247, v228
    v_mul_f32 v232, 0x3e22f983, v246
    v_mul_f32 v233, 0x3e22f983, v247
    v_cvt_pk_bf16_f32 v246, v244, v245
    v_lshlrev_b32_e64 v244, 16, v246
    v_and_b32 v245, 0xffff0000, v246
    v_mul_f32 v244, v244, v228
    v_mul_f32 v245, v245, v228
    v_mul_f32 v230, 0xbfb8aa3b, v244
    v_mul_f32 v231, 0xbfb8aa3b, v245
    s_mul_i32 s4, s58, 16896
    s_add_u32 s4, s4, 93184
    v_lshl_add_u32 v229, v0, 3, s4
    v_add_f32 v228, v228, v228
    v_lshlrev_b32 v236, 16, v226
    v_and_b32 v238, 0xffff0000, v226
    v_lshlrev_b32_e64 v237, 16, v227
    v_and_b32 v239, 0xffff0000, v227
    v_mul_f32 v236, v236, v228
    v_mul_f32 v237, v237, v228
    v_mul_f32 v238, v238, v228
    v_mul_f32 v239, v239, v228
    v_mul_f32 v244, 0x41000000, v230
    v_mul_f32 v246, 0x41000000, v232
    v_mul_f32 v245, 0x41000000, v231
    v_mul_f32 v247, 0x41000000, v233
    v_exp_f32 v244, v244
    v_fract_f32 v246, v246
    v_exp_f32 v245, v245
    v_fract_f32 v247, v247
    v_cos_f32 v240, v246
    v_sin_f32 v241, v246
    v_cos_f32 v242, v247
    v_sin_f32 v243, v247
    v_mul_f32 v240, v240, v244
    v_mul_f32 v241, v241, v244
    v_mul_f32 v242, v242, v245
    v_mul_f32_e64 v243, v243, v245
    s_mov_b32 s4, 0
LV_1:
    v_cvt_pk_bf16_f32 v248, v236, -v237
    v_cvt_pk_bf16_f32 v249, v238, -v239
    ds_write_b64 v229, v[248:249] offset:0
    v_pk_mul_f32 v[244:245], v[236:237], v[240:241] op_sel_hi:[1,0]
    v_pk_mul_f32 v[246:247], v[238:239], v[242:243] op_sel_hi:[1,0]
    v_pk_fma_f32 v[236:237], v[236:237], v[240:241], v[244:245] op_sel:[1,1,0] op_sel_hi:[0,1,1] neg_lo:[1,0,0]
    v_pk_fma_f32 v[238:239], v[238:239], v[242:243], v[246:247] op_sel:[1,1,0] op_sel_hi:[0,1,1] neg_lo:[1,0,0]
    v_cvt_pk_bf16_f32 v250, v236, -v237
    v_cvt_pk_bf16_f32 v251, v238, -v239
    ds_write_b64 v229, v[250:251] offset:528
    v_pk_mul_f32 v[244:245], v[236:237], v[240:241] op_sel_hi:[1,0]
    v_pk_mul_f32 v[246:247], v[238:239], v[242:243] op_sel_hi:[1,0]
    v_pk_fma_f32 v[236:237], v[236:237], v[240:241], v[244:245] op_sel:[1,1,0] op_sel_hi:[0,1,1] neg_lo:[1,0,0]
    v_pk_fma_f32 v[238:239], v[238:239], v[242:243], v[246:247] op_sel:[1,1,0] op_sel_hi:[0,1,1] neg_lo:[1,0,0]
    v_cvt_pk_bf16_f32 v252, v236, -v237
    v_cvt_pk_bf16_f32 v253, v238, -v239
    ds_write_b64 v229, v[252:253] offset:1056
    v_pk_mul_f32 v[244:245], v[236:237], v[240:241] op_sel_hi:[1,0]
    v_pk_mul_f32 v[246:247], v[238:239], v[242:243] op_sel_hi:[1,0]
    v_pk_fma_f32 v[236:237], v[236:237], v[240:241], v[244:245] op_sel:[1,1,0] op_sel_hi:[0,1,1] neg_lo:[1,0,0]
    v_pk_fma_f32 v[238:239], v[238:239], v[242:243], v[246:247] op_sel:[1,1,0] op_sel_hi:[0,1,1] neg_lo:[1,0,0]
    v_cvt_pk_bf16_f32 v254, v236, -v237
    v_cvt_pk_bf16_f32 v255, v238, -v239
    ds_write_b64 v229, v[254:255] offset:1584
    v_pk_mul_f32 v[244:245], v[236:237], v[240:241] op_sel_hi:[1,0]
    v_pk_mul_f32 v[246:247], v[238:239], v[242:243] op_sel_hi:[1,0]
    v_pk_fma_f32 v[236:237], v[236:237], v[240:241], v[244:245] op_sel:[1,1,0] op_sel_hi:[0,1,1] neg_lo:[1,0,0]
    v_pk_fma_f32 v[238:239], v[238:239], v[242:243], v[246:247] op_sel:[1,1,0] op_sel_hi:[0,1,1] neg_lo:[1,0,0]
    v_add_u32 v229, 2112, v229
    s_add_u32 s4, s4, 1
    s_cmp_lt_u32 s4, 8
    s_cbranch_scc1 LV_1
    s_nop 0
    ds_read_b128 v[48:51], v14 offset:0
    ds_read_b128 v[52:55], v14 offset:64
    ds_read_b128 v[56:59], v14 offset:128
    ds_read_b128 v[60:63], v14 offset:192
    ds_read_b128 v[64:67], v14 offset:256
    ds_read_b128 v[68:71], v14 offset:320
    ds_read_b128 v[72:75], v14 offset:384
    ds_read_b128 v[76:79], v14 offset:448
    ds_read_b128 v[80:83], v14 offset:8448
    ds_read_b128 v[84:87], v14 offset:8512
    ds_read_b128 v[88:91], v14 offset:8576
    ds_read_b128 v[92:95], v14 offset:8640
    ds_read_b128 v[96:99], v14 offset:8704
    ds_read_b128 v[100:103], v14 offset:8768
    ds_read_b128 v[104:107], v14 offset:8832
    ds_read_b128 v[108:111], v14 offset:8896
    v_exp_f32 v244, v230
    v_fract_f32 v246, v232
    v_exp_f32 v245, v231
    v_fract_f32 v247, v233
    v_cos_f32 v20, v246
    v_sin_f32 v21, v246
    v_cos_f32 v22, v247
    v_sin_f32 v23, v247
    v_mul_f32 v20, v20, v244
    v_mul_f32 v21, v21, v244
    v_mul_f32 v22, v22, v245
    v_mul_f32 v23, v23, v245
    v_mul_f32 v244, 0x43800000, v230
    v_mul_f32 v246, 0x43800000, v232
    v_mul_f32 v245, 0x43800000, v231
    v_mul_f32 v247, 0x43800000, v233
    v_exp_f32 v244, v244
    v_fract_f32 v246, v246
    v_exp_f32 v245, v245
    v_fract_f32 v247, v247
    v_cos_f32 v24, v246
    v_sin_f32 v25, v246
    v_cos_f32 v26, v247
    v_sin_f32 v27, v247
    v_mul_f32 v24, v24, v244
    v_mul_f32 v25, v25, v244
    v_mul_f32 v26, v26, v245
    v_mul_f32 v27, v27, v245
    v_mov_b32 v248, 0x3f80
    v_mov_b32 v249, 0x3f80
    ds_write_b64 v11, v[248:249]
    v_cvt_pk_bf16_f32 v250, v20, v21
    v_cvt_pk_bf16_f32 v251, v22, v23
    ds_write_b64 v11, v[250:251] offset:528
    v_pk_mul_f32 v[244:245], v[20:21], v[20:21] op_sel_hi:[1,0]
    v_pk_mul_f32 v[246:247], v[22:23], v[22:23] op_sel_hi:[1,0]
    v_pk_fma_f32 v[28:29], v[20:21], v[20:21], v[244:245] op_sel:[1,1,0] op_sel_hi:[0,1,1] neg_lo:[1,0,0]
    v_pk_fma_f32 v[30:31], v[22:23], v[22:23], v[246:247] op_sel:[1,1,0] op_sel_hi:[0,1,1] neg_lo:[1,0,0]
    v_cvt_pk_bf16_f32 v252, v28, v29
    v_cvt_pk_bf16_f32 v253, v30, v31
    ds_write_b64 v11, v[252:253] offset:1056
    v_pk_mul_f32 v[244:245], v[28:29], v[20:21] op_sel_hi:[1,0]
    v_pk_mul_f32 v[246:247], v[30:31], v[22:23] op_sel_hi:[1,0]
    v_pk_fma_f32 v[220:221], v[28:29], v[20:21], v[244:245] op_sel:[1,1,0] op_sel_hi:[0,1,1] neg_lo:[1,0,0]
    v_pk_fma_f32 v[222:223], v[30:31], v[22:23], v[246:247] op_sel:[1,1,0] op_sel_hi:[0,1,1] neg_lo:[1,0,0]
    v_pk_mul_f32 v[240:241], v[28:29], v[28:29] op_sel_hi:[1,0]
    v_pk_mul_f32 v[242:243], v[30:31], v[30:31] op_sel_hi:[1,0]
    v_pk_fma_f32 v[32:33], v[28:29], v[28:29], v[240:241] op_sel:[1,1,0] op_sel_hi:[0,1,1] neg_lo:[1,0,0]
    v_pk_fma_f32 v[34:35], v[30:31], v[30:31], v[242:243] op_sel:[1,1,0] op_sel_hi:[0,1,1] neg_lo:[1,0,0]
    v_cvt_pk_bf16_f32 v254, v220, v221
    v_cvt_pk_bf16_f32 v255, v222, v223
    ds_write_b64 v11, v[254:255] offset:1584
    v_cvt_pk_bf16_f32 v248, v32, v33
    v_cvt_pk_bf16_f32 v249, v34, v35
    ds_write_b64 v11, v[248:249] offset:2112
    v_pk_mul_f32 v[244:245], v[32:33], v[20:21] op_sel_hi:[1,0]
    v_pk_mul_f32 v[246:247], v[34:35], v[22:23] op_sel_hi:[1,0]
    v_pk_fma_f32 v[220:221], v[32:33], v[20:21], v[244:245] op_sel:[1,1,0] op_sel_hi:[0,1,1] neg_lo:[1,0,0]
    v_pk_fma_f32 v[222:223], v[34:35], v[22:23], v[246:247] op_sel:[1,1,0] op_sel_hi:[0,1,1] neg_lo:[1,0,0]
    v_pk_mul_f32 v[240:241], v[32:33], v[28:29] op_sel_hi:[1,0]
    v_pk_mul_f32 v[242:243], v[34:35], v[30:31] op_sel_hi:[1,0]
    v_pk_fma_f32 v[36:37], v[32:33], v[28:29], v[240:241] op_sel:[1,1,0] op_sel_hi:[0,1,1] neg_lo:[1,0,0]
    v_pk_fma_f32 v[38:39], v[34:35], v[30:31], v[242:243] op_sel:[1,1,0] op_sel_hi:[0,1,1] neg_lo:[1,0,0]
    v_cvt_pk_bf16_f32 v250, v220, v221
    v_cvt_pk_bf16_f32 v251, v222, v223
    ds_write_b64 v11, v[250:251] offset:2640
    v_cvt_pk_bf16_f32 v252, v36, v37
    v_cvt_pk_bf16_f32 v253, v38, v39
    ds_write_b64 v11, v[252:253] offset:3168
    v_pk_mul_f32 v[244:245], v[36:37], v[20:21] op_sel_hi:[1,0]
    v_pk_mul_f32 v[246:247], v[38:39], v[22:23] op_sel_hi:[1,0]
    v_pk_fma_f32 v[220:221], v[36:37], v[20:21], v[244:245] op_sel:[1,1,0] op_sel_hi:[0,1,1] neg_lo:[1,0,0]
    v_pk_fma_f32 v[222:223], v[38:39], v[22:23], v[246:247] op_sel:[1,1,0] op_sel_hi:[0,1,1] neg_lo:[1,0,0]
    v_pk_mul_f32 v[240:241], v[36:37], v[28:29] op_sel_hi:[1,0]
    v_pk_mul_f32 v[242:243], v[38:39], v[30:31] op_sel_hi:[1,0]
    v_pk_fma_f32 v[40:41], v[36:37], v[28:29], v[240:241] op_sel:[1,1,0] op_sel_hi:[0,1,1] neg_lo:[1,0,0]
    v_pk_fma_f32 v[42:43], v[38:39], v[30:31], v[242:243] op_sel:[1,1,0] op_sel_hi:[0,1,1] neg_lo:[1,0,0]
    v_cvt_pk_bf16_f32 v254, v220, v221
    v_cvt_pk_bf16_f32 v255, v222, v223
    ds_write_b64 v11, v[254:255] offset:3696
    v_cvt_pk_bf16_f32 v248, v40, v41
    v_cvt_pk_bf16_f32 v249, v42, v43
    ds_write_b64 v11, v[248:249] offset:4224
    v_pk_mul_f32 v[244:245], v[40:41], v[20:21] op_sel_hi:[1,0]
    v_pk_mul_f32 v[246:247], v[42:43], v[22:23] op_sel_hi:[1,0]
    v_pk_fma_f32 v[220:221], v[40:41], v[20:21], v[244:245] op_sel:[1,1,0] op_sel_hi:[0,1,1] neg_lo:[1,0,0]
    v_pk_fma_f32 v[222:223], v[42:43], v[22:23], v[246:247] op_sel:[1,1,0] op_sel_hi:[0,1,1] neg_lo:[1,0,0]
    v_pk_mul_f32 v[240:241], v[40:41], v[28:29] op_sel_hi:[1,0]
    v_pk_mul_f32 v[242:243], v[42:43], v[30:31] op_sel_hi:[1,0]
    v_pk_fma_f32 v[44:45], v[40:41], v[28:29], v[240:241] op_sel:[1,1,0] op_sel_hi:[0,1,1] neg_lo:[1,0,0]
    v_pk_fma_f32 v[46:47], v[42:43], v[30:31], v[242:243] op_sel:[1,1,0] op_sel_hi:[0,1,1] neg_lo:[1,0,0]
    v_cvt_pk_bf16_f32 v250, v220, v221
    v_cvt_pk_bf16_f32 v251, v222, v223
    ds_write_b64 v11, v[250:251] offset:4752
    v_cvt_pk_bf16_f32 v252, v44, v45
    v_cvt_pk_bf16_f32 v253, v46, v47
    ds_write_b64 v11, v[252:253] offset:5280
    v_cvt_pk_bf16_f32 v254, v24, v25
    v_cvt_pk_bf16_f32 v255, v26, v27
    ds_write_b64 v11, v[254:255] offset:5808
    v_pk_mul_f32 v[244:245], v[28:29], v[24:25] op_sel_hi:[1,0]
    v_pk_mul_f32 v[246:247], v[30:31], v[26:27] op_sel_hi:[1,0]
    v_pk_fma_f32 v[220:221], v[28:29], v[24:25], v[244:245] op_sel:[1,1,0] op_sel_hi:[0,1,1] neg_lo:[1,0,0]
    v_pk_fma_f32 v[222:223], v[30:31], v[26:27], v[246:247] op_sel:[1,1,0] op_sel_hi:[0,1,1] neg_lo:[1,0,0]
    v_cvt_pk_bf16_f32 v248, v220, v221
    v_cvt_pk_bf16_f32 v249, v222, v223
    ds_write_b64 v11, v[248:249] offset:6336
    v_pk_mul_f32 v[244:245], v[32:33], v[24:25] op_sel_hi:[1,0]
    v_pk_mul_f32 v[246:247], v[34:35], v[26:27] op_sel_hi:[1,0]
    v_pk_fma_f32 v[220:221], v[32:33], v[24:25], v[244:245] op_sel:[1,1,0] op_sel_hi:[0,1,1] neg_lo:[1,0,0]
    v_pk_fma_f32 v[222:223], v[34:35], v[26:27], v[246:247] op_sel:[1,1,0] op_sel_hi:[0,1,1] neg_lo:[1,0,0]
    v_cvt_pk_bf16_f32 v250, v220, v221
    v_cvt_pk_bf16_f32 v251, v222, v223
    ds_write_b64 v11, v[250:251] offset:6864
    v_pk_mul_f32 v[244:245], v[36:37], v[24:25] op_sel_hi:[1,0]
    v_pk_mul_f32 v[246:247], v[38:39], v[26:27] op_sel_hi:[1,0]
    v_pk_fma_f32 v[220:221], v[36:37], v[24:25], v[244:245] op_sel:[1,1,0] op_sel_hi:[0,1,1] neg_lo:[1,0,0]
    v_pk_fma_f32 v[222:223], v[38:39], v[26:27], v[246:247] op_sel:[1,1,0] op_sel_hi:[0,1,1] neg_lo:[1,0,0]
    v_cvt_pk_bf16_f32 v252, v220, v221
    v_cvt_pk_bf16_f32 v253, v222, v223
    ds_write_b64 v11, v[252:253] offset:7392
    v_pk_mul_f32 v[244:245], v[40:41], v[24:25] op_sel_hi:[1,0]
    v_pk_mul_f32 v[246:247], v[42:43], v[26:27] op_sel_hi:[1,0]
    v_pk_fma_f32 v[220:221], v[40:41], v[24:25], v[244:245] op_sel:[1,1,0] op_sel_hi:[0,1,1] neg_lo:[1,0,0]
    v_pk_fma_f32 v[222:223], v[42:43], v[26:27], v[246:247] op_sel:[1,1,0] op_sel_hi:[0,1,1] neg_lo:[1,0,0]
    v_cvt_pk_bf16_f32 v254, v220, v221
    v_cvt_pk_bf16_f32 v255, v222, v223
    ds_write_b64 v11, v[254:255] offset:7920
    v_pk_mul_f32 v[244:245], v[44:45], v[24:25] op_sel_hi:[1,0]
    v_pk_mul_f32 v[246:247], v[46:47], v[26:27] op_sel_hi:[1,0]
    v_pk_fma_f32 v[220:221], v[44:45], v[24:25], v[244:245] op_sel:[1,1,0] op_sel_hi:[0,1,1] neg_lo:[1,0,0]
    v_pk_fma_f32 v[222:223], v[46:47], v[26:27], v[246:247] op_sel:[1,1,0] op_sel_hi:[0,1,1] neg_lo:[1,0,0]
    v_cvt_pk_bf16_f32 v248, v220, v221
    v_cvt_pk_bf16_f32 v249, v222, v223
    ds_write_b64 v11, v[248:249] offset:8448
    ds_read_b128 v[112:115], v12 offset:0
    ds_read_b128 v[116:119], v12 offset:64
    ds_read_b128 v[120:123], v12 offset:128
    ds_read_b128 v[124:127], v12 offset:192
    ds_read_b128 v[128:131], v12 offset:256
    ds_read_b128 v[132:135], v12 offset:320
    ds_read_b128 v[136:139], v12 offset:384
    ds_read_b128 v[140:143], v12 offset:448
    v_pk_mul_f32 v[244:245], v[24:25], v[24:25] op_sel_hi:[1,0]
    v_pk_mul_f32 v[246:247], v[26:27], v[26:27] op_sel_hi:[1,0]
    v_pk_fma_f32 v[236:237], v[24:25], v[24:25], v[244:245] op_sel:[1,1,0] op_sel_hi:[0,1,1] neg_lo:[1,0,0]
    v_pk_fma_f32 v[238:239], v[26:27], v[26:27], v[246:247] op_sel:[1,1,0] op_sel_hi:[0,1,1] neg_lo:[1,0,0]
    v_cvt_pk_bf16_f32 v250, v236, v237
    v_cvt_pk_bf16_f32 v251, v238, v239
    ds_write_b64 v11, v[250:251] offset:8976
    v_pk_mul_f32 v[244:245], v[32:33], v[236:237] op_sel_hi:[1,0]
    v_pk_mul_f32 v[246:247], v[34:35], v[238:239] op_sel_hi:[1,0]
    v_pk_fma_f32 v[220:221], v[32:33], v[236:237], v[244:245] op_sel:[1,1,0] op_sel_hi:[0,1,1] neg_lo:[1,0,0]
    v_pk_fma_f32 v[222:223], v[34:35], v[238:239], v[246:247] op_sel:[1,1,0] op_sel_hi:[0,1,1] neg_lo:[1,0,0]
    v_cvt_pk_bf16_f32 v252, v220, v221
    v_cvt_pk_bf16_f32 v253, v222, v223
    ds_write_b64 v11, v[252:253] offset:9504
    v_pk_mul_f32 v[244:245], v[40:41], v[236:237] op_sel_hi:[1,0]
    v_pk_mul_f32 v[246:247], v[42:43], v[238:239] op_sel_hi:[1,0]
    v_pk_fma_f32 v[220:221], v[40:41], v[236:237], v[244:245] op_sel:[1,1,0] op_sel_hi:[0,1,1] neg_lo:[1,0,0]
    v_pk_fma_f32 v[222:223], v[42:43], v[238:239], v[246:247] op_sel:[1,1,0] op_sel_hi:[0,1,1] neg_lo:[1,0,0]
    v_cvt_pk_bf16_f32 v254, v220, v221
    v_cvt_pk_bf16_f32 v255, v222, v223
    ds_write_b64 v11, v[254:255] offset:10032
    v_pk_mul_f32 v[244:245], v[236:237], v[24:25] op_sel_hi:[1,0]
    v_pk_mul_f32 v[246:247], v[238:239], v[26:27] op_sel_hi:[1,0]
    v_pk_fma_f32 v[236:237], v[236:237], v[24:25], v[244:245] op_sel:[1,1,0] op_sel_hi:[0,1,1] neg_lo:[1,0,0]
    v_pk_fma_f32 v[238:239], v[238:239], v[26:27], v[246:247] op_sel:[1,1,0] op_sel_hi:[0,1,1] neg_lo:[1,0,0]
    v_cvt_pk_bf16_f32 v248, v236, v237
    v_cvt_pk_bf16_f32 v249, v238, v239
    ds_write_b64 v11, v[248:249] offset:10560
    v_pk_mul_f32 v[244:245], v[32:33], v[236:237] op_sel_hi:[1,0]
    v_pk_mul_f32 v[246:247], v[34:35], v[238:239] op_sel_hi:[1,0]
    v_pk_fma_f32 v[220:221], v[32:33], v[236:237], v[244:245] op_sel:[1,1,0] op_sel_hi:[0,1,1] neg_lo:[1,0,0]
    v_pk_fma_f32 v[222:223], v[34:35], v[238:239], v[246:247] op_sel:[1,1,0] op_sel_hi:[0,1,1] neg_lo:[1,0,0]
    v_cvt_pk_bf16_f32 v250, v220, v221
    v_cvt_pk_bf16_f32 v251, v222, v223
    ds_write_b64 v11, v[250:251] offset:11088
    v_pk_mul_f32 v[244:245], v[40:41], v[236:237] op_sel_hi:[1,0]
    v_pk_mul_f32 v[246:247], v[42:43], v[238:239] op_sel_hi:[1,0]
    v_pk_fma_f32 v[220:221], v[40:41], v[236:237], v[244:245] op_sel:[1,1,0] op_sel_hi:[0,1,1] neg_lo:[1,0,0]
    v_pk_fma_f32 v[222:223], v[42:43], v[238:239], v[246:247] op_sel:[1,1,0] op_sel_hi:[0,1,1] neg_lo:[1,0,0]
    v_cvt_pk_bf16_f32 v252, v220, v221
    v_cvt_pk_bf16_f32 v253, v222, v223
    ds_write_b64 v11, v[252:253] offset:11616
    v_pk_mul_f32 v[244:245], v[220:221], v[24:25] op_sel_hi:[1,0]
    v_pk_mul_f32 v[246:247], v[222:223], v[26:27] op_sel_hi:[1,0]
    v_pk_fma_f32 v[220:221], v[220:221], v[24:25], v[244:245] op_sel:[1,1,0] op_sel_hi:[0,1,1] neg_lo:[1,0,0]
    v_pk_fma_f32 v[222:223], v[222:223], v[26:27], v[246:247] op_sel:[1,1,0] op_sel_hi:[0,1,1] neg_lo:[1,0,0]
    v_cvt_pk_bf16_f32 v254, v220, v221
    v_cvt_pk_bf16_f32 v255, v222, v223
    ds_write_b64 v11, v[254:255] offset:12144
    v_pk_mul_f32 v[244:245], v[220:221], v[24:25] op_sel_hi:[1,0]
    v_pk_mul_f32 v[246:247], v[222:223], v[26:27] op_sel_hi:[1,0]
    v_pk_fma_f32 v[220:221], v[220:221], v[24:25], v[244:245] op_sel:[1,1,0] op_sel_hi:[0,1,1] neg_lo:[1,0,0]
    v_pk_fma_f32 v[222:223], v[222:223], v[26:27], v[246:247] op_sel:[1,1,0] op_sel_hi:[0,1,1] neg_lo:[1,0,0]
    v_cvt_pk_bf16_f32 v248, v220, v221
    v_cvt_pk_bf16_f32 v249, v222, v223
    ds_write_b64 v11, v[248:249] offset:12672
    v_pk_mul_f32 v[244:245], v[220:221], v[24:25] op_sel_hi:[1,0]
    v_pk_mul_f32 v[246:247], v[222:223], v[26:27] op_sel_hi:[1,0]
    v_pk_fma_f32 v[220:221], v[220:221], v[24:25], v[244:245] op_sel:[1,1,0] op_sel_hi:[0,1,1] neg_lo:[1,0,0]
    v_pk_fma_f32 v[222:223], v[222:223], v[26:27], v[246:247] op_sel:[1,1,0] op_sel_hi:[0,1,1] neg_lo:[1,0,0]
    v_cvt_pk_bf16_f32 v250, v220, v221
    v_cvt_pk_bf16_f32 v251, v222, v223
    ds_write_b64 v11, v[250:251] offset:13200
    v_pk_mul_f32 v[244:245], v[220:221], v[24:25] op_sel_hi:[1,0]
    v_pk_mul_f32 v[246:247], v[222:223], v[26:27] op_sel_hi:[1,0]
    v_pk_fma_f32 v[220:221], v[220:221], v[24:25], v[244:245] op_sel:[1,1,0] op_sel_hi:[0,1,1] neg_lo:[1,0,0]
    v_pk_fma_f32 v[222:223], v[222:223], v[26:27], v[246:247] op_sel:[1,1,0] op_sel_hi:[0,1,1] neg_lo:[1,0,0]
    v_cvt_pk_bf16_f32 v252, v220, v221
    v_cvt_pk_bf16_f32 v253, v222, v223
    ds_write_b64 v11, v[252:253] offset:13728
    ds_read_b128 v[144:147], v13 offset:0
    ds_read_b128 v[148:151], v13 offset:64
    ds_read_b128 v[152:155], v13 offset:128
    ds_read_b128 v[156:159], v13 offset:192
    ds_read_b128 v[160:163], v13 offset:256
    ds_read_b128 v[164:167], v13 offset:320
    ds_read_b128 v[168:171], v13 offset:384
    ds_read_b128 v[172:175], v13 offset:448
    s_mov_b64 exec, 0xffff
    ds_write_b64 v196, v[8:9]
    s_mov_b32 exec_lo, -1
    ds_write_b64 v197, v[8:9] offset:2080
    ds_write_b64 v198, v[8:9] offset:9472
    s_mov_b64 exec, -1
    s_waitcnt lgkmcnt(9)
    v_mfma_f32_16x16x32_bf16 v[204:207], v[112:115], v[48:51], 0
    v_mfma_f32_16x16x32_bf16 v[212:215], v[144:147], v[48:51], 0
    v_mfma_f32_16x16x32_bf16 v[204:207], v[116:119], v[52:55], v[204:207]
    v_mfma_f32_16x16x32_bf16 v[212:215], v[148:151], v[52:55], v[212:215]
    s_waitcnt lgkmcnt(7)
    v_mfma_f32_16x16x32_bf16 v[204:207], v[120:123], v[56:59], v[204:207]
    v_mfma_f32_16x16x32_bf16 v[212:215], v[152:155], v[56:59], v[212:215]
    v_mfma_f32_16x16x32_bf16 v[204:207], v[124:127], v[60:63], v[204:207]
    v_mfma_f32_16x16x32_bf16 v[212:215], v[156:159], v[60:63], v[212:215]
    s_waitcnt lgkmcnt(5)
    v_mfma_f32_16x16x32_bf16 v[204:207], v[128:131], v[64:67], v[204:207]
    v_mfma_f32_16x16x32_bf16 v[212:215], v[160:163], v[64:67], v[212:215]
    v_mfma_f32_16x16x32_bf16 v[204:207], v[132:135], v[68:71], v[204:207]
    v_mfma_f32_16x16x32_bf16 v[212:215], v[164:167], v[68:71], v[212:215]
    s_waitcnt lgkmcnt(3)
    v_mfma_f32_16x16x32_bf16 v[204:207], v[136:139], v[72:75], v[204:207]
    v_mfma_f32_16x16x32_bf16 v[212:215], v[168:171], v[72:75], v[212:215]
    v_mfma_f32_16x16x32_bf16 v[204:207], v[140:143], v[76:79], v[204:207]
    v_mfma_f32_16x16x32_bf16 v[212:215], v[172:175], v[76:79], v[212:215]
    v_mfma_f32_16x16x32_bf16 v[208:211], v[112:115], v[80:83], 0
    v_mfma_f32_16x16x32_bf16 v[216:219], v[144:147], v[80:83], 0
    v_mfma_f32_16x16x32_bf16 v[208:211], v[116:119], v[84:87], v[208:211]
    v_mfma_f32_16x16x32_bf16 v[216:219], v[148:151], v[84:87], v[216:219]
    v_mfma_f32_16x16x32_bf16 v[208:211], v[120:123], v[88:91], v[208:211]
    v_mfma_f32_16x16x32_bf16 v[216:219], v[152:155], v[88:91], v[216:219]
    v_mfma_f32_16x16x32_bf16 v[208:211], v[124:127], v[92:95], v[208:211]
    v_mfma_f32_16x16x32_bf16 v[216:219], v[156:159], v[92:95], v[216:219]
    v_mfma_f32_16x16x32_bf16 v[208:211], v[128:131], v[96:99], v[208:211]
    v_mfma_f32_16x16x32_bf16 v[216:219], v[160:163], v[96:99], v[216:219]
    v_mfma_f32_16x16x32_bf16 v[208:211], v[132:135], v[100:103], v[208:211]
    v_mfma_f32_16x16x32_bf16 v[216:219], v[164:167], v[100:103], v[216:219]
    v_mfma_f32_16x16x32_bf16 v[208:211], v[136:139], v[104:107], v[208:211]
    v_mfma_f32_16x16x32_bf16 v[216:219], v[168:171], v[104:107], v[216:219]
    v_mfma_f32_16x16x32_bf16 v[208:211], v[140:143], v[108:111], v[208:211]
    v_mfma_f32_16x16x32_bf16 v[216:219], v[172:175], v[108:111], v[216:219]
    s_lshl_b32 s4, s58, 4
    s_lshr_b64 s[6:7], s[66:67], s4
    s_lshl_b32 s6, s6, 16
    s_nop 3
    v_permlane32_swap_b32 v204, v208
    v_permlane32_swap_b32 v205, v209
    v_permlane32_swap_b32 v206, v210
    v_permlane32_swap_b32 v207, v211
    v_cvt_pk_bf16_f32 v248, v215, v219
    s_mov_b64 exec, 1
    v_add_f32 v204, s6, v204
    v_add_f32_e64 v204, 1.0, v204
    s_mov_b64 exec, -1
    v_permlane32_swap_b32 v212, v216
    v_permlane32_swap_b32 v213, v217
    v_permlane32_swap_b32 v214, v218
    ds_write_b16 v201, v248 offset:9504
    ds_write_b16_d16_hi v201, v248 offset:9520
    ds_write_b16 v201, v248 offset:9662
    ds_write_b16_d16_hi v201, v248 offset:9678
    ds_write_b16 v201, v248 offset:9820
    ds_write_b16_d16_hi v201, v248 offset:9836
    ds_write_b16 v201, v248 offset:9978
    ds_write_b16_d16_hi v201, v248 offset:9994
    v_cvt_pk_bf16_f32 v48, v204, v205
    v_cvt_pk_bf16_f32 v49, v206, v207
    ds_write_b64 v199, v[48:49] offset:32
    v_cvt_pk_bf16_f32 v50, v205, v206
    v_cvt_pk_bf16_f32 v51, v207, v212
    ds_write_b64 v199, v[50:51] offset:2400
    v_cvt_pk_bf16_f32 v52, v206, v207
    v_cvt_pk_bf16_f32 v53, v212, v213
    ds_write_b64 v199, v[52:53] offset:4768
    v_cvt_pk_bf16_f32 v54, v207, v212
    v_cvt_pk_bf16_f32 v55, v213, v214
    ds_write_b64 v199, v[54:55] offset:7136
    v_cvt_pk_bf16_f32 v56, v208, v208
    v_cvt_pk_bf16_f32 v57, v209, v210
    ds_write_b64 v199, v[56:57] offset:544
    v_cvt_pk_bf16_f32 v58, v208, v209
    v_cvt_pk_bf16_f32 v59, v210, v210
    ds_write_b64 v199, v[58:59] offset:2912
    v_cvt_pk_bf16_f32 v60, v209, v210
    v_cvt_pk_bf16_f32 v61, v210, v210
    ds_write_b64 v199, v[60:61] offset:5280
    v_cvt_pk_bf16_f32 v62, v210, v210
    v_cvt_pk_bf16_f32 v63, v210, v211
    ds_write_b64 v199, v[62:63] offset:7648
    v_cvt_pk_bf16_f32 v64, v216, v216
    v_cvt_pk_bf16_f32 v65, v216, v217
    v_cvt_pk_bf16_f32 v66, v217, v217
    v_cvt_pk_bf16_f32 v67, v218, v218
    ds_write_b128 v200, v[64:67] offset:1056
    v_cvt_pk_bf16_f32 v68, v216, v216
    v_cvt_pk_bf16_f32 v69, v217, v217
    v_cvt_pk_bf16_f32 v70, v217, v218
    v_cvt_pk_bf16_f32 v71, v218, v218
    ds_write_b128 v200, v[68:71] offset:3424
    v_cvt_pk_bf16_f32 v72, v216, v217
    v_cvt_pk_bf16_f32 v73, v217, v217
    v_cvt_pk_bf16_f32 v74, v218, v218
    v_cvt_pk_bf16_f32 v75, v218, v218
    ds_write_b128 v200, v[72:75] offset:5792
    v_cvt_pk_bf16_f32 v76, v217, v217
    v_cvt_pk_bf16_f32 v77, v217, v218
    v_cvt_pk_bf16_f32 v78, v218, v218
    v_cvt_pk_bf16_f32 v79, v218, v218
    ds_write_b128 v200, v[76:79] offset:8160
    v_cvt_pk_bf16_f32 v80, v8, v204
    v_mov_b32 v81, v50
    v_mov_b32 v82, v79
    v_cvt_pk_bf16_f32 v83, v218, v8
    s_mov_b64 exec, 1
    ds_write_b32 v202, v80 offset:2396
    ds_write_b32 v202, v48 offset:4764
    ds_write_b64 v202, v[80:81] offset:7128
    s_brev_b64 exec, 1
    ds_write_b64 v202, v[78:79] offset:2080
    ds_write_b32 v202, v83 offset:2088
    ds_write_b64 v202, v[78:79] offset:4448
    ds_write_b64 v202, v[82:83] offset:6816
    ds_write_b32 v202, v79 offset:9184
    s_mov_b64 exec, -1
    s_mov_b64 exec, 1
    ds_write_b32 v4, v5 offset:160
    s_mov_b64 exec, -1
    v_lshl_add_u32 v15, v0, 3, s10
LW_2:
    ds_read_b32 v34, v6 offset:128
    s_waitcnt lgkmcnt(0)
    v_cmp_eq_u32 vcc, 0, v34
    s_cbranch_vccnz LW_2
    ds_write_b64 v15, v[8:9] offset:4096
    v_lshlrev_b32 v7, 4, v2
    v_lshlrev_b32 v15, 5, v1
    v_sub_u32_e64 v7, v7, v15
    s_add_u32 s4, s10, 480
    v_add_u32 v7, s4, v7
    s_lshl_b32 s4, s58, 13
    s_add_u32 s4, s4, 93184
    v_lshlrev_b32_e64 v15, 6, v1
    v_lshl_add_u32 v15, v2, 4, v15
    v_add_u32 v8, s4, v15
    v_sub_u32 v204, 20, v1
    v_lshlrev_b32_e64 v205, 3, v2
    v_mov_b32 v206, 0x7f
    v_lshlrev_b32 v206, v204, v206
    v_subrev_u32 v204, 1, v204
    v_mov_b32 v207, 0x1ff
    v_lshlrev_b32 v207, v204, v207
    v_lshrrev_b32 v206, v205, v206
    v_lshrrev_b32 v207, v205, v207
    v_add_u32 v15, 1, v1
    v_and_b32 v204, 3, v15
    v_and_b32 v15, 28, v15
    v_lshl_add_u32 v208, v2, 3, v15
    v_lshl_add_u32 v208, v208, 1, s8
    v_mad_u32_u24 v1, v204, s9, v208
    v_lshlrev_b32 v208, 2, v2
    v_sub_u32 v15, v15, v208
    v_lshl_add_u32 v15, v15, 1, s8
    s_movk_i32 s4, 160
    v_mad_u32_u24 v2, v204, s4, v15
    s_mov_b32 s15, 0x3f800000
    ds_read_b64 v[48:49], v1 offset:0
    v_bfe_i32 v209, v206, 0, 1
    ds_read_b64 v[50:51], v1 offset:8
    v_bfe_i32 v210, v206, 1, 1
    ds_read_b64 v[52:53], v1 offset:64
    v_and_b32 v209, 0x3f80, v209
    ds_read_b64 v[54:55], v1 offset:72
    v_bfi_b32 v244, s15, v210, v209
    ds_read_b64 v[56:57], v1 offset:128
    v_bfe_i32 v209, v206, 2, 1
    ds_read_b64 v[58:59], v1 offset:136
    v_bfe_i32 v210, v206, 3, 1
    ds_read_b64 v[60:61], v1 offset:192
    v_and_b32 v209, 0x3f80, v209
    ds_read_b64 v[62:63], v1 offset:200
    v_bfi_b32 v245, s15, v210, v209
    ds_read_b64 v[64:65], v1 offset:256
    v_bfe_i32 v209, v206, 4, 1
    ds_read_b64 v[66:67], v1 offset:264
    v_bfe_i32 v210, v206, 5, 1
    ds_read_b64 v[68:69], v1 offset:320
    v_and_b32 v209, 0x3f80, v209
    ds_read_b64 v[70:71], v1 offset:328
    v_bfi_b32 v246, s15, v210, v209
    ds_read_b64 v[72:73], v1 offset:384
    v_bfe_i32 v209, v206, 6, 1
    ds_read_b64 v[74:75], v1 offset:392
    v_bfe_i32 v210, v206, 7, 1
    ds_read_b64 v[76:77], v1 offset:448
    v_and_b32 v209, 0x3f80, v209
    ds_read_b64 v[78:79], v1 offset:456
    v_bfi_b32 v247, s15, v210, v209
    ds_read_b64 v[80:81], v1 offset:512
    v_bfe_i32 v209, v207, 0, 1
    ds_read_b64 v[82:83], v1 offset:520
    v_bfe_i32 v210, v207, 1, 1
    ds_read_b64 v[84:85], v1 offset:576
    v_and_b32 v209, 0x3f80, v209
    ds_read_b64 v[86:87], v1 offset:584
    v_bfi_b32 v248, s15, v210, v209
    ds_read_b64 v[88:89], v1 offset:640
    v_bfe_i32 v209, v207, 2, 1
    ds_read_b64 v[90:91], v1 offset:648
    v_bfe_i32 v210, v207, 3, 1
    ds_read_b64 v[92:93], v1 offset:704
    v_and_b32 v209, 0x3f80, v209
    ds_read_b64 v[94:95], v1 offset:712
    v_bfi_b32 v249, s15, v210, v209
    ds_read_b64 v[96:97], v1 offset:768
    v_bfe_i32 v209, v207, 4, 1
    ds_read_b64 v[98:99], v1 offset:776
    v_bfe_i32 v210, v207, 5, 1
    ds_read_b64 v[100:101], v1 offset:832
    v_and_b32 v209, 0x3f80, v209
    ds_read_b64 v[102:103], v1 offset:840
    v_bfi_b32 v250, s15, v210, v209
    ds_read_b64 v[104:105], v1 offset:896
    v_bfe_i32 v209, v207, 6, 1
    ds_read_b64 v[106:107], v1 offset:904
    v_bfe_i32 v210, v207, 7, 1
    ds_read_b64 v[108:109], v1 offset:960
    v_and_b32 v209, 0x3f80, v209
    ds_read_b64 v[110:111], v1 offset:968
    v_bfi_b32 v251, s15, v210, v209
    ds_read_b64 v[112:113], v1 offset:1024
    v_lshlrev_b32_e64 v33, 4, v10
    ds_read_b64 v[114:115], v1 offset:1032
    v_add_u32 v32, 142336, v33
    ds_read_b64 v[116:117], v1 offset:1088
    s_lshl_b32 s13, s57, 14
    ds_read_b64 v[118:119], v1 offset:1096
    s_add_u32 s13, s13, 3145728
    ds_read_b64 v[120:121], v1 offset:1152
    s_and_b32 s12, s2, 7
    ds_read_b64 v[122:123], v1 offset:1160
    s_lshl_b32 s12, s12, 11
    ds_read_b64 v[124:125], v1 offset:1216
    s_lshl_b32 s4, s58, 7
    ds_read_b64 v[126:127], v1 offset:1224
    s_add_u32 s12, s12, s4
    ds_read_b64 v[128:129], v1 offset:1280
    s_lshr_b32 s4, s2, 3
    ds_read_b64 v[130:131], v1 offset:1288
    s_lshl_b32 s4, s4, 2
    ds_read_b64 v[132:133], v1 offset:1344
    s_add_u32 s12, s12, s4
    ds_read_b64 v[134:135], v1 offset:1352
    s_add_u32 s12, s12, 1015808
    ds_read_b64 v[136:137], v1 offset:1408
    v_lshlrev_b32_e64 v10, 3, v10
    ds_read_b64 v[138:139], v1 offset:1416
    v_add_u32 v9, 93184, v10
    ds_read_b64 v[140:141], v1 offset:1472
    s_mov_b32 s11, 0
    ds_read_b64 v[142:143], v1 offset:1480
    s_brev_b32 s68, 1
    ds_read_b64 v[144:145], v1 offset:1536
    ds_read_b64 v[146:147], v1 offset:1544
    ds_read_b64 v[148:149], v1 offset:1600
    ds_read_b64 v[150:151], v1 offset:1608
    ds_read_b64 v[152:153], v1 offset:1664
    ds_read_b64 v[154:155], v1 offset:1672
    ds_read_b64 v[156:157], v1 offset:1728
    ds_read_b64 v[158:159], v1 offset:1736
    ds_read_b64 v[160:161], v1 offset:1792
    ds_read_b64 v[162:163], v1 offset:1800
    ds_read_b64 v[164:165], v1 offset:1856
    ds_read_b64 v[166:167], v1 offset:1864
    ds_read_b64 v[168:169], v1 offset:1920
    ds_read_b64 v[170:171], v1 offset:1928
    ds_read_b64 v[172:173], v1 offset:1984
    ds_read_b64 v[174:175], v1 offset:1992
    ds_read_b64 v[176:177], v1 offset:2048
    ds_read_b64 v[178:179], v1 offset:2056
LW_3:
    ds_read_b32 v15, v6 offset:0
    s_waitcnt lgkmcnt(0)
    v_cmp_eq_u32 vcc, 0, v15
    s_cbranch_vccnz LW_3
    v_readfirstlane_b32 s14, v15
    ds_read_b128 v[180:183], v7 offset:4032
    ds_read_b128 v[184:187], v7 offset:3584
    ds_read_b128 v[188:191], v7 offset:3600
    ds_read_b128 v[192:195], v7 offset:3968
    ds_read_b128 v[196:199], v7 offset:3072
    s_waitcnt lgkmcnt(4)
    s_nop 0
    v_mfma_f32_16x16x32_bf16 v[204:207], v[76:79], v[180:183], 0
    ds_read_b128 v[200:203], v7 offset:3088
    v_mfma_f32_16x16x32_bf16 v[208:211], v[108:111], v[180:183], 0
    v_mfma_f32_16x16x32_bf16 v[212:215], v[140:143], v[180:183], 0
    v_mfma_f32_16x16x32_bf16 v[216:219], v[172:175], v[180:183], 0
    s_waitcnt lgkmcnt(4)
    v_mfma_f32_16x16x32_bf16 v[220:223], v[184:187], v[244:247], 0
    ds_read_b128 v[180:183], v7 offset:3904
    s_waitcnt lgkmcnt(4)
    v_mfma_f32_16x16x32_bf16 v[224:227], v[188:191], v[248:251], 0
    ds_read_b128 v[184:187], v7 offset:3840
    s_waitcnt lgkmcnt(4)
    s_nop 0
    v_mfma_f32_16x16x32_bf16 v[204:207], v[72:75], v[192:195], v[204:207]
    ds_read_b128 v[188:191], v7 offset:2560
    v_mfma_f32_16x16x32_bf16 v[208:211], v[104:107], v[192:195], v[208:211]
    v_mfma_f32_16x16x32_bf16 v[212:215], v[136:139], v[192:195], v[212:215]
    v_mfma_f32_16x16x32_bf16 v[216:219], v[168:171], v[192:195], v[216:219]
    s_waitcnt lgkmcnt(4)
    v_mfma_f32_16x16x32_bf16 v[228:231], v[196:199], v[244:247], 0
    ds_read_b128 v[192:195], v7 offset:2576
    s_waitcnt lgkmcnt(4)
    v_mfma_f32_16x16x32_bf16 v[232:235], v[200:203], v[248:251], 0
    ds_read_b128 v[196:199], v7 offset:3776
    s_waitcnt lgkmcnt(4)
    s_nop 0
    v_mfma_f32_16x16x32_bf16 v[204:207], v[68:71], v[180:183], v[204:207]
    ds_read_b128 v[200:203], v7 offset:2048
    v_mfma_f32_16x16x32_bf16 v[208:211], v[100:103], v[180:183], v[208:211]
    v_cvt_pk_bf16_f32 v236, v223, v222
    v_cvt_pk_bf16_f32 v237, v221, v220
    v_mfma_f32_16x16x32_bf16 v[212:215], v[132:135], v[180:183], v[212:215]
    v_cvt_pk_bf16_f32 v238, v227, v226
    v_cvt_pk_bf16_f32 v239, v225, v224
    v_mfma_f32_16x16x32_bf16 v[216:219], v[164:167], v[180:183], v[216:219]
    v_cvt_pk_bf16_f32 v240, v231, v230
    v_cvt_pk_bf16_f32 v241, v229, v228
    s_waitcnt lgkmcnt(4)
    s_nop 0
    v_mfma_f32_16x16x32_bf16 v[204:207], v[64:67], v[184:187], v[204:207]
    ds_read_b128 v[180:183], v7 offset:2064
    v_mfma_f32_16x16x32_bf16 v[208:211], v[96:99], v[184:187], v[208:211]
    v_cvt_pk_bf16_f32 v242, v235, v234
    v_cvt_pk_bf16_f32 v243, v233, v232
    v_mfma_f32_16x16x32_bf16 v[212:215], v[128:131], v[184:187], v[212:215]
    v_mfma_f32_16x16x32_bf16 v[216:219], v[160:163], v[184:187], v[216:219]
    s_waitcnt lgkmcnt(4)
    v_mfma_f32_16x16x32_bf16 v[220:223], v[188:191], v[244:247], 0
    ds_read_b128 v[184:187], v7 offset:3712
    s_waitcnt lgkmcnt(4)
    v_mfma_f32_16x16x32_bf16 v[224:227], v[192:195], v[248:251], 0
    ds_read_b128 v[188:191], v7 offset:3648
    s_waitcnt lgkmcnt(4)
    s_nop 0
    v_mfma_f32_16x16x32_bf16 v[204:207], v[60:63], v[196:199], v[204:207]
    ds_read_b128 v[192:195], v7 offset:3584
    v_mfma_f32_16x16x32_bf16 v[208:211], v[92:95], v[196:199], v[208:211]
    v_mfma_f32_16x16x32_bf16 v[212:215], v[124:127], v[196:199], v[212:215]
    v_mfma_f32_16x16x32_bf16 v[216:219], v[156:159], v[196:199], v[216:219]
    s_waitcnt lgkmcnt(4)
    v_mfma_f32_16x16x32_bf16 v[228:231], v[200:203], v[244:247], 0
    ds_read_b128 v[196:199], v7 offset:3520
    s_waitcnt lgkmcnt(4)
    v_mfma_f32_16x16x32_bf16 v[232:235], v[180:183], v[248:251], 0
    ds_read_b128 v[200:203], v7 offset:3456
    s_waitcnt lgkmcnt(4)
    s_nop 0
    v_mfma_f32_16x16x32_bf16 v[204:207], v[56:59], v[184:187], v[204:207]
    ds_read_b128 v[180:183], v7 offset:3392
    v_mfma_f32_16x16x32_bf16 v[208:211], v[88:91], v[184:187], v[208:211]
    v_cvt_pk_bf16_f32 v244, v223, v222
    v_cvt_pk_bf16_f32 v245, v221, v220
    v_mfma_f32_16x16x32_bf16 v[212:215], v[120:123], v[184:187], v[212:215]
    v_cvt_pk_bf16_f32 v246, v227, v226
    v_cvt_pk_bf16_f32 v247, v225, v224
    v_mfma_f32_16x16x32_bf16 v[216:219], v[152:155], v[184:187], v[216:219]
    v_cvt_pk_bf16_f32 v248, v231, v230
    v_cvt_pk_bf16_f32 v249, v229, v228
    s_waitcnt lgkmcnt(4)
    s_nop 0
    v_mfma_f32_16x16x32_bf16 v[204:207], v[52:55], v[188:191], v[204:207]
    ds_read_b128 v[184:187], v7 offset:3328
    v_mfma_f32_16x16x32_bf16 v[208:211], v[84:87], v[188:191], v[208:211]
    v_cvt_pk_bf16_f32 v250, v235, v234
    v_cvt_pk_bf16_f32 v251, v233, v232
    v_mfma_f32_16x16x32_bf16 v[212:215], v[116:119], v[188:191], v[212:215]
    v_mfma_f32_16x16x32_bf16 v[216:219], v[148:151], v[188:191], v[216:219]
    s_waitcnt lgkmcnt(4)
    s_nop 0
    v_mfma_f32_16x16x32_bf16 v[204:207], v[48:51], v[192:195], v[204:207]
    ds_read_b128 v[188:191], v7 offset:3264
    v_mfma_f32_16x16x32_bf16 v[208:211], v[80:83], v[192:195], v[208:211]
    v_mfma_f32_16x16x32_bf16 v[212:215], v[112:115], v[192:195], v[212:215]
    v_mfma_f32_16x16x32_bf16 v[216:219], v[144:147], v[192:195], v[216:219]
    v_mfma_f32_16x16x32_bf16 v[220:223], v[176:179], v[192:195], 0
    s_waitcnt lgkmcnt(4)
    s_nop 0
    v_mfma_f32_16x16x32_bf16 v[208:211], v[76:79], v[196:199], v[208:211]
    ds_read_b128 v[192:195], v7 offset:3200
    v_mfma_f32_16x16x32_bf16 v[212:215], v[108:111], v[196:199], v[212:215]
    v_mfma_f32_16x16x32_bf16 v[216:219], v[140:143], v[196:199], v[216:219]
    v_mfma_f32_16x16x32_bf16 v[220:223], v[172:175], v[196:199], v[220:223]
    s_waitcnt lgkmcnt(4)
    s_nop 0
    v_mfma_f32_16x16x32_bf16 v[208:211], v[72:75], v[200:203], v[208:211]
    ds_read_b128 v[196:199], v7 offset:3136
    v_mfma_f32_16x16x32_bf16 v[212:215], v[104:107], v[200:203], v[212:215]
    v_mfma_f32_16x16x32_bf16 v[216:219], v[136:139], v[200:203], v[216:219]
    v_mfma_f32_16x16x32_bf16 v[220:223], v[168:171], v[200:203], v[220:223]
    s_waitcnt lgkmcnt(4)
    s_nop 0
    v_mfma_f32_16x16x32_bf16 v[208:211], v[68:71], v[180:183], v[208:211]
    ds_read_b128 v[200:203], v7 offset:3072
    v_mfma_f32_16x16x32_bf16 v[212:215], v[100:103], v[180:183], v[212:215]
    v_mfma_f32_16x16x32_bf16 v[216:219], v[132:135], v[180:183], v[216:219]
    v_mfma_f32_16x16x32_bf16 v[220:223], v[164:167], v[180:183], v[220:223]
    s_waitcnt lgkmcnt(4)
    s_nop 0
    v_mfma_f32_16x16x32_bf16 v[208:211], v[64:67], v[184:187], v[208:211]
    ds_read_b128 v[180:183], v7 offset:3008
    v_mfma_f32_16x16x32_bf16 v[212:215], v[96:99], v[184:187], v[212:215]
    v_mfma_f32_16x16x32_bf16 v[216:219], v[128:131], v[184:187], v[216:219]
    v_mfma_f32_16x16x32_bf16 v[220:223], v[160:163], v[184:187], v[220:223]
    s_waitcnt lgkmcnt(4)
    s_nop 0
    v_mfma_f32_16x16x32_bf16 v[208:211], v[60:63], v[188:191], v[208:211]
    ds_read_b128 v[184:187], v7 offset:2944
    v_mfma_f32_16x16x32_bf16 v[212:215], v[92:95], v[188:191], v[212:215]
    v_mfma_f32_16x16x32_bf16 v[216:219], v[124:127], v[188:191], v[216:219]
    v_mfma_f32_16x16x32_bf16 v[220:223], v[156:159], v[188:191], v[220:223]
    s_waitcnt lgkmcnt(4)
    s_nop 0
    v_mfma_f32_16x16x32_bf16 v[208:211], v[56:59], v[192:195], v[208:211]
    ds_read_b128 v[188:191], v7 offset:2880
    v_mfma_f32_16x16x32_bf16 v[212:215], v[88:91], v[192:195], v[212:215]
    v_mfma_f32_16x16x32_bf16 v[216:219], v[120:123], v[192:195], v[216:219]
    v_mfma_f32_16x16x32_bf16 v[220:223], v[152:155], v[192:195], v[220:223]
    s_waitcnt lgkmcnt(4)
    s_nop 0
    v_mfma_f32_16x16x32_bf16 v[208:211], v[52:55], v[196:199], v[208:211]
    ds_read_b128 v[192:195], v7 offset:2816
    v_mfma_f32_16x16x32_bf16 v[212:215], v[84:87], v[196:199], v[212:215]
    v_mfma_f32_16x16x32_bf16 v[216:219], v[116:119], v[196:199], v[216:219]
    v_mfma_f32_16x16x32_bf16 v[220:223], v[148:151], v[196:199], v[220:223]
    s_waitcnt lgkmcnt(4)
    s_nop 0
    v_mfma_f32_16x16x32_bf16 v[208:211], v[48:51], v[200:203], v[208:211]
    ds_read_b128 v[196:199], v7 offset:2752
    v_mfma_f32_16x16x32_bf16 v[212:215], v[80:83], v[200:203], v[212:215]
    v_mfma_f32_16x16x32_bf16 v[216:219], v[112:115], v[200:203], v[216:219]
    v_mfma_f32_16x16x32_bf16 v[220:223], v[144:147], v[200:203], v[220:223]
    v_mfma_f32_16x16x32_bf16 v[224:227], v[176:179], v[200:203], 0
    s_waitcnt lgkmcnt(4)
    s_nop 0
    v_mfma_f32_16x16x32_bf16 v[212:215], v[76:79], v[180:183], v[212:215]
    ds_read_b128 v[200:203], v7 offset:2688
    v_mfma_f32_16x16x32_bf16 v[216:219], v[108:111], v[180:183], v[216:219]
    ds_write_b128 v8, v[204:207] offset:0
    v_mfma_f32_16x16x32_bf16 v[220:223], v[140:143], v[180:183], v[220:223]
    ds_write_b128 v8, v[208:211] offset:1024
    v_mfma_f32_16x16x32_bf16 v[224:227], v[172:175], v[180:183], v[224:227]
    s_mov_b64 exec, 1
    ds_write_b32 v4, v5 offset:144
    s_mov_b64 exec, -1
    s_waitcnt lgkmcnt(7)
    s_nop 0
    v_mfma_f32_16x16x32_bf16 v[212:215], v[72:75], v[184:187], v[212:215]
    ds_read_b128 v[180:183], v7 offset:2624
    v_mfma_f32_16x16x32_bf16 v[216:219], v[104:107], v[184:187], v[216:219]
    v_mfma_f32_16x16x32_bf16 v[220:223], v[136:139], v[184:187], v[220:223]
    v_mfma_f32_16x16x32_bf16 v[224:227], v[168:171], v[184:187], v[224:227]
    s_waitcnt lgkmcnt(7)
    s_nop 0
    v_mfma_f32_16x16x32_bf16 v[212:215], v[68:71], v[188:191], v[212:215]
    ds_read_b128 v[184:187], v7 offset:2560
    v_mfma_f32_16x16x32_bf16 v[216:219], v[100:103], v[188:191], v[216:219]
    ds_read_b32 v11, v6 offset:144
    v_mfma_f32_16x16x32_bf16 v[220:223], v[132:135], v[188:191], v[220:223]
    ds_read_b32 v15, v6 offset:112
    v_mfma_f32_16x16x32_bf16 v[224:227], v[164:167], v[188:191], v[224:227]
    s_waitcnt lgkmcnt(9)
    v_mfma_f32_16x16x32_bf16 v[212:215], v[64:67], v[192:195], v[212:215]
    ds_read_b128 v[188:191], v7 offset:2496
    v_mfma_f32_16x16x32_bf16 v[216:219], v[96:99], v[192:195], v[216:219]
    s_waitcnt lgkmcnt(1)
    v_min_u32 v11, v11, v15
    v_cmp_eq_u32_e64 vcc, 0, v11
    s_cbranch_vccnz L_SLOW0
L_BACK0:
    v_mfma_f32_16x16x32_bf16 v[220:223], v[128:131], v[192:195], v[220:223]
    ds_read_b64 v[12:13], v10 offset:1152
    v_mfma_f32_16x16x32_bf16 v[224:227], v[160:163], v[192:195], v[224:227]
    ds_read_b128 v[16:19], v32 offset:0
    v_mfma_f32_16x16x32_bf16 v[212:215], v[60:63], v[196:199], v[212:215]
    ds_read_b128 v[192:195], v7 offset:2432
    v_mfma_f32_16x16x32_bf16 v[216:219], v[92:95], v[196:199], v[216:219]
    ds_read_b64 v[204:205], v9 offset:0
    v_mfma_f32_16x16x32_bf16 v[220:223], v[124:127], v[196:199], v[220:223]
    ds_read_b64 v[206:207], v9 offset:8192
    v_mfma_f32_16x16x32_bf16 v[224:227], v[156:159], v[196:199], v[224:227]
    ds_read_b64 v[208:209], v9 offset:16384
    v_mfma_f32_16x16x32_bf16 v[212:215], v[56:59], v[200:203], v[212:215]
    ds_read_b128 v[196:199], v7 offset:2368
    v_mfma_f32_16x16x32_bf16 v[216:219], v[88:91], v[200:203], v[216:219]
    ds_read_b64 v[210:211], v9 offset:24576
    s_waitcnt lgkmcnt(0)
    v_lshlrev_b32 v20, 16, v16
    v_mfma_f32_16x16x32_bf16 v[220:223], v[120:123], v[200:203], v[220:223]
    v_and_b32 v21, 0xffff0000, v16
    v_lshlrev_b32_e64 v22, 16, v17
    v_mfma_f32_16x16x32_bf16 v[224:227], v[152:155], v[200:203], v[224:227]
    v_and_b32 v23, 0xffff0000, v17
    v_lshlrev_b32_e64 v24, 16, v18
    v_mfma_f32_16x16x32_bf16 v[212:215], v[52:55], v[180:183], v[212:215]
    ds_read_b128 v[200:203], v7 offset:2304
    v_mfma_f32_16x16x32_bf16 v[216:219], v[84:87], v[180:183], v[216:219]
    v_and_b32 v25, 0xffff0000, v18
    v_lshlrev_b32_e64 v26, 16, v19
    v_mfma_f32_16x16x32_bf16 v[220:223], v[116:119], v[180:183], v[220:223]
    v_and_b32 v27, 0xffff0000, v19
    v_add_f32_e64 v20, v204, v20
    v_mfma_f32_16x16x32_bf16 v[224:227], v[148:151], v[180:183], v[224:227]
    v_add_f32 v21, v206, v21
    v_add_f32 v22, v208, v22
    v_mfma_f32_16x16x32_bf16 v[212:215], v[48:51], v[184:187], v[212:215]
    ds_read_b64 v[180:181], v2 offset:9496
    ds_read_b64 v[182:183], v2 offset:10136
    v_mfma_f32_16x16x32_bf16 v[216:219], v[80:83], v[184:187], v[216:219]
    v_add_f32 v23, v210, v23
    v_add_f32 v24, v205, v24
    v_mfma_f32_16x16x32_bf16 v[220:223], v[112:115], v[184:187], v[220:223]
    v_add_f32_e64 v25, v207, v25
    v_mfma_f32_16x16x32_bf16 v[224:227], v[144:147], v[184:187], v[224:227]
    v_add_f32_e64 v26, v209, v26
    v_mfma_f32_16x16x32_bf16 v[228:231], v[176:179], v[184:187], 0
    v_add_f32_e64 v27, v211, v27
    v_mfma_f32_16x16x32_bf16 v[216:219], v[76:79], v[188:191], v[216:219]
    ds_read_b128 v[184:187], v7 offset:2240
    v_mfma_f32_16x16x32_bf16 v[220:223], v[108:111], v[188:191], v[220:223]
    v_cvt_pk_bf16_f32 v204, v20, v21
    v_mfma_f32_16x16x32_bf16 v[224:227], v[140:143], v[188:191], v[224:227]
    v_cvt_pk_bf16_f32 v205, v22, v23
    v_mfma_f32_16x16x32_bf16 v[228:231], v[172:175], v[188:191], v[228:231]
    v_cvt_pk_bf16_f32 v206, v24, v25
    v_mfma_f32_16x16x32_bf16 v[216:219], v[72:75], v[192:195], v[216:219]
    ds_read_b128 v[188:191], v7 offset:2176
    v_mfma_f32_16x16x32_bf16 v[220:223], v[104:107], v[192:195], v[220:223]
    v_cvt_pk_bf16_f32 v207, v26, v27
    v_mfma_f32_16x16x32_bf16 v[224:227], v[136:139], v[192:195], v[224:227]
    s_cmp_lg_u32 s14, 2
    s_cbranch_scc1 L_ES0
    buffer_store_dwordx4 v[204:207], v33, s[44:47], s13 offen
L_EB0:
    s_add_u32 s13, s13, 0x1000
    v_mfma_f32_16x16x32_bf16 v[228:231], v[168:171], v[192:195], v[228:231]
    v_mfma_f32_16x16x32_bf16 v[216:219], v[68:71], v[196:199], v[216:219]
    ds_read_b128 v[192:195], v7 offset:2112
    v_mfma_f32_16x16x32_bf16 v[220:223], v[100:103], v[196:199], v[220:223]
    v_mfma_f32_16x16x32_bf16 v[224:227], v[132:135], v[196:199], v[224:227]
    v_mfma_f32_16x16x32_bf16 v[228:231], v[164:167], v[196:199], v[228:231]
    s_waitcnt lgkmcnt(5)
    s_nop 0
    v_mfma_f32_16x16x32_bf16 v[216:219], v[64:67], v[200:203], v[216:219]
    ds_read_b128 v[196:199], v7 offset:2048
    v_mfma_f32_16x16x32_bf16 v[220:223], v[96:99], v[200:203], v[220:223]
    v_mfma_f32_16x16x32_bf16 v[224:227], v[128:131], v[200:203], v[224:227]
    v_mfma_f32_16x16x32_bf16 v[228:231], v[160:163], v[200:203], v[228:231]
    s_waitcnt lgkmcnt(4)
    v_mfma_f32_16x16x32_bf16 v[220:223], v[236:239], v[180:183], v[220:223]
    ds_read_b128 v[200:203], v7 offset:1984
    v_mfma_f32_16x16x32_bf16 v[224:227], v[240:243], v[180:183], v[224:227]
    s_waitcnt lgkmcnt(4)
    v_mfma_f32_16x16x32_bf16 v[216:219], v[60:63], v[184:187], v[216:219]
    ds_read_b128 v[180:183], v7 offset:1920
    v_mfma_f32_16x16x32_bf16 v[220:223], v[92:95], v[184:187], v[220:223]
    v_mfma_f32_16x16x32_bf16 v[224:227], v[124:127], v[184:187], v[224:227]
    v_mfma_f32_16x16x32_bf16 v[228:231], v[156:159], v[184:187], v[228:231]
    s_waitcnt lgkmcnt(4)
    s_nop 0
    v_mfma_f32_16x16x32_bf16 v[216:219], v[56:59], v[188:191], v[216:219]
    ds_read_b128 v[184:187], v7 offset:1856
    v_mfma_f32_16x16x32_bf16 v[220:223], v[88:91], v[188:191], v[220:223]
    v_mfma_f32_16x16x32_bf16 v[224:227], v[120:123], v[188:191], v[224:227]
    v_mfma_f32_16x16x32_bf16 v[228:231], v[152:155], v[188:191], v[228:231]
    s_waitcnt lgkmcnt(4)
    s_nop 0
    v_mfma_f32_16x16x32_bf16 v[216:219], v[52:55], v[192:195], v[216:219]
    ds_read_b128 v[188:191], v7 offset:1792
    v_mfma_f32_16x16x32_bf16 v[220:223], v[84:87], v[192:195], v[220:223]
    v_mfma_f32_16x16x32_bf16 v[224:227], v[116:119], v[192:195], v[224:227]
    v_mfma_f32_16x16x32_bf16 v[228:231], v[148:151], v[192:195], v[228:231]
    s_waitcnt lgkmcnt(4)
    s_nop 0
    v_mfma_f32_16x16x32_bf16 v[216:219], v[48:51], v[196:199], v[216:219]
    ds_read_b64 v[192:193], v2 offset:9528
    ds_read_b64 v[194:195], v2 offset:10168
    v_mfma_f32_16x16x32_bf16 v[220:223], v[80:83], v[196:199], v[220:223]
    v_mfma_f32_16x16x32_bf16 v[224:227], v[112:115], v[196:199], v[224:227]
    v_mfma_f32_16x16x32_bf16 v[228:231], v[144:147], v[196:199], v[228:231]
    v_mfma_f32_16x16x32_bf16 v[232:235], v[176:179], v[196:199], 0
    s_waitcnt lgkmcnt(5)
    s_nop 0
    v_mfma_f32_16x16x32_bf16 v[220:223], v[76:79], v[200:203], v[220:223]
    ds_read_b128 v[196:199], v7 offset:1728
    v_mfma_f32_16x16x32_bf16 v[224:227], v[108:111], v[200:203], v[224:227]
    ds_write_b128 v8, v[212:215] offset:2048
    v_mfma_f32_16x16x32_bf16 v[228:231], v[140:143], v[200:203], v[228:231]
    ds_write_b128 v8, v[216:219] offset:3072
    v_mfma_f32_16x16x32_bf16 v[232:235], v[172:175], v[200:203], v[232:235]
    s_mov_b64 exec, 1
    ds_write_b32 v4, v5 offset:16
    s_mov_b64 exec, -1
    s_waitcnt lgkmcnt(8)
    s_nop 0
    v_mfma_f32_16x16x32_bf16 v[220:223], v[72:75], v[180:183], v[220:223]
    ds_read_b128 v[200:203], v7 offset:1664
    v_mfma_f32_16x16x32_bf16 v[224:227], v[104:107], v[180:183], v[224:227]
    v_mfma_f32_16x16x32_bf16 v[228:231], v[136:139], v[180:183], v[228:231]
    v_mfma_f32_16x16x32_bf16 v[232:235], v[168:171], v[180:183], v[232:235]
    s_waitcnt lgkmcnt(8)
    s_nop 0
    v_mfma_f32_16x16x32_bf16 v[220:223], v[68:71], v[184:187], v[220:223]
    ds_read_b128 v[180:183], v7 offset:1600
    v_mfma_f32_16x16x32_bf16 v[224:227], v[100:103], v[184:187], v[224:227]
    ds_read_b32 v11, v6 offset:16
    v_mfma_f32_16x16x32_bf16 v[228:231], v[132:135], v[184:187], v[228:231]
    v_mfma_f32_16x16x32_bf16 v[232:235], v[164:167], v[184:187], v[232:235]
    s_waitcnt lgkmcnt(9)
    v_mfma_f32_16x16x32_bf16 v[220:223], v[64:67], v[188:191], v[220:223]
    ds_read_b128 v[184:187], v7 offset:1536
    v_mfma_f32_16x16x32_bf16 v[224:227], v[96:99], v[188:191], v[224:227]
    s_waitcnt lgkmcnt(1)
    v_cmp_eq_u32 vcc, 0, v11
    s_cbranch_vccnz L_SLOW1
L_BACK1:
    v_mfma_f32_16x16x32_bf16 v[228:231], v[128:131], v[188:191], v[228:231]
    ds_read_b128 v[16:19], v32 offset:4096
    v_mfma_f32_16x16x32_bf16 v[232:235], v[160:163], v[188:191], v[232:235]
    ds_read_b64 v[212:213], v9 offset:2048
    v_mfma_f32_16x16x32_bf16 v[224:227], v[236:239], v[192:195], v[224:227]
    ds_read_b128 v[188:191], v7 offset:1472
    ds_read_b64 v[214:215], v9 offset:10240
    v_mfma_f32_16x16x32_bf16 v[220:223], v[60:63], v[196:199], v[220:223]
    ds_read_b128 v[192:195], v7 offset:1408
    v_mfma_f32_16x16x32_bf16 v[224:227], v[92:95], v[196:199], v[224:227]
    ds_read_b64 v[216:217], v9 offset:18432
    ds_read_b64 v[218:219], v9 offset:26624
    v_mfma_f32_16x16x32_bf16 v[228:231], v[124:127], v[196:199], v[228:231]
    s_waitcnt lgkmcnt(0)
    v_lshlrev_b32 v20, 16, v16
    v_and_b32 v21, 0xffff0000, v16
    v_mfma_f32_16x16x32_bf16 v[232:235], v[156:159], v[196:199], v[232:235]
    v_lshlrev_b32_e64 v22, 16, v17
    v_and_b32 v23, 0xffff0000, v17
    v_mfma_f32_16x16x32_bf16 v[220:223], v[56:59], v[200:203], v[220:223]
    ds_read_b128 v[196:199], v7 offset:1344
    v_mfma_f32_16x16x32_bf16 v[224:227], v[88:91], v[200:203], v[224:227]
    v_lshlrev_b32_e64 v24, 16, v18
    v_and_b32 v25, 0xffff0000, v18
    v_mfma_f32_16x16x32_bf16 v[228:231], v[120:123], v[200:203], v[228:231]
    v_lshlrev_b32_e64 v26, 16, v19
    v_and_b32 v27, 0xffff0000, v19
    v_mfma_f32_16x16x32_bf16 v[232:235], v[152:155], v[200:203], v[232:235]
    v_add_f32 v20, v212, v20
    v_add_f32 v21, v214, v21
    v_mfma_f32_16x16x32_bf16 v[220:223], v[52:55], v[180:183], v[220:223]
    ds_read_b128 v[200:203], v7 offset:1280
    v_mfma_f32_16x16x32_bf16 v[224:227], v[84:87], v[180:183], v[224:227]
    v_add_f32 v22, v216, v22
    v_add_f32 v23, v218, v23
    v_mfma_f32_16x16x32_bf16 v[228:231], v[116:119], v[180:183], v[228:231]
    v_add_f32 v24, v213, v24
    v_add_f32 v25, v215, v25
    v_mfma_f32_16x16x32_bf16 v[232:235], v[148:151], v[180:183], v[232:235]
    v_add_f32_e64 v26, v217, v26
    v_mfma_f32_16x16x32_bf16 v[220:223], v[48:51], v[184:187], v[220:223]
    ds_read_b128 v[180:183], v7 offset:1216
    v_mfma_f32_16x16x32_bf16 v[224:227], v[80:83], v[184:187], v[224:227]
    v_add_f32_e64 v27, v219, v27
    v_mfma_f32_16x16x32_bf16 v[228:231], v[112:115], v[184:187], v[228:231]
    v_cvt_pk_bf16_f32 v212, v20, v21
    v_mfma_f32_16x16x32_bf16 v[232:235], v[144:147], v[184:187], v[232:235]
    v_cvt_pk_bf16_f32 v213, v22, v23
    v_mfma_f32_16x16x32_bf16 v[224:227], v[76:79], v[188:191], v[224:227]
    ds_read_b128 v[184:187], v7 offset:1152
    v_mfma_f32_16x16x32_bf16 v[228:231], v[108:111], v[188:191], v[228:231]
    v_cvt_pk_bf16_f32 v214, v24, v25
    v_mfma_f32_16x16x32_bf16 v[232:235], v[140:143], v[188:191], v[232:235]
    v_cvt_pk_bf16_f32 v215, v26, v27
    v_mfma_f32_16x16x32_bf16 v[224:227], v[72:75], v[192:195], v[224:227]
    ds_read_b128 v[188:191], v7 offset:1088
    v_mfma_f32_16x16x32_bf16 v[228:231], v[104:107], v[192:195], v[228:231]
    s_cmp_lg_u32 s14, 2
    s_cbranch_scc1 L_ES1
    buffer_store_dwordx4 v[212:215], v33, s[44:47], s13 offen
L_EB1:
    s_add_u32 s13, s13, 0x1000
    v_mfma_f32_16x16x32_bf16 v[232:235], v[136:139], v[192:195], v[232:235]
    s_waitcnt vmcnt(0)
    s_mov_b64 exec, 1
    buffer_store_dword v34, off, s[44:47], s12 offset:0
    s_mov_b64 exec, -1
    s_waitcnt lgkmcnt(4)
    v_mfma_f32_16x16x32_bf16 v[224:227], v[68:71], v[196:199], v[224:227]
    ds_read_b128 v[192:195], v7 offset:1024
    v_mfma_f32_16x16x32_bf16 v[228:231], v[100:103], v[196:199], v[228:231]
    v_mfma_f32_16x16x32_bf16 v[232:235], v[132:135], v[196:199], v[232:235]
    s_waitcnt lgkmcnt(4)
    v_mfma_f32_16x16x32_bf16 v[224:227], v[64:67], v[200:203], v[224:227]
    ds_read_b128 v[196:199], v7 offset:960
    v_mfma_f32_16x16x32_bf16 v[228:231], v[96:99], v[200:203], v[228:231]
    v_mfma_f32_16x16x32_bf16 v[232:235], v[128:131], v[200:203], v[232:235]
    s_waitcnt lgkmcnt(4)
    v_mfma_f32_16x16x32_bf16 v[224:227], v[60:63], v[180:183], v[224:227]
    ds_read_b128 v[200:203], v7 offset:896
    v_mfma_f32_16x16x32_bf16 v[228:231], v[92:95], v[180:183], v[228:231]
    v_mfma_f32_16x16x32_bf16 v[232:235], v[124:127], v[180:183], v[232:235]
    s_waitcnt lgkmcnt(4)
    s_nop 0
    v_mfma_f32_16x16x32_bf16 v[224:227], v[56:59], v[184:187], v[224:227]
    ds_read_b64 v[180:181], v2 offset:9496
    ds_read_b64 v[182:183], v2 offset:10136
    v_mfma_f32_16x16x32_bf16 v[228:231], v[88:91], v[184:187], v[228:231]
    v_mfma_f32_16x16x32_bf16 v[232:235], v[120:123], v[184:187], v[232:235]
    s_waitcnt lgkmcnt(5)
    v_mfma_f32_16x16x32_bf16 v[224:227], v[52:55], v[188:191], v[224:227]
    ds_read_b128 v[184:187], v7 offset:832
    v_mfma_f32_16x16x32_bf16 v[228:231], v[84:87], v[188:191], v[228:231]
    v_mfma_f32_16x16x32_bf16 v[232:235], v[116:119], v[188:191], v[232:235]
    s_waitcnt lgkmcnt(5)
    v_mfma_f32_16x16x32_bf16 v[224:227], v[48:51], v[192:195], v[224:227]
    ds_read_b128 v[188:191], v7 offset:768
    v_mfma_f32_16x16x32_bf16 v[228:231], v[80:83], v[192:195], v[228:231]
    v_mfma_f32_16x16x32_bf16 v[232:235], v[112:115], v[192:195], v[232:235]
    s_waitcnt lgkmcnt(5)
    s_nop 0
    v_mfma_f32_16x16x32_bf16 v[228:231], v[76:79], v[196:199], v[228:231]
    ds_read_b128 v[192:195], v7 offset:704
    ds_write_b128 v8, v[220:223] offset:4096
    v_mfma_f32_16x16x32_bf16 v[232:235], v[108:111], v[196:199], v[232:235]
    ds_write_b128 v8, v[224:227] offset:5120
    s_mov_b64 exec, 1
    ds_write_b32 v4, v5 offset:32
    s_mov_b64 exec, -1
    s_waitcnt lgkmcnt(8)
    v_mfma_f32_16x16x32_bf16 v[228:231], v[72:75], v[200:203], v[228:231]
    ds_read_b64 v[196:197], v2 offset:9528
    ds_read_b64 v[198:199], v2 offset:10168
    v_mfma_f32_16x16x32_bf16 v[232:235], v[104:107], v[200:203], v[232:235]
    s_waitcnt lgkmcnt(8)
    v_mfma_f32_16x16x32_bf16 v[228:231], v[244:247], v[180:183], v[228:231]
    ds_read_b128 v[200:203], v7 offset:640
    v_mfma_f32_16x16x32_bf16 v[232:235], v[248:251], v[180:183], v[232:235]
    s_waitcnt lgkmcnt(8)
    v_mfma_f32_16x16x32_bf16 v[228:231], v[68:71], v[184:187], v[228:231]
    ds_read_b128 v[180:183], v7 offset:576
    ds_read_b32 v11, v6 offset:32
    v_mfma_f32_16x16x32_bf16 v[232:235], v[100:103], v[184:187], v[232:235]
    s_waitcnt lgkmcnt(9)
    v_mfma_f32_16x16x32_bf16 v[228:231], v[64:67], v[188:191], v[228:231]
    ds_read_b64 v[184:185], v2 offset:9560
    ds_read_b64 v[186:187], v2 offset:10200
    v_mfma_f32_16x16x32_bf16 v[232:235], v[96:99], v[188:191], v[232:235]
    s_waitcnt lgkmcnt(10)
    v_mfma_f32_16x16x32_bf16 v[228:231], v[60:63], v[192:195], v[228:231]
    ds_read_b128 v[188:191], v7 offset:512
    s_waitcnt lgkmcnt(3)
    v_cmp_eq_u32 vcc, 0, v11
    s_cbranch_vccnz L_SLOW2
L_BACK2:
    v_mfma_f32_16x16x32_bf16 v[232:235], v[92:95], v[192:195], v[232:235]
    ds_read_b128 v[16:19], v32 offset:8192
    ds_read_b64 v[220:221], v9 offset:4096
    v_mfma_f32_16x16x32_bf16 v[228:231], v[240:243], v[196:199], v[228:231]
    ds_read_b128 v[192:195], v7 offset:448
    ds_read_b64 v[222:223], v9 offset:12288
    v_mfma_f32_16x16x32_bf16 v[232:235], v[244:247], v[196:199], v[232:235]
    ds_read_b64 v[224:225], v9 offset:20480
    ds_read_b64 v[226:227], v9 offset:28672
    v_mfma_f32_16x16x32_bf16 v[228:231], v[56:59], v[200:203], v[228:231]
    ds_read_b128 v[196:199], v7 offset:384
    s_waitcnt vmcnt(0)
    s_mov_b64 exec, 1
    buffer_store_dword v34, off, s[44:47], s12 offset:512
    s_mov_b64 exec, -1
    v_mfma_f32_16x16x32_bf16 v[232:235], v[88:91], v[200:203], v[232:235]
    v_mfma_f32_16x16x32_bf16 v[228:231], v[52:55], v[180:183], v[228:231]
    ds_read_b128 v[200:203], v7 offset:320
    s_waitcnt lgkmcnt(2)
    v_lshlrev_b32_e64 v20, 16, v16
    v_mfma_f32_16x16x32_bf16 v[232:235], v[84:87], v[180:183], v[232:235]
    v_and_b32 v21, 0xffff0000, v16
    v_lshlrev_b32_e64 v22, 16, v17
    v_mfma_f32_16x16x32_bf16 v[228:231], v[236:239], v[184:187], v[228:231]
    ds_read_b64 v[180:181], v2 offset:9592
    ds_read_b64 v[182:183], v2 offset:10232
    v_and_b32 v23, 0xffff0000, v17
    v_mfma_f32_16x16x32_bf16 v[232:235], v[240:243], v[184:187], v[232:235]
    v_lshlrev_b32_e64 v24, 16, v18
    v_and_b32 v25, 0xffff0000, v18
    v_mfma_f32_16x16x32_bf16 v[228:231], v[48:51], v[188:191], v[228:231]
    ds_read_b128 v[184:187], v7 offset:256
    v_lshlrev_b32_e64 v26, 16, v19
    v_mfma_f32_16x16x32_bf16 v[232:235], v[80:83], v[188:191], v[232:235]
    v_and_b32 v27, 0xffff0000, v19
    v_add_f32_e64 v20, v220, v20
    v_mfma_f32_16x16x32_bf16 v[232:235], v[76:79], v[192:195], v[232:235]
    ds_read_b128 v[188:191], v7 offset:192
    v_add_f32_e64 v21, v222, v21
    ds_write_b128 v8, v[228:231] offset:6144
    s_waitcnt lgkmcnt(6)
    v_mfma_f32_16x16x32_bf16 v[232:235], v[72:75], v[196:199], v[232:235]
    ds_read_b128 v[192:195], v7 offset:128
    v_add_f32_e64 v22, v224, v22
    s_waitcnt lgkmcnt(6)
    v_mfma_f32_16x16x32_bf16 v[232:235], v[68:71], v[200:203], v[232:235]
    ds_read_b128 v[196:199], v7 offset:64
    v_add_f32 v23, v226, v23
    s_waitcnt lgkmcnt(5)
    v_mfma_f32_16x16x32_bf16 v[232:235], v[236:239], v[180:183], v[232:235]
    ds_read_b128 v[200:203], v7 offset:0
    v_add_f32 v24, v221, v24
    s_waitcnt lgkmcnt(5)
    v_mfma_f32_16x16x32_bf16 v[232:235], v[64:67], v[184:187], v[232:235]
    v_add_f32 v25, v223, v25
    v_add_f32_e64 v26, v225, v26
    s_waitcnt lgkmcnt(4)
    v_mfma_f32_16x16x32_bf16 v[232:235], v[60:63], v[188:191], v[232:235]
    v_add_f32_e64 v27, v227, v27
    v_cvt_pk_bf16_f32 v220, v20, v21
    s_waitcnt lgkmcnt(2)
    v_mfma_f32_16x16x32_bf16 v[232:235], v[56:59], v[192:195], v[232:235]
    v_cvt_pk_bf16_f32 v221, v22, v23
    v_cvt_pk_bf16_f32 v222, v24, v25
    s_waitcnt lgkmcnt(1)
    v_mfma_f32_16x16x32_bf16 v[232:235], v[52:55], v[196:199], v[232:235]
    v_cvt_pk_bf16_f32 v223, v26, v27
    s_cmp_lg_u32 s14, 2
    s_cbranch_scc1 L_ES2
    buffer_store_dwordx4 v[220:223], v33, s[44:47], s13 offen
L_EB2:
    s_add_u32 s13, s13, 0x1000
    s_waitcnt lgkmcnt(0)
    v_mfma_f32_16x16x32_bf16 v[232:235], v[48:51], v[200:203], v[232:235]
    ds_read_b128 v[16:19], v32 offset:12288
    s_nop 6
    ds_write_b128 v8, v[232:235] offset:7168
    s_mov_b64 exec, 1
    ds_write_b32 v4, v5 offset:48
    s_mov_b64 exec, -1
    s_waitcnt vmcnt(0)
    s_mov_b64 exec, 1
    buffer_store_dword v34, off, s[44:47], s12 offset:1024
    s_mov_b64 exec, -1
    s_waitcnt lgkmcnt(2)
    v_lshlrev_b32_e64 v20, 16, v16
    v_and_b32 v21, 0xffff0000, v16
    v_lshlrev_b32_e64 v22, 16, v17
    v_and_b32 v23, 0xffff0000, v17
    v_lshlrev_b32_e64 v24, 16, v18
    v_and_b32 v25, 0xffff0000, v18
    v_lshlrev_b32_e64 v26, 16, v19
    v_and_b32 v27, 0xffff0000, v19
LW_4:
    ds_read_b32 v11, v6 offset:48
    s_waitcnt lgkmcnt(0)
    v_cmp_eq_u32_e64 vcc, 0, v11
    s_cbranch_vccnz LW_4
    ds_read_b64 v[228:229], v9 offset:6144
    ds_read_b64 v[230:231], v9 offset:14336
    ds_read_b64 v[232:233], v9 offset:22528
    ds_read_b64 v[234:235], v9 offset:30720
    s_waitcnt lgkmcnt(0)
    v_add_f32 v20, v228, v20
    v_add_f32 v21, v230, v21
    v_add_f32 v22, v232, v22
    v_add_f32 v23, v234, v23
    v_add_f32 v24, v229, v24
    v_add_f32 v25, v231, v25
    v_add_f32 v26, v233, v26
    v_add_f32_e64 v27, v235, v27
    v_cvt_pk_bf16_f32 v228, v20, v21
    v_cvt_pk_bf16_f32 v229, v22, v23
    v_cvt_pk_bf16_f32 v230, v24, v25
    v_cvt_pk_bf16_f32 v231, v26, v27
    s_cmp_lg_u32 s14, 2
    s_cbranch_scc1 L_ES3
    buffer_store_dwordx4 v[228:231], v33, s[44:47], s13 offen
L_EB3:
    s_add_u32 s13, s13, 0x1000
    s_waitcnt vmcnt(0)
    s_mov_b64 exec, 1
    buffer_store_dword v34, off, s[44:47], s12 offset:1536
    s_mov_b64 exec, -1
    s_branch L_FIN
L_SLOW0:
LW_5:
    ds_read_b32 v11, v6 offset:144
    s_waitcnt lgkmcnt(0)
    v_cmp_eq_u32_e64 vcc, 0, v11
    s_cbranch_vccnz LW_5
LW_6:
    ds_read_b32 v11, v6 offset:112
    s_waitcnt lgkmcnt(0)
    v_cmp_eq_u32 vcc, 0, v11
    s_cbranch_vccnz LW_6
    s_branch L_BACK0
L_SLOW1:
LW_7:
    ds_read_b32 v11, v6 offset:16
    s_waitcnt lgkmcnt(0)
    v_cmp_eq_u32 vcc, 0, v11
    s_cbranch_vccnz LW_7
    s_branch L_BACK1
L_SLOW2:
LW_8:
    ds_read_b32 v11, v6 offset:32
    s_waitcnt lgkmcnt(0)
    v_cmp_eq_u32 vcc, 0, v11
    s_cbranch_vccnz LW_8
    s_branch L_BACK2
L_ES0:
    v_lshlrev_b32_e64 v14, 24, v12
    v_and_or_b32 v14, v14, s68, v3
    v_lshlrev_b32_e64 v15, 16, v12
    v_and_or_b32 v15, v15, s68, v3
    buffer_store_dwordx2 v[204:205], v14, s[52:55], s60 offen offset:0
    buffer_store_dwordx2 v[206:207], v15, s[52:55], s60 offen offset:2048
    s_branch L_EB0
L_ES1:
    v_lshlrev_b32 v14, 8, v12
    v_and_or_b32 v14, v14, s68, v3
    v_and_or_b32 v15, v12, s68, v3
    buffer_store_dwordx2 v[212:213], v14, s[52:55], s61 offen offset:0
    buffer_store_dwordx2 v[214:215], v15, s[52:55], s61 offen offset:2048
    s_branch L_EB1
L_ES2:
    v_lshlrev_b32 v14, 24, v13
    v_and_or_b32 v14, v14, s68, v3
    v_lshlrev_b32_e64 v15, 16, v13
    v_and_or_b32 v15, v15, s68, v3
    buffer_store_dwordx2 v[220:221], v14, s[52:55], s62 offen offset:0
    buffer_store_dwordx2 v[222:223], v15, s[52:55], s62 offen offset:2048
    s_branch L_EB2
L_ES3:
    v_lshlrev_b32 v14, 8, v13
    v_and_or_b32 v14, v14, s68, v3
    v_and_or_b32 v15, v13, s68, v3
    buffer_store_dwordx2 v[228:229], v14, s[52:55], s63 offen offset:0
    buffer_store_dwordx2 v[230:231], v15, s[52:55], s63 offen offset:2048
    s_branch L_EB3
L_F0:
    s_setprio 2
    s_mov_b32 s61, 32768
    s_lshl_b32 s7, s2, 2
    s_add_u32 s7, s7, s3
    s_lshl_b32 s13, s2, 7
    s_add_u32 s13, s13, 32768
    s_lshl_b32 s8, s7, 12
    v_and_b32 v10, 31, v0
    v_lshlrev_b32 v10, 4, v10
    v_lshrrev_b32_e64 v11, 5, v0
    v_lshl_add_u32 v11, v11, 11, v10
    v_add_u32 v11, s8, v11
    s_cmp_lt_u32 s6, 28
    s_cselect_b32 s69, 1, 0
    s_lshr_b32 s8, s6, 2
    s_add_u32 s9, s5, 3
    s_and_b32 s9, s9, 7
    s_min_u32 s9, s9, 6
    s_cmp_lt_u32 s6, 28
    s_cselect_b32 s8, s8, s9
    s_mul_i32 s59, s5, 7
    s_add_u32 s59, s59, s8
    s_and_b32 s68, s6, 3
    s_lshl_b32 s8, s68, 2
    s_add_u32 s8, s8, s3
    s_lshl_b32 s8, s8, 6
    s_xor_b32 s9, s69, 1
    s_lshl_b32 s9, s9, 5
    s_add_u32 s8, s8, s9
    v_lshrrev_b32_e64 v12, 4, v0
    v_lshl_add_u32 v12, v12, 3, s8
    v_lshlrev_b32 v9, 1, v12
    s_movk_i32 s10, 7168
    v_mul_u32_u24 v14, s10, v12
    v_and_b32 v12, 7, v0
    v_lshl_add_u32 v14, v12, 4, v14
    s_lshl_b32 s8, s59, 7
    v_add_u32 v14, s8, v14
    v_and_b32 v12, 8, v0
    v_cmp_ne_u32_e64 vcc, 0, v12
    s_waitcnt lgkmcnt(0)
    global_load_dwordx4 v[16:19], v11, s[16:17] offset:0
    global_load_dwordx4 v[20:23], v11, s[16:17] offset:512
    global_load_dwordx4 v[24:27], v11, s[16:17] offset:1024
    global_load_dwordx4 v[28:31], v11, s[16:17] offset:1536
    s_load_dword s56, s[42:43], 0
    global_load_dwordx4 v[32:35], v10, s[32:33] offset:0
    global_load_dwordx4 v[36:39], v10, s[32:33] offset:512
    global_load_dwordx4 v[40:43], v10, s[32:33] offset:1024
    global_load_dwordx4 v[44:47], v10, s[32:33] offset:1536
    v_mov_b32 v12, s34
    v_mov_b32 v13, s35
    v_mov_b32 v10, s36
    v_mov_b32 v11, s37
    v_cndmask_b32 v12, v12, v10, vcc
    v_cndmask_b32 v13, v13, v11, vcc
    v_add_co_u32 v102, vcc, v12, v14
    s_movk_i32 s20, 7168
    s_mov_b32 s21, 0
    v_addc_co_u32 v103, vcc, 0, v13, vcc
    s_barrier
    s_mov_b32 s48, s16
    s_and_b32 s49, s17, 0xffff
    s_mov_b32 s50, 0x400000
    s_mov_b32 s51, 0x20000
    s_lshl_b32 s8, s6, 17
    s_lshl_b32 s9, s3, 15
    s_add_u32 s8, s8, s9
    s_lshl_b32 s9, s5, 8
    s_add_u32 s8, s8, s9
    s_add_u32 s9, s8, 4096
    v_lshrrev_b32 v10, 4, v0
    v_and_b32 v11, 15, v0
    v_lshlrev_b32 v11, 4, v11
    v_lshl_add_u32 v14, v10, 13, v11
    buffer_load_dwordx4 v[64:67], v14, s[48:51], s8 offen offset:0
    buffer_load_dwordx4 v[68:71], v14, s[48:51], s8 offen offset:2048
    buffer_load_dwordx4 v[72:75], v14, s[48:51], s9 offen offset:0
    buffer_load_dwordx4 v[76:79], v14, s[48:51], s9 offen offset:2048
    s_mul_i32 s8, s3, 4608
    s_add_u32 s8, s8, 17408
    s_movk_i32 s9, 1088
    v_mad_u32_u24 v96, v10, s9, v11
    v_add_u32 v96, s8, v96
    v_and_b32 v10, 7, v0
    v_lshrrev_b32_e64 v11, 3, v0
    s_movk_i32 s9, 544
    v_lshl_add_u32 v97, v11, 3, s8
    v_mad_u32_u24 v97, v10, s9, v97
    v_lshlrev_b32_e64 v98, 4, v10
    v_lshl_add_u32 v98, v11, 14, v98
    s_lshl_b32 s18, s5, 19
    s_lshl_b32 s9, s6, 9
    s_add_u32 s18, s18, s9
    s_lshl_b32 s9, s3, 7
    s_add_u32 s18, s18, s9
    s_add_u32 s18, s18, 3145728
    s_getreg_b32 s19, hwreg(HW_REG_XCC_ID, 0, 4)
    s_mov_b32 s22, 179200
    s_mov_b32 s23, 0
    s_lshl_b32 s62, s5, 7
    s_add_u32 s62, s62, 983040
    v_lshlrev_b32 v99, 10, v0
    s_mov_b32 s44, s42
    s_and_b32 s45, s43, 0xffff
    s_mov_b32 s46, 0x1000000
    s_mov_b32 s47, 0x20000
    s_mov_b32 s52, s40
    s_and_b32 s53, s41, 0xffff
    s_mov_b32 s54, 0x400000
    s_mov_b32 s55, 0x20000
    s_mov_b32 s24, s38
    s_and_b32 s25, s39, 0xffff
    s_mov_b32 s26, 0x700000
    s_mov_b32 s27, 0x20000
    s_lshl_b32 s7, s3, 2
    v_mov_b32 v2, s7
    v_and_b32 v11, 3, v0
    v_lshlrev_b32 v1, 2, v11
    v_mov_b32 v5, 1
    s_lshl_b32 s8, s3, 6
    v_add_u32 v14, s8, v0
    v_lshrrev_b32 v10, 2, v14
    v_lshlrev_b32_e64 v226, 7, v10
    v_lshl_add_u32 v226, v11, 4, v226
    s_mov_b32 s5, 40960
    s_mov_b32 s6, 49152
    s_mov_b32 s7, 57344
    s_mov_b32 s8, 0x3f803f80
    s_waitcnt vmcnt(8)
    s_nop 0
    v_dot2_f32_bf16 v48, v16, s8, 0
    v_dot2_f32_bf16 v49, v16, v16, 0
    v_dot2_f32_bf16 v48, v17, s8, v48
    v_dot2_f32_bf16 v49, v17, v17, v49
    v_dot2_f32_bf16 v48, v18, s8, v48
    v_dot2_f32_bf16 v49, v18, v18, v49
    v_dot2_f32_bf16 v48, v19, s8, v48
    v_dot2_f32_bf16 v49, v19, v19, v49
    v_dot2_f32_bf16 v48, v20, s8, v48
    v_dot2_f32_bf16 v49, v20, v20, v49
    v_dot2_f32_bf16 v48, v21, s8, v48
    v_dot2_f32_bf16 v49, v21, v21, v49
    v_dot2_f32_bf16 v48, v22, s8, v48
    v_dot2_f32_bf16 v49, v22, v22, v49
    v_dot2_f32_bf16 v48, v23, s8, v48
    v_dot2_f32_bf16 v49, v23, v23, v49
    v_dot2_f32_bf16 v48, v24, s8, v48
    v_dot2_f32_bf16 v49, v24, v24, v49
    v_dot2_f32_bf16 v48, v25, s8, v48
    v_dot2_f32_bf16 v49, v25, v25, v49
    v_dot2_f32_bf16 v48, v26, s8, v48
    v_dot2_f32_bf16 v49, v26, v26, v49
    v_dot2_f32_bf16 v48, v27, s8, v48
    v_dot2_f32_bf16 v49, v27, v27, v49
    v_dot2_f32_bf16 v48, v28, s8, v48
    v_dot2_f32_bf16 v49, v28, v28, v49
    v_dot2_f32_bf16 v48, v29, s8, v48
    v_dot2_f32_bf16 v49, v29, v29, v49
    v_dot2_f32_bf16 v48, v30, s8, v48
    v_dot2_f32_bf16 v49, v30, v30, v49
    v_dot2_f32_bf16 v48, v31, s8, v48
    v_dot2_f32_bf16 v49, v31, v31, v49
    s_waitcnt lgkmcnt(0)
    s_mul_i32 s56, s56, 0x9E3779B1
    s_add_u32 s56, s56, 0x7F4A7C15
    s_or_b32 s56, s56, 1
    v_mov_b32 v59, s56
    v_mov_b32 v100, s56
    v_mov_b32 v101, s19
    s_waitcnt vmcnt(4)
    v_dot2_f32_bf16 v50, v16, v32, 0
    v_dot2_f32_bf16 v51, v32, s8, 0
    v_dot2_f32_bf16 v50, v17, v33, v50
    v_dot2_f32_bf16 v51, v33, s8, v51
    v_dot2_f32_bf16 v50, v18, v34, v50
    v_dot2_f32_bf16 v51, v34, s8, v51
    v_dot2_f32_bf16 v50, v19, v35, v50
    v_dot2_f32_bf16 v51, v35, s8, v51
    v_dot2_f32_bf16 v50, v20, v36, v50
    v_dot2_f32_bf16 v51, v36, s8, v51
    v_dot2_f32_bf16 v50, v21, v37, v50
    v_dot2_f32_bf16 v51, v37, s8, v51
    v_dot2_f32_bf16 v50, v22, v38, v50
    v_dot2_f32_bf16 v51, v38, s8, v51
    v_dot2_f32_bf16 v50, v23, v39, v50
    v_dot2_f32_bf16 v51, v39, s8, v51
    v_dot2_f32_bf16 v50, v24, v40, v50
    v_dot2_f32_bf16 v51, v40, s8, v51
    v_dot2_f32_bf16 v50, v25, v41, v50
    v_dot2_f32_bf16 v51, v41, s8, v51
    v_dot2_f32_bf16 v50, v26, v42, v50
    v_dot2_f32_bf16 v51, v42, s8, v51
    v_dot2_f32_bf16 v50, v27, v43, v50
    v_dot2_f32_bf16 v51, v43, s8, v51
    v_dot2_f32_bf16 v50, v28, v44, v50
    v_dot2_f32_bf16 v51, v44, s8, v51
    v_dot2_f32_bf16 v50, v29, v45, v50
    v_dot2_f32_bf16 v51, v45, s8, v51
    v_dot2_f32_bf16 v50, v30, v46, v50
    v_dot2_f32_bf16 v51, v46, s8, v51
    v_dot2_f32_bf16 v50, v31, v47, v50
    v_dot2_f32_bf16 v51, v47, s8, v51
    s_nop 0
    s_nop 0
    v_add_f32_dpp v48, v48, v48 row_shr:1 row_mask:0xf bank_mask:0xf
    v_add_f32_dpp v49, v49, v49 row_shr:1 row_mask:0xf bank_mask:0xf
    v_add_f32_dpp v50, v50, v50 row_shr:1 row_mask:0xf bank_mask:0xf
    v_add_f32_dpp v51, v51, v51 row_shr:1 row_mask:0xf bank_mask:0xf
    v_add_f32_dpp v48, v48, v48 row_shr:2 row_mask:0xf bank_mask:0xf
    v_add_f32_dpp v49, v49, v49 row_shr:2 row_mask:0xf bank_mask:0xf
    v_add_f32_dpp v50, v50, v50 row_shr:2 row_mask:0xf bank_mask:0xf
    v_add_f32_dpp v51, v51, v51 row_shr:2 row_mask:0xf bank_mask:0xf
    v_add_f32_dpp v48, v48, v48 row_shr:4 row_mask:0xf bank_mask:0xf
    v_add_f32_dpp v49, v49, v49 row_shr:4 row_mask:0xf bank_mask:0xf
    v_add_f32_dpp v50, v50, v50 row_shr:4 row_mask:0xf bank_mask:0xf
    v_add_f32_dpp v51, v51, v51 row_shr:4 row_mask:0xf bank_mask:0xf
    v_add_f32_dpp v48, v48, v48 row_shr:8 row_mask:0xf bank_mask:0xf
    v_add_f32_dpp v49, v49, v49 row_shr:8 row_mask:0xf bank_mask:0xf
    v_add_f32_dpp v50, v50, v50 row_shr:8 row_mask:0xf bank_mask:0xf
    v_add_f32_dpp v51, v51, v51 row_shr:8 row_mask:0xf bank_mask:0xf
    v_add_f32_dpp v48, v48, v48 row_bcast:15 row_mask:0xa bank_mask:0xf
    v_add_f32_dpp v49, v49, v49 row_bcast:15 row_mask:0xa bank_mask:0xf
    v_add_f32_dpp v50, v50, v50 row_bcast:15 row_mask:0xa bank_mask:0xf
    v_add_f32_dpp v51, v51, v51 row_bcast:15 row_mask:0xa bank_mask:0xf
    v_mul_f32 v48, 0x3a800000, v48
    v_mul_f32 v49, 0x3a800000, v49
    v_cvt_pk_bf16_f32 v52, v48, v48
    v_fma_f32 v49, -v48, v48, v49
    v_max_f32_e64 v49, 0, v49
    v_and_b32 v53, 0xffff0000, v52
    v_cvt_pk_bf16_f32 v49, v49, v49
    v_and_b32 v49, 0xffff0000, v49
    v_add_f32 v49, 0x3727c5ac, v49
    v_fma_f32 v50, -v53, v51, v50
    v_cvt_pk_bf16_f32 v49, v49, v49
    v_and_b32 v49, 0xffff0000, v49
    v_sqrt_f32 v49, v49
    v_lshlrev_b32 v10, 2, v2
    v_lshlrev_b32 v11, 4, v0
    v_mov_b32 v61, 0
    v_cvt_pk_bf16_f32 v54, v49, v49
    v_and_b32 v49, 0xffff0000, v54
    v_rcp_f32 v49, v49
    s_nop 0
    v_mul_f32_e64 v50, v50, v49
    v_cvt_pk_bf16_f32 v50, v50, v50
    v_bfe_i32 v51, v50, 15, 1
    v_or_b32 v51, 0x80008000, v51
    v_xor_b32_e64 v55, v50, v51
    s_mov_b32 s8, 0xffff
    v_mov_b32_dpp v56, v52 row_bcast:31 row_mask:0x8 bank_mask:0xf
    v_mov_b32_dpp v57, v54 row_bcast:31 row_mask:0x8 bank_mask:0xf
    v_mov_b32_dpp v58, v55 row_bcast:31 row_mask:0x8 bank_mask:0xf
    v_bfi_b32 v56, s8, v56, v52
    v_bfi_b32 v57, s8, v57, v54
    v_bfi_b32 v58, s8, v58, v55
    s_brev_b64 exec, 1
    ds_write_b128 v10, v[56:59] offset:576
    ds_add_rtn_u32 v60, v61, v5 offset:512
    s_mov_b64 exec, -1
    s_waitcnt lgkmcnt(0)
    v_readlane_b32 s8, v60, 63
    s_cmp_lg_u32 s8, 3
    s_cbranch_scc1 L_NOPUB
    s_mov_b64 exec, 0xf
    ds_read_b128 v[52:55], v11 offset:576
    s_waitcnt lgkmcnt(0)
    buffer_store_dwordx4 v[52:55], v11, s[44:47], s13 offen sc1
    ds_write_b32 v61, v5 offset:516
    s_mov_b64 exec, -1
    s_waitcnt vmcnt(1)
    s_branch L_PUB2
L_NOPUB:
    s_waitcnt vmcnt(0)
L_PUB2:
    s_nop 0
    ds_write_b128 v96, v[64:67] offset:0
    ds_write_b128 v96, v[68:71] offset:272
    ds_write_b128 v96, v[72:75] offset:544
    ds_write_b128 v96, v[76:79] offset:816
    ds_read_b64 v[80:81], v97 offset:0
    ds_read_b64 v[82:83], v97 offset:272
    ds_read_b64 v[84:85], v97 offset:64
    ds_read_b64 v[86:87], v97 offset:336
    ds_read_b64 v[88:89], v97 offset:128
    ds_read_b64 v[90:91], v97 offset:400
    ds_read_b64 v[92:93], v97 offset:192
    ds_read_b64 v[94:95], v97 offset:464
    s_waitcnt lgkmcnt(6)
    buffer_store_dwordx4 v[80:83], v98, s[44:47], s18 offen
    s_add_u32 s18, s18, 0x20000
    s_waitcnt lgkmcnt(4)
    buffer_store_dwordx4 v[84:87], v98, s[44:47], s18 offen
    s_add_u32 s18, s18, 0x20000
    s_waitcnt lgkmcnt(2)
    buffer_store_dwordx4 v[88:91], v98, s[44:47], s18 offen
    s_add_u32 s18, s18, 0x20000
    s_waitcnt lgkmcnt(0)
    buffer_store_dwordx4 v[92:95], v98, s[44:47], s18 offen
    s_add_u32 s18, s18, 0x20000
    s_mov_b64 exec, 1
    ds_write_b32 v2, v59 offset:128
    s_mov_b64 exec, -1
LW_9:
    ds_read_b32 v60, v61 offset:516
    s_waitcnt lgkmcnt(0)
    v_cmp_eq_u32_e64 vcc, 0, v60
    s_cbranch_vccnz LW_9
    s_waitcnt vmcnt(0)
    s_mov_b64 exec, 1
    ds_add_rtn_u32 v60, v61, v5 offset:520
    s_waitcnt lgkmcnt(0)
    v_readfirstlane_b32 s8, v60
    s_cmp_lg_u32 s8, 3
    s_cbranch_scc1 L_NOXF0
    s_add_u32 s13, s13, 950272
    buffer_store_dwordx2 v[100:101], v61, s[44:47], s13 offen sc1
    ds_write_b32 v61, v5 offset:524
L_NOXF0:
    s_mov_b64 exec, -1
LW_10:
    ds_read_b32 v60, v61 offset:524
    s_waitcnt lgkmcnt(0)
    v_cmp_eq_u32 vcc, 0, v60
    s_cbranch_vccnz LW_10
    global_load_dwordx4 v[112:115], v[102:103], off
    v_lshl_add_u64 v[102:103], s[20:21], 0, v[102:103]
    global_load_dwordx4 v[116:119], v[102:103], off
    v_lshl_add_u64 v[102:103], s[20:21], 0, v[102:103]
    global_load_dwordx4 v[120:123], v[102:103], off
    v_lshl_add_u64 v[102:103], s[20:21], 0, v[102:103]
    global_load_dwordx4 v[124:127], v[102:103], off
    v_lshl_add_u64 v[102:103], s[20:21], 0, v[102:103]
    global_load_dwordx4 v[128:131], v[102:103], off
    v_lshl_add_u64 v[102:103], s[20:21], 0, v[102:103]
    global_load_dwordx4 v[132:135], v[102:103], off
    v_lshl_add_u64 v[102:103], s[20:21], 0, v[102:103]
    global_load_dwordx4 v[136:139], v[102:103], off
    v_lshl_add_u64 v[102:103], s[20:21], 0, v[102:103]
    global_load_dwordx4 v[140:143], v[102:103], off
    v_lshl_add_u64 v[102:103], s[22:23], 0, v[102:103]
    s_cmp_lg_u32 s3, 0
    s_cbranch_scc1 L_NOZ
    v_lshlrev_b32 v224, 4, v0
    v_mov_b32 v228, 0
    v_mov_b32 v229, 0
    v_mov_b32 v230, 0
    v_mov_b32_e64 v231, 0
    ds_write_b128 v224, v[228:231] offset:1024
    ds_write_b128 v224, v[228:231] offset:2048
    ds_write_b128 v224, v[228:231] offset:3072
L_NOZ:
    s_lshl_b32 s4, s3, 6
    v_add_u32 v14, s4, v0
    v_lshlrev_b32_e64 v15, 4, v14
    s_mov_b32 s64, 0x05040100
    s_mov_b32 s65, 0x07060302
    v_lshlrev_b32 v224, 4, v0
    v_and_b32 v10, 15, v0
    v_lshlrev_b32 v10, 2, v10
    v_and_b32 v11, 48, v0
    s_movk_i32 s4, 0xfff
    v_lshlrev_b32 v248, 1, v14
    v_sub_u32 v248, s4, v248
    v_subrev_u32 v249, 1, v248
    v_subrev_u32 v250, 512, v248
    v_subrev_u32 v251, 513, v248
    v_subrev_u32 v252, 1024, v248
    v_subrev_u32 v253, 1025, v248
    v_subrev_u32 v254, 1536, v248
    v_subrev_u32 v255, 1537, v248
    v_lshlrev_b32 v227, 3, v14
    v_lshrrev_b32 v225, 4, v14
    v_lshlrev_b32 v225, 2, v225
    v_lshlrev_b32_e64 v14, 2, v14
    s_mov_b32 s16, 0
    s_mov_b32 s17, 0xffff0000
    v_lshlrev_b32 v3, 3, v11
    s_lshl_b32 s8, s3, 12
    s_add_u32 s8, s8, 125952
    v_add_u32 v3, s8, v3
    v_lshrrev_b32 v12, 5, v0
    v_lshlrev_b32_e64 v4, 7, v12
    v_bfe_u32 v12, v0, 4, 1
    v_lshl_add_u32 v4, v12, 3, v4
    v_bfe_u32 v12, v0, 3, 1
    v_lshl_add_u32 v4, v12, 9, v4
    v_and_b32_e64 v12, 7, v0
    v_lshl_add_u32 v4, v12, 4, v4
    s_lshl_b32 s8, s3, 10
    s_add_u32 s8, s8, 125952
    v_add_u32 v4, s8, v4
    v_bfe_u32 v12, v0, 4, 1
    v_lshlrev_b32 v12, 16, v12
    v_lshrrev_b32 v13, 5, v0
    v_lshl_add_u32 v12, v13, 12, v12
    v_lshl_add_u32 v12, v10, 1, v12
    s_lshl_b32 s10, s59, 17
    s_lshl_b32 s11, s68, 9
    s_add_u32 s10, s10, s11
    s_lshl_b32 s11, s3, 7
    s_add_u32 s10, s10, s11
    s_nop 0
    v_mov_b32 v208, 0x3f803f80
    v_mov_b32 v209, 0x3f803f80
    v_mov_b32 v210, 0x3f803f80
    v_mov_b32 v211, 0x3f803f80
    v_mov_b32 v212, 0x3f803f80
    v_mov_b32 v213, 0x3f803f80
    v_mov_b32 v214, 0x3f803f80
    v_mov_b32 v215, 0x3f803f80
    v_sub_u32 v56, 18428, v14
    v_add_u32 v57, 142336, v15
    v_mov_b32 v58, v15
    s_lshl_b32 s13, s57, 14
    s_add_u32 s13, s13, 3145728
    s_mov_b32 s63, 0
    buffer_load_dwordx4 v[32:35], v226, s[44:47], s61 offen sc1
    buffer_load_dwordx4 v[36:39], v226, s[44:47], s5 offen sc1
    buffer_load_dwordx4 v[40:43], v226, s[44:47], s6 offen sc1
    buffer_load_dwordx4 v[44:47], v226, s[44:47], s7 offen sc1
    s_mov_b32 exec_hi, 0
    buffer_load_dwordx2 v[96:97], v99, s[44:47], s62 offen sc1
    s_mov_b32 exec_hi, -1
    s_branch L_KPW
L_KP:
    s_sleep 1
    s_mov_b64 exec, s[30:31]
    s_cbranch_execz L_KS0
    buffer_load_dwordx4 v[32:35], v226, s[44:47], s61 offen sc1
L_KS0:
    s_mov_b64 exec, s[8:9]
    s_cbranch_execz L_KS1
    buffer_load_dwordx4 v[36:39], v226, s[44:47], s5 offen sc1
L_KS1:
    s_mov_b64 exec, s[14:15]
    s_cbranch_execz L_KS2
    buffer_load_dwordx4 v[40:43], v226, s[44:47], s6 offen sc1
L_KS2:
    s_mov_b64 exec, s[28:29]
    s_cbranch_execz L_KS3
    buffer_load_dwordx4 v[44:47], v226, s[44:47], s7 offen sc1
L_KS3:
    s_mov_b64 exec, -1
    s_cmp_lg_u32 s63, 0
    s_cbranch_scc1 L_KPW
    s_mov_b32 exec_hi, 0
    buffer_load_dwordx2 v[96:97], v99, s[44:47], s62 offen sc1
    s_mov_b32 exec_hi, -1
L_KPW:
    s_waitcnt vmcnt(0)
    s_add_u32 s16, s16, 1
    v_cmp_ne_u32 s[30:31], s56, v35
    v_cmp_ne_u32 s[8:9], s56, v39
    v_cmp_ne_u32 s[14:15], s56, v43
    v_cmp_ne_u32 s[28:29], s56, v47
    s_cmp_lg_u32 s63, 0
    s_cbranch_scc1 L_XBACK0
    v_cmp_ne_u32 vcc, s56, v96
    s_cmp_lg_u32 vcc_lo, 0
    s_cbranch_scc1 L_XBACK0
    v_cmp_ne_u32 vcc, s19, v97
    s_mov_b32 s63, 1
    s_cmp_eq_u32 vcc_lo, 0
    s_cselect_b32 s60, 2, 1
    s_cbranch_scc0 L_XSLOW
    buffer_load_dwordx4 v[64:67], v58, s[44:47], s13 offen sc1
    s_add_u32 s13, s13, 0x1000
    buffer_load_dwordx4 v[68:71], v58, s[44:47], s13 offen sc1
    s_add_u32 s13, s13, 0x1000
    buffer_load_dwordx4 v[72:75], v58, s[44:47], s13 offen sc1
    s_add_u32 s13, s13, 0x1000
    buffer_load_dwordx4 v[76:79], v58, s[44:47], s13 offen sc1
    s_add_u32 s13, s13, 0x1000
L_XBACK0:
    s_or_b64 vcc, s[30:31], s[8:9]
    s_or_b64 s[66:67], s[14:15], s[28:29]
    s_or_b64 vcc, vcc, s[66:67]
    s_cbranch_vccz L_KPOK
    s_cmp_lt_u32 s16, 0x4000
    s_cbranch_scc1 L_KP
L_KPOK:
    s_cmp_lg_u32 s63, 0
    s_cbranch_scc1 L_KP2
    s_mov_b32 exec_hi, 0
    buffer_load_dwordx2 v[96:97], v99, s[44:47], s62 offen sc1
    s_mov_b32 exec_hi, -1
L_KP2:
    s_nop 0
    ds_write2st64_b64 v227, v[32:33], v[36:37] offset0:18 offset1:22
    ds_write2st64_b64 v227, v[40:41], v[44:45] offset0:26 offset1:30
    v_lshl_or_b32 v248, v34, 16, v248
    v_and_or_b32 v249, v34, s17, v249
    v_lshl_or_b32 v250, v38, 16, v250
    v_and_or_b32 v251, v38, s17, v251
    v_lshl_or_b32 v252, v42, 16, v252
    v_and_or_b32 v253, v42, s17, v253
    v_lshl_or_b32 v254, v46, 16, v254
    v_and_or_b32 v255, v46, s17, v255
    v_max_u32 v226, v248, v249
    v_min_u32 v227, v248, v249
    v_max_u32 v228, v252, v253
    v_min_u32 v229, v252, v253
    v_med3_u32 v227, v226, v227, v250
    v_med3_u32 v229, v228, v229, v254
    v_max_u32 v226, v226, v250
    v_max_u32 v228, v228, v254
    v_med3_u32 v227, v226, v227, v251
    v_med3_u32 v229, v228, v229, v255
    v_max_u32 v226, v226, v251
    v_max_u32 v228, v228, v255
    v_min_u32 v230, v226, v228
    v_max_u32 v226, v226, v228
    v_max3_u32 v227, v227, v229, v230
    ds_write_b32 v14, v226 offset:8192
    v_add_u32 v15, 4096, v15
    v_max_u32_dpp v226, v226, v226 row_shr:1 row_mask:0xf bank_mask:0xf
    v_max_u32_dpp v227, v227, v227 row_shr:1 row_mask:0xf bank_mask:0xf
    ds_write2_b32 v15, v34, v38 offset0:0 offset1:1
    v_max_u32_dpp v226, v226, v226 row_shr:2 row_mask:0xf bank_mask:0xf
    v_max_u32_dpp v227, v227, v227 row_shr:2 row_mask:0xf bank_mask:0xf
    ds_write2_b32 v15, v42, v46 offset0:2 offset1:3
    v_max_u32_dpp v226, v226, v226 row_shr:4 row_mask:0xf bank_mask:0xf
    v_max_u32_dpp v227, v227, v227 row_shr:4 row_mask:0xf bank_mask:0xf
    s_nop 0
    s_nop 0
    v_max_u32_dpp v226, v226, v226 row_shr:8 row_mask:0xf bank_mask:0xf
    v_max_u32_dpp v227, v227, v227 row_shr:8 row_mask:0xf bank_mask:0xf
    s_mov_b32 exec_lo, 0x80008000
    s_mov_b32 exec_hi, 0x80008000
    ds_write2_b32 v225, v226, v227 offset0:96 offset1:112
    s_mov_b64 exec, 1
    ds_write_b32 v2, v5 offset:64
    s_mov_b64 exec, -1
    s_cmp_lg_u32 s63, 0
    s_cbranch_scc1 L_XBACK1
    s_mov_b32 s16, 0
    s_branch L_XPW
L_XP:
    s_cmp_ge_u32 s16, 0x4000
    s_cbranch_scc1 L_XBACK1
    s_sleep 1
    s_mov_b32 exec_hi, 0
    buffer_load_dwordx2 v[96:97], v99, s[44:47], s62 offen sc1
    s_mov_b32 exec_hi, -1
L_XPW:
    s_add_u32 s16, s16, 1
    s_waitcnt vmcnt(0)
    v_cmp_ne_u32 vcc, s56, v96
    s_cmp_lg_u32 vcc_lo, 0
    s_cbranch_scc1 L_XP
    v_cmp_ne_u32 vcc, s19, v97
    s_mov_b32 s63, 2
    s_cmp_eq_u32 vcc_lo, 0
    s_cselect_b32 s60, 2, 1
    s_cbranch_scc0 L_XSLOW
    buffer_load_dwordx4 v[64:67], v58, s[44:47], s13 offen sc1
    s_add_u32 s13, s13, 0x1000
    buffer_load_dwordx4 v[68:71], v58, s[44:47], s13 offen sc1
    s_add_u32 s13, s13, 0x1000
    buffer_load_dwordx4 v[72:75], v58, s[44:47], s13 offen sc1
    s_add_u32 s13, s13, 0x1000
    buffer_load_dwordx4 v[76:79], v58, s[44:47], s13 offen sc1
    s_add_u32 s13, s13, 0x1000
L_XBACK1:
    s_cmp_eq_u32 s69, 0
    s_cbranch_scc1 L_NG5
    global_load_dwordx4 v[144:147], v[102:103], off
    v_lshl_add_u64 v[102:103], s[20:21], 0, v[102:103]
    global_load_dwordx4 v[148:151], v[102:103], off
    v_lshl_add_u64 v[102:103], s[20:21], 0, v[102:103]
    global_load_dwordx4 v[152:155], v[102:103], off
    v_lshl_add_u64 v[102:103], s[20:21], 0, v[102:103]
    global_load_dwordx4 v[156:159], v[102:103], off
    v_lshl_add_u64 v[102:103], s[20:21], 0, v[102:103]
    global_load_dwordx4 v[160:163], v[102:103], off
    v_lshl_add_u64 v[102:103], s[20:21], 0, v[102:103]
    global_load_dwordx4 v[164:167], v[102:103], off
    v_lshl_add_u64 v[102:103], s[20:21], 0, v[102:103]
    global_load_dwordx4 v[168:171], v[102:103], off
    v_lshl_add_u64 v[102:103], s[20:21], 0, v[102:103]
    global_load_dwordx4 v[172:175], v[102:103], off
L_NG5:
LW_11:
    ds_read_b32 v225, v1 offset:64
    s_waitcnt lgkmcnt(0)
    v_cmp_eq_u32_e64 vcc, 0, v225
    s_cbranch_vccnz LW_11
    ds_read2_b32 v[226:227], v10 offset0:96 offset1:112
    ds_read_b128 v[228:231], v11 offset:384
    ds_read_b128 v[232:235], v224 offset:8192
    s_waitcnt lgkmcnt(1)
    v_cmp_gt_u32 vcc, v228, v226
    v_cmp_gt_u32 s[8:9], v229, v226
    v_cmp_gt_u32 s[14:15], v230, v226
    v_cmp_gt_u32 s[28:29], v231, v226
    v_cndmask_b32 v236, 0, 1, vcc
    v_cndmask_b32 v237, 0, 1, s[8:9]
    v_addc_co_u32 v236, vcc, 0, v236, s[14:15]
    v_addc_co_u32 v236, vcc, v237, v236, s[28:29]
    v_mov_b32 v237, v236
    s_nop 1
    v_permlane32_swap_b32 v236, v237
    v_add_u32 v236, v236, v237
    v_mov_b32 v237, v236
    s_nop 1
    v_permlane16_swap_b32 v236, v237
    v_add_u32 v236, v236, v237
    v_cmp_eq_u32 vcc, 7, v236
    s_ff1_i32_b32 s5, vcc_lo
    v_readlane_b32 s4, v226, s5
    s_waitcnt lgkmcnt(0)
    s_nop 0
    v_cmp_le_u32 vcc, s4, v227
    s_cbranch_vccnz L_SLOWT
L_CAND:
    v_cmp_le_u32 s[8:9], s4, v232
    v_cmp_le_u32 s[14:15], s4, v233
    v_cmp_le_u32 s[28:29], s4, v234
    v_cmp_le_u32 s[30:31], s4, v235
    s_bcnt1_i32_b64 s5, s[8:9]
    s_bcnt1_i32_b64 s6, s[14:15]
    s_bcnt1_i32_b64 s7, s[28:29]
    s_bcnt1_i32_b64 s16, s[30:31]
    s_add_u32 s6, s6, s5
    s_add_u32 s7, s7, s6
    s_add_u32 s16, s16, s7
    s_cmp_gt_u32 s16, 15
    s_cbranch_scc1 L_TRIM
    v_mbcnt_lo_u32_b32 v236, s8, 0
    v_mbcnt_hi_u32_b32 v236, s9, v236
    v_add_lshl_u32 v236, v236, 0, 2
    s_mov_b64 exec, s[8:9]
    ds_write_b32 v236, v232 offset:192
    s_mov_b64 exec, -1
    v_mbcnt_lo_u32_b32 v237, s14, 0
    v_mbcnt_hi_u32_b32 v237, s15, v237
    v_add_lshl_u32 v237, v237, s5, 2
    s_mov_b64 exec, s[14:15]
    ds_write_b32 v237, v233 offset:192
    s_mov_b64 exec, -1
    v_mbcnt_lo_u32_b32 v238, s28, 0
    v_mbcnt_hi_u32_b32 v238, s29, v238
    v_add_lshl_u32 v238, v238, s6, 2
    s_mov_b64 exec, s[28:29]
    ds_write_b32 v238, v234 offset:192
    s_mov_b64 exec, -1
    v_mbcnt_lo_u32_b32 v239, s30, 0
    v_mbcnt_hi_u32_b32 v239, s31, v239
    v_add_lshl_u32 v239, v239, s7, 2
    s_mov_b64 exec, s[30:31]
    ds_write_b32 v239, v235 offset:192
    s_mov_b64 exec, -1
    s_movk_i32 s4, 0x7ff
    ds_read_b32 v16, v10 offset:192
    ds_read_b128 v[20:23], v11 offset:192
    s_cmp_lg_u32 s69, 1
    s_waitcnt lgkmcnt(1)
    v_bfi_b32 v14, v16, 0, s4
    s_cbranch_scc1 L_NOXS
    s_nop 0
    v_lshl_add_u32 v15, v14, 11, v9
    s_mov_b32 exec_lo, 0x7fff7fff
    s_mov_b32 exec_hi, 0x7fff7fff
    buffer_load_dwordx4 v[208:211], v15, s[48:51], 0 offen
    buffer_load_dwordx4 v[212:215], v15, s[48:51], 0 offen offset:64
    s_mov_b64 exec, -1
    v_lshrrev_b32 v15, 1, v14
    v_lshlrev_b32_e64 v15, 3, v15
    ds_read_b64 v[8:9], v15 offset:9216
    v_lshlrev_b32_e64 v15, 11, v0
    buffer_load_dword v219, v15, s[24:27], s10 offen
    s_waitcnt vmcnt(11)
    s_branch L_N2
L_NOXS:
    s_waitcnt vmcnt(0)
L_N2:
    v_lshlrev_b32 v176, 16, v64
    v_and_b32 v184, 0xffff0000, v64
    v_lshlrev_b32_e64 v192, 16, v65
    v_and_b32 v200, 0xffff0000, v65
    v_lshlrev_b32_e64 v177, 16, v66
    v_and_b32 v185, 0xffff0000, v66
    v_lshlrev_b32_e64 v193, 16, v67
    v_and_b32 v201, 0xffff0000, v67
    v_lshlrev_b32_e64 v178, 16, v68
    v_and_b32 v186, 0xffff0000, v68
    v_lshlrev_b32_e64 v194, 16, v69
    v_and_b32 v202, 0xffff0000, v69
    v_lshlrev_b32_e64 v179, 16, v70
    v_and_b32 v187, 0xffff0000, v70
    v_lshlrev_b32_e64 v195, 16, v71
    v_and_b32 v203, 0xffff0000, v71
    v_lshlrev_b32_e64 v180, 16, v72
    v_and_b32 v188, 0xffff0000, v72
    v_lshlrev_b32_e64 v196, 16, v73
    v_and_b32 v204, 0xffff0000, v73
    v_lshlrev_b32_e64 v181, 16, v74
    v_and_b32 v189, 0xffff0000, v74
    v_lshlrev_b32_e64 v197, 16, v75
    v_and_b32 v205, 0xffff0000, v75
    v_lshlrev_b32_e64 v182, 16, v76
    v_and_b32 v190, 0xffff0000, v76
    v_lshlrev_b32_e64 v198, 16, v77
    v_and_b32 v206, 0xffff0000, v77
    v_lshlrev_b32_e64 v183, 16, v78
    v_and_b32 v191, 0xffff0000, v78
    v_lshlrev_b32_e64 v199, 16, v79
    v_and_b32 v207, 0xffff0000, v79
    v_lshlrev_b32_e64 v80, 16, v33
    v_and_b32 v81, 0xffff0000, v33
    v_lshlrev_b32_e64 v82, 16, v37
    v_and_b32 v83, 0xffff0000, v37
    v_lshlrev_b32_e64 v84, 16, v41
    v_and_b32 v85, 0xffff0000, v41
    v_lshlrev_b32_e64 v86, 16, v45
    v_and_b32 v87, 0xffff0000, v45
    v_rcp_f32 v80, v80
    v_rcp_f32 v81, v81
    v_rcp_f32 v82, v82
    v_rcp_f32 v83, v83
    v_rcp_f32 v84, v84
    v_rcp_f32 v85, v85
    v_rcp_f32 v86, v86
    v_rcp_f32 v87, v87
    v_lshlrev_b32_e64 v88, 16, v32
    v_and_b32 v89, 0xffff0000, v32
    v_lshlrev_b32_e64 v90, 16, v36
    v_and_b32 v91, 0xffff0000, v36
    v_lshlrev_b32_e64 v92, 16, v40
    v_and_b32 v93, 0xffff0000, v40
    v_lshlrev_b32_e64 v94, 16, v44
    v_and_b32 v95, 0xffff0000, v44
    v_pk_mul_f32 v[88:89], v[88:89], v[80:81]
    v_pk_mul_f32 v[90:91], v[90:91], v[82:83]
    v_pk_mul_f32 v[92:93], v[92:93], v[84:85]
    v_pk_mul_f32 v[94:95], v[94:95], v[86:87]
    v_pk_fma_f32 v[176:177], v[176:177], v[80:81], v[88:89] neg_lo:[0,0,1] neg_hi:[0,0,1]
    v_pk_fma_f32 v[178:179], v[178:179], v[82:83], v[90:91] neg_lo:[0,0,1] neg_hi:[0,0,1]
    v_pk_fma_f32 v[180:181], v[180:181], v[84:85], v[92:93] neg_lo:[0,0,1] neg_hi:[0,0,1]
    v_pk_fma_f32 v[182:183], v[182:183], v[86:87], v[94:95] neg_lo:[0,0,1] neg_hi:[0,0,1]
    v_cvt_pk_bf16_f32 v48, v177, v176
    v_cvt_pk_bf16_f32 v49, v179, v178
    v_cvt_pk_bf16_f32 v50, v181, v180
    v_cvt_pk_bf16_f32 v51, v183, v182
    ds_write2st64_b32 v56, v48, v49 offset0:12 offset1:8
    ds_write2st64_b32 v56, v50, v51 offset0:4 offset1:0
    v_pk_fma_f32 v[184:185], v[184:185], v[80:81], v[88:89] neg_lo:[0,0,1] neg_hi:[0,0,1]
    v_pk_fma_f32 v[186:187], v[186:187], v[82:83], v[90:91] neg_lo:[0,0,1] neg_hi:[0,0,1]
    v_pk_fma_f32 v[188:189], v[188:189], v[84:85], v[92:93] neg_lo:[0,0,1] neg_hi:[0,0,1]
    v_pk_fma_f32 v[190:191], v[190:191], v[86:87], v[94:95] neg_lo:[0,0,1] neg_hi:[0,0,1]
    v_cvt_pk_bf16_f32 v52, v185, v184
    v_cvt_pk_bf16_f32 v53, v187, v186
    v_cvt_pk_bf16_f32 v54, v189, v188
    v_cvt_pk_bf16_f32 v55, v191, v190
    ds_write2st64_b32 v56, v52, v53 offset0:30 offset1:26
    ds_write2st64_b32 v56, v54, v55 offset0:22 offset1:18
    v_pk_fma_f32 v[192:193], v[192:193], v[80:81], v[88:89] neg_lo:[0,0,1] neg_hi:[0,0,1]
    v_pk_fma_f32 v[194:195], v[194:195], v[82:83], v[90:91] neg_lo:[0,0,1] neg_hi:[0,0,1]
    v_pk_fma_f32 v[196:197], v[196:197], v[84:85], v[92:93] neg_lo:[0,0,1] neg_hi:[0,0,1]
    v_pk_fma_f32 v[198:199], v[198:199], v[86:87], v[94:95] neg_lo:[0,0,1] neg_hi:[0,0,1]
    v_cvt_pk_bf16_f32 v48, v193, v192
    v_cvt_pk_bf16_f32 v49, v195, v194
    v_cvt_pk_bf16_f32 v50, v197, v196
    v_cvt_pk_bf16_f32 v51, v199, v198
    ds_write2st64_b32 v56, v48, v49 offset0:48 offset1:44
    ds_write2st64_b32 v56, v50, v51 offset0:40 offset1:36
    v_pk_fma_f32 v[200:201], v[200:201], v[80:81], v[88:89] neg_lo:[0,0,1] neg_hi:[0,0,1]
    v_pk_fma_f32 v[202:203], v[202:203], v[82:83], v[90:91] neg_lo:[0,0,1] neg_hi:[0,0,1]
    v_pk_fma_f32 v[204:205], v[204:205], v[84:85], v[92:93] neg_lo:[0,0,1] neg_hi:[0,0,1]
    v_pk_fma_f32 v[206:207], v[206:207], v[86:87], v[94:95] neg_lo:[0,0,1] neg_hi:[0,0,1]
    v_cvt_pk_bf16_f32 v52, v201, v200
    v_cvt_pk_bf16_f32 v53, v203, v202
    v_cvt_pk_bf16_f32 v54, v205, v204
    v_cvt_pk_bf16_f32 v55, v207, v206
    ds_write2st64_b32 v56, v52, v53 offset0:66 offset1:62
    ds_write2st64_b32 v56, v54, v55 offset0:58 offset1:54
    v_mov_b32 v59, s60
    s_mov_b64 exec, 1
    ds_write_b32 v2, v59 offset:0
    s_mov_b64 exec, -1
    s_waitcnt lgkmcnt(9)
    v_cmp_gt_u32_e64 vcc, v20, v16
    v_cmp_gt_u32 s[8:9], v21, v16
    v_cmp_gt_u32 s[14:15], v22, v16
    v_cmp_gt_u32 s[28:29], v23, v16
    v_cndmask_b32 v24, 0, 1, vcc
    v_cndmask_b32 v25, 0, 1, s[8:9]
    v_addc_co_u32 v24, vcc, 0, v24, s[14:15]
    v_addc_co_u32 v24, vcc, v25, v24, s[28:29]
    v_mov_b32 v25, v24
    s_nop 1
    v_permlane32_swap_b32 v24, v25
    v_add_u32 v24, v24, v25
    v_mov_b32 v25, v24
    s_nop 1
    v_permlane16_swap_b32 v24, v25
    v_add_u32 v24, v24, v25
    v_cmp_gt_u32 s[30:31], 8, v24
    v_lshlrev_b32 v15, 2, v24
    v_and_b32 v10, 7, v0
    v_lshlrev_b32_e64 v10, 2, v10
    v_bfe_u32 v20, v14, 1, 8
    v_lshrrev_b32 v21, 9, v14
    v_lshlrev_b32 v20, 3, v20
    v_lshl_add_u32 v20, v21, 1, v20
    v_and_b32 v14, 1, v14
    v_add_u32 v20, v20, v14
    v_mov_b32 v22, 0x80
    s_mov_b64 exec, s[30:31]
    ds_write_b32 v15, v16 offset:256
    s_cmp_lg_u32 s3, 0
    s_cbranch_scc1 L_NOSEL
    ds_write_b8 v20, v22 offset:1152
    s_cmp_lg_u32 s2, 255
    s_cbranch_scc1 L_NOSEL
    s_mov_b64 exec, 1
    v_mov_b32 v22, s56
    buffer_store_dword v22, v2, s[44:47], 0 offen sc1
L_NOSEL:
    s_mov_b64 exec, -1
    ds_read_b32 v7, v10 offset:256
LW_12:
    ds_read_b32 v11, v1 offset:160
    s_waitcnt lgkmcnt(0)
    v_cmp_eq_u32 vcc, 0, v11
    s_cbranch_vccnz LW_12
    ds_write_b128 v57, v[64:67] offset:0
    ds_write_b128 v57, v[68:71] offset:4096
    ds_write_b128 v57, v[72:75] offset:8192
    ds_write_b128 v57, v[76:79] offset:12288
    s_mov_b64 exec, 1
    ds_write_b32 v2, v5 offset:112
    s_mov_b64 exec, -1
    s_cmp_lg_u32 s69, 1
    s_cbranch_scc1 L_GATHER
    v_lshl_add_u32 v3, v24, 4, v3
    v_lshlrev_b32 v14, 4, v14
    v_lshlrev_b32_e64 v13, 4, v0
    s_lshl_b32 s4, s59, 14
    s_add_u32 s4, s4, 65536
    s_lshl_b32 s6, s3, 12
    s_add_u32 s6, s6, s4
    s_lshl_b32 s5, s68, 10
    s_add_u32 s5, s5, s6
    v_mov_b32 v218, s56
    s_waitcnt vmcnt(11)
    v_perm_b32 v48, v116, v112, s64
    v_perm_b32 v52, v116, v112, s65
    v_perm_b32 v49, v124, v120, s64
    v_perm_b32 v53, v124, v120, s65
    v_perm_b32 v50, v132, v128, s64
    v_perm_b32 v54, v132, v128, s65
    v_perm_b32 v51, v140, v136, s64
    v_perm_b32 v55, v140, v136, s65
    v_perm_b32 v56, v117, v113, s64
    v_perm_b32 v60, v117, v113, s65
    v_perm_b32 v57, v125, v121, s64
    v_perm_b32 v61, v125, v121, s65
    v_perm_b32 v58, v133, v129, s64
    v_perm_b32 v62, v133, v129, s65
    v_perm_b32 v59, v141, v137, s64
    v_perm_b32 v63, v141, v137, s65
    v_perm_b32 v64, v118, v114, s64
    v_perm_b32 v68, v118, v114, s65
    v_perm_b32 v65, v126, v122, s64
    v_perm_b32 v69, v126, v122, s65
    v_perm_b32 v66, v134, v130, s64
    v_perm_b32 v70, v134, v130, s65
    v_perm_b32 v67, v142, v138, s64
    v_perm_b32 v71, v142, v138, s65
    v_perm_b32 v72, v119, v115, s64
    v_perm_b32 v76, v119, v115, s65
    v_perm_b32 v73, v127, v123, s64
    v_perm_b32 v77, v127, v123, s65
    v_perm_b32 v74, v135, v131, s64
    v_perm_b32 v78, v135, v131, s65
    v_perm_b32 v75, v143, v139, s64
    v_perm_b32 v79, v143, v139, s65
    s_waitcnt vmcnt(3)
    s_nop 0
    v_perm_b32 v80, v148, v144, s64
    v_perm_b32 v84, v148, v144, s65
    v_perm_b32 v81, v156, v152, s64
    v_perm_b32 v85, v156, v152, s65
    v_perm_b32 v82, v164, v160, s64
    v_perm_b32 v86, v164, v160, s65
    v_perm_b32 v83, v172, v168, s64
    v_perm_b32 v87, v172, v168, s65
    v_perm_b32 v88, v149, v145, s64
    v_perm_b32 v92, v149, v145, s65
    v_perm_b32 v89, v157, v153, s64
    v_perm_b32 v93, v157, v153, s65
    v_perm_b32 v90, v165, v161, s64
    v_perm_b32 v94, v165, v161, s65
    v_perm_b32 v91, v173, v169, s64
    v_perm_b32 v95, v173, v169, s65
    v_perm_b32 v96, v150, v146, s64
    v_perm_b32 v100, v150, v146, s65
    v_perm_b32 v97, v158, v154, s64
    v_perm_b32 v101, v158, v154, s65
    v_perm_b32 v98, v166, v162, s64
    v_perm_b32 v102, v166, v162, s65
    v_perm_b32 v99, v174, v170, s64
    v_perm_b32 v103, v174, v170, s65
    v_perm_b32 v104, v151, v147, s64
    v_perm_b32 v108, v151, v147, s65
    v_perm_b32 v105, v159, v155, s64
    v_perm_b32 v109, v159, v155, s65
    v_perm_b32 v106, v167, v163, s64
    v_perm_b32 v110, v167, v163, s65
    v_perm_b32 v107, v175, v171, s64
    v_perm_b32 v111, v175, v171, s65
    s_waitcnt vmcnt(1)
    v_mfma_f32_16x16x32_bf16 v[16:19], v[48:51], v[208:211], 0
    v_lshrrev_b32 v6, v14, v9
    v_mfma_f32_16x16x32_bf16 v[16:19], v[80:83], v[212:215], v[16:19]
    v_lshrrev_b32_e64 v8, v14, v8
    v_mfma_f32_16x16x32_bf16 v[20:23], v[52:55], v[208:211], 0
    v_lshlrev_b32_e64 v6, 16, v6
    v_mfma_f32_16x16x32_bf16 v[20:23], v[84:87], v[212:215], v[20:23]
    v_lshlrev_b32_e64 v8, 16, v8
    v_mfma_f32_16x16x32_bf16 v[24:27], v[56:59], v[208:211], 0
    v_rcp_f32_e64 v6, v6
    v_mfma_f32_16x16x32_bf16 v[24:27], v[88:91], v[212:215], v[24:27]
    v_xor_b32 v8, 0x80000000, v8
    v_mfma_f32_16x16x32_bf16 v[28:31], v[60:63], v[208:211], 0
    s_nop 0
    s_nop 0
    v_fmac_f32_dpp v16, v16, v8 row_newbcast:15 row_mask:0xf bank_mask:0xf
    v_fmac_f32_dpp v17, v17, v8 row_newbcast:15 row_mask:0xf bank_mask:0xf
    v_mfma_f32_16x16x32_bf16 v[28:31], v[92:95], v[212:215], v[28:31]
    v_fmac_f32_dpp v18, v18, v8 row_newbcast:15 row_mask:0xf bank_mask:0xf
    v_fmac_f32_dpp v19, v19, v8 row_newbcast:15 row_mask:0xf bank_mask:0xf
    v_mfma_f32_16x16x32_bf16 v[32:35], v[64:67], v[208:211], 0
    v_fmac_f32_dpp v20, v20, v8 row_newbcast:15 row_mask:0xf bank_mask:0xf
    v_fmac_f32_dpp v21, v21, v8 row_newbcast:15 row_mask:0xf bank_mask:0xf
    v_mfma_f32_16x16x32_bf16 v[32:35], v[96:99], v[212:215], v[32:35]
    v_fmac_f32_dpp v22, v22, v8 row_newbcast:15 row_mask:0xf bank_mask:0xf
    v_fmac_f32_dpp v23, v23, v8 row_newbcast:15 row_mask:0xf bank_mask:0xf
    v_mfma_f32_16x16x32_bf16 v[36:39], v[68:71], v[208:211], 0
    v_fmac_f32_dpp v24, v24, v8 row_newbcast:15 row_mask:0xf bank_mask:0xf
    v_fmac_f32_dpp v25, v25, v8 row_newbcast:15 row_mask:0xf bank_mask:0xf
    v_mfma_f32_16x16x32_bf16 v[36:39], v[100:103], v[212:215], v[36:39]
    v_fmac_f32_dpp v26, v26, v8 row_newbcast:15 row_mask:0xf bank_mask:0xf
    v_fmac_f32_dpp v27, v27, v8 row_newbcast:15 row_mask:0xf bank_mask:0xf
    v_mfma_f32_16x16x32_bf16 v[40:43], v[72:75], v[208:211], 0
    v_fmac_f32_dpp v28, v28, v8 row_newbcast:15 row_mask:0xf bank_mask:0xf
    v_fmac_f32_dpp v29, v29, v8 row_newbcast:15 row_mask:0xf bank_mask:0xf
    v_mfma_f32_16x16x32_bf16 v[40:43], v[104:107], v[212:215], v[40:43]
    v_fmac_f32_dpp v30, v30, v8 row_newbcast:15 row_mask:0xf bank_mask:0xf
    v_fmac_f32_dpp v31, v31, v8 row_newbcast:15 row_mask:0xf bank_mask:0xf
    v_mfma_f32_16x16x32_bf16 v[44:47], v[76:79], v[208:211], 0
    v_fmac_f32_dpp v32, v32, v8 row_newbcast:15 row_mask:0xf bank_mask:0xf
    v_fmac_f32_dpp v33, v33, v8 row_newbcast:15 row_mask:0xf bank_mask:0xf
    v_mfma_f32_16x16x32_bf16 v[44:47], v[108:111], v[212:215], v[44:47]
    v_fmac_f32_dpp v34, v34, v8 row_newbcast:15 row_mask:0xf bank_mask:0xf
    v_fmac_f32_dpp v35, v35, v8 row_newbcast:15 row_mask:0xf bank_mask:0xf
    v_fmac_f32_dpp v36, v36, v8 row_newbcast:15 row_mask:0xf bank_mask:0xf
    v_fmac_f32_dpp v37, v37, v8 row_newbcast:15 row_mask:0xf bank_mask:0xf
    v_fmac_f32_dpp v38, v38, v8 row_newbcast:15 row_mask:0xf bank_mask:0xf
    v_fmac_f32_dpp v39, v39, v8 row_newbcast:15 row_mask:0xf bank_mask:0xf
    v_fmac_f32_dpp v40, v40, v8 row_newbcast:15 row_mask:0xf bank_mask:0xf
    v_fmac_f32_dpp v41, v41, v8 row_newbcast:15 row_mask:0xf bank_mask:0xf
    v_fmac_f32_dpp v42, v42, v8 row_newbcast:15 row_mask:0xf bank_mask:0xf
    v_fmac_f32_dpp v43, v43, v8 row_newbcast:15 row_mask:0xf bank_mask:0xf
    v_fmac_f32_dpp v44, v44, v8 row_newbcast:15 row_mask:0xf bank_mask:0xf
    v_fmac_f32_dpp v45, v45, v8 row_newbcast:15 row_mask:0xf bank_mask:0xf
    v_fmac_f32_dpp v46, v46, v8 row_newbcast:15 row_mask:0xf bank_mask:0xf
    v_fmac_f32_dpp v47, v47, v8 row_newbcast:15 row_mask:0xf bank_mask:0xf
    s_mov_b64 exec, s[30:31]
    s_nop 0
    ds_write_b128 v3, v[16:19] offset:0
    ds_write_b128 v3, v[20:23] offset:512
    ds_write_b128 v3, v[24:27] offset:1024
    ds_write_b128 v3, v[28:31] offset:1536
    ds_write_b128 v3, v[32:35] offset:2048
    ds_write_b128 v3, v[36:39] offset:2560
    ds_write_b128 v3, v[40:43] offset:3072
    ds_write_b128 v3, v[44:47] offset:3584
    ds_write_b32 v15, v6 offset:288
    s_mov_b64 exec, 1
    ds_write_b32 v2, v5 offset:80
    s_mov_b64 exec, -1
    ds_read_b32 v6, v10 offset:288
LW_13:
    ds_read_b32 v11, v1 offset:80
    s_waitcnt lgkmcnt(0)
    v_cmp_eq_u32_e64 vcc, 0, v11
    s_cbranch_vccnz LW_13
    ds_read_b64 v[224:225], v4 offset:0
    ds_read_b64 v[226:227], v4 offset:256
    ds_read_b64 v[228:229], v4 offset:4096
    ds_read_b64 v[230:231], v4 offset:4352
    ds_read_b64 v[232:233], v4 offset:8192
    ds_read_b64 v[234:235], v4 offset:8448
    ds_read_b64 v[236:237], v4 offset:12288
    ds_read_b64 v[238:239], v4 offset:12544
    s_waitcnt lgkmcnt(4)
    v_add_f32 v224, v224, v228
    v_add_f32 v225, v225, v229
    v_add_f32 v226, v226, v230
    v_add_f32 v227, v227, v231
    s_waitcnt lgkmcnt(0)
    v_add_f32 v232, v232, v236
    v_add_f32 v233, v233, v237
    v_add_f32 v234, v234, v238
    v_add_f32 v235, v235, v239
    v_add_f32 v224, v224, v232
    v_add_f32 v225, v225, v233
    v_add_f32 v226, v226, v234
    v_add_f32 v227, v227, v235
    v_cvt_pk_bf16_f32 v216, v224, v225
    v_cvt_pk_bf16_f32 v217, v226, v227
    buffer_store_dwordx4 v[216:219], v13, s[44:47], s5 offen sc1
    s_add_u32 s11, s10, 0
    s_nop 0
    buffer_load_dwordx2 v[176:177], v12, s[24:27], s11 offen
    s_add_u32 s11, s10, 16384
    buffer_load_dwordx2 v[178:179], v12, s[24:27], s11 offen
    s_add_u32 s11, s10, 2048
    buffer_load_dwordx2 v[180:181], v12, s[24:27], s11 offen
    s_add_u32 s11, s10, 18432
    buffer_load_dwordx2 v[182:183], v12, s[24:27], s11 offen
    s_add_u32 s11, s10, 32768
    buffer_load_dwordx2 v[184:185], v12, s[24:27], s11 offen
    s_add_u32 s11, s10, 49152
    buffer_load_dwordx2 v[186:187], v12, s[24:27], s11 offen
    s_add_u32 s11, s10, 34816
    buffer_load_dwordx2 v[188:189], v12, s[24:27], s11 offen
    s_add_u32 s11, s10, 51200
    buffer_load_dwordx2 v[190:191], v12, s[24:27], s11 offen
    s_add_u32 s11, s10, 8192
    buffer_load_dwordx2 v[192:193], v12, s[24:27], s11 offen
    s_add_u32 s11, s10, 24576
    buffer_load_dwordx2 v[194:195], v12, s[24:27], s11 offen
    s_add_u32 s11, s10, 10240
    buffer_load_dwordx2 v[196:197], v12, s[24:27], s11 offen
    s_add_u32 s11, s10, 26624
    buffer_load_dwordx2 v[198:199], v12, s[24:27], s11 offen
    s_add_u32 s11, s10, 40960
    buffer_load_dwordx2 v[200:201], v12, s[24:27], s11 offen
    s_add_u32 s11, s10, 57344
    buffer_load_dwordx2 v[202:203], v12, s[24:27], s11 offen
    s_add_u32 s11, s10, 43008
    buffer_load_dwordx2 v[204:205], v12, s[24:27], s11 offen
    s_add_u32 s11, s10, 59392
    buffer_load_dwordx2 v[206:207], v12, s[24:27], s11 offen
    v_bfe_u32 v10, v0, 3, 1
    v_lshrrev_b32_e64 v11, 4, v0
    v_cmp_ne_u32 s[22:23], 0, v10
    v_lshlrev_b32_e64 v15, 2, v10
    v_lshl_add_u32 v15, v11, 3, v15
    v_lshlrev_b32_e64 v10, 8, v10
    v_lshl_add_u32 v10, v11, 9, v10
    v_lshlrev_b32 v9, 4, v11
    v_and_b32 v11, 7, v0
    v_lshl_add_u32 v10, v11, 4, v10
    s_movk_i32 s5, 144
    v_mad_u32_u24 v15, v11, s5, v15
    v_mad_u32_u24 v9, v11, s5, v9
    s_lshl_b32 s5, s3, 5
    v_add_u32 v15, s5, v15
    s_lshl_b32 s4, s59, 15
    s_lshl_b32 s5, s68, 13
    s_add_u32 s4, s4, s5
    s_lshl_b32 s5, s3, 11
    s_add_u32 s4, s4, s5
    s_add_u32 s4, s4, 1048576
    v_mul_f32 v12, 0xbfb8aa3b, v6
    v_mul_f32 v14, v6, v6
    v_mov_b32 v50, s56
    v_mov_b32_e64 v54, s56
    s_mov_b32 s16, 0
    s_waitcnt vmcnt(8)
    buffer_load_dwordx3 v[144:146], v13, s[44:47], s6 offen offset:0 sc1
    buffer_load_dwordx3 v[148:150], v13, s[44:47], s6 offen offset:1024 sc1
    buffer_load_dwordx3 v[152:154], v13, s[44:47], s6 offen offset:2048 sc1
    buffer_load_dwordx3 v[156:158], v13, s[44:47], s6 offen offset:3072 sc1
    s_waitcnt vmcnt(12)
    s_nop 0
    v_perm_b32 v112, v178, v176, s64
    v_perm_b32 v116, v178, v176, s65
    v_perm_b32 v113, v182, v180, s64
    v_perm_b32 v117, v182, v180, s65
    v_perm_b32 v114, v186, v184, s64
    v_perm_b32 v118, v186, v184, s65
    v_perm_b32 v115, v190, v188, s64
    v_perm_b32 v119, v190, v188, s65
    v_perm_b32 v120, v179, v177, s64
    v_perm_b32 v124, v179, v177, s65
    v_perm_b32 v121, v183, v181, s64
    v_perm_b32 v125, v183, v181, s65
    v_perm_b32 v122, v187, v185, s64
    v_perm_b32 v126, v187, v185, s65
    v_perm_b32 v123, v191, v189, s64
    v_perm_b32 v127, v191, v189, s65
    s_waitcnt vmcnt(4)
    s_nop 0
    v_perm_b32 v128, v194, v192, s64
    v_perm_b32 v132, v194, v192, s65
    v_perm_b32 v129, v198, v196, s64
    v_perm_b32 v133, v198, v196, s65
    v_perm_b32 v130, v202, v200, s64
    v_perm_b32 v134, v202, v200, s65
    v_perm_b32 v131, v206, v204, s64
    v_perm_b32 v135, v206, v204, s65
    v_perm_b32 v136, v195, v193, s64
    v_perm_b32 v140, v195, v193, s65
    v_perm_b32 v137, v199, v197, s64
    v_perm_b32 v141, v199, v197, s65
    v_perm_b32 v138, v203, v201, s64
    v_perm_b32 v142, v203, v201, s65
    v_perm_b32 v139, v207, v205, s64
    v_perm_b32 v143, v207, v205, s65
    s_branch L_HPW
L_HP:
    s_sleep 3
    s_cmp_eq_u64 s[18:19], 0
    s_cbranch_scc1 L_HS0
    buffer_load_dwordx3 v[144:146], v13, s[44:47], s6 offen offset:0 sc1
L_HS0:
    s_cmp_eq_u64 s[8:9], 0
    s_cbranch_scc1 L_HS1
    buffer_load_dwordx3 v[148:150], v13, s[44:47], s6 offen offset:1024 sc1
L_HS1:
    s_cmp_eq_u64 s[14:15], 0
    s_cbranch_scc1 L_HS2
    buffer_load_dwordx3 v[152:154], v13, s[44:47], s6 offen offset:2048 sc1
L_HS2:
    s_cmp_eq_u64 s[28:29], 0
    s_cbranch_scc1 L_HS3
    buffer_load_dwordx3 v[156:158], v13, s[44:47], s6 offen offset:3072 sc1
L_HS3:
L_HPW:
    s_add_u32 s16, s16, 1
    s_waitcnt vmcnt(0)
    v_cmp_ne_u32 s[18:19], s56, v146
    v_cmp_ne_u32 s[8:9], s56, v150
    v_cmp_ne_u32 s[14:15], s56, v154
    v_cmp_ne_u32 s[28:29], s56, v158
    s_or_b64 vcc, s[18:19], s[8:9]
    s_or_b64 s[20:21], s[14:15], s[28:29]
    s_or_b64 vcc, vcc, s[20:21]
    s_cbranch_vccz L_HOK
    s_cmp_lt_u32 s16, 0x4000
    s_cbranch_scc1 L_HP
L_HOK:
    v_lshlrev_b32 v224, 16, v144
    v_and_b32 v225, 0xffff0000, v144
    v_lshlrev_b32_e64 v226, 16, v148
    v_and_b32 v227, 0xffff0000, v148
    v_lshlrev_b32_e64 v228, 16, v152
    v_and_b32 v229, 0xffff0000, v152
    v_lshlrev_b32_e64 v230, 16, v156
    v_and_b32 v231, 0xffff0000, v156
    v_add_f32 v224, v224, v226
    v_add_f32 v228, v228, v230
    v_add_f32 v225, v225, v227
    v_add_f32 v229, v229, v231
    v_add_f32 v224, v224, v228
    v_add_f32 v225, v225, v229
    v_mul_f32 v244, v12, v224
    v_mul_f32 v245, v12, v225
    v_exp_f32 v244, v244
    v_exp_f32 v245, v245
    v_lshlrev_b32_e64 v232, 16, v145
    v_and_b32 v233, 0xffff0000, v145
    v_lshlrev_b32_e64 v234, 16, v149
    v_and_b32 v235, 0xffff0000, v149
    v_lshlrev_b32_e64 v236, 16, v153
    v_and_b32 v237, 0xffff0000, v153
    v_lshlrev_b32_e64 v238, 16, v157
    v_and_b32 v239, 0xffff0000, v157
    v_add_f32 v244, 1.0, v244
    v_add_f32 v245, 1.0, v245
    v_rcp_f32 v244, v244
    v_rcp_f32 v245, v245
    v_add_f32 v232, v232, v234
    v_add_f32 v236, v236, v238
    v_add_f32 v233, v233, v235
    v_add_f32 v237, v237, v239
    v_mul_f32 v224, v224, v14
    v_add_f32 v232, v232, v236
    v_mul_f32 v225, v225, v14
    v_add_f32 v233, v233, v237
    v_mul_f32 v224, v224, v244
    v_mul_f32 v225, v225, v245
    v_mul_f32 v224, v224, v232
    v_mul_f32 v225, v225, v233
    v_cvt_pk_bf16_f32 v244, v224, v225
    ds_write_b32 v15, v244 offset:4096
    s_mov_b64 exec, 1
    ds_write_b32 v2, v5 offset:176
    s_mov_b64 exec, -1
LW_14:
    ds_read_b32 v11, v1 offset:176
    s_waitcnt lgkmcnt(0)
    v_cmp_eq_u32_e64 vcc, 0, v11
    s_cbranch_vccnz LW_14
    ds_read_b128 v[224:227], v9 offset:4096
    ds_read_b128 v[228:231], v9 offset:4160
    s_waitcnt lgkmcnt(1)
    v_mfma_f32_16x16x32_bf16 v[16:19], v[112:115], v[224:227], 0
    v_mfma_f32_16x16x32_bf16 v[20:23], v[116:119], v[224:227], 0
    v_mfma_f32_16x16x32_bf16 v[24:27], v[120:123], v[224:227], 0
    v_mfma_f32_16x16x32_bf16 v[28:31], v[124:127], v[224:227], 0
    s_waitcnt lgkmcnt(0)
    v_mfma_f32_16x16x32_bf16 v[16:19], v[128:131], v[228:231], v[16:19]
    v_mfma_f32_16x16x32_bf16 v[20:23], v[132:135], v[228:231], v[20:23]
    v_mfma_f32_16x16x32_bf16 v[24:27], v[136:139], v[228:231], v[24:27]
    v_mfma_f32_16x16x32_bf16 v[28:31], v[140:143], v[228:231], v[28:31]
    s_nop 0
    s_nop 3
    v_cndmask_b32 v16, v16, v18, s[22:23]
    v_cndmask_b32 v20, v20, v22, s[22:23]
    v_cndmask_b32 v24, v24, v26, s[22:23]
    v_cndmask_b32 v28, v28, v30, s[22:23]
    v_cvt_pk_bf16_f32 v48, v16, v20
    v_cvt_pk_bf16_f32 v49, v24, v28
    buffer_store_dwordx4 v[48:51], v10, s[44:47], s4 offen offset:0 sc1
    v_cndmask_b32 v17, v17, v19, s[22:23]
    v_cndmask_b32 v21, v21, v23, s[22:23]
    v_cndmask_b32 v25, v25, v27, s[22:23]
    v_cndmask_b32 v29, v29, v31, s[22:23]
    v_cvt_pk_bf16_f32 v52, v17, v21
    v_cvt_pk_bf16_f32 v53, v25, v29
    buffer_store_dwordx4 v[52:55], v10, s[44:47], s4 offen offset:128 sc1
L_GATHER:
    s_waitcnt lgkmcnt(0)
    s_movk_i32 s4, 0x7ff
    v_bfi_b32 v14, v7, 0, s4
    v_lshrrev_b32 v10, 3, v0
    s_lshl_b32 s4, s3, 3
    v_add_lshl_u32 v10, v10, s4, 15
    v_and_b32 v11, 7, v0
    v_lshlrev_b32 v11, 4, v11
    v_add_u32 v10, v10, v11
    s_lshl_b32 s4, s57, 7
    s_add_u32 s4, s4, 1048576
    s_mov_b32 s11, 0
    v_bfe_u32 v12, v0, 3, 2
    v_lshlrev_b32 v13, 11, v14
    v_lshl_add_u32 v13, v12, 1, v13
    s_lshl_b32 s8, s57, 3
    v_add_u32 v13, s8, v13
    buffer_load_ushort v80, v13, s[48:51], 0 offen
LW_15:
    ds_read_b32 v15, v1 offset:112
    s_waitcnt lgkmcnt(0)
    v_cmp_eq_u32 vcc, 0, v15
    s_cbranch_vccnz LW_15
    v_lshrrev_b32 v15, 16, v7
    v_bfe_i32 v82, v15, 15, 1
    v_not_b32_e64 v82, v82
    v_or_b32 v82, 0x8000, v82
    v_xor_b32 v15, v15, v82
    v_lshlrev_b32 v15, 16, v15
    v_mul_f32 v15, 0xbfb8aa3b, v15
    v_exp_f32 v15, v15
    v_lshlrev_b32 v83, 13, v12
    v_add_f32 v15, 1.0, v15
    v_rcp_f32 v15, v15
    v_lshl_add_u32 v83, v14, 2, v83
    v_add_u32 v83, 93184, v83
    v_lshl_add_u32 v84, v12, 2, v11
    s_cmp_lg_u32 s60, 2
    s_cbranch_scc1 L_AFT
    s_cmp_ge_u32 s3, 2
    s_cbranch_scc1 L_AFT
L_TILE:
    s_lshl_b32 s8, s3, 4
    s_cmp_eq_u32 s3, 0
    s_cselect_b32 s8, 144, s8
    v_add_u32_e64 v92, s8, v1
    s_and_b32 s14, s2, 7
    s_lshr_b32 s15, s2, 3
    s_lshl_b32 s16, s14, 11
    s_lshl_b32 s8, s3, 9
    s_add_u32 s16, s16, s8
    s_lshr_b32 s9, s15, 3
    s_lshl_b32 s9, s9, 7
    s_add_u32 s16, s16, s9
    s_add_u32 s16, s16, 1015808
    s_lshl_b32 s9, s15, 4
    s_add_u32 s8, s8, s9
    s_lshl_b32 s17, s14, 19
    s_lshl_b32 s9, s8, 3
    s_add_u32 s17, s17, s9
    s_add_u32 s17, s17, 3145728
    s_lshl_b32 s18, s8, 11
    s_lshl_b32 s9, s14, 8
    s_add_u32 s18, s18, s9
    s_add_u32 s19, s18, 4096
    s_mul_i32 s9, s3, 4352
    s_add_u32 s9, s9, 125952
    s_cmp_eq_u32 s3, 3
    s_cselect_b32 s9, 9216, s9
    v_lshlrev_b32 v93, 2, v0
    v_and_b32 v98, 7, v0
    v_lshrrev_b32 v99, 3, v0
    v_lshlrev_b32_e64 v94, 4, v98
    v_lshl_add_u32 v94, v99, 14, v94
    s_movk_i32 s8, 544
    v_lshl_add_u32 v95, v99, 3, s9
    v_mad_u32_u24 v95, v98, s8, v95
    v_lshrrev_b32 v98, 4, v0
    v_and_b32 v99, 15, v0
    v_lshlrev_b32_e64 v99, 4, v99
    s_movk_i32 s8, 1088
    v_mad_u32_u24 v96, v98, s8, v99
    v_add_u32_e64 v96, s9, v96
    v_lshl_add_u32 v97, v98, 13, v99
    s_lshl_b32 s8, s15, 6
    s_lshl_b32 s9, s3, 1
    s_add_u32 s8, s8, s9
    v_lshl_add_u32 v98, v98, 4, s8
    ds_read_u16 v100, v98 offset:1152
    ds_read_u16 v101, v98 offset:1160
    s_brev_b32 s8, 1
    s_mov_b32 s20, 0
    s_setprio 0
LW_16:
    s_sleep 2
    ds_read_b32 v99, v92 offset:0
    s_waitcnt lgkmcnt(0)
    v_cmp_eq_u32 vcc, 0, v99
    s_cbranch_vccnz LW_16
    s_setprio 2
    v_lshlrev_b32 v102, 24, v100
    v_lshlrev_b32 v103, 16, v100
    v_lshlrev_b32 v104, 24, v101
    v_lshlrev_b32_e64 v105, 16, v101
    v_and_or_b32 v102, v102, s8, v97
    v_and_or_b32 v103, v103, s8, v97
    v_and_or_b32 v104, v104, s8, v97
    v_and_or_b32 v105, v105, s8, v97
    s_mov_b32 exec_hi, 0
L_TP:
    s_sleep 1
    buffer_load_dword v99, v93, s[44:47], s16 offen sc1
    s_add_u32 s20, s20, 1
    s_waitcnt vmcnt(0)
    v_cmp_ne_u32 vcc, s56, v99
    s_cbranch_vccz L_TOK
    s_cmp_lt_u32 s20, 0x4000
    s_cbranch_scc1 L_TP
L_TOK:
    s_mov_b32 exec_hi, -1
    buffer_load_dwordx4 v[16:19], v94, s[44:47], s17 offen sc1
    s_add_u32 s17, s17, 0x20000
    buffer_load_dwordx4 v[20:23], v94, s[44:47], s17 offen sc1
    s_add_u32 s17, s17, 0x20000
    buffer_load_dwordx4 v[24:27], v94, s[44:47], s17 offen sc1
    s_add_u32 s17, s17, 0x20000
    buffer_load_dwordx4 v[28:31], v94, s[44:47], s17 offen sc1
    s_add_u32 s17, s17, 0x20000
    s_waitcnt vmcnt(3)
    ds_write_b64 v95, v[16:17] offset:0
    ds_write_b64 v95, v[18:19] offset:272
    s_waitcnt vmcnt(2)
    ds_write_b64 v95, v[20:21] offset:64
    ds_write_b64 v95, v[22:23] offset:336
    s_waitcnt vmcnt(1)
    ds_write_b64 v95, v[24:25] offset:128
    ds_write_b64 v95, v[26:27] offset:400
    s_waitcnt vmcnt(0)
    ds_write_b64 v95, v[28:29] offset:192
    ds_write_b64 v95, v[30:31] offset:464
    ds_read_b128 v[32:35], v96 offset:0
    ds_read_b128 v[36:39], v96 offset:272
    ds_read_b128 v[40:43], v96 offset:544
    ds_read_b128 v[44:47], v96 offset:816
    s_waitcnt lgkmcnt(3)
    buffer_store_dwordx4 v[32:35], v102, s[52:55], s18 offen offset:0 sc1
    s_waitcnt lgkmcnt(2)
    buffer_store_dwordx4 v[36:39], v103, s[52:55], s18 offen offset:2048 sc1
    s_waitcnt lgkmcnt(1)
    buffer_store_dwordx4 v[40:43], v104, s[52:55], s19 offen offset:0 sc1
    s_waitcnt lgkmcnt(0)
    buffer_store_dwordx4 v[44:47], v105, s[52:55], s19 offen offset:2048 sc1
    s_cmp_ge_u32 s3, 2
    s_cbranch_scc1 L_FIN
L_AFT:
    s_cmp_eq_u32 s69, 1
    s_cbranch_scc1 L_GGO
    s_setprio 0
LW_17:
    s_sleep 2
    ds_read_b32 v81, v1 offset:48
    s_waitcnt lgkmcnt(0)
    v_cmp_eq_u32_e64 vcc, 0, v81
    s_cbranch_vccnz LW_17
    s_setprio 2
L_GGO:
    s_mov_b64 s[8:9], -1
    s_cmp_lt_u32 s3, 3
    s_cselect_b64 s[12:13], -1, 0
    s_add_u32 s5, s4, 0x100000
    v_mov_b32 v148, 0
    v_mov_b32 v149, 0
    v_mov_b32 v150, s56
    s_waitcnt vmcnt(0)
L_GP:
    s_cmp_eq_u64 s[8:9], 0
    s_cbranch_scc1 L_GS0
    buffer_load_dwordx3 v[144:146], v10, s[44:47], s4 offen sc1
L_GS0:
    s_cmp_eq_u64 s[12:13], 0
    s_cbranch_scc1 L_GS1
    buffer_load_dwordx3 v[148:150], v10, s[44:47], s5 offen sc1
L_GS1:
    s_add_u32 s11, s11, 1
    s_waitcnt vmcnt(0)
    v_cmp_ne_u32 s[8:9], s56, v146
    v_cmp_ne_u32 s[12:13], s56, v150
    s_or_b64 vcc, s[8:9], s[12:13]
    s_cbranch_vccz L_GOT
    s_sleep 2
    s_cmp_lt_u32 s11, 0x4000
    s_cbranch_scc1 L_GP
L_GOT:
    v_lshlrev_b32_e64 v176, 16, v144
    v_and_b32 v177, 0xffff0000, v144
    v_lshlrev_b32_e64 v178, 16, v145
    v_and_b32 v179, 0xffff0000, v145
    v_lshlrev_b32_e64 v180, 16, v148
    v_and_b32 v181, 0xffff0000, v148
    v_lshlrev_b32_e64 v182, 16, v149
    v_and_b32 v183, 0xffff0000, v149
    v_add_f32 v176, v176, v180
    v_add_f32 v177, v177, v181
    v_add_f32 v178, v178, v182
    v_add_f32 v179, v179, v183
    v_add_f32_dpp v176, v176, v176 row_ror:8 row_mask:0xf bank_mask:0xf
    v_add_f32_dpp v177, v177, v177 row_ror:8 row_mask:0xf bank_mask:0xf
    v_add_f32_dpp v178, v178, v178 row_ror:8 row_mask:0xf bank_mask:0xf
    v_add_f32_dpp v179, v179, v179 row_ror:8 row_mask:0xf bank_mask:0xf
    s_mov_b32 exec_lo, 0x00ff00ff
    s_mov_b32 exec_hi, 0x00ff00ff
    ds_add_f32 v11, v176 offset:1024
    ds_add_f32 v11, v177 offset:1028
    ds_add_f32 v11, v178 offset:1032
    ds_add_f32 v11, v179 offset:1036
    s_mov_b64 exec, 1
    ds_write_b32 v2, v5 offset:96
    s_mov_b64 exec, -1
    s_lshl_b32 s8, s60, 2
    s_add_u32 s8, s3, s8
    s_cmp_ge_u32 s8, 10
    s_cbranch_scc1 L_TILE
    s_cmp_lg_u32 s3, 0
    s_cbranch_scc1 L_FIN
LW_18:
    ds_read_b32 v81, v1 offset:48
    s_waitcnt lgkmcnt(0)
    v_cmp_eq_u32_e64 vcc, 0, v81
    s_cbranch_vccnz LW_18
    ds_read_b32 v89, v83
    v_lshlrev_b32_e64 v80, 16, v80
LW_19:
    ds_read_b32 v81, v1 offset:96
    s_waitcnt lgkmcnt(0)
    v_cmp_eq_u32_e64 vcc, 0, v81
    s_cbranch_vccnz LW_19
    ds_read_b32 v90, v84 offset:1024
    v_add_f32 v80, v80, v89
    s_waitcnt lgkmcnt(0)
    v_fma_f32 v80, v90, v15, v80
    v_cvt_pk_bf16_f32 v80, v80, v80
    s_mov_b32 exec_hi, 0
    buffer_store_short v80, v13, s[52:55], 0 offen
    s_mov_b64 exec, -1
    s_branch L_FIN
L_XSLOW:
    s_lshl_b32 s13, s57, 3
    v_lshlrev_b32_e64 v96, 8, v58
    buffer_load_dwordx2 v[64:65], v96, s[48:51], s13 offen offset:0
    buffer_load_dwordx2 v[66:67], v96, s[48:51], s13 offen offset:2048
    s_add_u32 s13, s13, 0x100000
    buffer_load_dwordx2 v[68:69], v96, s[48:51], s13 offen offset:0
    buffer_load_dwordx2 v[70:71], v96, s[48:51], s13 offen offset:2048
    s_add_u32 s13, s13, 0x100000
    buffer_load_dwordx2 v[72:73], v96, s[48:51], s13 offen offset:0
    buffer_load_dwordx2 v[74:75], v96, s[48:51], s13 offen offset:2048
    s_add_u32 s13, s13, 0x100000
    buffer_load_dwordx2 v[76:77], v96, s[48:51], s13 offen offset:0
    buffer_load_dwordx2 v[78:79], v96, s[48:51], s13 offen offset:2048
    s_add_u32 s13, s13, 0x100000
    s_cmp_eq_u32 s63, 1
    s_cbranch_scc1 L_XBACK0
    s_branch L_XBACK1
L_TRIM:
    v_subrev_u32 v236, s4, v232
    v_subrev_u32 v237, s4, v233
    v_subrev_u32 v238, s4, v234
    v_subrev_u32_e64 v239, s4, v235
    v_min3_u32 v236, v236, v237, v238
    v_min_u32 v236, v236, v239
    s_nop 1
    v_min_u32_dpp v236, v236, v236 row_shr:1 row_mask:0xf bank_mask:0xf
    s_nop 0
    s_nop 0
    v_min_u32_dpp v236, v236, v236 row_shr:2 row_mask:0xf bank_mask:0xf
    s_nop 0
    s_nop 0
    v_min_u32_dpp v236, v236, v236 row_shr:4 row_mask:0xf bank_mask:0xf
    s_nop 0
    s_nop 0
    v_min_u32_dpp v236, v236, v236 row_shr:8 row_mask:0xf bank_mask:0xf
    s_nop 0
    s_nop 0
    v_min_u32_dpp v236, v236, v236 row_bcast:15 row_mask:0xa bank_mask:0xf
    s_nop 0
    s_nop 0
    v_min_u32_dpp v236, v236, v236 row_bcast:31 row_mask:0xc bank_mask:0xf
    s_nop 0
    v_readlane_b32 s5, v236, 63
    s_add_u32 s4, s4, s5
    s_add_u32 s4, s4, 1
    s_branch L_CAND
L_SLOWT:
    v_max3_u32 v228, v232, v233, v234
    v_max_u32 v228, v228, v235
    s_mov_b32 s4, 0
    s_brev_b32 s5, 1
L_BS:
    s_or_b32 s6, s4, s5
    v_cmp_le_u32_e64 vcc, s6, v228
    s_lshr_b32 s5, s5, 1
    s_bcnt1_i32_b64 s7, vcc
    s_cmp_ge_u32 s7, 8
    s_cselect_b32 s4, s6, s4
    s_cmp_lg_u32 s7, 8
    s_cbranch_scc1 L_BS
    v_mbcnt_lo_u32_b32 v229, vcc_lo, 0
    v_mbcnt_hi_u32_b32 v229, vcc_hi, v229
    v_lshlrev_b32 v229, 2, v229
    s_mov_b64 exec, vcc
    ds_write_b32 v229, v0 offset:320
    s_mov_b64 exec, -1
    v_lshrrev_b32 v230, 3, v0
    v_lshlrev_b32_e64 v230, 2, v230
    ds_read_b32 v229, v230 offset:320
    s_waitcnt lgkmcnt(0)
    v_and_b32 v230, 7, v0
    v_lshl_add_u32 v229, v229, 3, v230
    v_lshlrev_b32_e64 v230, 3, v229
    ds_read_b64 v[226:227], v230 offset:4096
    v_and_b32 v230, 1, v229
    v_and_b32 v229, -2, v229
    v_lshl_add_u32 v229, v230, 10, v229
    v_sub_u32 v232, 0xfff, v229
    v_sub_u32 v233, 0xffe, v229
    v_sub_u32 v234, 0xdff, v229
    v_sub_u32 v235, 0xdfe, v229
    s_mov_b32 s5, 0xffff0000
    s_waitcnt lgkmcnt(0)
    v_lshl_or_b32 v232, v226, 16, v232
    v_and_or_b32 v233, v226, s5, v233
    v_lshl_or_b32 v234, v227, 16, v234
    v_and_or_b32 v235, v227, s5, v235
    s_branch L_CAND
L_FIN:
L_END:
    s_endpgm
.section .rodata,"a"
.p2align 6
.amdhsa_kernel parallel_sum__ssm_conv_s4d__moe_arch_mod__prompt_kernel
  .amdhsa_next_free_vgpr 256
  .amdhsa_next_free_sgpr 102
  .amdhsa_accum_offset 256
  .amdhsa_group_segment_fixed_size 0
  .amdhsa_kernarg_size 120
  .amdhsa_user_sgpr_count 2
  .amdhsa_user_sgpr_kernarg_segment_ptr 1
  .amdhsa_system_sgpr_workgroup_id_x 1
  .amdhsa_float_denorm_mode_32 3
.end_amdhsa_kernel
```

```asm
; @launch grid=(256,1,1) block=(512,1,1) lds=160768
.amdgcn_target "amdgcn-amd-amdhsa--gfx950"
.text
.globl parallel_sum__ssm_conv_s4d__moe_arch_mod__prompt_kernel
.p2align 8
.type parallel_sum__ssm_conv_s4d__moe_arch_mod__prompt_kernel,@function
parallel_sum__ssm_conv_s4d__moe_arch_mod__prompt_kernel:
    s_cmp_ge_u32 s2, 256
    s_cbranch_scc1 L_END
    s_load_dwordx16 s[16:31], s[0:1], 0
    s_load_dwordx8 s[32:39], s[0:1], 64
    s_load_dwordx2 s[40:41], s[0:1], 96
    s_load_dwordx2 s[42:43], s[0:1], 112
    s_getpc_b64 s[14:15]
    v_lshrrev_b32_e64 v1, 6, v0
    v_and_b32 v10, 255, v0
    v_and_b32 v0, 63, v0
    v_readfirstlane_b32 s3, v1
    v_lshlrev_b32 v1, 2, v0
    v_mov_b32 v2, 0
    ds_write2st64_b32 v1, v2, v2 offset0:0 offset1:2
    s_and_b32 s5, s2, 7
    s_lshr_b32 s6, s2, 3
    s_lshl_b32 s57, s5, 5
    s_add_u32 s57, s57, s6
    s_and_b32 s58, s3, 3
    s_lshl_b32 s7, s57, 2
    s_add_u32 s7, s7, s58
    s_lshl_b32 s7, s7, 8
    v_add_u32_e64 v15, s7, v1
    s_mov_b32 s60, 0
    s_lshl_b32 s4, s57, 3
    s_cmp_lt_u32 s3, 4
    s_cbranch_scc1 L_F0
    s_and_b32 s8, s6, 15
    s_lshl_b32 s8, s8, 2
    s_add_u32 s8, s8, s58
    s_lshl_b32 s8, s8, 9
    v_lshl_add_u32 v2, v0, 7, s8
    v_min_u32 v2, L_END-parallel_sum__ssm_conv_s4d__moe_arch_mod__prompt_kernel-128, v2
    s_mov_b64 exec, 0xf
    global_load_dword v16, v2, s[14:15]
    s_mov_b64 exec, -1
    v_lshlrev_b32 v3, 12, v10
    v_add_u32 v3, s4, v3
    s_lshr_b32 s8, s6, 2
    s_add_u32 s9, s5, 3
    s_and_b32 s9, s9, 7
    s_min_u32 s9, s9, 6
    s_cmp_lt_u32 s6, 28
    s_cselect_b32 s8, s8, s9
    s_mul_i32 s9, s5, 7
    s_add_u32 s8, s8, s9
    s_lshl_b32 s8, s8, 7
    s_and_b32 s9, s6, 3
    s_lshl_b32 s9, s9, 8
    v_add_u32 v17, s9, v10
    s_movk_i32 s9, 7168
    v_mul_u32_u24 v17, s9, v17
    v_add_u32 v17, s8, v17
    s_waitcnt lgkmcnt(0)
    s_add_u32 s6, s26, s4
    s_addc_u32 s7, s27, 0
    s_load_dwordx2 s[64:65], s[6:7], 0
    global_load_dword v224, v15, s[18:19]
    global_load_dword v225, v15, s[20:21]
    global_load_dword v226, v15, s[22:23]
    global_load_dword v227, v15, s[24:25]
    s_add_u32 s6, s28, s4
    s_addc_u32 s7, s29, 0
    s_load_dwordx2 s[66:67], s[6:7], 0
    s_lshl_b32 s8, s8, 10
    s_bfe_u32 s9, s2, 0x20003
    s_lshl_b32 s9, s9, 2
    s_add_u32 s9, s9, s58
    s_lshl_b32 s9, s9, 7
    s_add_u32 s8, s8, s9
    v_lshl_add_u32 v15, v0, 11, s8
    s_barrier
    s_mov_b32 s61, 0x100000
    s_mov_b32 s62, 0x200000
    s_mov_b32 s63, 0x300000
    s_mov_b32 s44, s42
    s_and_b32 s45, s43, 0xffff
    s_mov_b32 s46, 0x1000000
    s_mov_b32 s47, 0x20000
    s_mov_b32 s48, s16
    s_and_b32 s49, s17, 0xffff
    s_mov_b32 s50, 0x400000
    s_mov_b32 s51, 0x20000
    s_mov_b32 s52, s40
    s_and_b32 s53, s41, 0xffff
    s_mov_b32 s54, 0x400000
    s_mov_b32 s55, 0x20000
    s_setprio 2
    s_mul_i32 s8, s58, 14336
    s_add_u32 s8, s8, 35840
    s_mul_i32 s10, s58, 4608
    s_add_u32 s10, s10, 17408
    s_mul_i32 s11, s58, 16896
    s_add_u32 s11, s11, 93184
    s_movk_i32 s9, 528
    v_lshl_add_u32 v11, v0, 3, s8
    v_and_b32 v1, 15, v0
    v_lshrrev_b32 v2, 4, v0
    v_lshlrev_b32 v7, 4, v2
    v_mad_u32_u24 v14, v1, s9, v7
    v_add_u32 v14, s11, v14
    v_add_u32 v7, s8, v7
    v_lshrrev_b32 v8, 2, v1
    v_lshlrev_b32 v9, 3, v8
    s_mov_b32 s4, 0x01030000
    v_lshrrev_b32 v12, v9, s4
    v_and_b32 v12, 0xff, v12
    v_add_u32_e64 v12, v12, v1
    v_mad_u32_u24 v12, v12, s9, v7
    s_mov_b32 s4, 0x14110804
    v_lshrrev_b32 v13, v9, s4
    v_and_b32 v13, 0xff, v13
    v_and_b32 v9, 3, v1
    v_add_u32 v13, v13, v9
    v_add_u32 v8, 23, v8
    v_cmp_eq_u32 vcc, 3, v9
    s_nop 1
    v_cndmask_b32 v13, v13, v8, vcc
    v_mad_u32_u24 v13, v13, s9, v7
    s_lshl_b32 s4, s58, 2
    v_mov_b32 v4, s4
    v_mov_b32 v5, 1
    v_lshlrev_b32 v6, 2, v9
    s_movk_i32 s9, 2368
    v_lshrrev_b32 v7, 2, v0
    v_lshl_add_u32 v8, v9, 3, s8
    v_mad_u32_u24 v196, v7, s9, v8
    s_movk_i32 s4, 160
    v_mad_u32_u24 v198, v7, s4, v8
    v_lshrrev_b32 v7, 3, v0
    v_and_b32_e64 v8, 7, v0
    v_lshl_add_u32 v8, v8, 3, s8
    v_mad_u32_u24 v197, v7, s9, v8
    v_lshrrev_b32 v7, 5, v0
    v_lshlrev_b32 v7, 8, v7
    v_lshl_add_u32 v7, v1, 4, v7
    v_add_u32 v7, s8, v7
    v_and_b32 v8, 1, v2
    v_lshl_add_u32 v199, v8, 3, v7
    v_lshl_add_u32 v200, v8, 9, v7
    v_and_b32 v7, 1, v1
    s_movk_i32 s4, 640
    v_mul_u32_u24_e64 v7, s4, v7
    v_lshl_add_u32 v7, v2, 5, v7
    v_and_b32_e64 v8, 14, v1
    v_add3_u32 v201, v7, v8, s8
    v_mov_b32 v202, s8
    v_mov_b32 v8, 0
    v_mov_b32 v9, 0
    s_waitcnt lgkmcnt(0)
    s_lshl_b32 s4, s58, 4
    s_lshr_b64 s[6:7], s[64:65], s4
    s_lshl_b32 s6, s6, 16
    v_mov_b32 v228, s6
    v_mul_f32 v228, 0x3fb8aa3b, v228
    v_exp_f32 v228, v228
    s_nop 0
    v_cvt_pk_bf16_f32 v228, v228, v228
    v_and_b32 v228, 0xffff0000, v228
    s_waitcnt vmcnt(0)
    v_lshlrev_b32 v244, 16, v224
    v_and_b32 v245, 0xffff0000, v224
    v_lshlrev_b32_e64 v246, 16, v225
    v_and_b32 v247, 0xffff0000, v225
    v_mul_f32 v244, 0x3fb8aa3b, v244
    v_mul_f32 v245, 0x3fb8aa3b, v245
    v_exp_f32 v244, v244
    v_exp_f32 v245, v245
    v_mul_f32 v246, v246, v228
    v_mul_f32 v247, v247, v228
    v_mul_f32 v232, 0x3e22f983, v246
    v_mul_f32 v233, 0x3e22f983, v247
    v_cvt_pk_bf16_f32 v246, v244, v245
    v_lshlrev_b32_e64 v244, 16, v246
    v_and_b32 v245, 0xffff0000, v246
    v_mul_f32 v244, v244, v228
    v_mul_f32 v245, v245, v228
    v_mul_f32 v230, 0xbfb8aa3b, v244
    v_mul_f32 v231, 0xbfb8aa3b, v245
    s_mul_i32 s4, s58, 16896
    s_add_u32 s4, s4, 93184
    v_lshl_add_u32 v229, v0, 3, s4
    v_add_f32 v228, v228, v228
    v_lshlrev_b32 v236, 16, v226
    v_and_b32 v238, 0xffff0000, v226
    v_lshlrev_b32_e64 v237, 16, v227
    v_and_b32 v239, 0xffff0000, v227
    v_mul_f32 v236, v236, v228
    v_mul_f32 v237, v237, v228
    v_mul_f32 v238, v238, v228
    v_mul_f32 v239, v239, v228
    v_mul_f32 v244, 0x41000000, v230
    v_mul_f32 v246, 0x41000000, v232
    v_mul_f32 v245, 0x41000000, v231
    v_mul_f32 v247, 0x41000000, v233
    v_exp_f32 v244, v244
    v_fract_f32 v246, v246
    v_exp_f32 v245, v245
    v_fract_f32 v247, v247
    v_cos_f32 v240, v246
    v_sin_f32 v241, v246
    v_cos_f32 v242, v247
    v_sin_f32 v243, v247
    v_mul_f32 v240, v240, v244
    v_mul_f32 v241, v241, v244
    v_mul_f32 v242, v242, v245
    v_mul_f32_e64 v243, v243, v245
    s_mov_b32 s4, 0
LV_1:
    v_cvt_pk_bf16_f32 v248, v236, -v237
    v_cvt_pk_bf16_f32 v249, v238, -v239
    ds_write_b64 v229, v[248:249] offset:0
    v_pk_mul_f32 v[244:245], v[236:237], v[240:241] op_sel_hi:[1,0]
    v_pk_mul_f32 v[246:247], v[238:239], v[242:243] op_sel_hi:[1,0]
    v_pk_fma_f32 v[236:237], v[236:237], v[240:241], v[244:245] op_sel:[1,1,0] op_sel_hi:[0,1,1] neg_lo:[1,0,0]
    v_pk_fma_f32 v[238:239], v[238:239], v[242:243], v[246:247] op_sel:[1,1,0] op_sel_hi:[0,1,1] neg_lo:[1,0,0]
    v_cvt_pk_bf16_f32 v250, v236, -v237
    v_cvt_pk_bf16_f32 v251, v238, -v239
    ds_write_b64 v229, v[250:251] offset:528
    v_pk_mul_f32 v[244:245], v[236:237], v[240:241] op_sel_hi:[1,0]
    v_pk_mul_f32 v[246:247], v[238:239], v[242:243] op_sel_hi:[1,0]
    v_pk_fma_f32 v[236:237], v[236:237], v[240:241], v[244:245] op_sel:[1,1,0] op_sel_hi:[0,1,1] neg_lo:[1,0,0]
    v_pk_fma_f32 v[238:239], v[238:239], v[242:243], v[246:247] op_sel:[1,1,0] op_sel_hi:[0,1,1] neg_lo:[1,0,0]
    v_cvt_pk_bf16_f32 v252, v236, -v237
    v_cvt_pk_bf16_f32 v253, v238, -v239
    ds_write_b64 v229, v[252:253] offset:1056
    v_pk_mul_f32 v[244:245], v[236:237], v[240:241] op_sel_hi:[1,0]
    v_pk_mul_f32 v[246:247], v[238:239], v[242:243] op_sel_hi:[1,0]
    v_pk_fma_f32 v[236:237], v[236:237], v[240:241], v[244:245] op_sel:[1,1,0] op_sel_hi:[0,1,1] neg_lo:[1,0,0]
    v_pk_fma_f32 v[238:239], v[238:239], v[242:243], v[246:247] op_sel:[1,1,0] op_sel_hi:[0,1,1] neg_lo:[1,0,0]
    v_cvt_pk_bf16_f32 v254, v236, -v237
    v_cvt_pk_bf16_f32 v255, v238, -v239
    ds_write_b64 v229, v[254:255] offset:1584
    v_pk_mul_f32 v[244:245], v[236:237], v[240:241] op_sel_hi:[1,0]
    v_pk_mul_f32 v[246:247], v[238:239], v[242:243] op_sel_hi:[1,0]
    v_pk_fma_f32 v[236:237], v[236:237], v[240:241], v[244:245] op_sel:[1,1,0] op_sel_hi:[0,1,1] neg_lo:[1,0,0]
    v_pk_fma_f32 v[238:239], v[238:239], v[242:243], v[246:247] op_sel:[1,1,0] op_sel_hi:[0,1,1] neg_lo:[1,0,0]
    v_add_u32 v229, 2112, v229
    s_add_u32 s4, s4, 1
    s_cmp_lt_u32 s4, 8
    s_cbranch_scc1 LV_1
    s_nop 0
    ds_read_b128 v[48:51], v14 offset:0
    ds_read_b128 v[52:55], v14 offset:64
    ds_read_b128 v[56:59], v14 offset:128
    ds_read_b128 v[60:63], v14 offset:192
    ds_read_b128 v[64:67], v14 offset:256
    ds_read_b128 v[68:71], v14 offset:320
    ds_read_b128 v[72:75], v14 offset:384
    ds_read_b128 v[76:79], v14 offset:448
    ds_read_b128 v[80:83], v14 offset:8448
    ds_read_b128 v[84:87], v14 offset:8512
    ds_read_b128 v[88:91], v14 offset:8576
    ds_read_b128 v[92:95], v14 offset:8640
    ds_read_b128 v[96:99], v14 offset:8704
    ds_read_b128 v[100:103], v14 offset:8768
    ds_read_b128 v[104:107], v14 offset:8832
    ds_read_b128 v[108:111], v14 offset:8896
    v_exp_f32 v244, v230
    v_fract_f32 v246, v232
    v_exp_f32 v245, v231
    v_fract_f32 v247, v233
    v_cos_f32 v20, v246
    v_sin_f32 v21, v246
    v_cos_f32 v22, v247
    v_sin_f32 v23, v247
    v_mul_f32 v20, v20, v244
    v_mul_f32 v21, v21, v244
    v_mul_f32 v22, v22, v245
    v_mul_f32 v23, v23, v245
    v_mul_f32 v244, 0x43800000, v230
    v_mul_f32 v246, 0x43800000, v232
    v_mul_f32 v245, 0x43800000, v231
    v_mul_f32 v247, 0x43800000, v233
    v_exp_f32 v244, v244
    v_fract_f32 v246, v246
    v_exp_f32 v245, v245
    v_fract_f32 v247, v247
    v_cos_f32 v24, v246
    v_sin_f32 v25, v246
    v_cos_f32 v26, v247
    v_sin_f32 v27, v247
    v_mul_f32 v24, v24, v244
    v_mul_f32 v25, v25, v244
    v_mul_f32 v26, v26, v245
    v_mul_f32 v27, v27, v245
    v_mov_b32 v248, 0x3f80
    v_mov_b32 v249, 0x3f80
    ds_write_b64 v11, v[248:249]
    v_cvt_pk_bf16_f32 v250, v20, v21
    v_cvt_pk_bf16_f32 v251, v22, v23
    ds_write_b64 v11, v[250:251] offset:528
    v_pk_mul_f32 v[244:245], v[20:21], v[20:21] op_sel_hi:[1,0]
    v_pk_mul_f32 v[246:247], v[22:23], v[22:23] op_sel_hi:[1,0]
    v_pk_fma_f32 v[28:29], v[20:21], v[20:21], v[244:245] op_sel:[1,1,0] op_sel_hi:[0,1,1] neg_lo:[1,0,0]
    v_pk_fma_f32 v[30:31], v[22:23], v[22:23], v[246:247] op_sel:[1,1,0] op_sel_hi:[0,1,1] neg_lo:[1,0,0]
    v_cvt_pk_bf16_f32 v252, v28, v29
    v_cvt_pk_bf16_f32 v253, v30, v31
    ds_write_b64 v11, v[252:253] offset:1056
    v_pk_mul_f32 v[244:245], v[28:29], v[20:21] op_sel_hi:[1,0]
    v_pk_mul_f32 v[246:247], v[30:31], v[22:23] op_sel_hi:[1,0]
    v_pk_fma_f32 v[220:221], v[28:29], v[20:21], v[244:245] op_sel:[1,1,0] op_sel_hi:[0,1,1] neg_lo:[1,0,0]
    v_pk_fma_f32 v[222:223], v[30:31], v[22:23], v[246:247] op_sel:[1,1,0] op_sel_hi:[0,1,1] neg_lo:[1,0,0]
    v_pk_mul_f32 v[240:241], v[28:29], v[28:29] op_sel_hi:[1,0]
    v_pk_mul_f32 v[242:243], v[30:31], v[30:31] op_sel_hi:[1,0]
    v_pk_fma_f32 v[32:33], v[28:29], v[28:29], v[240:241] op_sel:[1,1,0] op_sel_hi:[0,1,1] neg_lo:[1,0,0]
    v_pk_fma_f32 v[34:35], v[30:31], v[30:31], v[242:243] op_sel:[1,1,0] op_sel_hi:[0,1,1] neg_lo:[1,0,0]
    v_cvt_pk_bf16_f32 v254, v220, v221
    v_cvt_pk_bf16_f32 v255, v222, v223
    ds_write_b64 v11, v[254:255] offset:1584
    v_cvt_pk_bf16_f32 v248, v32, v33
    v_cvt_pk_bf16_f32 v249, v34, v35
    ds_write_b64 v11, v[248:249] offset:2112
    v_pk_mul_f32 v[244:245], v[32:33], v[20:21] op_sel_hi:[1,0]
    v_pk_mul_f32 v[246:247], v[34:35], v[22:23] op_sel_hi:[1,0]
    v_pk_fma_f32 v[220:221], v[32:33], v[20:21], v[244:245] op_sel:[1,1,0] op_sel_hi:[0,1,1] neg_lo:[1,0,0]
    v_pk_fma_f32 v[222:223], v[34:35], v[22:23], v[246:247] op_sel:[1,1,0] op_sel_hi:[0,1,1] neg_lo:[1,0,0]
    v_pk_mul_f32 v[240:241], v[32:33], v[28:29] op_sel_hi:[1,0]
    v_pk_mul_f32 v[242:243], v[34:35], v[30:31] op_sel_hi:[1,0]
    v_pk_fma_f32 v[36:37], v[32:33], v[28:29], v[240:241] op_sel:[1,1,0] op_sel_hi:[0,1,1] neg_lo:[1,0,0]
    v_pk_fma_f32 v[38:39], v[34:35], v[30:31], v[242:243] op_sel:[1,1,0] op_sel_hi:[0,1,1] neg_lo:[1,0,0]
    v_cvt_pk_bf16_f32 v250, v220, v221
    v_cvt_pk_bf16_f32 v251, v222, v223
    ds_write_b64 v11, v[250:251] offset:2640
    v_cvt_pk_bf16_f32 v252, v36, v37
    v_cvt_pk_bf16_f32 v253, v38, v39
    ds_write_b64 v11, v[252:253] offset:3168
    v_pk_mul_f32 v[244:245], v[36:37], v[20:21] op_sel_hi:[1,0]
    v_pk_mul_f32 v[246:247], v[38:39], v[22:23] op_sel_hi:[1,0]
    v_pk_fma_f32 v[220:221], v[36:37], v[20:21], v[244:245] op_sel:[1,1,0] op_sel_hi:[0,1,1] neg_lo:[1,0,0]
    v_pk_fma_f32 v[222:223], v[38:39], v[22:23], v[246:247] op_sel:[1,1,0] op_sel_hi:[0,1,1] neg_lo:[1,0,0]
    v_pk_mul_f32 v[240:241], v[36:37], v[28:29] op_sel_hi:[1,0]
    v_pk_mul_f32 v[242:243], v[38:39], v[30:31] op_sel_hi:[1,0]
    v_pk_fma_f32 v[40:41], v[36:37], v[28:29], v[240:241] op_sel:[1,1,0] op_sel_hi:[0,1,1] neg_lo:[1,0,0]
    v_pk_fma_f32 v[42:43], v[38:39], v[30:31], v[242:243] op_sel:[1,1,0] op_sel_hi:[0,1,1] neg_lo:[1,0,0]
    v_cvt_pk_bf16_f32 v254, v220, v221
    v_cvt_pk_bf16_f32 v255, v222, v223
    ds_write_b64 v11, v[254:255] offset:3696
    v_cvt_pk_bf16_f32 v248, v40, v41
    v_cvt_pk_bf16_f32 v249, v42, v43
    ds_write_b64 v11, v[248:249] offset:4224
    v_pk_mul_f32 v[244:245], v[40:41], v[20:21] op_sel_hi:[1,0]
    v_pk_mul_f32 v[246:247], v[42:43], v[22:23] op_sel_hi:[1,0]
    v_pk_fma_f32 v[220:221], v[40:41], v[20:21], v[244:245] op_sel:[1,1,0] op_sel_hi:[0,1,1] neg_lo:[1,0,0]
    v_pk_fma_f32 v[222:223], v[42:43], v[22:23], v[246:247] op_sel:[1,1,0] op_sel_hi:[0,1,1] neg_lo:[1,0,0]
    v_pk_mul_f32 v[240:241], v[40:41], v[28:29] op_sel_hi:[1,0]
    v_pk_mul_f32 v[242:243], v[42:43], v[30:31] op_sel_hi:[1,0]
    v_pk_fma_f32 v[44:45], v[40:41], v[28:29], v[240:241] op_sel:[1,1,0] op_sel_hi:[0,1,1] neg_lo:[1,0,0]
    v_pk_fma_f32 v[46:47], v[42:43], v[30:31], v[242:243] op_sel:[1,1,0] op_sel_hi:[0,1,1] neg_lo:[1,0,0]
    v_cvt_pk_bf16_f32 v250, v220, v221
    v_cvt_pk_bf16_f32 v251, v222, v223
    ds_write_b64 v11, v[250:251] offset:4752
    v_cvt_pk_bf16_f32 v252, v44, v45
    v_cvt_pk_bf16_f32 v253, v46, v47
    ds_write_b64 v11, v[252:253] offset:5280
    v_cvt_pk_bf16_f32 v254, v24, v25
    v_cvt_pk_bf16_f32 v255, v26, v27
    ds_write_b64 v11, v[254:255] offset:5808
    v_pk_mul_f32 v[244:245], v[28:29], v[24:25] op_sel_hi:[1,0]
    v_pk_mul_f32 v[246:247], v[30:31], v[26:27] op_sel_hi:[1,0]
    v_pk_fma_f32 v[220:221], v[28:29], v[24:25], v[244:245] op_sel:[1,1,0] op_sel_hi:[0,1,1] neg_lo:[1,0,0]
    v_pk_fma_f32 v[222:223], v[30:31], v[26:27], v[246:247] op_sel:[1,1,0] op_sel_hi:[0,1,1] neg_lo:[1,0,0]
    v_cvt_pk_bf16_f32 v248, v220, v221
    v_cvt_pk_bf16_f32 v249, v222, v223
    ds_write_b64 v11, v[248:249] offset:6336
    v_pk_mul_f32 v[244:245], v[32:33], v[24:25] op_sel_hi:[1,0]
    v_pk_mul_f32 v[246:247], v[34:35], v[26:27] op_sel_hi:[1,0]
    v_pk_fma_f32 v[220:221], v[32:33], v[24:25], v[244:245] op_sel:[1,1,0] op_sel_hi:[0,1,1] neg_lo:[1,0,0]
    v_pk_fma_f32 v[222:223], v[34:35], v[26:27], v[246:247] op_sel:[1,1,0] op_sel_hi:[0,1,1] neg_lo:[1,0,0]
    v_cvt_pk_bf16_f32 v250, v220, v221
    v_cvt_pk_bf16_f32 v251, v222, v223
    ds_write_b64 v11, v[250:251] offset:6864
    v_pk_mul_f32 v[244:245], v[36:37], v[24:25] op_sel_hi:[1,0]
    v_pk_mul_f32 v[246:247], v[38:39], v[26:27] op_sel_hi:[1,0]
    v_pk_fma_f32 v[220:221], v[36:37], v[24:25], v[244:245] op_sel:[1,1,0] op_sel_hi:[0,1,1] neg_lo:[1,0,0]
    v_pk_fma_f32 v[222:223], v[38:39], v[26:27], v[246:247] op_sel:[1,1,0] op_sel_hi:[0,1,1] neg_lo:[1,0,0]
    v_cvt_pk_bf16_f32 v252, v220, v221
    v_cvt_pk_bf16_f32 v253, v222, v223
    ds_write_b64 v11, v[252:253] offset:7392
    v_pk_mul_f32 v[244:245], v[40:41], v[24:25] op_sel_hi:[1,0]
    v_pk_mul_f32 v[246:247], v[42:43], v[26:27] op_sel_hi:[1,0]
    v_pk_fma_f32 v[220:221], v[40:41], v[24:25], v[244:245] op_sel:[1,1,0] op_sel_hi:[0,1,1] neg_lo:[1,0,0]
    v_pk_fma_f32 v[222:223], v[42:43], v[26:27], v[246:247] op_sel:[1,1,0] op_sel_hi:[0,1,1] neg_lo:[1,0,0]
    v_cvt_pk_bf16_f32 v254, v220, v221
    v_cvt_pk_bf16_f32 v255, v222, v223
    ds_write_b64 v11, v[254:255] offset:7920
    v_pk_mul_f32 v[244:245], v[44:45], v[24:25] op_sel_hi:[1,0]
    v_pk_mul_f32 v[246:247], v[46:47], v[26:27] op_sel_hi:[1,0]
    v_pk_fma_f32 v[220:221], v[44:45], v[24:25], v[244:245] op_sel:[1,1,0] op_sel_hi:[0,1,1] neg_lo:[1,0,0]
    v_pk_fma_f32 v[222:223], v[46:47], v[26:27], v[246:247] op_sel:[1,1,0] op_sel_hi:[0,1,1] neg_lo:[1,0,0]
    v_cvt_pk_bf16_f32 v248, v220, v221
    v_cvt_pk_bf16_f32 v249, v222, v223
    ds_write_b64 v11, v[248:249] offset:8448
    ds_read_b128 v[112:115], v12 offset:0
    ds_read_b128 v[116:119], v12 offset:64
    ds_read_b128 v[120:123], v12 offset:128
    ds_read_b128 v[124:127], v12 offset:192
    ds_read_b128 v[128:131], v12 offset:256
    ds_read_b128 v[132:135], v12 offset:320
    ds_read_b128 v[136:139], v12 offset:384
    ds_read_b128 v[140:143], v12 offset:448
    v_pk_mul_f32 v[244:245], v[24:25], v[24:25] op_sel_hi:[1,0]
    v_pk_mul_f32 v[246:247], v[26:27], v[26:27] op_sel_hi:[1,0]
    v_pk_fma_f32 v[236:237], v[24:25], v[24:25], v[244:245] op_sel:[1,1,0] op_sel_hi:[0,1,1] neg_lo:[1,0,0]
    v_pk_fma_f32 v[238:239], v[26:27], v[26:27], v[246:247] op_sel:[1,1,0] op_sel_hi:[0,1,1] neg_lo:[1,0,0]
    v_cvt_pk_bf16_f32 v250, v236, v237
    v_cvt_pk_bf16_f32 v251, v238, v239
    ds_write_b64 v11, v[250:251] offset:8976
    v_pk_mul_f32 v[244:245], v[32:33], v[236:237] op_sel_hi:[1,0]
    v_pk_mul_f32 v[246:247], v[34:35], v[238:239] op_sel_hi:[1,0]
    v_pk_fma_f32 v[220:221], v[32:33], v[236:237], v[244:245] op_sel:[1,1,0] op_sel_hi:[0,1,1] neg_lo:[1,0,0]
    v_pk_fma_f32 v[222:223], v[34:35], v[238:239], v[246:247] op_sel:[1,1,0] op_sel_hi:[0,1,1] neg_lo:[1,0,0]
    v_cvt_pk_bf16_f32 v252, v220, v221
    v_cvt_pk_bf16_f32 v253, v222, v223
    ds_write_b64 v11, v[252:253] offset:9504
    v_pk_mul_f32 v[244:245], v[40:41], v[236:237] op_sel_hi:[1,0]
    v_pk_mul_f32 v[246:247], v[42:43], v[238:239] op_sel_hi:[1,0]
    v_pk_fma_f32 v[220:221], v[40:41], v[236:237], v[244:245] op_sel:[1,1,0] op_sel_hi:[0,1,1] neg_lo:[1,0,0]
    v_pk_fma_f32 v[222:223], v[42:43], v[238:239], v[246:247] op_sel:[1,1,0] op_sel_hi:[0,1,1] neg_lo:[1,0,0]
    v_cvt_pk_bf16_f32 v254, v220, v221
    v_cvt_pk_bf16_f32 v255, v222, v223
    ds_write_b64 v11, v[254:255] offset:10032
    v_pk_mul_f32 v[244:245], v[236:237], v[24:25] op_sel_hi:[1,0]
    v_pk_mul_f32 v[246:247], v[238:239], v[26:27] op_sel_hi:[1,0]
    v_pk_fma_f32 v[236:237], v[236:237], v[24:25], v[244:245] op_sel:[1,1,0] op_sel_hi:[0,1,1] neg_lo:[1,0,0]
    v_pk_fma_f32 v[238:239], v[238:239], v[26:27], v[246:247] op_sel:[1,1,0] op_sel_hi:[0,1,1] neg_lo:[1,0,0]
    v_cvt_pk_bf16_f32 v248, v236, v237
    v_cvt_pk_bf16_f32 v249, v238, v239
    ds_write_b64 v11, v[248:249] offset:10560
    v_pk_mul_f32 v[244:245], v[32:33], v[236:237] op_sel_hi:[1,0]
    v_pk_mul_f32 v[246:247], v[34:35], v[238:239] op_sel_hi:[1,0]
    v_pk_fma_f32 v[220:221], v[32:33], v[236:237], v[244:245] op_sel:[1,1,0] op_sel_hi:[0,1,1] neg_lo:[1,0,0]
    v_pk_fma_f32 v[222:223], v[34:35], v[238:239], v[246:247] op_sel:[1,1,0] op_sel_hi:[0,1,1] neg_lo:[1,0,0]
    v_cvt_pk_bf16_f32 v250, v220, v221
    v_cvt_pk_bf16_f32 v251, v222, v223
    ds_write_b64 v11, v[250:251] offset:11088
    v_pk_mul_f32 v[244:245], v[40:41], v[236:237] op_sel_hi:[1,0]
    v_pk_mul_f32 v[246:247], v[42:43], v[238:239] op_sel_hi:[1,0]
    v_pk_fma_f32 v[220:221], v[40:41], v[236:237], v[244:245] op_sel:[1,1,0] op_sel_hi:[0,1,1] neg_lo:[1,0,0]
    v_pk_fma_f32 v[222:223], v[42:43], v[238:239], v[246:247] op_sel:[1,1,0] op_sel_hi:[0,1,1] neg_lo:[1,0,0]
    v_cvt_pk_bf16_f32 v252, v220, v221
    v_cvt_pk_bf16_f32 v253, v222, v223
    ds_write_b64 v11, v[252:253] offset:11616
    v_pk_mul_f32 v[244:245], v[220:221], v[24:25] op_sel_hi:[1,0]
    v_pk_mul_f32 v[246:247], v[222:223], v[26:27] op_sel_hi:[1,0]
    v_pk_fma_f32 v[220:221], v[220:221], v[24:25], v[244:245] op_sel:[1,1,0] op_sel_hi:[0,1,1] neg_lo:[1,0,0]
    v_pk_fma_f32 v[222:223], v[222:223], v[26:27], v[246:247] op_sel:[1,1,0] op_sel_hi:[0,1,1] neg_lo:[1,0,0]
    v_cvt_pk_bf16_f32 v254, v220, v221
    v_cvt_pk_bf16_f32 v255, v222, v223
    ds_write_b64 v11, v[254:255] offset:12144
    v_pk_mul_f32 v[244:245], v[220:221], v[24:25] op_sel_hi:[1,0]
    v_pk_mul_f32 v[246:247], v[222:223], v[26:27] op_sel_hi:[1,0]
    v_pk_fma_f32 v[220:221], v[220:221], v[24:25], v[244:245] op_sel:[1,1,0] op_sel_hi:[0,1,1] neg_lo:[1,0,0]
    v_pk_fma_f32 v[222:223], v[222:223], v[26:27], v[246:247] op_sel:[1,1,0] op_sel_hi:[0,1,1] neg_lo:[1,0,0]
    v_cvt_pk_bf16_f32 v248, v220, v221
    v_cvt_pk_bf16_f32 v249, v222, v223
    ds_write_b64 v11, v[248:249] offset:12672
    v_pk_mul_f32 v[244:245], v[220:221], v[24:25] op_sel_hi:[1,0]
    v_pk_mul_f32 v[246:247], v[222:223], v[26:27] op_sel_hi:[1,0]
    v_pk_fma_f32 v[220:221], v[220:221], v[24:25], v[244:245] op_sel:[1,1,0] op_sel_hi:[0,1,1] neg_lo:[1,0,0]
    v_pk_fma_f32 v[222:223], v[222:223], v[26:27], v[246:247] op_sel:[1,1,0] op_sel_hi:[0,1,1] neg_lo:[1,0,0]
    v_cvt_pk_bf16_f32 v250, v220, v221
    v_cvt_pk_bf16_f32 v251, v222, v223
    ds_write_b64 v11, v[250:251] offset:13200
    v_pk_mul_f32 v[244:245], v[220:221], v[24:25] op_sel_hi:[1,0]
    v_pk_mul_f32 v[246:247], v[222:223], v[26:27] op_sel_hi:[1,0]
    v_pk_fma_f32 v[220:221], v[220:221], v[24:25], v[244:245] op_sel:[1,1,0] op_sel_hi:[0,1,1] neg_lo:[1,0,0]
    v_pk_fma_f32 v[222:223], v[222:223], v[26:27], v[246:247] op_sel:[1,1,0] op_sel_hi:[0,1,1] neg_lo:[1,0,0]
    v_cvt_pk_bf16_f32 v252, v220, v221
    v_cvt_pk_bf16_f32 v253, v222, v223
    ds_write_b64 v11, v[252:253] offset:13728
    ds_read_b128 v[144:147], v13 offset:0
    ds_read_b128 v[148:151], v13 offset:64
    ds_read_b128 v[152:155], v13 offset:128
    ds_read_b128 v[156:159], v13 offset:192
    ds_read_b128 v[160:163], v13 offset:256
    ds_read_b128 v[164:167], v13 offset:320
    ds_read_b128 v[168:171], v13 offset:384
    ds_read_b128 v[172:175], v13 offset:448
    s_mov_b64 exec, 0xffff
    ds_write_b64 v196, v[8:9]
    s_mov_b32 exec_lo, -1
    ds_write_b64 v197, v[8:9] offset:2080
    ds_write_b64 v198, v[8:9] offset:9472
    s_mov_b64 exec, -1
    s_waitcnt lgkmcnt(9)
    v_mfma_f32_16x16x32_bf16 v[204:207], v[112:115], v[48:51], 0
    v_mfma_f32_16x16x32_bf16 v[212:215], v[144:147], v[48:51], 0
    v_mfma_f32_16x16x32_bf16 v[204:207], v[116:119], v[52:55], v[204:207]
    v_mfma_f32_16x16x32_bf16 v[212:215], v[148:151], v[52:55], v[212:215]
    s_waitcnt lgkmcnt(7)
    v_mfma_f32_16x16x32_bf16 v[204:207], v[120:123], v[56:59], v[204:207]
    v_mfma_f32_16x16x32_bf16 v[212:215], v[152:155], v[56:59], v[212:215]
    v_mfma_f32_16x16x32_bf16 v[204:207], v[124:127], v[60:63], v[204:207]
    v_mfma_f32_16x16x32_bf16 v[212:215], v[156:159], v[60:63], v[212:215]
    s_waitcnt lgkmcnt(5)
    v_mfma_f32_16x16x32_bf16 v[204:207], v[128:131], v[64:67], v[204:207]
    v_mfma_f32_16x16x32_bf16 v[212:215], v[160:163], v[64:67], v[212:215]
    v_mfma_f32_16x16x32_bf16 v[204:207], v[132:135], v[68:71], v[204:207]
    v_mfma_f32_16x16x32_bf16 v[212:215], v[164:167], v[68:71], v[212:215]
    s_waitcnt lgkmcnt(3)
    v_mfma_f32_16x16x32_bf16 v[204:207], v[136:139], v[72:75], v[204:207]
    v_mfma_f32_16x16x32_bf16 v[212:215], v[168:171], v[72:75], v[212:215]
    v_mfma_f32_16x16x32_bf16 v[204:207], v[140:143], v[76:79], v[204:207]
    v_mfma_f32_16x16x32_bf16 v[212:215], v[172:175], v[76:79], v[212:215]
    v_mfma_f32_16x16x32_bf16 v[208:211], v[112:115], v[80:83], 0
    v_mfma_f32_16x16x32_bf16 v[216:219], v[144:147], v[80:83], 0
    v_mfma_f32_16x16x32_bf16 v[208:211], v[116:119], v[84:87], v[208:211]
    v_mfma_f32_16x16x32_bf16 v[216:219], v[148:151], v[84:87], v[216:219]
    v_mfma_f32_16x16x32_bf16 v[208:211], v[120:123], v[88:91], v[208:211]
    v_mfma_f32_16x16x32_bf16 v[216:219], v[152:155], v[88:91], v[216:219]
    v_mfma_f32_16x16x32_bf16 v[208:211], v[124:127], v[92:95], v[208:211]
    v_mfma_f32_16x16x32_bf16 v[216:219], v[156:159], v[92:95], v[216:219]
    v_mfma_f32_16x16x32_bf16 v[208:211], v[128:131], v[96:99], v[208:211]
    v_mfma_f32_16x16x32_bf16 v[216:219], v[160:163], v[96:99], v[216:219]
    v_mfma_f32_16x16x32_bf16 v[208:211], v[132:135], v[100:103], v[208:211]
    v_mfma_f32_16x16x32_bf16 v[216:219], v[164:167], v[100:103], v[216:219]
    v_mfma_f32_16x16x32_bf16 v[208:211], v[136:139], v[104:107], v[208:211]
    v_mfma_f32_16x16x32_bf16 v[216:219], v[168:171], v[104:107], v[216:219]
    v_mfma_f32_16x16x32_bf16 v[208:211], v[140:143], v[108:111], v[208:211]
    v_mfma_f32_16x16x32_bf16 v[216:219], v[172:175], v[108:111], v[216:219]
    s_lshl_b32 s4, s58, 4
    s_lshr_b64 s[6:7], s[66:67], s4
    s_lshl_b32 s6, s6, 16
    s_nop 3
    v_permlane32_swap_b32 v204, v208
    v_permlane32_swap_b32 v205, v209
    v_permlane32_swap_b32 v206, v210
    v_permlane32_swap_b32 v207, v211
    v_cvt_pk_bf16_f32 v248, v215, v219
    s_mov_b64 exec, 1
    v_add_f32 v204, s6, v204
    v_add_f32_e64 v204, 1.0, v204
    s_mov_b64 exec, -1
    v_permlane32_swap_b32 v212, v216
    v_permlane32_swap_b32 v213, v217
    v_permlane32_swap_b32 v214, v218
    ds_write_b16 v201, v248 offset:9504
    ds_write_b16_d16_hi v201, v248 offset:9520
    ds_write_b16 v201, v248 offset:9662
    ds_write_b16_d16_hi v201, v248 offset:9678
    ds_write_b16 v201, v248 offset:9820
    ds_write_b16_d16_hi v201, v248 offset:9836
    ds_write_b16 v201, v248 offset:9978
    ds_write_b16_d16_hi v201, v248 offset:9994
    v_cvt_pk_bf16_f32 v48, v204, v205
    v_cvt_pk_bf16_f32 v49, v206, v207
    ds_write_b64 v199, v[48:49] offset:32
    v_cvt_pk_bf16_f32 v50, v205, v206
    v_cvt_pk_bf16_f32 v51, v207, v212
    ds_write_b64 v199, v[50:51] offset:2400
    v_cvt_pk_bf16_f32 v52, v206, v207
    v_cvt_pk_bf16_f32 v53, v212, v213
    ds_write_b64 v199, v[52:53] offset:4768
    v_cvt_pk_bf16_f32 v54, v207, v212
    v_cvt_pk_bf16_f32 v55, v213, v214
    ds_write_b64 v199, v[54:55] offset:7136
    v_cvt_pk_bf16_f32 v56, v208, v208
    v_cvt_pk_bf16_f32 v57, v209, v210
    ds_write_b64 v199, v[56:57] offset:544
    v_cvt_pk_bf16_f32 v58, v208, v209
    v_cvt_pk_bf16_f32 v59, v210, v210
    ds_write_b64 v199, v[58:59] offset:2912
    v_cvt_pk_bf16_f32 v60, v209, v210
    v_cvt_pk_bf16_f32 v61, v210, v210
    ds_write_b64 v199, v[60:61] offset:5280
    v_cvt_pk_bf16_f32 v62, v210, v210
    v_cvt_pk_bf16_f32 v63, v210, v211
    ds_write_b64 v199, v[62:63] offset:7648
    v_cvt_pk_bf16_f32 v64, v216, v216
    v_cvt_pk_bf16_f32 v65, v216, v217
    v_cvt_pk_bf16_f32 v66, v217, v217
    v_cvt_pk_bf16_f32 v67, v218, v218
    ds_write_b128 v200, v[64:67] offset:1056
    v_cvt_pk_bf16_f32 v68, v216, v216
    v_cvt_pk_bf16_f32 v69, v217, v217
    v_cvt_pk_bf16_f32 v70, v217, v218
    v_cvt_pk_bf16_f32 v71, v218, v218
    ds_write_b128 v200, v[68:71] offset:3424
    v_cvt_pk_bf16_f32 v72, v216, v217
    v_cvt_pk_bf16_f32 v73, v217, v217
    v_cvt_pk_bf16_f32 v74, v218, v218
    v_cvt_pk_bf16_f32 v75, v218, v218
    ds_write_b128 v200, v[72:75] offset:5792
    v_cvt_pk_bf16_f32 v76, v217, v217
    v_cvt_pk_bf16_f32 v77, v217, v218
    v_cvt_pk_bf16_f32 v78, v218, v218
    v_cvt_pk_bf16_f32 v79, v218, v218
    ds_write_b128 v200, v[76:79] offset:8160
    v_cvt_pk_bf16_f32 v80, v8, v204
    v_mov_b32 v81, v50
    v_mov_b32 v82, v79
    v_cvt_pk_bf16_f32 v83, v218, v8
    s_mov_b64 exec, 1
    ds_write_b32 v202, v80 offset:2396
    ds_write_b32 v202, v48 offset:4764
    ds_write_b64 v202, v[80:81] offset:7128
    s_brev_b64 exec, 1
    ds_write_b64 v202, v[78:79] offset:2080
    ds_write_b32 v202, v83 offset:2088
    ds_write_b64 v202, v[78:79] offset:4448
    ds_write_b64 v202, v[82:83] offset:6816
    ds_write_b32 v202, v79 offset:9184
    s_mov_b64 exec, -1
    s_mov_b64 exec, 1
    ds_write_b32 v4, v5 offset:160
    s_mov_b64 exec, -1
    v_lshl_add_u32 v15, v0, 3, s10
LW_2:
    ds_read_b32 v34, v6 offset:128
    s_waitcnt lgkmcnt(0)
    v_cmp_eq_u32 vcc, 0, v34
    s_cbranch_vccnz LW_2
    ds_write_b64 v15, v[8:9] offset:4096
    v_lshlrev_b32 v7, 4, v2
    v_lshlrev_b32 v15, 5, v1
    v_sub_u32_e64 v7, v7, v15
    s_add_u32 s4, s10, 480
    v_add_u32 v7, s4, v7
    s_lshl_b32 s4, s58, 13
    s_add_u32 s4, s4, 93184
    v_lshlrev_b32_e64 v15, 6, v1
    v_lshl_add_u32 v15, v2, 4, v15
    v_add_u32 v8, s4, v15
    v_sub_u32 v204, 20, v1
    v_lshlrev_b32_e64 v205, 3, v2
    v_mov_b32 v206, 0x7f
    v_lshlrev_b32 v206, v204, v206
    v_subrev_u32 v204, 1, v204
    v_mov_b32 v207, 0x1ff
    v_lshlrev_b32 v207, v204, v207
    v_lshrrev_b32 v206, v205, v206
    v_lshrrev_b32 v207, v205, v207
    v_add_u32 v15, 1, v1
    v_and_b32 v204, 3, v15
    v_and_b32 v15, 28, v15
    v_lshl_add_u32 v208, v2, 3, v15
    v_lshl_add_u32 v208, v208, 1, s8
    v_mad_u32_u24 v1, v204, s9, v208
    v_lshlrev_b32 v208, 2, v2
    v_sub_u32 v15, v15, v208
    v_lshl_add_u32 v15, v15, 1, s8
    s_movk_i32 s4, 160
    v_mad_u32_u24 v2, v204, s4, v15
    s_mov_b32 s15, 0x3f800000
    ds_read_b64 v[48:49], v1 offset:0
    v_bfe_i32 v209, v206, 0, 1
    ds_read_b64 v[50:51], v1 offset:8
    v_bfe_i32 v210, v206, 1, 1
    ds_read_b64 v[52:53], v1 offset:64
    v_and_b32 v209, 0x3f80, v209
    ds_read_b64 v[54:55], v1 offset:72
    v_bfi_b32 v244, s15, v210, v209
    ds_read_b64 v[56:57], v1 offset:128
    v_bfe_i32 v209, v206, 2, 1
    ds_read_b64 v[58:59], v1 offset:136
    v_bfe_i32 v210, v206, 3, 1
    ds_read_b64 v[60:61], v1 offset:192
    v_and_b32 v209, 0x3f80, v209
    ds_read_b64 v[62:63], v1 offset:200
    v_bfi_b32 v245, s15, v210, v209
    ds_read_b64 v[64:65], v1 offset:256
    v_bfe_i32 v209, v206, 4, 1
    ds_read_b64 v[66:67], v1 offset:264
    v_bfe_i32 v210, v206, 5, 1
    ds_read_b64 v[68:69], v1 offset:320
    v_and_b32 v209, 0x3f80, v209
    ds_read_b64 v[70:71], v1 offset:328
    v_bfi_b32 v246, s15, v210, v209
    ds_read_b64 v[72:73], v1 offset:384
    v_bfe_i32 v209, v206, 6, 1
    ds_read_b64 v[74:75], v1 offset:392
    v_bfe_i32 v210, v206, 7, 1
    ds_read_b64 v[76:77], v1 offset:448
    v_and_b32 v209, 0x3f80, v209
    ds_read_b64 v[78:79], v1 offset:456
    v_bfi_b32 v247, s15, v210, v209
    ds_read_b64 v[80:81], v1 offset:512
    v_bfe_i32 v209, v207, 0, 1
    ds_read_b64 v[82:83], v1 offset:520
    v_bfe_i32 v210, v207, 1, 1
    ds_read_b64 v[84:85], v1 offset:576
    v_and_b32 v209, 0x3f80, v209
    ds_read_b64 v[86:87], v1 offset:584
    v_bfi_b32 v248, s15, v210, v209
    ds_read_b64 v[88:89], v1 offset:640
    v_bfe_i32 v209, v207, 2, 1
    ds_read_b64 v[90:91], v1 offset:648
    v_bfe_i32 v210, v207, 3, 1
    ds_read_b64 v[92:93], v1 offset:704
    v_and_b32 v209, 0x3f80, v209
    ds_read_b64 v[94:95], v1 offset:712
    v_bfi_b32 v249, s15, v210, v209
    ds_read_b64 v[96:97], v1 offset:768
    v_bfe_i32 v209, v207, 4, 1
    ds_read_b64 v[98:99], v1 offset:776
    v_bfe_i32 v210, v207, 5, 1
    ds_read_b64 v[100:101], v1 offset:832
    v_and_b32 v209, 0x3f80, v209
    ds_read_b64 v[102:103], v1 offset:840
    v_bfi_b32 v250, s15, v210, v209
    ds_read_b64 v[104:105], v1 offset:896
    v_bfe_i32 v209, v207, 6, 1
    ds_read_b64 v[106:107], v1 offset:904
    v_bfe_i32 v210, v207, 7, 1
    ds_read_b64 v[108:109], v1 offset:960
    v_and_b32 v209, 0x3f80, v209
    ds_read_b64 v[110:111], v1 offset:968
    v_bfi_b32 v251, s15, v210, v209
    ds_read_b64 v[112:113], v1 offset:1024
    v_lshlrev_b32_e64 v33, 4, v10
    ds_read_b64 v[114:115], v1 offset:1032
    v_add_u32 v32, 142336, v33
    ds_read_b64 v[116:117], v1 offset:1088
    s_lshl_b32 s13, s57, 14
    ds_read_b64 v[118:119], v1 offset:1096
    s_add_u32 s13, s13, 3145728
    ds_read_b64 v[120:121], v1 offset:1152
    s_and_b32 s12, s2, 7
    ds_read_b64 v[122:123], v1 offset:1160
    s_lshl_b32 s12, s12, 11
    ds_read_b64 v[124:125], v1 offset:1216
    s_lshl_b32 s4, s58, 7
    ds_read_b64 v[126:127], v1 offset:1224
    s_add_u32 s12, s12, s4
    ds_read_b64 v[128:129], v1 offset:1280
    s_lshr_b32 s4, s2, 3
    ds_read_b64 v[130:131], v1 offset:1288
    s_lshl_b32 s4, s4, 2
    ds_read_b64 v[132:133], v1 offset:1344
    s_add_u32 s12, s12, s4
    ds_read_b64 v[134:135], v1 offset:1352
    s_add_u32 s12, s12, 1015808
    ds_read_b64 v[136:137], v1 offset:1408
    v_lshlrev_b32_e64 v10, 3, v10
    ds_read_b64 v[138:139], v1 offset:1416
    v_add_u32 v9, 93184, v10
    ds_read_b64 v[140:141], v1 offset:1472
    s_mov_b32 s11, 0
    ds_read_b64 v[142:143], v1 offset:1480
    s_brev_b32 s68, 1
    ds_read_b64 v[144:145], v1 offset:1536
    ds_read_b64 v[146:147], v1 offset:1544
    ds_read_b64 v[148:149], v1 offset:1600
    ds_read_b64 v[150:151], v1 offset:1608
    ds_read_b64 v[152:153], v1 offset:1664
    ds_read_b64 v[154:155], v1 offset:1672
    ds_read_b64 v[156:157], v1 offset:1728
    ds_read_b64 v[158:159], v1 offset:1736
    ds_read_b64 v[160:161], v1 offset:1792
    ds_read_b64 v[162:163], v1 offset:1800
    ds_read_b64 v[164:165], v1 offset:1856
    ds_read_b64 v[166:167], v1 offset:1864
    ds_read_b64 v[168:169], v1 offset:1920
    ds_read_b64 v[170:171], v1 offset:1928
    ds_read_b64 v[172:173], v1 offset:1984
    ds_read_b64 v[174:175], v1 offset:1992
    ds_read_b64 v[176:177], v1 offset:2048
    ds_read_b64 v[178:179], v1 offset:2056
L_WXR:
    ds_read_b32 v11, v6 offset:160
    ds_read_b32 v15, v6 offset:0
    s_waitcnt lgkmcnt(0)
    v_min_u32 v11, v11, v15
    v_cmp_eq_u32_e64 vcc, 0, v11
    s_cbranch_vccnz L_WXR
    v_readfirstlane_b32 s14, v15
    ds_read_b128 v[180:183], v7 offset:4032
    ds_read_b128 v[184:187], v7 offset:3584
    ds_read_b128 v[188:191], v7 offset:3600
    ds_read_b128 v[192:195], v7 offset:3968
    ds_read_b128 v[196:199], v7 offset:3072
    s_waitcnt lgkmcnt(4)
    s_nop 0
    v_mfma_f32_16x16x32_bf16 v[204:207], v[76:79], v[180:183], 0
    ds_read_b128 v[200:203], v7 offset:3088
    v_mfma_f32_16x16x32_bf16 v[208:211], v[108:111], v[180:183], 0
    v_mfma_f32_16x16x32_bf16 v[212:215], v[140:143], v[180:183], 0
    v_mfma_f32_16x16x32_bf16 v[216:219], v[172:175], v[180:183], 0
    s_waitcnt lgkmcnt(4)
    v_mfma_f32_16x16x32_bf16 v[220:223], v[184:187], v[244:247], 0
    ds_read_b128 v[180:183], v7 offset:3904
    s_waitcnt lgkmcnt(4)
    v_mfma_f32_16x16x32_bf16 v[224:227], v[188:191], v[248:251], 0
    ds_read_b128 v[184:187], v7 offset:3840
    s_waitcnt lgkmcnt(4)
    s_nop 0
    v_mfma_f32_16x16x32_bf16 v[204:207], v[72:75], v[192:195], v[204:207]
    ds_read_b128 v[188:191], v7 offset:2560
    v_mfma_f32_16x16x32_bf16 v[208:211], v[104:107], v[192:195], v[208:211]
    v_mfma_f32_16x16x32_bf16 v[212:215], v[136:139], v[192:195], v[212:215]
    v_mfma_f32_16x16x32_bf16 v[216:219], v[168:171], v[192:195], v[216:219]
    s_waitcnt lgkmcnt(4)
    v_mfma_f32_16x16x32_bf16 v[228:231], v[196:199], v[244:247], 0
    ds_read_b128 v[192:195], v7 offset:2576
    s_waitcnt lgkmcnt(4)
    v_mfma_f32_16x16x32_bf16 v[232:235], v[200:203], v[248:251], 0
    ds_read_b128 v[196:199], v7 offset:3776
    s_waitcnt lgkmcnt(4)
    s_nop 0
    v_mfma_f32_16x16x32_bf16 v[204:207], v[68:71], v[180:183], v[204:207]
    ds_read_b128 v[200:203], v7 offset:2048
    v_mfma_f32_16x16x32_bf16 v[208:211], v[100:103], v[180:183], v[208:211]
    v_cvt_pk_bf16_f32 v236, v223, v222
    v_cvt_pk_bf16_f32 v237, v221, v220
    v_mfma_f32_16x16x32_bf16 v[212:215], v[132:135], v[180:183], v[212:215]
    v_cvt_pk_bf16_f32 v238, v227, v226
    v_cvt_pk_bf16_f32 v239, v225, v224
    v_mfma_f32_16x16x32_bf16 v[216:219], v[164:167], v[180:183], v[216:219]
    v_cvt_pk_bf16_f32 v240, v231, v230
    v_cvt_pk_bf16_f32 v241, v229, v228
    s_waitcnt lgkmcnt(4)
    s_nop 0
    v_mfma_f32_16x16x32_bf16 v[204:207], v[64:67], v[184:187], v[204:207]
    ds_read_b128 v[180:183], v7 offset:2064
    v_mfma_f32_16x16x32_bf16 v[208:211], v[96:99], v[184:187], v[208:211]
    v_cvt_pk_bf16_f32 v242, v235, v234
    v_cvt_pk_bf16_f32 v243, v233, v232
    v_mfma_f32_16x16x32_bf16 v[212:215], v[128:131], v[184:187], v[212:215]
    v_mfma_f32_16x16x32_bf16 v[216:219], v[160:163], v[184:187], v[216:219]
    s_waitcnt lgkmcnt(4)
    v_mfma_f32_16x16x32_bf16 v[220:223], v[188:191], v[244:247], 0
    ds_read_b128 v[184:187], v7 offset:3712
    s_waitcnt lgkmcnt(4)
    v_mfma_f32_16x16x32_bf16 v[224:227], v[192:195], v[248:251], 0
    ds_read_b128 v[188:191], v7 offset:3648
    s_waitcnt lgkmcnt(4)
    s_nop 0
    v_mfma_f32_16x16x32_bf16 v[204:207], v[60:63], v[196:199], v[204:207]
    ds_read_b128 v[192:195], v7 offset:3584
    v_mfma_f32_16x16x32_bf16 v[208:211], v[92:95], v[196:199], v[208:211]
    v_mfma_f32_16x16x32_bf16 v[212:215], v[124:127], v[196:199], v[212:215]
    v_mfma_f32_16x16x32_bf16 v[216:219], v[156:159], v[196:199], v[216:219]
    s_waitcnt lgkmcnt(4)
    v_mfma_f32_16x16x32_bf16 v[228:231], v[200:203], v[244:247], 0
    ds_read_b128 v[196:199], v7 offset:3520
    s_waitcnt lgkmcnt(4)
    v_mfma_f32_16x16x32_bf16 v[232:235], v[180:183], v[248:251], 0
    ds_read_b128 v[200:203], v7 offset:3456
    s_waitcnt lgkmcnt(4)
    s_nop 0
    v_mfma_f32_16x16x32_bf16 v[204:207], v[56:59], v[184:187], v[204:207]
    ds_read_b128 v[180:183], v7 offset:3392
    v_mfma_f32_16x16x32_bf16 v[208:211], v[88:91], v[184:187], v[208:211]
    v_cvt_pk_bf16_f32 v244, v223, v222
    v_cvt_pk_bf16_f32 v245, v221, v220
    v_mfma_f32_16x16x32_bf16 v[212:215], v[120:123], v[184:187], v[212:215]
    v_cvt_pk_bf16_f32 v246, v227, v226
    v_cvt_pk_bf16_f32 v247, v225, v224
    v_mfma_f32_16x16x32_bf16 v[216:219], v[152:155], v[184:187], v[216:219]
    v_cvt_pk_bf16_f32 v248, v231, v230
    v_cvt_pk_bf16_f32 v249, v229, v228
    s_waitcnt lgkmcnt(4)
    s_nop 0
    v_mfma_f32_16x16x32_bf16 v[204:207], v[52:55], v[188:191], v[204:207]
    ds_read_b128 v[184:187], v7 offset:3328
    v_mfma_f32_16x16x32_bf16 v[208:211], v[84:87], v[188:191], v[208:211]
    v_cvt_pk_bf16_f32 v250, v235, v234
    v_cvt_pk_bf16_f32 v251, v233, v232
    v_mfma_f32_16x16x32_bf16 v[212:215], v[116:119], v[188:191], v[212:215]
    v_mfma_f32_16x16x32_bf16 v[216:219], v[148:151], v[188:191], v[216:219]
    s_waitcnt lgkmcnt(4)
    s_nop 0
    v_mfma_f32_16x16x32_bf16 v[204:207], v[48:51], v[192:195], v[204:207]
    ds_read_b128 v[188:191], v7 offset:3264
    v_mfma_f32_16x16x32_bf16 v[208:211], v[80:83], v[192:195], v[208:211]
    v_mfma_f32_16x16x32_bf16 v[212:215], v[112:115], v[192:195], v[212:215]
    v_mfma_f32_16x16x32_bf16 v[216:219], v[144:147], v[192:195], v[216:219]
    v_mfma_f32_16x16x32_bf16 v[220:223], v[176:179], v[192:195], 0
    s_waitcnt lgkmcnt(4)
    s_nop 0
    v_mfma_f32_16x16x32_bf16 v[208:211], v[76:79], v[196:199], v[208:211]
    ds_read_b128 v[192:195], v7 offset:3200
    v_mfma_f32_16x16x32_bf16 v[212:215], v[108:111], v[196:199], v[212:215]
    v_mfma_f32_16x16x32_bf16 v[216:219], v[140:143], v[196:199], v[216:219]
    v_mfma_f32_16x16x32_bf16 v[220:223], v[172:175], v[196:199], v[220:223]
    s_waitcnt lgkmcnt(4)
    s_nop 0
    v_mfma_f32_16x16x32_bf16 v[208:211], v[72:75], v[200:203], v[208:211]
    ds_read_b128 v[196:199], v7 offset:3136
    v_mfma_f32_16x16x32_bf16 v[212:215], v[104:107], v[200:203], v[212:215]
    v_mfma_f32_16x16x32_bf16 v[216:219], v[136:139], v[200:203], v[216:219]
    v_mfma_f32_16x16x32_bf16 v[220:223], v[168:171], v[200:203], v[220:223]
    s_waitcnt lgkmcnt(4)
    s_nop 0
    v_mfma_f32_16x16x32_bf16 v[208:211], v[68:71], v[180:183], v[208:211]
    ds_read_b128 v[200:203], v7 offset:3072
    v_mfma_f32_16x16x32_bf16 v[212:215], v[100:103], v[180:183], v[212:215]
    v_mfma_f32_16x16x32_bf16 v[216:219], v[132:135], v[180:183], v[216:219]
    v_mfma_f32_16x16x32_bf16 v[220:223], v[164:167], v[180:183], v[220:223]
    s_waitcnt lgkmcnt(4)
    s_nop 0
    v_mfma_f32_16x16x32_bf16 v[208:211], v[64:67], v[184:187], v[208:211]
    ds_read_b128 v[180:183], v7 offset:3008
    v_mfma_f32_16x16x32_bf16 v[212:215], v[96:99], v[184:187], v[212:215]
    v_mfma_f32_16x16x32_bf16 v[216:219], v[128:131], v[184:187], v[216:219]
    v_mfma_f32_16x16x32_bf16 v[220:223], v[160:163], v[184:187], v[220:223]
    s_waitcnt lgkmcnt(4)
    s_nop 0
    v_mfma_f32_16x16x32_bf16 v[208:211], v[60:63], v[188:191], v[208:211]
    ds_read_b128 v[184:187], v7 offset:2944
    v_mfma_f32_16x16x32_bf16 v[212:215], v[92:95], v[188:191], v[212:215]
    v_mfma_f32_16x16x32_bf16 v[216:219], v[124:127], v[188:191], v[216:219]
    v_mfma_f32_16x16x32_bf16 v[220:223], v[156:159], v[188:191], v[220:223]
    s_waitcnt lgkmcnt(4)
    s_nop 0
    v_mfma_f32_16x16x32_bf16 v[208:211], v[56:59], v[192:195], v[208:211]
    ds_read_b128 v[188:191], v7 offset:2880
    v_mfma_f32_16x16x32_bf16 v[212:215], v[88:91], v[192:195], v[212:215]
    v_mfma_f32_16x16x32_bf16 v[216:219], v[120:123], v[192:195], v[216:219]
    v_mfma_f32_16x16x32_bf16 v[220:223], v[152:155], v[192:195], v[220:223]
    s_waitcnt lgkmcnt(4)
    s_nop 0
    v_mfma_f32_16x16x32_bf16 v[208:211], v[52:55], v[196:199], v[208:211]
    ds_read_b128 v[192:195], v7 offset:2816
    v_mfma_f32_16x16x32_bf16 v[212:215], v[84:87], v[196:199], v[212:215]
    v_mfma_f32_16x16x32_bf16 v[216:219], v[116:119], v[196:199], v[216:219]
    v_mfma_f32_16x16x32_bf16 v[220:223], v[148:151], v[196:199], v[220:223]
    s_waitcnt lgkmcnt(4)
    s_nop 0
    v_mfma_f32_16x16x32_bf16 v[208:211], v[48:51], v[200:203], v[208:211]
    ds_read_b128 v[196:199], v7 offset:2752
    v_mfma_f32_16x16x32_bf16 v[212:215], v[80:83], v[200:203], v[212:215]
    v_mfma_f32_16x16x32_bf16 v[216:219], v[112:115], v[200:203], v[216:219]
    v_mfma_f32_16x16x32_bf16 v[220:223], v[144:147], v[200:203], v[220:223]
    v_mfma_f32_16x16x32_bf16 v[224:227], v[176:179], v[200:203], 0
    s_waitcnt lgkmcnt(4)
    s_nop 0
    v_mfma_f32_16x16x32_bf16 v[212:215], v[76:79], v[180:183], v[212:215]
    ds_read_b128 v[200:203], v7 offset:2688
    v_mfma_f32_16x16x32_bf16 v[216:219], v[108:111], v[180:183], v[216:219]
    ds_write_b128 v8, v[204:207] offset:0
    v_mfma_f32_16x16x32_bf16 v[220:223], v[140:143], v[180:183], v[220:223]
    ds_write_b128 v8, v[208:211] offset:1024
    v_mfma_f32_16x16x32_bf16 v[224:227], v[172:175], v[180:183], v[224:227]
    s_mov_b64 exec, 1
    ds_write_b32 v4, v5 offset:144
    s_mov_b64 exec, -1
    s_waitcnt lgkmcnt(7)
    s_nop 0
    v_mfma_f32_16x16x32_bf16 v[212:215], v[72:75], v[184:187], v[212:215]
    ds_read_b128 v[180:183], v7 offset:2624
    v_mfma_f32_16x16x32_bf16 v[216:219], v[104:107], v[184:187], v[216:219]
    v_mfma_f32_16x16x32_bf16 v[220:223], v[136:139], v[184:187], v[220:223]
    v_mfma_f32_16x16x32_bf16 v[224:227], v[168:171], v[184:187], v[224:227]
    s_waitcnt lgkmcnt(7)
    s_nop 0
    v_mfma_f32_16x16x32_bf16 v[212:215], v[68:71], v[188:191], v[212:215]
    ds_read_b128 v[184:187], v7 offset:2560
    v_mfma_f32_16x16x32_bf16 v[216:219], v[100:103], v[188:191], v[216:219]
    ds_read_b32 v11, v6 offset:144
    v_mfma_f32_16x16x32_bf16 v[220:223], v[132:135], v[188:191], v[220:223]
    ds_read_b32 v15, v6 offset:112
    v_mfma_f32_16x16x32_bf16 v[224:227], v[164:167], v[188:191], v[224:227]
    s_waitcnt lgkmcnt(9)
    v_mfma_f32_16x16x32_bf16 v[212:215], v[64:67], v[192:195], v[212:215]
    ds_read_b128 v[188:191], v7 offset:2496
    v_mfma_f32_16x16x32_bf16 v[216:219], v[96:99], v[192:195], v[216:219]
    s_waitcnt lgkmcnt(1)
    v_min_u32 v11, v11, v15
    v_cmp_eq_u32_e64 vcc, 0, v11
    s_cbranch_vccnz L_SLOW0
L_BACK0:
    v_mfma_f32_16x16x32_bf16 v[220:223], v[128:131], v[192:195], v[220:223]
    ds_read_b64 v[12:13], v10 offset:1152
    v_mfma_f32_16x16x32_bf16 v[224:227], v[160:163], v[192:195], v[224:227]
    ds_read_b128 v[28:31], v32 offset:0
    v_mfma_f32_16x16x32_bf16 v[212:215], v[60:63], v[196:199], v[212:215]
    ds_read_b128 v[192:195], v7 offset:2432
    v_mfma_f32_16x16x32_bf16 v[216:219], v[92:95], v[196:199], v[216:219]
    ds_read_b64 v[204:205], v9 offset:0
    v_mfma_f32_16x16x32_bf16 v[220:223], v[124:127], v[196:199], v[220:223]
    ds_read_b64 v[206:207], v9 offset:8192
    v_mfma_f32_16x16x32_bf16 v[224:227], v[156:159], v[196:199], v[224:227]
    ds_read_b64 v[208:209], v9 offset:16384
    v_mfma_f32_16x16x32_bf16 v[212:215], v[56:59], v[200:203], v[212:215]
    ds_read_b128 v[196:199], v7 offset:2368
    v_mfma_f32_16x16x32_bf16 v[216:219], v[88:91], v[200:203], v[216:219]
    ds_read_b64 v[210:211], v9 offset:24576
    s_waitcnt lgkmcnt(0)
    v_lshlrev_b32 v20, 16, v28
    v_mfma_f32_16x16x32_bf16 v[220:223], v[120:123], v[200:203], v[220:223]
    v_and_b32 v21, 0xffff0000, v28
    v_lshlrev_b32_e64 v22, 16, v29
    v_mfma_f32_16x16x32_bf16 v[224:227], v[152:155], v[200:203], v[224:227]
    v_and_b32 v23, 0xffff0000, v29
    v_lshlrev_b32_e64 v24, 16, v30
    v_mfma_f32_16x16x32_bf16 v[212:215], v[52:55], v[180:183], v[212:215]
    ds_read_b128 v[200:203], v7 offset:2304
    v_mfma_f32_16x16x32_bf16 v[216:219], v[84:87], v[180:183], v[216:219]
    v_and_b32 v25, 0xffff0000, v30
    v_lshlrev_b32_e64 v26, 16, v31
    v_mfma_f32_16x16x32_bf16 v[220:223], v[116:119], v[180:183], v[220:223]
    v_and_b32 v27, 0xffff0000, v31
    v_add_f32_e64 v20, v204, v20
    v_mfma_f32_16x16x32_bf16 v[224:227], v[148:151], v[180:183], v[224:227]
    v_add_f32 v21, v206, v21
    v_add_f32 v22, v208, v22
    v_mfma_f32_16x16x32_bf16 v[212:215], v[48:51], v[184:187], v[212:215]
    ds_read_b64 v[180:181], v2 offset:9496
    ds_read_b64 v[182:183], v2 offset:10136
    v_mfma_f32_16x16x32_bf16 v[216:219], v[80:83], v[184:187], v[216:219]
    v_add_f32 v23, v210, v23
    v_add_f32 v24, v205, v24
    v_mfma_f32_16x16x32_bf16 v[220:223], v[112:115], v[184:187], v[220:223]
    v_add_f32_e64 v25, v207, v25
    v_mfma_f32_16x16x32_bf16 v[224:227], v[144:147], v[184:187], v[224:227]
    v_add_f32_e64 v26, v209, v26
    v_mfma_f32_16x16x32_bf16 v[228:231], v[176:179], v[184:187], 0
    v_add_f32_e64 v27, v211, v27
    v_mfma_f32_16x16x32_bf16 v[216:219], v[76:79], v[188:191], v[216:219]
    ds_read_b128 v[184:187], v7 offset:2240
    v_mfma_f32_16x16x32_bf16 v[220:223], v[108:111], v[188:191], v[220:223]
    v_cvt_pk_bf16_f32 v204, v20, v21
    v_mfma_f32_16x16x32_bf16 v[224:227], v[140:143], v[188:191], v[224:227]
    v_cvt_pk_bf16_f32 v205, v22, v23
    v_mfma_f32_16x16x32_bf16 v[228:231], v[172:175], v[188:191], v[228:231]
    v_cvt_pk_bf16_f32 v206, v24, v25
    v_mfma_f32_16x16x32_bf16 v[216:219], v[72:75], v[192:195], v[216:219]
    ds_read_b128 v[188:191], v7 offset:2176
    v_mfma_f32_16x16x32_bf16 v[220:223], v[104:107], v[192:195], v[220:223]
    v_cvt_pk_bf16_f32 v207, v26, v27
    v_mfma_f32_16x16x32_bf16 v[224:227], v[136:139], v[192:195], v[224:227]
    s_cmp_lg_u32 s14, 2
    s_cbranch_scc1 L_ES0
    buffer_store_dwordx4 v[204:207], v33, s[44:47], s13 offen
L_EB0:
    s_add_u32 s13, s13, 0x1000
    v_mfma_f32_16x16x32_bf16 v[228:231], v[168:171], v[192:195], v[228:231]
    v_mfma_f32_16x16x32_bf16 v[216:219], v[68:71], v[196:199], v[216:219]
    ds_read_b128 v[192:195], v7 offset:2112
    v_mfma_f32_16x16x32_bf16 v[220:223], v[100:103], v[196:199], v[220:223]
    v_mfma_f32_16x16x32_bf16 v[224:227], v[132:135], v[196:199], v[224:227]
    v_mfma_f32_16x16x32_bf16 v[228:231], v[164:167], v[196:199], v[228:231]
    s_waitcnt lgkmcnt(5)
    s_nop 0
    v_mfma_f32_16x16x32_bf16 v[216:219], v[64:67], v[200:203], v[216:219]
    ds_read_b128 v[196:199], v7 offset:2048
    v_mfma_f32_16x16x32_bf16 v[220:223], v[96:99], v[200:203], v[220:223]
    v_mfma_f32_16x16x32_bf16 v[224:227], v[128:131], v[200:203], v[224:227]
    v_mfma_f32_16x16x32_bf16 v[228:231], v[160:163], v[200:203], v[228:231]
    s_waitcnt lgkmcnt(4)
    v_mfma_f32_16x16x32_bf16 v[220:223], v[236:239], v[180:183], v[220:223]
    ds_read_b128 v[200:203], v7 offset:1984
    v_mfma_f32_16x16x32_bf16 v[224:227], v[240:243], v[180:183], v[224:227]
    s_waitcnt lgkmcnt(4)
    v_mfma_f32_16x16x32_bf16 v[216:219], v[60:63], v[184:187], v[216:219]
    ds_read_b128 v[180:183], v7 offset:1920
    v_mfma_f32_16x16x32_bf16 v[220:223], v[92:95], v[184:187], v[220:223]
    v_mfma_f32_16x16x32_bf16 v[224:227], v[124:127], v[184:187], v[224:227]
    v_mfma_f32_16x16x32_bf16 v[228:231], v[156:159], v[184:187], v[228:231]
    s_waitcnt lgkmcnt(4)
    s_nop 0
    v_mfma_f32_16x16x32_bf16 v[216:219], v[56:59], v[188:191], v[216:219]
    ds_read_b128 v[184:187], v7 offset:1856
    v_mfma_f32_16x16x32_bf16 v[220:223], v[88:91], v[188:191], v[220:223]
    v_mfma_f32_16x16x32_bf16 v[224:227], v[120:123], v[188:191], v[224:227]
    v_mfma_f32_16x16x32_bf16 v[228:231], v[152:155], v[188:191], v[228:231]
    s_waitcnt lgkmcnt(4)
    s_nop 0
    v_mfma_f32_16x16x32_bf16 v[216:219], v[52:55], v[192:195], v[216:219]
    ds_read_b128 v[188:191], v7 offset:1792
    v_mfma_f32_16x16x32_bf16 v[220:223], v[84:87], v[192:195], v[220:223]
    v_mfma_f32_16x16x32_bf16 v[224:227], v[116:119], v[192:195], v[224:227]
    v_mfma_f32_16x16x32_bf16 v[228:231], v[148:151], v[192:195], v[228:231]
    s_waitcnt lgkmcnt(4)
    s_nop 0
    v_mfma_f32_16x16x32_bf16 v[216:219], v[48:51], v[196:199], v[216:219]
    ds_read_b64 v[192:193], v2 offset:9528
    ds_read_b64 v[194:195], v2 offset:10168
    v_mfma_f32_16x16x32_bf16 v[220:223], v[80:83], v[196:199], v[220:223]
    v_mfma_f32_16x16x32_bf16 v[224:227], v[112:115], v[196:199], v[224:227]
    v_mfma_f32_16x16x32_bf16 v[228:231], v[144:147], v[196:199], v[228:231]
    v_mfma_f32_16x16x32_bf16 v[232:235], v[176:179], v[196:199], 0
    s_waitcnt lgkmcnt(5)
    s_nop 0
    v_mfma_f32_16x16x32_bf16 v[220:223], v[76:79], v[200:203], v[220:223]
    ds_read_b128 v[196:199], v7 offset:1728
    v_mfma_f32_16x16x32_bf16 v[224:227], v[108:111], v[200:203], v[224:227]
    ds_write_b128 v8, v[212:215] offset:2048
    v_mfma_f32_16x16x32_bf16 v[228:231], v[140:143], v[200:203], v[228:231]
    ds_write_b128 v8, v[216:219] offset:3072
    v_mfma_f32_16x16x32_bf16 v[232:235], v[172:175], v[200:203], v[232:235]
    s_mov_b64 exec, 1
    ds_write_b32 v4, v5 offset:16
    s_mov_b64 exec, -1
    s_waitcnt lgkmcnt(8)
    s_nop 0
    v_mfma_f32_16x16x32_bf16 v[220:223], v[72:75], v[180:183], v[220:223]
    ds_read_b128 v[200:203], v7 offset:1664
    v_mfma_f32_16x16x32_bf16 v[224:227], v[104:107], v[180:183], v[224:227]
    v_mfma_f32_16x16x32_bf16 v[228:231], v[136:139], v[180:183], v[228:231]
    v_mfma_f32_16x16x32_bf16 v[232:235], v[168:171], v[180:183], v[232:235]
    s_waitcnt lgkmcnt(8)
    s_nop 0
    v_mfma_f32_16x16x32_bf16 v[220:223], v[68:71], v[184:187], v[220:223]
    ds_read_b128 v[180:183], v7 offset:1600
    v_mfma_f32_16x16x32_bf16 v[224:227], v[100:103], v[184:187], v[224:227]
    ds_read_b32 v11, v6 offset:16
    v_mfma_f32_16x16x32_bf16 v[228:231], v[132:135], v[184:187], v[228:231]
    v_mfma_f32_16x16x32_bf16 v[232:235], v[164:167], v[184:187], v[232:235]
    s_waitcnt lgkmcnt(9)
    v_mfma_f32_16x16x32_bf16 v[220:223], v[64:67], v[188:191], v[220:223]
    ds_read_b128 v[184:187], v7 offset:1536
    v_mfma_f32_16x16x32_bf16 v[224:227], v[96:99], v[188:191], v[224:227]
    s_waitcnt lgkmcnt(1)
    v_cmp_eq_u32 vcc, 0, v11
    s_cbranch_vccnz L_SLOW1
L_BACK1:
    v_mfma_f32_16x16x32_bf16 v[228:231], v[128:131], v[188:191], v[228:231]
    ds_read_b128 v[28:31], v32 offset:4096
    v_mfma_f32_16x16x32_bf16 v[232:235], v[160:163], v[188:191], v[232:235]
    ds_read_b64 v[212:213], v9 offset:2048
    v_mfma_f32_16x16x32_bf16 v[224:227], v[236:239], v[192:195], v[224:227]
    ds_read_b128 v[188:191], v7 offset:1472
    ds_read_b64 v[214:215], v9 offset:10240
    v_mfma_f32_16x16x32_bf16 v[220:223], v[60:63], v[196:199], v[220:223]
    ds_read_b128 v[192:195], v7 offset:1408
    v_mfma_f32_16x16x32_bf16 v[224:227], v[92:95], v[196:199], v[224:227]
    ds_read_b64 v[216:217], v9 offset:18432
    ds_read_b64 v[218:219], v9 offset:26624
    v_mfma_f32_16x16x32_bf16 v[228:231], v[124:127], v[196:199], v[228:231]
    s_waitcnt lgkmcnt(0)
    v_lshlrev_b32 v20, 16, v28
    v_and_b32 v21, 0xffff0000, v28
    v_mfma_f32_16x16x32_bf16 v[232:235], v[156:159], v[196:199], v[232:235]
    v_lshlrev_b32_e64 v22, 16, v29
    v_and_b32 v23, 0xffff0000, v29
    v_mfma_f32_16x16x32_bf16 v[220:223], v[56:59], v[200:203], v[220:223]
    ds_read_b128 v[196:199], v7 offset:1344
    v_mfma_f32_16x16x32_bf16 v[224:227], v[88:91], v[200:203], v[224:227]
    v_lshlrev_b32_e64 v24, 16, v30
    v_and_b32 v25, 0xffff0000, v30
    v_mfma_f32_16x16x32_bf16 v[228:231], v[120:123], v[200:203], v[228:231]
    v_lshlrev_b32_e64 v26, 16, v31
    v_and_b32 v27, 0xffff0000, v31
    v_mfma_f32_16x16x32_bf16 v[232:235], v[152:155], v[200:203], v[232:235]
    v_add_f32 v20, v212, v20
    v_add_f32 v21, v214, v21
    v_mfma_f32_16x16x32_bf16 v[220:223], v[52:55], v[180:183], v[220:223]
    ds_read_b128 v[200:203], v7 offset:1280
    v_mfma_f32_16x16x32_bf16 v[224:227], v[84:87], v[180:183], v[224:227]
    v_add_f32 v22, v216, v22
    v_add_f32 v23, v218, v23
    v_mfma_f32_16x16x32_bf16 v[228:231], v[116:119], v[180:183], v[228:231]
    v_add_f32 v24, v213, v24
    v_add_f32 v25, v215, v25
    v_mfma_f32_16x16x32_bf16 v[232:235], v[148:151], v[180:183], v[232:235]
    v_add_f32_e64 v26, v217, v26
    v_mfma_f32_16x16x32_bf16 v[220:223], v[48:51], v[184:187], v[220:223]
    ds_read_b128 v[180:183], v7 offset:1216
    v_mfma_f32_16x16x32_bf16 v[224:227], v[80:83], v[184:187], v[224:227]
    v_add_f32_e64 v27, v219, v27
    v_mfma_f32_16x16x32_bf16 v[228:231], v[112:115], v[184:187], v[228:231]
    v_cvt_pk_bf16_f32 v212, v20, v21
    v_mfma_f32_16x16x32_bf16 v[232:235], v[144:147], v[184:187], v[232:235]
    v_cvt_pk_bf16_f32 v213, v22, v23
    v_mfma_f32_16x16x32_bf16 v[224:227], v[76:79], v[188:191], v[224:227]
    ds_read_b128 v[184:187], v7 offset:1152
    v_mfma_f32_16x16x32_bf16 v[228:231], v[108:111], v[188:191], v[228:231]
    v_cvt_pk_bf16_f32 v214, v24, v25
    v_mfma_f32_16x16x32_bf16 v[232:235], v[140:143], v[188:191], v[232:235]
    v_cvt_pk_bf16_f32 v215, v26, v27
    v_mfma_f32_16x16x32_bf16 v[224:227], v[72:75], v[192:195], v[224:227]
    ds_read_b128 v[188:191], v7 offset:1088
    v_mfma_f32_16x16x32_bf16 v[228:231], v[104:107], v[192:195], v[228:231]
    s_cmp_lg_u32 s14, 2
    s_cbranch_scc1 L_ES1
    buffer_store_dwordx4 v[212:215], v33, s[44:47], s13 offen
L_EB1:
    s_add_u32 s13, s13, 0x1000
    v_mfma_f32_16x16x32_bf16 v[232:235], v[136:139], v[192:195], v[232:235]
    s_waitcnt vmcnt(0)
    s_mov_b64 exec, 1
    buffer_store_dword v34, off, s[44:47], s12 offset:0
    s_mov_b64 exec, -1
    s_waitcnt lgkmcnt(4)
    v_mfma_f32_16x16x32_bf16 v[224:227], v[68:71], v[196:199], v[224:227]
    ds_read_b128 v[192:195], v7 offset:1024
    v_mfma_f32_16x16x32_bf16 v[228:231], v[100:103], v[196:199], v[228:231]
    v_mfma_f32_16x16x32_bf16 v[232:235], v[132:135], v[196:199], v[232:235]
    s_waitcnt lgkmcnt(4)
    v_mfma_f32_16x16x32_bf16 v[224:227], v[64:67], v[200:203], v[224:227]
    ds_read_b128 v[196:199], v7 offset:960
    v_mfma_f32_16x16x32_bf16 v[228:231], v[96:99], v[200:203], v[228:231]
    v_mfma_f32_16x16x32_bf16 v[232:235], v[128:131], v[200:203], v[232:235]
    s_waitcnt lgkmcnt(4)
    v_mfma_f32_16x16x32_bf16 v[224:227], v[60:63], v[180:183], v[224:227]
    ds_read_b128 v[200:203], v7 offset:896
    v_mfma_f32_16x16x32_bf16 v[228:231], v[92:95], v[180:183], v[228:231]
    v_mfma_f32_16x16x32_bf16 v[232:235], v[124:127], v[180:183], v[232:235]
    s_waitcnt lgkmcnt(4)
    s_nop 0
    v_mfma_f32_16x16x32_bf16 v[224:227], v[56:59], v[184:187], v[224:227]
    ds_read_b64 v[180:181], v2 offset:9496
    ds_read_b64 v[182:183], v2 offset:10136
    v_mfma_f32_16x16x32_bf16 v[228:231], v[88:91], v[184:187], v[228:231]
    v_mfma_f32_16x16x32_bf16 v[232:235], v[120:123], v[184:187], v[232:235]
    s_waitcnt lgkmcnt(5)
    v_mfma_f32_16x16x32_bf16 v[224:227], v[52:55], v[188:191], v[224:227]
    ds_read_b128 v[184:187], v7 offset:832
    v_mfma_f32_16x16x32_bf16 v[228:231], v[84:87], v[188:191], v[228:231]
    v_mfma_f32_16x16x32_bf16 v[232:235], v[116:119], v[188:191], v[232:235]
    s_waitcnt lgkmcnt(5)
    v_mfma_f32_16x16x32_bf16 v[224:227], v[48:51], v[192:195], v[224:227]
    ds_read_b128 v[188:191], v7 offset:768
    v_mfma_f32_16x16x32_bf16 v[228:231], v[80:83], v[192:195], v[228:231]
    v_mfma_f32_16x16x32_bf16 v[232:235], v[112:115], v[192:195], v[232:235]
    s_waitcnt lgkmcnt(5)
    s_nop 0
    v_mfma_f32_16x16x32_bf16 v[228:231], v[76:79], v[196:199], v[228:231]
    ds_read_b128 v[192:195], v7 offset:704
    ds_write_b128 v8, v[220:223] offset:4096
    v_mfma_f32_16x16x32_bf16 v[232:235], v[108:111], v[196:199], v[232:235]
    ds_write_b128 v8, v[224:227] offset:5120
    s_mov_b64 exec, 1
    ds_write_b32 v4, v5 offset:32
    s_mov_b64 exec, -1
    s_waitcnt lgkmcnt(8)
    v_mfma_f32_16x16x32_bf16 v[228:231], v[72:75], v[200:203], v[228:231]
    ds_read_b64 v[196:197], v2 offset:9528
    ds_read_b64 v[198:199], v2 offset:10168
    v_mfma_f32_16x16x32_bf16 v[232:235], v[104:107], v[200:203], v[232:235]
    s_waitcnt lgkmcnt(8)
    v_mfma_f32_16x16x32_bf16 v[228:231], v[244:247], v[180:183], v[228:231]
    ds_read_b128 v[200:203], v7 offset:640
    v_mfma_f32_16x16x32_bf16 v[232:235], v[248:251], v[180:183], v[232:235]
    s_waitcnt lgkmcnt(8)
    v_mfma_f32_16x16x32_bf16 v[228:231], v[68:71], v[184:187], v[228:231]
    ds_read_b128 v[180:183], v7 offset:576
    ds_read_b32 v11, v6 offset:32
    v_mfma_f32_16x16x32_bf16 v[232:235], v[100:103], v[184:187], v[232:235]
    s_waitcnt lgkmcnt(9)
    v_mfma_f32_16x16x32_bf16 v[228:231], v[64:67], v[188:191], v[228:231]
    ds_read_b64 v[184:185], v2 offset:9560
    ds_read_b64 v[186:187], v2 offset:10200
    v_mfma_f32_16x16x32_bf16 v[232:235], v[96:99], v[188:191], v[232:235]
    s_waitcnt lgkmcnt(10)
    v_mfma_f32_16x16x32_bf16 v[228:231], v[60:63], v[192:195], v[228:231]
    ds_read_b128 v[188:191], v7 offset:512
    s_waitcnt lgkmcnt(3)
    v_cmp_eq_u32 vcc, 0, v11
    s_cbranch_vccnz L_SLOW2
L_BACK2:
    v_mfma_f32_16x16x32_bf16 v[232:235], v[92:95], v[192:195], v[232:235]
    ds_read_b128 v[28:31], v32 offset:8192
    ds_read_b64 v[220:221], v9 offset:4096
    v_mfma_f32_16x16x32_bf16 v[228:231], v[240:243], v[196:199], v[228:231]
    ds_read_b128 v[192:195], v7 offset:448
    ds_read_b64 v[222:223], v9 offset:12288
    v_mfma_f32_16x16x32_bf16 v[232:235], v[244:247], v[196:199], v[232:235]
    ds_read_b64 v[224:225], v9 offset:20480
    ds_read_b64 v[226:227], v9 offset:28672
    v_mfma_f32_16x16x32_bf16 v[228:231], v[56:59], v[200:203], v[228:231]
    ds_read_b128 v[196:199], v7 offset:384
    s_waitcnt vmcnt(0)
    s_mov_b64 exec, 1
    buffer_store_dword v34, off, s[44:47], s12 offset:512
    s_mov_b64 exec, -1
    v_mfma_f32_16x16x32_bf16 v[232:235], v[88:91], v[200:203], v[232:235]
    v_mfma_f32_16x16x32_bf16 v[228:231], v[52:55], v[180:183], v[228:231]
    ds_read_b128 v[200:203], v7 offset:320
    s_waitcnt lgkmcnt(2)
    v_lshlrev_b32_e64 v20, 16, v28
    v_mfma_f32_16x16x32_bf16 v[232:235], v[84:87], v[180:183], v[232:235]
    v_and_b32 v21, 0xffff0000, v28
    v_lshlrev_b32_e64 v22, 16, v29
    v_mfma_f32_16x16x32_bf16 v[228:231], v[236:239], v[184:187], v[228:231]
    ds_read_b64 v[180:181], v2 offset:9592
    ds_read_b64 v[182:183], v2 offset:10232
    v_and_b32 v23, 0xffff0000, v29
    v_mfma_f32_16x16x32_bf16 v[232:235], v[240:243], v[184:187], v[232:235]
    v_lshlrev_b32_e64 v24, 16, v30
    v_and_b32 v25, 0xffff0000, v30
    v_mfma_f32_16x16x32_bf16 v[228:231], v[48:51], v[188:191], v[228:231]
    ds_read_b128 v[184:187], v7 offset:256
    v_lshlrev_b32_e64 v26, 16, v31
    v_mfma_f32_16x16x32_bf16 v[232:235], v[80:83], v[188:191], v[232:235]
    v_and_b32 v27, 0xffff0000, v31
    v_add_f32_e64 v20, v220, v20
    v_mfma_f32_16x16x32_bf16 v[232:235], v[76:79], v[192:195], v[232:235]
    ds_read_b128 v[188:191], v7 offset:192
    v_add_f32_e64 v21, v222, v21
    ds_write_b128 v8, v[228:231] offset:6144
    s_waitcnt lgkmcnt(6)
    v_mfma_f32_16x16x32_bf16 v[232:235], v[72:75], v[196:199], v[232:235]
    ds_read_b128 v[192:195], v7 offset:128
    v_add_f32_e64 v22, v224, v22
    s_waitcnt lgkmcnt(6)
    v_mfma_f32_16x16x32_bf16 v[232:235], v[68:71], v[200:203], v[232:235]
    ds_read_b128 v[196:199], v7 offset:64
    v_add_f32 v23, v226, v23
    s_waitcnt lgkmcnt(5)
    v_mfma_f32_16x16x32_bf16 v[232:235], v[236:239], v[180:183], v[232:235]
    ds_read_b128 v[200:203], v7 offset:0
    v_add_f32 v24, v221, v24
    s_waitcnt lgkmcnt(5)
    v_mfma_f32_16x16x32_bf16 v[232:235], v[64:67], v[184:187], v[232:235]
    v_add_f32 v25, v223, v25
    v_add_f32_e64 v26, v225, v26
    s_waitcnt lgkmcnt(4)
    v_mfma_f32_16x16x32_bf16 v[232:235], v[60:63], v[188:191], v[232:235]
    v_add_f32_e64 v27, v227, v27
    v_cvt_pk_bf16_f32 v220, v20, v21
    s_waitcnt lgkmcnt(2)
    v_mfma_f32_16x16x32_bf16 v[232:235], v[56:59], v[192:195], v[232:235]
    v_cvt_pk_bf16_f32 v221, v22, v23
    v_cvt_pk_bf16_f32 v222, v24, v25
    s_waitcnt lgkmcnt(1)
    v_mfma_f32_16x16x32_bf16 v[232:235], v[52:55], v[196:199], v[232:235]
    v_cvt_pk_bf16_f32 v223, v26, v27
    s_cmp_lg_u32 s14, 2
    s_cbranch_scc1 L_ES2
    buffer_store_dwordx4 v[220:223], v33, s[44:47], s13 offen
L_EB2:
    s_add_u32 s13, s13, 0x1000
    s_waitcnt lgkmcnt(0)
    v_mfma_f32_16x16x32_bf16 v[232:235], v[48:51], v[200:203], v[232:235]
    ds_read_b128 v[28:31], v32 offset:12288
    s_nop 6
    ds_write_b128 v8, v[232:235] offset:7168
    s_mov_b64 exec, 1
    ds_write_b32 v4, v5 offset:48
    s_mov_b64 exec, -1
    s_waitcnt vmcnt(0)
    s_mov_b64 exec, 1
    buffer_store_dword v34, off, s[44:47], s12 offset:1024
    s_mov_b64 exec, -1
    s_waitcnt lgkmcnt(2)
    v_lshlrev_b32_e64 v20, 16, v28
    v_and_b32 v21, 0xffff0000, v28
    v_lshlrev_b32_e64 v22, 16, v29
    v_and_b32 v23, 0xffff0000, v29
    v_lshlrev_b32_e64 v24, 16, v30
    v_and_b32 v25, 0xffff0000, v30
    v_lshlrev_b32_e64 v26, 16, v31
    v_and_b32 v27, 0xffff0000, v31
LW_3:
    ds_read_b32 v11, v6 offset:48
    s_waitcnt lgkmcnt(0)
    v_cmp_eq_u32_e64 vcc, 0, v11
    s_cbranch_vccnz LW_3
    ds_read_b64 v[228:229], v9 offset:6144
    ds_read_b64 v[230:231], v9 offset:14336
    ds_read_b64 v[232:233], v9 offset:22528
    ds_read_b64 v[234:235], v9 offset:30720
    s_waitcnt lgkmcnt(0)
    v_add_f32 v20, v228, v20
    v_add_f32 v21, v230, v21
    v_add_f32 v22, v232, v22
    v_add_f32 v23, v234, v23
    v_add_f32 v24, v229, v24
    v_add_f32 v25, v231, v25
    v_add_f32 v26, v233, v26
    v_add_f32_e64 v27, v235, v27
    v_cvt_pk_bf16_f32 v228, v20, v21
    v_cvt_pk_bf16_f32 v229, v22, v23
    v_cvt_pk_bf16_f32 v230, v24, v25
    v_cvt_pk_bf16_f32 v231, v26, v27
    s_cmp_lg_u32 s14, 2
    s_cbranch_scc1 L_ES3
    buffer_store_dwordx4 v[228:231], v33, s[44:47], s13 offen
L_EB3:
    s_add_u32 s13, s13, 0x1000
    s_waitcnt vmcnt(0)
    s_mov_b64 exec, 1
    buffer_store_dword v34, off, s[44:47], s12 offset:1536
    s_mov_b64 exec, -1
    s_branch L_FIN
L_SLOW0:
LW_4:
    ds_read_b32 v11, v6 offset:144
    s_waitcnt lgkmcnt(0)
    v_cmp_eq_u32_e64 vcc, 0, v11
    s_cbranch_vccnz LW_4
LW_5:
    ds_read_b32 v11, v6 offset:112
    s_waitcnt lgkmcnt(0)
    v_cmp_eq_u32 vcc, 0, v11
    s_cbranch_vccnz LW_5
    s_branch L_BACK0
L_SLOW1:
LW_6:
    ds_read_b32 v11, v6 offset:16
    s_waitcnt lgkmcnt(0)
    v_cmp_eq_u32 vcc, 0, v11
    s_cbranch_vccnz LW_6
    s_branch L_BACK1
L_SLOW2:
LW_7:
    ds_read_b32 v11, v6 offset:32
    s_waitcnt lgkmcnt(0)
    v_cmp_eq_u32 vcc, 0, v11
    s_cbranch_vccnz LW_7
    s_branch L_BACK2
L_ES0:
    v_lshlrev_b32_e64 v14, 24, v12
    v_and_or_b32 v14, v14, s68, v3
    v_lshlrev_b32_e64 v15, 16, v12
    v_and_or_b32 v15, v15, s68, v3
    buffer_store_dwordx2 v[204:205], v14, s[52:55], s60 offen offset:0
    buffer_store_dwordx2 v[206:207], v15, s[52:55], s60 offen offset:2048
    s_branch L_EB0
L_ES1:
    v_lshlrev_b32 v14, 8, v12
    v_and_or_b32 v14, v14, s68, v3
    v_and_or_b32 v15, v12, s68, v3
    buffer_store_dwordx2 v[212:213], v14, s[52:55], s61 offen offset:0
    buffer_store_dwordx2 v[214:215], v15, s[52:55], s61 offen offset:2048
    s_branch L_EB1
L_ES2:
    v_lshlrev_b32 v14, 24, v13
    v_and_or_b32 v14, v14, s68, v3
    v_lshlrev_b32_e64 v15, 16, v13
    v_and_or_b32 v15, v15, s68, v3
    buffer_store_dwordx2 v[220:221], v14, s[52:55], s62 offen offset:0
    buffer_store_dwordx2 v[222:223], v15, s[52:55], s62 offen offset:2048
    s_branch L_EB2
L_ES3:
    v_lshlrev_b32 v14, 8, v13
    v_and_or_b32 v14, v14, s68, v3
    v_and_or_b32 v15, v13, s68, v3
    buffer_store_dwordx2 v[228:229], v14, s[52:55], s63 offen offset:0
    buffer_store_dwordx2 v[230:231], v15, s[52:55], s63 offen offset:2048
    s_branch L_EB3
L_F0:
    s_setprio 2
    s_mov_b32 s61, 32768
    s_lshl_b32 s7, s2, 2
    s_add_u32 s7, s7, s3
    s_lshl_b32 s13, s2, 7
    s_add_u32 s13, s13, 32768
    s_lshl_b32 s8, s7, 12
    v_and_b32 v10, 31, v0
    v_lshlrev_b32 v10, 4, v10
    v_lshrrev_b32_e64 v11, 5, v0
    v_lshl_add_u32 v11, v11, 11, v10
    v_add_u32 v11, s8, v11
    s_cmp_lt_u32 s6, 28
    s_cselect_b32 s69, 1, 0
    s_lshr_b32 s8, s6, 2
    s_add_u32 s9, s5, 3
    s_and_b32 s9, s9, 7
    s_min_u32 s9, s9, 6
    s_cmp_lt_u32 s6, 28
    s_cselect_b32 s8, s8, s9
    s_mul_i32 s59, s5, 7
    s_add_u32 s59, s59, s8
    s_and_b32 s68, s6, 3
    s_lshl_b32 s8, s68, 2
    s_add_u32 s8, s8, s3
    s_lshl_b32 s8, s8, 6
    s_xor_b32 s9, s69, 1
    s_lshl_b32 s9, s9, 5
    s_add_u32 s8, s8, s9
    v_lshrrev_b32_e64 v12, 4, v0
    v_lshl_add_u32 v12, v12, 3, s8
    v_lshlrev_b32 v9, 1, v12
    s_movk_i32 s10, 7168
    v_mul_u32_u24 v14, s10, v12
    v_and_b32 v12, 7, v0
    v_lshl_add_u32 v14, v12, 4, v14
    s_lshl_b32 s8, s59, 7
    v_add_u32 v14, s8, v14
    v_and_b32 v12, 8, v0
    v_cmp_ne_u32_e64 vcc, 0, v12
    s_waitcnt lgkmcnt(0)
    global_load_dwordx4 v[16:19], v11, s[16:17] offset:0
    global_load_dwordx4 v[20:23], v11, s[16:17] offset:512
    global_load_dwordx4 v[24:27], v11, s[16:17] offset:1024
    global_load_dwordx4 v[28:31], v11, s[16:17] offset:1536
    s_load_dword s56, s[42:43], 0
    global_load_dwordx4 v[32:35], v10, s[32:33] offset:0
    global_load_dwordx4 v[36:39], v10, s[32:33] offset:512
    global_load_dwordx4 v[40:43], v10, s[32:33] offset:1024
    global_load_dwordx4 v[44:47], v10, s[32:33] offset:1536
    v_mov_b32 v12, s34
    v_mov_b32 v13, s35
    v_mov_b32 v10, s36
    v_mov_b32 v11, s37
    v_cndmask_b32 v12, v12, v10, vcc
    v_cndmask_b32 v13, v13, v11, vcc
    v_add_co_u32 v102, vcc, v12, v14
    s_movk_i32 s20, 7168
    s_mov_b32 s21, 0
    v_addc_co_u32 v103, vcc, 0, v13, vcc
    s_barrier
    s_mov_b32 s48, s16
    s_and_b32 s49, s17, 0xffff
    s_mov_b32 s50, 0x400000
    s_mov_b32 s51, 0x20000
    s_lshl_b32 s8, s6, 17
    s_lshl_b32 s9, s3, 15
    s_add_u32 s8, s8, s9
    s_lshl_b32 s9, s5, 8
    s_add_u32 s8, s8, s9
    s_add_u32 s9, s8, 4096
    v_lshrrev_b32 v10, 4, v0
    v_and_b32 v11, 15, v0
    v_lshlrev_b32 v11, 4, v11
    v_lshl_add_u32 v14, v10, 13, v11
    buffer_load_dwordx4 v[64:67], v14, s[48:51], s8 offen offset:0
    buffer_load_dwordx4 v[68:71], v14, s[48:51], s8 offen offset:2048
    buffer_load_dwordx4 v[72:75], v14, s[48:51], s9 offen offset:0
    buffer_load_dwordx4 v[76:79], v14, s[48:51], s9 offen offset:2048
    s_mul_i32 s8, s3, 4608
    s_add_u32 s8, s8, 17408
    s_movk_i32 s9, 1088
    v_mad_u32_u24 v96, v10, s9, v11
    v_add_u32 v96, s8, v96
    v_and_b32 v10, 7, v0
    v_lshrrev_b32_e64 v11, 3, v0
    s_movk_i32 s9, 544
    v_lshl_add_u32 v97, v11, 3, s8
    v_mad_u32_u24 v97, v10, s9, v97
    v_lshlrev_b32_e64 v98, 4, v10
    v_lshl_add_u32 v98, v11, 14, v98
    s_lshl_b32 s18, s5, 19
    s_lshl_b32 s9, s6, 9
    s_add_u32 s18, s18, s9
    s_lshl_b32 s9, s3, 7
    s_add_u32 s18, s18, s9
    s_add_u32 s18, s18, 3145728
    s_getreg_b32 s19, hwreg(HW_REG_XCC_ID, 0, 4)
    s_mov_b32 s22, 179200
    s_mov_b32 s23, 0
    s_lshl_b32 s62, s5, 7
    s_add_u32 s62, s62, 983040
    v_lshlrev_b32 v99, 10, v0
    s_mov_b32 s44, s42
    s_and_b32 s45, s43, 0xffff
    s_mov_b32 s46, 0x1000000
    s_mov_b32 s47, 0x20000
    s_mov_b32 s52, s40
    s_and_b32 s53, s41, 0xffff
    s_mov_b32 s54, 0x400000
    s_mov_b32 s55, 0x20000
    s_mov_b32 s24, s38
    s_and_b32 s25, s39, 0xffff
    s_mov_b32 s26, 0x700000
    s_mov_b32 s27, 0x20000
    s_lshl_b32 s7, s3, 2
    v_mov_b32 v2, s7
    v_and_b32 v11, 3, v0
    v_lshlrev_b32 v1, 2, v11
    v_mov_b32 v5, 1
    s_lshl_b32 s8, s3, 6
    v_add_u32 v14, s8, v0
    v_lshrrev_b32 v10, 2, v14
    v_lshlrev_b32_e64 v226, 7, v10
    v_lshl_add_u32 v226, v11, 4, v226
    s_mov_b32 s5, 40960
    s_mov_b32 s6, 49152
    s_mov_b32 s7, 57344
    s_mov_b32 s8, 0x3f803f80
    s_waitcnt vmcnt(8)
    s_nop 0
    v_dot2_f32_bf16 v48, v16, s8, 0
    v_dot2_f32_bf16 v49, v16, v16, 0
    v_dot2_f32_bf16 v48, v17, s8, v48
    v_dot2_f32_bf16 v49, v17, v17, v49
    v_dot2_f32_bf16 v48, v18, s8, v48
    v_dot2_f32_bf16 v49, v18, v18, v49
    v_dot2_f32_bf16 v48, v19, s8, v48
    v_dot2_f32_bf16 v49, v19, v19, v49
    v_dot2_f32_bf16 v48, v20, s8, v48
    v_dot2_f32_bf16 v49, v20, v20, v49
    v_dot2_f32_bf16 v48, v21, s8, v48
    v_dot2_f32_bf16 v49, v21, v21, v49
    v_dot2_f32_bf16 v48, v22, s8, v48
    v_dot2_f32_bf16 v49, v22, v22, v49
    v_dot2_f32_bf16 v48, v23, s8, v48
    v_dot2_f32_bf16 v49, v23, v23, v49
    v_dot2_f32_bf16 v48, v24, s8, v48
    v_dot2_f32_bf16 v49, v24, v24, v49
    v_dot2_f32_bf16 v48, v25, s8, v48
    v_dot2_f32_bf16 v49, v25, v25, v49
    v_dot2_f32_bf16 v48, v26, s8, v48
    v_dot2_f32_bf16 v49, v26, v26, v49
    v_dot2_f32_bf16 v48, v27, s8, v48
    v_dot2_f32_bf16 v49, v27, v27, v49
    v_dot2_f32_bf16 v48, v28, s8, v48
    v_dot2_f32_bf16 v49, v28, v28, v49
    v_dot2_f32_bf16 v48, v29, s8, v48
    v_dot2_f32_bf16 v49, v29, v29, v49
    v_dot2_f32_bf16 v48, v30, s8, v48
    v_dot2_f32_bf16 v49, v30, v30, v49
    v_dot2_f32_bf16 v48, v31, s8, v48
    v_dot2_f32_bf16 v49, v31, v31, v49
    s_waitcnt lgkmcnt(0)
    s_mul_i32 s56, s56, 0x9E3779B1
    s_add_u32 s56, s56, 0x7F4A7C15
    s_or_b32 s56, s56, 1
    v_mov_b32 v59, s56
    v_mov_b32 v100, s56
    v_mov_b32 v101, s19
    s_waitcnt vmcnt(4)
    v_dot2_f32_bf16 v50, v16, v32, 0
    v_dot2_f32_bf16 v51, v32, s8, 0
    v_dot2_f32_bf16 v50, v17, v33, v50
    v_dot2_f32_bf16 v51, v33, s8, v51
    v_dot2_f32_bf16 v50, v18, v34, v50
    v_dot2_f32_bf16 v51, v34, s8, v51
    v_dot2_f32_bf16 v50, v19, v35, v50
    v_dot2_f32_bf16 v51, v35, s8, v51
    v_dot2_f32_bf16 v50, v20, v36, v50
    v_dot2_f32_bf16 v51, v36, s8, v51
    v_dot2_f32_bf16 v50, v21, v37, v50
    v_dot2_f32_bf16 v51, v37, s8, v51
    v_dot2_f32_bf16 v50, v22, v38, v50
    v_dot2_f32_bf16 v51, v38, s8, v51
    v_dot2_f32_bf16 v50, v23, v39, v50
    v_dot2_f32_bf16 v51, v39, s8, v51
    v_dot2_f32_bf16 v50, v24, v40, v50
    v_dot2_f32_bf16 v51, v40, s8, v51
    v_dot2_f32_bf16 v50, v25, v41, v50
    v_dot2_f32_bf16 v51, v41, s8, v51
    v_dot2_f32_bf16 v50, v26, v42, v50
    v_dot2_f32_bf16 v51, v42, s8, v51
    v_dot2_f32_bf16 v50, v27, v43, v50
    v_dot2_f32_bf16 v51, v43, s8, v51
    v_dot2_f32_bf16 v50, v28, v44, v50
    v_dot2_f32_bf16 v51, v44, s8, v51
    v_dot2_f32_bf16 v50, v29, v45, v50
    v_dot2_f32_bf16 v51, v45, s8, v51
    v_dot2_f32_bf16 v50, v30, v46, v50
    v_dot2_f32_bf16 v51, v46, s8, v51
    v_dot2_f32_bf16 v50, v31, v47, v50
    v_dot2_f32_bf16 v51, v47, s8, v51
    s_nop 0
    s_nop 0
    v_add_f32_dpp v48, v48, v48 row_shr:1 row_mask:0xf bank_mask:0xf
    v_add_f32_dpp v49, v49, v49 row_shr:1 row_mask:0xf bank_mask:0xf
    v_add_f32_dpp v50, v50, v50 row_shr:1 row_mask:0xf bank_mask:0xf
    v_add_f32_dpp v51, v51, v51 row_shr:1 row_mask:0xf bank_mask:0xf
    v_add_f32_dpp v48, v48, v48 row_shr:2 row_mask:0xf bank_mask:0xf
    v_add_f32_dpp v49, v49, v49 row_shr:2 row_mask:0xf bank_mask:0xf
    v_add_f32_dpp v50, v50, v50 row_shr:2 row_mask:0xf bank_mask:0xf
    v_add_f32_dpp v51, v51, v51 row_shr:2 row_mask:0xf bank_mask:0xf
    v_add_f32_dpp v48, v48, v48 row_shr:4 row_mask:0xf bank_mask:0xf
    v_add_f32_dpp v49, v49, v49 row_shr:4 row_mask:0xf bank_mask:0xf
    v_add_f32_dpp v50, v50, v50 row_shr:4 row_mask:0xf bank_mask:0xf
    v_add_f32_dpp v51, v51, v51 row_shr:4 row_mask:0xf bank_mask:0xf
    v_add_f32_dpp v48, v48, v48 row_shr:8 row_mask:0xf bank_mask:0xf
    v_add_f32_dpp v49, v49, v49 row_shr:8 row_mask:0xf bank_mask:0xf
    v_add_f32_dpp v50, v50, v50 row_shr:8 row_mask:0xf bank_mask:0xf
    v_add_f32_dpp v51, v51, v51 row_shr:8 row_mask:0xf bank_mask:0xf
    v_add_f32_dpp v48, v48, v48 row_bcast:15 row_mask:0xa bank_mask:0xf
    v_add_f32_dpp v49, v49, v49 row_bcast:15 row_mask:0xa bank_mask:0xf
    v_add_f32_dpp v50, v50, v50 row_bcast:15 row_mask:0xa bank_mask:0xf
    v_add_f32_dpp v51, v51, v51 row_bcast:15 row_mask:0xa bank_mask:0xf
    v_mul_f32 v48, 0x3a800000, v48
    v_mul_f32 v49, 0x3a800000, v49
    v_cvt_pk_bf16_f32 v52, v48, v48
    v_fma_f32 v49, -v48, v48, v49
    v_max_f32_e64 v49, 0, v49
    v_and_b32 v53, 0xffff0000, v52
    v_cvt_pk_bf16_f32 v49, v49, v49
    v_and_b32 v49, 0xffff0000, v49
    v_add_f32 v49, 0x3727c5ac, v49
    v_fma_f32 v50, -v53, v51, v50
    v_cvt_pk_bf16_f32 v49, v49, v49
    v_and_b32 v49, 0xffff0000, v49
    v_sqrt_f32 v49, v49
    v_lshlrev_b32 v10, 2, v2
    v_lshlrev_b32 v11, 4, v0
    v_mov_b32 v61, 0
    v_cvt_pk_bf16_f32 v54, v49, v49
    v_and_b32 v49, 0xffff0000, v54
    v_rcp_f32 v49, v49
    s_nop 0
    v_mul_f32_e64 v50, v50, v49
    v_cvt_pk_bf16_f32 v50, v50, v50
    v_bfe_i32 v51, v50, 15, 1
    v_or_b32 v51, 0x80008000, v51
    v_xor_b32_e64 v55, v50, v51
    s_mov_b32 s8, 0xffff
    v_mov_b32_dpp v56, v52 row_bcast:31 row_mask:0x8 bank_mask:0xf
    v_mov_b32_dpp v57, v54 row_bcast:31 row_mask:0x8 bank_mask:0xf
    v_mov_b32_dpp v58, v55 row_bcast:31 row_mask:0x8 bank_mask:0xf
    v_bfi_b32 v56, s8, v56, v52
    v_bfi_b32 v57, s8, v57, v54
    v_bfi_b32 v58, s8, v58, v55
    s_brev_b64 exec, 1
    ds_write_b128 v10, v[56:59] offset:576
    ds_add_rtn_u32 v60, v61, v5 offset:512
    s_mov_b64 exec, -1
    s_waitcnt lgkmcnt(0)
    v_readlane_b32 s8, v60, 63
    s_cmp_lg_u32 s8, 3
    s_cbranch_scc1 L_NOPUB
    s_mov_b64 exec, 0xf
    ds_read_b128 v[52:55], v11 offset:576
    s_waitcnt lgkmcnt(0)
    buffer_store_dwordx4 v[52:55], v11, s[44:47], s13 offen sc1
    ds_write_b32 v61, v5 offset:516
    s_mov_b64 exec, -1
    s_waitcnt vmcnt(1)
    s_branch L_PUB2
L_NOPUB:
    s_waitcnt vmcnt(0)
L_PUB2:
    s_nop 0
    ds_write_b128 v96, v[64:67] offset:0
    ds_write_b128 v96, v[68:71] offset:272
    ds_write_b128 v96, v[72:75] offset:544
    ds_write_b128 v96, v[76:79] offset:816
    ds_read_b64 v[80:81], v97 offset:0
    ds_read_b64 v[82:83], v97 offset:272
    ds_read_b64 v[84:85], v97 offset:64
    ds_read_b64 v[86:87], v97 offset:336
    ds_read_b64 v[88:89], v97 offset:128
    ds_read_b64 v[90:91], v97 offset:400
    ds_read_b64 v[92:93], v97 offset:192
    ds_read_b64 v[94:95], v97 offset:464
    s_waitcnt lgkmcnt(6)
    buffer_store_dwordx4 v[80:83], v98, s[44:47], s18 offen
    s_add_u32 s18, s18, 0x20000
    s_waitcnt lgkmcnt(4)
    buffer_store_dwordx4 v[84:87], v98, s[44:47], s18 offen
    s_add_u32 s18, s18, 0x20000
    s_waitcnt lgkmcnt(2)
    buffer_store_dwordx4 v[88:91], v98, s[44:47], s18 offen
    s_add_u32 s18, s18, 0x20000
    s_waitcnt lgkmcnt(0)
    buffer_store_dwordx4 v[92:95], v98, s[44:47], s18 offen
    s_add_u32 s18, s18, 0x20000
    s_mov_b64 exec, 1
    ds_write_b32 v2, v59 offset:128
    s_mov_b64 exec, -1
LW_8:
    ds_read_b32 v60, v61 offset:516
    s_waitcnt lgkmcnt(0)
    v_cmp_eq_u32_e64 vcc, 0, v60
    s_cbranch_vccnz LW_8
    s_waitcnt vmcnt(0)
    s_mov_b64 exec, 1
    ds_add_rtn_u32 v60, v61, v5 offset:520
    s_waitcnt lgkmcnt(0)
    v_readfirstlane_b32 s8, v60
    s_cmp_lg_u32 s8, 3
    s_cbranch_scc1 L_NOXF0
    s_add_u32 s13, s13, 950272
    buffer_store_dwordx2 v[100:101], v61, s[44:47], s13 offen sc1
    ds_write_b32 v61, v5 offset:524
L_NOXF0:
    s_mov_b64 exec, -1
LW_9:
    ds_read_b32 v60, v61 offset:524
    s_waitcnt lgkmcnt(0)
    v_cmp_eq_u32 vcc, 0, v60
    s_cbranch_vccnz LW_9
    global_load_dwordx4 v[112:115], v[102:103], off
    v_lshl_add_u64 v[102:103], s[20:21], 0, v[102:103]
    global_load_dwordx4 v[116:119], v[102:103], off
    v_lshl_add_u64 v[102:103], s[20:21], 0, v[102:103]
    global_load_dwordx4 v[120:123], v[102:103], off
    v_lshl_add_u64 v[102:103], s[20:21], 0, v[102:103]
    global_load_dwordx4 v[124:127], v[102:103], off
    v_lshl_add_u64 v[102:103], s[20:21], 0, v[102:103]
    global_load_dwordx4 v[128:131], v[102:103], off
    v_lshl_add_u64 v[102:103], s[20:21], 0, v[102:103]
    global_load_dwordx4 v[132:135], v[102:103], off
    v_lshl_add_u64 v[102:103], s[20:21], 0, v[102:103]
    global_load_dwordx4 v[136:139], v[102:103], off
    v_lshl_add_u64 v[102:103], s[20:21], 0, v[102:103]
    global_load_dwordx4 v[140:143], v[102:103], off
    v_lshl_add_u64 v[102:103], s[22:23], 0, v[102:103]
    s_cmp_lg_u32 s3, 0
    s_cbranch_scc1 L_NOZ
    v_lshlrev_b32 v224, 4, v0
    v_mov_b32 v228, 0
    v_mov_b32 v229, 0
    v_mov_b32 v230, 0
    v_mov_b32_e64 v231, 0
    ds_write_b128 v224, v[228:231] offset:1024
    ds_write_b128 v224, v[228:231] offset:2048
    ds_write_b128 v224, v[228:231] offset:3072
L_NOZ:
    s_lshl_b32 s4, s3, 6
    v_add_u32 v14, s4, v0
    v_lshlrev_b32_e64 v15, 4, v14
    s_mov_b32 s64, 0x05040100
    s_mov_b32 s65, 0x07060302
    v_lshlrev_b32 v224, 4, v0
    v_and_b32 v10, 15, v0
    v_lshlrev_b32 v10, 2, v10
    v_and_b32 v11, 48, v0
    s_movk_i32 s4, 0xfff
    v_lshlrev_b32 v248, 1, v14
    v_sub_u32 v248, s4, v248
    v_subrev_u32 v249, 1, v248
    v_subrev_u32 v250, 512, v248
    v_subrev_u32 v251, 513, v248
    v_subrev_u32 v252, 1024, v248
    v_subrev_u32 v253, 1025, v248
    v_subrev_u32 v254, 1536, v248
    v_subrev_u32 v255, 1537, v248
    v_lshlrev_b32 v227, 3, v14
    v_lshrrev_b32 v225, 4, v14
    v_lshlrev_b32 v225, 2, v225
    v_lshlrev_b32_e64 v14, 2, v14
    s_mov_b32 s16, 0
    s_mov_b32 s17, 0xffff0000
    v_lshlrev_b32 v3, 3, v11
    s_lshl_b32 s8, s3, 12
    s_add_u32 s8, s8, 125952
    v_add_u32 v3, s8, v3
    v_lshrrev_b32 v12, 5, v0
    v_lshlrev_b32_e64 v4, 7, v12
    v_bfe_u32 v12, v0, 4, 1
    v_lshl_add_u32 v4, v12, 3, v4
    v_bfe_u32 v12, v0, 3, 1
    v_lshl_add_u32 v4, v12, 9, v4
    v_and_b32_e64 v12, 7, v0
    v_lshl_add_u32 v4, v12, 4, v4
    s_lshl_b32 s8, s3, 10
    s_add_u32 s8, s8, 125952
    v_add_u32 v4, s8, v4
    v_bfe_u32 v12, v0, 4, 1
    v_lshlrev_b32 v12, 16, v12
    v_lshrrev_b32 v13, 5, v0
    v_lshl_add_u32 v12, v13, 12, v12
    v_lshl_add_u32 v12, v10, 1, v12
    s_lshl_b32 s10, s59, 17
    s_lshl_b32 s11, s68, 9
    s_add_u32 s10, s10, s11
    s_lshl_b32 s11, s3, 7
    s_add_u32 s10, s10, s11
    s_nop 0
    v_mov_b32 v208, 0x3f803f80
    v_mov_b32 v209, 0x3f803f80
    v_mov_b32 v210, 0x3f803f80
    v_mov_b32 v211, 0x3f803f80
    v_mov_b32 v212, 0x3f803f80
    v_mov_b32 v213, 0x3f803f80
    v_mov_b32 v214, 0x3f803f80
    v_mov_b32 v215, 0x3f803f80
    v_sub_u32 v56, 18428, v14
    v_add_u32 v57, 142336, v15
    v_mov_b32 v58, v15
    s_lshl_b32 s13, s57, 14
    s_add_u32 s13, s13, 3145728
    s_mov_b32 s63, 0
    buffer_load_dwordx4 v[32:35], v226, s[44:47], s61 offen sc1
    buffer_load_dwordx4 v[36:39], v226, s[44:47], s5 offen sc1
    buffer_load_dwordx4 v[40:43], v226, s[44:47], s6 offen sc1
    buffer_load_dwordx4 v[44:47], v226, s[44:47], s7 offen sc1
    s_mov_b32 exec_hi, 0
    buffer_load_dwordx2 v[96:97], v99, s[44:47], s62 offen sc1
    s_mov_b32 exec_hi, -1
    s_branch L_KPW
L_KP:
    s_sleep 1
    s_mov_b64 exec, s[30:31]
    s_cbranch_execz L_KS0
    buffer_load_dwordx4 v[32:35], v226, s[44:47], s61 offen sc1
L_KS0:
    s_mov_b64 exec, s[8:9]
    s_cbranch_execz L_KS1
    buffer_load_dwordx4 v[36:39], v226, s[44:47], s5 offen sc1
L_KS1:
    s_mov_b64 exec, s[14:15]
    s_cbranch_execz L_KS2
    buffer_load_dwordx4 v[40:43], v226, s[44:47], s6 offen sc1
L_KS2:
    s_mov_b64 exec, s[28:29]
    s_cbranch_execz L_KS3
    buffer_load_dwordx4 v[44:47], v226, s[44:47], s7 offen sc1
L_KS3:
    s_mov_b64 exec, -1
    s_cmp_lg_u32 s63, 0
    s_cbranch_scc1 L_KPW
    s_mov_b32 exec_hi, 0
    buffer_load_dwordx2 v[96:97], v99, s[44:47], s62 offen sc1
    s_mov_b32 exec_hi, -1
L_KPW:
    s_waitcnt vmcnt(0)
    s_add_u32 s16, s16, 1
    v_cmp_ne_u32 s[30:31], s56, v35
    v_cmp_ne_u32 s[8:9], s56, v39
    v_cmp_ne_u32 s[14:15], s56, v43
    v_cmp_ne_u32 s[28:29], s56, v47
    s_cmp_lg_u32 s63, 0
    s_cbranch_scc1 L_XBACK0
    v_cmp_ne_u32 vcc, s56, v96
    s_cmp_lg_u32 vcc_lo, 0
    s_cbranch_scc1 L_XBACK0
    v_cmp_ne_u32 vcc, s19, v97
    s_mov_b32 s63, 1
    s_cmp_eq_u32 vcc_lo, 0
    s_cselect_b32 s60, 2, 1
    s_cbranch_scc0 L_XSLOW
    buffer_load_dwordx4 v[64:67], v58, s[44:47], s13 offen
    s_add_u32 s13, s13, 0x1000
    buffer_load_dwordx4 v[68:71], v58, s[44:47], s13 offen
    s_add_u32 s13, s13, 0x1000
    buffer_load_dwordx4 v[72:75], v58, s[44:47], s13 offen
    s_add_u32 s13, s13, 0x1000
    buffer_load_dwordx4 v[76:79], v58, s[44:47], s13 offen
    s_add_u32 s13, s13, 0x1000
L_XBACK0:
    s_or_b64 vcc, s[30:31], s[8:9]
    s_or_b64 s[66:67], s[14:15], s[28:29]
    s_or_b64 vcc, vcc, s[66:67]
    s_cbranch_vccz L_KPOK
    s_cmp_lt_u32 s16, 0x4000
    s_cbranch_scc1 L_KP
L_KPOK:
    s_cmp_lg_u32 s63, 0
    s_cbranch_scc1 L_KP2
    s_mov_b32 exec_hi, 0
    buffer_load_dwordx2 v[96:97], v99, s[44:47], s62 offen sc1
    s_mov_b32 exec_hi, -1
L_KP2:
    s_nop 0
    ds_write2st64_b64 v227, v[32:33], v[36:37] offset0:18 offset1:22
    ds_write2st64_b64 v227, v[40:41], v[44:45] offset0:26 offset1:30
    v_lshl_or_b32 v248, v34, 16, v248
    v_and_or_b32 v249, v34, s17, v249
    v_lshl_or_b32 v250, v38, 16, v250
    v_and_or_b32 v251, v38, s17, v251
    v_lshl_or_b32 v252, v42, 16, v252
    v_and_or_b32 v253, v42, s17, v253
    v_lshl_or_b32 v254, v46, 16, v254
    v_and_or_b32 v255, v46, s17, v255
    v_max_u32 v226, v248, v249
    v_min_u32 v227, v248, v249
    v_max_u32 v228, v252, v253
    v_min_u32 v229, v252, v253
    v_med3_u32 v227, v226, v227, v250
    v_med3_u32 v229, v228, v229, v254
    v_max_u32 v226, v226, v250
    v_max_u32 v228, v228, v254
    v_med3_u32 v227, v226, v227, v251
    v_med3_u32 v229, v228, v229, v255
    v_max_u32 v226, v226, v251
    v_max_u32 v228, v228, v255
    v_min_u32 v230, v226, v228
    v_max_u32 v226, v226, v228
    v_max3_u32 v227, v227, v229, v230
    ds_write_b32 v14, v226 offset:8192
    v_add_u32 v15, 4096, v15
    v_max_u32_dpp v226, v226, v226 row_shr:1 row_mask:0xf bank_mask:0xf
    v_max_u32_dpp v227, v227, v227 row_shr:1 row_mask:0xf bank_mask:0xf
    ds_write2_b32 v15, v34, v38 offset0:0 offset1:1
    v_max_u32_dpp v226, v226, v226 row_shr:2 row_mask:0xf bank_mask:0xf
    v_max_u32_dpp v227, v227, v227 row_shr:2 row_mask:0xf bank_mask:0xf
    ds_write2_b32 v15, v42, v46 offset0:2 offset1:3
    v_max_u32_dpp v226, v226, v226 row_shr:4 row_mask:0xf bank_mask:0xf
    v_max_u32_dpp v227, v227, v227 row_shr:4 row_mask:0xf bank_mask:0xf
    s_nop 0
    s_nop 0
    v_max_u32_dpp v226, v226, v226 row_shr:8 row_mask:0xf bank_mask:0xf
    v_max_u32_dpp v227, v227, v227 row_shr:8 row_mask:0xf bank_mask:0xf
    s_mov_b32 exec_lo, 0x80008000
    s_mov_b32 exec_hi, 0x80008000
    ds_write2_b32 v225, v226, v227 offset0:96 offset1:112
    s_mov_b64 exec, 1
    ds_write_b32 v2, v5 offset:64
    s_mov_b64 exec, -1
    s_cmp_lg_u32 s63, 0
    s_cbranch_scc1 L_XBACK1
    s_mov_b32 s16, 0
    s_branch L_XPW
L_XP:
    s_cmp_ge_u32 s16, 0x4000
    s_cbranch_scc1 L_XBACK1
    s_sleep 1
    s_mov_b32 exec_hi, 0
    buffer_load_dwordx2 v[96:97], v99, s[44:47], s62 offen sc1
    s_mov_b32 exec_hi, -1
L_XPW:
    s_add_u32 s16, s16, 1
    s_waitcnt vmcnt(0)
    v_cmp_ne_u32 vcc, s56, v96
    s_cmp_lg_u32 vcc_lo, 0
    s_cbranch_scc1 L_XP
    v_cmp_ne_u32 vcc, s19, v97
    s_mov_b32 s63, 2
    s_cmp_eq_u32 vcc_lo, 0
    s_cselect_b32 s60, 2, 1
    s_cbranch_scc0 L_XSLOW
    buffer_load_dwordx4 v[64:67], v58, s[44:47], s13 offen
    s_add_u32 s13, s13, 0x1000
    buffer_load_dwordx4 v[68:71], v58, s[44:47], s13 offen
    s_add_u32 s13, s13, 0x1000
    buffer_load_dwordx4 v[72:75], v58, s[44:47], s13 offen
    s_add_u32 s13, s13, 0x1000
    buffer_load_dwordx4 v[76:79], v58, s[44:47], s13 offen
    s_add_u32 s13, s13, 0x1000
L_XBACK1:
    s_cmp_eq_u32 s69, 0
    s_cbranch_scc1 L_NG5
    global_load_dwordx4 v[144:147], v[102:103], off
    v_lshl_add_u64 v[102:103], s[20:21], 0, v[102:103]
    global_load_dwordx4 v[148:151], v[102:103], off
    v_lshl_add_u64 v[102:103], s[20:21], 0, v[102:103]
    global_load_dwordx4 v[152:155], v[102:103], off
    v_lshl_add_u64 v[102:103], s[20:21], 0, v[102:103]
    global_load_dwordx4 v[156:159], v[102:103], off
    v_lshl_add_u64 v[102:103], s[20:21], 0, v[102:103]
    global_load_dwordx4 v[160:163], v[102:103], off
    v_lshl_add_u64 v[102:103], s[20:21], 0, v[102:103]
    global_load_dwordx4 v[164:167], v[102:103], off
    v_lshl_add_u64 v[102:103], s[20:21], 0, v[102:103]
    global_load_dwordx4 v[168:171], v[102:103], off
    v_lshl_add_u64 v[102:103], s[20:21], 0, v[102:103]
    global_load_dwordx4 v[172:175], v[102:103], off
L_NG5:
LW_10:
    ds_read_b32 v225, v1 offset:64
    s_waitcnt lgkmcnt(0)
    v_cmp_eq_u32_e64 vcc, 0, v225
    s_cbranch_vccnz LW_10
    ds_read2_b32 v[226:227], v10 offset0:96 offset1:112
    ds_read_b128 v[228:231], v11 offset:384
    ds_read_b128 v[232:235], v224 offset:8192
    s_waitcnt lgkmcnt(1)
    v_cmp_gt_u32 vcc, v228, v226
    v_cmp_gt_u32 s[8:9], v229, v226
    v_cmp_gt_u32 s[14:15], v230, v226
    v_cmp_gt_u32 s[28:29], v231, v226
    v_cndmask_b32 v236, 0, 1, vcc
    v_cndmask_b32 v237, 0, 1, s[8:9]
    v_addc_co_u32 v236, vcc, 0, v236, s[14:15]
    v_addc_co_u32 v236, vcc, v237, v236, s[28:29]
    v_mov_b32 v237, v236
    s_nop 1
    v_permlane32_swap_b32 v236, v237
    v_add_u32 v236, v236, v237
    v_mov_b32 v237, v236
    s_nop 1
    v_permlane16_swap_b32 v236, v237
    v_add_u32 v236, v236, v237
    v_cmp_eq_u32 vcc, 7, v236
    s_ff1_i32_b32 s5, vcc_lo
    v_readlane_b32 s4, v226, s5
    s_waitcnt lgkmcnt(0)
    s_nop 0
    v_cmp_le_u32 vcc, s4, v227
    s_cbranch_vccnz L_SLOWT
L_CAND:
    v_cmp_le_u32 s[8:9], s4, v232
    v_cmp_le_u32 s[14:15], s4, v233
    v_cmp_le_u32 s[28:29], s4, v234
    v_cmp_le_u32 s[30:31], s4, v235
    s_bcnt1_i32_b64 s5, s[8:9]
    s_bcnt1_i32_b64 s6, s[14:15]
    s_bcnt1_i32_b64 s7, s[28:29]
    s_bcnt1_i32_b64 s16, s[30:31]
    s_add_u32 s6, s6, s5
    s_add_u32 s7, s7, s6
    s_add_u32 s16, s16, s7
    s_cmp_gt_u32 s16, 15
    s_cbranch_scc1 L_TRIM
    v_mbcnt_lo_u32_b32 v236, s8, 0
    v_mbcnt_hi_u32_b32 v236, s9, v236
    v_add_lshl_u32 v236, v236, 0, 2
    s_mov_b64 exec, s[8:9]
    ds_write_b32 v236, v232 offset:192
    s_mov_b64 exec, -1
    v_mbcnt_lo_u32_b32 v237, s14, 0
    v_mbcnt_hi_u32_b32 v237, s15, v237
    v_add_lshl_u32 v237, v237, s5, 2
    s_mov_b64 exec, s[14:15]
    ds_write_b32 v237, v233 offset:192
    s_mov_b64 exec, -1
    v_mbcnt_lo_u32_b32 v238, s28, 0
    v_mbcnt_hi_u32_b32 v238, s29, v238
    v_add_lshl_u32 v238, v238, s6, 2
    s_mov_b64 exec, s[28:29]
    ds_write_b32 v238, v234 offset:192
    s_mov_b64 exec, -1
    v_mbcnt_lo_u32_b32 v239, s30, 0
    v_mbcnt_hi_u32_b32 v239, s31, v239
    v_add_lshl_u32 v239, v239, s7, 2
    s_mov_b64 exec, s[30:31]
    ds_write_b32 v239, v235 offset:192
    s_mov_b64 exec, -1
    s_movk_i32 s4, 0x7ff
    ds_read_b32 v16, v10 offset:192
    ds_read_b128 v[20:23], v11 offset:192
    s_cmp_lg_u32 s69, 1
    s_waitcnt lgkmcnt(1)
    v_bfi_b32 v14, v16, 0, s4
    s_cbranch_scc1 L_NOXS
    s_nop 0
    v_lshl_add_u32 v15, v14, 11, v9
    s_mov_b32 exec_lo, 0x7fff7fff
    s_mov_b32 exec_hi, 0x7fff7fff
    buffer_load_dwordx4 v[208:211], v15, s[48:51], 0 offen
    buffer_load_dwordx4 v[212:215], v15, s[48:51], 0 offen offset:64
    s_mov_b64 exec, -1
    v_lshrrev_b32 v15, 1, v14
    v_lshlrev_b32_e64 v15, 3, v15
    ds_read_b64 v[8:9], v15 offset:9216
    v_lshlrev_b32_e64 v15, 11, v0
    buffer_load_dword v219, v15, s[24:27], s10 offen
    s_waitcnt vmcnt(11)
    s_branch L_N2
L_NOXS:
    s_waitcnt vmcnt(0)
L_N2:
    v_lshlrev_b32 v176, 16, v64
    v_and_b32 v184, 0xffff0000, v64
    v_lshlrev_b32_e64 v192, 16, v65
    v_and_b32 v200, 0xffff0000, v65
    v_lshlrev_b32_e64 v177, 16, v66
    v_and_b32 v185, 0xffff0000, v66
    v_lshlrev_b32_e64 v193, 16, v67
    v_and_b32 v201, 0xffff0000, v67
    v_lshlrev_b32_e64 v178, 16, v68
    v_and_b32 v186, 0xffff0000, v68
    v_lshlrev_b32_e64 v194, 16, v69
    v_and_b32 v202, 0xffff0000, v69
    v_lshlrev_b32_e64 v179, 16, v70
    v_and_b32 v187, 0xffff0000, v70
    v_lshlrev_b32_e64 v195, 16, v71
    v_and_b32 v203, 0xffff0000, v71
    v_lshlrev_b32_e64 v180, 16, v72
    v_and_b32 v188, 0xffff0000, v72
    v_lshlrev_b32_e64 v196, 16, v73
    v_and_b32 v204, 0xffff0000, v73
    v_lshlrev_b32_e64 v181, 16, v74
    v_and_b32 v189, 0xffff0000, v74
    v_lshlrev_b32_e64 v197, 16, v75
    v_and_b32 v205, 0xffff0000, v75
    v_lshlrev_b32_e64 v182, 16, v76
    v_and_b32 v190, 0xffff0000, v76
    v_lshlrev_b32_e64 v198, 16, v77
    v_and_b32 v206, 0xffff0000, v77
    v_lshlrev_b32_e64 v183, 16, v78
    v_and_b32 v191, 0xffff0000, v78
    v_lshlrev_b32_e64 v199, 16, v79
    v_and_b32 v207, 0xffff0000, v79
    v_lshlrev_b32_e64 v80, 16, v33
    v_and_b32 v81, 0xffff0000, v33
    v_lshlrev_b32_e64 v82, 16, v37
    v_and_b32 v83, 0xffff0000, v37
    v_lshlrev_b32_e64 v84, 16, v41
    v_and_b32 v85, 0xffff0000, v41
    v_lshlrev_b32_e64 v86, 16, v45
    v_and_b32 v87, 0xffff0000, v45
    v_rcp_f32 v80, v80
    v_rcp_f32 v81, v81
    v_rcp_f32 v82, v82
    v_rcp_f32 v83, v83
    v_rcp_f32 v84, v84
    v_rcp_f32 v85, v85
    v_rcp_f32 v86, v86
    v_rcp_f32 v87, v87
    v_lshlrev_b32_e64 v88, 16, v32
    v_and_b32 v89, 0xffff0000, v32
    v_lshlrev_b32_e64 v90, 16, v36
    v_and_b32 v91, 0xffff0000, v36
    v_lshlrev_b32_e64 v92, 16, v40
    v_and_b32 v93, 0xffff0000, v40
    v_lshlrev_b32_e64 v94, 16, v44
    v_and_b32 v95, 0xffff0000, v44
    v_pk_mul_f32 v[88:89], v[88:89], v[80:81]
    v_pk_mul_f32 v[90:91], v[90:91], v[82:83]
    v_pk_mul_f32 v[92:93], v[92:93], v[84:85]
    v_pk_mul_f32 v[94:95], v[94:95], v[86:87]
    v_pk_fma_f32 v[176:177], v[176:177], v[80:81], v[88:89] neg_lo:[0,0,1] neg_hi:[0,0,1]
    v_pk_fma_f32 v[178:179], v[178:179], v[82:83], v[90:91] neg_lo:[0,0,1] neg_hi:[0,0,1]
    v_pk_fma_f32 v[180:181], v[180:181], v[84:85], v[92:93] neg_lo:[0,0,1] neg_hi:[0,0,1]
    v_pk_fma_f32 v[182:183], v[182:183], v[86:87], v[94:95] neg_lo:[0,0,1] neg_hi:[0,0,1]
    v_cvt_pk_bf16_f32 v48, v177, v176
    v_cvt_pk_bf16_f32 v49, v179, v178
    v_cvt_pk_bf16_f32 v50, v181, v180
    v_cvt_pk_bf16_f32 v51, v183, v182
    ds_write2st64_b32 v56, v48, v49 offset0:12 offset1:8
    ds_write2st64_b32 v56, v50, v51 offset0:4 offset1:0
    v_pk_fma_f32 v[184:185], v[184:185], v[80:81], v[88:89] neg_lo:[0,0,1] neg_hi:[0,0,1]
    v_pk_fma_f32 v[186:187], v[186:187], v[82:83], v[90:91] neg_lo:[0,0,1] neg_hi:[0,0,1]
    v_pk_fma_f32 v[188:189], v[188:189], v[84:85], v[92:93] neg_lo:[0,0,1] neg_hi:[0,0,1]
    v_pk_fma_f32 v[190:191], v[190:191], v[86:87], v[94:95] neg_lo:[0,0,1] neg_hi:[0,0,1]
    v_cvt_pk_bf16_f32 v52, v185, v184
    v_cvt_pk_bf16_f32 v53, v187, v186
    v_cvt_pk_bf16_f32 v54, v189, v188
    v_cvt_pk_bf16_f32 v55, v191, v190
    ds_write2st64_b32 v56, v52, v53 offset0:30 offset1:26
    ds_write2st64_b32 v56, v54, v55 offset0:22 offset1:18
    v_pk_fma_f32 v[192:193], v[192:193], v[80:81], v[88:89] neg_lo:[0,0,1] neg_hi:[0,0,1]
    v_pk_fma_f32 v[194:195], v[194:195], v[82:83], v[90:91] neg_lo:[0,0,1] neg_hi:[0,0,1]
    v_pk_fma_f32 v[196:197], v[196:197], v[84:85], v[92:93] neg_lo:[0,0,1] neg_hi:[0,0,1]
    v_pk_fma_f32 v[198:199], v[198:199], v[86:87], v[94:95] neg_lo:[0,0,1] neg_hi:[0,0,1]
    v_cvt_pk_bf16_f32 v48, v193, v192
    v_cvt_pk_bf16_f32 v49, v195, v194
    v_cvt_pk_bf16_f32 v50, v197, v196
    v_cvt_pk_bf16_f32 v51, v199, v198
    ds_write2st64_b32 v56, v48, v49 offset0:48 offset1:44
    ds_write2st64_b32 v56, v50, v51 offset0:40 offset1:36
    v_pk_fma_f32 v[200:201], v[200:201], v[80:81], v[88:89] neg_lo:[0,0,1] neg_hi:[0,0,1]
    v_pk_fma_f32 v[202:203], v[202:203], v[82:83], v[90:91] neg_lo:[0,0,1] neg_hi:[0,0,1]
    v_pk_fma_f32 v[204:205], v[204:205], v[84:85], v[92:93] neg_lo:[0,0,1] neg_hi:[0,0,1]
    v_pk_fma_f32 v[206:207], v[206:207], v[86:87], v[94:95] neg_lo:[0,0,1] neg_hi:[0,0,1]
    v_cvt_pk_bf16_f32 v52, v201, v200
    v_cvt_pk_bf16_f32 v53, v203, v202
    v_cvt_pk_bf16_f32 v54, v205, v204
    v_cvt_pk_bf16_f32 v55, v207, v206
    ds_write2st64_b32 v56, v52, v53 offset0:66 offset1:62
    ds_write2st64_b32 v56, v54, v55 offset0:58 offset1:54
    v_mov_b32 v59, s60
    s_mov_b64 exec, 1
    ds_write_b32 v2, v59 offset:0
    s_mov_b64 exec, -1
    s_waitcnt lgkmcnt(9)
    v_cmp_gt_u32_e64 vcc, v20, v16
    v_cmp_gt_u32 s[8:9], v21, v16
    v_cmp_gt_u32 s[14:15], v22, v16
    v_cmp_gt_u32 s[28:29], v23, v16
    v_cndmask_b32 v24, 0, 1, vcc
    v_cndmask_b32 v25, 0, 1, s[8:9]
    v_addc_co_u32 v24, vcc, 0, v24, s[14:15]
    v_addc_co_u32 v24, vcc, v25, v24, s[28:29]
    v_mov_b32 v25, v24
    s_nop 1
    v_permlane32_swap_b32 v24, v25
    v_add_u32 v24, v24, v25
    v_mov_b32 v25, v24
    s_nop 1
    v_permlane16_swap_b32 v24, v25
    v_add_u32 v24, v24, v25
    v_cmp_gt_u32 s[30:31], 8, v24
    v_lshlrev_b32 v15, 2, v24
    v_and_b32 v10, 7, v0
    v_lshlrev_b32_e64 v10, 2, v10
    v_bfe_u32 v20, v14, 1, 8
    v_lshrrev_b32 v21, 9, v14
    v_lshlrev_b32 v20, 3, v20
    v_lshl_add_u32 v20, v21, 1, v20
    v_and_b32 v14, 1, v14
    v_add_u32 v20, v20, v14
    v_mov_b32 v22, 0x80
    s_mov_b64 exec, s[30:31]
    ds_write_b32 v15, v16 offset:256
    s_cmp_lg_u32 s3, 0
    s_cbranch_scc1 L_NOSEL
    ds_write_b8 v20, v22 offset:1152
    s_cmp_lg_u32 s2, 255
    s_cbranch_scc1 L_NOSEL
    s_mov_b64 exec, 1
    v_mov_b32 v22, s56
    buffer_store_dword v22, v2, s[44:47], 0 offen sc1
L_NOSEL:
    s_mov_b64 exec, -1
    ds_read_b32 v7, v10 offset:256
LW_11:
    ds_read_b32 v11, v1 offset:160
    s_waitcnt lgkmcnt(0)
    v_cmp_eq_u32 vcc, 0, v11
    s_cbranch_vccnz LW_11
    ds_write_b128 v57, v[64:67] offset:0
    ds_write_b128 v57, v[68:71] offset:4096
    ds_write_b128 v57, v[72:75] offset:8192
    ds_write_b128 v57, v[76:79] offset:12288
    s_mov_b64 exec, 1
    ds_write_b32 v2, v5 offset:112
    s_mov_b64 exec, -1
    s_cmp_lg_u32 s69, 1
    s_cbranch_scc1 L_GATHER
    v_lshl_add_u32 v3, v24, 4, v3
    v_lshlrev_b32 v14, 4, v14
    v_lshlrev_b32_e64 v13, 4, v0
    s_lshl_b32 s4, s59, 14
    s_add_u32 s4, s4, 65536
    s_lshl_b32 s6, s3, 12
    s_add_u32 s6, s6, s4
    s_lshl_b32 s5, s68, 10
    s_add_u32 s5, s5, s6
    v_mov_b32 v218, s56
    s_waitcnt vmcnt(11)
    v_perm_b32 v48, v116, v112, s64
    v_perm_b32 v52, v116, v112, s65
    v_perm_b32 v49, v124, v120, s64
    v_perm_b32 v53, v124, v120, s65
    v_perm_b32 v50, v132, v128, s64
    v_perm_b32 v54, v132, v128, s65
    v_perm_b32 v51, v140, v136, s64
    v_perm_b32 v55, v140, v136, s65
    v_perm_b32 v56, v117, v113, s64
    v_perm_b32 v60, v117, v113, s65
    v_perm_b32 v57, v125, v121, s64
    v_perm_b32 v61, v125, v121, s65
    v_perm_b32 v58, v133, v129, s64
    v_perm_b32 v62, v133, v129, s65
    v_perm_b32 v59, v141, v137, s64
    v_perm_b32 v63, v141, v137, s65
    v_perm_b32 v64, v118, v114, s64
    v_perm_b32 v68, v118, v114, s65
    v_perm_b32 v65, v126, v122, s64
    v_perm_b32 v69, v126, v122, s65
    v_perm_b32 v66, v134, v130, s64
    v_perm_b32 v70, v134, v130, s65
    v_perm_b32 v67, v142, v138, s64
    v_perm_b32 v71, v142, v138, s65
    v_perm_b32 v72, v119, v115, s64
    v_perm_b32 v76, v119, v115, s65
    v_perm_b32 v73, v127, v123, s64
    v_perm_b32 v77, v127, v123, s65
    v_perm_b32 v74, v135, v131, s64
    v_perm_b32 v78, v135, v131, s65
    v_perm_b32 v75, v143, v139, s64
    v_perm_b32 v79, v143, v139, s65
    s_waitcnt vmcnt(3)
    s_nop 0
    v_perm_b32 v80, v148, v144, s64
    v_perm_b32 v84, v148, v144, s65
    v_perm_b32 v81, v156, v152, s64
    v_perm_b32 v85, v156, v152, s65
    v_perm_b32 v82, v164, v160, s64
    v_perm_b32 v86, v164, v160, s65
    v_perm_b32 v83, v172, v168, s64
    v_perm_b32 v87, v172, v168, s65
    v_perm_b32 v88, v149, v145, s64
    v_perm_b32 v92, v149, v145, s65
    v_perm_b32 v89, v157, v153, s64
    v_perm_b32 v93, v157, v153, s65
    v_perm_b32 v90, v165, v161, s64
    v_perm_b32 v94, v165, v161, s65
    v_perm_b32 v91, v173, v169, s64
    v_perm_b32 v95, v173, v169, s65
    v_perm_b32 v96, v150, v146, s64
    v_perm_b32 v100, v150, v146, s65
    v_perm_b32 v97, v158, v154, s64
    v_perm_b32 v101, v158, v154, s65
    v_perm_b32 v98, v166, v162, s64
    v_perm_b32 v102, v166, v162, s65
    v_perm_b32 v99, v174, v170, s64
    v_perm_b32 v103, v174, v170, s65
    v_perm_b32 v104, v151, v147, s64
    v_perm_b32 v108, v151, v147, s65
    v_perm_b32 v105, v159, v155, s64
    v_perm_b32 v109, v159, v155, s65
    v_perm_b32 v106, v167, v163, s64
    v_perm_b32 v110, v167, v163, s65
    v_perm_b32 v107, v175, v171, s64
    v_perm_b32 v111, v175, v171, s65
    s_waitcnt vmcnt(1)
    v_mfma_f32_16x16x32_bf16 v[16:19], v[48:51], v[208:211], 0
    v_lshrrev_b32 v6, v14, v9
    v_mfma_f32_16x16x32_bf16 v[16:19], v[80:83], v[212:215], v[16:19]
    v_lshrrev_b32_e64 v8, v14, v8
    v_mfma_f32_16x16x32_bf16 v[20:23], v[52:55], v[208:211], 0
    v_lshlrev_b32_e64 v6, 16, v6
    v_mfma_f32_16x16x32_bf16 v[20:23], v[84:87], v[212:215], v[20:23]
    v_lshlrev_b32_e64 v8, 16, v8
    v_mfma_f32_16x16x32_bf16 v[24:27], v[56:59], v[208:211], 0
    v_rcp_f32_e64 v6, v6
    v_mfma_f32_16x16x32_bf16 v[24:27], v[88:91], v[212:215], v[24:27]
    v_xor_b32 v8, 0x80000000, v8
    v_mfma_f32_16x16x32_bf16 v[28:31], v[60:63], v[208:211], 0
    s_nop 0
    s_nop 0
    v_fmac_f32_dpp v16, v16, v8 row_newbcast:15 row_mask:0xf bank_mask:0xf
    v_fmac_f32_dpp v17, v17, v8 row_newbcast:15 row_mask:0xf bank_mask:0xf
    v_mfma_f32_16x16x32_bf16 v[28:31], v[92:95], v[212:215], v[28:31]
    v_fmac_f32_dpp v18, v18, v8 row_newbcast:15 row_mask:0xf bank_mask:0xf
    v_fmac_f32_dpp v19, v19, v8 row_newbcast:15 row_mask:0xf bank_mask:0xf
    v_mfma_f32_16x16x32_bf16 v[32:35], v[64:67], v[208:211], 0
    v_fmac_f32_dpp v20, v20, v8 row_newbcast:15 row_mask:0xf bank_mask:0xf
    v_fmac_f32_dpp v21, v21, v8 row_newbcast:15 row_mask:0xf bank_mask:0xf
    v_mfma_f32_16x16x32_bf16 v[32:35], v[96:99], v[212:215], v[32:35]
    v_fmac_f32_dpp v22, v22, v8 row_newbcast:15 row_mask:0xf bank_mask:0xf
    v_fmac_f32_dpp v23, v23, v8 row_newbcast:15 row_mask:0xf bank_mask:0xf
    v_mfma_f32_16x16x32_bf16 v[36:39], v[68:71], v[208:211], 0
    v_fmac_f32_dpp v24, v24, v8 row_newbcast:15 row_mask:0xf bank_mask:0xf
    v_fmac_f32_dpp v25, v25, v8 row_newbcast:15 row_mask:0xf bank_mask:0xf
    v_mfma_f32_16x16x32_bf16 v[36:39], v[100:103], v[212:215], v[36:39]
    v_fmac_f32_dpp v26, v26, v8 row_newbcast:15 row_mask:0xf bank_mask:0xf
    v_fmac_f32_dpp v27, v27, v8 row_newbcast:15 row_mask:0xf bank_mask:0xf
    v_mfma_f32_16x16x32_bf16 v[40:43], v[72:75], v[208:211], 0
    v_fmac_f32_dpp v28, v28, v8 row_newbcast:15 row_mask:0xf bank_mask:0xf
    v_fmac_f32_dpp v29, v29, v8 row_newbcast:15 row_mask:0xf bank_mask:0xf
    v_mfma_f32_16x16x32_bf16 v[40:43], v[104:107], v[212:215], v[40:43]
    v_fmac_f32_dpp v30, v30, v8 row_newbcast:15 row_mask:0xf bank_mask:0xf
    v_fmac_f32_dpp v31, v31, v8 row_newbcast:15 row_mask:0xf bank_mask:0xf
    v_mfma_f32_16x16x32_bf16 v[44:47], v[76:79], v[208:211], 0
    v_fmac_f32_dpp v32, v32, v8 row_newbcast:15 row_mask:0xf bank_mask:0xf
    v_fmac_f32_dpp v33, v33, v8 row_newbcast:15 row_mask:0xf bank_mask:0xf
    v_mfma_f32_16x16x32_bf16 v[44:47], v[108:111], v[212:215], v[44:47]
    v_fmac_f32_dpp v34, v34, v8 row_newbcast:15 row_mask:0xf bank_mask:0xf
    v_fmac_f32_dpp v35, v35, v8 row_newbcast:15 row_mask:0xf bank_mask:0xf
    v_fmac_f32_dpp v36, v36, v8 row_newbcast:15 row_mask:0xf bank_mask:0xf
    v_fmac_f32_dpp v37, v37, v8 row_newbcast:15 row_mask:0xf bank_mask:0xf
    v_fmac_f32_dpp v38, v38, v8 row_newbcast:15 row_mask:0xf bank_mask:0xf
    v_fmac_f32_dpp v39, v39, v8 row_newbcast:15 row_mask:0xf bank_mask:0xf
    v_fmac_f32_dpp v40, v40, v8 row_newbcast:15 row_mask:0xf bank_mask:0xf
    v_fmac_f32_dpp v41, v41, v8 row_newbcast:15 row_mask:0xf bank_mask:0xf
    v_fmac_f32_dpp v42, v42, v8 row_newbcast:15 row_mask:0xf bank_mask:0xf
    v_fmac_f32_dpp v43, v43, v8 row_newbcast:15 row_mask:0xf bank_mask:0xf
    v_fmac_f32_dpp v44, v44, v8 row_newbcast:15 row_mask:0xf bank_mask:0xf
    v_fmac_f32_dpp v45, v45, v8 row_newbcast:15 row_mask:0xf bank_mask:0xf
    v_fmac_f32_dpp v46, v46, v8 row_newbcast:15 row_mask:0xf bank_mask:0xf
    v_fmac_f32_dpp v47, v47, v8 row_newbcast:15 row_mask:0xf bank_mask:0xf
    s_mov_b64 exec, s[30:31]
    s_nop 0
    ds_write_b128 v3, v[16:19] offset:0
    ds_write_b128 v3, v[20:23] offset:512
    ds_write_b128 v3, v[24:27] offset:1024
    ds_write_b128 v3, v[28:31] offset:1536
    ds_write_b128 v3, v[32:35] offset:2048
    ds_write_b128 v3, v[36:39] offset:2560
    ds_write_b128 v3, v[40:43] offset:3072
    ds_write_b128 v3, v[44:47] offset:3584
    ds_write_b32 v15, v6 offset:288
    s_mov_b64 exec, 1
    ds_write_b32 v2, v5 offset:80
    s_mov_b64 exec, -1
    ds_read_b32 v6, v10 offset:288
LW_12:
    ds_read_b32 v11, v1 offset:80
    s_waitcnt lgkmcnt(0)
    v_cmp_eq_u32_e64 vcc, 0, v11
    s_cbranch_vccnz LW_12
    ds_read_b64 v[224:225], v4 offset:0
    ds_read_b64 v[226:227], v4 offset:256
    ds_read_b64 v[228:229], v4 offset:4096
    ds_read_b64 v[230:231], v4 offset:4352
    ds_read_b64 v[232:233], v4 offset:8192
    ds_read_b64 v[234:235], v4 offset:8448
    ds_read_b64 v[236:237], v4 offset:12288
    ds_read_b64 v[238:239], v4 offset:12544
    s_waitcnt lgkmcnt(4)
    v_add_f32 v224, v224, v228
    v_add_f32 v225, v225, v229
    v_add_f32 v226, v226, v230
    v_add_f32 v227, v227, v231
    s_waitcnt lgkmcnt(0)
    v_add_f32 v232, v232, v236
    v_add_f32 v233, v233, v237
    v_add_f32 v234, v234, v238
    v_add_f32 v235, v235, v239
    v_add_f32 v224, v224, v232
    v_add_f32 v225, v225, v233
    v_add_f32 v226, v226, v234
    v_add_f32 v227, v227, v235
    v_cvt_pk_bf16_f32 v216, v224, v225
    v_cvt_pk_bf16_f32 v217, v226, v227
    buffer_store_dwordx4 v[216:219], v13, s[44:47], s5 offen sc1
    s_add_u32 s11, s10, 0
    s_nop 0
    buffer_load_dwordx2 v[176:177], v12, s[24:27], s11 offen
    s_add_u32 s11, s10, 16384
    buffer_load_dwordx2 v[178:179], v12, s[24:27], s11 offen
    s_add_u32 s11, s10, 2048
    buffer_load_dwordx2 v[180:181], v12, s[24:27], s11 offen
    s_add_u32 s11, s10, 18432
    buffer_load_dwordx2 v[182:183], v12, s[24:27], s11 offen
    s_add_u32 s11, s10, 32768
    buffer_load_dwordx2 v[184:185], v12, s[24:27], s11 offen
    s_add_u32 s11, s10, 49152
    buffer_load_dwordx2 v[186:187], v12, s[24:27], s11 offen
    s_add_u32 s11, s10, 34816
    buffer_load_dwordx2 v[188:189], v12, s[24:27], s11 offen
    s_add_u32 s11, s10, 51200
    buffer_load_dwordx2 v[190:191], v12, s[24:27], s11 offen
    s_add_u32 s11, s10, 8192
    buffer_load_dwordx2 v[192:193], v12, s[24:27], s11 offen
    s_add_u32 s11, s10, 24576
    buffer_load_dwordx2 v[194:195], v12, s[24:27], s11 offen
    s_add_u32 s11, s10, 10240
    buffer_load_dwordx2 v[196:197], v12, s[24:27], s11 offen
    s_add_u32 s11, s10, 26624
    buffer_load_dwordx2 v[198:199], v12, s[24:27], s11 offen
    s_add_u32 s11, s10, 40960
    buffer_load_dwordx2 v[200:201], v12, s[24:27], s11 offen
    s_add_u32 s11, s10, 57344
    buffer_load_dwordx2 v[202:203], v12, s[24:27], s11 offen
    s_add_u32 s11, s10, 43008
    buffer_load_dwordx2 v[204:205], v12, s[24:27], s11 offen
    s_add_u32 s11, s10, 59392
    buffer_load_dwordx2 v[206:207], v12, s[24:27], s11 offen
    v_bfe_u32 v10, v0, 3, 1
    v_lshrrev_b32_e64 v11, 4, v0
    v_cmp_ne_u32 s[22:23], 0, v10
    v_lshlrev_b32_e64 v15, 2, v10
    v_lshl_add_u32 v15, v11, 3, v15
    v_lshlrev_b32_e64 v10, 8, v10
    v_lshl_add_u32 v10, v11, 9, v10
    v_lshlrev_b32 v9, 4, v11
    v_and_b32 v11, 7, v0
    v_lshl_add_u32 v10, v11, 4, v10
    s_movk_i32 s5, 144
    v_mad_u32_u24 v15, v11, s5, v15
    v_mad_u32_u24 v9, v11, s5, v9
    s_lshl_b32 s5, s3, 5
    v_add_u32 v15, s5, v15
    s_lshl_b32 s4, s59, 15
    s_lshl_b32 s5, s68, 13
    s_add_u32 s4, s4, s5
    s_lshl_b32 s5, s3, 11
    s_add_u32 s4, s4, s5
    s_add_u32 s4, s4, 1048576
    v_mul_f32 v12, 0xbfb8aa3b, v6
    v_mul_f32 v14, v6, v6
    v_mov_b32 v50, s56
    v_mov_b32_e64 v54, s56
    s_mov_b32 s16, 0
    s_waitcnt vmcnt(8)
    buffer_load_dwordx3 v[144:146], v13, s[44:47], s6 offen offset:0 sc1
    buffer_load_dwordx3 v[148:150], v13, s[44:47], s6 offen offset:1024 sc1
    buffer_load_dwordx3 v[152:154], v13, s[44:47], s6 offen offset:2048 sc1
    buffer_load_dwordx3 v[156:158], v13, s[44:47], s6 offen offset:3072 sc1
    s_waitcnt vmcnt(12)
    s_nop 0
    v_perm_b32 v112, v178, v176, s64
    v_perm_b32 v116, v178, v176, s65
    v_perm_b32 v113, v182, v180, s64
    v_perm_b32 v117, v182, v180, s65
    v_perm_b32 v114, v186, v184, s64
    v_perm_b32 v118, v186, v184, s65
    v_perm_b32 v115, v190, v188, s64
    v_perm_b32 v119, v190, v188, s65
    v_perm_b32 v120, v179, v177, s64
    v_perm_b32 v124, v179, v177, s65
    v_perm_b32 v121, v183, v181, s64
    v_perm_b32 v125, v183, v181, s65
    v_perm_b32 v122, v187, v185, s64
    v_perm_b32 v126, v187, v185, s65
    v_perm_b32 v123, v191, v189, s64
    v_perm_b32 v127, v191, v189, s65
    s_waitcnt vmcnt(4)
    s_nop 0
    v_perm_b32 v128, v194, v192, s64
    v_perm_b32 v132, v194, v192, s65
    v_perm_b32 v129, v198, v196, s64
    v_perm_b32 v133, v198, v196, s65
    v_perm_b32 v130, v202, v200, s64
    v_perm_b32 v134, v202, v200, s65
    v_perm_b32 v131, v206, v204, s64
    v_perm_b32 v135, v206, v204, s65
    v_perm_b32 v136, v195, v193, s64
    v_perm_b32 v140, v195, v193, s65
    v_perm_b32 v137, v199, v197, s64
    v_perm_b32 v141, v199, v197, s65
    v_perm_b32 v138, v203, v201, s64
    v_perm_b32 v142, v203, v201, s65
    v_perm_b32 v139, v207, v205, s64
    v_perm_b32 v143, v207, v205, s65
    s_branch L_HPW
L_HP:
    s_sleep 3
    s_cmp_eq_u64 s[18:19], 0
    s_cbranch_scc1 L_HS0
    buffer_load_dwordx3 v[144:146], v13, s[44:47], s6 offen offset:0 sc1
L_HS0:
    s_cmp_eq_u64 s[8:9], 0
    s_cbranch_scc1 L_HS1
    buffer_load_dwordx3 v[148:150], v13, s[44:47], s6 offen offset:1024 sc1
L_HS1:
    s_cmp_eq_u64 s[14:15], 0
    s_cbranch_scc1 L_HS2
    buffer_load_dwordx3 v[152:154], v13, s[44:47], s6 offen offset:2048 sc1
L_HS2:
    s_cmp_eq_u64 s[28:29], 0
    s_cbranch_scc1 L_HS3
    buffer_load_dwordx3 v[156:158], v13, s[44:47], s6 offen offset:3072 sc1
L_HS3:
L_HPW:
    s_add_u32 s16, s16, 1
    s_waitcnt vmcnt(0)
    v_cmp_ne_u32 s[18:19], s56, v146
    v_cmp_ne_u32 s[8:9], s56, v150
    v_cmp_ne_u32 s[14:15], s56, v154
    v_cmp_ne_u32 s[28:29], s56, v158
    s_or_b64 vcc, s[18:19], s[8:9]
    s_or_b64 s[20:21], s[14:15], s[28:29]
    s_or_b64 vcc, vcc, s[20:21]
    s_cbranch_vccz L_HOK
    s_cmp_lt_u32 s16, 0x4000
    s_cbranch_scc1 L_HP
L_HOK:
    v_lshlrev_b32 v224, 16, v144
    v_and_b32 v225, 0xffff0000, v144
    v_lshlrev_b32_e64 v226, 16, v148
    v_and_b32 v227, 0xffff0000, v148
    v_lshlrev_b32_e64 v228, 16, v152
    v_and_b32 v229, 0xffff0000, v152
    v_lshlrev_b32_e64 v230, 16, v156
    v_and_b32 v231, 0xffff0000, v156
    v_add_f32 v224, v224, v226
    v_add_f32 v228, v228, v230
    v_add_f32 v225, v225, v227
    v_add_f32 v229, v229, v231
    v_add_f32 v224, v224, v228
    v_add_f32 v225, v225, v229
    v_mul_f32 v244, v12, v224
    v_mul_f32 v245, v12, v225
    v_exp_f32 v244, v244
    v_exp_f32 v245, v245
    v_lshlrev_b32_e64 v232, 16, v145
    v_and_b32 v233, 0xffff0000, v145
    v_lshlrev_b32_e64 v234, 16, v149
    v_and_b32 v235, 0xffff0000, v149
    v_lshlrev_b32_e64 v236, 16, v153
    v_and_b32 v237, 0xffff0000, v153
    v_lshlrev_b32_e64 v238, 16, v157
    v_and_b32 v239, 0xffff0000, v157
    v_add_f32 v244, 1.0, v244
    v_add_f32 v245, 1.0, v245
    v_rcp_f32 v244, v244
    v_rcp_f32 v245, v245
    v_add_f32 v232, v232, v234
    v_add_f32 v236, v236, v238
    v_add_f32 v233, v233, v235
    v_add_f32 v237, v237, v239
    v_mul_f32 v224, v224, v14
    v_add_f32 v232, v232, v236
    v_mul_f32 v225, v225, v14
    v_add_f32 v233, v233, v237
    v_mul_f32 v224, v224, v244
    v_mul_f32 v225, v225, v245
    v_mul_f32 v224, v224, v232
    v_mul_f32 v225, v225, v233
    v_cvt_pk_bf16_f32 v244, v224, v225
    ds_write_b32 v15, v244 offset:4096
    s_mov_b64 exec, 1
    ds_write_b32 v2, v5 offset:176
    s_mov_b64 exec, -1
LW_13:
    ds_read_b32 v11, v1 offset:176
    s_waitcnt lgkmcnt(0)
    v_cmp_eq_u32_e64 vcc, 0, v11
    s_cbranch_vccnz LW_13
    ds_read_b128 v[224:227], v9 offset:4096
    ds_read_b128 v[228:231], v9 offset:4160
    s_waitcnt lgkmcnt(1)
    v_mfma_f32_16x16x32_bf16 v[16:19], v[112:115], v[224:227], 0
    v_mfma_f32_16x16x32_bf16 v[20:23], v[116:119], v[224:227], 0
    v_mfma_f32_16x16x32_bf16 v[24:27], v[120:123], v[224:227], 0
    v_mfma_f32_16x16x32_bf16 v[28:31], v[124:127], v[224:227], 0
    s_waitcnt lgkmcnt(0)
    v_mfma_f32_16x16x32_bf16 v[16:19], v[128:131], v[228:231], v[16:19]
    v_mfma_f32_16x16x32_bf16 v[20:23], v[132:135], v[228:231], v[20:23]
    v_mfma_f32_16x16x32_bf16 v[24:27], v[136:139], v[228:231], v[24:27]
    v_mfma_f32_16x16x32_bf16 v[28:31], v[140:143], v[228:231], v[28:31]
    s_nop 0
    s_nop 3
    v_cndmask_b32 v16, v16, v18, s[22:23]
    v_cndmask_b32 v20, v20, v22, s[22:23]
    v_cndmask_b32 v24, v24, v26, s[22:23]
    v_cndmask_b32 v28, v28, v30, s[22:23]
    v_cvt_pk_bf16_f32 v48, v16, v20
    v_cvt_pk_bf16_f32 v49, v24, v28
    buffer_store_dwordx4 v[48:51], v10, s[44:47], s4 offen offset:0 sc1
    v_cndmask_b32 v17, v17, v19, s[22:23]
    v_cndmask_b32 v21, v21, v23, s[22:23]
    v_cndmask_b32 v25, v25, v27, s[22:23]
    v_cndmask_b32 v29, v29, v31, s[22:23]
    v_cvt_pk_bf16_f32 v52, v17, v21
    v_cvt_pk_bf16_f32 v53, v25, v29
    buffer_store_dwordx4 v[52:55], v10, s[44:47], s4 offen offset:128 sc1
L_GATHER:
    s_waitcnt lgkmcnt(0)
    s_movk_i32 s4, 0x7ff
    v_bfi_b32 v14, v7, 0, s4
    v_lshrrev_b32 v10, 3, v0
    s_lshl_b32 s4, s3, 3
    v_add_lshl_u32 v10, v10, s4, 15
    v_and_b32 v11, 7, v0
    v_lshlrev_b32 v11, 4, v11
    v_add_u32 v10, v10, v11
    s_lshl_b32 s4, s57, 7
    s_add_u32 s4, s4, 1048576
    s_mov_b32 s11, 0
    v_bfe_u32 v12, v0, 3, 2
    v_lshlrev_b32 v13, 11, v14
    v_lshl_add_u32 v13, v12, 1, v13
    s_lshl_b32 s8, s57, 3
    v_add_u32 v13, s8, v13
    buffer_load_ushort v80, v13, s[48:51], 0 offen
LW_14:
    ds_read_b32 v15, v1 offset:112
    s_waitcnt lgkmcnt(0)
    v_cmp_eq_u32 vcc, 0, v15
    s_cbranch_vccnz LW_14
    v_lshrrev_b32 v15, 16, v7
    v_bfe_i32 v82, v15, 15, 1
    v_not_b32_e64 v82, v82
    v_or_b32 v82, 0x8000, v82
    v_xor_b32 v15, v15, v82
    v_lshlrev_b32 v15, 16, v15
    v_mul_f32 v15, 0xbfb8aa3b, v15
    v_exp_f32 v15, v15
    v_lshlrev_b32 v83, 13, v12
    v_add_f32 v15, 1.0, v15
    v_rcp_f32 v15, v15
    v_lshl_add_u32 v83, v14, 2, v83
    v_add_u32 v83, 93184, v83
    v_lshl_add_u32 v84, v12, 2, v11
    s_cmp_lg_u32 s60, 2
    s_cbranch_scc1 L_AFT
    s_cmp_ge_u32 s3, 2
    s_cbranch_scc1 L_AFT
L_TILE:
    s_lshl_b32 s8, s3, 4
    s_cmp_eq_u32 s3, 0
    s_cselect_b32 s8, 144, s8
    v_add_u32_e64 v92, s8, v1
    s_and_b32 s14, s2, 7
    s_lshr_b32 s15, s2, 3
    s_lshl_b32 s16, s14, 11
    s_lshl_b32 s8, s3, 9
    s_add_u32 s16, s16, s8
    s_lshr_b32 s9, s15, 3
    s_lshl_b32 s9, s9, 7
    s_add_u32 s16, s16, s9
    s_add_u32 s16, s16, 1015808
    s_lshl_b32 s9, s15, 4
    s_add_u32 s8, s8, s9
    s_lshl_b32 s17, s14, 19
    s_lshl_b32 s9, s8, 3
    s_add_u32 s17, s17, s9
    s_add_u32 s17, s17, 3145728
    s_lshl_b32 s18, s8, 11
    s_lshl_b32 s9, s14, 8
    s_add_u32 s18, s18, s9
    s_add_u32 s19, s18, 4096
    s_mul_i32 s9, s3, 4352
    s_add_u32 s9, s9, 125952
    s_cmp_eq_u32 s3, 3
    s_cselect_b32 s9, 9216, s9
    v_lshlrev_b32 v93, 2, v0
    v_and_b32 v98, 7, v0
    v_lshrrev_b32 v99, 3, v0
    v_lshlrev_b32_e64 v94, 4, v98
    v_lshl_add_u32 v94, v99, 14, v94
    s_movk_i32 s8, 544
    v_lshl_add_u32 v95, v99, 3, s9
    v_mad_u32_u24 v95, v98, s8, v95
    v_lshrrev_b32 v98, 4, v0
    v_and_b32 v99, 15, v0
    v_lshlrev_b32_e64 v99, 4, v99
    s_movk_i32 s8, 1088
    v_mad_u32_u24 v96, v98, s8, v99
    v_add_u32_e64 v96, s9, v96
    v_lshl_add_u32 v97, v98, 13, v99
    s_lshl_b32 s8, s15, 6
    s_lshl_b32 s9, s3, 1
    s_add_u32 s8, s8, s9
    v_lshl_add_u32 v98, v98, 4, s8
    ds_read_u16 v100, v98 offset:1152
    ds_read_u16 v101, v98 offset:1160
    s_brev_b32 s8, 1
    s_mov_b32 s20, 0
    s_setprio 0
LW_15:
    s_sleep 2
    ds_read_b32 v99, v92 offset:0
    s_waitcnt lgkmcnt(0)
    v_cmp_eq_u32 vcc, 0, v99
    s_cbranch_vccnz LW_15
    s_setprio 2
    v_lshlrev_b32 v102, 24, v100
    v_lshlrev_b32 v103, 16, v100
    v_lshlrev_b32 v104, 24, v101
    v_lshlrev_b32_e64 v105, 16, v101
    v_and_or_b32 v102, v102, s8, v97
    v_and_or_b32 v103, v103, s8, v97
    v_and_or_b32 v104, v104, s8, v97
    v_and_or_b32 v105, v105, s8, v97
    s_mov_b32 exec_hi, 0
L_TP:
    s_sleep 1
    buffer_load_dword v99, v93, s[44:47], s16 offen sc1
    s_add_u32 s20, s20, 1
    s_waitcnt vmcnt(0)
    v_cmp_ne_u32 vcc, s56, v99
    s_cbranch_vccz L_TOK
    s_cmp_lt_u32 s20, 0x4000
    s_cbranch_scc1 L_TP
L_TOK:
    s_mov_b32 exec_hi, -1
    buffer_load_dwordx4 v[16:19], v94, s[44:47], s17 offen sc1
    s_add_u32 s17, s17, 0x20000
    buffer_load_dwordx4 v[20:23], v94, s[44:47], s17 offen sc1
    s_add_u32 s17, s17, 0x20000
    buffer_load_dwordx4 v[24:27], v94, s[44:47], s17 offen sc1
    s_add_u32 s17, s17, 0x20000
    buffer_load_dwordx4 v[28:31], v94, s[44:47], s17 offen sc1
    s_add_u32 s17, s17, 0x20000
    s_waitcnt vmcnt(3)
    ds_write_b64 v95, v[16:17] offset:0
    ds_write_b64 v95, v[18:19] offset:272
    s_waitcnt vmcnt(2)
    ds_write_b64 v95, v[20:21] offset:64
    ds_write_b64 v95, v[22:23] offset:336
    s_waitcnt vmcnt(1)
    ds_write_b64 v95, v[24:25] offset:128
    ds_write_b64 v95, v[26:27] offset:400
    s_waitcnt vmcnt(0)
    ds_write_b64 v95, v[28:29] offset:192
    ds_write_b64 v95, v[30:31] offset:464
    ds_read_b128 v[32:35], v96 offset:0
    ds_read_b128 v[36:39], v96 offset:272
    ds_read_b128 v[40:43], v96 offset:544
    ds_read_b128 v[44:47], v96 offset:816
    s_waitcnt lgkmcnt(3)
    buffer_store_dwordx4 v[32:35], v102, s[52:55], s18 offen offset:0 sc1
    s_waitcnt lgkmcnt(2)
    buffer_store_dwordx4 v[36:39], v103, s[52:55], s18 offen offset:2048 sc1
    s_waitcnt lgkmcnt(1)
    buffer_store_dwordx4 v[40:43], v104, s[52:55], s19 offen offset:0 sc1
    s_waitcnt lgkmcnt(0)
    buffer_store_dwordx4 v[44:47], v105, s[52:55], s19 offen offset:2048 sc1
    s_cmp_ge_u32 s3, 2
    s_cbranch_scc1 L_FIN
L_AFT:
    s_cmp_eq_u32 s69, 1
    s_cbranch_scc1 L_GGO
    s_setprio 0
LW_16:
    s_sleep 2
    ds_read_b32 v81, v1 offset:48
    s_waitcnt lgkmcnt(0)
    v_cmp_eq_u32_e64 vcc, 0, v81
    s_cbranch_vccnz LW_16
    s_setprio 2
L_GGO:
    s_mov_b64 s[8:9], -1
    s_cmp_lt_u32 s3, 3
    s_cselect_b64 s[12:13], -1, 0
    s_add_u32 s5, s4, 0x100000
    v_mov_b32 v148, 0
    v_mov_b32 v149, 0
    v_mov_b32 v150, s56
    s_waitcnt vmcnt(0)
L_GP:
    s_cmp_eq_u64 s[8:9], 0
    s_cbranch_scc1 L_GS0
    buffer_load_dwordx3 v[144:146], v10, s[44:47], s4 offen sc1
L_GS0:
    s_cmp_eq_u64 s[12:13], 0
    s_cbranch_scc1 L_GS1
    buffer_load_dwordx3 v[148:150], v10, s[44:47], s5 offen sc1
L_GS1:
    s_add_u32 s11, s11, 1
    s_waitcnt vmcnt(0)
    v_cmp_ne_u32 s[8:9], s56, v146
    v_cmp_ne_u32 s[12:13], s56, v150
    s_or_b64 vcc, s[8:9], s[12:13]
    s_cbranch_vccz L_GOT
    s_sleep 2
    s_cmp_lt_u32 s11, 0x4000
    s_cbranch_scc1 L_GP
L_GOT:
    v_lshlrev_b32_e64 v176, 16, v144
    v_and_b32 v177, 0xffff0000, v144
    v_lshlrev_b32_e64 v178, 16, v145
    v_and_b32 v179, 0xffff0000, v145
    v_lshlrev_b32_e64 v180, 16, v148
    v_and_b32 v181, 0xffff0000, v148
    v_lshlrev_b32_e64 v182, 16, v149
    v_and_b32 v183, 0xffff0000, v149
    v_add_f32 v176, v176, v180
    v_add_f32 v177, v177, v181
    v_add_f32 v178, v178, v182
    v_add_f32 v179, v179, v183
    v_add_f32_dpp v176, v176, v176 row_ror:8 row_mask:0xf bank_mask:0xf
    v_add_f32_dpp v177, v177, v177 row_ror:8 row_mask:0xf bank_mask:0xf
    v_add_f32_dpp v178, v178, v178 row_ror:8 row_mask:0xf bank_mask:0xf
    v_add_f32_dpp v179, v179, v179 row_ror:8 row_mask:0xf bank_mask:0xf
    s_mov_b32 exec_lo, 0x00ff00ff
    s_mov_b32 exec_hi, 0x00ff00ff
    ds_add_f32 v11, v176 offset:1024
    ds_add_f32 v11, v177 offset:1028
    ds_add_f32 v11, v178 offset:1032
    ds_add_f32 v11, v179 offset:1036
    s_mov_b64 exec, 1
    ds_write_b32 v2, v5 offset:96
    s_mov_b64 exec, -1
    s_lshl_b32 s8, s60, 2
    s_add_u32 s8, s3, s8
    s_cmp_ge_u32 s8, 10
    s_cbranch_scc1 L_TILE
    s_cmp_lg_u32 s3, 0
    s_cbranch_scc1 L_FIN
LW_17:
    ds_read_b32 v81, v1 offset:48
    s_waitcnt lgkmcnt(0)
    v_cmp_eq_u32_e64 vcc, 0, v81
    s_cbranch_vccnz LW_17
    ds_read_b32 v89, v83
    v_lshlrev_b32_e64 v80, 16, v80
LW_18:
    ds_read_b32 v81, v1 offset:96
    s_waitcnt lgkmcnt(0)
    v_cmp_eq_u32_e64 vcc, 0, v81
    s_cbranch_vccnz LW_18
    ds_read_b32 v90, v84 offset:1024
    v_add_f32 v80, v80, v89
    s_waitcnt lgkmcnt(0)
    v_fma_f32 v80, v90, v15, v80
    v_cvt_pk_bf16_f32 v80, v80, v80
    s_mov_b32 exec_hi, 0
    buffer_store_short v80, v13, s[52:55], 0 offen
    s_mov_b64 exec, -1
    s_branch L_FIN
L_XSLOW:
    s_lshl_b32 s13, s57, 3
    v_lshlrev_b32_e64 v96, 8, v58
    buffer_load_dwordx2 v[64:65], v96, s[48:51], s13 offen offset:0
    buffer_load_dwordx2 v[66:67], v96, s[48:51], s13 offen offset:2048
    s_add_u32 s13, s13, 0x100000
    buffer_load_dwordx2 v[68:69], v96, s[48:51], s13 offen offset:0
    buffer_load_dwordx2 v[70:71], v96, s[48:51], s13 offen offset:2048
    s_add_u32 s13, s13, 0x100000
    buffer_load_dwordx2 v[72:73], v96, s[48:51], s13 offen offset:0
    buffer_load_dwordx2 v[74:75], v96, s[48:51], s13 offen offset:2048
    s_add_u32 s13, s13, 0x100000
    buffer_load_dwordx2 v[76:77], v96, s[48:51], s13 offen offset:0
    buffer_load_dwordx2 v[78:79], v96, s[48:51], s13 offen offset:2048
    s_add_u32 s13, s13, 0x100000
    s_cmp_eq_u32 s63, 1
    s_cbranch_scc1 L_XBACK0
    s_branch L_XBACK1
L_TRIM:
    v_subrev_u32 v236, s4, v232
    v_subrev_u32 v237, s4, v233
    v_subrev_u32 v238, s4, v234
    v_subrev_u32_e64 v239, s4, v235
    v_min3_u32 v236, v236, v237, v238
    v_min_u32 v236, v236, v239
    s_nop 1
    v_min_u32_dpp v236, v236, v236 row_shr:1 row_mask:0xf bank_mask:0xf
    s_nop 0
    s_nop 0
    v_min_u32_dpp v236, v236, v236 row_shr:2 row_mask:0xf bank_mask:0xf
    s_nop 0
    s_nop 0
    v_min_u32_dpp v236, v236, v236 row_shr:4 row_mask:0xf bank_mask:0xf
    s_nop 0
    s_nop 0
    v_min_u32_dpp v236, v236, v236 row_shr:8 row_mask:0xf bank_mask:0xf
    s_nop 0
    s_nop 0
    v_min_u32_dpp v236, v236, v236 row_bcast:15 row_mask:0xa bank_mask:0xf
    s_nop 0
    s_nop 0
    v_min_u32_dpp v236, v236, v236 row_bcast:31 row_mask:0xc bank_mask:0xf
    s_nop 0
    v_readlane_b32 s5, v236, 63
    s_add_u32 s4, s4, s5
    s_add_u32 s4, s4, 1
    s_branch L_CAND
L_SLOWT:
    v_max3_u32 v228, v232, v233, v234
    v_max_u32 v228, v228, v235
    s_mov_b32 s4, 0
    s_brev_b32 s5, 1
L_BS:
    s_or_b32 s6, s4, s5
    v_cmp_le_u32_e64 vcc, s6, v228
    s_lshr_b32 s5, s5, 1
    s_bcnt1_i32_b64 s7, vcc
    s_cmp_ge_u32 s7, 8
    s_cselect_b32 s4, s6, s4
    s_cmp_lg_u32 s7, 8
    s_cbranch_scc1 L_BS
    v_mbcnt_lo_u32_b32 v229, vcc_lo, 0
    v_mbcnt_hi_u32_b32 v229, vcc_hi, v229
    v_lshlrev_b32 v229, 2, v229
    s_mov_b64 exec, vcc
    ds_write_b32 v229, v0 offset:320
    s_mov_b64 exec, -1
    v_lshrrev_b32 v230, 3, v0
    v_lshlrev_b32_e64 v230, 2, v230
    ds_read_b32 v229, v230 offset:320
    s_waitcnt lgkmcnt(0)
    v_and_b32 v230, 7, v0
    v_lshl_add_u32 v229, v229, 3, v230
    v_lshlrev_b32_e64 v230, 3, v229
    ds_read_b64 v[226:227], v230 offset:4096
    v_and_b32 v230, 1, v229
    v_and_b32 v229, -2, v229
    v_lshl_add_u32 v229, v230, 10, v229
    v_sub_u32 v232, 0xfff, v229
    v_sub_u32 v233, 0xffe, v229
    v_sub_u32 v234, 0xdff, v229
    v_sub_u32 v235, 0xdfe, v229
    s_mov_b32 s5, 0xffff0000
    s_waitcnt lgkmcnt(0)
    v_lshl_or_b32 v232, v226, 16, v232
    v_and_or_b32 v233, v226, s5, v233
    v_lshl_or_b32 v234, v227, 16, v234
    v_and_or_b32 v235, v227, s5, v235
    s_branch L_CAND
L_FIN:
L_END:
    s_endpgm
.section .rodata,"a"
.p2align 6
.amdhsa_kernel parallel_sum__ssm_conv_s4d__moe_arch_mod__prompt_kernel
  .amdhsa_next_free_vgpr 256
  .amdhsa_next_free_sgpr 102
  .amdhsa_accum_offset 256
  .amdhsa_group_segment_fixed_size 0
  .amdhsa_kernarg_size 120
  .amdhsa_user_sgpr_count 2
  .amdhsa_user_sgpr_kernarg_segment_ptr 1
  .amdhsa_system_sgpr_workgroup_id_x 1
  .amdhsa_float_denorm_mode_32 3
.end_amdhsa_kernel
```

```asm
; @launch grid=(256,1,1) block=(512,1,1) lds=156672
.amdgcn_target "amdgcn-amd-amdhsa--gfx950"
.text
.globl parallel_sum__ssm_conv_s4d__moe_arch_mod__prompt_kernel
.p2align 8
.type parallel_sum__ssm_conv_s4d__moe_arch_mod__prompt_kernel,@function
parallel_sum__ssm_conv_s4d__moe_arch_mod__prompt_kernel:
    s_cmp_ge_u32 s2, 256
    s_cbranch_scc1 L_END
    s_load_dwordx16 s[16:31], s[0:1], 0
    s_load_dwordx8 s[32:39], s[0:1], 64
    s_load_dwordx2 s[40:41], s[0:1], 96
    s_load_dwordx2 s[42:43], s[0:1], 112
    s_getpc_b64 s[14:15]
    v_lshrrev_b32_e64 v1, 6, v0
    v_and_b32 v10, 255, v0
    v_and_b32 v0, 63, v0
    v_readfirstlane_b32 s3, v1
    v_lshlrev_b32 v1, 2, v0
    v_mov_b32 v2, 0
    ds_write2st64_b32 v1, v2, v2 offset0:0 offset1:2
    s_and_b32 s5, s2, 7
    s_lshr_b32 s6, s2, 3
    s_lshl_b32 s57, s5, 5
    s_add_u32 s57, s57, s6
    s_and_b32 s58, s3, 3
    s_lshl_b32 s7, s57, 2
    s_add_u32 s7, s7, s58
    s_lshl_b32 s7, s7, 8
    v_add_u32_e64 v15, s7, v1
    s_mov_b32 s60, 0
    s_lshl_b32 s4, s57, 3
    s_cmp_lt_u32 s3, 4
    s_cbranch_scc1 L_F0
    s_and_b32 s8, s6, 15
    s_lshl_b32 s8, s8, 2
    s_add_u32 s8, s8, s58
    s_lshl_b32 s8, s8, 9
    v_lshl_add_u32 v2, v0, 7, s8
    v_min_u32 v2, L_END-parallel_sum__ssm_conv_s4d__moe_arch_mod__prompt_kernel-128, v2
    s_mov_b64 exec, 0xf
    global_load_dword v255, v2, s[14:15]
    s_mov_b64 exec, -1
    v_lshlrev_b32 v3, 12, v10
    v_add_u32_e64 v3, s4, v3
    s_waitcnt lgkmcnt(0)
    global_load_dword v224, v15, s[18:19]
    global_load_dword v225, v15, s[20:21]
    global_load_dword v226, v15, s[22:23]
    global_load_dword v227, v15, s[24:25]
    s_add_u32 s6, s26, s4
    s_addc_u32 s7, s27, 0
    s_load_dwordx2 s[64:65], s[6:7], 0
    s_add_u32 s6, s28, s4
    s_addc_u32 s7, s29, 0
    s_load_dwordx2 s[66:67], s[6:7], 0
    s_barrier
    s_mov_b32 s61, 0x100000
    s_mov_b32 s62, 0x200000
    s_mov_b32 s63, 0x300000
    s_mov_b32 s44, s42
    s_and_b32 s45, s43, 0xffff
    s_mov_b32 s46, 0x1000000
    s_mov_b32 s47, 0x20000
    s_mov_b32 s48, s16
    s_and_b32 s49, s17, 0xffff
    s_mov_b32 s50, 0x400000
    s_mov_b32 s51, 0x20000
    s_mov_b32 s52, s40
    s_and_b32 s53, s41, 0xffff
    s_mov_b32 s54, 0x400000
    s_mov_b32 s55, 0x20000
    s_setprio 2
    s_nop 0
    s_mul_i32 s8, s58, 17408
    s_add_u32 s8, s8, 52224
    s_mul_i32 s10, s58, 4608
    s_add_u32 s10, s10, 121856
    s_mul_i32 s11, s58, 8704
    s_add_u32 s11, s11, 17408
    s_movk_i32 s9, 544
    s_sub_u32 m0, s8, 48064
    v_lshl_add_u32 v15, v0, 3, s10
    v_and_b32 v16, 15, v0
    v_lshrrev_b32 v17, 4, v0
    v_lshlrev_b32 v18, 4, v17
    v_mad_u32_u24 v12, v16, s9, v18
    v_add_u32 v14, s11, v12
    v_add_u32 v12, s8, v12
    v_add_u32 v11, s8, v18
    v_cmp_gt_u32 vcc, 3, v16
    s_nop 0
    s_nop 0
    v_cndmask_b32 v19, 12, 4, vcc
    v_cmp_eq_u32 vcc, 3, v16
    s_nop 1
    v_cndmask_b32 v19, v19, 28, vcc
    v_mad_u32_u24 v13, v19, s9, v12
    v_and_b32_e64 v20, 3, v16
    s_sub_u32 s11, s11, 17408
    s_lshl_b32 s4, s58, 2
    v_mov_b32 v4, s4
    v_mov_b32 v5, 1
    v_lshlrev_b32 v6, 2, v20
    s_movk_i32 s9, 2368
    v_lshrrev_b32 v18, 2, v0
    v_lshl_add_u32 v19, v20, 3, s8
    v_mad_u32_u24 v200, v18, s9, v19
    s_movk_i32 s4, 160
    v_mad_u32_u24 v202, v18, s4, v19
    v_lshrrev_b32 v18, 3, v0
    v_and_b32_e64 v19, 7, v0
    v_lshl_add_u32 v19, v19, 3, s8
    v_mad_u32_u24 v201, v18, s9, v19
    v_lshrrev_b32 v18, 5, v0
    v_lshlrev_b32 v18, 8, v18
    v_lshl_add_u32 v18, v16, 4, v18
    v_add_u32 v18, s8, v18
    v_and_b32 v19, 1, v17
    v_lshl_add_u32 v203, v19, 3, v18
    v_lshl_add_u32 v46, v19, 9, v18
    v_and_b32 v18, 1, v16
    s_movk_i32 s4, 640
    v_mul_u32_u24_e64 v18, s4, v18
    v_lshl_add_u32 v18, v17, 5, v18
    v_and_b32_e64 v19, 14, v16
    v_add3_u32 v47, v18, v19, s8
    v_mov_b32 v35, s8
    v_mov_b32 v252, 0
    v_mov_b32 v253, 0
    v_lshlrev_b32 v7, 4, v17
    v_lshlrev_b32 v18, 5, v16
    v_sub_u32 v7, v7, v18
    s_add_u32 s4, s10, 480
    v_add_u32 v7, s4, v7
    s_lshl_b32 s4, s58, 13
    s_add_u32 s4, s4, 17408
    v_lshlrev_b32_e64 v18, 6, v16
    v_lshl_add_u32 v18, v17, 4, v18
    v_add_u32 v8, s4, v18
    v_sub_u32 v22, 20, v16
    v_lshlrev_b32_e64 v23, 3, v17
    v_mov_b32 v24, 0x7f
    v_lshlrev_b32 v24, v22, v24
    v_subrev_u32 v22, 1, v22
    v_mov_b32 v25, 0x1ff
    v_lshlrev_b32 v25, v22, v25
    v_lshrrev_b32 v24, v23, v24
    v_lshrrev_b32 v25, v23, v25
    v_add_u32 v18, 1, v16
    v_and_b32 v22, 3, v18
    v_and_b32 v18, 28, v18
    v_lshl_add_u32 v26, v17, 3, v18
    v_lshl_add_u32 v26, v26, 1, s8
    v_mad_u32_u24 v1, v22, s9, v26
    v_lshlrev_b32 v26, 2, v17
    v_sub_u32 v18, v18, v26
    v_lshl_add_u32 v18, v18, 1, s8
    s_movk_i32 s4, 160
    v_mad_u32_u24 v2, v22, s4, v18
    s_mov_b32 s15, 0x3f800000
    v_bfe_i32 v27, v24, 0, 1
    v_bfe_i32 v28, v24, 1, 1
    v_and_b32 v27, 0x3f80, v27
    v_bfi_b32 v244, s15, v28, v27
    v_bfe_i32 v27, v24, 2, 1
    v_bfe_i32 v28, v24, 3, 1
    v_and_b32 v27, 0x3f80, v27
    v_bfi_b32 v245, s15, v28, v27
    v_bfe_i32 v27, v24, 4, 1
    v_bfe_i32 v28, v24, 5, 1
    v_and_b32 v27, 0x3f80, v27
    v_bfi_b32 v246, s15, v28, v27
    v_bfe_i32 v27, v24, 6, 1
    v_bfe_i32 v28, v24, 7, 1
    v_and_b32 v27, 0x3f80, v27
    v_bfi_b32 v247, s15, v28, v27
    v_bfe_i32 v27, v25, 0, 1
    v_bfe_i32 v28, v25, 1, 1
    v_and_b32 v27, 0x3f80, v27
    v_bfi_b32 v248, s15, v28, v27
    v_bfe_i32 v27, v25, 2, 1
    v_bfe_i32 v28, v25, 3, 1
    v_and_b32 v27, 0x3f80, v27
    v_bfi_b32 v249, s15, v28, v27
    v_bfe_i32 v27, v25, 4, 1
    v_bfe_i32 v28, v25, 5, 1
    v_and_b32 v27, 0x3f80, v27
    v_bfi_b32 v250, s15, v28, v27
    v_bfe_i32 v27, v25, 6, 1
    v_bfe_i32 v28, v25, 7, 1
    v_and_b32 v27, 0x3f80, v27
    v_bfi_b32 v251, s15, v28, v27
    v_lshlrev_b32 v33, 4, v10
    v_lshlrev_b32 v32, 2, v10
    v_sub_u32 v32, 122876, v32
    s_and_b32 s31, s2, 7
    s_lshl_b32 s31, s31, 2
    s_add_u32 s31, s31, s58
    s_lshl_b32 s31, s31, 7
    s_add_u32 s31, s31, 983040
    s_lshl_b32 s13, s57, 14
    s_add_u32 s13, s13, 3145728
    s_and_b32 s12, s2, 7
    s_lshl_b32 s12, s12, 11
    s_lshl_b32 s4, s58, 7
    s_add_u32 s12, s12, s4
    s_lshr_b32 s4, s2, 3
    s_lshl_b32 s4, s4, 2
    s_add_u32 s12, s12, s4
    s_add_u32 s12, s12, 1015808
    v_lshlrev_b32_e64 v10, 3, v10
    v_add_u32 v9, 17408, v10
    s_brev_b32 s68, 1
    s_waitcnt lgkmcnt(0)
    s_lshl_b32 s4, s58, 4
    s_lshr_b64 s[6:7], s[64:65], s4
    s_lshl_b32 s6, s6, 16
    v_mov_b32 v228, s6
    v_mul_f32 v228, 0x3fb8aa3b, v228
    v_exp_f32 v228, v228
    s_nop 0
    v_cvt_pk_bf16_f32 v228, v228, v228
    v_and_b32 v228, 0xffff0000, v228
    s_lshl_b32 s4, s58, 12
    v_lshl_add_u32 v254, v0, 7, s4
    s_waitcnt vmcnt(0)
    s_mov_b32 exec_hi, 0
    buffer_load_dword v255, v254, s[44:47], s13 offen
    s_mov_b32 exec_hi, -1
    v_lshlrev_b32_e64 v236, 16, v224
    v_and_b32 v237, 0xffff0000, v224
    v_lshlrev_b32_e64 v238, 16, v225
    v_and_b32 v239, 0xffff0000, v225
    v_mul_f32 v236, 0x3fb8aa3b, v236
    v_mul_f32 v237, 0x3fb8aa3b, v237
    v_exp_f32 v236, v236
    v_exp_f32 v237, v237
    v_mul_f32 v238, v238, v228
    v_mul_f32 v239, v239, v228
    v_mul_f32 v232, 0x3e22f983, v238
    v_mul_f32 v233, 0x3e22f983, v239
    v_cvt_pk_bf16_f32 v238, v236, v237
    v_lshlrev_b32_e64 v236, 16, v238
    v_and_b32 v237, 0xffff0000, v238
    v_mul_f32 v236, v236, v228
    v_mul_f32 v237, v237, v228
    v_mul_f32 v230, 0xbfb8aa3b, v236
    v_mul_f32 v231, 0xbfb8aa3b, v237
    v_add_f32_e64 v228, v228, v228
    v_mul_f32 v28, 0x42000000, v230
    v_mul_f32 v30, 0x42000000, v232
    v_mul_f32 v29, 0x42000000, v231
    v_mul_f32 v31, 0x42000000, v233
    v_exp_f32 v20, v230
    v_fract_f32 v22, v232
    v_exp_f32 v28, v28
    v_fract_f32 v30, v30
    v_exp_f32 v21, v231
    v_fract_f32 v23, v233
    v_exp_f32 v29, v29
    v_fract_f32 v31, v31
    v_cos_f32 v16, v22
    v_lshlrev_b32 v240, 16, v226
    v_sin_f32_e64 v17, v22
    v_and_b32 v242, 0xffff0000, v226
    v_cos_f32 v18, v23
    v_lshlrev_b32 v241, 16, v227
    v_sin_f32_e64 v19, v23
    v_and_b32 v243, 0xffff0000, v227
    v_cos_f32 v24, v30
    v_mul_f32 v240, v240, v228
    v_sin_f32 v25, v30
    v_mul_f32 v241, v241, v228
    v_cos_f32 v26, v31
    v_mul_f32 v242, v242, v228
    v_sin_f32 v27, v31
    v_mul_f32 v243, v243, v228
    v_mul_f32 v16, v16, v20
    v_mul_f32 v17, v17, v20
    v_mul_f32 v18, v18, v21
    v_mul_f32 v19, v19, v21
    v_mul_f32 v24, v24, v28
    v_mul_f32 v25, v25, v28
    v_mul_f32 v26, v26, v29
    v_mul_f32 v27, v27, v29
    v_mov_b32 v112, 0x3c00
    v_mov_b32 v113, 0x3c00
    v_pk_mul_f32 v[20:21], v[16:17], v[16:17] op_sel_hi:[1,0]
    v_pk_mul_f32 v[22:23], v[18:19], v[18:19] op_sel_hi:[1,0]
    v_pk_mul_f32 v[28:29], v[24:25], v[24:25] op_sel_hi:[1,0]
    v_pk_mul_f32 v[30:31], v[26:27], v[26:27] op_sel_hi:[1,0]
    v_cvt_pk_f16_f32 v114, v16, v17
    v_cvt_pk_f16_f32 v115, v18, v19
    v_cvt_pk_f16_f32 v40, v24, v25
    v_cvt_pk_f16_f32 v41, v26, v27
    v_pk_fma_f32 v[16:17], v[16:17], v[16:17], v[20:21] op_sel:[1,1,0] op_sel_hi:[0,1,1] neg_lo:[1,0,0]
    v_pk_fma_f32 v[18:19], v[18:19], v[18:19], v[22:23] op_sel:[1,1,0] op_sel_hi:[0,1,1] neg_lo:[1,0,0]
    v_pk_fma_f32 v[24:25], v[24:25], v[24:25], v[28:29] op_sel:[1,1,0] op_sel_hi:[0,1,1] neg_lo:[1,0,0]
    v_pk_fma_f32 v[26:27], v[26:27], v[26:27], v[30:31] op_sel:[1,1,0] op_sel_hi:[0,1,1] neg_lo:[1,0,0]
    v_pk_mul_f32 v[20:21], v[16:17], v[16:17] op_sel_hi:[1,0]
    v_pk_mul_f32 v[22:23], v[18:19], v[18:19] op_sel_hi:[1,0]
    v_pk_mul_f32 v[28:29], v[24:25], v[24:25] op_sel_hi:[1,0]
    v_pk_mul_f32 v[30:31], v[26:27], v[26:27] op_sel_hi:[1,0]
    v_cvt_pk_f16_f32 v116, v16, v17
    v_cvt_pk_f16_f32 v117, v18, v19
    v_cvt_pk_f16_f32 v42, v24, v25
    v_cvt_pk_f16_f32 v43, v26, v27
    v_pk_fma_f32 v[16:17], v[16:17], v[16:17], v[20:21] op_sel:[1,1,0] op_sel_hi:[0,1,1] neg_lo:[1,0,0]
    v_pk_fma_f32 v[18:19], v[18:19], v[18:19], v[22:23] op_sel:[1,1,0] op_sel_hi:[0,1,1] neg_lo:[1,0,0]
    v_pk_fma_f32 v[24:25], v[24:25], v[24:25], v[28:29] op_sel:[1,1,0] op_sel_hi:[0,1,1] neg_lo:[1,0,0]
    v_pk_fma_f32 v[26:27], v[26:27], v[26:27], v[30:31] op_sel:[1,1,0] op_sel_hi:[0,1,1] neg_lo:[1,0,0]
    v_cvt_pk_f16_f32 v80, v240, -v241
    v_cvt_pk_f16_f32 v81, v242, -v243
    v_pk_mul_f32 v[20:21], v[16:17], v[16:17] op_sel_hi:[1,0]
    v_pk_mul_f32 v[22:23], v[18:19], v[18:19] op_sel_hi:[1,0]
    v_pk_mul_f32 v[28:29], v[24:25], v[24:25] op_sel_hi:[1,0]
    v_pk_mul_f32 v[30:31], v[26:27], v[26:27] op_sel_hi:[1,0]
    v_cvt_pk_f16_f32 v120, v16, v17
    v_cvt_pk_f16_f32 v121, v18, v19
    v_cvt_pk_f16_f32 v44, v24, v25
    v_cvt_pk_f16_f32 v45, v26, v27
    v_pk_fma_f32 v[16:17], v[16:17], v[16:17], v[20:21] op_sel:[1,1,0] op_sel_hi:[0,1,1] neg_lo:[1,0,0]
    v_pk_fma_f32 v[18:19], v[18:19], v[18:19], v[22:23] op_sel:[1,1,0] op_sel_hi:[0,1,1] neg_lo:[1,0,0]
    v_pk_fma_f32 v[24:25], v[24:25], v[24:25], v[28:29] op_sel:[1,1,0] op_sel_hi:[0,1,1] neg_lo:[1,0,0]
    v_pk_fma_f32 v[26:27], v[26:27], v[26:27], v[30:31] op_sel:[1,1,0] op_sel_hi:[0,1,1] neg_lo:[1,0,0]
    v_pk_mul_f16 v118, v116, v114 op_sel_hi:[1,0]
    v_pk_mul_f16 v119, v117, v115 op_sel_hi:[1,0]
    v_pk_mul_f16 v122, v120, v114 op_sel_hi:[1,0]
    v_pk_mul_f16 v123, v121, v115 op_sel_hi:[1,0]
    v_pk_fma_f16 v118, v116, v114, v118 op_sel:[1,1,0] op_sel_hi:[0,1,1] neg_lo:[1,0,0]
    v_pk_fma_f16 v119, v117, v115, v119 op_sel:[1,1,0] op_sel_hi:[0,1,1] neg_lo:[1,0,0]
    v_pk_fma_f16 v122, v120, v114, v122 op_sel:[1,1,0] op_sel_hi:[0,1,1] neg_lo:[1,0,0]
    v_pk_fma_f16 v123, v121, v115, v123 op_sel:[1,1,0] op_sel_hi:[0,1,1] neg_lo:[1,0,0]
    v_pk_mul_f32 v[20:21], v[16:17], v[16:17] op_sel_hi:[1,0]
    v_pk_mul_f32 v[22:23], v[18:19], v[18:19] op_sel_hi:[1,0]
    v_cvt_pk_f16_f32 v128, v16, v17
    v_cvt_pk_f16_f32 v129, v18, v19
    v_cvt_pk_f16_f32 v134, v24, v25
    v_cvt_pk_f16_f32 v135, v26, v27
    v_pk_fma_f32 v[16:17], v[16:17], v[16:17], v[20:21] op_sel:[1,1,0] op_sel_hi:[0,1,1] neg_lo:[1,0,0]
    v_pk_fma_f32 v[18:19], v[18:19], v[18:19], v[22:23] op_sel:[1,1,0] op_sel_hi:[0,1,1] neg_lo:[1,0,0]
    ds_write_addtid_b32 v112 offset:48064
    ds_write_addtid_b32 v113 offset:48320
    ds_write_addtid_b32 v114 offset:48608
    ds_write_addtid_b32 v115 offset:48864
    ds_write_addtid_b32 v116 offset:49152
    ds_write_addtid_b32 v117 offset:49408
    ds_write_addtid_b32 v120 offset:50240
    ds_write_addtid_b32 v121 offset:50496
    ds_write_addtid_b32 v118 offset:49696
    ds_write_addtid_b32 v119 offset:49952
    ds_write_addtid_b32 v122 offset:50784
    ds_write_addtid_b32 v123 offset:51040
    ds_write_addtid_b32 v128 offset:56768
    ds_write_addtid_b32 v129 offset:57024
    ds_write_addtid_b32 v134 offset:52416
    ds_write_addtid_b32 v135 offset:52672
    ds_write_addtid_b32 v44 offset:63296
    ds_write_addtid_b32 v45 offset:63552
    v_pk_mul_f16 v124, v120, v116 op_sel_hi:[1,0]
    v_pk_mul_f16 v125, v121, v117 op_sel_hi:[1,0]
    v_pk_mul_f16 v126, v120, v118 op_sel_hi:[1,0]
    v_pk_mul_f16 v127, v121, v119 op_sel_hi:[1,0]
    v_pk_fma_f16 v124, v120, v116, v124 op_sel:[1,1,0] op_sel_hi:[0,1,1] neg_lo:[1,0,0]
    v_pk_fma_f16 v125, v121, v117, v125 op_sel:[1,1,0] op_sel_hi:[0,1,1] neg_lo:[1,0,0]
    v_pk_fma_f16 v126, v120, v118, v126 op_sel:[1,1,0] op_sel_hi:[0,1,1] neg_lo:[1,0,0]
    v_pk_fma_f16 v127, v121, v119, v127 op_sel:[1,1,0] op_sel_hi:[0,1,1] neg_lo:[1,0,0]
    v_pk_mul_f16 v132, v128, v116 op_sel_hi:[1,0]
    v_pk_mul_f16 v133, v129, v117 op_sel_hi:[1,0]
    v_pk_mul_f16 v136, v134, v116 op_sel_hi:[1,0]
    v_pk_mul_f16 v137, v135, v117 op_sel_hi:[1,0]
    v_pk_fma_f16 v132, v128, v116, v132 op_sel:[1,1,0] op_sel_hi:[0,1,1] neg_lo:[1,0,0]
    v_pk_fma_f16 v133, v129, v117, v133 op_sel:[1,1,0] op_sel_hi:[0,1,1] neg_lo:[1,0,0]
    v_pk_fma_f16 v136, v134, v116, v136 op_sel:[1,1,0] op_sel_hi:[0,1,1] neg_lo:[1,0,0]
    v_pk_fma_f16 v137, v135, v117, v137 op_sel:[1,1,0] op_sel_hi:[0,1,1] neg_lo:[1,0,0]
    v_pk_mul_f16 v138, v134, v120 op_sel_hi:[1,0]
    v_pk_mul_f16 v139, v135, v121 op_sel_hi:[1,0]
    v_pk_mul_f16 v140, v134, v124 op_sel_hi:[1,0]
    v_pk_mul_f16 v141, v135, v125 op_sel_hi:[1,0]
    v_pk_fma_f16 v138, v134, v120, v138 op_sel:[1,1,0] op_sel_hi:[0,1,1] neg_lo:[1,0,0]
    v_pk_fma_f16 v139, v135, v121, v139 op_sel:[1,1,0] op_sel_hi:[0,1,1] neg_lo:[1,0,0]
    v_pk_fma_f16 v140, v134, v124, v140 op_sel:[1,1,0] op_sel_hi:[0,1,1] neg_lo:[1,0,0]
    v_pk_fma_f16 v141, v135, v125, v141 op_sel:[1,1,0] op_sel_hi:[0,1,1] neg_lo:[1,0,0]
    v_pk_mul_f16 v142, v134, v128 op_sel_hi:[1,0]
    v_pk_mul_f16 v143, v135, v129 op_sel_hi:[1,0]
    v_pk_mul_f16 v144, v134, v132 op_sel_hi:[1,0]
    v_pk_mul_f16 v145, v135, v133 op_sel_hi:[1,0]
    v_pk_fma_f16 v142, v134, v128, v142 op_sel:[1,1,0] op_sel_hi:[0,1,1] neg_lo:[1,0,0]
    v_pk_fma_f16 v143, v135, v129, v143 op_sel:[1,1,0] op_sel_hi:[0,1,1] neg_lo:[1,0,0]
    v_pk_fma_f16 v144, v134, v132, v144 op_sel:[1,1,0] op_sel_hi:[0,1,1] neg_lo:[1,0,0]
    v_pk_fma_f16 v145, v135, v133, v145 op_sel:[1,1,0] op_sel_hi:[0,1,1] neg_lo:[1,0,0]
    ds_write_addtid_b32 v124 offset:51328
    ds_write_addtid_b32 v125 offset:51584
    ds_write_addtid_b32 v126 offset:51872
    ds_write_addtid_b32 v127 offset:52128
    ds_write_addtid_b32 v132 offset:57856
    ds_write_addtid_b32 v133 offset:58112
    ds_write_addtid_b32 v136 offset:52960
    ds_write_addtid_b32 v137 offset:53216
    ds_write_addtid_b32 v138 offset:53504
    ds_write_addtid_b32 v139 offset:53760
    ds_write_addtid_b32 v138 offset:54592
    ds_write_addtid_b32 v139 offset:54848
    ds_write_addtid_b32 v140 offset:54048
    ds_write_addtid_b32 v141 offset:54304
    ds_write_addtid_b32 v140 offset:55136
    ds_write_addtid_b32 v141 offset:55392
    ds_write_addtid_b32 v142 offset:55680
    ds_write_addtid_b32 v143 offset:55936
    ds_write_addtid_b32 v144 offset:56224
    ds_write_addtid_b32 v145 offset:56480
    ds_read_b128 v[168:171], v12 offset:0
    ds_read_b128 v[172:175], v12 offset:64
    ds_read_b128 v[176:179], v12 offset:128
    ds_read_b128 v[180:183], v12 offset:192
    ds_read_b128 v[184:187], v12 offset:256
    ds_read_b128 v[188:191], v12 offset:320
    ds_read_b128 v[192:195], v12 offset:384
    ds_read_b128 v[196:199], v12 offset:448
    s_mov_b32 m0, s11
    s_nop 0
    v_cvt_pk_f16_f32 v38, v16, v17
    v_cvt_pk_f16_f32 v39, v18, v19
    v_pk_mul_f16 v82, v80, v128 op_sel_hi:[1,0]
    v_pk_mul_f16 v83, v81, v129 op_sel_hi:[1,0]
    v_pk_mul_f16 v88, v80, v40 op_sel_hi:[1,0]
    v_pk_mul_f16 v89, v81, v41 op_sel_hi:[1,0]
    v_pk_fma_f16 v82, v80, v128, v82 op_sel:[1,1,0] op_sel_hi:[0,1,1] neg_hi:[1,0,0]
    v_pk_fma_f16 v83, v81, v129, v83 op_sel:[1,1,0] op_sel_hi:[0,1,1] neg_hi:[1,0,0]
    v_pk_fma_f16 v88, v80, v40, v88 op_sel:[1,1,0] op_sel_hi:[0,1,1] neg_hi:[1,0,0]
    v_pk_fma_f16 v89, v81, v41, v89 op_sel:[1,1,0] op_sel_hi:[0,1,1] neg_hi:[1,0,0]
    v_pk_mul_f16 v84, v80, v38 op_sel_hi:[1,0]
    v_pk_mul_f16 v85, v81, v39 op_sel_hi:[1,0]
    v_pk_mul_f16 v86, v82, v38 op_sel_hi:[1,0]
    v_pk_mul_f16 v87, v83, v39 op_sel_hi:[1,0]
    v_pk_fma_f16 v84, v80, v38, v84 op_sel:[1,1,0] op_sel_hi:[0,1,1] neg_hi:[1,0,0]
    v_pk_fma_f16 v85, v81, v39, v85 op_sel:[1,1,0] op_sel_hi:[0,1,1] neg_hi:[1,0,0]
    v_pk_fma_f16 v86, v82, v38, v86 op_sel:[1,1,0] op_sel_hi:[0,1,1] neg_hi:[1,0,0]
    v_pk_fma_f16 v87, v83, v39, v87 op_sel:[1,1,0] op_sel_hi:[0,1,1] neg_hi:[1,0,0]
    v_pk_mul_f16 v90, v82, v40 op_sel_hi:[1,0]
    v_pk_mul_f16 v91, v83, v41 op_sel_hi:[1,0]
    v_pk_mul_f16 v96, v80, v42 op_sel_hi:[1,0]
    v_pk_mul_f16 v97, v81, v43 op_sel_hi:[1,0]
    v_pk_fma_f16 v90, v82, v40, v90 op_sel:[1,1,0] op_sel_hi:[0,1,1] neg_hi:[1,0,0]
    v_pk_fma_f16 v91, v83, v41, v91 op_sel:[1,1,0] op_sel_hi:[0,1,1] neg_hi:[1,0,0]
    v_pk_fma_f16 v96, v80, v42, v96 op_sel:[1,1,0] op_sel_hi:[0,1,1] neg_hi:[1,0,0]
    v_pk_fma_f16 v97, v81, v43, v97 op_sel:[1,1,0] op_sel_hi:[0,1,1] neg_hi:[1,0,0]
    v_pk_mul_f16 v92, v84, v40 op_sel_hi:[1,0]
    v_pk_mul_f16 v93, v85, v41 op_sel_hi:[1,0]
    v_pk_mul_f16 v94, v86, v40 op_sel_hi:[1,0]
    v_pk_mul_f16 v95, v87, v41 op_sel_hi:[1,0]
    v_pk_fma_f16 v92, v84, v40, v92 op_sel:[1,1,0] op_sel_hi:[0,1,1] neg_hi:[1,0,0]
    v_pk_fma_f16 v93, v85, v41, v93 op_sel:[1,1,0] op_sel_hi:[0,1,1] neg_hi:[1,0,0]
    v_pk_fma_f16 v94, v86, v40, v94 op_sel:[1,1,0] op_sel_hi:[0,1,1] neg_hi:[1,0,0]
    v_pk_fma_f16 v95, v87, v41, v95 op_sel:[1,1,0] op_sel_hi:[0,1,1] neg_hi:[1,0,0]
    ds_write_addtid_b32 v80 offset:17408
    ds_write_addtid_b32 v81 offset:17664
    ds_write_addtid_b32 v82 offset:17952
    ds_write_addtid_b32 v83 offset:18208
    ds_write_addtid_b32 v84 offset:18496
    ds_write_addtid_b32 v85 offset:18752
    ds_write_addtid_b32 v86 offset:19040
    ds_write_addtid_b32 v87 offset:19296
    ds_write_addtid_b32 v88 offset:19584
    ds_write_addtid_b32 v89 offset:19840
    ds_write_addtid_b32 v90 offset:20128
    ds_write_addtid_b32 v91 offset:20384
    ds_write_addtid_b32 v92 offset:20672
    ds_write_addtid_b32 v93 offset:20928
    ds_write_addtid_b32 v94 offset:21216
    ds_write_addtid_b32 v95 offset:21472
    ds_write_addtid_b32 v96 offset:21760
    ds_write_addtid_b32 v97 offset:22016
    v_pk_mul_f16 v98, v82, v42 op_sel_hi:[1,0]
    v_pk_mul_f16 v99, v83, v43 op_sel_hi:[1,0]
    v_pk_mul_f16 v104, v88, v42 op_sel_hi:[1,0]
    v_pk_mul_f16 v105, v89, v43 op_sel_hi:[1,0]
    v_pk_fma_f16 v98, v82, v42, v98 op_sel:[1,1,0] op_sel_hi:[0,1,1] neg_hi:[1,0,0]
    v_pk_fma_f16 v99, v83, v43, v99 op_sel:[1,1,0] op_sel_hi:[0,1,1] neg_hi:[1,0,0]
    v_pk_fma_f16 v104, v88, v42, v104 op_sel:[1,1,0] op_sel_hi:[0,1,1] neg_hi:[1,0,0]
    v_pk_fma_f16 v105, v89, v43, v105 op_sel:[1,1,0] op_sel_hi:[0,1,1] neg_hi:[1,0,0]
    v_pk_mul_f16 v100, v84, v42 op_sel_hi:[1,0]
    v_pk_mul_f16 v101, v85, v43 op_sel_hi:[1,0]
    v_pk_mul_f16 v102, v86, v42 op_sel_hi:[1,0]
    v_pk_mul_f16 v103, v87, v43 op_sel_hi:[1,0]
    v_pk_fma_f16 v100, v84, v42, v100 op_sel:[1,1,0] op_sel_hi:[0,1,1] neg_hi:[1,0,0]
    v_pk_fma_f16 v101, v85, v43, v101 op_sel:[1,1,0] op_sel_hi:[0,1,1] neg_hi:[1,0,0]
    v_pk_fma_f16 v102, v86, v42, v102 op_sel:[1,1,0] op_sel_hi:[0,1,1] neg_hi:[1,0,0]
    v_pk_fma_f16 v103, v87, v43, v103 op_sel:[1,1,0] op_sel_hi:[0,1,1] neg_hi:[1,0,0]
    v_pk_mul_f16 v106, v90, v42 op_sel_hi:[1,0]
    v_pk_mul_f16 v107, v91, v43 op_sel_hi:[1,0]
    v_pk_mul_f16 v108, v92, v42 op_sel_hi:[1,0]
    v_pk_mul_f16 v109, v93, v43 op_sel_hi:[1,0]
    v_pk_fma_f16 v106, v90, v42, v106 op_sel:[1,1,0] op_sel_hi:[0,1,1] neg_hi:[1,0,0]
    v_pk_fma_f16 v107, v91, v43, v107 op_sel:[1,1,0] op_sel_hi:[0,1,1] neg_hi:[1,0,0]
    v_pk_fma_f16 v108, v92, v42, v108 op_sel:[1,1,0] op_sel_hi:[0,1,1] neg_hi:[1,0,0]
    v_pk_fma_f16 v109, v93, v43, v109 op_sel:[1,1,0] op_sel_hi:[0,1,1] neg_hi:[1,0,0]
    v_pk_mul_f16 v110, v94, v42 op_sel_hi:[1,0]
    v_pk_mul_f16 v111, v95, v43 op_sel_hi:[1,0]
    v_pk_mul_f16 v130, v128, v114 op_sel_hi:[1,0]
    v_pk_mul_f16 v131, v129, v115 op_sel_hi:[1,0]
    v_pk_fma_f16 v110, v94, v42, v110 op_sel:[1,1,0] op_sel_hi:[0,1,1] neg_hi:[1,0,0]
    v_pk_fma_f16 v111, v95, v43, v111 op_sel:[1,1,0] op_sel_hi:[0,1,1] neg_hi:[1,0,0]
    v_pk_fma_f16 v130, v128, v114, v130 op_sel:[1,1,0] op_sel_hi:[0,1,1] neg_lo:[1,0,0]
    v_pk_fma_f16 v131, v129, v115, v131 op_sel:[1,1,0] op_sel_hi:[0,1,1] neg_lo:[1,0,0]
    ds_write_addtid_b32 v98 offset:22304
    ds_write_addtid_b32 v99 offset:22560
    ds_write_addtid_b32 v100 offset:22848
    ds_write_addtid_b32 v101 offset:23104
    ds_write_addtid_b32 v102 offset:23392
    ds_write_addtid_b32 v103 offset:23648
    ds_write_addtid_b32 v104 offset:23936
    ds_write_addtid_b32 v105 offset:24192
    ds_write_addtid_b32 v106 offset:24480
    ds_write_addtid_b32 v107 offset:24736
    ds_write_addtid_b32 v108 offset:25024
    ds_write_addtid_b32 v109 offset:25280
    ds_write_addtid_b32 v110 offset:25568
    ds_write_addtid_b32 v111 offset:25824
    ds_read_b128 v[48:51], v14 offset:0
    ds_read_b128 v[52:55], v14 offset:64
    ds_read_b128 v[56:59], v14 offset:128
    ds_read_b128 v[60:63], v14 offset:192
    ds_read_b128 v[64:67], v14 offset:256
    ds_read_b128 v[68:71], v14 offset:320
    ds_read_b128 v[72:75], v14 offset:384
    ds_read_b128 v[76:79], v14 offset:448
    ds_read_b128 v[80:83], v11 offset:15232
    ds_read_b128 v[84:87], v11 offset:15296
    ds_read_b128 v[88:91], v11 offset:15360
    ds_read_b128 v[92:95], v11 offset:15424
    ds_read_b128 v[96:99], v11 offset:15488
    ds_read_b128 v[100:103], v11 offset:15552
    ds_read_b128 v[104:107], v11 offset:15616
    ds_read_b128 v[108:111], v11 offset:15680
    s_sub_u32 m0, s8, 48064
    v_pk_mul_f32 v[28:29], v[24:25], v[24:25] op_sel_hi:[1,0]
    v_pk_mul_f32 v[30:31], v[26:27], v[26:27] op_sel_hi:[1,0]
    v_pk_fma_f32 v[24:25], v[24:25], v[24:25], v[28:29] op_sel:[1,1,0] op_sel_hi:[0,1,1] neg_lo:[1,0,0]
    v_pk_fma_f32 v[26:27], v[26:27], v[26:27], v[30:31] op_sel:[1,1,0] op_sel_hi:[0,1,1] neg_lo:[1,0,0]
    v_cvt_pk_f16_f32 v146, v24, v25
    v_cvt_pk_f16_f32 v147, v26, v27
    v_pk_mul_f32 v[28:29], v[24:25], v[24:25] op_sel_hi:[1,0]
    v_pk_mul_f32 v[30:31], v[26:27], v[26:27] op_sel_hi:[1,0]
    v_pk_fma_f32 v[24:25], v[24:25], v[24:25], v[28:29] op_sel:[1,1,0] op_sel_hi:[0,1,1] neg_lo:[1,0,0]
    v_pk_fma_f32 v[26:27], v[26:27], v[26:27], v[30:31] op_sel:[1,1,0] op_sel_hi:[0,1,1] neg_lo:[1,0,0]
    v_cvt_pk_f16_f32 v166, v24, v25
    v_cvt_pk_f16_f32 v167, v26, v27
    s_waitcnt lgkmcnt(8)
    s_nop 0
    v_mfma_f32_16x16x32_f16 v[204:207], v[168:171], v[48:51], 0
    v_pk_mul_f16 v152, v146, v134 op_sel_hi:[1,0]
    v_pk_mul_f16 v153, v147, v135 op_sel_hi:[1,0]
    v_pk_mul_f16 v148, v146, v120 op_sel_hi:[1,0]
    v_pk_mul_f16 v149, v147, v121 op_sel_hi:[1,0]
    v_mfma_f32_16x16x32_f16 v[204:207], v[172:175], v[52:55], v[204:207]
    v_pk_fma_f16 v152, v146, v134, v152 op_sel:[1,1,0] op_sel_hi:[0,1,1] neg_lo:[1,0,0]
    v_pk_fma_f16 v153, v147, v135, v153 op_sel:[1,1,0] op_sel_hi:[0,1,1] neg_lo:[1,0,0]
    v_pk_fma_f16 v148, v146, v120, v148 op_sel:[1,1,0] op_sel_hi:[0,1,1] neg_lo:[1,0,0]
    v_pk_fma_f16 v149, v147, v121, v149 op_sel:[1,1,0] op_sel_hi:[0,1,1] neg_lo:[1,0,0]
    v_mfma_f32_16x16x32_f16 v[204:207], v[176:179], v[56:59], v[204:207]
    v_pk_mul_f16 v150, v146, v128 op_sel_hi:[1,0]
    v_pk_mul_f16 v151, v147, v129 op_sel_hi:[1,0]
    v_pk_mul_f16 v158, v128, v166 op_sel_hi:[1,0]
    v_pk_mul_f16 v159, v129, v167 op_sel_hi:[1,0]
    v_mfma_f32_16x16x32_f16 v[204:207], v[180:183], v[60:63], v[204:207]
    v_pk_fma_f16 v150, v146, v128, v150 op_sel:[1,1,0] op_sel_hi:[0,1,1] neg_lo:[1,0,0]
    v_pk_fma_f16 v151, v147, v129, v151 op_sel:[1,1,0] op_sel_hi:[0,1,1] neg_lo:[1,0,0]
    v_pk_fma_f16 v158, v128, v166, v158 op_sel:[1,1,0] op_sel_hi:[0,1,1] neg_lo:[1,0,0]
    v_pk_fma_f16 v159, v129, v167, v159 op_sel:[1,1,0] op_sel_hi:[0,1,1] neg_lo:[1,0,0]
    v_mfma_f32_16x16x32_f16 v[204:207], v[184:187], v[64:67], v[204:207]
    v_pk_mul_f16 v154, v152, v120 op_sel_hi:[1,0]
    v_pk_mul_f16 v155, v153, v121 op_sel_hi:[1,0]
    v_pk_mul_f16 v156, v152, v128 op_sel_hi:[1,0]
    v_pk_mul_f16 v157, v153, v129 op_sel_hi:[1,0]
    v_mfma_f32_16x16x32_f16 v[204:207], v[188:191], v[68:71], v[204:207]
    v_pk_fma_f16 v154, v152, v120, v154 op_sel:[1,1,0] op_sel_hi:[0,1,1] neg_lo:[1,0,0]
    v_pk_fma_f16 v155, v153, v121, v155 op_sel:[1,1,0] op_sel_hi:[0,1,1] neg_lo:[1,0,0]
    v_pk_fma_f16 v156, v152, v128, v156 op_sel:[1,1,0] op_sel_hi:[0,1,1] neg_lo:[1,0,0]
    v_pk_fma_f16 v157, v153, v129, v157 op_sel:[1,1,0] op_sel_hi:[0,1,1] neg_lo:[1,0,0]
    v_mfma_f32_16x16x32_f16 v[204:207], v[192:195], v[72:75], v[204:207]
    v_pk_mul_f16 v160, v142, v166 op_sel_hi:[1,0]
    v_pk_mul_f16 v161, v143, v167 op_sel_hi:[1,0]
    v_pk_mul_f16 v162, v150, v166 op_sel_hi:[1,0]
    v_pk_mul_f16 v163, v151, v167 op_sel_hi:[1,0]
    v_mfma_f32_16x16x32_f16 v[204:207], v[196:199], v[76:79], v[204:207]
    v_pk_fma_f16 v160, v142, v166, v160 op_sel:[1,1,0] op_sel_hi:[0,1,1] neg_lo:[1,0,0]
    v_pk_fma_f16 v161, v143, v167, v161 op_sel:[1,1,0] op_sel_hi:[0,1,1] neg_lo:[1,0,0]
    v_pk_fma_f16 v162, v150, v166, v162 op_sel:[1,1,0] op_sel_hi:[0,1,1] neg_lo:[1,0,0]
    v_pk_fma_f16 v163, v151, v167, v163 op_sel:[1,1,0] op_sel_hi:[0,1,1] neg_lo:[1,0,0]
    v_pk_mul_f16 v164, v156, v166 op_sel_hi:[1,0]
    v_pk_mul_f16 v165, v157, v167 op_sel_hi:[1,0]
    v_pk_fma_f16 v164, v156, v166, v164 op_sel:[1,1,0] op_sel_hi:[0,1,1] neg_lo:[1,0,0]
    v_pk_fma_f16 v165, v157, v167, v165 op_sel:[1,1,0] op_sel_hi:[0,1,1] neg_lo:[1,0,0]
    ds_write_addtid_b32 v130 offset:57312
    ds_write_addtid_b32 v131 offset:57568
    ds_write_addtid_b32 v146 offset:58944
    ds_write_addtid_b32 v147 offset:59200
    ds_write_addtid_b32 v152 offset:61120
    ds_write_addtid_b32 v153 offset:61376
    ds_write_addtid_b32 v148 offset:59488
    ds_write_addtid_b32 v149 offset:59744
    ds_write_addtid_b32 v150 offset:60032
    ds_write_addtid_b32 v151 offset:60288
    ds_write_addtid_b32 v158 offset:64928
    ds_write_addtid_b32 v159 offset:65184
    ds_write_addtid_b32 v154 offset:61664
    ds_write_addtid_b32 v155 offset:61920
    ds_write_addtid_b32 v156 offset:62208
    ds_write_addtid_b32 v157 offset:62464
    ds_write_addtid_b32 v160 offset:58400
    ds_write_addtid_b32 v161 offset:58656
    ds_write_addtid_b32 v162 offset:60576
    ds_write_addtid_b32 v163 offset:60832
    ds_write_addtid_b32 v164 offset:62752
    ds_write_addtid_b32 v165 offset:63008
    ds_read_b128 v[112:115], v13 offset:0
    ds_read_b128 v[116:119], v13 offset:64
    ds_read_b128 v[120:123], v13 offset:128
    ds_read_b128 v[124:127], v13 offset:192
    ds_read_b128 v[128:131], v13 offset:256
    ds_read_b128 v[132:135], v13 offset:320
    ds_read_b128 v[136:139], v13 offset:384
    ds_read_b128 v[140:143], v13 offset:448
    s_mov_b64 exec, 0xffff
    ds_write_b64 v200, v[252:253]
    s_mov_b32 exec_lo, -1
    ds_write_b64 v201, v[252:253] offset:2080
    ds_write_b64 v202, v[252:253] offset:9472
    s_mov_b64 exec, -1
    v_pk_mul_f16 v220, v48, v80 op_sel_hi:[1,0]
    v_pk_mul_f16 v221, v49, v81 op_sel_hi:[1,0]
    v_pk_mul_f16 v222, v50, v82 op_sel_hi:[1,0]
    v_pk_mul_f16 v223, v51, v83 op_sel_hi:[1,0]
    v_pk_fma_f16 v80, v48, v80, v220 op_sel:[1,1,0] op_sel_hi:[0,1,1] neg_hi:[1,0,0]
    v_pk_fma_f16 v81, v49, v81, v221 op_sel:[1,1,0] op_sel_hi:[0,1,1] neg_hi:[1,0,0]
    v_pk_fma_f16 v82, v50, v82, v222 op_sel:[1,1,0] op_sel_hi:[0,1,1] neg_hi:[1,0,0]
    v_pk_fma_f16 v83, v51, v83, v223 op_sel:[1,1,0] op_sel_hi:[0,1,1] neg_hi:[1,0,0]
    v_pk_mul_f16 v220, v52, v84 op_sel_hi:[1,0]
    v_pk_mul_f16 v221, v53, v85 op_sel_hi:[1,0]
    v_mfma_f32_16x16x32_f16 v[208:211], v[168:171], v[80:83], 0
    v_pk_mul_f16 v222, v54, v86 op_sel_hi:[1,0]
    v_pk_mul_f16 v223, v55, v87 op_sel_hi:[1,0]
    v_pk_fma_f16 v84, v52, v84, v220 op_sel:[1,1,0] op_sel_hi:[0,1,1] neg_hi:[1,0,0]
    v_pk_fma_f16 v85, v53, v85, v221 op_sel:[1,1,0] op_sel_hi:[0,1,1] neg_hi:[1,0,0]
    v_pk_fma_f16 v86, v54, v86, v222 op_sel:[1,1,0] op_sel_hi:[0,1,1] neg_hi:[1,0,0]
    v_pk_fma_f16 v87, v55, v87, v223 op_sel:[1,1,0] op_sel_hi:[0,1,1] neg_hi:[1,0,0]
    s_waitcnt lgkmcnt(9)
    s_nop 0
    v_pk_mul_f16 v220, v56, v88 op_sel_hi:[1,0]
    v_pk_mul_f16 v221, v57, v89 op_sel_hi:[1,0]
    v_mfma_f32_16x16x32_f16 v[208:211], v[172:175], v[84:87], v[208:211]
    v_pk_mul_f16 v222, v58, v90 op_sel_hi:[1,0]
    v_pk_mul_f16 v223, v59, v91 op_sel_hi:[1,0]
    v_pk_fma_f16 v88, v56, v88, v220 op_sel:[1,1,0] op_sel_hi:[0,1,1] neg_hi:[1,0,0]
    v_mfma_f32_16x16x32_f16 v[212:215], v[112:115], v[48:51], 0
    v_pk_fma_f16 v89, v57, v89, v221 op_sel:[1,1,0] op_sel_hi:[0,1,1] neg_hi:[1,0,0]
    v_pk_fma_f16 v90, v58, v90, v222 op_sel:[1,1,0] op_sel_hi:[0,1,1] neg_hi:[1,0,0]
    v_pk_fma_f16 v91, v59, v91, v223 op_sel:[1,1,0] op_sel_hi:[0,1,1] neg_hi:[1,0,0]
    v_mfma_f32_16x16x32_f16 v[216:219], v[112:115], v[80:83], 0
    v_pk_mul_f16 v220, v60, v92 op_sel_hi:[1,0]
    v_pk_mul_f16 v221, v61, v93 op_sel_hi:[1,0]
    v_mfma_f32_16x16x32_f16 v[208:211], v[176:179], v[88:91], v[208:211]
    v_pk_mul_f16 v222, v62, v94 op_sel_hi:[1,0]
    v_pk_mul_f16 v223, v63, v95 op_sel_hi:[1,0]
    v_pk_fma_f16 v92, v60, v92, v220 op_sel:[1,1,0] op_sel_hi:[0,1,1] neg_hi:[1,0,0]
    v_mfma_f32_16x16x32_f16 v[212:215], v[116:119], v[52:55], v[212:215]
    v_pk_fma_f16 v93, v61, v93, v221 op_sel:[1,1,0] op_sel_hi:[0,1,1] neg_hi:[1,0,0]
    v_pk_fma_f16 v94, v62, v94, v222 op_sel:[1,1,0] op_sel_hi:[0,1,1] neg_hi:[1,0,0]
    v_pk_fma_f16 v95, v63, v95, v223 op_sel:[1,1,0] op_sel_hi:[0,1,1] neg_hi:[1,0,0]
    v_mfma_f32_16x16x32_f16 v[216:219], v[116:119], v[84:87], v[216:219]
    s_waitcnt lgkmcnt(7)
    s_nop 0
    v_pk_mul_f16 v220, v64, v96 op_sel_hi:[1,0]
    v_pk_mul_f16 v221, v65, v97 op_sel_hi:[1,0]
    v_mfma_f32_16x16x32_f16 v[208:211], v[180:183], v[92:95], v[208:211]
    v_pk_mul_f16 v222, v66, v98 op_sel_hi:[1,0]
    v_pk_mul_f16 v223, v67, v99 op_sel_hi:[1,0]
    v_pk_fma_f16 v96, v64, v96, v220 op_sel:[1,1,0] op_sel_hi:[0,1,1] neg_hi:[1,0,0]
    v_mfma_f32_16x16x32_f16 v[212:215], v[120:123], v[56:59], v[212:215]
    v_pk_fma_f16 v97, v65, v97, v221 op_sel:[1,1,0] op_sel_hi:[0,1,1] neg_hi:[1,0,0]
    v_pk_fma_f16 v98, v66, v98, v222 op_sel:[1,1,0] op_sel_hi:[0,1,1] neg_hi:[1,0,0]
    v_pk_fma_f16 v99, v67, v99, v223 op_sel:[1,1,0] op_sel_hi:[0,1,1] neg_hi:[1,0,0]
    v_mfma_f32_16x16x32_f16 v[216:219], v[120:123], v[88:91], v[216:219]
    v_pk_mul_f16 v220, v68, v100 op_sel_hi:[1,0]
    v_pk_mul_f16 v221, v69, v101 op_sel_hi:[1,0]
    v_mfma_f32_16x16x32_f16 v[208:211], v[184:187], v[96:99], v[208:211]
    v_pk_mul_f16 v222, v70, v102 op_sel_hi:[1,0]
    v_pk_mul_f16 v223, v71, v103 op_sel_hi:[1,0]
    v_pk_fma_f16 v100, v68, v100, v220 op_sel:[1,1,0] op_sel_hi:[0,1,1] neg_hi:[1,0,0]
    v_mfma_f32_16x16x32_f16 v[212:215], v[124:127], v[60:63], v[212:215]
    v_pk_fma_f16 v101, v69, v101, v221 op_sel:[1,1,0] op_sel_hi:[0,1,1] neg_hi:[1,0,0]
    v_pk_fma_f16 v102, v70, v102, v222 op_sel:[1,1,0] op_sel_hi:[0,1,1] neg_hi:[1,0,0]
    v_pk_fma_f16 v103, v71, v103, v223 op_sel:[1,1,0] op_sel_hi:[0,1,1] neg_hi:[1,0,0]
    v_mfma_f32_16x16x32_f16 v[216:219], v[124:127], v[92:95], v[216:219]
    s_waitcnt lgkmcnt(5)
    s_nop 0
    v_pk_mul_f16 v220, v72, v104 op_sel_hi:[1,0]
    v_pk_mul_f16 v221, v73, v105 op_sel_hi:[1,0]
    v_mfma_f32_16x16x32_f16 v[208:211], v[188:191], v[100:103], v[208:211]
    v_pk_mul_f16 v222, v74, v106 op_sel_hi:[1,0]
    v_pk_mul_f16 v223, v75, v107 op_sel_hi:[1,0]
    v_pk_fma_f16 v104, v72, v104, v220 op_sel:[1,1,0] op_sel_hi:[0,1,1] neg_hi:[1,0,0]
    v_mfma_f32_16x16x32_f16 v[212:215], v[128:131], v[64:67], v[212:215]
    v_pk_fma_f16 v105, v73, v105, v221 op_sel:[1,1,0] op_sel_hi:[0,1,1] neg_hi:[1,0,0]
    v_pk_fma_f16 v106, v74, v106, v222 op_sel:[1,1,0] op_sel_hi:[0,1,1] neg_hi:[1,0,0]
    v_pk_fma_f16 v107, v75, v107, v223 op_sel:[1,1,0] op_sel_hi:[0,1,1] neg_hi:[1,0,0]
    v_mfma_f32_16x16x32_f16 v[216:219], v[128:131], v[96:99], v[216:219]
    v_pk_mul_f16 v220, v76, v108 op_sel_hi:[1,0]
    v_pk_mul_f16 v221, v77, v109 op_sel_hi:[1,0]
    v_mfma_f32_16x16x32_f16 v[208:211], v[192:195], v[104:107], v[208:211]
    v_pk_mul_f16 v222, v78, v110 op_sel_hi:[1,0]
    v_pk_mul_f16 v223, v79, v111 op_sel_hi:[1,0]
    v_pk_fma_f16 v108, v76, v108, v220 op_sel:[1,1,0] op_sel_hi:[0,1,1] neg_hi:[1,0,0]
    v_mfma_f32_16x16x32_f16 v[212:215], v[132:135], v[68:71], v[212:215]
    v_pk_fma_f16 v109, v77, v109, v221 op_sel:[1,1,0] op_sel_hi:[0,1,1] neg_hi:[1,0,0]
    v_pk_fma_f16 v110, v78, v110, v222 op_sel:[1,1,0] op_sel_hi:[0,1,1] neg_hi:[1,0,0]
    v_pk_fma_f16 v111, v79, v111, v223 op_sel:[1,1,0] op_sel_hi:[0,1,1] neg_hi:[1,0,0]
    v_mfma_f32_16x16x32_f16 v[216:219], v[132:135], v[100:103], v[216:219]
    s_waitcnt lgkmcnt(3)
    s_nop 0
    v_mfma_f32_16x16x32_f16 v[208:211], v[196:199], v[108:111], v[208:211]
    v_mfma_f32_16x16x32_f16 v[212:215], v[136:139], v[72:75], v[212:215]
    v_mfma_f32_16x16x32_f16 v[216:219], v[136:139], v[104:107], v[216:219]
    v_mfma_f32_16x16x32_f16 v[212:215], v[140:143], v[76:79], v[212:215]
    v_mfma_f32_16x16x32_f16 v[216:219], v[140:143], v[108:111], v[216:219]
    s_lshl_b32 s4, s58, 4
    s_lshr_b64 s[6:7], s[66:67], s4
    s_lshl_b32 s6, s6, 16
    s_nop 0
    v_permlane32_swap_b32 v204, v208
    v_permlane32_swap_b32 v205, v209
    v_permlane32_swap_b32 v206, v210
    v_permlane32_swap_b32 v207, v211
    v_cvt_pk_bf16_f32 v220, v215, v219
    s_mov_b64 exec, 1
    v_add_f32 v204, s6, v204
    v_add_f32_e64 v204, 1.0, v204
    s_mov_b64 exec, -1
    v_permlane32_swap_b32 v212, v216
    v_permlane32_swap_b32 v213, v217
    v_permlane32_swap_b32 v214, v218
    ds_write_b16 v47, v220 offset:9504
    ds_write_b16_d16_hi v47, v220 offset:9520
    ds_write_b16 v47, v220 offset:9662
    ds_write_b16_d16_hi v47, v220 offset:9678
    ds_write_b16 v47, v220 offset:9820
    ds_write_b16_d16_hi v47, v220 offset:9836
    ds_write_b16 v47, v220 offset:9978
    ds_write_b16_d16_hi v47, v220 offset:9994
    v_cvt_pk_bf16_f32 v48, v204, v205
    v_cvt_pk_bf16_f32 v49, v206, v207
    v_cvt_pk_bf16_f32 v50, v205, v206
    v_cvt_pk_bf16_f32 v51, v207, v212
    v_cvt_pk_bf16_f32 v52, v206, v207
    v_cvt_pk_bf16_f32 v53, v212, v213
    v_cvt_pk_bf16_f32 v54, v207, v212
    v_cvt_pk_bf16_f32 v55, v213, v214
    v_cvt_pk_bf16_f32 v56, v208, v208
    v_cvt_pk_bf16_f32 v57, v209, v210
    v_cvt_pk_bf16_f32 v58, v208, v209
    v_cvt_pk_bf16_f32 v59, v210, v210
    v_cvt_pk_bf16_f32 v60, v209, v210
    v_cvt_pk_bf16_f32 v61, v210, v210
    v_cvt_pk_bf16_f32 v62, v210, v210
    v_cvt_pk_bf16_f32 v63, v210, v211
    v_cvt_pk_bf16_f32 v64, v216, v216
    v_cvt_pk_bf16_f32 v65, v216, v217
    v_cvt_pk_bf16_f32 v66, v217, v217
    v_cvt_pk_bf16_f32 v67, v218, v218
    v_cvt_pk_bf16_f32 v68, v216, v216
    v_cvt_pk_bf16_f32 v69, v217, v217
    v_cvt_pk_bf16_f32 v70, v217, v218
    v_cvt_pk_bf16_f32 v71, v218, v218
    v_cvt_pk_bf16_f32 v72, v216, v217
    v_cvt_pk_bf16_f32 v73, v217, v217
    v_cvt_pk_bf16_f32 v74, v218, v218
    v_cvt_pk_bf16_f32 v75, v218, v218
    v_cvt_pk_bf16_f32 v76, v217, v217
    v_cvt_pk_bf16_f32 v77, v217, v218
    v_cvt_pk_bf16_f32 v78, v218, v218
    v_cvt_pk_bf16_f32 v79, v218, v218
    v_cvt_pk_bf16_f32 v80, v252, v204
    v_mov_b32 v81, v50
    v_mov_b32 v82, v79
    v_cvt_pk_bf16_f32 v83, v218, v252
    ds_write_b64 v203, v[48:49] offset:32
    ds_write_b64 v203, v[50:51] offset:2400
    ds_write_b64 v203, v[52:53] offset:4768
    ds_write_b64 v203, v[54:55] offset:7136
    ds_write_b64 v203, v[56:57] offset:544
    ds_write_b64 v203, v[58:59] offset:2912
    ds_write_b64 v203, v[60:61] offset:5280
    ds_write_b64 v203, v[62:63] offset:7648
    ds_write_b128 v46, v[64:67] offset:1056
    ds_write_b128 v46, v[68:71] offset:3424
    ds_write_b128 v46, v[72:75] offset:5792
    ds_write_b128 v46, v[76:79] offset:8160
    s_mov_b64 exec, 1
    ds_write_b32 v35, v80 offset:2396
    ds_write_b32 v35, v48 offset:4764
    ds_write_b64 v35, v[80:81] offset:7128
    s_brev_b64 exec, 1
    ds_write_b64 v35, v[78:79] offset:2080
    ds_write_b32 v35, v83 offset:2088
    ds_write_b64 v35, v[78:79] offset:4448
    ds_write_b64 v35, v[82:83] offset:6816
    ds_write_b32 v35, v79 offset:9184
    s_mov_b64 exec, -1
LW_1:
    ds_read_b32 v34, v6 offset:128
    s_waitcnt lgkmcnt(0)
    v_cmp_eq_u32 vcc, 0, v34
    s_cbranch_vccnz LW_1
    s_buffer_load_dwordx8 s[16:23], s[44:47], s31 glc
    v_readfirstlane_b32 s28, v34
    ds_write_b64 v15, v[252:253] offset:4096
    s_mov_b32 s5, 0
    s_mov_b32 s29, s28
    s_nop 0
    ds_read_b64 v[48:49], v1 offset:0
    ds_read_b64 v[50:51], v1 offset:8
    ds_read_b64 v[52:53], v1 offset:64
    ds_read_b64 v[54:55], v1 offset:72
    ds_read_b64 v[56:57], v1 offset:128
    ds_read_b64 v[58:59], v1 offset:136
    ds_read_b64 v[60:61], v1 offset:192
    ds_read_b64 v[62:63], v1 offset:200
    ds_read_b64 v[64:65], v1 offset:256
    ds_read_b64 v[66:67], v1 offset:264
    ds_read_b64 v[68:69], v1 offset:320
    ds_read_b64 v[70:71], v1 offset:328
    ds_read_b64 v[72:73], v1 offset:384
    ds_read_b64 v[74:75], v1 offset:392
    ds_read_b64 v[76:77], v1 offset:448
    ds_read_b64 v[78:79], v1 offset:456
    ds_read_b64 v[80:81], v1 offset:512
    ds_read_b64 v[82:83], v1 offset:520
    ds_read_b64 v[84:85], v1 offset:576
    ds_read_b64 v[86:87], v1 offset:584
    ds_read_b64 v[88:89], v1 offset:640
    ds_read_b64 v[90:91], v1 offset:648
    ds_read_b64 v[92:93], v1 offset:704
    ds_read_b64 v[94:95], v1 offset:712
    ds_read_b64 v[96:97], v1 offset:768
    ds_read_b64 v[98:99], v1 offset:776
    ds_read_b64 v[100:101], v1 offset:832
    ds_read_b64 v[102:103], v1 offset:840
    ds_read_b64 v[104:105], v1 offset:896
    ds_read_b64 v[106:107], v1 offset:904
    ds_read_b64 v[108:109], v1 offset:960
    ds_read_b64 v[110:111], v1 offset:968
    ds_read_b64 v[112:113], v1 offset:1024
    ds_read_b64 v[114:115], v1 offset:1032
    ds_read_b64 v[116:117], v1 offset:1088
    ds_read_b64 v[118:119], v1 offset:1096
    ds_read_b64 v[120:121], v1 offset:1152
    ds_read_b64 v[122:123], v1 offset:1160
    ds_read_b64 v[124:125], v1 offset:1216
    ds_read_b64 v[126:127], v1 offset:1224
    s_branch L_XC
L_XP:
    s_sleep 2
    ds_read_b32 v11, v4 offset:528
    s_buffer_load_dwordx8 s[16:23], s[44:47], s31 glc
    s_add_u32 s5, s5, 1
    s_waitcnt lgkmcnt(0)
    v_cmp_eq_u32 vcc, 1, v11
    s_cbranch_vccnz L_XSLOW
    s_cmp_ge_u32 s5, 0x4000
    s_cbranch_scc1 L_XSLOW
L_XC:
    s_waitcnt lgkmcnt(0)
    s_xor_b64 s[16:17], s[16:17], s[28:29]
    s_xor_b64 s[18:19], s[18:19], s[28:29]
    s_xor_b64 s[20:21], s[20:21], s[28:29]
    s_xor_b64 s[22:23], s[22:23], s[28:29]
    s_or_b64 s[16:17], s[16:17], s[18:19]
    s_or_b64 s[20:21], s[20:21], s[22:23]
    s_or_b64 s[16:17], s[16:17], s[20:21]
    s_cbranch_scc1 L_XP
    s_add_u32 s4, s13, 0
    s_nop 0
    buffer_load_dwordx4 v[16:19], v33, s[44:47], s4 offen sc1
    s_add_u32 s4, s13, 4096
    buffer_load_dwordx4 v[20:23], v33, s[44:47], s4 offen sc1
    s_add_u32 s4, s13, 8192
    buffer_load_dwordx4 v[24:27], v33, s[44:47], s4 offen sc1
    s_add_u32 s4, s13, 12288
    buffer_load_dwordx4 v[28:31], v33, s[44:47], s4 offen sc1
L_XBACK:
    ds_read_b64 v[128:129], v1 offset:1280
    ds_read_b64 v[130:131], v1 offset:1288
    ds_read_b64 v[132:133], v1 offset:1344
    ds_read_b64 v[134:135], v1 offset:1352
    ds_read_b64 v[136:137], v1 offset:1408
    ds_read_b64 v[138:139], v1 offset:1416
    ds_read_b64 v[140:141], v1 offset:1472
    ds_read_b64 v[142:143], v1 offset:1480
    ds_read_b64 v[144:145], v1 offset:1536
    ds_read_b64 v[146:147], v1 offset:1544
    ds_read_b64 v[148:149], v1 offset:1600
    ds_read_b64 v[150:151], v1 offset:1608
    ds_read_b64 v[152:153], v1 offset:1664
    ds_read_b64 v[154:155], v1 offset:1672
    ds_read_b64 v[156:157], v1 offset:1728
    ds_read_b64 v[158:159], v1 offset:1736
    ds_read_b64 v[160:161], v1 offset:1792
    ds_read_b64 v[162:163], v1 offset:1800
    ds_read_b64 v[164:165], v1 offset:1856
    ds_read_b64 v[166:167], v1 offset:1864
    ds_read_b64 v[168:169], v1 offset:1920
    ds_read_b64 v[170:171], v1 offset:1928
    ds_read_b64 v[172:173], v1 offset:1984
    ds_read_b64 v[174:175], v1 offset:1992
    ds_read_b64 v[176:177], v1 offset:2048
    ds_read_b64 v[178:179], v1 offset:2056
LW_2:
    ds_read_b32 v11, v4 offset:528
    s_waitcnt lgkmcnt(0)
    v_cmp_eq_u32_e64 vcc, 0, v11
    s_cbranch_vccnz LW_2
    ds_read2st64_b64 v[180:183], v10 offset0:18 offset1:22
    ds_read2st64_b64 v[184:187], v10 offset0:26 offset1:30
    s_waitcnt vmcnt(0)
    v_lshlrev_b32 v204, 16, v16
    v_and_b32 v212, 0xffff0000, v16
    v_lshlrev_b32_e64 v220, 16, v17
    v_and_b32 v228, 0xffff0000, v17
    v_lshlrev_b32_e64 v205, 16, v18
    v_and_b32 v213, 0xffff0000, v18
    v_lshlrev_b32_e64 v221, 16, v19
    v_and_b32 v229, 0xffff0000, v19
    s_waitcnt lgkmcnt(0)
    v_lshlrev_b32 v188, 16, v181
    v_and_b32 v189, 0xffff0000, v181
    v_lshlrev_b32_e64 v190, 16, v183
    v_and_b32 v191, 0xffff0000, v183
    v_lshlrev_b32_e64 v192, 16, v185
    v_and_b32 v193, 0xffff0000, v185
    v_lshlrev_b32_e64 v194, 16, v187
    v_and_b32 v195, 0xffff0000, v187
    v_lshlrev_b32_e64 v206, 16, v20
    v_and_b32 v214, 0xffff0000, v20
    v_lshlrev_b32_e64 v222, 16, v21
    v_and_b32 v230, 0xffff0000, v21
    v_rcp_f32 v188, v188
    v_rcp_f32 v189, v189
    v_lshlrev_b32_e64 v207, 16, v22
    v_and_b32 v215, 0xffff0000, v22
    v_lshlrev_b32_e64 v223, 16, v23
    v_and_b32 v231, 0xffff0000, v23
    v_rcp_f32 v190, v190
    v_rcp_f32 v191, v191
    v_lshlrev_b32_e64 v208, 16, v24
    v_and_b32 v216, 0xffff0000, v24
    v_lshlrev_b32_e64 v224, 16, v25
    v_and_b32 v232, 0xffff0000, v25
    v_rcp_f32 v192, v192
    v_rcp_f32 v193, v193
    v_lshlrev_b32_e64 v209, 16, v26
    v_and_b32 v217, 0xffff0000, v26
    v_lshlrev_b32_e64 v225, 16, v27
    v_and_b32 v233, 0xffff0000, v27
    v_rcp_f32 v194, v194
    v_rcp_f32 v195, v195
    v_lshlrev_b32_e64 v210, 16, v28
    v_and_b32 v218, 0xffff0000, v28
    v_lshlrev_b32_e64 v226, 16, v29
    v_and_b32 v234, 0xffff0000, v29
    v_lshlrev_b32_e64 v211, 16, v30
    v_and_b32 v219, 0xffff0000, v30
    v_lshlrev_b32_e64 v227, 16, v31
    v_and_b32 v235, 0xffff0000, v31
    v_lshlrev_b32_e64 v196, 16, v180
    v_and_b32 v197, 0xffff0000, v180
    v_lshlrev_b32_e64 v198, 16, v182
    v_and_b32 v199, 0xffff0000, v182
    v_lshlrev_b32_e64 v200, 16, v184
    v_and_b32 v201, 0xffff0000, v184
    v_lshlrev_b32_e64 v202, 16, v186
    v_and_b32 v203, 0xffff0000, v186
    v_pk_mul_f32 v[196:197], v[196:197], v[188:189]
    v_pk_mul_f32 v[198:199], v[198:199], v[190:191]
    v_pk_mul_f32 v[200:201], v[200:201], v[192:193]
    v_pk_mul_f32 v[202:203], v[202:203], v[194:195]
    v_pk_fma_f32 v[204:205], v[204:205], v[188:189], v[196:197] neg_lo:[0,0,1] neg_hi:[0,0,1]
    v_pk_fma_f32 v[206:207], v[206:207], v[190:191], v[198:199] neg_lo:[0,0,1] neg_hi:[0,0,1]
    v_pk_fma_f32 v[208:209], v[208:209], v[192:193], v[200:201] neg_lo:[0,0,1] neg_hi:[0,0,1]
    v_pk_fma_f32 v[210:211], v[210:211], v[194:195], v[202:203] neg_lo:[0,0,1] neg_hi:[0,0,1]
    v_cvt_pk_bf16_f32 v36, v205, v204
    v_cvt_pk_bf16_f32 v37, v207, v206
    v_cvt_pk_bf16_f32 v38, v209, v208
    v_cvt_pk_bf16_f32 v39, v211, v210
    ds_write2st64_b32 v32, v36, v37 offset0:12 offset1:8
    ds_write2st64_b32 v32, v38, v39 offset0:4 offset1:0
    v_pk_fma_f32 v[212:213], v[212:213], v[188:189], v[196:197] neg_lo:[0,0,1] neg_hi:[0,0,1]
    v_pk_fma_f32 v[214:215], v[214:215], v[190:191], v[198:199] neg_lo:[0,0,1] neg_hi:[0,0,1]
    v_pk_fma_f32 v[216:217], v[216:217], v[192:193], v[200:201] neg_lo:[0,0,1] neg_hi:[0,0,1]
    v_pk_fma_f32 v[218:219], v[218:219], v[194:195], v[202:203] neg_lo:[0,0,1] neg_hi:[0,0,1]
    v_cvt_pk_bf16_f32 v40, v213, v212
    v_cvt_pk_bf16_f32 v41, v215, v214
    v_cvt_pk_bf16_f32 v42, v217, v216
    v_cvt_pk_bf16_f32 v43, v219, v218
    ds_write2st64_b32 v32, v40, v41 offset0:30 offset1:26
    ds_write2st64_b32 v32, v42, v43 offset0:22 offset1:18
    v_pk_fma_f32 v[220:221], v[220:221], v[188:189], v[196:197] neg_lo:[0,0,1] neg_hi:[0,0,1]
    v_pk_fma_f32 v[222:223], v[222:223], v[190:191], v[198:199] neg_lo:[0,0,1] neg_hi:[0,0,1]
    v_pk_fma_f32 v[224:225], v[224:225], v[192:193], v[200:201] neg_lo:[0,0,1] neg_hi:[0,0,1]
    v_pk_fma_f32 v[226:227], v[226:227], v[194:195], v[202:203] neg_lo:[0,0,1] neg_hi:[0,0,1]
    v_cvt_pk_bf16_f32 v36, v221, v220
    v_cvt_pk_bf16_f32 v37, v223, v222
    v_cvt_pk_bf16_f32 v38, v225, v224
    v_cvt_pk_bf16_f32 v39, v227, v226
    ds_write2st64_b32 v32, v36, v37 offset0:48 offset1:44
    ds_write2st64_b32 v32, v38, v39 offset0:40 offset1:36
    v_pk_fma_f32 v[228:229], v[228:229], v[188:189], v[196:197] neg_lo:[0,0,1] neg_hi:[0,0,1]
    v_pk_fma_f32 v[230:231], v[230:231], v[190:191], v[198:199] neg_lo:[0,0,1] neg_hi:[0,0,1]
    v_pk_fma_f32 v[232:233], v[232:233], v[192:193], v[200:201] neg_lo:[0,0,1] neg_hi:[0,0,1]
    v_pk_fma_f32 v[234:235], v[234:235], v[194:195], v[202:203] neg_lo:[0,0,1] neg_hi:[0,0,1]
    v_cvt_pk_bf16_f32 v40, v229, v228
    v_cvt_pk_bf16_f32 v41, v231, v230
    v_cvt_pk_bf16_f32 v42, v233, v232
    v_cvt_pk_bf16_f32 v43, v235, v234
    ds_write2st64_b32 v32, v40, v41 offset0:66 offset1:62
    ds_write2st64_b32 v32, v42, v43 offset0:58 offset1:54
    s_mov_b64 exec, 1
    ds_write_b32 v4, v11 offset:0
    s_mov_b64 exec, -1
LW_3:
    ds_read_b32 v15, v6 offset:0
    s_waitcnt lgkmcnt(0)
    v_cmp_eq_u32 vcc, 0, v15
    s_cbranch_vccnz LW_3
    v_cmp_ne_u32 vcc, 2, v15
    s_cmp_eq_u32 vcc_lo, 0
    s_cselect_b32 s14, 2, 1
    ds_read_b128 v[180:183], v7 offset:4032
    ds_read_b128 v[184:187], v7 offset:3584
    ds_read_b128 v[188:191], v7 offset:3600
    ds_read_b128 v[192:195], v7 offset:3968
    ds_read_b128 v[196:199], v7 offset:3072
    s_waitcnt lgkmcnt(4)
    s_nop 0
    v_mfma_f32_16x16x32_bf16 v[204:207], v[76:79], v[180:183], 0
    ds_read_b128 v[200:203], v7 offset:3088
    v_mfma_f32_16x16x32_bf16 v[208:211], v[108:111], v[180:183], 0
    v_mfma_f32_16x16x32_bf16 v[212:215], v[140:143], v[180:183], 0
    v_mfma_f32_16x16x32_bf16 v[216:219], v[172:175], v[180:183], 0
    s_waitcnt lgkmcnt(4)
    v_mfma_f32_16x16x32_bf16 v[220:223], v[184:187], v[244:247], 0
    ds_read_b128 v[180:183], v7 offset:3904
    s_waitcnt lgkmcnt(4)
    v_mfma_f32_16x16x32_bf16 v[224:227], v[188:191], v[248:251], 0
    ds_read_b128 v[184:187], v7 offset:3840
    s_waitcnt lgkmcnt(4)
    s_nop 0
    v_mfma_f32_16x16x32_bf16 v[204:207], v[72:75], v[192:195], v[204:207]
    ds_read_b128 v[188:191], v7 offset:2560
    v_mfma_f32_16x16x32_bf16 v[208:211], v[104:107], v[192:195], v[208:211]
    v_mfma_f32_16x16x32_bf16 v[212:215], v[136:139], v[192:195], v[212:215]
    v_mfma_f32_16x16x32_bf16 v[216:219], v[168:171], v[192:195], v[216:219]
    s_waitcnt lgkmcnt(4)
    v_mfma_f32_16x16x32_bf16 v[228:231], v[196:199], v[244:247], 0
    ds_read_b128 v[192:195], v7 offset:2576
    s_waitcnt lgkmcnt(4)
    v_mfma_f32_16x16x32_bf16 v[232:235], v[200:203], v[248:251], 0
    ds_read_b128 v[196:199], v7 offset:3776
    s_waitcnt lgkmcnt(4)
    s_nop 0
    v_mfma_f32_16x16x32_bf16 v[204:207], v[68:71], v[180:183], v[204:207]
    ds_read_b128 v[200:203], v7 offset:2048
    v_mfma_f32_16x16x32_bf16 v[208:211], v[100:103], v[180:183], v[208:211]
    v_cvt_pk_bf16_f32 v236, v223, v222
    v_cvt_pk_bf16_f32 v237, v221, v220
    v_mfma_f32_16x16x32_bf16 v[212:215], v[132:135], v[180:183], v[212:215]
    v_cvt_pk_bf16_f32 v238, v227, v226
    v_cvt_pk_bf16_f32 v239, v225, v224
    v_mfma_f32_16x16x32_bf16 v[216:219], v[164:167], v[180:183], v[216:219]
    v_cvt_pk_bf16_f32 v240, v231, v230
    v_cvt_pk_bf16_f32 v241, v229, v228
    s_waitcnt lgkmcnt(4)
    s_nop 0
    v_mfma_f32_16x16x32_bf16 v[204:207], v[64:67], v[184:187], v[204:207]
    ds_read_b128 v[180:183], v7 offset:2064
    v_mfma_f32_16x16x32_bf16 v[208:211], v[96:99], v[184:187], v[208:211]
    v_cvt_pk_bf16_f32 v242, v235, v234
    v_cvt_pk_bf16_f32 v243, v233, v232
    v_mfma_f32_16x16x32_bf16 v[212:215], v[128:131], v[184:187], v[212:215]
    v_mfma_f32_16x16x32_bf16 v[216:219], v[160:163], v[184:187], v[216:219]
    s_waitcnt lgkmcnt(4)
    v_mfma_f32_16x16x32_bf16 v[220:223], v[188:191], v[244:247], 0
    ds_read_b128 v[184:187], v7 offset:3712
    s_waitcnt lgkmcnt(4)
    v_mfma_f32_16x16x32_bf16 v[224:227], v[192:195], v[248:251], 0
    ds_read_b128 v[188:191], v7 offset:3648
    s_waitcnt lgkmcnt(4)
    s_nop 0
    v_mfma_f32_16x16x32_bf16 v[204:207], v[60:63], v[196:199], v[204:207]
    ds_read_b128 v[192:195], v7 offset:3584
    v_mfma_f32_16x16x32_bf16 v[208:211], v[92:95], v[196:199], v[208:211]
    v_mfma_f32_16x16x32_bf16 v[212:215], v[124:127], v[196:199], v[212:215]
    v_mfma_f32_16x16x32_bf16 v[216:219], v[156:159], v[196:199], v[216:219]
    s_waitcnt lgkmcnt(4)
    v_mfma_f32_16x16x32_bf16 v[228:231], v[200:203], v[244:247], 0
    ds_read_b128 v[196:199], v7 offset:3520
    s_waitcnt lgkmcnt(4)
    v_mfma_f32_16x16x32_bf16 v[232:235], v[180:183], v[248:251], 0
    ds_read_b128 v[200:203], v7 offset:3456
    s_waitcnt lgkmcnt(4)
    s_nop 0
    v_mfma_f32_16x16x32_bf16 v[204:207], v[56:59], v[184:187], v[204:207]
    ds_read_b128 v[180:183], v7 offset:3392
    v_mfma_f32_16x16x32_bf16 v[208:211], v[88:91], v[184:187], v[208:211]
    v_cvt_pk_bf16_f32 v244, v223, v222
    v_cvt_pk_bf16_f32 v245, v221, v220
    v_mfma_f32_16x16x32_bf16 v[212:215], v[120:123], v[184:187], v[212:215]
    v_cvt_pk_bf16_f32 v246, v227, v226
    v_cvt_pk_bf16_f32 v247, v225, v224
    v_mfma_f32_16x16x32_bf16 v[216:219], v[152:155], v[184:187], v[216:219]
    v_cvt_pk_bf16_f32 v248, v231, v230
    v_cvt_pk_bf16_f32 v249, v229, v228
    s_waitcnt lgkmcnt(4)
    s_nop 0
    v_mfma_f32_16x16x32_bf16 v[204:207], v[52:55], v[188:191], v[204:207]
    ds_read_b128 v[184:187], v7 offset:3328
    v_mfma_f32_16x16x32_bf16 v[208:211], v[84:87], v[188:191], v[208:211]
    v_cvt_pk_bf16_f32 v250, v235, v234
    v_cvt_pk_bf16_f32 v251, v233, v232
    v_mfma_f32_16x16x32_bf16 v[212:215], v[116:119], v[188:191], v[212:215]
    v_mfma_f32_16x16x32_bf16 v[216:219], v[148:151], v[188:191], v[216:219]
    s_waitcnt lgkmcnt(4)
    s_nop 0
    v_mfma_f32_16x16x32_bf16 v[204:207], v[48:51], v[192:195], v[204:207]
    ds_read_b128 v[188:191], v7 offset:3264
    v_mfma_f32_16x16x32_bf16 v[208:211], v[80:83], v[192:195], v[208:211]
    v_mfma_f32_16x16x32_bf16 v[212:215], v[112:115], v[192:195], v[212:215]
    v_mfma_f32_16x16x32_bf16 v[216:219], v[144:147], v[192:195], v[216:219]
    v_mfma_f32_16x16x32_bf16 v[220:223], v[176:179], v[192:195], 0
    s_waitcnt lgkmcnt(4)
    s_nop 0
    v_mfma_f32_16x16x32_bf16 v[208:211], v[76:79], v[196:199], v[208:211]
    ds_read_b128 v[192:195], v7 offset:3200
    v_mfma_f32_16x16x32_bf16 v[212:215], v[108:111], v[196:199], v[212:215]
    v_mfma_f32_16x16x32_bf16 v[216:219], v[140:143], v[196:199], v[216:219]
    v_mfma_f32_16x16x32_bf16 v[220:223], v[172:175], v[196:199], v[220:223]
    s_waitcnt lgkmcnt(4)
    s_nop 0
    v_mfma_f32_16x16x32_bf16 v[208:211], v[72:75], v[200:203], v[208:211]
    ds_read_b128 v[196:199], v7 offset:3136
    v_mfma_f32_16x16x32_bf16 v[212:215], v[104:107], v[200:203], v[212:215]
    v_mfma_f32_16x16x32_bf16 v[216:219], v[136:139], v[200:203], v[216:219]
    v_mfma_f32_16x16x32_bf16 v[220:223], v[168:171], v[200:203], v[220:223]
    s_waitcnt lgkmcnt(4)
    s_nop 0
    v_mfma_f32_16x16x32_bf16 v[208:211], v[68:71], v[180:183], v[208:211]
    ds_read_b128 v[200:203], v7 offset:3072
    v_mfma_f32_16x16x32_bf16 v[212:215], v[100:103], v[180:183], v[212:215]
    v_mfma_f32_16x16x32_bf16 v[216:219], v[132:135], v[180:183], v[216:219]
    v_mfma_f32_16x16x32_bf16 v[220:223], v[164:167], v[180:183], v[220:223]
    s_waitcnt lgkmcnt(4)
    s_nop 0
    v_mfma_f32_16x16x32_bf16 v[208:211], v[64:67], v[184:187], v[208:211]
    ds_read_b128 v[180:183], v7 offset:3008
    v_mfma_f32_16x16x32_bf16 v[212:215], v[96:99], v[184:187], v[212:215]
    v_mfma_f32_16x16x32_bf16 v[216:219], v[128:131], v[184:187], v[216:219]
    v_mfma_f32_16x16x32_bf16 v[220:223], v[160:163], v[184:187], v[220:223]
    s_waitcnt lgkmcnt(4)
    s_nop 0
    v_mfma_f32_16x16x32_bf16 v[208:211], v[60:63], v[188:191], v[208:211]
    ds_read_b128 v[184:187], v7 offset:2944
    v_mfma_f32_16x16x32_bf16 v[212:215], v[92:95], v[188:191], v[212:215]
    v_mfma_f32_16x16x32_bf16 v[216:219], v[124:127], v[188:191], v[216:219]
    v_mfma_f32_16x16x32_bf16 v[220:223], v[156:159], v[188:191], v[220:223]
    s_waitcnt lgkmcnt(4)
    s_nop 0
    v_mfma_f32_16x16x32_bf16 v[208:211], v[56:59], v[192:195], v[208:211]
    ds_read_b128 v[188:191], v7 offset:2880
    v_mfma_f32_16x16x32_bf16 v[212:215], v[88:91], v[192:195], v[212:215]
    v_mfma_f32_16x16x32_bf16 v[216:219], v[120:123], v[192:195], v[216:219]
    v_mfma_f32_16x16x32_bf16 v[220:223], v[152:155], v[192:195], v[220:223]
    s_waitcnt lgkmcnt(4)
    s_nop 0
    v_mfma_f32_16x16x32_bf16 v[208:211], v[52:55], v[196:199], v[208:211]
    ds_read_b128 v[192:195], v7 offset:2816
    v_mfma_f32_16x16x32_bf16 v[212:215], v[84:87], v[196:199], v[212:215]
    v_mfma_f32_16x16x32_bf16 v[216:219], v[116:119], v[196:199], v[216:219]
    v_mfma_f32_16x16x32_bf16 v[220:223], v[148:151], v[196:199], v[220:223]
    s_waitcnt lgkmcnt(4)
    s_nop 0
    v_mfma_f32_16x16x32_bf16 v[208:211], v[48:51], v[200:203], v[208:211]
    ds_read_b128 v[196:199], v7 offset:2752
    v_mfma_f32_16x16x32_bf16 v[212:215], v[80:83], v[200:203], v[212:215]
    v_mfma_f32_16x16x32_bf16 v[216:219], v[112:115], v[200:203], v[216:219]
    v_mfma_f32_16x16x32_bf16 v[220:223], v[144:147], v[200:203], v[220:223]
    v_mfma_f32_16x16x32_bf16 v[224:227], v[176:179], v[200:203], 0
    s_waitcnt lgkmcnt(4)
    s_nop 0
    v_mfma_f32_16x16x32_bf16 v[212:215], v[76:79], v[180:183], v[212:215]
    ds_read_b128 v[200:203], v7 offset:2688
    v_mfma_f32_16x16x32_bf16 v[216:219], v[108:111], v[180:183], v[216:219]
    ds_write_b128 v8, v[204:207] offset:0
    v_mfma_f32_16x16x32_bf16 v[220:223], v[140:143], v[180:183], v[220:223]
    ds_write_b128 v8, v[208:211] offset:1024
    v_mfma_f32_16x16x32_bf16 v[224:227], v[172:175], v[180:183], v[224:227]
    s_mov_b64 exec, 1
    ds_write_b32 v4, v5 offset:144
    s_mov_b64 exec, -1
    s_waitcnt lgkmcnt(7)
    s_nop 0
    v_mfma_f32_16x16x32_bf16 v[212:215], v[72:75], v[184:187], v[212:215]
    ds_read_b128 v[180:183], v7 offset:2624
    v_mfma_f32_16x16x32_bf16 v[216:219], v[104:107], v[184:187], v[216:219]
    v_mfma_f32_16x16x32_bf16 v[220:223], v[136:139], v[184:187], v[220:223]
    v_mfma_f32_16x16x32_bf16 v[224:227], v[168:171], v[184:187], v[224:227]
    s_waitcnt lgkmcnt(7)
    s_nop 0
    v_mfma_f32_16x16x32_bf16 v[212:215], v[68:71], v[188:191], v[212:215]
    ds_read_b128 v[184:187], v7 offset:2560
    v_mfma_f32_16x16x32_bf16 v[216:219], v[100:103], v[188:191], v[216:219]
    ds_read_b32 v11, v6 offset:144
    v_mfma_f32_16x16x32_bf16 v[220:223], v[132:135], v[188:191], v[220:223]
    v_mfma_f32_16x16x32_bf16 v[224:227], v[164:167], v[188:191], v[224:227]
    s_waitcnt lgkmcnt(8)
    v_mfma_f32_16x16x32_bf16 v[212:215], v[64:67], v[192:195], v[212:215]
    ds_read_b128 v[188:191], v7 offset:2496
    v_mfma_f32_16x16x32_bf16 v[216:219], v[96:99], v[192:195], v[216:219]
    s_waitcnt lgkmcnt(1)
    v_cmp_eq_u32 vcc, 0, v11
    s_cbranch_vccnz L_SLOW0
L_BACK0:
    v_mfma_f32_16x16x32_bf16 v[220:223], v[128:131], v[192:195], v[220:223]
    ds_read_b64 v[204:205], v9 offset:0
    v_mfma_f32_16x16x32_bf16 v[224:227], v[160:163], v[192:195], v[224:227]
    ds_read_b64 v[206:207], v9 offset:8192
    v_mfma_f32_16x16x32_bf16 v[212:215], v[60:63], v[196:199], v[212:215]
    ds_read_b128 v[192:195], v7 offset:2432
    v_mfma_f32_16x16x32_bf16 v[216:219], v[92:95], v[196:199], v[216:219]
    ds_read_b64 v[208:209], v9 offset:16384
    v_mfma_f32_16x16x32_bf16 v[220:223], v[124:127], v[196:199], v[220:223]
    ds_read_b64 v[210:211], v9 offset:24576
    v_mfma_f32_16x16x32_bf16 v[224:227], v[156:159], v[196:199], v[224:227]
    v_mfma_f32_16x16x32_bf16 v[212:215], v[56:59], v[200:203], v[212:215]
    ds_read_b128 v[196:199], v7 offset:2368
    v_mfma_f32_16x16x32_bf16 v[216:219], v[88:91], v[200:203], v[216:219]
    s_waitcnt lgkmcnt(1)
    v_lshlrev_b32 v36, 16, v16
    v_and_b32 v37, 0xffff0000, v16
    v_mfma_f32_16x16x32_bf16 v[220:223], v[120:123], v[200:203], v[220:223]
    v_lshlrev_b32_e64 v38, 16, v17
    v_and_b32 v39, 0xffff0000, v17
    v_mfma_f32_16x16x32_bf16 v[224:227], v[152:155], v[200:203], v[224:227]
    v_lshlrev_b32_e64 v40, 16, v18
    v_and_b32 v41, 0xffff0000, v18
    v_mfma_f32_16x16x32_bf16 v[212:215], v[52:55], v[180:183], v[212:215]
    ds_read_b128 v[200:203], v7 offset:2304
    v_mfma_f32_16x16x32_bf16 v[216:219], v[84:87], v[180:183], v[216:219]
    v_lshlrev_b32_e64 v42, 16, v19
    v_and_b32 v43, 0xffff0000, v19
    v_mfma_f32_16x16x32_bf16 v[220:223], v[116:119], v[180:183], v[220:223]
    v_add_f32 v36, v204, v36
    v_add_f32 v37, v206, v37
    v_mfma_f32_16x16x32_bf16 v[224:227], v[148:151], v[180:183], v[224:227]
    v_add_f32 v38, v208, v38
    v_add_f32 v39, v210, v39
    v_mfma_f32_16x16x32_bf16 v[212:215], v[48:51], v[184:187], v[212:215]
    ds_read_b64 v[180:181], v2 offset:9496
    ds_read_b64 v[182:183], v2 offset:10136
    v_mfma_f32_16x16x32_bf16 v[216:219], v[80:83], v[184:187], v[216:219]
    v_add_f32 v40, v205, v40
    v_add_f32 v41, v207, v41
    v_mfma_f32_16x16x32_bf16 v[220:223], v[112:115], v[184:187], v[220:223]
    v_add_f32_e64 v42, v209, v42
    v_mfma_f32_16x16x32_bf16 v[224:227], v[144:147], v[184:187], v[224:227]
    v_add_f32_e64 v43, v211, v43
    v_mfma_f32_16x16x32_bf16 v[228:231], v[176:179], v[184:187], 0
    v_cvt_pk_bf16_f32 v204, v36, v37
    v_mfma_f32_16x16x32_bf16 v[216:219], v[76:79], v[188:191], v[216:219]
    ds_read_b128 v[184:187], v7 offset:2240
    v_mfma_f32_16x16x32_bf16 v[220:223], v[108:111], v[188:191], v[220:223]
    v_cvt_pk_bf16_f32 v205, v38, v39
    v_mfma_f32_16x16x32_bf16 v[224:227], v[140:143], v[188:191], v[224:227]
    v_cvt_pk_bf16_f32 v206, v40, v41
    v_mfma_f32_16x16x32_bf16 v[228:231], v[172:175], v[188:191], v[228:231]
    v_cvt_pk_bf16_f32 v207, v42, v43
    v_mfma_f32_16x16x32_bf16 v[216:219], v[72:75], v[192:195], v[216:219]
    ds_read_b128 v[188:191], v7 offset:2176
    v_mfma_f32_16x16x32_bf16 v[220:223], v[104:107], v[192:195], v[220:223]
    s_cmp_lg_u32 s14, 2
    s_cbranch_scc1 L_ES0
    buffer_store_dwordx4 v[204:207], v33, s[44:47], s13 offen
L_EB0:
    s_add_u32 s13, s13, 0x1000
    v_mfma_f32_16x16x32_bf16 v[224:227], v[136:139], v[192:195], v[224:227]
    v_mfma_f32_16x16x32_bf16 v[228:231], v[168:171], v[192:195], v[228:231]
    s_waitcnt lgkmcnt(5)
    s_nop 0
    v_mfma_f32_16x16x32_bf16 v[216:219], v[68:71], v[196:199], v[216:219]
    ds_read_b128 v[192:195], v7 offset:2112
    v_mfma_f32_16x16x32_bf16 v[220:223], v[100:103], v[196:199], v[220:223]
    v_mfma_f32_16x16x32_bf16 v[224:227], v[132:135], v[196:199], v[224:227]
    v_mfma_f32_16x16x32_bf16 v[228:231], v[164:167], v[196:199], v[228:231]
    s_waitcnt lgkmcnt(5)
    s_nop 0
    v_mfma_f32_16x16x32_bf16 v[216:219], v[64:67], v[200:203], v[216:219]
    ds_read_b128 v[196:199], v7 offset:2048
    v_mfma_f32_16x16x32_bf16 v[220:223], v[96:99], v[200:203], v[220:223]
    v_mfma_f32_16x16x32_bf16 v[224:227], v[128:131], v[200:203], v[224:227]
    v_mfma_f32_16x16x32_bf16 v[228:231], v[160:163], v[200:203], v[228:231]
    s_waitcnt lgkmcnt(4)
    v_mfma_f32_16x16x32_bf16 v[220:223], v[236:239], v[180:183], v[220:223]
    ds_read_b128 v[200:203], v7 offset:1984
    v_mfma_f32_16x16x32_bf16 v[224:227], v[240:243], v[180:183], v[224:227]
    s_waitcnt lgkmcnt(4)
    v_mfma_f32_16x16x32_bf16 v[216:219], v[60:63], v[184:187], v[216:219]
    ds_read_b128 v[180:183], v7 offset:1920
    v_mfma_f32_16x16x32_bf16 v[220:223], v[92:95], v[184:187], v[220:223]
    v_mfma_f32_16x16x32_bf16 v[224:227], v[124:127], v[184:187], v[224:227]
    v_mfma_f32_16x16x32_bf16 v[228:231], v[156:159], v[184:187], v[228:231]
    s_waitcnt lgkmcnt(4)
    s_nop 0
    v_mfma_f32_16x16x32_bf16 v[216:219], v[56:59], v[188:191], v[216:219]
    ds_read_b128 v[184:187], v7 offset:1856
    v_mfma_f32_16x16x32_bf16 v[220:223], v[88:91], v[188:191], v[220:223]
    v_mfma_f32_16x16x32_bf16 v[224:227], v[120:123], v[188:191], v[224:227]
    v_mfma_f32_16x16x32_bf16 v[228:231], v[152:155], v[188:191], v[228:231]
    s_waitcnt lgkmcnt(4)
    s_nop 0
    v_mfma_f32_16x16x32_bf16 v[216:219], v[52:55], v[192:195], v[216:219]
    ds_read_b128 v[188:191], v7 offset:1792
    v_mfma_f32_16x16x32_bf16 v[220:223], v[84:87], v[192:195], v[220:223]
    v_mfma_f32_16x16x32_bf16 v[224:227], v[116:119], v[192:195], v[224:227]
    v_mfma_f32_16x16x32_bf16 v[228:231], v[148:151], v[192:195], v[228:231]
    s_waitcnt lgkmcnt(4)
    s_nop 0
    v_mfma_f32_16x16x32_bf16 v[216:219], v[48:51], v[196:199], v[216:219]
    ds_read_b64 v[192:193], v2 offset:9528
    ds_read_b64 v[194:195], v2 offset:10168
    v_mfma_f32_16x16x32_bf16 v[220:223], v[80:83], v[196:199], v[220:223]
    v_mfma_f32_16x16x32_bf16 v[224:227], v[112:115], v[196:199], v[224:227]
    v_mfma_f32_16x16x32_bf16 v[228:231], v[144:147], v[196:199], v[228:231]
    v_mfma_f32_16x16x32_bf16 v[232:235], v[176:179], v[196:199], 0
    s_waitcnt lgkmcnt(5)
    s_nop 0
    v_mfma_f32_16x16x32_bf16 v[220:223], v[76:79], v[200:203], v[220:223]
    ds_read_b128 v[196:199], v7 offset:1728
    v_mfma_f32_16x16x32_bf16 v[224:227], v[108:111], v[200:203], v[224:227]
    ds_write_b128 v8, v[212:215] offset:2048
    v_mfma_f32_16x16x32_bf16 v[228:231], v[140:143], v[200:203], v[228:231]
    ds_write_b128 v8, v[216:219] offset:3072
    v_mfma_f32_16x16x32_bf16 v[232:235], v[172:175], v[200:203], v[232:235]
    s_mov_b64 exec, 1
    ds_write_b32 v4, v5 offset:16
    s_mov_b64 exec, -1
    s_waitcnt lgkmcnt(8)
    s_nop 0
    v_mfma_f32_16x16x32_bf16 v[220:223], v[72:75], v[180:183], v[220:223]
    ds_read_b128 v[200:203], v7 offset:1664
    v_mfma_f32_16x16x32_bf16 v[224:227], v[104:107], v[180:183], v[224:227]
    v_mfma_f32_16x16x32_bf16 v[228:231], v[136:139], v[180:183], v[228:231]
    v_mfma_f32_16x16x32_bf16 v[232:235], v[168:171], v[180:183], v[232:235]
    s_waitcnt lgkmcnt(8)
    s_nop 0
    v_mfma_f32_16x16x32_bf16 v[220:223], v[68:71], v[184:187], v[220:223]
    ds_read_b128 v[180:183], v7 offset:1600
    v_mfma_f32_16x16x32_bf16 v[224:227], v[100:103], v[184:187], v[224:227]
    ds_read_b32 v11, v6 offset:16
    v_mfma_f32_16x16x32_bf16 v[228:231], v[132:135], v[184:187], v[228:231]
    v_mfma_f32_16x16x32_bf16 v[232:235], v[164:167], v[184:187], v[232:235]
    s_waitcnt lgkmcnt(9)
    v_mfma_f32_16x16x32_bf16 v[220:223], v[64:67], v[188:191], v[220:223]
    ds_read_b128 v[184:187], v7 offset:1536
    v_mfma_f32_16x16x32_bf16 v[224:227], v[96:99], v[188:191], v[224:227]
    s_waitcnt lgkmcnt(1)
    v_cmp_eq_u32 vcc, 0, v11
    s_cbranch_vccnz L_SLOW1
L_BACK1:
    v_mfma_f32_16x16x32_bf16 v[228:231], v[128:131], v[188:191], v[228:231]
    ds_read_b64 v[212:213], v9 offset:2048
    v_mfma_f32_16x16x32_bf16 v[232:235], v[160:163], v[188:191], v[232:235]
    ds_read_b64 v[214:215], v9 offset:10240
    v_mfma_f32_16x16x32_bf16 v[224:227], v[236:239], v[192:195], v[224:227]
    ds_read_b128 v[188:191], v7 offset:1472
    ds_read_b64 v[216:217], v9 offset:18432
    v_mfma_f32_16x16x32_bf16 v[220:223], v[60:63], v[196:199], v[220:223]
    ds_read_b128 v[192:195], v7 offset:1408
    v_mfma_f32_16x16x32_bf16 v[224:227], v[92:95], v[196:199], v[224:227]
    ds_read_b64 v[218:219], v9 offset:26624
    s_waitcnt lgkmcnt(0)
    v_lshlrev_b32 v36, 16, v20
    v_mfma_f32_16x16x32_bf16 v[228:231], v[124:127], v[196:199], v[228:231]
    v_and_b32 v37, 0xffff0000, v20
    v_lshlrev_b32_e64 v38, 16, v21
    v_mfma_f32_16x16x32_bf16 v[232:235], v[156:159], v[196:199], v[232:235]
    v_and_b32 v39, 0xffff0000, v21
    v_lshlrev_b32_e64 v40, 16, v22
    v_mfma_f32_16x16x32_bf16 v[220:223], v[56:59], v[200:203], v[220:223]
    ds_read_b128 v[196:199], v7 offset:1344
    v_mfma_f32_16x16x32_bf16 v[224:227], v[88:91], v[200:203], v[224:227]
    v_and_b32 v41, 0xffff0000, v22
    v_lshlrev_b32_e64 v42, 16, v23
    v_mfma_f32_16x16x32_bf16 v[228:231], v[120:123], v[200:203], v[228:231]
    v_and_b32 v43, 0xffff0000, v23
    v_add_f32_e64 v36, v212, v36
    v_mfma_f32_16x16x32_bf16 v[232:235], v[152:155], v[200:203], v[232:235]
    v_add_f32 v37, v214, v37
    v_add_f32 v38, v216, v38
    v_mfma_f32_16x16x32_bf16 v[220:223], v[52:55], v[180:183], v[220:223]
    ds_read_b128 v[200:203], v7 offset:1280
    v_mfma_f32_16x16x32_bf16 v[224:227], v[84:87], v[180:183], v[224:227]
    v_add_f32 v39, v218, v39
    v_add_f32 v40, v213, v40
    v_mfma_f32_16x16x32_bf16 v[228:231], v[116:119], v[180:183], v[228:231]
    v_add_f32 v41, v215, v41
    v_add_f32 v42, v217, v42
    v_mfma_f32_16x16x32_bf16 v[232:235], v[148:151], v[180:183], v[232:235]
    v_add_f32_e64 v43, v219, v43
    v_mfma_f32_16x16x32_bf16 v[220:223], v[48:51], v[184:187], v[220:223]
    ds_read_b128 v[180:183], v7 offset:1216
    v_mfma_f32_16x16x32_bf16 v[224:227], v[80:83], v[184:187], v[224:227]
    v_cvt_pk_bf16_f32 v212, v36, v37
    v_mfma_f32_16x16x32_bf16 v[228:231], v[112:115], v[184:187], v[228:231]
    v_cvt_pk_bf16_f32 v213, v38, v39
    v_mfma_f32_16x16x32_bf16 v[232:235], v[144:147], v[184:187], v[232:235]
    v_cvt_pk_bf16_f32 v214, v40, v41
    v_mfma_f32_16x16x32_bf16 v[224:227], v[76:79], v[188:191], v[224:227]
    ds_read_b128 v[184:187], v7 offset:1152
    v_mfma_f32_16x16x32_bf16 v[228:231], v[108:111], v[188:191], v[228:231]
    v_cvt_pk_bf16_f32 v215, v42, v43
    v_mfma_f32_16x16x32_bf16 v[232:235], v[140:143], v[188:191], v[232:235]
    s_cmp_lg_u32 s14, 2
    s_cbranch_scc1 L_ES1
    buffer_store_dwordx4 v[212:215], v33, s[44:47], s13 offen
L_EB1:
    s_add_u32 s13, s13, 0x1000
    v_mfma_f32_16x16x32_bf16 v[224:227], v[72:75], v[192:195], v[224:227]
    ds_read_b128 v[188:191], v7 offset:1088
    v_mfma_f32_16x16x32_bf16 v[228:231], v[104:107], v[192:195], v[228:231]
    s_waitcnt vmcnt(0)
    s_mov_b64 exec, 1
    buffer_store_dword v34, off, s[44:47], s12 offset:0
    s_mov_b64 exec, -1
    v_mfma_f32_16x16x32_bf16 v[232:235], v[136:139], v[192:195], v[232:235]
    s_waitcnt lgkmcnt(4)
    v_mfma_f32_16x16x32_bf16 v[224:227], v[68:71], v[196:199], v[224:227]
    ds_read_b128 v[192:195], v7 offset:1024
    v_mfma_f32_16x16x32_bf16 v[228:231], v[100:103], v[196:199], v[228:231]
    v_mfma_f32_16x16x32_bf16 v[232:235], v[132:135], v[196:199], v[232:235]
    s_waitcnt lgkmcnt(4)
    v_mfma_f32_16x16x32_bf16 v[224:227], v[64:67], v[200:203], v[224:227]
    ds_read_b128 v[196:199], v7 offset:960
    v_mfma_f32_16x16x32_bf16 v[228:231], v[96:99], v[200:203], v[228:231]
    v_mfma_f32_16x16x32_bf16 v[232:235], v[128:131], v[200:203], v[232:235]
    s_waitcnt lgkmcnt(4)
    v_mfma_f32_16x16x32_bf16 v[224:227], v[60:63], v[180:183], v[224:227]
    ds_read_b128 v[200:203], v7 offset:896
    v_mfma_f32_16x16x32_bf16 v[228:231], v[92:95], v[180:183], v[228:231]
    v_mfma_f32_16x16x32_bf16 v[232:235], v[124:127], v[180:183], v[232:235]
    s_waitcnt lgkmcnt(4)
    s_nop 0
    v_mfma_f32_16x16x32_bf16 v[224:227], v[56:59], v[184:187], v[224:227]
    ds_read_b64 v[180:181], v2 offset:9496
    ds_read_b64 v[182:183], v2 offset:10136
    v_mfma_f32_16x16x32_bf16 v[228:231], v[88:91], v[184:187], v[228:231]
    v_mfma_f32_16x16x32_bf16 v[232:235], v[120:123], v[184:187], v[232:235]
    s_waitcnt lgkmcnt(5)
    v_mfma_f32_16x16x32_bf16 v[224:227], v[52:55], v[188:191], v[224:227]
    ds_read_b128 v[184:187], v7 offset:832
    v_mfma_f32_16x16x32_bf16 v[228:231], v[84:87], v[188:191], v[228:231]
    v_mfma_f32_16x16x32_bf16 v[232:235], v[116:119], v[188:191], v[232:235]
    s_waitcnt lgkmcnt(5)
    v_mfma_f32_16x16x32_bf16 v[224:227], v[48:51], v[192:195], v[224:227]
    ds_read_b128 v[188:191], v7 offset:768
    v_mfma_f32_16x16x32_bf16 v[228:231], v[80:83], v[192:195], v[228:231]
    v_mfma_f32_16x16x32_bf16 v[232:235], v[112:115], v[192:195], v[232:235]
    s_waitcnt lgkmcnt(5)
    s_nop 0
    v_mfma_f32_16x16x32_bf16 v[228:231], v[76:79], v[196:199], v[228:231]
    ds_read_b128 v[192:195], v7 offset:704
    ds_write_b128 v8, v[220:223] offset:4096
    v_mfma_f32_16x16x32_bf16 v[232:235], v[108:111], v[196:199], v[232:235]
    ds_write_b128 v8, v[224:227] offset:5120
    s_mov_b64 exec, 1
    ds_write_b32 v4, v5 offset:32
    s_mov_b64 exec, -1
    s_waitcnt lgkmcnt(8)
    v_mfma_f32_16x16x32_bf16 v[228:231], v[72:75], v[200:203], v[228:231]
    ds_read_b64 v[196:197], v2 offset:9528
    ds_read_b64 v[198:199], v2 offset:10168
    v_mfma_f32_16x16x32_bf16 v[232:235], v[104:107], v[200:203], v[232:235]
    s_waitcnt lgkmcnt(8)
    v_mfma_f32_16x16x32_bf16 v[228:231], v[244:247], v[180:183], v[228:231]
    ds_read_b128 v[200:203], v7 offset:640
    v_mfma_f32_16x16x32_bf16 v[232:235], v[248:251], v[180:183], v[232:235]
    s_waitcnt lgkmcnt(8)
    s_nop 0
    v_mfma_f32_16x16x32_bf16 v[228:231], v[68:71], v[184:187], v[228:231]
    ds_read_b128 v[180:183], v7 offset:576
    ds_read_b32 v11, v6 offset:32
    v_mfma_f32_16x16x32_bf16 v[232:235], v[100:103], v[184:187], v[232:235]
    ds_read_b32 v15, v6 offset:112
    s_waitcnt lgkmcnt(10)
    v_mfma_f32_16x16x32_bf16 v[228:231], v[64:67], v[188:191], v[228:231]
    ds_read_b64 v[184:185], v2 offset:9560
    ds_read_b64 v[186:187], v2 offset:10200
    v_mfma_f32_16x16x32_bf16 v[232:235], v[96:99], v[188:191], v[232:235]
    s_waitcnt lgkmcnt(11)
    v_mfma_f32_16x16x32_bf16 v[228:231], v[60:63], v[192:195], v[228:231]
    ds_read_b128 v[188:191], v7 offset:512
    s_waitcnt lgkmcnt(3)
    v_min_u32 v11, v11, v15
    v_cmp_eq_u32 vcc, 0, v11
    s_cbranch_vccnz L_SLOW2
L_BACK2:
    v_mfma_f32_16x16x32_bf16 v[232:235], v[92:95], v[192:195], v[232:235]
    ds_read_b64 v[12:13], v10 offset:1152
    ds_read_b64 v[220:221], v9 offset:4096
    v_mfma_f32_16x16x32_bf16 v[228:231], v[240:243], v[196:199], v[228:231]
    ds_read_b128 v[192:195], v7 offset:448
    ds_read_b64 v[222:223], v9 offset:12288
    v_mfma_f32_16x16x32_bf16 v[232:235], v[244:247], v[196:199], v[232:235]
    ds_read_b64 v[224:225], v9 offset:20480
    ds_read_b64 v[226:227], v9 offset:28672
    v_mfma_f32_16x16x32_bf16 v[228:231], v[56:59], v[200:203], v[228:231]
    ds_read_b128 v[196:199], v7 offset:384
    s_waitcnt vmcnt(0)
    s_mov_b64 exec, 1
    buffer_store_dword v34, off, s[44:47], s12 offset:512
    s_mov_b64 exec, -1
    v_mfma_f32_16x16x32_bf16 v[232:235], v[88:91], v[200:203], v[232:235]
    v_mfma_f32_16x16x32_bf16 v[228:231], v[52:55], v[180:183], v[228:231]
    ds_read_b128 v[200:203], v7 offset:320
    s_waitcnt lgkmcnt(2)
    v_lshlrev_b32_e64 v36, 16, v24
    v_mfma_f32_16x16x32_bf16 v[232:235], v[84:87], v[180:183], v[232:235]
    v_and_b32 v37, 0xffff0000, v24
    v_lshlrev_b32_e64 v38, 16, v25
    v_mfma_f32_16x16x32_bf16 v[228:231], v[236:239], v[184:187], v[228:231]
    ds_read_b64 v[180:181], v2 offset:9592
    ds_read_b64 v[182:183], v2 offset:10232
    v_and_b32 v39, 0xffff0000, v25
    v_mfma_f32_16x16x32_bf16 v[232:235], v[240:243], v[184:187], v[232:235]
    v_lshlrev_b32_e64 v40, 16, v26
    v_and_b32 v41, 0xffff0000, v26
    v_mfma_f32_16x16x32_bf16 v[228:231], v[48:51], v[188:191], v[228:231]
    ds_read_b128 v[184:187], v7 offset:256
    v_lshlrev_b32_e64 v42, 16, v27
    v_mfma_f32_16x16x32_bf16 v[232:235], v[80:83], v[188:191], v[232:235]
    v_and_b32 v43, 0xffff0000, v27
    v_add_f32_e64 v36, v220, v36
    v_mfma_f32_16x16x32_bf16 v[232:235], v[76:79], v[192:195], v[232:235]
    ds_read_b128 v[188:191], v7 offset:192
    v_add_f32_e64 v37, v222, v37
    ds_write_b128 v8, v[228:231] offset:6144
    s_waitcnt lgkmcnt(6)
    v_mfma_f32_16x16x32_bf16 v[232:235], v[72:75], v[196:199], v[232:235]
    ds_read_b128 v[192:195], v7 offset:128
    v_add_f32_e64 v38, v224, v38
    s_waitcnt lgkmcnt(6)
    v_mfma_f32_16x16x32_bf16 v[232:235], v[68:71], v[200:203], v[232:235]
    ds_read_b128 v[196:199], v7 offset:64
    v_add_f32 v39, v226, v39
    s_waitcnt lgkmcnt(5)
    v_mfma_f32_16x16x32_bf16 v[232:235], v[236:239], v[180:183], v[232:235]
    ds_read_b128 v[200:203], v7 offset:0
    v_add_f32 v40, v221, v40
    s_waitcnt lgkmcnt(5)
    v_mfma_f32_16x16x32_bf16 v[232:235], v[64:67], v[184:187], v[232:235]
    v_add_f32 v41, v223, v41
    v_add_f32_e64 v42, v225, v42
    s_waitcnt lgkmcnt(4)
    v_mfma_f32_16x16x32_bf16 v[232:235], v[60:63], v[188:191], v[232:235]
    v_add_f32_e64 v43, v227, v43
    v_cvt_pk_bf16_f32 v220, v36, v37
    s_waitcnt lgkmcnt(2)
    v_mfma_f32_16x16x32_bf16 v[232:235], v[56:59], v[192:195], v[232:235]
    v_cvt_pk_bf16_f32 v221, v38, v39
    v_cvt_pk_bf16_f32 v222, v40, v41
    s_waitcnt lgkmcnt(1)
    v_mfma_f32_16x16x32_bf16 v[232:235], v[52:55], v[196:199], v[232:235]
    v_cvt_pk_bf16_f32 v223, v42, v43
    s_cmp_lg_u32 s14, 2
    s_cbranch_scc1 L_ES2
    buffer_store_dwordx4 v[220:223], v33, s[44:47], s13 offen
L_EB2:
    s_add_u32 s13, s13, 0x1000
    s_waitcnt lgkmcnt(0)
    v_mfma_f32_16x16x32_bf16 v[232:235], v[48:51], v[200:203], v[232:235]
    s_nop 7
    ds_write_b128 v8, v[232:235] offset:7168
    s_mov_b64 exec, 1
    ds_write_b32 v4, v5 offset:48
    s_mov_b64 exec, -1
    s_waitcnt vmcnt(0)
    s_mov_b64 exec, 1
    buffer_store_dword v34, off, s[44:47], s12 offset:1024
    s_mov_b64 exec, -1
    v_lshlrev_b32 v36, 16, v28
    v_and_b32 v37, 0xffff0000, v28
    v_lshlrev_b32_e64 v38, 16, v29
    v_and_b32 v39, 0xffff0000, v29
    v_lshlrev_b32_e64 v40, 16, v30
    v_and_b32 v41, 0xffff0000, v30
    v_lshlrev_b32_e64 v42, 16, v31
    v_and_b32 v43, 0xffff0000, v31
LW_4:
    ds_read_b32 v11, v6 offset:48
    s_waitcnt lgkmcnt(0)
    v_cmp_eq_u32_e64 vcc, 0, v11
    s_cbranch_vccnz LW_4
    ds_read_b64 v[228:229], v9 offset:6144
    ds_read_b64 v[230:231], v9 offset:14336
    ds_read_b64 v[232:233], v9 offset:22528
    ds_read_b64 v[234:235], v9 offset:30720
    s_waitcnt lgkmcnt(0)
    v_add_f32 v36, v228, v36
    v_add_f32 v37, v230, v37
    v_add_f32 v38, v232, v38
    v_add_f32 v39, v234, v39
    v_add_f32 v40, v229, v40
    v_add_f32 v41, v231, v41
    v_add_f32 v42, v233, v42
    v_add_f32_e64 v43, v235, v43
    v_cvt_pk_bf16_f32 v228, v36, v37
    v_cvt_pk_bf16_f32 v229, v38, v39
    v_cvt_pk_bf16_f32 v230, v40, v41
    v_cvt_pk_bf16_f32 v231, v42, v43
    s_cmp_lg_u32 s14, 2
    s_cbranch_scc1 L_ES3
    buffer_store_dwordx4 v[228:231], v33, s[44:47], s13 offen
L_EB3:
    s_add_u32 s13, s13, 0x1000
    s_waitcnt vmcnt(0)
    s_mov_b64 exec, 1
    buffer_store_dword v34, off, s[44:47], s12 offset:1536
    s_mov_b64 exec, -1
    s_branch L_FIN
L_SLOW0:
LW_5:
    ds_read_b32 v11, v6 offset:144
    s_waitcnt lgkmcnt(0)
    v_cmp_eq_u32 vcc, 0, v11
    s_cbranch_vccnz LW_5
    s_branch L_BACK0
L_SLOW1:
LW_6:
    ds_read_b32 v11, v6 offset:16
    s_waitcnt lgkmcnt(0)
    v_cmp_eq_u32 vcc, 0, v11
    s_cbranch_vccnz LW_6
    s_branch L_BACK1
L_SLOW2:
LW_7:
    ds_read_b32 v11, v6 offset:32
    s_waitcnt lgkmcnt(0)
    v_cmp_eq_u32_e64 vcc, 0, v11
    s_cbranch_vccnz LW_7
LW_8:
    ds_read_b32 v11, v6 offset:112
    s_waitcnt lgkmcnt(0)
    v_cmp_eq_u32 vcc, 0, v11
    s_cbranch_vccnz LW_8
    s_branch L_BACK2
L_ES0:
LW_9:
    ds_read_b32 v11, v6 offset:112
    s_waitcnt lgkmcnt(0)
    v_cmp_eq_u32_e64 vcc, 0, v11
    s_cbranch_vccnz LW_9
    ds_read_b64 v[12:13], v10 offset:1152
    s_waitcnt lgkmcnt(0)
    v_lshlrev_b32 v14, 24, v12
    v_and_or_b32 v14, v14, s68, v3
    v_lshlrev_b32_e64 v15, 16, v12
    v_and_or_b32 v15, v15, s68, v3
    buffer_store_dwordx2 v[204:205], v14, s[52:55], s60 offen offset:0
    buffer_store_dwordx2 v[206:207], v15, s[52:55], s60 offen offset:2048
    s_branch L_EB0
L_ES1:
LW_10:
    ds_read_b32 v11, v6 offset:112
    s_waitcnt lgkmcnt(0)
    v_cmp_eq_u32 vcc, 0, v11
    s_cbranch_vccnz LW_10
    ds_read_b64 v[12:13], v10 offset:1152
    s_waitcnt lgkmcnt(0)
    v_lshlrev_b32 v14, 8, v12
    v_and_or_b32 v14, v14, s68, v3
    v_and_or_b32 v15, v12, s68, v3
    buffer_store_dwordx2 v[212:213], v14, s[52:55], s61 offen offset:0
    buffer_store_dwordx2 v[214:215], v15, s[52:55], s61 offen offset:2048
    s_branch L_EB1
L_ES2:
    v_lshlrev_b32 v14, 24, v13
    v_and_or_b32 v14, v14, s68, v3
    v_lshlrev_b32_e64 v15, 16, v13
    v_and_or_b32 v15, v15, s68, v3
    buffer_store_dwordx2 v[220:221], v14, s[52:55], s62 offen offset:0
    buffer_store_dwordx2 v[222:223], v15, s[52:55], s62 offen offset:2048
    s_branch L_EB2
L_ES3:
    v_lshlrev_b32 v14, 8, v13
    v_and_or_b32 v14, v14, s68, v3
    v_and_or_b32 v15, v13, s68, v3
    buffer_store_dwordx2 v[228:229], v14, s[52:55], s63 offen offset:0
    buffer_store_dwordx2 v[230:231], v15, s[52:55], s63 offen offset:2048
    s_branch L_EB3
L_XSLOW:
    s_nop 0
    buffer_load_dwordx2 v[16:17], v3, s[48:51], s60 offen offset:0
    buffer_load_dwordx2 v[18:19], v3, s[48:51], s60 offen offset:2048
    buffer_load_dwordx2 v[20:21], v3, s[48:51], s61 offen offset:0
    buffer_load_dwordx2 v[22:23], v3, s[48:51], s61 offen offset:2048
    buffer_load_dwordx2 v[24:25], v3, s[48:51], s62 offen offset:0
    buffer_load_dwordx2 v[26:27], v3, s[48:51], s62 offen offset:2048
    buffer_load_dwordx2 v[28:29], v3, s[48:51], s63 offen offset:0
    buffer_load_dwordx2 v[30:31], v3, s[48:51], s63 offen offset:2048
    s_branch L_XBACK
L_F0:
    s_setprio 2
    s_mov_b32 s61, 32768
    s_lshl_b32 s7, s2, 2
    s_add_u32 s7, s7, s3
    s_lshl_b32 s13, s2, 6
    s_add_u32 s13, s13, 32768
    s_lshl_b32 s8, s7, 12
    v_and_b32 v10, 31, v0
    v_lshlrev_b32 v10, 4, v10
    v_lshrrev_b32_e64 v11, 5, v0
    v_lshl_add_u32 v11, v11, 11, v10
    v_add_u32 v11, s8, v11
    s_cmp_lt_u32 s6, 28
    s_cselect_b32 s69, 1, 0
    s_lshr_b32 s8, s6, 2
    s_add_u32 s9, s5, 3
    s_and_b32 s9, s9, 7
    s_min_u32 s9, s9, 6
    s_cmp_lt_u32 s6, 28
    s_cselect_b32 s8, s8, s9
    s_mul_i32 s59, s5, 7
    s_add_u32 s59, s59, s8
    s_and_b32 s68, s6, 3
    s_lshl_b32 s8, s68, 2
    s_add_u32 s8, s8, s3
    s_lshl_b32 s8, s8, 6
    s_xor_b32 s9, s69, 1
    s_lshl_b32 s9, s9, 5
    s_add_u32 s8, s8, s9
    v_lshrrev_b32_e64 v12, 4, v0
    v_lshl_add_u32 v12, v12, 3, s8
    v_lshlrev_b32 v9, 1, v12
    s_movk_i32 s10, 7168
    v_mul_u32_u24 v14, s10, v12
    v_and_b32 v12, 7, v0
    v_lshl_add_u32 v14, v12, 4, v14
    s_lshl_b32 s8, s59, 7
    v_add_u32 v14, s8, v14
    v_and_b32 v12, 8, v0
    v_cmp_ne_u32_e64 vcc, 0, v12
    s_waitcnt lgkmcnt(0)
    global_load_dwordx4 v[16:19], v11, s[16:17] offset:0
    global_load_dwordx4 v[20:23], v11, s[16:17] offset:512
    global_load_dwordx4 v[24:27], v11, s[16:17] offset:1024
    global_load_dwordx4 v[28:31], v11, s[16:17] offset:1536
    s_load_dword s56, s[42:43], 0
    global_load_dwordx4 v[32:35], v10, s[32:33] offset:0
    global_load_dwordx4 v[36:39], v10, s[32:33] offset:512
    global_load_dwordx4 v[40:43], v10, s[32:33] offset:1024
    global_load_dwordx4 v[44:47], v10, s[32:33] offset:1536
    v_mov_b32 v12, s34
    v_mov_b32 v13, s35
    v_mov_b32 v10, s36
    v_mov_b32 v11, s37
    v_cndmask_b32 v12, v12, v10, vcc
    v_cndmask_b32 v13, v13, v11, vcc
    v_add_co_u32 v220, vcc, v12, v14
    s_movk_i32 s20, 7168
    s_mov_b32 s21, 0
    v_addc_co_u32 v221, vcc, 0, v13, vcc
    s_barrier
    s_mov_b32 s48, s16
    s_and_b32 s49, s17, 0xffff
    s_mov_b32 s50, 0x400000
    s_mov_b32 s51, 0x20000
    s_mov_b32 s52, s40
    s_and_b32 s53, s41, 0xffff
    s_mov_b32 s54, 0x400000
    s_mov_b32 s55, 0x20000
    s_lshl_b32 s8, s6, 17
    s_lshl_b32 s9, s3, 15
    s_add_u32 s8, s8, s9
    s_lshl_b32 s9, s5, 8
    s_add_u32 s8, s8, s9
    s_add_u32 s9, s8, 4096
    v_lshrrev_b32 v10, 4, v0
    v_and_b32 v11, 15, v0
    v_lshlrev_b32_e64 v11, 4, v11
    v_lshl_add_u32 v14, v10, 13, v11
    buffer_load_dwordx4 v[64:67], v14, s[48:51], s8 offen offset:0
    buffer_load_dwordx4 v[68:71], v14, s[48:51], s8 offen offset:2048
    buffer_load_dwordx4 v[72:75], v14, s[48:51], s9 offen offset:0
    buffer_load_dwordx4 v[76:79], v14, s[48:51], s9 offen offset:2048
    s_mul_i32 s8, s3, 4608
    s_add_u32 s8, s8, 121856
    s_movk_i32 s9, 1088
    v_mad_u32_u24 v96, v10, s9, v11
    v_add_u32 v96, s8, v96
    v_and_b32 v10, 7, v0
    v_lshrrev_b32_e64 v11, 3, v0
    s_movk_i32 s9, 544
    v_lshl_add_u32 v97, v11, 3, s8
    v_mad_u32_u24 v97, v10, s9, v97
    v_lshlrev_b32_e64 v98, 4, v10
    v_lshl_add_u32 v98, v11, 14, v98
    s_lshl_b32 s18, s5, 19
    s_lshl_b32 s9, s6, 9
    s_add_u32 s18, s18, s9
    s_lshl_b32 s9, s3, 7
    s_add_u32 s18, s18, s9
    s_add_u32 s18, s18, 3145728
    s_getreg_b32 s19, hwreg(HW_REG_XCC_ID, 0, 4)
    s_mov_b32 s22, 179200
    s_cmp_eq_u32 s69, 1
    s_cselect_b32 s22, s22, 0xfffbbc00
    s_cselect_b32 s23, 0, -1
    s_lshl_b32 s62, s5, 2
    s_bfe_u32 s9, s6, 0x20001
    s_add_u32 s62, s62, s9
    s_lshl_b32 s62, s62, 5
    s_lshr_b32 s9, s6, 3
    s_lshl_b32 s9, s9, 1
    s_add_u32 s62, s62, s9
    s_and_b32 s9, s6, 1
    s_add_u32 s62, s62, s9
    s_lshl_b32 s62, s62, 2
    s_add_u32 s62, s62, 983040
    s_lshl_b32 s19, s19, 1
    s_lshl_b32 s9, s5, 2
    s_lshl_b32 s40, 15, s9
    s_mov_b32 s41, s40
    s_mov_b32 s44, s42
    s_and_b32 s45, s43, 0xffff
    s_mov_b32 s46, 0x1000000
    s_mov_b32 s47, 0x20000
    s_mov_b32 s24, s38
    s_and_b32 s25, s39, 0xffff
    s_mov_b32 s26, 0x700000
    s_mov_b32 s27, 0x20000
    s_lshl_b32 s7, s3, 2
    v_mov_b32 v2, s7
    v_and_b32 v11, 3, v0
    v_lshlrev_b32 v1, 2, v11
    v_mov_b32 v5, 1
    s_lshl_b32 s8, s3, 6
    v_add_u32 v14, s8, v0
    v_lshlrev_b32_e64 v226, 4, v14
    s_mov_b32 s5, 36864
    s_mov_b32 s6, 40960
    s_mov_b32 s7, 45056
    s_cmp_lg_u32 s3, 0
    s_cbranch_scc1 L_NOZ
    v_lshlrev_b32 v224, 4, v0
    v_mov_b32 v228, 0
    v_mov_b32 v229, 0
    v_mov_b32 v230, 0
    v_mov_b32_e64 v231, 0
    ds_write_b128 v224, v[228:231] offset:1024
    ds_write_b128 v224, v[228:231] offset:2048
    ds_write_b128 v224, v[228:231] offset:3072
L_NOZ:
    s_lshl_b32 s4, s3, 6
    v_add_u32 v14, s4, v0
    v_lshlrev_b32_e64 v15, 4, v14
    s_mov_b32 s64, 0x05040100
    s_mov_b32 s65, 0x07060302
    v_lshlrev_b32 v224, 4, v0
    v_and_b32 v10, 15, v0
    v_lshlrev_b32 v10, 2, v10
    v_and_b32 v11, 48, v0
    s_movk_i32 s4, 0xfff
    v_lshlrev_b32 v248, 1, v14
    v_sub_u32 v248, s4, v248
    v_subrev_u32 v249, 1, v248
    v_subrev_u32 v250, 512, v248
    v_subrev_u32 v251, 513, v248
    v_subrev_u32 v252, 1024, v248
    v_subrev_u32 v253, 1025, v248
    v_subrev_u32 v254, 1536, v248
    v_subrev_u32 v255, 1537, v248
    v_lshlrev_b32 v227, 3, v14
    v_lshrrev_b32 v225, 4, v14
    v_lshlrev_b32 v225, 2, v225
    v_lshlrev_b32_e64 v14, 2, v14
    s_mov_b32 s16, 0
    s_mov_b32 s17, 0xffff0000
    v_lshlrev_b32 v3, 3, v11
    s_lshl_b32 s8, s3, 12
    s_add_u32 s8, s8, 140288
    v_add_u32 v3, s8, v3
    v_lshrrev_b32 v12, 5, v0
    v_lshlrev_b32_e64 v4, 7, v12
    v_bfe_u32 v12, v0, 4, 1
    v_lshl_add_u32 v4, v12, 3, v4
    v_bfe_u32 v12, v0, 3, 1
    v_lshl_add_u32 v4, v12, 9, v4
    v_and_b32_e64 v12, 7, v0
    v_lshl_add_u32 v4, v12, 4, v4
    s_lshl_b32 s8, s3, 10
    s_add_u32 s8, s8, 140288
    v_add_u32 v4, s8, v4
    v_bfe_u32 v12, v0, 4, 1
    v_lshlrev_b32 v12, 16, v12
    v_lshrrev_b32 v13, 5, v0
    v_lshl_add_u32 v12, v13, 12, v12
    v_lshl_add_u32 v222, v10, 1, v12
    s_lshl_b32 s10, s59, 17
    s_lshl_b32 s11, s68, 9
    s_add_u32 s10, s10, s11
    s_lshl_b32 s11, s3, 7
    s_add_u32 s10, s10, s11
    s_mov_b32 s8, 0x3f803f80
    s_waitcnt vmcnt(8)
    v_dot2_f32_bf16 v48, v16, s8, 0
    v_dot2_f32_bf16 v49, v16, v16, 0
    v_dot2_f32_bf16 v48, v17, s8, v48
    v_dot2_f32_bf16 v49, v17, v17, v49
    v_dot2_f32_bf16 v48, v18, s8, v48
    v_dot2_f32_bf16 v49, v18, v18, v49
    v_dot2_f32_bf16 v48, v19, s8, v48
    v_dot2_f32_bf16 v49, v19, v19, v49
    v_dot2_f32_bf16 v48, v20, s8, v48
    v_dot2_f32_bf16 v49, v20, v20, v49
    v_dot2_f32_bf16 v48, v21, s8, v48
    v_dot2_f32_bf16 v49, v21, v21, v49
    v_dot2_f32_bf16 v48, v22, s8, v48
    v_dot2_f32_bf16 v49, v22, v22, v49
    v_dot2_f32_bf16 v48, v23, s8, v48
    v_dot2_f32_bf16 v49, v23, v23, v49
    v_dot2_f32_bf16 v48, v24, s8, v48
    v_dot2_f32_bf16 v49, v24, v24, v49
    v_dot2_f32_bf16 v48, v25, s8, v48
    v_dot2_f32_bf16 v49, v25, v25, v49
    v_dot2_f32_bf16 v48, v26, s8, v48
    v_dot2_f32_bf16 v49, v26, v26, v49
    v_dot2_f32_bf16 v48, v27, s8, v48
    v_dot2_f32_bf16 v49, v27, v27, v49
    v_dot2_f32_bf16 v48, v28, s8, v48
    v_dot2_f32_bf16 v49, v28, v28, v49
    v_dot2_f32_bf16 v48, v29, s8, v48
    v_dot2_f32_bf16 v49, v29, v29, v49
    v_dot2_f32_bf16 v48, v30, s8, v48
    v_dot2_f32_bf16 v49, v30, v30, v49
    v_dot2_f32_bf16 v48, v31, s8, v48
    v_dot2_f32_bf16 v49, v31, v31, v49
    s_waitcnt lgkmcnt(0)
    s_mul_i32 s56, s56, 0x9E3779B1
    s_add_u32 s56, s56, 0x7F4A7C15
    s_or_b32 s56, s56, 1
    s_andn2_b32 s56, s56, 0x1e
    s_or_b32 s63, s19, s56
    v_mov_b32 v59, s63
    s_waitcnt vmcnt(4)
    v_dot2_f32_bf16 v50, v16, v32, 0
    v_dot2_f32_bf16 v51, v32, s8, 0
    v_dot2_f32_bf16 v50, v17, v33, v50
    v_dot2_f32_bf16 v51, v33, s8, v51
    v_dot2_f32_bf16 v50, v18, v34, v50
    v_dot2_f32_bf16 v51, v34, s8, v51
    v_dot2_f32_bf16 v50, v19, v35, v50
    v_dot2_f32_bf16 v51, v35, s8, v51
    v_dot2_f32_bf16 v50, v20, v36, v50
    v_dot2_f32_bf16 v51, v36, s8, v51
    v_dot2_f32_bf16 v50, v21, v37, v50
    v_dot2_f32_bf16 v51, v37, s8, v51
    v_dot2_f32_bf16 v50, v22, v38, v50
    v_dot2_f32_bf16 v51, v38, s8, v51
    v_dot2_f32_bf16 v50, v23, v39, v50
    v_dot2_f32_bf16 v51, v39, s8, v51
    v_dot2_f32_bf16 v50, v24, v40, v50
    v_dot2_f32_bf16 v51, v40, s8, v51
    v_dot2_f32_bf16 v50, v25, v41, v50
    v_dot2_f32_bf16 v51, v41, s8, v51
    v_dot2_f32_bf16 v50, v26, v42, v50
    v_dot2_f32_bf16 v51, v42, s8, v51
    v_dot2_f32_bf16 v50, v27, v43, v50
    v_dot2_f32_bf16 v51, v43, s8, v51
    v_dot2_f32_bf16 v50, v28, v44, v50
    v_dot2_f32_bf16 v51, v44, s8, v51
    v_dot2_f32_bf16 v50, v29, v45, v50
    v_dot2_f32_bf16 v51, v45, s8, v51
    v_dot2_f32_bf16 v50, v30, v46, v50
    v_dot2_f32_bf16 v51, v46, s8, v51
    v_dot2_f32_bf16 v50, v31, v47, v50
    v_dot2_f32_bf16 v51, v47, s8, v51
    s_nop 0
    s_nop 0
    v_add_f32_dpp v48, v48, v48 row_shr:1 row_mask:0xf bank_mask:0xf
    v_add_f32_dpp v49, v49, v49 row_shr:1 row_mask:0xf bank_mask:0xf
    v_add_f32_dpp v50, v50, v50 row_shr:1 row_mask:0xf bank_mask:0xf
    v_add_f32_dpp v51, v51, v51 row_shr:1 row_mask:0xf bank_mask:0xf
    v_add_f32_dpp v48, v48, v48 row_shr:2 row_mask:0xf bank_mask:0xf
    v_add_f32_dpp v49, v49, v49 row_shr:2 row_mask:0xf bank_mask:0xf
    v_add_f32_dpp v50, v50, v50 row_shr:2 row_mask:0xf bank_mask:0xf
    v_add_f32_dpp v51, v51, v51 row_shr:2 row_mask:0xf bank_mask:0xf
    v_add_f32_dpp v48, v48, v48 row_shr:4 row_mask:0xf bank_mask:0xf
    v_add_f32_dpp v49, v49, v49 row_shr:4 row_mask:0xf bank_mask:0xf
    v_add_f32_dpp v50, v50, v50 row_shr:4 row_mask:0xf bank_mask:0xf
    v_add_f32_dpp v51, v51, v51 row_shr:4 row_mask:0xf bank_mask:0xf
    v_add_f32_dpp v48, v48, v48 row_shr:8 row_mask:0xf bank_mask:0xf
    v_add_f32_dpp v49, v49, v49 row_shr:8 row_mask:0xf bank_mask:0xf
    v_add_f32_dpp v50, v50, v50 row_shr:8 row_mask:0xf bank_mask:0xf
    v_add_f32_dpp v51, v51, v51 row_shr:8 row_mask:0xf bank_mask:0xf
    v_add_f32_dpp v48, v48, v48 row_bcast:15 row_mask:0xa bank_mask:0xf
    v_add_f32_dpp v49, v49, v49 row_bcast:15 row_mask:0xa bank_mask:0xf
    v_add_f32_dpp v50, v50, v50 row_bcast:15 row_mask:0xa bank_mask:0xf
    v_add_f32_dpp v51, v51, v51 row_bcast:15 row_mask:0xa bank_mask:0xf
    v_mul_f32 v48, 0x3a800000, v48
    v_mul_f32 v49, 0x3a800000, v49
    v_cvt_pk_bf16_f32 v52, v48, v48
    v_fma_f32 v49, -v48, v48, v49
    v_max_f32_e64 v49, 0, v49
    v_and_b32 v53, 0xffff0000, v52
    v_cvt_pk_bf16_f32 v49, v49, v49
    v_and_b32 v49, 0xffff0000, v49
    v_add_f32 v49, 0x3727c5ac, v49
    v_fma_f32 v50, -v53, v51, v50
    v_cvt_pk_bf16_f32 v49, v49, v49
    v_and_b32 v49, 0xffff0000, v49
    v_sqrt_f32 v49, v49
    v_lshlrev_b32 v104, 2, v2
    v_mov_b32_e64 v61, 0
    v_cvt_pk_bf16_f32 v54, v49, v49
    v_and_b32 v49, 0xffff0000, v54
    v_rcp_f32 v49, v49
    s_nop 0
    v_mul_f32_e64 v50, v50, v49
    v_cvt_pk_bf16_f32 v50, v50, v50
    v_bfe_i32 v51, v50, 15, 1
    v_or_b32 v51, 0x80008000, v51
    v_xor_b32_e64 v55, v50, v51
    s_mov_b32 s8, 0xffff
    v_mov_b32_dpp v56, v52 row_bcast:31 row_mask:0x8 bank_mask:0xf
    v_mov_b32_dpp v57, v54 row_bcast:31 row_mask:0x8 bank_mask:0xf
    v_mov_b32_dpp v58, v55 row_bcast:31 row_mask:0x8 bank_mask:0xf
    v_bfi_b32 v56, s8, v56, v52
    v_bfi_b32 v57, s8, v57, v54
    v_bfi_b32 v58, s8, v58, v55
    s_brev_b64 exec, 1
    ds_write_b128 v104, v[56:59] offset:576
    ds_add_rtn_u32 v60, v61, v5 offset:512
    s_mov_b64 exec, -1
    s_waitcnt lgkmcnt(0)
    v_readlane_b32 s8, v60, 63
    s_cmp_lg_u32 s8, 3
    s_cbranch_scc1 L_NOPUB
    s_mov_b64 exec, 0xf
    ds_read_b128 v[52:55], v224 offset:576
    s_waitcnt lgkmcnt(0)
    buffer_store_dwordx4 v[52:55], v224, s[44:47], s13 offen sc1
    ds_write_b32 v61, v5 offset:516
    s_mov_b64 exec, -1
    s_waitcnt vmcnt(1)
    s_branch L_PUB2
L_NOPUB:
    s_waitcnt vmcnt(0)
L_PUB2:
    s_nop 0
    ds_write_b128 v96, v[64:67] offset:0
    ds_write_b128 v96, v[68:71] offset:272
    ds_write_b128 v96, v[72:75] offset:544
    ds_write_b128 v96, v[76:79] offset:816
    ds_read_b64 v[80:81], v97 offset:0
    ds_read_b64 v[82:83], v97 offset:272
    ds_read_b64 v[84:85], v97 offset:64
    ds_read_b64 v[86:87], v97 offset:336
    ds_read_b64 v[88:89], v97 offset:128
    ds_read_b64 v[90:91], v97 offset:400
    ds_read_b64 v[92:93], v97 offset:192
    ds_read_b64 v[94:95], v97 offset:464
    s_waitcnt lgkmcnt(6)
    buffer_store_dwordx4 v[80:83], v98, s[44:47], s18 offen
    s_add_u32 s18, s18, 0x20000
    s_waitcnt lgkmcnt(4)
    buffer_store_dwordx4 v[84:87], v98, s[44:47], s18 offen
    s_add_u32 s18, s18, 0x20000
    s_waitcnt lgkmcnt(2)
    buffer_store_dwordx4 v[88:91], v98, s[44:47], s18 offen
    s_add_u32 s18, s18, 0x20000
    s_waitcnt lgkmcnt(0)
    buffer_store_dwordx4 v[92:95], v98, s[44:47], s18 offen
    s_add_u32 s18, s18, 0x20000
    s_mov_b64 exec, 1
    ds_write_b32 v2, v59 offset:128
    s_mov_b64 exec, -1
LW_11:
    ds_read_b32 v60, v61 offset:516
    s_waitcnt lgkmcnt(0)
    v_cmp_eq_u32_e64 vcc, 0, v60
    s_cbranch_vccnz LW_11
    s_waitcnt vmcnt(0)
    s_mov_b64 exec, 1
    ds_add_rtn_u32 v60, v61, v5 offset:520
    s_waitcnt lgkmcnt(0)
    v_readfirstlane_b32 s8, v60
    s_cmp_lg_u32 s8, 3
    s_cbranch_scc1 L_NOXF
    buffer_store_dword v59, off, s[44:47], s62
L_NOXF:
    s_mov_b64 exec, -1
    s_nop 0
    global_load_dwordx4 v[112:115], v[220:221], off
    v_lshl_add_u64 v[220:221], s[20:21], 0, v[220:221]
    global_load_dwordx4 v[116:119], v[220:221], off
    v_lshl_add_u64 v[220:221], s[20:21], 0, v[220:221]
    global_load_dwordx4 v[120:123], v[220:221], off
    v_lshl_add_u64 v[220:221], s[20:21], 0, v[220:221]
    global_load_dwordx4 v[124:127], v[220:221], off
    v_lshl_add_u64 v[220:221], s[20:21], 0, v[220:221]
    s_waitcnt vmcnt(3)
    global_load_dwordx4 v[128:131], v[220:221], off
    v_lshl_add_u64 v[220:221], s[20:21], 0, v[220:221]
    s_waitcnt vmcnt(3)
    global_load_dwordx4 v[132:135], v[220:221], off
    v_lshl_add_u64 v[220:221], s[20:21], 0, v[220:221]
    s_waitcnt vmcnt(3)
    buffer_load_dwordx4 v[32:35], v226, s[44:47], s61 offen sc1
    s_waitcnt vmcnt(3)
    buffer_load_dwordx4 v[36:39], v226, s[44:47], s5 offen sc1
    s_waitcnt vmcnt(3)
    buffer_load_dwordx4 v[40:43], v226, s[44:47], s6 offen sc1
    s_waitcnt vmcnt(3)
    buffer_load_dwordx4 v[44:47], v226, s[44:47], s7 offen sc1
    s_waitcnt vmcnt(3)
    global_load_dwordx4 v[136:139], v[220:221], off
    v_lshl_add_u64 v[220:221], s[20:21], 0, v[220:221]
    s_waitcnt vmcnt(3)
    global_load_dwordx4 v[140:143], v[220:221], off
    v_lshl_add_u64 v[220:221], s[22:23], 0, v[220:221]
    s_waitcnt vmcnt(3)
    global_load_dwordx4 v[144:147], v[220:221], off
    v_lshl_add_u64 v[220:221], s[20:21], 0, v[220:221]
    s_waitcnt vmcnt(3)
    global_load_dwordx4 v[148:151], v[220:221], off
    v_lshl_add_u64 v[220:221], s[20:21], 0, v[220:221]
    s_branch L_KPW
L_KP:
    s_sleep 1
    s_mov_b64 exec, s[30:31]
    s_cbranch_execz L_KS0
    buffer_load_dwordx4 v[32:35], v226, s[44:47], s61 offen sc1
L_KS0:
    s_mov_b64 exec, s[8:9]
    s_cbranch_execz L_KS1
    buffer_load_dwordx4 v[36:39], v226, s[44:47], s5 offen sc1
L_KS1:
    s_mov_b64 exec, s[14:15]
    s_cbranch_execz L_KS2
    buffer_load_dwordx4 v[40:43], v226, s[44:47], s6 offen sc1
L_KS2:
    s_mov_b64 exec, s[28:29]
    s_cbranch_execz L_KS3
    buffer_load_dwordx4 v[44:47], v226, s[44:47], s7 offen sc1
L_KS3:
    s_mov_b64 exec, -1
    s_waitcnt vmcnt(0)
L_KPW:
    s_add_u32 s16, s16, 1
    v_xor_b32 v16, s63, v35
    v_xor_b32 v17, s63, v39
    v_xor_b32 v18, s63, v43
    v_xor_b32_e64 v19, s63, v47
    v_cmp_lt_u32 s[30:31], 31, v16
    v_cmp_lt_u32 s[8:9], 31, v17
    v_cmp_lt_u32 s[14:15], 31, v18
    v_cmp_lt_u32 s[28:29], 31, v19
    v_or3_b32 v16, v16, v17, v18
    s_or_b64 vcc, s[30:31], s[8:9]
    s_or_b64 s[66:67], s[14:15], s[28:29]
    s_or_b64 vcc, vcc, s[66:67]
    s_cbranch_vccz L_KPOK
    s_cmp_lt_u32 s16, 0x4000
    s_cbranch_scc1 L_KP
L_KPOK:
    v_or_b32 v16, v16, v19
    v_cmp_ne_u32 vcc, 0, v16
    s_and_b64 vcc, vcc, s[40:41]
    s_cselect_b32 s8, 1, 2
    v_mov_b32 v16, s8
    ds_write2st64_b64 v227, v[32:33], v[36:37] offset0:18 offset1:22
    ds_write2st64_b64 v227, v[40:41], v[44:45] offset0:26 offset1:30
    s_mov_b64 exec, 1
    ds_write_b32 v2, v16 offset:528
    s_mov_b64 exec, -1
    global_load_dwordx4 v[152:155], v[220:221], off
    v_lshl_add_u64 v[220:221], s[20:21], 0, v[220:221]
    v_lshl_or_b32 v248, v34, 16, v248
    v_and_or_b32 v249, v34, s17, v249
    v_lshl_or_b32 v250, v38, 16, v250
    v_and_or_b32 v251, v38, s17, v251
    v_lshl_or_b32 v252, v42, 16, v252
    v_and_or_b32 v253, v42, s17, v253
    v_lshl_or_b32 v254, v46, 16, v254
    v_and_or_b32 v255, v46, s17, v255
    v_max_u32 v226, v248, v249
    v_min_u32 v227, v248, v249
    v_max_u32 v228, v252, v253
    v_min_u32 v229, v252, v253
    v_med3_u32 v227, v226, v227, v250
    v_med3_u32 v229, v228, v229, v254
    v_max_u32 v226, v226, v250
    v_max_u32 v228, v228, v254
    v_med3_u32 v227, v226, v227, v251
    v_med3_u32 v229, v228, v229, v255
    v_max_u32 v226, v226, v251
    v_max_u32 v228, v228, v255
    v_min_u32 v230, v226, v228
    v_max_u32 v226, v226, v228
    v_max3_u32 v227, v227, v229, v230
    ds_write_b32 v14, v226 offset:8192
    v_add_u32 v15, 4096, v15
    v_max_u32_dpp v226, v226, v226 row_shr:1 row_mask:0xf bank_mask:0xf
    v_max_u32_dpp v227, v227, v227 row_shr:1 row_mask:0xf bank_mask:0xf
    ds_write2_b32 v15, v34, v38 offset0:0 offset1:1
    v_max_u32_dpp v226, v226, v226 row_shr:2 row_mask:0xf bank_mask:0xf
    v_max_u32_dpp v227, v227, v227 row_shr:2 row_mask:0xf bank_mask:0xf
    ds_write2_b32 v15, v42, v46 offset0:2 offset1:3
    v_max_u32_dpp v226, v226, v226 row_shr:4 row_mask:0xf bank_mask:0xf
    v_max_u32_dpp v227, v227, v227 row_shr:4 row_mask:0xf bank_mask:0xf
    s_nop 0
    s_nop 0
    v_max_u32_dpp v226, v226, v226 row_shr:8 row_mask:0xf bank_mask:0xf
    v_max_u32_dpp v227, v227, v227 row_shr:8 row_mask:0xf bank_mask:0xf
    s_mov_b32 exec_lo, 0x80008000
    s_mov_b32 exec_hi, 0x80008000
    ds_write2_b32 v225, v226, v227 offset0:96 offset1:112
    s_mov_b64 exec, 1
    ds_write_b32 v2, v16 offset:64
    s_mov_b64 exec, -1
    global_load_dwordx4 v[156:159], v[220:221], off
    v_lshl_add_u64 v[220:221], s[20:21], 0, v[220:221]
    global_load_dwordx4 v[160:163], v[220:221], off
    v_lshl_add_u64 v[220:221], s[20:21], 0, v[220:221]
LW_12:
    ds_read_b32 v225, v1 offset:64
    s_waitcnt lgkmcnt(0)
    v_cmp_eq_u32_e64 vcc, 0, v225
    s_cbranch_vccnz LW_12
    v_cmp_ne_u32 s[12:13], 2, v225
    ds_read2_b32 v[226:227], v10 offset0:96 offset1:112
    ds_read_b128 v[228:231], v11 offset:384
    ds_read_b128 v[232:235], v224 offset:8192
    s_waitcnt lgkmcnt(1)
    v_cmp_gt_u32 vcc, v228, v226
    v_cmp_gt_u32 s[8:9], v229, v226
    v_cmp_gt_u32 s[14:15], v230, v226
    v_cmp_gt_u32 s[28:29], v231, v226
    v_cndmask_b32 v236, 0, 1, vcc
    v_cndmask_b32 v237, 0, 1, s[8:9]
    v_addc_co_u32 v236, vcc, 0, v236, s[14:15]
    v_addc_co_u32 v236, vcc, v237, v236, s[28:29]
    v_mov_b32 v237, v236
    s_nop 1
    v_permlane32_swap_b32 v236, v237
    v_add_u32 v236, v236, v237
    v_mov_b32 v237, v236
    s_nop 1
    v_permlane16_swap_b32 v236, v237
    v_add_u32 v236, v236, v237
    v_cmp_eq_u32 vcc, 7, v236
    s_ff1_i32_b32 s5, vcc_lo
    v_readlane_b32 s4, v226, s5
    s_waitcnt lgkmcnt(0)
    s_nop 0
    v_cmp_le_u32 vcc, s4, v227
    s_cbranch_vccnz L_SLOWT
L_CAND:
    v_cmp_le_u32 s[8:9], s4, v232
    v_cmp_le_u32 s[14:15], s4, v233
    v_cmp_le_u32 s[28:29], s4, v234
    v_cmp_le_u32 s[30:31], s4, v235
    s_bcnt1_i32_b64 s5, s[8:9]
    s_bcnt1_i32_b64 s6, s[14:15]
    s_bcnt1_i32_b64 s7, s[28:29]
    s_bcnt1_i32_b64 s16, s[30:31]
    s_add_u32 s6, s6, s5
    s_add_u32 s7, s7, s6
    s_add_u32 s16, s16, s7
    s_cmp_gt_u32 s16, 16
    s_cbranch_scc1 L_TRIM
    v_mbcnt_lo_u32_b32 v236, s8, 0
    v_mbcnt_hi_u32_b32 v236, s9, v236
    v_add_lshl_u32 v236, v236, 0, 2
    s_mov_b64 exec, s[8:9]
    ds_write_b32 v236, v232 offset:192
    s_mov_b64 exec, -1
    v_mbcnt_lo_u32_b32 v237, s14, 0
    v_mbcnt_hi_u32_b32 v237, s15, v237
    v_add_lshl_u32 v237, v237, s5, 2
    s_mov_b64 exec, s[14:15]
    ds_write_b32 v237, v233 offset:192
    s_mov_b64 exec, -1
    v_mbcnt_lo_u32_b32 v238, s28, 0
    v_mbcnt_hi_u32_b32 v238, s29, v238
    v_add_lshl_u32 v238, v238, s6, 2
    s_mov_b64 exec, s[28:29]
    ds_write_b32 v238, v234 offset:192
    s_mov_b64 exec, -1
    v_mbcnt_lo_u32_b32 v239, s30, 0
    v_mbcnt_hi_u32_b32 v239, s31, v239
    v_add_lshl_u32 v239, v239, s7, 2
    s_mov_b64 exec, s[30:31]
    ds_write_b32 v239, v235 offset:192
    s_mov_b64 exec, -1
    s_nop 0
    global_load_dwordx4 v[164:167], v[220:221], off
    v_lshl_add_u64 v[220:221], s[20:21], 0, v[220:221]
    global_load_dwordx4 v[168:171], v[220:221], off
    v_lshl_add_u64 v[220:221], s[20:21], 0, v[220:221]
    global_load_dwordx4 v[172:175], v[220:221], off
    s_movk_i32 s4, 0x7ff
    ds_read_b32 v16, v10 offset:192
    ds_read_b128 v[20:23], v11 offset:192
    s_cmp_lg_u32 s69, 1
    s_waitcnt lgkmcnt(1)
    v_bfi_b32 v14, v16, 0, s4
    s_cbranch_scc1 L_NOXS
    v_lshl_add_u32 v15, v14, 11, v9
    buffer_load_dwordx4 v[208:211], v15, s[48:51], 0 offen
    buffer_load_dwordx4 v[212:215], v15, s[48:51], 0 offen offset:64
    v_lshrrev_b32 v15, 1, v14
    v_lshlrev_b32 v15, 3, v15
    ds_read_b64 v[8:9], v15 offset:9216
    s_add_u32 s11, s10, 0
    s_nop 0
    buffer_load_dwordx2 v[176:177], v222, s[24:27], s11 offen
    s_add_u32 s11, s10, 16384
    buffer_load_dwordx2 v[178:179], v222, s[24:27], s11 offen
    s_add_u32 s11, s10, 2048
    buffer_load_dwordx2 v[180:181], v222, s[24:27], s11 offen
    s_add_u32 s11, s10, 18432
    buffer_load_dwordx2 v[182:183], v222, s[24:27], s11 offen
    s_add_u32 s11, s10, 32768
    buffer_load_dwordx2 v[184:185], v222, s[24:27], s11 offen
    s_add_u32 s11, s10, 49152
    buffer_load_dwordx2 v[186:187], v222, s[24:27], s11 offen
    s_add_u32 s11, s10, 34816
    buffer_load_dwordx2 v[188:189], v222, s[24:27], s11 offen
    s_add_u32 s11, s10, 51200
    buffer_load_dwordx2 v[190:191], v222, s[24:27], s11 offen
L_NOXS:
    s_waitcnt lgkmcnt(0)
    v_cmp_gt_u32 vcc, v20, v16
    v_cmp_gt_u32 s[8:9], v21, v16
    v_cmp_gt_u32 s[14:15], v22, v16
    v_cmp_gt_u32 s[28:29], v23, v16
    v_cndmask_b32 v24, 0, 1, vcc
    v_cndmask_b32 v25, 0, 1, s[8:9]
    v_addc_co_u32 v24, vcc, 0, v24, s[14:15]
    v_addc_co_u32 v24, vcc, v25, v24, s[28:29]
    v_mov_b32 v25, v24
    s_nop 1
    v_permlane32_swap_b32 v24, v25
    v_add_u32 v24, v24, v25
    v_mov_b32 v25, v24
    s_nop 1
    v_permlane16_swap_b32 v24, v25
    v_add_u32 v24, v24, v25
    v_cmp_gt_u32 s[30:31], 8, v24
    v_lshlrev_b32 v15, 2, v24
    v_and_b32 v10, 7, v0
    v_lshlrev_b32_e64 v10, 2, v10
    v_bfe_u32 v20, v14, 1, 8
    v_lshrrev_b32 v21, 9, v14
    v_lshlrev_b32 v20, 3, v20
    v_lshl_add_u32 v20, v21, 1, v20
    v_and_b32 v14, 1, v14
    v_add_u32 v20, v20, v14
    v_mov_b32 v22, 0x80
    s_mov_b64 exec, s[30:31]
    ds_write_b32 v15, v16 offset:256
    s_cmp_lg_u32 s3, 0
    s_cbranch_scc1 L_NOSEL
    ds_write_b8 v20, v22 offset:1152
    s_cmp_lg_u32 s2, 255
    s_cbranch_scc1 L_NOSEL
    s_mov_b64 exec, 1
    v_mov_b32 v22, s56
    buffer_store_dword v22, v2, s[44:47], 0 offen sc1
L_NOSEL:
    s_mov_b64 exec, -1
    ds_read_b32 v7, v10 offset:256
    s_mov_b64 exec, 1
    ds_write_b32 v2, v5 offset:112
    s_mov_b64 exec, -1
    s_cmp_lg_u32 s69, 1
    s_cbranch_scc1 L_GATHER
    v_lshl_add_u32 v3, v24, 4, v3
    v_lshlrev_b32 v14, 4, v14
    v_lshlrev_b32 v13, 4, v0
    s_lshl_b32 s4, s59, 14
    s_add_u32 s4, s4, 65536
    s_lshl_b32 s6, s3, 12
    s_add_u32 s6, s6, s4
    s_lshl_b32 s5, s68, 10
    s_add_u32 s5, s5, s6
    v_mov_b32 v218, s56
    v_lshrrev_b32 v6, v14, v9
    v_lshrrev_b32 v8, v14, v8
    v_lshlrev_b32 v6, 16, v6
    v_xor_b32 v8, 0x8000, v8
    v_rcp_f32_e64 v6, v6
    v_perm_b32 v240, v8, v8, s64
    v_perm_b32 v241, v8, v8, s64
    v_perm_b32 v242, v8, v8, s64
    v_perm_b32 v243, v8, v8, s64
    s_waitcnt vmcnt(18)
    s_nop 0
    v_perm_b32 v48, v116, v112, s64
    v_perm_b32 v52, v116, v112, s65
    v_perm_b32 v49, v124, v120, s64
    v_perm_b32 v53, v124, v120, s65
    v_perm_b32 v50, v132, v128, s64
    v_perm_b32 v54, v132, v128, s65
    v_perm_b32 v51, v140, v136, s64
    v_perm_b32 v55, v140, v136, s65
    v_perm_b32 v56, v117, v113, s64
    v_perm_b32 v60, v117, v113, s65
    v_perm_b32 v57, v125, v121, s64
    v_perm_b32 v61, v125, v121, s65
    v_perm_b32 v58, v133, v129, s64
    v_perm_b32 v62, v133, v129, s65
    v_perm_b32 v59, v141, v137, s64
    v_perm_b32 v63, v141, v137, s65
    v_perm_b32 v64, v118, v114, s64
    v_perm_b32 v68, v118, v114, s65
    v_perm_b32 v65, v126, v122, s64
    v_perm_b32 v69, v126, v122, s65
    v_perm_b32 v66, v134, v130, s64
    v_perm_b32 v70, v134, v130, s65
    v_perm_b32 v67, v142, v138, s64
    v_perm_b32 v71, v142, v138, s65
    v_perm_b32 v72, v119, v115, s64
    v_perm_b32 v76, v119, v115, s65
    v_perm_b32 v73, v127, v123, s64
    v_perm_b32 v77, v127, v123, s65
    v_perm_b32 v74, v135, v131, s64
    v_perm_b32 v78, v135, v131, s65
    v_perm_b32 v75, v143, v139, s64
    v_perm_b32 v79, v143, v139, s65
    s_waitcnt vmcnt(10)
    s_nop 0
    v_mfma_f32_16x16x32_bf16 v[16:19], v[48:51], v[240:243], 0
    v_perm_b32 v80, v148, v144, s64
    v_perm_b32 v84, v148, v144, s65
    v_perm_b32 v81, v156, v152, s64
    v_perm_b32 v85, v156, v152, s65
    v_mfma_f32_16x16x32_bf16 v[20:23], v[52:55], v[240:243], 0
    v_perm_b32 v82, v164, v160, s64
    v_perm_b32 v86, v164, v160, s65
    v_perm_b32 v83, v172, v168, s64
    v_perm_b32 v87, v172, v168, s65
    v_mfma_f32_16x16x32_bf16 v[24:27], v[56:59], v[240:243], 0
    v_perm_b32 v88, v149, v145, s64
    v_perm_b32 v92, v149, v145, s65
    v_perm_b32 v89, v157, v153, s64
    v_perm_b32 v93, v157, v153, s65
    v_mfma_f32_16x16x32_bf16 v[28:31], v[60:63], v[240:243], 0
    v_perm_b32 v90, v165, v161, s64
    v_perm_b32 v94, v165, v161, s65
    v_perm_b32 v91, v173, v169, s64
    v_perm_b32 v95, v173, v169, s65
    v_mfma_f32_16x16x32_bf16 v[32:35], v[64:67], v[240:243], 0
    v_perm_b32 v96, v150, v146, s64
    v_perm_b32 v100, v150, v146, s65
    v_perm_b32 v97, v158, v154, s64
    v_perm_b32 v101, v158, v154, s65
    v_mfma_f32_16x16x32_bf16 v[36:39], v[68:71], v[240:243], 0
    v_perm_b32 v98, v166, v162, s64
    v_perm_b32 v102, v166, v162, s65
    v_perm_b32 v99, v174, v170, s64
    v_perm_b32 v103, v174, v170, s65
    v_mfma_f32_16x16x32_bf16 v[40:43], v[72:75], v[240:243], 0
    v_perm_b32 v104, v151, v147, s64
    v_perm_b32 v108, v151, v147, s65
    v_perm_b32 v105, v159, v155, s64
    v_perm_b32 v109, v159, v155, s65
    v_mfma_f32_16x16x32_bf16 v[44:47], v[76:79], v[240:243], 0
    v_perm_b32 v106, v167, v163, s64
    v_perm_b32 v110, v167, v163, s65
    v_perm_b32 v107, v175, v171, s64
    v_perm_b32 v111, v175, v171, s65
    v_mfma_f32_16x16x32_bf16 v[16:19], v[80:83], v[240:243], v[16:19]
    v_mfma_f32_16x16x32_bf16 v[20:23], v[84:87], v[240:243], v[20:23]
    v_mfma_f32_16x16x32_bf16 v[24:27], v[88:91], v[240:243], v[24:27]
    v_mfma_f32_16x16x32_bf16 v[28:31], v[92:95], v[240:243], v[28:31]
    v_mfma_f32_16x16x32_bf16 v[32:35], v[96:99], v[240:243], v[32:35]
    v_mfma_f32_16x16x32_bf16 v[36:39], v[100:103], v[240:243], v[36:39]
    v_mfma_f32_16x16x32_bf16 v[40:43], v[104:107], v[240:243], v[40:43]
    v_mfma_f32_16x16x32_bf16 v[44:47], v[108:111], v[240:243], v[44:47]
    s_waitcnt vmcnt(8)
    s_nop 0
    v_mfma_f32_16x16x32_bf16 v[16:19], v[48:51], v[208:211], v[16:19]
    s_add_u32 s11, s10, 8192
    buffer_load_dwordx2 v[192:193], v222, s[24:27], s11 offen
    v_mfma_f32_16x16x32_bf16 v[20:23], v[52:55], v[208:211], v[20:23]
    s_add_u32 s11, s10, 24576
    buffer_load_dwordx2 v[194:195], v222, s[24:27], s11 offen
    v_mfma_f32_16x16x32_bf16 v[24:27], v[56:59], v[208:211], v[24:27]
    s_add_u32 s11, s10, 10240
    buffer_load_dwordx2 v[196:197], v222, s[24:27], s11 offen
    v_mfma_f32_16x16x32_bf16 v[28:31], v[60:63], v[208:211], v[28:31]
    s_add_u32 s11, s10, 26624
    buffer_load_dwordx2 v[198:199], v222, s[24:27], s11 offen
    v_mfma_f32_16x16x32_bf16 v[32:35], v[64:67], v[208:211], v[32:35]
    s_add_u32 s11, s10, 40960
    buffer_load_dwordx2 v[200:201], v222, s[24:27], s11 offen
    v_mfma_f32_16x16x32_bf16 v[36:39], v[68:71], v[208:211], v[36:39]
    s_add_u32 s11, s10, 57344
    buffer_load_dwordx2 v[202:203], v222, s[24:27], s11 offen
    v_mfma_f32_16x16x32_bf16 v[40:43], v[72:75], v[208:211], v[40:43]
    s_add_u32 s11, s10, 43008
    buffer_load_dwordx2 v[204:205], v222, s[24:27], s11 offen
    v_mfma_f32_16x16x32_bf16 v[44:47], v[76:79], v[208:211], v[44:47]
    s_add_u32 s11, s10, 59392
    buffer_load_dwordx2 v[206:207], v222, s[24:27], s11 offen
    v_mfma_f32_16x16x32_bf16 v[16:19], v[80:83], v[212:215], v[16:19]
    v_mfma_f32_16x16x32_bf16 v[20:23], v[84:87], v[212:215], v[20:23]
    v_mfma_f32_16x16x32_bf16 v[24:27], v[88:91], v[212:215], v[24:27]
    v_mfma_f32_16x16x32_bf16 v[28:31], v[92:95], v[212:215], v[28:31]
    v_mfma_f32_16x16x32_bf16 v[32:35], v[96:99], v[212:215], v[32:35]
    v_mfma_f32_16x16x32_bf16 v[36:39], v[100:103], v[212:215], v[36:39]
    v_mfma_f32_16x16x32_bf16 v[40:43], v[104:107], v[212:215], v[40:43]
    v_mfma_f32_16x16x32_bf16 v[44:47], v[108:111], v[212:215], v[44:47]
    s_mov_b64 exec, s[30:31]
    s_nop 0
    ds_write_b128 v3, v[16:19] offset:0
    ds_write_b128 v3, v[20:23] offset:512
    ds_write_b128 v3, v[24:27] offset:1024
    ds_write_b128 v3, v[28:31] offset:1536
    ds_write_b128 v3, v[32:35] offset:2048
    ds_write_b128 v3, v[36:39] offset:2560
    ds_write_b128 v3, v[40:43] offset:3072
    ds_write_b128 v3, v[44:47] offset:3584
    ds_write_b32 v15, v6 offset:288
    s_mov_b64 exec, 1
    ds_write_b32 v2, v5 offset:80
    s_mov_b64 exec, -1
    ds_read_b32 v6, v10 offset:288
LW_13:
    ds_read_b32 v11, v1 offset:80
    s_waitcnt lgkmcnt(0)
    v_cmp_eq_u32_e64 vcc, 0, v11
    s_cbranch_vccnz LW_13
    ds_read_b64 v[224:225], v4 offset:0
    ds_read_b64 v[226:227], v4 offset:256
    ds_read_b64 v[228:229], v4 offset:4096
    ds_read_b64 v[230:231], v4 offset:4352
    ds_read_b64 v[232:233], v4 offset:8192
    ds_read_b64 v[234:235], v4 offset:8448
    ds_read_b64 v[236:237], v4 offset:12288
    ds_read_b64 v[238:239], v4 offset:12544
    s_waitcnt lgkmcnt(4)
    v_add_f32 v224, v224, v228
    v_add_f32 v225, v225, v229
    v_add_f32 v226, v226, v230
    v_add_f32 v227, v227, v231
    s_waitcnt lgkmcnt(0)
    v_add_f32 v232, v232, v236
    v_add_f32 v233, v233, v237
    v_add_f32 v234, v234, v238
    v_add_f32 v235, v235, v239
    v_add_f32 v224, v224, v232
    v_add_f32 v225, v225, v233
    v_add_f32 v226, v226, v234
    v_add_f32_e64 v227, v227, v235
    s_cmp_eq_u32 s12, 0
    v_cvt_pk_bf16_f32 v216, v224, v225
    v_cvt_pk_bf16_f32 v217, v226, v227
    s_cbranch_scc0 L_HSC
    buffer_store_dwordx4 v[216:219], v13, s[44:47], s5 offen
L_HSB:
    v_bfe_u32 v10, v0, 3, 1
    v_lshrrev_b32 v11, 4, v0
    v_cmp_ne_u32 s[22:23], 0, v10
    v_lshlrev_b32_e64 v15, 2, v10
    v_lshl_add_u32 v15, v11, 3, v15
    v_lshlrev_b32_e64 v10, 8, v10
    v_lshl_add_u32 v10, v11, 9, v10
    v_lshlrev_b32 v9, 4, v11
    v_and_b32 v11, 7, v0
    v_lshl_add_u32 v10, v11, 4, v10
    s_movk_i32 s5, 144
    v_mad_u32_u24 v15, v11, s5, v15
    v_mad_u32_u24 v9, v11, s5, v9
    s_lshl_b32 s5, s3, 5
    v_add_u32 v15, s5, v15
    s_lshl_b32 s4, s59, 15
    s_lshl_b32 s5, s68, 13
    s_add_u32 s4, s4, s5
    s_lshl_b32 s5, s3, 11
    s_add_u32 s4, s4, s5
    s_add_u32 s4, s4, 1048576
    v_mul_f32 v12, 0xbfb8aa3b, v6
    v_mul_f32 v14, v6, v6
    v_mov_b32 v50, s56
    v_mov_b32_e64 v54, s56
    s_mov_b32 s16, 0
    s_waitcnt vmcnt(9)
    v_perm_b32 v112, v178, v176, s64
    v_perm_b32 v116, v178, v176, s65
    v_perm_b32 v113, v182, v180, s64
    v_perm_b32 v117, v182, v180, s65
    v_perm_b32 v114, v186, v184, s64
    v_perm_b32 v118, v186, v184, s65
    v_perm_b32 v115, v190, v188, s64
    v_perm_b32 v119, v190, v188, s65
    v_perm_b32 v120, v179, v177, s64
    v_perm_b32 v124, v179, v177, s65
    v_perm_b32 v121, v183, v181, s64
    v_perm_b32 v125, v183, v181, s65
    v_perm_b32 v122, v187, v185, s64
    v_perm_b32 v126, v187, v185, s65
    v_perm_b32 v123, v191, v189, s64
    v_perm_b32 v127, v191, v189, s65
    buffer_load_dwordx3 v[144:146], v13, s[44:47], s6 offen offset:0 sc1
    buffer_load_dwordx3 v[148:150], v13, s[44:47], s6 offen offset:1024 sc1
    buffer_load_dwordx3 v[152:154], v13, s[44:47], s6 offen offset:2048 sc1
    buffer_load_dwordx3 v[156:158], v13, s[44:47], s6 offen offset:3072 sc1
    s_waitcnt vmcnt(5)
    s_nop 0
    v_perm_b32 v128, v194, v192, s64
    v_perm_b32 v132, v194, v192, s65
    v_perm_b32 v129, v198, v196, s64
    v_perm_b32 v133, v198, v196, s65
    v_perm_b32 v130, v202, v200, s64
    v_perm_b32 v134, v202, v200, s65
    v_perm_b32 v131, v206, v204, s64
    v_perm_b32 v135, v206, v204, s65
    v_perm_b32 v136, v195, v193, s64
    v_perm_b32 v140, v195, v193, s65
    v_perm_b32 v137, v199, v197, s64
    v_perm_b32 v141, v199, v197, s65
    v_perm_b32 v138, v203, v201, s64
    v_perm_b32 v142, v203, v201, s65
    v_perm_b32 v139, v207, v205, s64
    v_perm_b32 v143, v207, v205, s65
    s_branch L_HPW
L_HP:
    s_sleep 3
    s_cmp_eq_u64 s[18:19], 0
    s_cbranch_scc1 L_HS0
    buffer_load_dwordx3 v[144:146], v13, s[44:47], s6 offen offset:0 sc1
L_HS0:
    s_cmp_eq_u64 s[8:9], 0
    s_cbranch_scc1 L_HS1
    buffer_load_dwordx3 v[148:150], v13, s[44:47], s6 offen offset:1024 sc1
L_HS1:
    s_cmp_eq_u64 s[14:15], 0
    s_cbranch_scc1 L_HS2
    buffer_load_dwordx3 v[152:154], v13, s[44:47], s6 offen offset:2048 sc1
L_HS2:
    s_cmp_eq_u64 s[28:29], 0
    s_cbranch_scc1 L_HS3
    buffer_load_dwordx3 v[156:158], v13, s[44:47], s6 offen offset:3072 sc1
L_HS3:
L_HPW:
    s_add_u32 s16, s16, 1
    s_waitcnt vmcnt(0)
    v_cmp_ne_u32 s[18:19], s56, v146
    v_cmp_ne_u32 s[8:9], s56, v150
    v_cmp_ne_u32 s[14:15], s56, v154
    v_cmp_ne_u32 s[28:29], s56, v158
    s_or_b64 vcc, s[18:19], s[8:9]
    s_or_b64 s[20:21], s[14:15], s[28:29]
    s_or_b64 vcc, vcc, s[20:21]
    s_cbranch_vccz L_HOK
    s_cmp_lt_u32 s16, 0x4000
    s_cbranch_scc1 L_HP
L_HOK:
    v_lshlrev_b32 v224, 16, v144
    v_and_b32 v225, 0xffff0000, v144
    v_lshlrev_b32_e64 v226, 16, v148
    v_and_b32 v227, 0xffff0000, v148
    v_lshlrev_b32_e64 v228, 16, v152
    v_and_b32 v229, 0xffff0000, v152
    v_lshlrev_b32_e64 v230, 16, v156
    v_and_b32 v231, 0xffff0000, v156
    v_add_f32 v224, v224, v226
    v_add_f32 v228, v228, v230
    v_add_f32 v225, v225, v227
    v_add_f32 v229, v229, v231
    v_add_f32 v224, v224, v228
    v_add_f32 v225, v225, v229
    v_mul_f32 v244, v12, v224
    v_mul_f32 v245, v12, v225
    v_exp_f32 v244, v244
    v_exp_f32 v245, v245
    v_lshlrev_b32_e64 v232, 16, v145
    v_and_b32 v233, 0xffff0000, v145
    v_lshlrev_b32_e64 v234, 16, v149
    v_and_b32 v235, 0xffff0000, v149
    v_lshlrev_b32_e64 v236, 16, v153
    v_and_b32 v237, 0xffff0000, v153
    v_lshlrev_b32_e64 v238, 16, v157
    v_and_b32 v239, 0xffff0000, v157
    v_add_f32 v244, 1.0, v244
    v_add_f32 v245, 1.0, v245
    v_rcp_f32 v244, v244
    v_rcp_f32 v245, v245
    v_add_f32 v232, v232, v234
    v_add_f32 v236, v236, v238
    v_add_f32 v233, v233, v235
    v_add_f32 v237, v237, v239
    v_mul_f32 v224, v224, v14
    v_add_f32 v232, v232, v236
    v_mul_f32 v225, v225, v14
    v_add_f32 v233, v233, v237
    v_mul_f32 v224, v224, v244
    v_mul_f32 v225, v225, v245
    v_mul_f32 v224, v224, v232
    v_mul_f32 v225, v225, v233
    v_cvt_pk_bf16_f32 v244, v224, v225
    ds_write_b32 v15, v244 offset:4096
    s_mov_b64 exec, 1
    ds_write_b32 v2, v5 offset:176
    s_mov_b64 exec, -1
LW_14:
    ds_read_b32 v11, v1 offset:176
    s_waitcnt lgkmcnt(0)
    v_cmp_eq_u32_e64 vcc, 0, v11
    s_cbranch_vccnz LW_14
    ds_read_b128 v[224:227], v9 offset:4096
    ds_read_b128 v[228:231], v9 offset:4160
    s_waitcnt lgkmcnt(1)
    v_mfma_f32_16x16x32_bf16 v[16:19], v[112:115], v[224:227], 0
    v_mfma_f32_16x16x32_bf16 v[20:23], v[116:119], v[224:227], 0
    v_mfma_f32_16x16x32_bf16 v[24:27], v[120:123], v[224:227], 0
    v_mfma_f32_16x16x32_bf16 v[28:31], v[124:127], v[224:227], 0
    s_waitcnt lgkmcnt(0)
    v_mfma_f32_16x16x32_bf16 v[16:19], v[128:131], v[228:231], v[16:19]
    v_mfma_f32_16x16x32_bf16 v[20:23], v[132:135], v[228:231], v[20:23]
    v_mfma_f32_16x16x32_bf16 v[24:27], v[136:139], v[228:231], v[24:27]
    v_mfma_f32_16x16x32_bf16 v[28:31], v[140:143], v[228:231], v[28:31]
    s_nop 0
    s_nop 3
    v_cndmask_b32 v16, v16, v18, s[22:23]
    v_cndmask_b32 v20, v20, v22, s[22:23]
    v_cndmask_b32 v24, v24, v26, s[22:23]
    v_cndmask_b32 v28, v28, v30, s[22:23]
    v_cvt_pk_bf16_f32 v48, v16, v20
    v_cvt_pk_bf16_f32 v49, v24, v28
    buffer_store_dwordx4 v[48:51], v10, s[44:47], s4 offen offset:0 sc1
    v_cndmask_b32 v17, v17, v19, s[22:23]
    v_cndmask_b32 v21, v21, v23, s[22:23]
    v_cndmask_b32 v25, v25, v27, s[22:23]
    v_cndmask_b32 v29, v29, v31, s[22:23]
    v_cvt_pk_bf16_f32 v52, v17, v21
    v_cvt_pk_bf16_f32 v53, v25, v29
    buffer_store_dwordx4 v[52:55], v10, s[44:47], s4 offen offset:128 sc1
L_GATHER:
    s_waitcnt lgkmcnt(0)
    s_movk_i32 s4, 0x7ff
    v_bfi_b32 v14, v7, 0, s4
    v_lshrrev_b32 v10, 3, v0
    s_lshl_b32 s4, s3, 3
    v_add_lshl_u32 v10, v10, s4, 15
    v_and_b32 v11, 7, v0
    v_lshlrev_b32 v11, 4, v11
    v_add_u32 v10, v10, v11
    s_lshl_b32 s4, s57, 7
    s_add_u32 s4, s4, 1048576
    s_mov_b32 s11, 0
    v_bfe_u32 v12, v0, 3, 2
    v_lshlrev_b32 v13, 11, v14
    v_lshl_add_u32 v13, v12, 1, v13
    s_lshl_b32 s8, s57, 3
    v_add_u32 v13, s8, v13
    buffer_load_ushort v80, v13, s[48:51], 0 offen
LW_15:
    ds_read_b32 v15, v1 offset:112
    s_waitcnt lgkmcnt(0)
    v_cmp_eq_u32 vcc, 0, v15
    s_cbranch_vccnz LW_15
    s_cmp_eq_u32 s12, 0
    s_cselect_b32 s60, 2, 1
    v_lshrrev_b32 v15, 16, v7
    v_bfe_i32 v82, v15, 15, 1
    v_not_b32_e64 v82, v82
    v_or_b32 v82, 0x8000, v82
    v_xor_b32 v15, v15, v82
    v_lshlrev_b32 v15, 16, v15
    v_mul_f32 v15, 0xbfb8aa3b, v15
    v_exp_f32 v15, v15
    v_lshlrev_b32 v83, 13, v12
    v_add_f32 v15, 1.0, v15
    v_rcp_f32 v15, v15
    v_lshl_add_u32 v83, v14, 2, v83
    v_add_u32 v83, 17408, v83
    v_lshl_add_u32 v84, v12, 2, v11
    s_cmp_lg_u32 s60, 2
    s_cbranch_scc1 L_AFT
    s_cmp_ge_u32 s3, 2
    s_cbranch_scc1 L_AFT
L_TILE:
    s_lshl_b32 s8, s3, 4
    s_cmp_eq_u32 s3, 0
    s_cselect_b32 s8, 144, s8
    v_add_u32_e64 v92, s8, v1
    s_and_b32 s14, s2, 7
    s_lshr_b32 s15, s2, 3
    s_lshl_b32 s16, s14, 11
    s_lshl_b32 s8, s3, 9
    s_add_u32 s16, s16, s8
    s_lshr_b32 s9, s15, 3
    s_lshl_b32 s9, s9, 7
    s_add_u32 s16, s16, s9
    s_add_u32 s16, s16, 1015808
    s_lshl_b32 s9, s15, 4
    s_add_u32 s8, s8, s9
    s_lshl_b32 s17, s14, 19
    s_lshl_b32 s9, s8, 3
    s_add_u32 s17, s17, s9
    s_add_u32 s17, s17, 3145728
    s_lshl_b32 s18, s8, 11
    s_lshl_b32 s9, s14, 8
    s_add_u32 s18, s18, s9
    s_add_u32 s19, s18, 4096
    s_mul_i32 s9, s3, 4352
    s_add_u32 s9, s9, 140288
    s_cmp_eq_u32 s3, 3
    s_cselect_b32 s9, 9216, s9
    v_lshlrev_b32 v93, 2, v0
    v_and_b32 v98, 7, v0
    v_lshrrev_b32 v99, 3, v0
    v_lshlrev_b32_e64 v94, 4, v98
    v_lshl_add_u32 v94, v99, 14, v94
    s_movk_i32 s8, 544
    v_lshl_add_u32 v95, v99, 3, s9
    v_mad_u32_u24 v95, v98, s8, v95
    v_lshrrev_b32 v98, 4, v0
    v_and_b32 v99, 15, v0
    v_lshlrev_b32_e64 v99, 4, v99
    s_movk_i32 s8, 1088
    v_mad_u32_u24 v96, v98, s8, v99
    v_add_u32_e64 v96, s9, v96
    v_lshl_add_u32 v97, v98, 13, v99
    s_lshl_b32 s8, s15, 6
    s_lshl_b32 s9, s3, 1
    s_add_u32 s8, s8, s9
    v_lshl_add_u32 v98, v98, 4, s8
    ds_read_u16 v100, v98 offset:1152
    ds_read_u16 v101, v98 offset:1160
    s_brev_b32 s8, 1
    s_mov_b32 s20, 0
    s_setprio 0
LW_16:
    s_sleep 2
    ds_read_b32 v99, v92 offset:0
    s_waitcnt lgkmcnt(0)
    v_cmp_eq_u32 vcc, 0, v99
    s_cbranch_vccnz LW_16
    s_setprio 2
    v_lshlrev_b32 v102, 24, v100
    v_lshlrev_b32 v103, 16, v100
    v_lshlrev_b32 v104, 24, v101
    v_lshlrev_b32_e64 v105, 16, v101
    v_and_or_b32 v102, v102, s8, v97
    v_and_or_b32 v103, v103, s8, v97
    v_and_or_b32 v104, v104, s8, v97
    v_and_or_b32 v105, v105, s8, v97
    s_mov_b32 exec_hi, 0
L_TP:
    s_sleep 1
    buffer_load_dword v99, v93, s[44:47], s16 offen sc1
    s_add_u32 s20, s20, 1
    s_waitcnt vmcnt(0)
    v_cmp_ne_u32 vcc, s63, v99
    s_cbranch_vccz L_TOK
    s_cmp_lt_u32 s20, 0x4000
    s_cbranch_scc1 L_TP
L_TOK:
    s_mov_b32 exec_hi, -1
    buffer_load_dwordx4 v[16:19], v94, s[44:47], s17 offen sc1
    s_add_u32 s17, s17, 0x20000
    buffer_load_dwordx4 v[20:23], v94, s[44:47], s17 offen sc1
    s_add_u32 s17, s17, 0x20000
    buffer_load_dwordx4 v[24:27], v94, s[44:47], s17 offen sc1
    s_add_u32 s17, s17, 0x20000
    buffer_load_dwordx4 v[28:31], v94, s[44:47], s17 offen sc1
    s_add_u32 s17, s17, 0x20000
    s_waitcnt vmcnt(3)
    ds_write_b64 v95, v[16:17] offset:0
    ds_write_b64 v95, v[18:19] offset:272
    s_waitcnt vmcnt(2)
    ds_write_b64 v95, v[20:21] offset:64
    ds_write_b64 v95, v[22:23] offset:336
    s_waitcnt vmcnt(1)
    ds_write_b64 v95, v[24:25] offset:128
    ds_write_b64 v95, v[26:27] offset:400
    s_waitcnt vmcnt(0)
    ds_write_b64 v95, v[28:29] offset:192
    ds_write_b64 v95, v[30:31] offset:464
    ds_read_b128 v[32:35], v96 offset:0
    ds_read_b128 v[36:39], v96 offset:272
    ds_read_b128 v[40:43], v96 offset:544
    ds_read_b128 v[44:47], v96 offset:816
    s_waitcnt lgkmcnt(3)
    buffer_store_dwordx4 v[32:35], v102, s[52:55], s18 offen offset:0 sc1
    s_waitcnt lgkmcnt(2)
    buffer_store_dwordx4 v[36:39], v103, s[52:55], s18 offen offset:2048 sc1
    s_waitcnt lgkmcnt(1)
    buffer_store_dwordx4 v[40:43], v104, s[52:55], s19 offen offset:0 sc1
    s_waitcnt lgkmcnt(0)
    buffer_store_dwordx4 v[44:47], v105, s[52:55], s19 offen offset:2048 sc1
    s_cmp_ge_u32 s3, 2
    s_cbranch_scc1 L_FIN
L_AFT:
    s_cmp_eq_u32 s69, 1
    s_cbranch_scc1 L_GGO
    s_setprio 0
LW_17:
    s_sleep 2
    ds_read_b32 v81, v1 offset:48
    s_waitcnt lgkmcnt(0)
    v_cmp_eq_u32_e64 vcc, 0, v81
    s_cbranch_vccnz LW_17
    s_setprio 2
L_GGO:
    s_mov_b64 s[8:9], -1
    s_cmp_lt_u32 s3, 3
    s_cselect_b64 s[12:13], -1, 0
    s_add_u32 s5, s4, 0x100000
    v_mov_b32 v148, 0
    v_mov_b32 v149, 0
    v_mov_b32 v150, s56
    s_waitcnt vmcnt(0)
L_GP:
    s_cmp_eq_u64 s[8:9], 0
    s_cbranch_scc1 L_GS0
    buffer_load_dwordx3 v[144:146], v10, s[44:47], s4 offen sc1
L_GS0:
    s_cmp_eq_u64 s[12:13], 0
    s_cbranch_scc1 L_GS1
    buffer_load_dwordx3 v[148:150], v10, s[44:47], s5 offen sc1
L_GS1:
    s_add_u32 s11, s11, 1
    s_waitcnt vmcnt(0)
    v_cmp_ne_u32 s[8:9], s56, v146
    v_cmp_ne_u32 s[12:13], s56, v150
    s_or_b64 vcc, s[8:9], s[12:13]
    s_cbranch_vccz L_GOT
    s_sleep 2
    s_cmp_lt_u32 s11, 0x4000
    s_cbranch_scc1 L_GP
L_GOT:
    v_lshlrev_b32_e64 v176, 16, v144
    v_and_b32 v177, 0xffff0000, v144
    v_lshlrev_b32_e64 v178, 16, v145
    v_and_b32 v179, 0xffff0000, v145
    v_lshlrev_b32_e64 v180, 16, v148
    v_and_b32 v181, 0xffff0000, v148
    v_lshlrev_b32_e64 v182, 16, v149
    v_and_b32 v183, 0xffff0000, v149
    v_add_f32 v176, v176, v180
    v_add_f32 v177, v177, v181
    v_add_f32 v178, v178, v182
    v_add_f32 v179, v179, v183
    v_add_f32_dpp v176, v176, v176 row_ror:8 row_mask:0xf bank_mask:0xf
    v_add_f32_dpp v177, v177, v177 row_ror:8 row_mask:0xf bank_mask:0xf
    v_add_f32_dpp v178, v178, v178 row_ror:8 row_mask:0xf bank_mask:0xf
    v_add_f32_dpp v179, v179, v179 row_ror:8 row_mask:0xf bank_mask:0xf
    s_mov_b32 exec_lo, 0x00ff00ff
    s_mov_b32 exec_hi, 0x00ff00ff
    ds_add_f32 v11, v176 offset:1024
    ds_add_f32 v11, v177 offset:1028
    ds_add_f32 v11, v178 offset:1032
    ds_add_f32 v11, v179 offset:1036
    s_mov_b64 exec, 1
    ds_write_b32 v2, v5 offset:96
    s_mov_b64 exec, -1
    s_lshl_b32 s8, s60, 2
    s_add_u32 s8, s3, s8
    s_cmp_ge_u32 s8, 10
    s_cbranch_scc1 L_TILE
    s_cmp_lg_u32 s3, 0
    s_cbranch_scc1 L_FIN
LW_18:
    ds_read_b32 v81, v1 offset:48
    s_waitcnt lgkmcnt(0)
    v_cmp_eq_u32_e64 vcc, 0, v81
    s_cbranch_vccnz LW_18
    ds_read_b32 v89, v83
    v_lshlrev_b32_e64 v80, 16, v80
LW_19:
    ds_read_b32 v81, v1 offset:96
    s_waitcnt lgkmcnt(0)
    v_cmp_eq_u32_e64 vcc, 0, v81
    s_cbranch_vccnz LW_19
    ds_read_b32 v90, v84 offset:1024
    v_add_f32 v80, v80, v89
    s_waitcnt lgkmcnt(0)
    v_fma_f32 v80, v90, v15, v80
    v_cvt_pk_bf16_f32 v80, v80, v80
    s_mov_b32 exec_hi, 0
    buffer_store_short v80, v13, s[52:55], 0 offen
    s_mov_b64 exec, -1
    s_branch L_FIN
L_HSC:
    buffer_store_dwordx4 v[216:219], v13, s[44:47], s5 offen sc1
    s_branch L_HSB
L_TRIM:
    v_subrev_u32 v236, s4, v232
    v_subrev_u32 v237, s4, v233
    v_subrev_u32 v238, s4, v234
    v_subrev_u32 v239, s4, v235
    v_min3_u32 v236, v236, v237, v238
    v_min_u32 v236, v236, v239
    s_nop 1
    v_min_u32_dpp v236, v236, v236 row_shr:1 row_mask:0xf bank_mask:0xf
    s_nop 0
    s_nop 0
    v_min_u32_dpp v236, v236, v236 row_shr:2 row_mask:0xf bank_mask:0xf
    s_nop 0
    s_nop 0
    v_min_u32_dpp v236, v236, v236 row_shr:4 row_mask:0xf bank_mask:0xf
    s_nop 0
    s_nop 0
    v_min_u32_dpp v236, v236, v236 row_shr:8 row_mask:0xf bank_mask:0xf
    s_nop 0
    s_nop 0
    v_min_u32_dpp v236, v236, v236 row_bcast:15 row_mask:0xa bank_mask:0xf
    s_nop 0
    s_nop 0
    v_min_u32_dpp v236, v236, v236 row_bcast:31 row_mask:0xc bank_mask:0xf
    s_nop 0
    v_readlane_b32 s5, v236, 63
    s_add_u32 s4, s4, s5
    s_add_u32 s4, s4, 1
    s_branch L_CAND
L_SLOWT:
    v_max3_u32 v228, v232, v233, v234
    v_max_u32 v228, v228, v235
    s_mov_b32 s4, 0
    s_brev_b32 s5, 1
L_BS:
    s_or_b32 s6, s4, s5
    v_cmp_le_u32_e64 vcc, s6, v228
    s_lshr_b32 s5, s5, 1
    s_bcnt1_i32_b64 s7, vcc
    s_cmp_ge_u32 s7, 8
    s_cselect_b32 s4, s6, s4
    s_cmp_lg_u32 s7, 8
    s_cbranch_scc1 L_BS
    v_mbcnt_lo_u32_b32 v229, vcc_lo, 0
    v_mbcnt_hi_u32_b32 v229, vcc_hi, v229
    v_lshlrev_b32 v229, 2, v229
    s_mov_b64 exec, vcc
    ds_write_b32 v229, v0 offset:320
    s_mov_b64 exec, -1
    v_lshrrev_b32 v230, 3, v0
    v_lshlrev_b32_e64 v230, 2, v230
    ds_read_b32 v229, v230 offset:320
    s_waitcnt lgkmcnt(0)
    v_and_b32 v230, 7, v0
    v_lshl_add_u32 v229, v229, 3, v230
    v_lshlrev_b32_e64 v230, 3, v229
    ds_read_b64 v[226:227], v230 offset:4096
    v_and_b32 v230, 1, v229
    v_and_b32 v229, -2, v229
    v_lshl_add_u32 v229, v230, 10, v229
    v_sub_u32 v232, 0xfff, v229
    v_sub_u32 v233, 0xffe, v229
    v_sub_u32 v234, 0xdff, v229
    v_sub_u32 v235, 0xdfe, v229
    s_mov_b32 s5, 0xffff0000
    s_waitcnt lgkmcnt(0)
    v_lshl_or_b32 v232, v226, 16, v232
    v_and_or_b32 v233, v226, s5, v233
    v_lshl_or_b32 v234, v227, 16, v234
    v_and_or_b32 v235, v227, s5, v235
    s_branch L_CAND
L_FIN:
L_END:
    s_endpgm
.section .rodata,"a"
.p2align 6
.amdhsa_kernel parallel_sum__ssm_conv_s4d__moe_arch_mod__prompt_kernel
  .amdhsa_next_free_vgpr 256
  .amdhsa_next_free_sgpr 102
  .amdhsa_accum_offset 256
  .amdhsa_group_segment_fixed_size 0
  .amdhsa_kernarg_size 120
  .amdhsa_user_sgpr_count 2
  .amdhsa_user_sgpr_kernarg_segment_ptr 1
  .amdhsa_system_sgpr_workgroup_id_x 1
  .amdhsa_float_denorm_mode_32 3
.end_amdhsa_kernel
```

```asm
; @launch grid=(256,1,1) block=(512,1,1) lds=156672
.amdgcn_target "amdgcn-amd-amdhsa--gfx950"
.text
.globl parallel_sum__ssm_conv_s4d__moe_arch_mod__prompt_kernel
.p2align 8
.type parallel_sum__ssm_conv_s4d__moe_arch_mod__prompt_kernel,@function
parallel_sum__ssm_conv_s4d__moe_arch_mod__prompt_kernel:
    s_cmp_ge_u32 s2, 256
    s_cbranch_scc1 L_END
    s_load_dwordx16 s[16:31], s[0:1], 0
    s_load_dwordx8 s[32:39], s[0:1], 64
    s_load_dwordx2 s[40:41], s[0:1], 96
    s_load_dwordx2 s[42:43], s[0:1], 112
    s_getpc_b64 s[14:15]
    v_lshrrev_b32_e64 v1, 6, v0
    v_and_b32 v10, 255, v0
    v_and_b32 v0, 63, v0
    v_readfirstlane_b32 s3, v1
    v_lshlrev_b32 v1, 2, v0
    v_mov_b32 v2, 0
    ds_write2st64_b32 v1, v2, v2 offset0:0 offset1:2
    s_and_b32 s5, s2, 7
    s_lshr_b32 s6, s2, 3
    s_lshl_b32 s57, s5, 5
    s_add_u32 s57, s57, s6
    s_and_b32 s58, s3, 3
    s_lshl_b32 s7, s57, 2
    s_add_u32 s7, s7, s58
    s_lshl_b32 s7, s7, 8
    v_add_u32 v15, s7, v1
    s_mov_b32 s60, 0
    s_lshl_b32 s4, s57, 3
    s_cmp_lt_u32 s3, 4
    s_cbranch_scc1 L_F0
    s_and_b32 s8, s6, 15
    s_lshl_b32 s8, s8, 2
    s_add_u32 s8, s8, s58
    s_lshl_b32 s8, s8, 9
    s_mov_b32 s69, s8
    v_lshl_add_u32 v2, v0, 7, s8
    v_min_u32 v2, L_END-parallel_sum__ssm_conv_s4d__moe_arch_mod__prompt_kernel-128, v2
    s_mov_b64 exec, 0xf
    global_load_dword v255, v2, s[14:15]
    s_mov_b64 exec, -1
    v_lshlrev_b32 v3, 12, v10
    v_add_u32_e64 v3, s4, v3
    s_lshl_b32 s8, s5, 5
    s_add_u32 s8, s8, s58
    s_lshl_b32 s8, s8, 7
    s_add_u32 s8, s8, 983040
    v_lshl_add_u32 v2, v0, 9, s8
    s_lshl_b32 s59, s5, 2
    s_add_u32 s59, s59, s58
    s_lshl_b32 s59, s59, 5
    s_add_u32 s59, s59, s6
    s_lshl_b32 s59, s59, 9
    s_add_u32 s59, s59, 7340032
    s_sub_u32 s8, s59, 512
    v_lshl_add_u32 v4, v0, 7, s8
    v_cmp_lt_u32 vcc, 3, v0
    s_nop 0
    s_nop 0
    v_cndmask_b32 v2, v2, v4, vcc
    s_lshl_b32 s8, s2, 6
    s_add_u32 s8, s8, 7864320
    v_writelane_b32 v2, s8, 3
    s_waitcnt lgkmcnt(0)
    s_cmp_ge_u32 s6, 32
    s_cbranch_scc1 L_NFP
    s_mov_b64 exec, 127
    global_load_dword v255, v2, s[42:43]
    s_mov_b64 exec, -1
L_NFP:
    global_load_dword v224, v15, s[18:19]
    global_load_dword v225, v15, s[20:21]
    global_load_dword v226, v15, s[22:23]
    global_load_dword v227, v15, s[24:25]
    s_add_u32 s6, s26, s4
    s_addc_u32 s7, s27, 0
    s_load_dwordx2 s[64:65], s[6:7], 0
    s_add_u32 s6, s28, s4
    s_addc_u32 s7, s29, 0
    s_load_dwordx2 s[66:67], s[6:7], 0
    s_barrier
    s_mov_b64 s[26:27], s[14:15]
    s_mov_b32 s61, 0x100000
    s_mov_b32 s62, 0x200000
    s_mov_b32 s63, 0x300000
    s_mov_b32 s44, s42
    s_and_b32 s45, s43, 0xffff
    s_mov_b32 s46, 0x1000000
    s_mov_b32 s47, 0x20000
    s_mov_b32 s48, s16
    s_and_b32 s49, s17, 0xffff
    s_mov_b32 s50, 0x400000
    s_mov_b32 s51, 0x20000
    s_mov_b32 s52, s40
    s_and_b32 s53, s41, 0xffff
    s_mov_b32 s54, 0x400000
    s_mov_b32 s55, 0x20000
    s_setprio 2
    s_mul_i32 s8, s58, 17408
    s_add_u32 s8, s8, 52224
    s_mul_i32 s10, s58, 4608
    s_add_u32 s10, s10, 121856
    s_mul_i32 s11, s58, 8704
    s_add_u32 s11, s11, 17408
    s_movk_i32 s9, 544
    s_sub_u32 m0, s8, 48064
    v_lshl_add_u32 v15, v0, 3, s10
    v_and_b32 v16, 15, v0
    v_lshrrev_b32 v17, 4, v0
    v_lshlrev_b32 v18, 4, v17
    v_mad_u32_u24 v12, v16, s9, v18
    v_add_u32 v14, s11, v12
    v_add_u32 v12, s8, v12
    v_add_u32 v11, s8, v18
    v_cmp_gt_u32 vcc, 3, v16
    s_nop 0
    s_nop 0
    v_cndmask_b32 v19, 12, 4, vcc
    v_cmp_eq_u32 vcc, 3, v16
    s_nop 1
    v_cndmask_b32 v19, v19, 28, vcc
    v_mad_u32_u24 v13, v19, s9, v12
    v_and_b32_e64 v20, 3, v16
    s_sub_u32 s11, s11, 17408
    s_lshl_b32 s4, s58, 2
    v_mov_b32 v4, s4
    v_mov_b32 v5, 1
    v_lshlrev_b32 v6, 2, v20
    s_movk_i32 s9, 2368
    v_lshrrev_b32 v18, 2, v0
    v_lshl_add_u32 v19, v20, 3, s8
    v_mad_u32_u24 v200, v18, s9, v19
    s_movk_i32 s4, 160
    v_mad_u32_u24 v202, v18, s4, v19
    v_lshrrev_b32 v18, 3, v0
    v_and_b32_e64 v19, 7, v0
    v_lshl_add_u32 v19, v19, 3, s8
    v_mad_u32_u24 v201, v18, s9, v19
    v_lshrrev_b32 v18, 5, v0
    v_lshlrev_b32 v18, 8, v18
    v_lshl_add_u32 v18, v16, 4, v18
    v_add_u32 v18, s8, v18
    v_and_b32 v19, 1, v17
    v_lshl_add_u32 v203, v19, 3, v18
    v_lshl_add_u32 v46, v19, 9, v18
    v_and_b32 v18, 1, v16
    s_movk_i32 s4, 640
    v_mul_u32_u24_e64 v18, s4, v18
    v_lshl_add_u32 v18, v17, 5, v18
    v_and_b32_e64 v19, 14, v16
    v_add3_u32 v47, v18, v19, s8
    v_mov_b32 v35, s8
    v_mov_b32 v252, 0
    v_mov_b32 v253, 0
    v_lshlrev_b32 v7, 4, v17
    v_lshlrev_b32 v18, 5, v16
    v_sub_u32 v7, v7, v18
    s_add_u32 s4, s10, 480
    v_add_u32 v7, s4, v7
    s_lshl_b32 s4, s58, 13
    s_add_u32 s4, s4, 17408
    v_lshlrev_b32_e64 v18, 6, v16
    v_lshl_add_u32 v18, v17, 4, v18
    v_add_u32 v8, s4, v18
    v_sub_u32 v22, 20, v16
    v_lshlrev_b32_e64 v23, 3, v17
    v_mov_b32 v24, 0x7f
    v_lshlrev_b32 v24, v22, v24
    v_subrev_u32 v22, 1, v22
    v_mov_b32 v25, 0x1ff
    v_lshlrev_b32 v25, v22, v25
    v_lshrrev_b32 v24, v23, v24
    v_lshrrev_b32 v25, v23, v25
    v_add_u32 v18, 1, v16
    v_and_b32 v22, 3, v18
    v_and_b32 v18, 28, v18
    v_lshl_add_u32 v26, v17, 3, v18
    v_lshl_add_u32 v26, v26, 1, s8
    v_mad_u32_u24 v1, v22, s9, v26
    v_lshlrev_b32 v26, 2, v17
    v_sub_u32 v18, v18, v26
    v_lshl_add_u32 v18, v18, 1, s8
    s_movk_i32 s4, 160
    v_mad_u32_u24 v2, v22, s4, v18
    s_mov_b32 s15, 0x3f800000
    v_bfe_i32 v27, v24, 0, 1
    v_bfe_i32 v28, v24, 1, 1
    v_and_b32 v27, 0x3f80, v27
    v_bfi_b32 v244, s15, v28, v27
    v_bfe_i32 v27, v24, 2, 1
    v_bfe_i32 v28, v24, 3, 1
    v_and_b32 v27, 0x3f80, v27
    v_bfi_b32 v245, s15, v28, v27
    v_bfe_i32 v27, v24, 4, 1
    v_bfe_i32 v28, v24, 5, 1
    v_and_b32 v27, 0x3f80, v27
    v_bfi_b32 v246, s15, v28, v27
    v_bfe_i32 v27, v24, 6, 1
    v_bfe_i32 v28, v24, 7, 1
    v_and_b32 v27, 0x3f80, v27
    v_bfi_b32 v247, s15, v28, v27
    v_bfe_i32 v27, v25, 0, 1
    v_bfe_i32 v28, v25, 1, 1
    v_and_b32 v27, 0x3f80, v27
    v_bfi_b32 v248, s15, v28, v27
    v_bfe_i32 v27, v25, 2, 1
    v_bfe_i32 v28, v25, 3, 1
    v_and_b32 v27, 0x3f80, v27
    v_bfi_b32 v249, s15, v28, v27
    v_bfe_i32 v27, v25, 4, 1
    v_bfe_i32 v28, v25, 5, 1
    v_and_b32 v27, 0x3f80, v27
    v_bfi_b32 v250, s15, v28, v27
    v_bfe_i32 v27, v25, 6, 1
    v_bfe_i32 v28, v25, 7, 1
    v_and_b32 v27, 0x3f80, v27
    v_bfi_b32 v251, s15, v28, v27
    v_lshlrev_b32 v33, 4, v10
    v_lshlrev_b32 v32, 2, v10
    v_sub_u32 v32, 122876, v32
    s_mov_b32 s31, s59
    s_lshl_b32 s13, s57, 14
    s_add_u32 s13, s13, 3145728
    s_and_b32 s12, s2, 7
    s_lshl_b32 s12, s12, 12
    s_lshl_b32 s4, s58, 7
    s_add_u32 s12, s12, s4
    s_lshr_b32 s4, s2, 3
    s_lshl_b32 s4, s4, 2
    s_add_u32 s12, s12, s4
    s_add_u32 s12, s12, 983040
    v_lshlrev_b32 v10, 3, v10
    v_add_u32 v9, 17408, v10
    s_mov_b32 s30, 0
    s_brev_b32 s68, 1
    s_waitcnt lgkmcnt(0)
    s_lshl_b32 s4, s58, 4
    s_lshr_b64 s[6:7], s[64:65], s4
    s_lshl_b32 s6, s6, 16
    v_mov_b32_e64 v228, s6
    v_mul_f32 v228, 0x3fb8aa3b, v228
    v_exp_f32 v228, v228
    s_nop 0
    v_cvt_pk_bf16_f32 v228, v228, v228
    v_and_b32 v228, 0xffff0000, v228
    s_lshl_b32 s4, s58, 12
    v_lshl_add_u32 v254, v0, 7, s4
    s_waitcnt vmcnt(0)
    s_mov_b32 exec_hi, 0
    buffer_load_dword v255, v254, s[44:47], s13 offen
    s_mov_b32 exec_hi, -1
    v_lshlrev_b32_e64 v236, 16, v224
    v_and_b32 v237, 0xffff0000, v224
    v_lshlrev_b32_e64 v238, 16, v225
    v_and_b32 v239, 0xffff0000, v225
    v_mul_f32 v236, 0x3fb8aa3b, v236
    v_mul_f32 v237, 0x3fb8aa3b, v237
    v_exp_f32 v236, v236
    v_exp_f32 v237, v237
    v_mul_f32 v238, v238, v228
    v_mul_f32 v239, v239, v228
    v_mul_f32 v232, 0x3e22f983, v238
    v_mul_f32 v233, 0x3e22f983, v239
    v_cvt_pk_bf16_f32 v238, v236, v237
    v_lshlrev_b32_e64 v236, 16, v238
    v_and_b32 v237, 0xffff0000, v238
    v_mul_f32 v236, v236, v228
    v_mul_f32 v237, v237, v228
    v_mul_f32 v230, 0xbfb8aa3b, v236
    v_mul_f32 v231, 0xbfb8aa3b, v237
    v_add_f32_e64 v228, v228, v228
    v_mul_f32 v28, 0x42000000, v230
    v_mul_f32 v30, 0x42000000, v232
    v_mul_f32 v29, 0x42000000, v231
    v_mul_f32 v31, 0x42000000, v233
    v_exp_f32 v20, v230
    v_fract_f32 v22, v232
    v_exp_f32 v28, v28
    v_fract_f32 v30, v30
    v_exp_f32 v21, v231
    v_fract_f32 v23, v233
    v_exp_f32 v29, v29
    v_fract_f32 v31, v31
    v_cos_f32 v16, v22
    v_lshlrev_b32 v240, 16, v226
    v_sin_f32_e64 v17, v22
    v_and_b32 v242, 0xffff0000, v226
    v_cos_f32 v18, v23
    v_lshlrev_b32 v241, 16, v227
    v_sin_f32_e64 v19, v23
    v_and_b32 v243, 0xffff0000, v227
    v_cos_f32 v24, v30
    v_mul_f32 v240, v240, v228
    v_sin_f32 v25, v30
    v_mul_f32 v241, v241, v228
    v_cos_f32 v26, v31
    v_mul_f32 v242, v242, v228
    v_sin_f32 v27, v31
    v_mul_f32 v243, v243, v228
    v_mul_f32 v16, v16, v20
    v_mul_f32 v17, v17, v20
    v_mul_f32 v18, v18, v21
    v_mul_f32 v19, v19, v21
    v_mul_f32 v24, v24, v28
    v_mul_f32 v25, v25, v28
    v_mul_f32 v26, v26, v29
    v_mul_f32 v27, v27, v29
    v_mov_b32 v112, 0x3c00
    v_mov_b32 v113, 0x3c00
    v_pk_mul_f32 v[20:21], v[16:17], v[16:17] op_sel_hi:[1,0]
    v_pk_mul_f32 v[22:23], v[18:19], v[18:19] op_sel_hi:[1,0]
    v_pk_mul_f32 v[28:29], v[24:25], v[24:25] op_sel_hi:[1,0]
    v_pk_mul_f32 v[30:31], v[26:27], v[26:27] op_sel_hi:[1,0]
    v_cvt_pk_f16_f32 v114, v16, v17
    v_cvt_pk_f16_f32 v115, v18, v19
    v_cvt_pk_f16_f32 v40, v24, v25
    v_cvt_pk_f16_f32 v41, v26, v27
    v_pk_fma_f32 v[16:17], v[16:17], v[16:17], v[20:21] op_sel:[1,1,0] op_sel_hi:[0,1,1] neg_lo:[1,0,0]
    v_pk_fma_f32 v[18:19], v[18:19], v[18:19], v[22:23] op_sel:[1,1,0] op_sel_hi:[0,1,1] neg_lo:[1,0,0]
    v_pk_fma_f32 v[24:25], v[24:25], v[24:25], v[28:29] op_sel:[1,1,0] op_sel_hi:[0,1,1] neg_lo:[1,0,0]
    v_pk_fma_f32 v[26:27], v[26:27], v[26:27], v[30:31] op_sel:[1,1,0] op_sel_hi:[0,1,1] neg_lo:[1,0,0]
    v_pk_mul_f32 v[20:21], v[16:17], v[16:17] op_sel_hi:[1,0]
    v_pk_mul_f32 v[22:23], v[18:19], v[18:19] op_sel_hi:[1,0]
    v_pk_mul_f32 v[28:29], v[24:25], v[24:25] op_sel_hi:[1,0]
    v_pk_mul_f32 v[30:31], v[26:27], v[26:27] op_sel_hi:[1,0]
    v_cvt_pk_f16_f32 v116, v16, v17
    v_cvt_pk_f16_f32 v117, v18, v19
    v_cvt_pk_f16_f32 v42, v24, v25
    v_cvt_pk_f16_f32 v43, v26, v27
    v_pk_fma_f32 v[16:17], v[16:17], v[16:17], v[20:21] op_sel:[1,1,0] op_sel_hi:[0,1,1] neg_lo:[1,0,0]
    v_pk_fma_f32 v[18:19], v[18:19], v[18:19], v[22:23] op_sel:[1,1,0] op_sel_hi:[0,1,1] neg_lo:[1,0,0]
    v_pk_fma_f32 v[24:25], v[24:25], v[24:25], v[28:29] op_sel:[1,1,0] op_sel_hi:[0,1,1] neg_lo:[1,0,0]
    v_pk_fma_f32 v[26:27], v[26:27], v[26:27], v[30:31] op_sel:[1,1,0] op_sel_hi:[0,1,1] neg_lo:[1,0,0]
    v_cvt_pk_f16_f32 v80, v240, -v241
    v_cvt_pk_f16_f32 v81, v242, -v243
    v_pk_mul_f32 v[20:21], v[16:17], v[16:17] op_sel_hi:[1,0]
    v_pk_mul_f32 v[22:23], v[18:19], v[18:19] op_sel_hi:[1,0]
    v_pk_mul_f32 v[28:29], v[24:25], v[24:25] op_sel_hi:[1,0]
    v_pk_mul_f32 v[30:31], v[26:27], v[26:27] op_sel_hi:[1,0]
    v_cvt_pk_f16_f32 v120, v16, v17
    v_cvt_pk_f16_f32 v121, v18, v19
    v_cvt_pk_f16_f32 v44, v24, v25
    v_cvt_pk_f16_f32 v45, v26, v27
    v_pk_fma_f32 v[16:17], v[16:17], v[16:17], v[20:21] op_sel:[1,1,0] op_sel_hi:[0,1,1] neg_lo:[1,0,0]
    v_pk_fma_f32 v[18:19], v[18:19], v[18:19], v[22:23] op_sel:[1,1,0] op_sel_hi:[0,1,1] neg_lo:[1,0,0]
    v_pk_fma_f32 v[24:25], v[24:25], v[24:25], v[28:29] op_sel:[1,1,0] op_sel_hi:[0,1,1] neg_lo:[1,0,0]
    v_pk_fma_f32 v[26:27], v[26:27], v[26:27], v[30:31] op_sel:[1,1,0] op_sel_hi:[0,1,1] neg_lo:[1,0,0]
    v_pk_mul_f16 v118, v116, v114 op_sel_hi:[1,0]
    v_pk_mul_f16 v119, v117, v115 op_sel_hi:[1,0]
    v_pk_mul_f16 v122, v120, v114 op_sel_hi:[1,0]
    v_pk_mul_f16 v123, v121, v115 op_sel_hi:[1,0]
    v_pk_fma_f16 v118, v116, v114, v118 op_sel:[1,1,0] op_sel_hi:[0,1,1] neg_lo:[1,0,0]
    v_pk_fma_f16 v119, v117, v115, v119 op_sel:[1,1,0] op_sel_hi:[0,1,1] neg_lo:[1,0,0]
    v_pk_fma_f16 v122, v120, v114, v122 op_sel:[1,1,0] op_sel_hi:[0,1,1] neg_lo:[1,0,0]
    v_pk_fma_f16 v123, v121, v115, v123 op_sel:[1,1,0] op_sel_hi:[0,1,1] neg_lo:[1,0,0]
    v_pk_mul_f32 v[20:21], v[16:17], v[16:17] op_sel_hi:[1,0]
    v_pk_mul_f32 v[22:23], v[18:19], v[18:19] op_sel_hi:[1,0]
    v_cvt_pk_f16_f32 v128, v16, v17
    v_cvt_pk_f16_f32 v129, v18, v19
    v_cvt_pk_f16_f32 v134, v24, v25
    v_cvt_pk_f16_f32 v135, v26, v27
    v_pk_fma_f32 v[16:17], v[16:17], v[16:17], v[20:21] op_sel:[1,1,0] op_sel_hi:[0,1,1] neg_lo:[1,0,0]
    v_pk_fma_f32 v[18:19], v[18:19], v[18:19], v[22:23] op_sel:[1,1,0] op_sel_hi:[0,1,1] neg_lo:[1,0,0]
    ds_write_addtid_b32 v112 offset:48064
    ds_write_addtid_b32 v113 offset:48320
    ds_write_addtid_b32 v114 offset:48608
    ds_write_addtid_b32 v115 offset:48864
    ds_write_addtid_b32 v116 offset:49152
    ds_write_addtid_b32 v117 offset:49408
    ds_write_addtid_b32 v120 offset:50240
    ds_write_addtid_b32 v121 offset:50496
    ds_write_addtid_b32 v118 offset:49696
    ds_write_addtid_b32 v119 offset:49952
    ds_write_addtid_b32 v122 offset:50784
    ds_write_addtid_b32 v123 offset:51040
    ds_write_addtid_b32 v128 offset:56768
    ds_write_addtid_b32 v129 offset:57024
    ds_write_addtid_b32 v134 offset:52416
    ds_write_addtid_b32 v135 offset:52672
    ds_write_addtid_b32 v44 offset:63296
    ds_write_addtid_b32 v45 offset:63552
    v_pk_mul_f16 v124, v120, v116 op_sel_hi:[1,0]
    v_pk_mul_f16 v125, v121, v117 op_sel_hi:[1,0]
    v_pk_mul_f16 v126, v120, v118 op_sel_hi:[1,0]
    v_pk_mul_f16 v127, v121, v119 op_sel_hi:[1,0]
    v_pk_fma_f16 v124, v120, v116, v124 op_sel:[1,1,0] op_sel_hi:[0,1,1] neg_lo:[1,0,0]
    v_pk_fma_f16 v125, v121, v117, v125 op_sel:[1,1,0] op_sel_hi:[0,1,1] neg_lo:[1,0,0]
    v_pk_fma_f16 v126, v120, v118, v126 op_sel:[1,1,0] op_sel_hi:[0,1,1] neg_lo:[1,0,0]
    v_pk_fma_f16 v127, v121, v119, v127 op_sel:[1,1,0] op_sel_hi:[0,1,1] neg_lo:[1,0,0]
    v_pk_mul_f16 v132, v128, v116 op_sel_hi:[1,0]
    v_pk_mul_f16 v133, v129, v117 op_sel_hi:[1,0]
    v_pk_mul_f16 v136, v134, v116 op_sel_hi:[1,0]
    v_pk_mul_f16 v137, v135, v117 op_sel_hi:[1,0]
    v_pk_fma_f16 v132, v128, v116, v132 op_sel:[1,1,0] op_sel_hi:[0,1,1] neg_lo:[1,0,0]
    v_pk_fma_f16 v133, v129, v117, v133 op_sel:[1,1,0] op_sel_hi:[0,1,1] neg_lo:[1,0,0]
    v_pk_fma_f16 v136, v134, v116, v136 op_sel:[1,1,0] op_sel_hi:[0,1,1] neg_lo:[1,0,0]
    v_pk_fma_f16 v137, v135, v117, v137 op_sel:[1,1,0] op_sel_hi:[0,1,1] neg_lo:[1,0,0]
    v_pk_mul_f16 v138, v134, v120 op_sel_hi:[1,0]
    v_pk_mul_f16 v139, v135, v121 op_sel_hi:[1,0]
    v_pk_mul_f16 v140, v134, v124 op_sel_hi:[1,0]
    v_pk_mul_f16 v141, v135, v125 op_sel_hi:[1,0]
    v_pk_fma_f16 v138, v134, v120, v138 op_sel:[1,1,0] op_sel_hi:[0,1,1] neg_lo:[1,0,0]
    v_pk_fma_f16 v139, v135, v121, v139 op_sel:[1,1,0] op_sel_hi:[0,1,1] neg_lo:[1,0,0]
    v_pk_fma_f16 v140, v134, v124, v140 op_sel:[1,1,0] op_sel_hi:[0,1,1] neg_lo:[1,0,0]
    v_pk_fma_f16 v141, v135, v125, v141 op_sel:[1,1,0] op_sel_hi:[0,1,1] neg_lo:[1,0,0]
    v_pk_mul_f16 v142, v134, v128 op_sel_hi:[1,0]
    v_pk_mul_f16 v143, v135, v129 op_sel_hi:[1,0]
    v_pk_mul_f16 v144, v134, v132 op_sel_hi:[1,0]
    v_pk_mul_f16 v145, v135, v133 op_sel_hi:[1,0]
    v_pk_fma_f16 v142, v134, v128, v142 op_sel:[1,1,0] op_sel_hi:[0,1,1] neg_lo:[1,0,0]
    v_pk_fma_f16 v143, v135, v129, v143 op_sel:[1,1,0] op_sel_hi:[0,1,1] neg_lo:[1,0,0]
    v_pk_fma_f16 v144, v134, v132, v144 op_sel:[1,1,0] op_sel_hi:[0,1,1] neg_lo:[1,0,0]
    v_pk_fma_f16 v145, v135, v133, v145 op_sel:[1,1,0] op_sel_hi:[0,1,1] neg_lo:[1,0,0]
    ds_write_addtid_b32 v124 offset:51328
    ds_write_addtid_b32 v125 offset:51584
    ds_write_addtid_b32 v126 offset:51872
    ds_write_addtid_b32 v127 offset:52128
    ds_write_addtid_b32 v132 offset:57856
    ds_write_addtid_b32 v133 offset:58112
    ds_write_addtid_b32 v136 offset:52960
    ds_write_addtid_b32 v137 offset:53216
    ds_write_addtid_b32 v138 offset:53504
    ds_write_addtid_b32 v139 offset:53760
    ds_write_addtid_b32 v138 offset:54592
    ds_write_addtid_b32 v139 offset:54848
    ds_write_addtid_b32 v140 offset:54048
    ds_write_addtid_b32 v141 offset:54304
    ds_write_addtid_b32 v140 offset:55136
    ds_write_addtid_b32 v141 offset:55392
    ds_write_addtid_b32 v142 offset:55680
    ds_write_addtid_b32 v143 offset:55936
    ds_write_addtid_b32 v144 offset:56224
    ds_write_addtid_b32 v145 offset:56480
    ds_read_b128 v[168:171], v12 offset:0
    ds_read_b128 v[172:175], v12 offset:64
    ds_read_b128 v[176:179], v12 offset:128
    ds_read_b128 v[180:183], v12 offset:192
    ds_read_b128 v[184:187], v12 offset:256
    ds_read_b128 v[188:191], v12 offset:320
    ds_read_b128 v[192:195], v12 offset:384
    ds_read_b128 v[196:199], v12 offset:448
    s_mov_b32 m0, s11
    s_nop 0
    v_cvt_pk_f16_f32 v38, v16, v17
    v_cvt_pk_f16_f32 v39, v18, v19
    v_pk_mul_f16 v82, v80, v128 op_sel_hi:[1,0]
    v_pk_mul_f16 v83, v81, v129 op_sel_hi:[1,0]
    v_pk_mul_f16 v88, v80, v40 op_sel_hi:[1,0]
    v_pk_mul_f16 v89, v81, v41 op_sel_hi:[1,0]
    v_pk_fma_f16 v82, v80, v128, v82 op_sel:[1,1,0] op_sel_hi:[0,1,1] neg_hi:[1,0,0]
    v_pk_fma_f16 v83, v81, v129, v83 op_sel:[1,1,0] op_sel_hi:[0,1,1] neg_hi:[1,0,0]
    v_pk_fma_f16 v88, v80, v40, v88 op_sel:[1,1,0] op_sel_hi:[0,1,1] neg_hi:[1,0,0]
    v_pk_fma_f16 v89, v81, v41, v89 op_sel:[1,1,0] op_sel_hi:[0,1,1] neg_hi:[1,0,0]
    v_pk_mul_f16 v84, v80, v38 op_sel_hi:[1,0]
    v_pk_mul_f16 v85, v81, v39 op_sel_hi:[1,0]
    v_pk_mul_f16 v86, v82, v38 op_sel_hi:[1,0]
    v_pk_mul_f16 v87, v83, v39 op_sel_hi:[1,0]
    v_pk_fma_f16 v84, v80, v38, v84 op_sel:[1,1,0] op_sel_hi:[0,1,1] neg_hi:[1,0,0]
    v_pk_fma_f16 v85, v81, v39, v85 op_sel:[1,1,0] op_sel_hi:[0,1,1] neg_hi:[1,0,0]
    v_pk_fma_f16 v86, v82, v38, v86 op_sel:[1,1,0] op_sel_hi:[0,1,1] neg_hi:[1,0,0]
    v_pk_fma_f16 v87, v83, v39, v87 op_sel:[1,1,0] op_sel_hi:[0,1,1] neg_hi:[1,0,0]
    v_pk_mul_f16 v90, v82, v40 op_sel_hi:[1,0]
    v_pk_mul_f16 v91, v83, v41 op_sel_hi:[1,0]
    v_pk_mul_f16 v96, v80, v42 op_sel_hi:[1,0]
    v_pk_mul_f16 v97, v81, v43 op_sel_hi:[1,0]
    v_pk_fma_f16 v90, v82, v40, v90 op_sel:[1,1,0] op_sel_hi:[0,1,1] neg_hi:[1,0,0]
    v_pk_fma_f16 v91, v83, v41, v91 op_sel:[1,1,0] op_sel_hi:[0,1,1] neg_hi:[1,0,0]
    v_pk_fma_f16 v96, v80, v42, v96 op_sel:[1,1,0] op_sel_hi:[0,1,1] neg_hi:[1,0,0]
    v_pk_fma_f16 v97, v81, v43, v97 op_sel:[1,1,0] op_sel_hi:[0,1,1] neg_hi:[1,0,0]
    v_pk_mul_f16 v92, v84, v40 op_sel_hi:[1,0]
    v_pk_mul_f16 v93, v85, v41 op_sel_hi:[1,0]
    v_pk_mul_f16 v94, v86, v40 op_sel_hi:[1,0]
    v_pk_mul_f16 v95, v87, v41 op_sel_hi:[1,0]
    v_pk_fma_f16 v92, v84, v40, v92 op_sel:[1,1,0] op_sel_hi:[0,1,1] neg_hi:[1,0,0]
    v_pk_fma_f16 v93, v85, v41, v93 op_sel:[1,1,0] op_sel_hi:[0,1,1] neg_hi:[1,0,0]
    v_pk_fma_f16 v94, v86, v40, v94 op_sel:[1,1,0] op_sel_hi:[0,1,1] neg_hi:[1,0,0]
    v_pk_fma_f16 v95, v87, v41, v95 op_sel:[1,1,0] op_sel_hi:[0,1,1] neg_hi:[1,0,0]
    ds_write_addtid_b32 v80 offset:17408
    ds_write_addtid_b32 v81 offset:17664
    ds_write_addtid_b32 v82 offset:17952
    ds_write_addtid_b32 v83 offset:18208
    ds_write_addtid_b32 v84 offset:18496
    ds_write_addtid_b32 v85 offset:18752
    ds_write_addtid_b32 v86 offset:19040
    ds_write_addtid_b32 v87 offset:19296
    ds_write_addtid_b32 v88 offset:19584
    ds_write_addtid_b32 v89 offset:19840
    ds_write_addtid_b32 v90 offset:20128
    ds_write_addtid_b32 v91 offset:20384
    ds_write_addtid_b32 v92 offset:20672
    ds_write_addtid_b32 v93 offset:20928
    ds_write_addtid_b32 v94 offset:21216
    ds_write_addtid_b32 v95 offset:21472
    ds_write_addtid_b32 v96 offset:21760
    ds_write_addtid_b32 v97 offset:22016
    v_pk_mul_f16 v98, v82, v42 op_sel_hi:[1,0]
    v_pk_mul_f16 v99, v83, v43 op_sel_hi:[1,0]
    v_pk_mul_f16 v104, v88, v42 op_sel_hi:[1,0]
    v_pk_mul_f16 v105, v89, v43 op_sel_hi:[1,0]
    v_pk_fma_f16 v98, v82, v42, v98 op_sel:[1,1,0] op_sel_hi:[0,1,1] neg_hi:[1,0,0]
    v_pk_fma_f16 v99, v83, v43, v99 op_sel:[1,1,0] op_sel_hi:[0,1,1] neg_hi:[1,0,0]
    v_pk_fma_f16 v104, v88, v42, v104 op_sel:[1,1,0] op_sel_hi:[0,1,1] neg_hi:[1,0,0]
    v_pk_fma_f16 v105, v89, v43, v105 op_sel:[1,1,0] op_sel_hi:[0,1,1] neg_hi:[1,0,0]
    v_pk_mul_f16 v100, v84, v42 op_sel_hi:[1,0]
    v_pk_mul_f16 v101, v85, v43 op_sel_hi:[1,0]
    v_pk_mul_f16 v102, v86, v42 op_sel_hi:[1,0]
    v_pk_mul_f16 v103, v87, v43 op_sel_hi:[1,0]
    v_pk_fma_f16 v100, v84, v42, v100 op_sel:[1,1,0] op_sel_hi:[0,1,1] neg_hi:[1,0,0]
    v_pk_fma_f16 v101, v85, v43, v101 op_sel:[1,1,0] op_sel_hi:[0,1,1] neg_hi:[1,0,0]
    v_pk_fma_f16 v102, v86, v42, v102 op_sel:[1,1,0] op_sel_hi:[0,1,1] neg_hi:[1,0,0]
    v_pk_fma_f16 v103, v87, v43, v103 op_sel:[1,1,0] op_sel_hi:[0,1,1] neg_hi:[1,0,0]
    v_pk_mul_f16 v106, v90, v42 op_sel_hi:[1,0]
    v_pk_mul_f16 v107, v91, v43 op_sel_hi:[1,0]
    v_pk_mul_f16 v108, v92, v42 op_sel_hi:[1,0]
    v_pk_mul_f16 v109, v93, v43 op_sel_hi:[1,0]
    v_pk_fma_f16 v106, v90, v42, v106 op_sel:[1,1,0] op_sel_hi:[0,1,1] neg_hi:[1,0,0]
    v_pk_fma_f16 v107, v91, v43, v107 op_sel:[1,1,0] op_sel_hi:[0,1,1] neg_hi:[1,0,0]
    v_pk_fma_f16 v108, v92, v42, v108 op_sel:[1,1,0] op_sel_hi:[0,1,1] neg_hi:[1,0,0]
    v_pk_fma_f16 v109, v93, v43, v109 op_sel:[1,1,0] op_sel_hi:[0,1,1] neg_hi:[1,0,0]
    v_pk_mul_f16 v110, v94, v42 op_sel_hi:[1,0]
    v_pk_mul_f16 v111, v95, v43 op_sel_hi:[1,0]
    v_pk_mul_f16 v130, v128, v114 op_sel_hi:[1,0]
    v_pk_mul_f16 v131, v129, v115 op_sel_hi:[1,0]
    v_pk_fma_f16 v110, v94, v42, v110 op_sel:[1,1,0] op_sel_hi:[0,1,1] neg_hi:[1,0,0]
    v_pk_fma_f16 v111, v95, v43, v111 op_sel:[1,1,0] op_sel_hi:[0,1,1] neg_hi:[1,0,0]
    v_pk_fma_f16 v130, v128, v114, v130 op_sel:[1,1,0] op_sel_hi:[0,1,1] neg_lo:[1,0,0]
    v_pk_fma_f16 v131, v129, v115, v131 op_sel:[1,1,0] op_sel_hi:[0,1,1] neg_lo:[1,0,0]
    ds_write_addtid_b32 v98 offset:22304
    ds_write_addtid_b32 v99 offset:22560
    ds_write_addtid_b32 v100 offset:22848
    ds_write_addtid_b32 v101 offset:23104
    ds_write_addtid_b32 v102 offset:23392
    ds_write_addtid_b32 v103 offset:23648
    ds_write_addtid_b32 v104 offset:23936
    ds_write_addtid_b32 v105 offset:24192
    ds_write_addtid_b32 v106 offset:24480
    ds_write_addtid_b32 v107 offset:24736
    ds_write_addtid_b32 v108 offset:25024
    ds_write_addtid_b32 v109 offset:25280
    ds_write_addtid_b32 v110 offset:25568
    ds_write_addtid_b32 v111 offset:25824
    ds_read_b128 v[48:51], v14 offset:0
    ds_read_b128 v[52:55], v14 offset:64
    ds_read_b128 v[56:59], v14 offset:128
    ds_read_b128 v[60:63], v14 offset:192
    ds_read_b128 v[64:67], v14 offset:256
    ds_read_b128 v[68:71], v14 offset:320
    ds_read_b128 v[72:75], v14 offset:384
    ds_read_b128 v[76:79], v14 offset:448
    ds_read_b128 v[80:83], v11 offset:15232
    ds_read_b128 v[84:87], v11 offset:15296
    ds_read_b128 v[88:91], v11 offset:15360
    ds_read_b128 v[92:95], v11 offset:15424
    ds_read_b128 v[96:99], v11 offset:15488
    ds_read_b128 v[100:103], v11 offset:15552
    ds_read_b128 v[104:107], v11 offset:15616
    ds_read_b128 v[108:111], v11 offset:15680
    s_sub_u32 m0, s8, 48064
    v_pk_mul_f32 v[28:29], v[24:25], v[24:25] op_sel_hi:[1,0]
    v_pk_mul_f32 v[30:31], v[26:27], v[26:27] op_sel_hi:[1,0]
    v_pk_fma_f32 v[24:25], v[24:25], v[24:25], v[28:29] op_sel:[1,1,0] op_sel_hi:[0,1,1] neg_lo:[1,0,0]
    v_pk_fma_f32 v[26:27], v[26:27], v[26:27], v[30:31] op_sel:[1,1,0] op_sel_hi:[0,1,1] neg_lo:[1,0,0]
    v_cvt_pk_f16_f32 v146, v24, v25
    v_cvt_pk_f16_f32 v147, v26, v27
    v_pk_mul_f32 v[28:29], v[24:25], v[24:25] op_sel_hi:[1,0]
    v_pk_mul_f32 v[30:31], v[26:27], v[26:27] op_sel_hi:[1,0]
    v_pk_fma_f32 v[24:25], v[24:25], v[24:25], v[28:29] op_sel:[1,1,0] op_sel_hi:[0,1,1] neg_lo:[1,0,0]
    v_pk_fma_f32 v[26:27], v[26:27], v[26:27], v[30:31] op_sel:[1,1,0] op_sel_hi:[0,1,1] neg_lo:[1,0,0]
    v_cvt_pk_f16_f32 v166, v24, v25
    v_cvt_pk_f16_f32 v167, v26, v27
    s_waitcnt lgkmcnt(8)
    s_nop 0
    v_mfma_f32_16x16x32_f16 v[204:207], v[168:171], v[48:51], 0
    v_pk_mul_f16 v152, v146, v134 op_sel_hi:[1,0]
    v_pk_mul_f16 v153, v147, v135 op_sel_hi:[1,0]
    v_pk_mul_f16 v148, v146, v120 op_sel_hi:[1,0]
    v_pk_mul_f16 v149, v147, v121 op_sel_hi:[1,0]
    v_mfma_f32_16x16x32_f16 v[204:207], v[172:175], v[52:55], v[204:207]
    v_pk_fma_f16 v152, v146, v134, v152 op_sel:[1,1,0] op_sel_hi:[0,1,1] neg_lo:[1,0,0]
    v_pk_fma_f16 v153, v147, v135, v153 op_sel:[1,1,0] op_sel_hi:[0,1,1] neg_lo:[1,0,0]
    v_pk_fma_f16 v148, v146, v120, v148 op_sel:[1,1,0] op_sel_hi:[0,1,1] neg_lo:[1,0,0]
    v_pk_fma_f16 v149, v147, v121, v149 op_sel:[1,1,0] op_sel_hi:[0,1,1] neg_lo:[1,0,0]
    v_mfma_f32_16x16x32_f16 v[204:207], v[176:179], v[56:59], v[204:207]
    v_pk_mul_f16 v150, v146, v128 op_sel_hi:[1,0]
    v_pk_mul_f16 v151, v147, v129 op_sel_hi:[1,0]
    v_pk_mul_f16 v158, v128, v166 op_sel_hi:[1,0]
    v_pk_mul_f16 v159, v129, v167 op_sel_hi:[1,0]
    v_mfma_f32_16x16x32_f16 v[204:207], v[180:183], v[60:63], v[204:207]
    v_pk_fma_f16 v150, v146, v128, v150 op_sel:[1,1,0] op_sel_hi:[0,1,1] neg_lo:[1,0,0]
    v_pk_fma_f16 v151, v147, v129, v151 op_sel:[1,1,0] op_sel_hi:[0,1,1] neg_lo:[1,0,0]
    v_pk_fma_f16 v158, v128, v166, v158 op_sel:[1,1,0] op_sel_hi:[0,1,1] neg_lo:[1,0,0]
    v_pk_fma_f16 v159, v129, v167, v159 op_sel:[1,1,0] op_sel_hi:[0,1,1] neg_lo:[1,0,0]
    v_mfma_f32_16x16x32_f16 v[204:207], v[184:187], v[64:67], v[204:207]
    v_pk_mul_f16 v154, v152, v120 op_sel_hi:[1,0]
    v_pk_mul_f16 v155, v153, v121 op_sel_hi:[1,0]
    v_pk_mul_f16 v156, v152, v128 op_sel_hi:[1,0]
    v_pk_mul_f16 v157, v153, v129 op_sel_hi:[1,0]
    v_mfma_f32_16x16x32_f16 v[204:207], v[188:191], v[68:71], v[204:207]
    v_pk_fma_f16 v154, v152, v120, v154 op_sel:[1,1,0] op_sel_hi:[0,1,1] neg_lo:[1,0,0]
    v_pk_fma_f16 v155, v153, v121, v155 op_sel:[1,1,0] op_sel_hi:[0,1,1] neg_lo:[1,0,0]
    v_pk_fma_f16 v156, v152, v128, v156 op_sel:[1,1,0] op_sel_hi:[0,1,1] neg_lo:[1,0,0]
    v_pk_fma_f16 v157, v153, v129, v157 op_sel:[1,1,0] op_sel_hi:[0,1,1] neg_lo:[1,0,0]
    v_mfma_f32_16x16x32_f16 v[204:207], v[192:195], v[72:75], v[204:207]
    v_pk_mul_f16 v160, v142, v166 op_sel_hi:[1,0]
    v_pk_mul_f16 v161, v143, v167 op_sel_hi:[1,0]
    v_pk_mul_f16 v162, v150, v166 op_sel_hi:[1,0]
    v_pk_mul_f16 v163, v151, v167 op_sel_hi:[1,0]
    v_mfma_f32_16x16x32_f16 v[204:207], v[196:199], v[76:79], v[204:207]
    v_pk_fma_f16 v160, v142, v166, v160 op_sel:[1,1,0] op_sel_hi:[0,1,1] neg_lo:[1,0,0]
    v_pk_fma_f16 v161, v143, v167, v161 op_sel:[1,1,0] op_sel_hi:[0,1,1] neg_lo:[1,0,0]
    v_pk_fma_f16 v162, v150, v166, v162 op_sel:[1,1,0] op_sel_hi:[0,1,1] neg_lo:[1,0,0]
    v_pk_fma_f16 v163, v151, v167, v163 op_sel:[1,1,0] op_sel_hi:[0,1,1] neg_lo:[1,0,0]
    v_pk_mul_f16 v164, v156, v166 op_sel_hi:[1,0]
    v_pk_mul_f16 v165, v157, v167 op_sel_hi:[1,0]
    v_pk_fma_f16 v164, v156, v166, v164 op_sel:[1,1,0] op_sel_hi:[0,1,1] neg_lo:[1,0,0]
    v_pk_fma_f16 v165, v157, v167, v165 op_sel:[1,1,0] op_sel_hi:[0,1,1] neg_lo:[1,0,0]
    ds_write_addtid_b32 v130 offset:57312
    ds_write_addtid_b32 v131 offset:57568
    ds_write_addtid_b32 v146 offset:58944
    ds_write_addtid_b32 v147 offset:59200
    ds_write_addtid_b32 v152 offset:61120
    ds_write_addtid_b32 v153 offset:61376
    ds_write_addtid_b32 v148 offset:59488
    ds_write_addtid_b32 v149 offset:59744
    ds_write_addtid_b32 v150 offset:60032
    ds_write_addtid_b32 v151 offset:60288
    ds_write_addtid_b32 v158 offset:64928
    ds_write_addtid_b32 v159 offset:65184
    ds_write_addtid_b32 v154 offset:61664
    ds_write_addtid_b32 v155 offset:61920
    ds_write_addtid_b32 v156 offset:62208
    ds_write_addtid_b32 v157 offset:62464
    ds_write_addtid_b32 v160 offset:58400
    ds_write_addtid_b32 v161 offset:58656
    ds_write_addtid_b32 v162 offset:60576
    ds_write_addtid_b32 v163 offset:60832
    ds_write_addtid_b32 v164 offset:62752
    ds_write_addtid_b32 v165 offset:63008
    ds_read_b128 v[112:115], v13 offset:0
    ds_read_b128 v[116:119], v13 offset:64
    ds_read_b128 v[120:123], v13 offset:128
    ds_read_b128 v[124:127], v13 offset:192
    ds_read_b128 v[128:131], v13 offset:256
    ds_read_b128 v[132:135], v13 offset:320
    ds_read_b128 v[136:139], v13 offset:384
    ds_read_b128 v[140:143], v13 offset:448
    s_mov_b64 exec, 0xffff
    ds_write_b64 v200, v[252:253]
    s_mov_b32 exec_lo, -1
    ds_write_b64 v201, v[252:253] offset:2080
    ds_write_b64 v202, v[252:253] offset:9472
    s_mov_b64 exec, -1
    ds_read_b32 v34, v6 offset:128
    s_buffer_load_dwordx8 s[16:23], s[44:47], s31
L_XI1:
    v_pk_mul_f16 v220, v48, v80 op_sel_hi:[1,0]
    v_pk_mul_f16 v221, v49, v81 op_sel_hi:[1,0]
    v_pk_mul_f16 v222, v50, v82 op_sel_hi:[1,0]
    v_pk_mul_f16 v223, v51, v83 op_sel_hi:[1,0]
    v_pk_fma_f16 v80, v48, v80, v220 op_sel:[1,1,0] op_sel_hi:[0,1,1] neg_hi:[1,0,0]
    v_pk_fma_f16 v81, v49, v81, v221 op_sel:[1,1,0] op_sel_hi:[0,1,1] neg_hi:[1,0,0]
    v_pk_fma_f16 v82, v50, v82, v222 op_sel:[1,1,0] op_sel_hi:[0,1,1] neg_hi:[1,0,0]
    v_pk_fma_f16 v83, v51, v83, v223 op_sel:[1,1,0] op_sel_hi:[0,1,1] neg_hi:[1,0,0]
    v_pk_mul_f16 v220, v52, v84 op_sel_hi:[1,0]
    v_pk_mul_f16 v221, v53, v85 op_sel_hi:[1,0]
    v_mfma_f32_16x16x32_f16 v[208:211], v[168:171], v[80:83], 0
    v_pk_mul_f16 v222, v54, v86 op_sel_hi:[1,0]
    v_pk_mul_f16 v223, v55, v87 op_sel_hi:[1,0]
    v_pk_fma_f16 v84, v52, v84, v220 op_sel:[1,1,0] op_sel_hi:[0,1,1] neg_hi:[1,0,0]
    v_pk_fma_f16 v85, v53, v85, v221 op_sel:[1,1,0] op_sel_hi:[0,1,1] neg_hi:[1,0,0]
    v_pk_fma_f16 v86, v54, v86, v222 op_sel:[1,1,0] op_sel_hi:[0,1,1] neg_hi:[1,0,0]
    v_pk_fma_f16 v87, v55, v87, v223 op_sel:[1,1,0] op_sel_hi:[0,1,1] neg_hi:[1,0,0]
    s_waitcnt lgkmcnt(9)
    s_nop 0
    v_pk_mul_f16 v220, v56, v88 op_sel_hi:[1,0]
    v_pk_mul_f16 v221, v57, v89 op_sel_hi:[1,0]
    v_mfma_f32_16x16x32_f16 v[208:211], v[172:175], v[84:87], v[208:211]
    v_pk_mul_f16 v222, v58, v90 op_sel_hi:[1,0]
    v_pk_mul_f16 v223, v59, v91 op_sel_hi:[1,0]
    v_pk_fma_f16 v88, v56, v88, v220 op_sel:[1,1,0] op_sel_hi:[0,1,1] neg_hi:[1,0,0]
    v_mfma_f32_16x16x32_f16 v[212:215], v[112:115], v[48:51], 0
    v_pk_fma_f16 v89, v57, v89, v221 op_sel:[1,1,0] op_sel_hi:[0,1,1] neg_hi:[1,0,0]
    v_pk_fma_f16 v90, v58, v90, v222 op_sel:[1,1,0] op_sel_hi:[0,1,1] neg_hi:[1,0,0]
    v_pk_fma_f16 v91, v59, v91, v223 op_sel:[1,1,0] op_sel_hi:[0,1,1] neg_hi:[1,0,0]
    v_mfma_f32_16x16x32_f16 v[216:219], v[112:115], v[80:83], 0
    v_pk_mul_f16 v220, v60, v92 op_sel_hi:[1,0]
    v_pk_mul_f16 v221, v61, v93 op_sel_hi:[1,0]
    v_mfma_f32_16x16x32_f16 v[208:211], v[176:179], v[88:91], v[208:211]
    v_pk_mul_f16 v222, v62, v94 op_sel_hi:[1,0]
    v_pk_mul_f16 v223, v63, v95 op_sel_hi:[1,0]
    v_pk_fma_f16 v92, v60, v92, v220 op_sel:[1,1,0] op_sel_hi:[0,1,1] neg_hi:[1,0,0]
    v_mfma_f32_16x16x32_f16 v[212:215], v[116:119], v[52:55], v[212:215]
    v_pk_fma_f16 v93, v61, v93, v221 op_sel:[1,1,0] op_sel_hi:[0,1,1] neg_hi:[1,0,0]
    v_pk_fma_f16 v94, v62, v94, v222 op_sel:[1,1,0] op_sel_hi:[0,1,1] neg_hi:[1,0,0]
    v_pk_fma_f16 v95, v63, v95, v223 op_sel:[1,1,0] op_sel_hi:[0,1,1] neg_hi:[1,0,0]
    v_mfma_f32_16x16x32_f16 v[216:219], v[116:119], v[84:87], v[216:219]
    s_waitcnt lgkmcnt(7)
    s_nop 0
    v_pk_mul_f16 v220, v64, v96 op_sel_hi:[1,0]
    v_pk_mul_f16 v221, v65, v97 op_sel_hi:[1,0]
    v_mfma_f32_16x16x32_f16 v[208:211], v[180:183], v[92:95], v[208:211]
    v_pk_mul_f16 v222, v66, v98 op_sel_hi:[1,0]
    v_pk_mul_f16 v223, v67, v99 op_sel_hi:[1,0]
    v_pk_fma_f16 v96, v64, v96, v220 op_sel:[1,1,0] op_sel_hi:[0,1,1] neg_hi:[1,0,0]
    v_mfma_f32_16x16x32_f16 v[212:215], v[120:123], v[56:59], v[212:215]
    v_pk_fma_f16 v97, v65, v97, v221 op_sel:[1,1,0] op_sel_hi:[0,1,1] neg_hi:[1,0,0]
    v_pk_fma_f16 v98, v66, v98, v222 op_sel:[1,1,0] op_sel_hi:[0,1,1] neg_hi:[1,0,0]
    v_pk_fma_f16 v99, v67, v99, v223 op_sel:[1,1,0] op_sel_hi:[0,1,1] neg_hi:[1,0,0]
    v_mfma_f32_16x16x32_f16 v[216:219], v[120:123], v[88:91], v[216:219]
    v_pk_mul_f16 v220, v68, v100 op_sel_hi:[1,0]
    v_pk_mul_f16 v221, v69, v101 op_sel_hi:[1,0]
    v_mfma_f32_16x16x32_f16 v[208:211], v[184:187], v[96:99], v[208:211]
    v_pk_mul_f16 v222, v70, v102 op_sel_hi:[1,0]
    v_pk_mul_f16 v223, v71, v103 op_sel_hi:[1,0]
    v_pk_fma_f16 v100, v68, v100, v220 op_sel:[1,1,0] op_sel_hi:[0,1,1] neg_hi:[1,0,0]
    v_mfma_f32_16x16x32_f16 v[212:215], v[124:127], v[60:63], v[212:215]
    v_pk_fma_f16 v101, v69, v101, v221 op_sel:[1,1,0] op_sel_hi:[0,1,1] neg_hi:[1,0,0]
    v_pk_fma_f16 v102, v70, v102, v222 op_sel:[1,1,0] op_sel_hi:[0,1,1] neg_hi:[1,0,0]
    v_pk_fma_f16 v103, v71, v103, v223 op_sel:[1,1,0] op_sel_hi:[0,1,1] neg_hi:[1,0,0]
    v_mfma_f32_16x16x32_f16 v[216:219], v[124:127], v[92:95], v[216:219]
    s_waitcnt lgkmcnt(5)
    s_nop 0
    v_pk_mul_f16 v220, v72, v104 op_sel_hi:[1,0]
    v_pk_mul_f16 v221, v73, v105 op_sel_hi:[1,0]
    v_mfma_f32_16x16x32_f16 v[208:211], v[188:191], v[100:103], v[208:211]
    v_pk_mul_f16 v222, v74, v106 op_sel_hi:[1,0]
    v_pk_mul_f16 v223, v75, v107 op_sel_hi:[1,0]
    v_pk_fma_f16 v104, v72, v104, v220 op_sel:[1,1,0] op_sel_hi:[0,1,1] neg_hi:[1,0,0]
    v_mfma_f32_16x16x32_f16 v[212:215], v[128:131], v[64:67], v[212:215]
    v_pk_fma_f16 v105, v73, v105, v221 op_sel:[1,1,0] op_sel_hi:[0,1,1] neg_hi:[1,0,0]
    v_pk_fma_f16 v106, v74, v106, v222 op_sel:[1,1,0] op_sel_hi:[0,1,1] neg_hi:[1,0,0]
    v_pk_fma_f16 v107, v75, v107, v223 op_sel:[1,1,0] op_sel_hi:[0,1,1] neg_hi:[1,0,0]
    v_mfma_f32_16x16x32_f16 v[216:219], v[128:131], v[96:99], v[216:219]
    v_pk_mul_f16 v220, v76, v108 op_sel_hi:[1,0]
    v_pk_mul_f16 v221, v77, v109 op_sel_hi:[1,0]
    v_mfma_f32_16x16x32_f16 v[208:211], v[192:195], v[104:107], v[208:211]
    v_pk_mul_f16 v222, v78, v110 op_sel_hi:[1,0]
    v_pk_mul_f16 v223, v79, v111 op_sel_hi:[1,0]
    v_pk_fma_f16 v108, v76, v108, v220 op_sel:[1,1,0] op_sel_hi:[0,1,1] neg_hi:[1,0,0]
    v_mfma_f32_16x16x32_f16 v[212:215], v[132:135], v[68:71], v[212:215]
    v_pk_fma_f16 v109, v77, v109, v221 op_sel:[1,1,0] op_sel_hi:[0,1,1] neg_hi:[1,0,0]
    v_pk_fma_f16 v110, v78, v110, v222 op_sel:[1,1,0] op_sel_hi:[0,1,1] neg_hi:[1,0,0]
    v_pk_fma_f16 v111, v79, v111, v223 op_sel:[1,1,0] op_sel_hi:[0,1,1] neg_hi:[1,0,0]
    v_mfma_f32_16x16x32_f16 v[216:219], v[132:135], v[100:103], v[216:219]
    s_waitcnt lgkmcnt(3)
    s_nop 0
    v_mfma_f32_16x16x32_f16 v[208:211], v[196:199], v[108:111], v[208:211]
    v_mfma_f32_16x16x32_f16 v[212:215], v[136:139], v[72:75], v[212:215]
    v_mfma_f32_16x16x32_f16 v[216:219], v[136:139], v[104:107], v[216:219]
    v_mfma_f32_16x16x32_f16 v[212:215], v[140:143], v[76:79], v[212:215]
    v_mfma_f32_16x16x32_f16 v[216:219], v[140:143], v[108:111], v[216:219]
    s_waitcnt lgkmcnt(0)
    v_readfirstlane_b32 s28, v34
    s_add_u32 s31, s31, 64
    s_mov_b32 s29, s28
    s_cmp_eq_u32 s28, 0
    s_cbranch_scc1 L_XE1
    s_xor_b64 s[16:17], s[16:17], s[28:29]
    s_xor_b64 s[18:19], s[18:19], s[28:29]
    s_xor_b64 s[20:21], s[20:21], s[28:29]
    s_xor_b64 s[22:23], s[22:23], s[28:29]
    s_or_b64 s[16:17], s[16:17], s[18:19]
    s_or_b64 s[20:21], s[20:21], s[22:23]
    s_or_b64 s[16:17], s[16:17], s[20:21]
    s_cbranch_scc1 L_XE1
    s_setprio 3
    s_add_u32 s4, s13, 0
    buffer_load_dwordx4 v[16:19], v33, s[44:47], s4 offen sc1
    s_add_u32 s4, s13, 4096
    buffer_load_dwordx4 v[20:23], v33, s[44:47], s4 offen sc1
    s_add_u32 s4, s13, 8192
    buffer_load_dwordx4 v[24:27], v33, s[44:47], s4 offen sc1
    s_add_u32 s4, s13, 12288
    buffer_load_dwordx4 v[28:31], v33, s[44:47], s4 offen sc1
    s_mov_b64 exec, 1
    ds_write_b32 v4, v5 offset:544
    s_mov_b64 exec, -1
    s_setprio 2
    s_mov_b32 s30, 1
L_XE1:
    s_cmp_lg_u32 s30, 0
    s_cbranch_scc1 L_XI2
    ds_read_b32 v34, v6 offset:128
    s_buffer_load_dwordx8 s[16:23], s[44:47], s31
L_XI2:
    s_lshl_b32 s4, s58, 4
    s_lshr_b64 s[6:7], s[66:67], s4
    s_lshl_b32 s6, s6, 16
    v_permlane32_swap_b32 v204, v208
    v_permlane32_swap_b32 v205, v209
    v_permlane32_swap_b32 v206, v210
    v_permlane32_swap_b32 v207, v211
    v_cvt_pk_bf16_f32 v220, v215, v219
    s_mov_b64 exec, 1
    v_add_f32 v204, s6, v204
    v_add_f32 v204, 1.0, v204
    s_mov_b64 exec, -1
    v_permlane32_swap_b32 v212, v216
    v_permlane32_swap_b32 v213, v217
    v_permlane32_swap_b32 v214, v218
    ds_write_b16 v47, v220 offset:9504
    ds_write_b16_d16_hi v47, v220 offset:9520
    ds_write_b16 v47, v220 offset:9662
    ds_write_b16_d16_hi v47, v220 offset:9678
    ds_write_b16 v47, v220 offset:9820
    ds_write_b16_d16_hi v47, v220 offset:9836
    ds_write_b16 v47, v220 offset:9978
    ds_write_b16_d16_hi v47, v220 offset:9994
    v_cvt_pk_bf16_f32 v48, v204, v205
    v_cvt_pk_bf16_f32 v49, v206, v207
    v_cvt_pk_bf16_f32 v50, v205, v206
    v_cvt_pk_bf16_f32 v51, v207, v212
    v_cvt_pk_bf16_f32 v52, v206, v207
    v_cvt_pk_bf16_f32 v53, v212, v213
    v_cvt_pk_bf16_f32 v54, v207, v212
    v_cvt_pk_bf16_f32 v55, v213, v214
    v_cvt_pk_bf16_f32 v56, v208, v208
    v_cvt_pk_bf16_f32 v57, v209, v210
    v_cvt_pk_bf16_f32 v58, v208, v209
    v_cvt_pk_bf16_f32 v59, v210, v210
    v_cvt_pk_bf16_f32 v60, v209, v210
    v_cvt_pk_bf16_f32 v61, v210, v210
    v_cvt_pk_bf16_f32 v62, v210, v210
    v_cvt_pk_bf16_f32 v63, v210, v211
    v_cvt_pk_bf16_f32 v64, v216, v216
    v_cvt_pk_bf16_f32 v65, v216, v217
    v_cvt_pk_bf16_f32 v66, v217, v217
    v_cvt_pk_bf16_f32 v67, v218, v218
    v_cvt_pk_bf16_f32 v68, v216, v216
    v_cvt_pk_bf16_f32 v69, v217, v217
    v_cvt_pk_bf16_f32 v70, v217, v218
    v_cvt_pk_bf16_f32 v71, v218, v218
    v_cvt_pk_bf16_f32 v72, v216, v217
    v_cvt_pk_bf16_f32 v73, v217, v217
    v_cvt_pk_bf16_f32 v74, v218, v218
    v_cvt_pk_bf16_f32 v75, v218, v218
    v_cvt_pk_bf16_f32 v76, v217, v217
    v_cvt_pk_bf16_f32 v77, v217, v218
    v_cvt_pk_bf16_f32 v78, v218, v218
    v_cvt_pk_bf16_f32 v79, v218, v218
    v_cvt_pk_bf16_f32 v80, v252, v204
    v_mov_b32 v81, v50
    v_mov_b32 v82, v79
    v_cvt_pk_bf16_f32 v83, v218, v252
    s_cmp_lg_u32 s30, 0
    s_cbranch_scc1 L_XE2
    s_waitcnt lgkmcnt(0)
    v_readfirstlane_b32 s28, v34
    s_add_u32 s31, s31, 64
    s_mov_b32 s29, s28
    s_cmp_eq_u32 s28, 0
    s_cbranch_scc1 L_XE2
    s_xor_b64 s[16:17], s[16:17], s[28:29]
    s_xor_b64 s[18:19], s[18:19], s[28:29]
    s_xor_b64 s[20:21], s[20:21], s[28:29]
    s_xor_b64 s[22:23], s[22:23], s[28:29]
    s_or_b64 s[16:17], s[16:17], s[18:19]
    s_or_b64 s[20:21], s[20:21], s[22:23]
    s_or_b64 s[16:17], s[16:17], s[20:21]
    s_cbranch_scc1 L_XE2
    s_setprio 3
    s_add_u32 s4, s13, 0
    buffer_load_dwordx4 v[16:19], v33, s[44:47], s4 offen sc1
    s_add_u32 s4, s13, 4096
    buffer_load_dwordx4 v[20:23], v33, s[44:47], s4 offen sc1
    s_add_u32 s4, s13, 8192
    buffer_load_dwordx4 v[24:27], v33, s[44:47], s4 offen sc1
    s_add_u32 s4, s13, 12288
    buffer_load_dwordx4 v[28:31], v33, s[44:47], s4 offen sc1
    s_mov_b64 exec, 1
    ds_write_b32 v4, v5 offset:544
    s_mov_b64 exec, -1
    s_setprio 2
    s_mov_b32 s30, 1
L_XE2:
    ds_write_b64 v203, v[48:49] offset:32
    ds_write_b64 v203, v[50:51] offset:2400
    ds_write_b64 v203, v[52:53] offset:4768
    ds_write_b64 v203, v[54:55] offset:7136
    ds_write_b64 v203, v[56:57] offset:544
    ds_write_b64 v203, v[58:59] offset:2912
    ds_write_b64 v203, v[60:61] offset:5280
    ds_write_b64 v203, v[62:63] offset:7648
    ds_write_b128 v46, v[64:67] offset:1056
    ds_write_b128 v46, v[68:71] offset:3424
    ds_write_b128 v46, v[72:75] offset:5792
    ds_write_b128 v46, v[76:79] offset:8160
    s_mov_b64 exec, 1
    ds_write_b32 v35, v80 offset:2396
    ds_write_b32 v35, v48 offset:4764
    ds_write_b64 v35, v[80:81] offset:7128
    s_brev_b64 exec, 1
    ds_write_b64 v35, v[78:79] offset:2080
    ds_write_b32 v35, v83 offset:2088
    ds_write_b64 v35, v[78:79] offset:4448
    ds_write_b64 v35, v[82:83] offset:6816
    ds_write_b32 v35, v79 offset:9184
    s_mov_b64 exec, -1
LW_1:
    ds_read_b32 v34, v6 offset:128
    s_waitcnt lgkmcnt(0)
    v_cmp_eq_u32 vcc, 0, v34
    s_cbranch_vccnz LW_1
    s_cmp_lg_u32 s30, 0
    s_cbranch_scc1 L_XS1
    s_buffer_load_dwordx8 s[16:23], s[44:47], s31
L_XS1:
    v_readfirstlane_b32 s28, v34
    ds_write_b64 v15, v[252:253] offset:4096
    s_mov_b32 s5, 0
    s_mov_b32 s29, s28
    s_nop 0
    ds_read_b64 v[48:49], v1 offset:0
    ds_read_b64 v[50:51], v1 offset:8
    ds_read_b64 v[52:53], v1 offset:64
    ds_read_b64 v[54:55], v1 offset:72
    ds_read_b64 v[56:57], v1 offset:128
    ds_read_b64 v[58:59], v1 offset:136
    ds_read_b64 v[60:61], v1 offset:192
    ds_read_b64 v[62:63], v1 offset:200
    ds_read_b64 v[64:65], v1 offset:256
    ds_read_b64 v[66:67], v1 offset:264
    ds_read_b64 v[68:69], v1 offset:320
    ds_read_b64 v[70:71], v1 offset:328
    ds_read_b64 v[72:73], v1 offset:384
    ds_read_b64 v[74:75], v1 offset:392
    ds_read_b64 v[76:77], v1 offset:448
    ds_read_b64 v[78:79], v1 offset:456
    ds_read_b64 v[80:81], v1 offset:512
    ds_read_b64 v[82:83], v1 offset:520
    ds_read_b64 v[84:85], v1 offset:576
    ds_read_b64 v[86:87], v1 offset:584
    ds_read_b64 v[88:89], v1 offset:640
    ds_read_b64 v[90:91], v1 offset:648
    ds_read_b64 v[92:93], v1 offset:704
    ds_read_b64 v[94:95], v1 offset:712
    ds_read_b64 v[96:97], v1 offset:768
    ds_read_b64 v[98:99], v1 offset:776
    ds_read_b64 v[100:101], v1 offset:832
    ds_read_b64 v[102:103], v1 offset:840
    ds_read_b64 v[104:105], v1 offset:896
    ds_read_b64 v[106:107], v1 offset:904
    ds_read_b64 v[108:109], v1 offset:960
    ds_read_b64 v[110:111], v1 offset:968
    ds_read_b64 v[112:113], v1 offset:1024
    ds_read_b64 v[114:115], v1 offset:1032
    ds_read_b64 v[116:117], v1 offset:1088
    ds_read_b64 v[118:119], v1 offset:1096
    ds_read_b64 v[120:121], v1 offset:1152
    ds_read_b64 v[122:123], v1 offset:1160
    ds_read_b64 v[124:125], v1 offset:1216
    ds_read_b64 v[126:127], v1 offset:1224
    s_cmp_lg_u32 s30, 0
    s_cbranch_scc1 L_XA
    s_waitcnt lgkmcnt(0)
    s_xor_b64 s[16:17], s[16:17], s[28:29]
    s_xor_b64 s[18:19], s[18:19], s[28:29]
    s_xor_b64 s[20:21], s[20:21], s[28:29]
    s_xor_b64 s[22:23], s[22:23], s[28:29]
    s_or_b64 s[16:17], s[16:17], s[18:19]
    s_or_b64 s[20:21], s[20:21], s[22:23]
    s_or_b64 s[16:17], s[16:17], s[20:21]
    s_cbranch_scc1 L_XF
    s_setprio 3
    s_add_u32 s4, s13, 0
    s_nop 0
    buffer_load_dwordx4 v[16:19], v33, s[44:47], s4 offen sc1
    s_add_u32 s4, s13, 4096
    buffer_load_dwordx4 v[20:23], v33, s[44:47], s4 offen sc1
    s_add_u32 s4, s13, 8192
    buffer_load_dwordx4 v[24:27], v33, s[44:47], s4 offen sc1
    s_add_u32 s4, s13, 12288
    buffer_load_dwordx4 v[28:31], v33, s[44:47], s4 offen sc1
    s_mov_b64 exec, 1
    ds_write_b32 v4, v5 offset:544
    s_mov_b64 exec, -1
    s_setprio 2
L_XA:
    s_nop 0
    ds_read_b64 v[128:129], v1 offset:1280
    ds_read_b64 v[130:131], v1 offset:1288
    ds_read_b64 v[132:133], v1 offset:1344
    ds_read_b64 v[134:135], v1 offset:1352
    ds_read_b64 v[136:137], v1 offset:1408
    ds_read_b64 v[138:139], v1 offset:1416
    ds_read_b64 v[140:141], v1 offset:1472
    ds_read_b64 v[142:143], v1 offset:1480
    ds_read_b64 v[144:145], v1 offset:1536
    ds_read_b64 v[146:147], v1 offset:1544
    ds_read_b64 v[148:149], v1 offset:1600
    ds_read_b64 v[150:151], v1 offset:1608
    ds_read_b64 v[152:153], v1 offset:1664
    ds_read_b64 v[154:155], v1 offset:1672
    ds_read_b64 v[156:157], v1 offset:1728
    ds_read_b64 v[158:159], v1 offset:1736
    ds_read_b64 v[160:161], v1 offset:1792
    ds_read_b64 v[162:163], v1 offset:1800
    ds_read_b64 v[164:165], v1 offset:1856
    ds_read_b64 v[166:167], v1 offset:1864
    ds_read_b64 v[168:169], v1 offset:1920
    ds_read_b64 v[170:171], v1 offset:1928
    ds_read_b64 v[172:173], v1 offset:1984
    ds_read_b64 v[174:175], v1 offset:1992
    ds_read_b64 v[176:177], v1 offset:2048
    ds_read_b64 v[178:179], v1 offset:2056
L_XBACK:
    s_waitcnt vmcnt(3)
    v_lshlrev_b32 v36, 16, v16
    v_and_b32 v37, 0xffff0000, v16
    v_lshlrev_b32_e64 v38, 16, v17
    v_and_b32 v39, 0xffff0000, v17
    v_lshlrev_b32_e64 v40, 16, v18
    v_and_b32 v41, 0xffff0000, v18
    v_lshlrev_b32_e64 v42, 16, v19
    v_and_b32 v43, 0xffff0000, v19
L_MSW:
    ds_read_b32 v11, v4 offset:528
    ds_read_b64 v[12:13], v10 offset:9216
    s_waitcnt lgkmcnt(0)
    v_cmp_eq_u32 vcc, 0, v11
    s_cbranch_vccnz L_MSW
    v_lshlrev_b32 v44, 16, v13
    v_and_b32 v45, 0xffff0000, v13
    v_rcp_f32 v44, v44
    v_rcp_f32 v45, v45
    v_lshlrev_b32_e64 v46, 16, v12
    v_and_b32 v47, 0xffff0000, v12
    v_pk_mul_f32 v[46:47], v[46:47], v[44:45]
    v_pk_fma_f32 v[36:37], v[36:37], v[44:45], v[46:47] op_sel:[0,0,0] op_sel_hi:[1,0,0] neg_lo:[0,0,1] neg_hi:[0,0,1]
    v_pk_fma_f32 v[40:41], v[40:41], v[44:45], v[46:47] op_sel:[0,1,1] op_sel_hi:[1,1,1] neg_lo:[0,0,1] neg_hi:[0,0,1]
    v_pk_fma_f32 v[38:39], v[38:39], v[44:45], v[46:47] op_sel:[0,0,0] op_sel_hi:[1,0,0] neg_lo:[0,0,1] neg_hi:[0,0,1]
    v_pk_fma_f32 v[42:43], v[42:43], v[44:45], v[46:47] op_sel:[0,1,1] op_sel_hi:[1,1,1] neg_lo:[0,0,1] neg_hi:[0,0,1]
    v_cvt_pk_bf16_f32 v36, v40, v36
    v_cvt_pk_bf16_f32 v37, v41, v37
    v_cvt_pk_bf16_f32 v38, v42, v38
    v_cvt_pk_bf16_f32 v39, v43, v39
    ds_write2st64_b32 v32, v36, v37 offset0:12 offset1:30
    ds_write2st64_b32 v32, v38, v39 offset0:48 offset1:66
    s_mov_b64 exec, 1
    ds_write_b32 v4, v11 offset:0
    s_mov_b64 exec, -1
L_XRW:
    ds_read_b32 v15, v6 offset:0
    ds_read_b128 v[180:183], v7 offset:4032
    ds_read_b128 v[184:187], v7 offset:3584
    ds_read_b128 v[188:191], v7 offset:3600
    ds_read_b128 v[192:195], v7 offset:3968
    ds_read_b128 v[196:199], v7 offset:3072
    s_waitcnt lgkmcnt(5)
    v_cmp_eq_u32 vcc, 0, v15
    s_cbranch_vccnz L_XRW
    v_cmp_ne_u32_e64 vcc, 2, v15
    s_cmp_eq_u32 vcc_lo, 0
    s_cselect_b32 s14, 2, 1
    s_waitcnt lgkmcnt(4)
    v_mfma_f32_16x16x32_bf16 v[204:207], v[76:79], v[180:183], 0
    ds_read_b128 v[200:203], v7 offset:3088
    v_mfma_f32_16x16x32_bf16 v[208:211], v[108:111], v[180:183], 0
    ds_read_b64 v[12:13], v10 offset:11264
    s_waitcnt vmcnt(2)
    v_mfma_f32_16x16x32_bf16 v[212:215], v[140:143], v[180:183], 0
    v_lshlrev_b32 v36, 16, v20
    v_and_b32 v37, 0xffff0000, v20
    v_mfma_f32_16x16x32_bf16 v[216:219], v[172:175], v[180:183], 0
    v_lshlrev_b32_e64 v38, 16, v21
    v_and_b32 v39, 0xffff0000, v21
    s_waitcnt lgkmcnt(5)
    v_mfma_f32_16x16x32_bf16 v[220:223], v[184:187], v[244:247], 0
    ds_read_b128 v[180:183], v7 offset:3904
    v_lshlrev_b32_e64 v40, 16, v22
    s_waitcnt lgkmcnt(5)
    v_mfma_f32_16x16x32_bf16 v[224:227], v[188:191], v[248:251], 0
    ds_read_b128 v[184:187], v7 offset:3840
    v_and_b32 v41, 0xffff0000, v22
    s_waitcnt lgkmcnt(5)
    v_mfma_f32_16x16x32_bf16 v[204:207], v[72:75], v[192:195], v[204:207]
    ds_read_b128 v[188:191], v7 offset:3776
    v_mfma_f32_16x16x32_bf16 v[208:211], v[104:107], v[192:195], v[208:211]
    v_lshlrev_b32 v42, 16, v23
    v_and_b32 v43, 0xffff0000, v23
    v_mfma_f32_16x16x32_bf16 v[212:215], v[136:139], v[192:195], v[212:215]
    s_waitcnt lgkmcnt(3)
    v_lshlrev_b32 v44, 16, v13
    v_and_b32 v45, 0xffff0000, v13
    v_mfma_f32_16x16x32_bf16 v[216:219], v[168:171], v[192:195], v[216:219]
    v_rcp_f32 v44, v44
    v_rcp_f32 v45, v45
    v_mfma_f32_16x16x32_bf16 v[228:231], v[196:199], v[244:247], 0
    ds_read_b128 v[192:195], v7 offset:3712
    v_lshlrev_b32_e64 v46, 16, v12
    v_mfma_f32_16x16x32_bf16 v[232:235], v[200:203], v[248:251], 0
    ds_read_b128 v[196:199], v7 offset:3648
    v_and_b32 v47, 0xffff0000, v12
    s_waitcnt lgkmcnt(4)
    v_mfma_f32_16x16x32_bf16 v[204:207], v[68:71], v[180:183], v[204:207]
    ds_read_b128 v[200:203], v7 offset:3584
    v_mfma_f32_16x16x32_bf16 v[208:211], v[100:103], v[180:183], v[208:211]
    v_mul_f32 v46, v46, v44
    v_mul_f32_e64 v47, v47, v45
    v_mfma_f32_16x16x32_bf16 v[212:215], v[132:135], v[180:183], v[212:215]
    v_fma_f32 v36, v36, v44, -v46
    v_fma_f32 v40, v40, v45, -v47
    v_mfma_f32_16x16x32_bf16 v[216:219], v[164:167], v[180:183], v[216:219]
    v_fma_f32 v37, v37, v44, -v46
    v_fma_f32 v41, v41, v45, -v47
    s_waitcnt lgkmcnt(4)
    s_nop 0
    v_mfma_f32_16x16x32_bf16 v[204:207], v[64:67], v[184:187], v[204:207]
    ds_read_b128 v[180:183], v7 offset:3520
    v_mfma_f32_16x16x32_bf16 v[208:211], v[96:99], v[184:187], v[208:211]
    v_fma_f32 v38, v38, v44, -v46
    v_fma_f32 v42, v42, v45, -v47
    v_mfma_f32_16x16x32_bf16 v[212:215], v[128:131], v[184:187], v[212:215]
    v_fma_f32 v39, v39, v44, -v46
    v_fma_f32 v43, v43, v45, -v47
    v_mfma_f32_16x16x32_bf16 v[216:219], v[160:163], v[184:187], v[216:219]
    v_cvt_pk_bf16_f32 v36, v40, v36
    v_cvt_pk_bf16_f32 v37, v41, v37
    s_waitcnt lgkmcnt(4)
    s_nop 0
    v_mfma_f32_16x16x32_bf16 v[204:207], v[60:63], v[188:191], v[204:207]
    ds_read_b128 v[184:187], v7 offset:3456
    v_mfma_f32_16x16x32_bf16 v[208:211], v[92:95], v[188:191], v[208:211]
    v_cvt_pk_bf16_f32 v38, v42, v38
    v_cvt_pk_bf16_f32 v39, v43, v39
    v_mfma_f32_16x16x32_bf16 v[212:215], v[124:127], v[188:191], v[212:215]
    ds_write2st64_b32 v32, v36, v37 offset0:8 offset1:26
    ds_write2st64_b32 v32, v38, v39 offset0:44 offset1:62
    v_mfma_f32_16x16x32_bf16 v[216:219], v[156:159], v[188:191], v[216:219]
    s_mov_b64 exec, 1
    ds_write_b32 v4, v5 offset:160
    s_mov_b64 exec, -1
    s_waitcnt lgkmcnt(7)
    s_nop 0
    v_mfma_f32_16x16x32_bf16 v[204:207], v[56:59], v[192:195], v[204:207]
    ds_read_b128 v[188:191], v7 offset:3392
    v_mfma_f32_16x16x32_bf16 v[208:211], v[88:91], v[192:195], v[208:211]
    v_cvt_pk_bf16_f32 v236, v223, v222
    v_cvt_pk_bf16_f32 v237, v221, v220
    v_mfma_f32_16x16x32_bf16 v[212:215], v[120:123], v[192:195], v[212:215]
    v_cvt_pk_bf16_f32 v238, v227, v226
    v_cvt_pk_bf16_f32 v239, v225, v224
    v_mfma_f32_16x16x32_bf16 v[216:219], v[152:155], v[192:195], v[216:219]
    v_cvt_pk_bf16_f32 v240, v231, v230
    v_cvt_pk_bf16_f32 v241, v229, v228
    s_waitcnt lgkmcnt(7)
    s_nop 0
    v_mfma_f32_16x16x32_bf16 v[204:207], v[52:55], v[196:199], v[204:207]
    ds_read_b128 v[192:195], v7 offset:3328
    v_mfma_f32_16x16x32_bf16 v[208:211], v[84:87], v[196:199], v[208:211]
    v_cvt_pk_bf16_f32 v242, v235, v234
    v_cvt_pk_bf16_f32 v243, v233, v232
    v_mfma_f32_16x16x32_bf16 v[212:215], v[116:119], v[196:199], v[212:215]
    v_mfma_f32_16x16x32_bf16 v[216:219], v[148:151], v[196:199], v[216:219]
    s_waitcnt lgkmcnt(7)
    v_mfma_f32_16x16x32_bf16 v[204:207], v[48:51], v[200:203], v[204:207]
    ds_read_b128 v[196:199], v7 offset:3264
    v_mfma_f32_16x16x32_bf16 v[208:211], v[80:83], v[200:203], v[208:211]
    ds_read_b64 v[12:13], v10 offset:13312
    s_waitcnt vmcnt(0)
    v_mfma_f32_16x16x32_bf16 v[212:215], v[112:115], v[200:203], v[212:215]
    v_lshlrev_b32_e64 v36, 16, v24
    v_and_b32 v37, 0xffff0000, v24
    v_mfma_f32_16x16x32_bf16 v[216:219], v[144:147], v[200:203], v[216:219]
    v_lshlrev_b32_e64 v38, 16, v25
    v_and_b32 v39, 0xffff0000, v25
    v_mfma_f32_16x16x32_bf16 v[220:223], v[176:179], v[200:203], 0
    v_lshlrev_b32_e64 v40, 16, v26
    v_and_b32 v41, 0xffff0000, v26
    s_waitcnt lgkmcnt(8)
    v_mfma_f32_16x16x32_bf16 v[208:211], v[76:79], v[180:183], v[208:211]
    ds_read_b128 v[200:203], v7 offset:3200
    v_mfma_f32_16x16x32_bf16 v[212:215], v[108:111], v[180:183], v[212:215]
    ds_read_b32 v11, v6 offset:160
    v_lshlrev_b32 v42, 16, v27
    v_mfma_f32_16x16x32_bf16 v[216:219], v[140:143], v[180:183], v[216:219]
    v_and_b32 v43, 0xffff0000, v27
    s_waitcnt lgkmcnt(2)
    v_lshlrev_b32 v44, 16, v13
    v_mfma_f32_16x16x32_bf16 v[220:223], v[172:175], v[180:183], v[220:223]
    v_and_b32 v45, 0xffff0000, v13
    v_rcp_f32_e64 v44, v44
    v_mfma_f32_16x16x32_bf16 v[208:211], v[72:75], v[184:187], v[208:211]
    ds_read_b128 v[180:183], v7 offset:3136
    v_mfma_f32_16x16x32_bf16 v[212:215], v[104:107], v[184:187], v[212:215]
    v_rcp_f32 v45, v45
    v_lshlrev_b32 v46, 16, v12
    v_mfma_f32_16x16x32_bf16 v[216:219], v[136:139], v[184:187], v[216:219]
    v_and_b32 v47, 0xffff0000, v12
    v_mul_f32_e64 v46, v46, v44
    v_mfma_f32_16x16x32_bf16 v[220:223], v[168:171], v[184:187], v[220:223]
    v_mul_f32_e64 v47, v47, v45
    v_fma_f32 v36, v36, v44, -v46
    v_mfma_f32_16x16x32_bf16 v[208:211], v[68:71], v[188:191], v[208:211]
    ds_read_b128 v[184:187], v7 offset:3072
    v_mfma_f32_16x16x32_bf16 v[212:215], v[100:103], v[188:191], v[212:215]
    s_waitcnt lgkmcnt(2)
    v_cmp_eq_u32_e64 vcc, 0, v11
    s_cbranch_vccnz L_SLOW3
L_BACK3:
    v_mfma_f32_16x16x32_bf16 v[216:219], v[132:135], v[188:191], v[216:219]
    v_fma_f32 v40, v40, v45, -v47
    v_fma_f32 v37, v37, v44, -v46
    v_mfma_f32_16x16x32_bf16 v[220:223], v[164:167], v[188:191], v[220:223]
    v_fma_f32 v41, v41, v45, -v47
    v_fma_f32 v38, v38, v44, -v46
    v_mfma_f32_16x16x32_bf16 v[208:211], v[64:67], v[192:195], v[208:211]
    ds_read_b128 v[188:191], v7 offset:3008
    v_mfma_f32_16x16x32_bf16 v[212:215], v[96:99], v[192:195], v[212:215]
    v_fma_f32 v42, v42, v45, -v47
    v_fma_f32 v39, v39, v44, -v46
    v_mfma_f32_16x16x32_bf16 v[216:219], v[128:131], v[192:195], v[216:219]
    v_fma_f32 v43, v43, v45, -v47
    v_mfma_f32_16x16x32_bf16 v[220:223], v[160:163], v[192:195], v[220:223]
    v_cvt_pk_bf16_f32 v36, v40, v36
    v_mfma_f32_16x16x32_bf16 v[208:211], v[60:63], v[196:199], v[208:211]
    ds_read_b128 v[192:195], v7 offset:2560
    v_mfma_f32_16x16x32_bf16 v[212:215], v[92:95], v[196:199], v[212:215]
    v_cvt_pk_bf16_f32 v37, v41, v37
    v_mfma_f32_16x16x32_bf16 v[216:219], v[124:127], v[196:199], v[216:219]
    v_cvt_pk_bf16_f32 v38, v42, v38
    v_mfma_f32_16x16x32_bf16 v[220:223], v[156:159], v[196:199], v[220:223]
    v_cvt_pk_bf16_f32 v39, v43, v39
    v_mfma_f32_16x16x32_bf16 v[208:211], v[56:59], v[200:203], v[208:211]
    ds_read_b128 v[196:199], v7 offset:2576
    v_mfma_f32_16x16x32_bf16 v[212:215], v[88:91], v[200:203], v[212:215]
    ds_write2st64_b32 v32, v36, v37 offset0:4 offset1:22
    v_mfma_f32_16x16x32_bf16 v[216:219], v[120:123], v[200:203], v[216:219]
    ds_write2st64_b32 v32, v38, v39 offset0:40 offset1:58
    v_mfma_f32_16x16x32_bf16 v[220:223], v[152:155], v[200:203], v[220:223]
    s_waitcnt lgkmcnt(6)
    s_nop 0
    v_mfma_f32_16x16x32_bf16 v[208:211], v[52:55], v[180:183], v[208:211]
    ds_read_b128 v[200:203], v7 offset:2944
    v_mfma_f32_16x16x32_bf16 v[212:215], v[84:87], v[180:183], v[212:215]
    v_mfma_f32_16x16x32_bf16 v[216:219], v[116:119], v[180:183], v[216:219]
    v_mfma_f32_16x16x32_bf16 v[220:223], v[148:151], v[180:183], v[220:223]
    s_waitcnt lgkmcnt(6)
    s_nop 0
    v_mfma_f32_16x16x32_bf16 v[208:211], v[48:51], v[184:187], v[208:211]
    ds_read_b128 v[180:183], v7 offset:2880
    v_mfma_f32_16x16x32_bf16 v[212:215], v[80:83], v[184:187], v[212:215]
    v_mfma_f32_16x16x32_bf16 v[216:219], v[112:115], v[184:187], v[216:219]
    v_mfma_f32_16x16x32_bf16 v[220:223], v[144:147], v[184:187], v[220:223]
    v_mfma_f32_16x16x32_bf16 v[224:227], v[176:179], v[184:187], 0
    s_waitcnt lgkmcnt(6)
    s_nop 0
    v_mfma_f32_16x16x32_bf16 v[212:215], v[76:79], v[188:191], v[212:215]
    ds_read_b128 v[184:187], v7 offset:2816
    v_mfma_f32_16x16x32_bf16 v[216:219], v[108:111], v[188:191], v[216:219]
    ds_write_b128 v8, v[204:207] offset:0
    v_mfma_f32_16x16x32_bf16 v[220:223], v[140:143], v[188:191], v[220:223]
    ds_write_b128 v8, v[208:211] offset:1024
    v_mfma_f32_16x16x32_bf16 v[224:227], v[172:175], v[188:191], v[224:227]
    s_mov_b64 exec, 1
    ds_write_b32 v4, v5 offset:144
    s_mov_b64 exec, -1
    s_waitcnt lgkmcnt(9)
    v_mfma_f32_16x16x32_bf16 v[228:231], v[192:195], v[244:247], 0
    ds_read_b128 v[188:191], v7 offset:2048
    s_waitcnt lgkmcnt(9)
    v_mfma_f32_16x16x32_bf16 v[232:235], v[196:199], v[248:251], 0
    ds_read_b128 v[192:195], v7 offset:2064
    ds_read_b32 v11, v6 offset:144
    s_waitcnt lgkmcnt(8)
    v_mfma_f32_16x16x32_bf16 v[212:215], v[72:75], v[200:203], v[212:215]
    ds_read_b128 v[196:199], v7 offset:2752
    v_mfma_f32_16x16x32_bf16 v[216:219], v[104:107], v[200:203], v[216:219]
    s_waitcnt lgkmcnt(1)
    v_cmp_eq_u32 vcc, 0, v11
    s_cbranch_vccnz L_SLOW0
L_BACK0:
    v_mfma_f32_16x16x32_bf16 v[220:223], v[136:139], v[200:203], v[220:223]
    ds_read_b64 v[204:205], v9 offset:0
    v_mfma_f32_16x16x32_bf16 v[224:227], v[168:171], v[200:203], v[224:227]
    ds_read_b64 v[206:207], v9 offset:8192
    v_mfma_f32_16x16x32_bf16 v[212:215], v[68:71], v[180:183], v[212:215]
    ds_read_b128 v[200:203], v7 offset:2688
    v_mfma_f32_16x16x32_bf16 v[216:219], v[100:103], v[180:183], v[216:219]
    v_cvt_pk_bf16_f32 v252, v231, v230
    v_mfma_f32_16x16x32_bf16 v[220:223], v[132:135], v[180:183], v[220:223]
    v_cvt_pk_bf16_f32 v253, v229, v228
    v_mfma_f32_16x16x32_bf16 v[224:227], v[164:167], v[180:183], v[224:227]
    v_cvt_pk_bf16_f32 v254, v235, v234
    v_mfma_f32_16x16x32_bf16 v[212:215], v[64:67], v[184:187], v[212:215]
    ds_read_b128 v[180:183], v7 offset:2624
    v_mfma_f32_16x16x32_bf16 v[216:219], v[96:99], v[184:187], v[216:219]
    v_cvt_pk_bf16_f32 v255, v233, v232
    ds_read_b64 v[208:209], v9 offset:16384
    v_mfma_f32_16x16x32_bf16 v[220:223], v[128:131], v[184:187], v[220:223]
    ds_read_b64 v[210:211], v9 offset:24576
    s_waitcnt lgkmcnt(0)
    v_lshlrev_b32 v36, 16, v16
    v_mfma_f32_16x16x32_bf16 v[224:227], v[160:163], v[184:187], v[224:227]
    v_and_b32 v37, 0xffff0000, v16
    v_lshlrev_b32_e64 v38, 16, v17
    v_mfma_f32_16x16x32_bf16 v[228:231], v[188:191], v[244:247], 0
    ds_read_b128 v[184:187], v7 offset:2560
    v_and_b32 v39, 0xffff0000, v17
    v_mfma_f32_16x16x32_bf16 v[232:235], v[192:195], v[248:251], 0
    ds_read_b128 v[188:191], v7 offset:2496
    v_lshlrev_b32_e64 v40, 16, v18
    v_mfma_f32_16x16x32_bf16 v[212:215], v[60:63], v[196:199], v[212:215]
    ds_read_b128 v[192:195], v7 offset:2432
    v_mfma_f32_16x16x32_bf16 v[216:219], v[92:95], v[196:199], v[216:219]
    v_and_b32 v41, 0xffff0000, v18
    v_lshlrev_b32_e64 v42, 16, v19
    v_mfma_f32_16x16x32_bf16 v[220:223], v[124:127], v[196:199], v[220:223]
    v_and_b32 v43, 0xffff0000, v19
    v_add_f32_e64 v36, v204, v36
    v_mfma_f32_16x16x32_bf16 v[224:227], v[156:159], v[196:199], v[224:227]
    v_add_f32 v37, v206, v37
    v_add_f32 v38, v208, v38
    v_mfma_f32_16x16x32_bf16 v[212:215], v[56:59], v[200:203], v[212:215]
    ds_read_b128 v[196:199], v7 offset:2368
    v_mfma_f32_16x16x32_bf16 v[216:219], v[88:91], v[200:203], v[216:219]
    v_cvt_pk_bf16_f32 v248, v231, v230
    v_cvt_pk_bf16_f32 v249, v229, v228
    v_mfma_f32_16x16x32_bf16 v[220:223], v[120:123], v[200:203], v[220:223]
    v_cvt_pk_bf16_f32 v250, v235, v234
    v_cvt_pk_bf16_f32 v251, v233, v232
    v_mfma_f32_16x16x32_bf16 v[224:227], v[152:155], v[200:203], v[224:227]
    v_add_f32 v39, v210, v39
    v_add_f32 v40, v205, v40
    v_mfma_f32_16x16x32_bf16 v[212:215], v[52:55], v[180:183], v[212:215]
    ds_read_b128 v[200:203], v7 offset:2304
    v_mfma_f32_16x16x32_bf16 v[216:219], v[84:87], v[180:183], v[216:219]
    v_add_f32 v41, v207, v41
    v_add_f32 v42, v209, v42
    v_mfma_f32_16x16x32_bf16 v[220:223], v[116:119], v[180:183], v[220:223]
    v_add_f32_e64 v43, v211, v43
    v_cvt_pk_bf16_f32 v204, v36, v37
    v_mfma_f32_16x16x32_bf16 v[224:227], v[148:151], v[180:183], v[224:227]
    v_cvt_pk_bf16_f32 v205, v38, v39
    v_cvt_pk_bf16_f32 v206, v40, v41
    s_waitcnt lgkmcnt(4)
    s_nop 0
    v_mfma_f32_16x16x32_bf16 v[212:215], v[48:51], v[184:187], v[212:215]
    ds_read_b64 v[180:181], v2 offset:9496
    ds_read_b64 v[182:183], v2 offset:10136
    v_mfma_f32_16x16x32_bf16 v[216:219], v[80:83], v[184:187], v[216:219]
    v_cvt_pk_bf16_f32 v207, v42, v43
    s_cmp_lg_u32 s14, 2
    s_cbranch_scc1 L_ES0
    buffer_store_dwordx4 v[204:207], v33, s[44:47], s13 offen
L_EB0:
    s_add_u32 s13, s13, 0x1000
    v_mfma_f32_16x16x32_bf16 v[220:223], v[112:115], v[184:187], v[220:223]
    ds_read_b64 v[12:13], v10 offset:15360
    v_lshlrev_b32_e64 v36, 16, v28
    v_mfma_f32_16x16x32_bf16 v[224:227], v[144:147], v[184:187], v[224:227]
    v_and_b32 v37, 0xffff0000, v28
    v_lshlrev_b32_e64 v38, 16, v29
    v_mfma_f32_16x16x32_bf16 v[228:231], v[176:179], v[184:187], 0
    v_and_b32 v39, 0xffff0000, v29
    v_lshlrev_b32 v40, 16, v30
    s_waitcnt lgkmcnt(6)
    v_mfma_f32_16x16x32_bf16 v[216:219], v[76:79], v[188:191], v[216:219]
    ds_read_b128 v[184:187], v7 offset:2240
    v_mfma_f32_16x16x32_bf16 v[220:223], v[108:111], v[188:191], v[220:223]
    v_and_b32 v41, 0xffff0000, v30
    v_lshlrev_b32_e64 v42, 16, v31
    v_mfma_f32_16x16x32_bf16 v[224:227], v[140:143], v[188:191], v[224:227]
    v_and_b32 v43, 0xffff0000, v31
    s_waitcnt lgkmcnt(1)
    v_lshlrev_b32 v44, 16, v13
    v_mfma_f32_16x16x32_bf16 v[228:231], v[172:175], v[188:191], v[228:231]
    v_and_b32 v45, 0xffff0000, v13
    v_rcp_f32_e64 v44, v44
    v_mfma_f32_16x16x32_bf16 v[216:219], v[72:75], v[192:195], v[216:219]
    ds_read_b128 v[188:191], v7 offset:2176
    v_mfma_f32_16x16x32_bf16 v[220:223], v[104:107], v[192:195], v[220:223]
    v_rcp_f32 v45, v45
    v_lshlrev_b32 v46, 16, v12
    v_mfma_f32_16x16x32_bf16 v[224:227], v[136:139], v[192:195], v[224:227]
    v_and_b32 v47, 0xffff0000, v12
    v_mul_f32_e64 v46, v46, v44
    v_mfma_f32_16x16x32_bf16 v[228:231], v[168:171], v[192:195], v[228:231]
    v_mul_f32_e64 v47, v47, v45
    v_fma_f32 v36, v36, v44, -v46
    v_mfma_f32_16x16x32_bf16 v[216:219], v[68:71], v[196:199], v[216:219]
    ds_read_b128 v[192:195], v7 offset:2112
    v_mfma_f32_16x16x32_bf16 v[220:223], v[100:103], v[196:199], v[220:223]
    v_fma_f32 v40, v40, v45, -v47
    v_fma_f32 v37, v37, v44, -v46
    v_mfma_f32_16x16x32_bf16 v[224:227], v[132:135], v[196:199], v[224:227]
    v_fma_f32 v41, v41, v45, -v47
    v_fma_f32 v38, v38, v44, -v46
    v_mfma_f32_16x16x32_bf16 v[228:231], v[164:167], v[196:199], v[228:231]
    v_fma_f32 v42, v42, v45, -v47
    v_fma_f32 v39, v39, v44, -v46
    v_mfma_f32_16x16x32_bf16 v[216:219], v[64:67], v[200:203], v[216:219]
    ds_read_b128 v[196:199], v7 offset:2048
    v_mfma_f32_16x16x32_bf16 v[220:223], v[96:99], v[200:203], v[220:223]
    v_fma_f32 v43, v43, v45, -v47
    v_mfma_f32_16x16x32_bf16 v[224:227], v[128:131], v[200:203], v[224:227]
    v_cvt_pk_bf16_f32 v36, v40, v36
    v_mfma_f32_16x16x32_bf16 v[228:231], v[160:163], v[200:203], v[228:231]
    v_cvt_pk_bf16_f32 v37, v41, v37
    v_mfma_f32_16x16x32_bf16 v[220:223], v[236:239], v[180:183], v[220:223]
    ds_read_b128 v[200:203], v7 offset:1984
    v_mfma_f32_16x16x32_bf16 v[224:227], v[240:243], v[180:183], v[224:227]
    v_cvt_pk_bf16_f32 v38, v42, v38
    s_waitcnt lgkmcnt(4)
    s_nop 0
    v_mfma_f32_16x16x32_bf16 v[216:219], v[60:63], v[184:187], v[216:219]
    ds_read_b128 v[180:183], v7 offset:1920
    v_mfma_f32_16x16x32_bf16 v[220:223], v[92:95], v[184:187], v[220:223]
    v_cvt_pk_bf16_f32 v39, v43, v39
    v_mfma_f32_16x16x32_bf16 v[224:227], v[124:127], v[184:187], v[224:227]
    ds_write2st64_b32 v32, v36, v37 offset0:0 offset1:18
    v_mfma_f32_16x16x32_bf16 v[228:231], v[156:159], v[184:187], v[228:231]
    ds_write2st64_b32 v32, v38, v39 offset0:36 offset1:54
    s_waitcnt lgkmcnt(6)
    s_nop 0
    v_mfma_f32_16x16x32_bf16 v[216:219], v[56:59], v[188:191], v[216:219]
    ds_read_b128 v[184:187], v7 offset:1856
    v_mfma_f32_16x16x32_bf16 v[220:223], v[88:91], v[188:191], v[220:223]
    v_mfma_f32_16x16x32_bf16 v[224:227], v[120:123], v[188:191], v[224:227]
    v_mfma_f32_16x16x32_bf16 v[228:231], v[152:155], v[188:191], v[228:231]
    s_waitcnt lgkmcnt(6)
    s_nop 0
    v_mfma_f32_16x16x32_bf16 v[216:219], v[52:55], v[192:195], v[216:219]
    ds_read_b128 v[188:191], v7 offset:1792
    v_mfma_f32_16x16x32_bf16 v[220:223], v[84:87], v[192:195], v[220:223]
    v_mfma_f32_16x16x32_bf16 v[224:227], v[116:119], v[192:195], v[224:227]
    v_mfma_f32_16x16x32_bf16 v[228:231], v[148:151], v[192:195], v[228:231]
    s_waitcnt lgkmcnt(6)
    s_nop 0
    v_mfma_f32_16x16x32_bf16 v[216:219], v[48:51], v[196:199], v[216:219]
    ds_read_b64 v[192:193], v2 offset:9528
    ds_read_b64 v[194:195], v2 offset:10168
    v_mfma_f32_16x16x32_bf16 v[220:223], v[80:83], v[196:199], v[220:223]
    v_mfma_f32_16x16x32_bf16 v[224:227], v[112:115], v[196:199], v[224:227]
    v_mfma_f32_16x16x32_bf16 v[228:231], v[144:147], v[196:199], v[228:231]
    v_mfma_f32_16x16x32_bf16 v[232:235], v[176:179], v[196:199], 0
    s_waitcnt lgkmcnt(7)
    s_nop 0
    v_mfma_f32_16x16x32_bf16 v[220:223], v[76:79], v[200:203], v[220:223]
    ds_read_b128 v[196:199], v7 offset:1728
    v_mfma_f32_16x16x32_bf16 v[224:227], v[108:111], v[200:203], v[224:227]
    ds_write_b128 v8, v[212:215] offset:2048
    v_mfma_f32_16x16x32_bf16 v[228:231], v[140:143], v[200:203], v[228:231]
    ds_write_b128 v8, v[216:219] offset:3072
    v_mfma_f32_16x16x32_bf16 v[232:235], v[172:175], v[200:203], v[232:235]
    s_mov_b64 exec, 1
    ds_write_b32 v4, v5 offset:16
    s_mov_b64 exec, -1
    s_waitcnt lgkmcnt(10)
    s_nop 0
    v_mfma_f32_16x16x32_bf16 v[220:223], v[72:75], v[180:183], v[220:223]
    ds_read_b128 v[200:203], v7 offset:1664
    v_mfma_f32_16x16x32_bf16 v[224:227], v[104:107], v[180:183], v[224:227]
    v_mfma_f32_16x16x32_bf16 v[228:231], v[136:139], v[180:183], v[228:231]
    v_mfma_f32_16x16x32_bf16 v[232:235], v[168:171], v[180:183], v[232:235]
    s_waitcnt lgkmcnt(8)
    s_nop 0
    v_mfma_f32_16x16x32_bf16 v[220:223], v[68:71], v[184:187], v[220:223]
    ds_read_b128 v[180:183], v7 offset:1600
    v_mfma_f32_16x16x32_bf16 v[224:227], v[100:103], v[184:187], v[224:227]
    ds_read_b32 v11, v6 offset:16
    v_mfma_f32_16x16x32_bf16 v[228:231], v[132:135], v[184:187], v[228:231]
    v_mfma_f32_16x16x32_bf16 v[232:235], v[164:167], v[184:187], v[232:235]
    s_waitcnt lgkmcnt(9)
    v_mfma_f32_16x16x32_bf16 v[220:223], v[64:67], v[188:191], v[220:223]
    ds_read_b128 v[184:187], v7 offset:1536
    v_mfma_f32_16x16x32_bf16 v[224:227], v[96:99], v[188:191], v[224:227]
    s_waitcnt lgkmcnt(1)
    v_cmp_eq_u32 vcc, 0, v11
    s_cbranch_vccnz L_SLOW1
L_BACK1:
    v_mfma_f32_16x16x32_bf16 v[228:231], v[128:131], v[188:191], v[228:231]
    ds_read_b64 v[212:213], v9 offset:2048
    v_mfma_f32_16x16x32_bf16 v[232:235], v[160:163], v[188:191], v[232:235]
    ds_read_b64 v[214:215], v9 offset:10240
    v_mfma_f32_16x16x32_bf16 v[224:227], v[236:239], v[192:195], v[224:227]
    ds_read_b128 v[188:191], v7 offset:1472
    ds_read_b64 v[216:217], v9 offset:18432
    v_mfma_f32_16x16x32_bf16 v[220:223], v[60:63], v[196:199], v[220:223]
    ds_read_b128 v[192:195], v7 offset:1408
    v_mfma_f32_16x16x32_bf16 v[224:227], v[92:95], v[196:199], v[224:227]
    ds_read_b64 v[218:219], v9 offset:26624
    s_waitcnt lgkmcnt(0)
    v_lshlrev_b32 v36, 16, v20
    v_mfma_f32_16x16x32_bf16 v[228:231], v[124:127], v[196:199], v[228:231]
    v_and_b32 v37, 0xffff0000, v20
    v_lshlrev_b32_e64 v38, 16, v21
    v_mfma_f32_16x16x32_bf16 v[232:235], v[156:159], v[196:199], v[232:235]
    v_and_b32 v39, 0xffff0000, v21
    v_lshlrev_b32_e64 v40, 16, v22
    v_mfma_f32_16x16x32_bf16 v[220:223], v[56:59], v[200:203], v[220:223]
    ds_read_b128 v[196:199], v7 offset:1344
    v_mfma_f32_16x16x32_bf16 v[224:227], v[88:91], v[200:203], v[224:227]
    v_and_b32 v41, 0xffff0000, v22
    v_lshlrev_b32_e64 v42, 16, v23
    v_mfma_f32_16x16x32_bf16 v[228:231], v[120:123], v[200:203], v[228:231]
    v_and_b32 v43, 0xffff0000, v23
    v_add_f32_e64 v36, v212, v36
    v_mfma_f32_16x16x32_bf16 v[232:235], v[152:155], v[200:203], v[232:235]
    v_add_f32 v37, v214, v37
    v_add_f32 v38, v216, v38
    v_mfma_f32_16x16x32_bf16 v[220:223], v[52:55], v[180:183], v[220:223]
    ds_read_b128 v[200:203], v7 offset:1280
    v_mfma_f32_16x16x32_bf16 v[224:227], v[84:87], v[180:183], v[224:227]
    v_add_f32 v39, v218, v39
    v_add_f32 v40, v213, v40
    v_mfma_f32_16x16x32_bf16 v[228:231], v[116:119], v[180:183], v[228:231]
    v_add_f32_e64 v41, v215, v41
    v_mfma_f32_16x16x32_bf16 v[232:235], v[148:151], v[180:183], v[232:235]
    v_add_f32_e64 v42, v217, v42
    v_mfma_f32_16x16x32_bf16 v[220:223], v[48:51], v[184:187], v[220:223]
    ds_read_b128 v[180:183], v7 offset:1216
    v_mfma_f32_16x16x32_bf16 v[224:227], v[80:83], v[184:187], v[224:227]
    v_add_f32_e64 v43, v219, v43
    v_mfma_f32_16x16x32_bf16 v[228:231], v[112:115], v[184:187], v[228:231]
    v_cvt_pk_bf16_f32 v212, v36, v37
    v_mfma_f32_16x16x32_bf16 v[232:235], v[144:147], v[184:187], v[232:235]
    v_cvt_pk_bf16_f32 v213, v38, v39
    v_mfma_f32_16x16x32_bf16 v[224:227], v[76:79], v[188:191], v[224:227]
    ds_read_b128 v[184:187], v7 offset:1152
    v_mfma_f32_16x16x32_bf16 v[228:231], v[108:111], v[188:191], v[228:231]
    v_cvt_pk_bf16_f32 v214, v40, v41
    v_mfma_f32_16x16x32_bf16 v[232:235], v[140:143], v[188:191], v[232:235]
    v_cvt_pk_bf16_f32 v215, v42, v43
    v_mfma_f32_16x16x32_bf16 v[224:227], v[72:75], v[192:195], v[224:227]
    ds_read_b128 v[188:191], v7 offset:1088
    v_mfma_f32_16x16x32_bf16 v[228:231], v[104:107], v[192:195], v[228:231]
    s_cmp_lg_u32 s14, 2
    s_cbranch_scc1 L_ES1
    buffer_store_dwordx4 v[212:215], v33, s[44:47], s13 offen
L_EB1:
    s_add_u32 s13, s13, 0x1000
    v_mfma_f32_16x16x32_bf16 v[232:235], v[136:139], v[192:195], v[232:235]
    s_waitcnt lgkmcnt(4)
    v_mfma_f32_16x16x32_bf16 v[224:227], v[68:71], v[196:199], v[224:227]
    ds_read_b128 v[192:195], v7 offset:1024
    v_mfma_f32_16x16x32_bf16 v[228:231], v[100:103], v[196:199], v[228:231]
    v_mfma_f32_16x16x32_bf16 v[232:235], v[132:135], v[196:199], v[232:235]
    s_waitcnt lgkmcnt(4)
    v_mfma_f32_16x16x32_bf16 v[224:227], v[64:67], v[200:203], v[224:227]
    ds_read_b128 v[196:199], v7 offset:960
    v_mfma_f32_16x16x32_bf16 v[228:231], v[96:99], v[200:203], v[228:231]
    v_mfma_f32_16x16x32_bf16 v[232:235], v[128:131], v[200:203], v[232:235]
    s_waitcnt lgkmcnt(4)
    v_mfma_f32_16x16x32_bf16 v[224:227], v[60:63], v[180:183], v[224:227]
    ds_read_b128 v[200:203], v7 offset:896
    v_mfma_f32_16x16x32_bf16 v[228:231], v[92:95], v[180:183], v[228:231]
    v_mfma_f32_16x16x32_bf16 v[232:235], v[124:127], v[180:183], v[232:235]
    s_waitcnt lgkmcnt(4)
    v_mfma_f32_16x16x32_bf16 v[224:227], v[56:59], v[184:187], v[224:227]
    ds_read_b64 v[180:181], v2 offset:9496
    ds_read_b64 v[182:183], v2 offset:10136
    v_mfma_f32_16x16x32_bf16 v[228:231], v[88:91], v[184:187], v[228:231]
    v_mfma_f32_16x16x32_bf16 v[232:235], v[120:123], v[184:187], v[232:235]
    s_waitcnt lgkmcnt(5)
    v_mfma_f32_16x16x32_bf16 v[224:227], v[52:55], v[188:191], v[224:227]
    ds_read_b128 v[184:187], v7 offset:832
    v_mfma_f32_16x16x32_bf16 v[228:231], v[84:87], v[188:191], v[228:231]
    v_mfma_f32_16x16x32_bf16 v[232:235], v[116:119], v[188:191], v[232:235]
    s_waitcnt lgkmcnt(5)
    v_mfma_f32_16x16x32_bf16 v[224:227], v[48:51], v[192:195], v[224:227]
    ds_read_b128 v[188:191], v7 offset:768
    v_mfma_f32_16x16x32_bf16 v[228:231], v[80:83], v[192:195], v[228:231]
    v_mfma_f32_16x16x32_bf16 v[232:235], v[112:115], v[192:195], v[232:235]
    s_waitcnt lgkmcnt(5)
    s_nop 0
    v_mfma_f32_16x16x32_bf16 v[228:231], v[76:79], v[196:199], v[228:231]
    ds_read_b128 v[192:195], v7 offset:704
    ds_write_b128 v8, v[220:223] offset:4096
    v_mfma_f32_16x16x32_bf16 v[232:235], v[108:111], v[196:199], v[232:235]
    ds_write_b128 v8, v[224:227] offset:5120
    s_mov_b64 exec, 1
    ds_write_b32 v4, v5 offset:32
    s_mov_b64 exec, -1
    s_waitcnt lgkmcnt(8)
    v_mfma_f32_16x16x32_bf16 v[228:231], v[72:75], v[200:203], v[228:231]
    ds_read_b64 v[196:197], v2 offset:9528
    ds_read_b64 v[198:199], v2 offset:10168
    s_waitcnt vmcnt(0)
    s_mov_b64 exec, 1
    buffer_store_dword v34, off, s[44:47], s12 offset:0
    s_mov_b64 exec, -1
    v_mfma_f32_16x16x32_bf16 v[232:235], v[104:107], v[200:203], v[232:235]
    s_waitcnt lgkmcnt(8)
    v_mfma_f32_16x16x32_bf16 v[228:231], v[252:255], v[180:183], v[228:231]
    ds_read_b128 v[200:203], v7 offset:640
    v_mfma_f32_16x16x32_bf16 v[232:235], v[248:251], v[180:183], v[232:235]
    s_waitcnt lgkmcnt(8)
    v_mfma_f32_16x16x32_bf16 v[228:231], v[68:71], v[184:187], v[228:231]
    ds_read_b128 v[180:183], v7 offset:576
    ds_read_b32 v11, v6 offset:32
    v_mfma_f32_16x16x32_bf16 v[232:235], v[100:103], v[184:187], v[232:235]
    ds_read_b32 v15, v6 offset:112
    s_waitcnt lgkmcnt(10)
    v_mfma_f32_16x16x32_bf16 v[228:231], v[64:67], v[188:191], v[228:231]
    ds_read_b64 v[184:185], v2 offset:9560
    ds_read_b64 v[186:187], v2 offset:10200
    v_mfma_f32_16x16x32_bf16 v[232:235], v[96:99], v[188:191], v[232:235]
    s_waitcnt lgkmcnt(11)
    v_mfma_f32_16x16x32_bf16 v[228:231], v[60:63], v[192:195], v[228:231]
    ds_read_b128 v[188:191], v7 offset:512
    s_waitcnt lgkmcnt(3)
    v_min_u32 v11, v11, v15
    v_cmp_eq_u32 vcc, 0, v11
    s_cbranch_vccnz L_SLOW2
L_BACK2:
    v_mfma_f32_16x16x32_bf16 v[232:235], v[92:95], v[192:195], v[232:235]
    ds_read_b64 v[12:13], v10 offset:1152
    ds_read_b64 v[220:221], v9 offset:4096
    v_mfma_f32_16x16x32_bf16 v[228:231], v[240:243], v[196:199], v[228:231]
    ds_read_b128 v[192:195], v7 offset:448
    ds_read_b64 v[222:223], v9 offset:12288
    v_mfma_f32_16x16x32_bf16 v[232:235], v[252:255], v[196:199], v[232:235]
    ds_read_b64 v[224:225], v9 offset:20480
    ds_read_b64 v[226:227], v9 offset:28672
    v_mfma_f32_16x16x32_bf16 v[228:231], v[56:59], v[200:203], v[228:231]
    ds_read_b128 v[196:199], v7 offset:384
    v_mfma_f32_16x16x32_bf16 v[232:235], v[88:91], v[200:203], v[232:235]
    v_mfma_f32_16x16x32_bf16 v[228:231], v[52:55], v[180:183], v[228:231]
    ds_read_b128 v[200:203], v7 offset:320
    s_waitcnt lgkmcnt(2)
    v_lshlrev_b32 v36, 16, v24
    v_mfma_f32_16x16x32_bf16 v[232:235], v[84:87], v[180:183], v[232:235]
    v_and_b32 v37, 0xffff0000, v24
    v_lshlrev_b32_e64 v38, 16, v25
    v_mfma_f32_16x16x32_bf16 v[228:231], v[236:239], v[184:187], v[228:231]
    ds_read_b64 v[180:181], v2 offset:9592
    ds_read_b64 v[182:183], v2 offset:10232
    v_and_b32 v39, 0xffff0000, v25
    v_mfma_f32_16x16x32_bf16 v[232:235], v[240:243], v[184:187], v[232:235]
    v_lshlrev_b32_e64 v40, 16, v26
    v_and_b32 v41, 0xffff0000, v26
    v_mfma_f32_16x16x32_bf16 v[228:231], v[48:51], v[188:191], v[228:231]
    ds_read_b128 v[184:187], v7 offset:256
    v_lshlrev_b32_e64 v42, 16, v27
    v_mfma_f32_16x16x32_bf16 v[232:235], v[80:83], v[188:191], v[232:235]
    v_and_b32 v43, 0xffff0000, v27
    v_add_f32_e64 v36, v220, v36
    v_mfma_f32_16x16x32_bf16 v[232:235], v[76:79], v[192:195], v[232:235]
    ds_read_b128 v[188:191], v7 offset:192
    v_add_f32_e64 v37, v222, v37
    ds_write_b128 v8, v[228:231] offset:6144
    s_waitcnt lgkmcnt(6)
    v_mfma_f32_16x16x32_bf16 v[232:235], v[72:75], v[196:199], v[232:235]
    ds_read_b128 v[192:195], v7 offset:128
    v_add_f32_e64 v38, v224, v38
    s_waitcnt lgkmcnt(6)
    v_mfma_f32_16x16x32_bf16 v[232:235], v[68:71], v[200:203], v[232:235]
    ds_read_b128 v[196:199], v7 offset:64
    v_add_f32 v39, v226, v39
    s_waitcnt lgkmcnt(5)
    v_mfma_f32_16x16x32_bf16 v[232:235], v[236:239], v[180:183], v[232:235]
    ds_read_b128 v[200:203], v7 offset:0
    v_add_f32 v40, v221, v40
    s_waitcnt lgkmcnt(5)
    v_mfma_f32_16x16x32_bf16 v[232:235], v[64:67], v[184:187], v[232:235]
    v_add_f32 v41, v223, v41
    v_add_f32_e64 v42, v225, v42
    s_waitcnt lgkmcnt(4)
    v_mfma_f32_16x16x32_bf16 v[232:235], v[60:63], v[188:191], v[232:235]
    v_add_f32_e64 v43, v227, v43
    v_cvt_pk_bf16_f32 v220, v36, v37
    s_waitcnt lgkmcnt(2)
    v_mfma_f32_16x16x32_bf16 v[232:235], v[56:59], v[192:195], v[232:235]
    v_cvt_pk_bf16_f32 v221, v38, v39
    v_cvt_pk_bf16_f32 v222, v40, v41
    s_waitcnt lgkmcnt(1)
    v_mfma_f32_16x16x32_bf16 v[232:235], v[52:55], v[196:199], v[232:235]
    v_cvt_pk_bf16_f32 v223, v42, v43
    s_cmp_lg_u32 s14, 2
    s_cbranch_scc1 L_ES2
    buffer_store_dwordx4 v[220:223], v33, s[44:47], s13 offen
L_EB2:
    s_add_u32 s13, s13, 0x1000
    s_waitcnt lgkmcnt(0)
    v_mfma_f32_16x16x32_bf16 v[232:235], v[48:51], v[200:203], v[232:235]
    s_nop 7
    ds_write_b128 v8, v[232:235] offset:7168
    s_mov_b64 exec, 1
    ds_write_b32 v4, v5 offset:48
    s_mov_b64 exec, -1
    v_lshlrev_b32_e64 v36, 16, v28
    v_and_b32 v37, 0xffff0000, v28
    v_lshlrev_b32_e64 v38, 16, v29
    v_and_b32 v39, 0xffff0000, v29
    v_lshlrev_b32_e64 v40, 16, v30
    v_and_b32 v41, 0xffff0000, v30
    v_lshlrev_b32_e64 v42, 16, v31
    v_and_b32 v43, 0xffff0000, v31
LW_2:
    ds_read_b32 v11, v6 offset:48
    s_waitcnt lgkmcnt(0)
    v_cmp_eq_u32_e64 vcc, 0, v11
    s_cbranch_vccnz LW_2
    ds_read_b64 v[228:229], v9 offset:6144
    ds_read_b64 v[230:231], v9 offset:14336
    ds_read_b64 v[232:233], v9 offset:22528
    ds_read_b64 v[234:235], v9 offset:30720
    s_waitcnt lgkmcnt(0)
    v_add_f32 v36, v228, v36
    v_add_f32 v37, v230, v37
    v_add_f32 v38, v232, v38
    v_add_f32 v39, v234, v39
    v_add_f32 v40, v229, v40
    v_add_f32 v41, v231, v41
    v_add_f32 v42, v233, v42
    v_add_f32_e64 v43, v235, v43
    v_cvt_pk_bf16_f32 v228, v36, v37
    v_cvt_pk_bf16_f32 v229, v38, v39
    v_cvt_pk_bf16_f32 v230, v40, v41
    v_cvt_pk_bf16_f32 v231, v42, v43
    s_cmp_lg_u32 s14, 2
    s_cbranch_scc1 L_ES3
    buffer_store_dwordx4 v[228:231], v33, s[44:47], s13 offen
L_EB3:
    s_add_u32 s13, s13, 0x1000
    s_cmp_lg_u32 s14, 2
    s_cbranch_scc1 L_CNL
    s_lshr_b32 s8, s2, 3
    s_and_b32 s9, s2, 7
    s_lshr_b32 s21, s58, 1
    s_add_u32 s21, s21, 2
    v_lshrrev_b32 v69, 3, v0
    v_and_b32 v70, 7, v0
    s_lshl_b32 s20, s8, 5
    s_add_u32 s20, s20, s21
    v_lshrrev_b32_e64 v68, 4, v0
    v_lshl_add_u32 v68, v68, 2, s20
    v_and_b32_e64 v67, 1, v69
    v_lshl_add_u32 v68, v68, 1, v67
    ds_read_u8 v71, v68 offset:1152
    ds_read_u8 v68, v68 offset:1184
    s_mul_i32 s20, s58, 17408
    s_add_u32 s20, s20, 52224
    v_lshl_add_u32 v65, v69, 3, s20
    v_lshl_add_u32 v66, v70, 4, s20
    s_movk_i32 s20, 288
    v_mad_u32_u24 v65, v70, s20, v65
    s_movk_i32 s20, 144
    v_mad_u32_u24 v66, v69, s20, v66
    v_lshlrev_b32_e64 v70, 4, v70
    v_lshl_add_u32 v64, v69, 14, v70
    v_lshl_add_u32 v69, v69, 11, v70
    s_and_b32 s20, s58, 1
    s_lshl_b32 s17, s9, 1
    s_add_u32 s17, s17, s20
    s_lshl_b32 s21, s21, 5
    s_add_u32 s21, s21, s8
    s_lshl_b32 s16, s17, 18
    s_lshl_b32 s20, s21, 7
    s_add_u32 s16, s16, s20
    s_add_u32 s16, s16, 3145728
    s_lshl_b32 s18, s21, 15
    s_lshl_b32 s17, s17, 7
    s_add_u32 s18, s18, s17
    s_add_u32 s19, s18, 0x4000
    s_add_u32 s17, s16, 0x20000
    s_lshl_b32 s20, s9, 5
    s_lshr_b32 s8, s8, 3
    s_add_u32 s20, s20, s8
    s_lshl_b32 s20, s20, 7
    s_add_u32 s20, s20, 983552
    s_mov_b32 s21, 0
    s_waitcnt lgkmcnt(0)
    v_lshl_or_b32 v67, v71, 24, v69
    v_lshl_or_b32 v68, v68, 24, v69
    v_lshlrev_b32 v71, 2, v0
    s_waitcnt vmcnt(0)
    s_mov_b64 exec, 1
    buffer_store_dword v34, off, s[44:47], s12 offset:512
    s_mov_b64 exec, -1
    s_mov_b32 exec_hi, 0
LT_3:
    buffer_load_dword v69, v71, s[44:47], s20 offen sc1
    s_add_u32 s21, s21, 1
    s_waitcnt vmcnt(0)
    v_cmp_ne_u32_e64 vcc, v34, v69
    s_cbranch_vccz LT_3K
    s_sleep 1
    s_cmp_lt_u32 s21, 0x4000
    s_cbranch_scc1 LT_3
LT_3K:
    s_mov_b32 exec_hi, -1
    buffer_load_dwordx4 v[48:51], v64, s[44:47], s16 offen sc1
    buffer_load_dwordx4 v[52:55], v64, s[44:47], s17 offen sc1
    s_mov_b64 exec, 1
    ds_write_b32 v4, v5 offset:560
    s_mov_b64 exec, -1
    s_waitcnt vmcnt(1)
    ds_write_b64 v65, v[48:49] offset:0
    ds_write_b64 v65, v[50:51] offset:144
    s_waitcnt vmcnt(0)
    ds_write_b64 v65, v[52:53] offset:64
    ds_write_b64 v65, v[54:55] offset:208
    ds_read_b128 v[56:59], v66 offset:0
    ds_read_b128 v[60:63], v66 offset:1152
    s_waitcnt lgkmcnt(1)
    buffer_store_dwordx4 v[56:59], v67, s[52:55], s18 offen sc1
    s_waitcnt lgkmcnt(0)
    buffer_store_dwordx4 v[60:63], v68, s[52:55], s19 offen sc1
    s_branch L_FIN
L_CNL:
    s_mov_b64 exec, 1
    ds_write_b32 v4, v5 offset:560
    s_mov_b64 exec, -1
    s_branch L_FIN
L_SLOW0:
LW_4:
    ds_read_b32 v11, v6 offset:144
    s_waitcnt lgkmcnt(0)
    v_cmp_eq_u32 vcc, 0, v11
    s_cbranch_vccnz LW_4
    s_branch L_BACK0
L_SLOW1:
LW_5:
    ds_read_b32 v11, v6 offset:16
    s_waitcnt lgkmcnt(0)
    v_cmp_eq_u32 vcc, 0, v11
    s_cbranch_vccnz LW_5
    s_branch L_BACK1
L_SLOW2:
LW_6:
    ds_read_b32 v11, v6 offset:32
    s_waitcnt lgkmcnt(0)
    v_cmp_eq_u32_e64 vcc, 0, v11
    s_cbranch_vccnz LW_6
LW_7:
    ds_read_b32 v11, v6 offset:112
    s_waitcnt lgkmcnt(0)
    v_cmp_eq_u32 vcc, 0, v11
    s_cbranch_vccnz LW_7
    s_branch L_BACK2
L_SLOW3:
LW_8:
    ds_read_b32 v11, v6 offset:160
    s_waitcnt lgkmcnt(0)
    v_cmp_eq_u32 vcc, 0, v11
    s_cbranch_vccnz LW_8
    s_branch L_BACK3
L_ES0:
LW_9:
    ds_read_b32 v11, v6 offset:112
    s_waitcnt lgkmcnt(0)
    v_cmp_eq_u32_e64 vcc, 0, v11
    s_cbranch_vccnz LW_9
    ds_read_b64 v[12:13], v10 offset:1152
    s_waitcnt lgkmcnt(0)
    v_lshlrev_b32 v14, 24, v12
    v_and_or_b32 v14, v14, s68, v3
    v_lshlrev_b32_e64 v15, 16, v12
    v_and_or_b32 v15, v15, s68, v3
    buffer_store_dwordx2 v[204:205], v14, s[52:55], s60 offen offset:0
    buffer_store_dwordx2 v[206:207], v15, s[52:55], s60 offen offset:2048
    s_branch L_EB0
L_ES1:
LW_10:
    ds_read_b32 v11, v6 offset:112
    s_waitcnt lgkmcnt(0)
    v_cmp_eq_u32 vcc, 0, v11
    s_cbranch_vccnz LW_10
    ds_read_b64 v[12:13], v10 offset:1152
    s_waitcnt lgkmcnt(0)
    v_lshlrev_b32 v14, 8, v12
    v_and_or_b32 v14, v14, s68, v3
    v_and_or_b32 v15, v12, s68, v3
    buffer_store_dwordx2 v[212:213], v14, s[52:55], s61 offen offset:0
    buffer_store_dwordx2 v[214:215], v15, s[52:55], s61 offen offset:2048
    s_branch L_EB1
L_ES2:
    v_lshlrev_b32 v14, 24, v13
    v_and_or_b32 v14, v14, s68, v3
    v_lshlrev_b32_e64 v15, 16, v13
    v_and_or_b32 v15, v15, s68, v3
    buffer_store_dwordx2 v[220:221], v14, s[52:55], s62 offen offset:0
    buffer_store_dwordx2 v[222:223], v15, s[52:55], s62 offen offset:2048
    s_branch L_EB2
L_ES3:
    v_lshlrev_b32 v14, 8, v13
    v_and_or_b32 v14, v14, s68, v3
    v_and_or_b32 v15, v13, s68, v3
    buffer_store_dwordx2 v[228:229], v14, s[52:55], s63 offen offset:0
    buffer_store_dwordx2 v[230:231], v15, s[52:55], s63 offen offset:2048
    s_branch L_EB3
L_XF:
    s_add_u32 s31, s31, 64
    s_buffer_load_dwordx8 s[16:23], s[44:47], s31
    ds_read_b64 v[128:129], v1 offset:1280
    ds_read_b64 v[130:131], v1 offset:1288
    ds_read_b64 v[132:133], v1 offset:1344
    ds_read_b64 v[134:135], v1 offset:1352
    ds_read_b64 v[136:137], v1 offset:1408
    ds_read_b64 v[138:139], v1 offset:1416
    ds_read_b64 v[140:141], v1 offset:1472
    ds_read_b64 v[142:143], v1 offset:1480
    ds_read_b64 v[144:145], v1 offset:1536
    ds_read_b64 v[146:147], v1 offset:1544
    ds_read_b64 v[148:149], v1 offset:1600
    ds_read_b64 v[150:151], v1 offset:1608
    ds_read_b64 v[152:153], v1 offset:1664
    ds_read_b64 v[154:155], v1 offset:1672
    ds_read_b64 v[156:157], v1 offset:1728
    ds_read_b64 v[158:159], v1 offset:1736
    ds_read_b64 v[160:161], v1 offset:1792
    ds_read_b64 v[162:163], v1 offset:1800
    ds_read_b64 v[164:165], v1 offset:1856
    ds_read_b64 v[166:167], v1 offset:1864
    ds_read_b64 v[168:169], v1 offset:1920
    ds_read_b64 v[170:171], v1 offset:1928
    ds_read_b64 v[172:173], v1 offset:1984
    ds_read_b64 v[174:175], v1 offset:1992
    ds_read_b64 v[176:177], v1 offset:2048
    ds_read_b64 v[178:179], v1 offset:2056
    s_branch L_XC
L_XP:
    s_sleep 2
    ds_read_b32 v11, v4 offset:528
    s_cmp_ge_u32 s5, 2
    s_cbranch_scc1 L_XG
    s_add_u32 s31, s31, 64
    s_buffer_load_dwordx8 s[16:23], s[44:47], s31
    s_branch L_XH
L_XG:
    s_buffer_load_dwordx8 s[16:23], s[44:47], s31 glc
L_XH:
    s_add_u32 s5, s5, 1
    s_waitcnt lgkmcnt(0)
    v_cmp_eq_u32 vcc, 1, v11
    s_cbranch_vccnz L_XSLOW
    s_cmp_ge_u32 s5, 0x4000
    s_cbranch_scc1 L_XSLOW
L_XC:
    s_waitcnt lgkmcnt(0)
    s_xor_b64 s[16:17], s[16:17], s[28:29]
    s_xor_b64 s[18:19], s[18:19], s[28:29]
    s_xor_b64 s[20:21], s[20:21], s[28:29]
    s_xor_b64 s[22:23], s[22:23], s[28:29]
    s_or_b64 s[16:17], s[16:17], s[18:19]
    s_or_b64 s[20:21], s[20:21], s[22:23]
    s_or_b64 s[16:17], s[16:17], s[20:21]
    s_cbranch_scc1 L_XP
    s_setprio 3
    s_add_u32 s4, s13, 0
    buffer_load_dwordx4 v[16:19], v33, s[44:47], s4 offen sc1
    s_add_u32 s4, s13, 4096
    buffer_load_dwordx4 v[20:23], v33, s[44:47], s4 offen sc1
    s_add_u32 s4, s13, 8192
    buffer_load_dwordx4 v[24:27], v33, s[44:47], s4 offen sc1
    s_add_u32 s4, s13, 12288
    buffer_load_dwordx4 v[28:31], v33, s[44:47], s4 offen sc1
    s_mov_b64 exec, 1
    ds_write_b32 v4, v5 offset:544
    s_mov_b64 exec, -1
    s_setprio 2
    s_branch L_XBACK
L_XSLOW:
    buffer_load_dwordx2 v[16:17], v3, s[48:51], s60 offen offset:0
    buffer_load_dwordx2 v[18:19], v3, s[48:51], s60 offen offset:2048
    buffer_load_dwordx2 v[20:21], v3, s[48:51], s61 offen offset:0
    buffer_load_dwordx2 v[22:23], v3, s[48:51], s61 offen offset:2048
    buffer_load_dwordx2 v[24:25], v3, s[48:51], s62 offen offset:0
    buffer_load_dwordx2 v[26:27], v3, s[48:51], s62 offen offset:2048
    buffer_load_dwordx2 v[28:29], v3, s[48:51], s63 offen offset:0
    buffer_load_dwordx2 v[30:31], v3, s[48:51], s63 offen offset:2048
    s_waitcnt vmcnt(0)
    s_branch L_XBACK
L_F0:
    s_setprio 2
    s_mov_b32 s61, 7864320
    s_lshl_b32 s7, s2, 2
    s_add_u32 s7, s7, s3
    s_lshl_b32 s13, s2, 6
    s_add_u32 s13, s13, 7864320
    s_lshl_b32 s8, s7, 12
    v_and_b32 v10, 31, v0
    v_lshlrev_b32 v10, 4, v10
    v_lshrrev_b32 v11, 5, v0
    v_lshl_add_u32 v11, v11, 11, v10
    v_add_u32 v11, s8, v11
    s_cmp_lt_u32 s6, 28
    s_cselect_b32 s69, 1, 0
    s_lshr_b32 s8, s6, 2
    s_add_u32 s9, s5, 3
    s_and_b32 s9, s9, 7
    s_min_u32 s9, s9, 6
    s_cmp_lt_u32 s6, 28
    s_cselect_b32 s8, s8, s9
    s_mul_i32 s59, s5, 7
    s_add_u32 s59, s59, s8
    s_and_b32 s68, s6, 3
    s_lshl_b32 s8, s68, 2
    s_add_u32 s8, s8, s3
    s_lshl_b32 s8, s8, 6
    s_xor_b32 s9, s69, 1
    s_lshl_b32 s9, s9, 5
    s_add_u32 s8, s8, s9
    v_lshrrev_b32_e64 v12, 4, v0
    v_lshl_add_u32 v12, v12, 3, s8
    v_lshlrev_b32 v9, 1, v12
    s_movk_i32 s10, 7168
    v_mul_u32_u24 v14, s10, v12
    v_and_b32 v12, 7, v0
    v_lshl_add_u32 v14, v12, 4, v14
    s_lshl_b32 s8, s59, 7
    v_add_u32 v14, s8, v14
    v_and_b32 v12, 8, v0
    v_cmp_ne_u32_e64 vcc, 0, v12
    s_waitcnt lgkmcnt(0)
    global_load_dwordx4 v[16:19], v11, s[16:17] offset:0
    global_load_dwordx4 v[20:23], v11, s[16:17] offset:512
    global_load_dwordx4 v[24:27], v11, s[16:17] offset:1024
    global_load_dwordx4 v[28:31], v11, s[16:17] offset:1536
    s_load_dword s56, s[42:43], 0
    global_load_dwordx4 v[32:35], v10, s[32:33] offset:0
    global_load_dwordx4 v[36:39], v10, s[32:33] offset:512
    global_load_dwordx4 v[40:43], v10, s[32:33] offset:1024
    global_load_dwordx4 v[44:47], v10, s[32:33] offset:1536
    v_mov_b32 v12, s34
    v_mov_b32 v13, s35
    v_mov_b32 v10, s36
    v_mov_b32 v11, s37
    v_cndmask_b32 v12, v12, v10, vcc
    v_cndmask_b32 v13, v13, v11, vcc
    v_add_co_u32 v220, vcc, v12, v14
    s_movk_i32 s20, 7168
    s_mov_b32 s21, 0
    v_addc_co_u32 v221, vcc, 0, v13, vcc
    s_barrier
    s_mov_b32 s48, s16
    s_and_b32 s49, s17, 0xffff
    s_mov_b32 s50, 0x400000
    s_mov_b32 s51, 0x20000
    s_mov_b32 s52, s40
    s_and_b32 s53, s41, 0xffff
    s_mov_b32 s54, 0x400000
    s_mov_b32 s55, 0x20000
    s_lshl_b32 s8, s6, 17
    s_lshl_b32 s9, s3, 15
    s_add_u32 s8, s8, s9
    s_lshl_b32 s9, s5, 8
    s_add_u32 s8, s8, s9
    s_add_u32 s9, s8, 4096
    v_lshrrev_b32 v10, 4, v0
    v_and_b32 v11, 15, v0
    v_lshlrev_b32_e64 v11, 4, v11
    v_lshl_add_u32 v14, v10, 13, v11
    buffer_load_dwordx4 v[64:67], v14, s[48:51], s8 offen offset:0
    buffer_load_dwordx4 v[68:71], v14, s[48:51], s8 offen offset:2048
    buffer_load_dwordx4 v[72:75], v14, s[48:51], s9 offen offset:0
    buffer_load_dwordx4 v[76:79], v14, s[48:51], s9 offen offset:2048
    s_mul_i32 s8, s3, 4608
    s_add_u32 s8, s8, 121856
    s_movk_i32 s9, 1088
    v_mad_u32_u24 v96, v10, s9, v11
    v_add_u32 v96, s8, v96
    v_and_b32 v10, 7, v0
    v_lshrrev_b32_e64 v11, 3, v0
    s_movk_i32 s9, 544
    v_lshl_add_u32 v97, v11, 3, s8
    v_mad_u32_u24 v97, v10, s9, v97
    v_lshlrev_b32_e64 v98, 4, v10
    v_lshl_add_u32 v98, v11, 14, v98
    s_lshl_b32 s18, s5, 19
    s_lshl_b32 s9, s6, 9
    s_add_u32 s18, s18, s9
    s_lshl_b32 s9, s3, 7
    s_add_u32 s18, s18, s9
    s_add_u32 s18, s18, 3145728
    s_getreg_b32 s19, hwreg(HW_REG_XCC_ID, 0, 4)
    s_mov_b32 s22, 179200
    s_cmp_eq_u32 s69, 1
    s_cselect_b32 s22, s22, 0xfffbbc00
    s_cselect_b32 s23, 0, -1
    s_lshl_b32 s62, s5, 2
    s_bfe_u32 s9, s6, 0x20001
    s_add_u32 s62, s62, s9
    s_lshl_b32 s62, s62, 12
    s_lshr_b32 s9, s6, 3
    s_lshl_b32 s9, s9, 1
    s_add_u32 s62, s62, s9
    s_and_b32 s9, s6, 1
    s_add_u32 s62, s62, s9
    s_lshl_b32 s62, s62, 2
    s_add_u32 s62, s62, 7340032
    s_lshl_b32 s19, s19, 1
    s_lshl_b32 s9, s5, 2
    s_lshl_b32 s40, 15, s9
    s_mov_b32 s41, s40
    s_mov_b32 s44, s42
    s_and_b32 s45, s43, 0xffff
    s_mov_b32 s46, 0x1000000
    s_mov_b32 s47, 0x20000
    s_mov_b32 s24, s38
    s_and_b32 s25, s39, 0xffff
    s_mov_b32 s26, 0x700000
    s_mov_b32 s27, 0x20000
    s_lshl_b32 s7, s3, 2
    v_mov_b32 v2, s7
    v_and_b32 v11, 3, v0
    v_lshlrev_b32 v1, 2, v11
    v_mov_b32 v5, 1
    s_lshl_b32 s8, s3, 6
    v_add_u32 v14, s8, v0
    v_lshlrev_b32 v226, 4, v14
    v_lshlrev_b32 v105, 4, v11
    v_lshrrev_b32_e64 v63, 2, v0
    v_lshl_add_u32 v63, v63, 14, v105
    s_lshl_b32 s4, s5, 14
    v_add_u32 v223, 0, v226
    s_mov_b32 s5, 7868416
    s_mov_b32 s6, 7872512
    s_mov_b32 s7, 7876608
    s_cmp_lg_u32 s3, 0
    s_cbranch_scc1 L_NOZ
    v_lshlrev_b32 v224, 4, v0
    v_mov_b32 v228, 0
    v_mov_b32 v229, 0
    v_mov_b32 v230, 0
    v_mov_b32_e64 v231, 0
    ds_write_b128 v224, v[228:231] offset:1024
    ds_write_b128 v224, v[228:231] offset:2048
    ds_write_b128 v224, v[228:231] offset:3072
L_NOZ:
    s_lshl_b32 s4, s3, 6
    v_add_u32 v14, s4, v0
    v_lshlrev_b32_e64 v15, 4, v14
    s_mov_b32 s64, 0x05040100
    s_mov_b32 s65, 0x07060302
    v_lshlrev_b32 v224, 4, v0
    v_and_b32 v10, 15, v0
    v_lshlrev_b32 v10, 2, v10
    v_and_b32 v11, 48, v0
    s_movk_i32 s4, 0xfff
    v_lshlrev_b32 v248, 1, v14
    v_sub_u32 v248, s4, v248
    v_subrev_u32 v249, 1, v248
    v_subrev_u32 v250, 512, v248
    v_subrev_u32 v251, 513, v248
    v_subrev_u32 v252, 1024, v248
    v_subrev_u32 v253, 1025, v248
    v_subrev_u32 v254, 1536, v248
    v_subrev_u32 v255, 1537, v248
    v_lshlrev_b32 v227, 3, v14
    v_lshrrev_b32 v225, 4, v14
    v_lshlrev_b32 v225, 2, v225
    v_lshlrev_b32_e64 v14, 2, v14
    s_mov_b32 s16, 0
    s_mov_b32 s17, 0xffff0000
    v_lshlrev_b32 v3, 3, v11
    s_lshl_b32 s8, s3, 12
    s_add_u32 s8, s8, 140288
    v_add_u32 v3, s8, v3
    v_lshrrev_b32 v12, 5, v0
    v_lshlrev_b32_e64 v4, 7, v12
    v_bfe_u32 v12, v0, 4, 1
    v_lshl_add_u32 v4, v12, 3, v4
    v_bfe_u32 v12, v0, 3, 1
    v_lshl_add_u32 v4, v12, 9, v4
    v_and_b32_e64 v12, 7, v0
    v_lshl_add_u32 v4, v12, 4, v4
    s_lshl_b32 s8, s3, 10
    s_add_u32 s8, s8, 140288
    v_add_u32 v4, s8, v4
    v_bfe_u32 v12, v0, 4, 1
    v_lshlrev_b32 v12, 16, v12
    v_lshrrev_b32 v13, 5, v0
    v_lshl_add_u32 v12, v13, 12, v12
    v_lshl_add_u32 v222, v10, 1, v12
    s_lshl_b32 s10, s59, 17
    s_lshl_b32 s11, s68, 9
    s_add_u32 s10, s10, s11
    s_lshl_b32 s11, s3, 7
    s_add_u32 s10, s10, s11
    s_mov_b32 s8, 0x3f803f80
    s_waitcnt vmcnt(8)
    v_dot2_f32_bf16 v48, v16, s8, 0
    v_dot2_f32_bf16 v49, v16, v16, 0
    v_dot2_f32_bf16 v48, v17, s8, v48
    v_dot2_f32_bf16 v49, v17, v17, v49
    v_dot2_f32_bf16 v48, v18, s8, v48
    v_dot2_f32_bf16 v49, v18, v18, v49
    v_dot2_f32_bf16 v48, v19, s8, v48
    v_dot2_f32_bf16 v49, v19, v19, v49
    v_dot2_f32_bf16 v48, v20, s8, v48
    v_dot2_f32_bf16 v49, v20, v20, v49
    v_dot2_f32_bf16 v48, v21, s8, v48
    v_dot2_f32_bf16 v49, v21, v21, v49
    v_dot2_f32_bf16 v48, v22, s8, v48
    v_dot2_f32_bf16 v49, v22, v22, v49
    v_dot2_f32_bf16 v48, v23, s8, v48
    v_dot2_f32_bf16 v49, v23, v23, v49
    v_dot2_f32_bf16 v48, v24, s8, v48
    v_dot2_f32_bf16 v49, v24, v24, v49
    v_dot2_f32_bf16 v48, v25, s8, v48
    v_dot2_f32_bf16 v49, v25, v25, v49
    v_dot2_f32_bf16 v48, v26, s8, v48
    v_dot2_f32_bf16 v49, v26, v26, v49
    v_dot2_f32_bf16 v48, v27, s8, v48
    v_dot2_f32_bf16 v49, v27, v27, v49
    v_dot2_f32_bf16 v48, v28, s8, v48
    v_dot2_f32_bf16 v49, v28, v28, v49
    v_dot2_f32_bf16 v48, v29, s8, v48
    v_dot2_f32_bf16 v49, v29, v29, v49
    v_dot2_f32_bf16 v48, v30, s8, v48
    v_dot2_f32_bf16 v49, v30, v30, v49
    v_dot2_f32_bf16 v48, v31, s8, v48
    v_dot2_f32_bf16 v49, v31, v31, v49
    s_waitcnt lgkmcnt(0)
    s_mul_i32 s56, s56, 0x9E3779B1
    s_add_u32 s56, s56, 0x7F4A7C15
    s_or_b32 s56, s56, 1
    s_andn2_b32 s56, s56, 0x1e
    s_or_b32 s63, s19, s56
    v_mov_b32 v59, s63
    s_waitcnt vmcnt(4)
    v_dot2_f32_bf16 v50, v16, v32, 0
    v_dot2_f32_bf16 v51, v32, s8, 0
    v_dot2_f32_bf16 v50, v17, v33, v50
    v_dot2_f32_bf16 v51, v33, s8, v51
    v_dot2_f32_bf16 v50, v18, v34, v50
    v_dot2_f32_bf16 v51, v34, s8, v51
    v_dot2_f32_bf16 v50, v19, v35, v50
    v_dot2_f32_bf16 v51, v35, s8, v51
    v_dot2_f32_bf16 v50, v20, v36, v50
    v_dot2_f32_bf16 v51, v36, s8, v51
    v_dot2_f32_bf16 v50, v21, v37, v50
    v_dot2_f32_bf16 v51, v37, s8, v51
    v_dot2_f32_bf16 v50, v22, v38, v50
    v_dot2_f32_bf16 v51, v38, s8, v51
    v_dot2_f32_bf16 v50, v23, v39, v50
    v_dot2_f32_bf16 v51, v39, s8, v51
    v_dot2_f32_bf16 v50, v24, v40, v50
    v_dot2_f32_bf16 v51, v40, s8, v51
    v_dot2_f32_bf16 v50, v25, v41, v50
    v_dot2_f32_bf16 v51, v41, s8, v51
    v_dot2_f32_bf16 v50, v26, v42, v50
    v_dot2_f32_bf16 v51, v42, s8, v51
    v_dot2_f32_bf16 v50, v27, v43, v50
    v_dot2_f32_bf16 v51, v43, s8, v51
    v_dot2_f32_bf16 v50, v28, v44, v50
    v_dot2_f32_bf16 v51, v44, s8, v51
    v_dot2_f32_bf16 v50, v29, v45, v50
    v_dot2_f32_bf16 v51, v45, s8, v51
    v_dot2_f32_bf16 v50, v30, v46, v50
    v_dot2_f32_bf16 v51, v46, s8, v51
    v_dot2_f32_bf16 v50, v31, v47, v50
    v_dot2_f32_bf16 v51, v47, s8, v51
    s_nop 0
    s_nop 0
    v_add_f32_dpp v48, v48, v48 row_shr:1 row_mask:0xf bank_mask:0xf
    v_add_f32_dpp v49, v49, v49 row_shr:1 row_mask:0xf bank_mask:0xf
    v_add_f32_dpp v50, v50, v50 row_shr:1 row_mask:0xf bank_mask:0xf
    v_add_f32_dpp v51, v51, v51 row_shr:1 row_mask:0xf bank_mask:0xf
    v_add_f32_dpp v48, v48, v48 row_shr:2 row_mask:0xf bank_mask:0xf
    v_add_f32_dpp v49, v49, v49 row_shr:2 row_mask:0xf bank_mask:0xf
    v_add_f32_dpp v50, v50, v50 row_shr:2 row_mask:0xf bank_mask:0xf
    v_add_f32_dpp v51, v51, v51 row_shr:2 row_mask:0xf bank_mask:0xf
    v_add_f32_dpp v48, v48, v48 row_shr:4 row_mask:0xf bank_mask:0xf
    v_add_f32_dpp v49, v49, v49 row_shr:4 row_mask:0xf bank_mask:0xf
    v_add_f32_dpp v50, v50, v50 row_shr:4 row_mask:0xf bank_mask:0xf
    v_add_f32_dpp v51, v51, v51 row_shr:4 row_mask:0xf bank_mask:0xf
    v_add_f32_dpp v48, v48, v48 row_shr:8 row_mask:0xf bank_mask:0xf
    v_add_f32_dpp v49, v49, v49 row_shr:8 row_mask:0xf bank_mask:0xf
    v_add_f32_dpp v50, v50, v50 row_shr:8 row_mask:0xf bank_mask:0xf
    v_add_f32_dpp v51, v51, v51 row_shr:8 row_mask:0xf bank_mask:0xf
    v_add_f32_dpp v48, v48, v48 row_bcast:15 row_mask:0xa bank_mask:0xf
    v_add_f32_dpp v49, v49, v49 row_bcast:15 row_mask:0xa bank_mask:0xf
    v_add_f32_dpp v50, v50, v50 row_bcast:15 row_mask:0xa bank_mask:0xf
    v_add_f32_dpp v51, v51, v51 row_bcast:15 row_mask:0xa bank_mask:0xf
    v_mul_f32 v48, 0x3a800000, v48
    v_mul_f32 v49, 0x3a800000, v49
    v_cvt_pk_bf16_f32 v52, v48, v48
    v_fma_f32 v49, -v48, v48, v49
    v_max_f32_e64 v49, 0, v49
    v_and_b32 v53, 0xffff0000, v52
    v_cvt_pk_bf16_f32 v49, v49, v49
    v_and_b32 v49, 0xffff0000, v49
    v_add_f32 v49, 0x3727c5ac, v49
    v_fma_f32 v50, -v53, v51, v50
    v_cvt_pk_bf16_f32 v49, v49, v49
    v_and_b32 v49, 0xffff0000, v49
    v_sqrt_f32 v49, v49
    v_lshlrev_b32 v104, 2, v2
    v_mov_b32 v61, 0
    v_and_b32 v62, 62, v0
    v_mad_u32_u24 v62, v62, 3, v0
    v_lshlrev_b32_e64 v62, 6, v62
    v_cvt_pk_bf16_f32 v54, v49, v49
    v_and_b32 v49, 0xffff0000, v54
    v_rcp_f32 v49, v49
    s_nop 0
    v_mul_f32_e64 v50, v50, v49
    v_cvt_pk_bf16_f32 v50, v50, v50
    v_bfe_i32 v51, v50, 15, 1
    v_or_b32 v51, 0x80008000, v51
    v_xor_b32_e64 v55, v50, v51
    s_mov_b32 s8, 0xffff
    v_mov_b32_dpp v56, v52 row_bcast:31 row_mask:0x8 bank_mask:0xf
    v_mov_b32_dpp v57, v54 row_bcast:31 row_mask:0x8 bank_mask:0xf
    v_mov_b32_dpp v58, v55 row_bcast:31 row_mask:0x8 bank_mask:0xf
    v_bfi_b32 v56, s8, v56, v52
    v_bfi_b32 v57, s8, v57, v54
    v_bfi_b32 v58, s8, v58, v55
    s_brev_b64 exec, 1
    ds_write_b128 v104, v[56:59] offset:576
    ds_add_rtn_u32 v60, v61, v5 offset:512
    s_mov_b64 exec, -1
    s_waitcnt lgkmcnt(0)
    v_readlane_b32 s8, v60, 63
    s_cmp_lg_u32 s8, 3
    s_cbranch_scc1 L_NOPUB
    s_bfm_b64 exec, 4, 0
    ds_read_b128 v[52:55], v105 offset:576
    s_waitcnt lgkmcnt(0)
    buffer_store_dwordx4 v[52:55], v63, s[44:47], s13 offen sc1
    ds_write_b32 v61, v5 offset:516
    s_mov_b64 exec, -1
    s_waitcnt vmcnt(1)
    s_branch L_PUB2
L_NOPUB:
    s_waitcnt vmcnt(0)
L_PUB2:
    s_nop 0
    ds_write_b128 v96, v[64:67] offset:0
    ds_write_b128 v96, v[68:71] offset:272
    ds_write_b128 v96, v[72:75] offset:544
    ds_write_b128 v96, v[76:79] offset:816
    ds_read_b64 v[80:81], v97 offset:0
    ds_read_b64 v[82:83], v97 offset:272
    ds_read_b64 v[84:85], v97 offset:64
    ds_read_b64 v[86:87], v97 offset:336
    ds_read_b64 v[88:89], v97 offset:128
    ds_read_b64 v[90:91], v97 offset:400
    ds_read_b64 v[92:93], v97 offset:192
    ds_read_b64 v[94:95], v97 offset:464
    s_waitcnt lgkmcnt(6)
    buffer_store_dwordx4 v[80:83], v98, s[44:47], s18 offen
    s_add_u32 s18, s18, 0x20000
    s_waitcnt lgkmcnt(4)
    buffer_store_dwordx4 v[84:87], v98, s[44:47], s18 offen
    s_add_u32 s18, s18, 0x20000
    s_waitcnt lgkmcnt(2)
    buffer_store_dwordx4 v[88:91], v98, s[44:47], s18 offen
    s_add_u32 s18, s18, 0x20000
    s_waitcnt lgkmcnt(0)
    buffer_store_dwordx4 v[92:95], v98, s[44:47], s18 offen
    s_add_u32 s18, s18, 0x20000
    s_mov_b64 exec, 1
    ds_write_b32 v2, v59 offset:128
    s_mov_b64 exec, -1
LW_11:
    ds_read_b32 v60, v61 offset:516
    s_waitcnt lgkmcnt(0)
    v_cmp_eq_u32_e64 vcc, 0, v60
    s_cbranch_vccnz LW_11
    s_waitcnt vmcnt(0)
    s_mov_b64 exec, 1
    ds_add_rtn_u32 v60, v61, v5 offset:520
    s_waitcnt lgkmcnt(0)
    v_readfirstlane_b32 s8, v60
    s_cmp_lg_u32 s8, 3
    s_mov_b64 exec, -1
    s_cbranch_scc1 L_NOXF
    s_nop 0
    buffer_store_dword v59, v62, s[44:47], s62 offen offset:0
    buffer_store_dword v59, v62, s[44:47], s62 offen offset:128
    buffer_store_dword v59, v62, s[44:47], s62 offen offset:256
L_NOXF:
    global_load_dwordx4 v[112:115], v[220:221], off
    v_lshl_add_u64 v[220:221], s[20:21], 0, v[220:221]
    global_load_dwordx4 v[116:119], v[220:221], off
    v_lshl_add_u64 v[220:221], s[20:21], 0, v[220:221]
    global_load_dwordx4 v[120:123], v[220:221], off
    v_lshl_add_u64 v[220:221], s[20:21], 0, v[220:221]
    global_load_dwordx4 v[124:127], v[220:221], off
    v_lshl_add_u64 v[220:221], s[20:21], 0, v[220:221]
    s_waitcnt vmcnt(3)
    global_load_dwordx4 v[128:131], v[220:221], off
    v_lshl_add_u64 v[220:221], s[20:21], 0, v[220:221]
    s_waitcnt vmcnt(3)
    buffer_load_dwordx4 v[32:35], v223, s[44:47], s61 offen sc1
    s_waitcnt vmcnt(3)
    buffer_load_dwordx4 v[36:39], v223, s[44:47], s5 offen sc1
    s_waitcnt vmcnt(3)
    buffer_load_dwordx4 v[40:43], v223, s[44:47], s6 offen sc1
    s_waitcnt vmcnt(3)
    buffer_load_dwordx4 v[44:47], v223, s[44:47], s7 offen sc1
    s_waitcnt vmcnt(0)
    s_branch L_KPW
L_KP:
    s_sleep 1
    s_mov_b64 exec, s[30:31]
    s_cbranch_execz L_KS0
    buffer_load_dwordx4 v[32:35], v223, s[44:47], s61 offen sc1
L_KS0:
    s_mov_b64 exec, s[8:9]
    s_cbranch_execz L_KS1
    buffer_load_dwordx4 v[36:39], v223, s[44:47], s5 offen sc1
L_KS1:
    s_mov_b64 exec, s[14:15]
    s_cbranch_execz L_KS2
    buffer_load_dwordx4 v[40:43], v223, s[44:47], s6 offen sc1
L_KS2:
    s_mov_b64 exec, s[28:29]
    s_cbranch_execz L_KS3
    buffer_load_dwordx4 v[44:47], v223, s[44:47], s7 offen sc1
L_KS3:
    s_mov_b64 exec, -1
    s_waitcnt vmcnt(0)
L_KPW:
    s_add_u32 s16, s16, 1
    v_xor_b32 v16, s63, v35
    v_xor_b32 v17, s63, v39
    v_xor_b32 v18, s63, v43
    v_xor_b32_e64 v19, s63, v47
    v_cmp_lt_u32 s[30:31], 31, v16
    v_cmp_lt_u32 s[8:9], 31, v17
    v_cmp_lt_u32 s[14:15], 31, v18
    v_cmp_lt_u32 s[28:29], 31, v19
    v_or3_b32 v16, v16, v17, v18
    s_or_b64 vcc, s[30:31], s[8:9]
    s_or_b64 s[66:67], s[14:15], s[28:29]
    s_or_b64 vcc, vcc, s[66:67]
    s_cbranch_vccz L_KPOK
    s_cmp_lt_u32 s16, 0x4000
    s_cbranch_scc1 L_KP
L_KPOK:
    v_or_b32 v16, v16, v19
    v_cmp_ne_u32 vcc, 0, v16
    s_and_b64 vcc, vcc, s[40:41]
    s_cselect_b32 s8, 1, 2
    v_mov_b32 v16, s8
    ds_read_b32 v17, v1 offset:544
    ds_write2st64_b64 v227, v[32:33], v[36:37] offset0:18 offset1:22
    ds_write2st64_b64 v227, v[40:41], v[44:45] offset0:26 offset1:30
    s_mov_b64 exec, 1
    ds_write_b32 v2, v16 offset:528
    s_mov_b64 exec, -1
    v_lshl_or_b32 v248, v34, 16, v248
    v_and_or_b32 v249, v34, s17, v249
    v_lshl_or_b32 v250, v38, 16, v250
    v_and_or_b32 v251, v38, s17, v251
    v_lshl_or_b32 v252, v42, 16, v252
    v_and_or_b32 v253, v42, s17, v253
    v_lshl_or_b32 v254, v46, 16, v254
    v_and_or_b32 v255, v46, s17, v255
    s_waitcnt lgkmcnt(3)
    v_cmp_eq_u32 s[66:67], 0, v17
    s_cmp_lg_u32 s66, 0
    s_cbranch_scc1 L_NB0
    s_nop 0
    global_load_dwordx4 v[132:135], v[220:221], off
    v_lshl_add_u64 v[220:221], s[20:21], 0, v[220:221]
    global_load_dwordx4 v[136:139], v[220:221], off
    v_lshl_add_u64 v[220:221], s[20:21], 0, v[220:221]
    global_load_dwordx4 v[140:143], v[220:221], off
    v_lshl_add_u64 v[220:221], s[22:23], 0, v[220:221]
    global_load_dwordx4 v[144:147], v[220:221], off
    v_lshl_add_u64 v[220:221], s[20:21], 0, v[220:221]
L_NB0:
    v_max_u32 v226, v248, v249
    v_min_u32 v227, v248, v249
    v_max_u32 v228, v252, v253
    v_min_u32 v229, v252, v253
    v_med3_u32 v227, v226, v227, v250
    v_med3_u32 v229, v228, v229, v254
    v_max_u32 v226, v226, v250
    v_max_u32 v228, v228, v254
    v_med3_u32 v227, v226, v227, v251
    v_med3_u32 v229, v228, v229, v255
    v_max_u32 v226, v226, v251
    v_max_u32 v228, v228, v255
    v_min_u32 v230, v226, v228
    v_max_u32 v226, v226, v228
    v_max3_u32 v227, v227, v229, v230
    ds_write_b32 v14, v226 offset:8192
    ds_read_b32 v17, v1 offset:544
    v_add_u32 v15, 4096, v15
    v_max_u32_dpp v226, v226, v226 row_shr:1 row_mask:0xf bank_mask:0xf
    v_max_u32_dpp v227, v227, v227 row_shr:1 row_mask:0xf bank_mask:0xf
    ds_write2_b32 v15, v34, v38 offset0:0 offset1:1
    v_max_u32_dpp v226, v226, v226 row_shr:2 row_mask:0xf bank_mask:0xf
    v_max_u32_dpp v227, v227, v227 row_shr:2 row_mask:0xf bank_mask:0xf
    ds_write2_b32 v15, v42, v46 offset0:2 offset1:3
    v_max_u32_dpp v226, v226, v226 row_shr:4 row_mask:0xf bank_mask:0xf
    v_max_u32_dpp v227, v227, v227 row_shr:4 row_mask:0xf bank_mask:0xf
    s_nop 0
    s_nop 0
    v_max_u32_dpp v226, v226, v226 row_shr:8 row_mask:0xf bank_mask:0xf
    v_max_u32_dpp v227, v227, v227 row_shr:8 row_mask:0xf bank_mask:0xf
    s_mov_b32 exec_lo, 0x80008000
    s_mov_b32 exec_hi, 0x80008000
    ds_write2_b32 v225, v226, v227 offset0:96 offset1:112
    s_mov_b64 exec, 1
    ds_write_b32 v2, v16 offset:64
    s_mov_b64 exec, -1
    s_waitcnt lgkmcnt(4)
    v_cmp_eq_u32 vcc, 0, v17
    s_mov_b32 s67, vcc_lo
    s_cbranch_vccnz L_NB1
    s_cmp_eq_u32 s66, 0
    s_cbranch_scc1 L_NB2
    global_load_dwordx4 v[132:135], v[220:221], off
    v_lshl_add_u64 v[220:221], s[20:21], 0, v[220:221]
    global_load_dwordx4 v[136:139], v[220:221], off
    v_lshl_add_u64 v[220:221], s[20:21], 0, v[220:221]
    global_load_dwordx4 v[140:143], v[220:221], off
    v_lshl_add_u64 v[220:221], s[22:23], 0, v[220:221]
    global_load_dwordx4 v[144:147], v[220:221], off
    v_lshl_add_u64 v[220:221], s[20:21], 0, v[220:221]
L_NB2:
    global_load_dwordx4 v[148:151], v[220:221], off
    v_lshl_add_u64 v[220:221], s[20:21], 0, v[220:221]
    global_load_dwordx4 v[152:155], v[220:221], off
    v_lshl_add_u64 v[220:221], s[20:21], 0, v[220:221]
    global_load_dwordx4 v[156:159], v[220:221], off
    v_lshl_add_u64 v[220:221], s[20:21], 0, v[220:221]
    global_load_dwordx4 v[160:163], v[220:221], off
    v_lshl_add_u64 v[220:221], s[20:21], 0, v[220:221]
L_NB1:
LW_12:
    ds_read_b32 v225, v1 offset:64
    s_waitcnt lgkmcnt(0)
    v_cmp_eq_u32_e64 vcc, 0, v225
    s_cbranch_vccnz LW_12
    v_cmp_ne_u32 s[12:13], 2, v225
    ds_read2_b32 v[226:227], v10 offset0:96 offset1:112
    ds_read_b128 v[228:231], v11 offset:384
    ds_read_b128 v[232:235], v224 offset:8192
    s_waitcnt lgkmcnt(1)
    v_cmp_gt_u32 vcc, v228, v226
    v_cmp_gt_u32 s[8:9], v229, v226
    v_cmp_gt_u32 s[14:15], v230, v226
    v_cmp_gt_u32 s[28:29], v231, v226
    v_cndmask_b32 v236, 0, 1, vcc
    v_cndmask_b32 v237, 0, 1, s[8:9]
    v_addc_co_u32 v236, vcc, 0, v236, s[14:15]
    v_addc_co_u32 v236, vcc, v237, v236, s[28:29]
    v_mov_b32 v237, v236
    s_nop 1
    v_permlane32_swap_b32 v236, v237
    v_add_u32 v236, v236, v237
    v_mov_b32 v237, v236
    s_nop 1
    v_permlane16_swap_b32 v236, v237
    v_add_u32 v236, v236, v237
    v_cmp_eq_u32 vcc, 7, v236
    s_ff1_i32_b32 s5, vcc_lo
    v_readlane_b32 s4, v226, s5
    s_waitcnt lgkmcnt(0)
    s_nop 0
    v_cmp_le_u32 vcc, s4, v227
    s_cbranch_vccnz L_SLOWT
L_CAND:
    v_cmp_le_u32 s[8:9], s4, v232
    v_cmp_le_u32 s[14:15], s4, v233
    v_cmp_le_u32 s[28:29], s4, v234
    v_cmp_le_u32 s[30:31], s4, v235
    s_bcnt1_i32_b64 s5, s[8:9]
    s_bcnt1_i32_b64 s6, s[14:15]
    s_bcnt1_i32_b64 s7, s[28:29]
    s_bcnt1_i32_b64 s16, s[30:31]
    s_add_u32 s6, s6, s5
    s_add_u32 s7, s7, s6
    s_add_u32 s16, s16, s7
    s_cmp_gt_u32 s16, 16
    s_cbranch_scc1 L_TRIM
    v_mbcnt_lo_u32_b32 v236, s8, 0
    v_mbcnt_hi_u32_b32 v236, s9, v236
    v_add_lshl_u32 v236, v236, 0, 2
    s_mov_b64 exec, s[8:9]
    ds_write_b32 v236, v232 offset:192
    s_mov_b64 exec, -1
    v_mbcnt_lo_u32_b32 v237, s14, 0
    v_mbcnt_hi_u32_b32 v237, s15, v237
    v_add_lshl_u32 v237, v237, s5, 2
    s_mov_b64 exec, s[14:15]
    ds_write_b32 v237, v233 offset:192
    s_mov_b64 exec, -1
    v_mbcnt_lo_u32_b32 v238, s28, 0
    v_mbcnt_hi_u32_b32 v238, s29, v238
    v_add_lshl_u32 v238, v238, s6, 2
    s_mov_b64 exec, s[28:29]
    ds_write_b32 v238, v234 offset:192
    s_mov_b64 exec, -1
    v_mbcnt_lo_u32_b32 v239, s30, 0
    v_mbcnt_hi_u32_b32 v239, s31, v239
    v_add_lshl_u32 v239, v239, s7, 2
    s_mov_b64 exec, s[30:31]
    ds_write_b32 v239, v235 offset:192
    s_mov_b64 exec, -1
    s_cmp_eq_u32 s67, 0
    s_cbranch_scc1 L_NB3
    s_nop 0
    global_load_dwordx4 v[132:135], v[220:221], off
    v_lshl_add_u64 v[220:221], s[20:21], 0, v[220:221]
    global_load_dwordx4 v[136:139], v[220:221], off
    v_lshl_add_u64 v[220:221], s[20:21], 0, v[220:221]
    global_load_dwordx4 v[140:143], v[220:221], off
    v_lshl_add_u64 v[220:221], s[22:23], 0, v[220:221]
    global_load_dwordx4 v[144:147], v[220:221], off
    v_lshl_add_u64 v[220:221], s[20:21], 0, v[220:221]
    global_load_dwordx4 v[148:151], v[220:221], off
    v_lshl_add_u64 v[220:221], s[20:21], 0, v[220:221]
    global_load_dwordx4 v[152:155], v[220:221], off
    v_lshl_add_u64 v[220:221], s[20:21], 0, v[220:221]
    global_load_dwordx4 v[156:159], v[220:221], off
    v_lshl_add_u64 v[220:221], s[20:21], 0, v[220:221]
    global_load_dwordx4 v[160:163], v[220:221], off
    v_lshl_add_u64 v[220:221], s[20:21], 0, v[220:221]
L_NB3:
    global_load_dwordx4 v[164:167], v[220:221], off
    v_lshl_add_u64 v[220:221], s[20:21], 0, v[220:221]
    global_load_dwordx4 v[168:171], v[220:221], off
    v_lshl_add_u64 v[220:221], s[20:21], 0, v[220:221]
    global_load_dwordx4 v[172:175], v[220:221], off
    s_movk_i32 s4, 0x7ff
    ds_read_b32 v16, v10 offset:192
    ds_read_b128 v[20:23], v11 offset:192
    s_cmp_lg_u32 s69, 1
    s_waitcnt lgkmcnt(1)
    v_bfi_b32 v14, v16, 0, s4
    s_cbranch_scc1 L_NOXS
    v_lshl_add_u32 v15, v14, 11, v9
    buffer_load_dwordx4 v[208:211], v15, s[48:51], 0 offen
    buffer_load_dwordx4 v[212:215], v15, s[48:51], 0 offen offset:64
    v_lshrrev_b32 v15, 1, v14
    v_lshlrev_b32 v15, 3, v15
    ds_read_b64 v[8:9], v15 offset:9216
    s_add_u32 s11, s10, 0
    s_nop 0
    buffer_load_dwordx2 v[176:177], v222, s[24:27], s11 offen
    s_add_u32 s11, s10, 16384
    buffer_load_dwordx2 v[178:179], v222, s[24:27], s11 offen
    s_add_u32 s11, s10, 2048
    buffer_load_dwordx2 v[180:181], v222, s[24:27], s11 offen
    s_add_u32 s11, s10, 18432
    buffer_load_dwordx2 v[182:183], v222, s[24:27], s11 offen
    s_add_u32 s11, s10, 32768
    buffer_load_dwordx2 v[184:185], v222, s[24:27], s11 offen
    s_add_u32 s11, s10, 49152
    buffer_load_dwordx2 v[186:187], v222, s[24:27], s11 offen
    s_add_u32 s11, s10, 34816
    buffer_load_dwordx2 v[188:189], v222, s[24:27], s11 offen
    s_add_u32 s11, s10, 51200
    buffer_load_dwordx2 v[190:191], v222, s[24:27], s11 offen
L_NOXS:
    s_waitcnt lgkmcnt(0)
    v_cmp_gt_u32 vcc, v20, v16
    v_cmp_gt_u32 s[8:9], v21, v16
    v_cmp_gt_u32 s[14:15], v22, v16
    v_cmp_gt_u32 s[28:29], v23, v16
    v_cndmask_b32 v24, 0, 1, vcc
    v_cndmask_b32 v25, 0, 1, s[8:9]
    v_addc_co_u32 v24, vcc, 0, v24, s[14:15]
    v_addc_co_u32 v24, vcc, v25, v24, s[28:29]
    v_mov_b32 v25, v24
    s_nop 1
    v_permlane32_swap_b32 v24, v25
    v_add_u32 v24, v24, v25
    v_mov_b32 v25, v24
    s_nop 1
    v_permlane16_swap_b32 v24, v25
    v_add_u32 v24, v24, v25
    v_cmp_gt_u32 s[30:31], 8, v24
    v_lshlrev_b32 v15, 2, v24
    v_and_b32 v10, 7, v0
    v_lshlrev_b32_e64 v10, 2, v10
    v_bfe_u32 v20, v14, 1, 8
    v_lshrrev_b32 v21, 9, v14
    v_lshlrev_b32 v20, 3, v20
    v_lshl_add_u32 v20, v21, 1, v20
    v_and_b32 v14, 1, v14
    v_add_u32 v20, v20, v14
    v_mov_b32 v22, 0x80
    s_mov_b64 exec, s[30:31]
    ds_write_b32 v15, v16 offset:256
    s_cmp_lg_u32 s3, 0
    s_cbranch_scc1 L_NOSEL
    ds_write_b8 v20, v22 offset:1152
    s_cmp_lg_u32 s2, 255
    s_cbranch_scc1 L_NOSEL
    s_mov_b64 exec, 1
    v_mov_b32 v22, s56
    buffer_store_dword v22, v2, s[44:47], 0 offen sc1
L_NOSEL:
    s_mov_b64 exec, -1
    ds_read_b32 v7, v10 offset:256
    s_mov_b64 exec, 1
    ds_write_b32 v2, v5 offset:112
    s_mov_b64 exec, -1
    s_cmp_lg_u32 s69, 1
    s_cbranch_scc1 L_GATHER
    v_lshl_add_u32 v3, v24, 4, v3
    v_lshlrev_b32 v14, 4, v14
    v_lshlrev_b32 v13, 4, v0
    s_lshl_b32 s4, s59, 14
    s_add_u32 s4, s4, 65536
    s_lshl_b32 s6, s3, 12
    s_add_u32 s6, s6, s4
    s_lshl_b32 s5, s68, 10
    s_add_u32 s5, s5, s6
    v_mov_b32 v218, s56
    v_lshrrev_b32 v6, v14, v9
    v_lshrrev_b32 v8, v14, v8
    v_lshlrev_b32 v6, 16, v6
    v_xor_b32 v8, 0x8000, v8
    v_rcp_f32_e64 v6, v6
    v_perm_b32 v240, v8, v8, s64
    v_perm_b32 v241, v8, v8, s64
    v_perm_b32 v242, v8, v8, s64
    v_perm_b32 v243, v8, v8, s64
    s_waitcnt vmcnt(18)
    s_nop 0
    v_perm_b32 v48, v116, v112, s64
    v_perm_b32 v52, v116, v112, s65
    v_perm_b32 v49, v124, v120, s64
    v_perm_b32 v53, v124, v120, s65
    v_perm_b32 v50, v132, v128, s64
    v_perm_b32 v54, v132, v128, s65
    v_perm_b32 v51, v140, v136, s64
    v_perm_b32 v55, v140, v136, s65
    v_perm_b32 v56, v117, v113, s64
    v_perm_b32 v60, v117, v113, s65
    v_perm_b32 v57, v125, v121, s64
    v_perm_b32 v61, v125, v121, s65
    v_perm_b32 v58, v133, v129, s64
    v_perm_b32 v62, v133, v129, s65
    v_perm_b32 v59, v141, v137, s64
    v_perm_b32 v63, v141, v137, s65
    v_perm_b32 v64, v118, v114, s64
    v_perm_b32 v68, v118, v114, s65
    v_perm_b32 v65, v126, v122, s64
    v_perm_b32 v69, v126, v122, s65
    v_perm_b32 v66, v134, v130, s64
    v_perm_b32 v70, v134, v130, s65
    v_perm_b32 v67, v142, v138, s64
    v_perm_b32 v71, v142, v138, s65
    v_perm_b32 v72, v119, v115, s64
    v_perm_b32 v76, v119, v115, s65
    v_perm_b32 v73, v127, v123, s64
    v_perm_b32 v77, v127, v123, s65
    v_perm_b32 v74, v135, v131, s64
    v_perm_b32 v78, v135, v131, s65
    v_perm_b32 v75, v143, v139, s64
    v_perm_b32 v79, v143, v139, s65
    s_waitcnt vmcnt(10)
    s_nop 0
    v_mfma_f32_16x16x32_bf16 v[16:19], v[48:51], v[240:243], 0
    v_perm_b32 v80, v148, v144, s64
    v_perm_b32 v84, v148, v144, s65
    v_perm_b32 v81, v156, v152, s64
    v_perm_b32 v85, v156, v152, s65
    v_mfma_f32_16x16x32_bf16 v[20:23], v[52:55], v[240:243], 0
    v_perm_b32 v82, v164, v160, s64
    v_perm_b32 v86, v164, v160, s65
    v_perm_b32 v83, v172, v168, s64
    v_perm_b32 v87, v172, v168, s65
    v_mfma_f32_16x16x32_bf16 v[24:27], v[56:59], v[240:243], 0
    v_perm_b32 v88, v149, v145, s64
    v_perm_b32 v92, v149, v145, s65
    v_perm_b32 v89, v157, v153, s64
    v_perm_b32 v93, v157, v153, s65
    v_mfma_f32_16x16x32_bf16 v[28:31], v[60:63], v[240:243], 0
    v_perm_b32 v90, v165, v161, s64
    v_perm_b32 v94, v165, v161, s65
    v_perm_b32 v91, v173, v169, s64
    v_perm_b32 v95, v173, v169, s65
    v_mfma_f32_16x16x32_bf16 v[32:35], v[64:67], v[240:243], 0
    v_perm_b32 v96, v150, v146, s64
    v_perm_b32 v100, v150, v146, s65
    v_perm_b32 v97, v158, v154, s64
    v_perm_b32 v101, v158, v154, s65
    v_mfma_f32_16x16x32_bf16 v[36:39], v[68:71], v[240:243], 0
    v_perm_b32 v98, v166, v162, s64
    v_perm_b32 v102, v166, v162, s65
    v_perm_b32 v99, v174, v170, s64
    v_perm_b32 v103, v174, v170, s65
    v_mfma_f32_16x16x32_bf16 v[40:43], v[72:75], v[240:243], 0
    v_perm_b32 v104, v151, v147, s64
    v_perm_b32 v108, v151, v147, s65
    v_perm_b32 v105, v159, v155, s64
    v_perm_b32 v109, v159, v155, s65
    v_mfma_f32_16x16x32_bf16 v[44:47], v[76:79], v[240:243], 0
    v_perm_b32 v106, v167, v163, s64
    v_perm_b32 v110, v167, v163, s65
    v_perm_b32 v107, v175, v171, s64
    v_perm_b32 v111, v175, v171, s65
    v_mfma_f32_16x16x32_bf16 v[16:19], v[80:83], v[240:243], v[16:19]
    v_mfma_f32_16x16x32_bf16 v[20:23], v[84:87], v[240:243], v[20:23]
    v_mfma_f32_16x16x32_bf16 v[24:27], v[88:91], v[240:243], v[24:27]
    v_mfma_f32_16x16x32_bf16 v[28:31], v[92:95], v[240:243], v[28:31]
    v_mfma_f32_16x16x32_bf16 v[32:35], v[96:99], v[240:243], v[32:35]
    v_mfma_f32_16x16x32_bf16 v[36:39], v[100:103], v[240:243], v[36:39]
    v_mfma_f32_16x16x32_bf16 v[40:43], v[104:107], v[240:243], v[40:43]
    v_mfma_f32_16x16x32_bf16 v[44:47], v[108:111], v[240:243], v[44:47]
    s_waitcnt vmcnt(8)
    s_nop 0
    v_mfma_f32_16x16x32_bf16 v[16:19], v[48:51], v[208:211], v[16:19]
    s_add_u32 s11, s10, 8192
    buffer_load_dwordx2 v[192:193], v222, s[24:27], s11 offen
    v_mfma_f32_16x16x32_bf16 v[20:23], v[52:55], v[208:211], v[20:23]
    s_add_u32 s11, s10, 24576
    buffer_load_dwordx2 v[194:195], v222, s[24:27], s11 offen
    v_mfma_f32_16x16x32_bf16 v[24:27], v[56:59], v[208:211], v[24:27]
    s_add_u32 s11, s10, 10240
    buffer_load_dwordx2 v[196:197], v222, s[24:27], s11 offen
    v_mfma_f32_16x16x32_bf16 v[28:31], v[60:63], v[208:211], v[28:31]
    s_add_u32 s11, s10, 26624
    buffer_load_dwordx2 v[198:199], v222, s[24:27], s11 offen
    v_mfma_f32_16x16x32_bf16 v[32:35], v[64:67], v[208:211], v[32:35]
    s_add_u32 s11, s10, 40960
    buffer_load_dwordx2 v[200:201], v222, s[24:27], s11 offen
    v_mfma_f32_16x16x32_bf16 v[36:39], v[68:71], v[208:211], v[36:39]
    s_add_u32 s11, s10, 57344
    buffer_load_dwordx2 v[202:203], v222, s[24:27], s11 offen
    v_mfma_f32_16x16x32_bf16 v[40:43], v[72:75], v[208:211], v[40:43]
    s_add_u32 s11, s10, 43008
    buffer_load_dwordx2 v[204:205], v222, s[24:27], s11 offen
    v_mfma_f32_16x16x32_bf16 v[44:47], v[76:79], v[208:211], v[44:47]
    s_add_u32 s11, s10, 59392
    buffer_load_dwordx2 v[206:207], v222, s[24:27], s11 offen
    v_mfma_f32_16x16x32_bf16 v[16:19], v[80:83], v[212:215], v[16:19]
    v_mfma_f32_16x16x32_bf16 v[20:23], v[84:87], v[212:215], v[20:23]
    v_mfma_f32_16x16x32_bf16 v[24:27], v[88:91], v[212:215], v[24:27]
    v_mfma_f32_16x16x32_bf16 v[28:31], v[92:95], v[212:215], v[28:31]
    v_mfma_f32_16x16x32_bf16 v[32:35], v[96:99], v[212:215], v[32:35]
    v_mfma_f32_16x16x32_bf16 v[36:39], v[100:103], v[212:215], v[36:39]
    v_mfma_f32_16x16x32_bf16 v[40:43], v[104:107], v[212:215], v[40:43]
    v_mfma_f32_16x16x32_bf16 v[44:47], v[108:111], v[212:215], v[44:47]
    s_mov_b64 exec, s[30:31]
    s_nop 0
    ds_write_b128 v3, v[16:19] offset:0
    ds_write_b128 v3, v[20:23] offset:512
    ds_write_b128 v3, v[24:27] offset:1024
    ds_write_b128 v3, v[28:31] offset:1536
    ds_write_b128 v3, v[32:35] offset:2048
    ds_write_b128 v3, v[36:39] offset:2560
    ds_write_b128 v3, v[40:43] offset:3072
    ds_write_b128 v3, v[44:47] offset:3584
    ds_write_b32 v15, v6 offset:288
    s_mov_b64 exec, 1
    ds_write_b32 v2, v5 offset:80
    s_mov_b64 exec, -1
    ds_read_b32 v6, v10 offset:288
LW_13:
    ds_read_b32 v11, v1 offset:80
    s_waitcnt lgkmcnt(0)
    v_cmp_eq_u32_e64 vcc, 0, v11
    s_cbranch_vccnz LW_13
    ds_read_b64 v[224:225], v4 offset:0
    ds_read_b64 v[226:227], v4 offset:256
    ds_read_b64 v[228:229], v4 offset:4096
    ds_read_b64 v[230:231], v4 offset:4352
    ds_read_b64 v[232:233], v4 offset:8192
    ds_read_b64 v[234:235], v4 offset:8448
    ds_read_b64 v[236:237], v4 offset:12288
    ds_read_b64 v[238:239], v4 offset:12544
    s_waitcnt lgkmcnt(4)
    v_add_f32 v224, v224, v228
    v_add_f32 v225, v225, v229
    v_add_f32 v226, v226, v230
    v_add_f32 v227, v227, v231
    s_waitcnt lgkmcnt(0)
    v_add_f32 v232, v232, v236
    v_add_f32 v233, v233, v237
    v_add_f32 v234, v234, v238
    v_add_f32 v235, v235, v239
    v_add_f32 v224, v224, v232
    v_add_f32 v225, v225, v233
    v_add_f32 v226, v226, v234
    v_add_f32_e64 v227, v227, v235
    s_cmp_eq_u32 s12, 0
    v_cvt_pk_bf16_f32 v216, v224, v225
    v_cvt_pk_bf16_f32 v217, v226, v227
    s_cbranch_scc0 L_HSC
    buffer_store_dwordx4 v[216:219], v13, s[44:47], s5 offen
L_HSB:
    v_bfe_u32 v10, v0, 3, 1
    v_lshrrev_b32 v11, 4, v0
    v_cmp_ne_u32 s[22:23], 0, v10
    v_lshlrev_b32_e64 v15, 2, v10
    v_lshl_add_u32 v15, v11, 3, v15
    v_lshlrev_b32_e64 v10, 8, v10
    v_lshl_add_u32 v10, v11, 9, v10
    v_lshlrev_b32 v9, 4, v11
    v_and_b32 v11, 7, v0
    v_lshl_add_u32 v10, v11, 4, v10
    s_movk_i32 s5, 144
    v_mad_u32_u24 v15, v11, s5, v15
    v_mad_u32_u24 v9, v11, s5, v9
    s_lshl_b32 s5, s3, 5
    v_add_u32 v15, s5, v15
    s_lshl_b32 s4, s59, 15
    s_lshl_b32 s5, s68, 13
    s_add_u32 s4, s4, s5
    s_lshl_b32 s5, s3, 11
    s_add_u32 s4, s4, s5
    s_add_u32 s4, s4, 1048576
    v_mul_f32 v12, 0xbfb8aa3b, v6
    v_mul_f32 v14, v6, v6
    v_mov_b32 v50, s56
    v_mov_b32_e64 v54, s56
    s_mov_b32 s16, 0
    s_waitcnt vmcnt(9)
    v_perm_b32 v112, v178, v176, s64
    v_perm_b32 v116, v178, v176, s65
    v_perm_b32 v113, v182, v180, s64
    v_perm_b32 v117, v182, v180, s65
    v_perm_b32 v114, v186, v184, s64
    v_perm_b32 v118, v186, v184, s65
    v_perm_b32 v115, v190, v188, s64
    v_perm_b32 v119, v190, v188, s65
    v_perm_b32 v120, v179, v177, s64
    v_perm_b32 v124, v179, v177, s65
    v_perm_b32 v121, v183, v181, s64
    v_perm_b32 v125, v183, v181, s65
    v_perm_b32 v122, v187, v185, s64
    v_perm_b32 v126, v187, v185, s65
    v_perm_b32 v123, v191, v189, s64
    v_perm_b32 v127, v191, v189, s65
    buffer_load_dwordx3 v[144:146], v13, s[44:47], s6 offen offset:0 sc1
    buffer_load_dwordx3 v[148:150], v13, s[44:47], s6 offen offset:1024 sc1
    buffer_load_dwordx3 v[152:154], v13, s[44:47], s6 offen offset:2048 sc1
    buffer_load_dwordx3 v[156:158], v13, s[44:47], s6 offen offset:3072 sc1
    s_waitcnt vmcnt(5)
    s_nop 0
    v_perm_b32 v128, v194, v192, s64
    v_perm_b32 v132, v194, v192, s65
    v_perm_b32 v129, v198, v196, s64
    v_perm_b32 v133, v198, v196, s65
    v_perm_b32 v130, v202, v200, s64
    v_perm_b32 v134, v202, v200, s65
    v_perm_b32 v131, v206, v204, s64
    v_perm_b32 v135, v206, v204, s65
    v_perm_b32 v136, v195, v193, s64
    v_perm_b32 v140, v195, v193, s65
    v_perm_b32 v137, v199, v197, s64
    v_perm_b32 v141, v199, v197, s65
    v_perm_b32 v138, v203, v201, s64
    v_perm_b32 v142, v203, v201, s65
    v_perm_b32 v139, v207, v205, s64
    v_perm_b32 v143, v207, v205, s65
    s_branch L_HPW
L_HP:
    s_sleep 3
    s_cmp_eq_u64 s[18:19], 0
    s_cbranch_scc1 L_HS0
    buffer_load_dwordx3 v[144:146], v13, s[44:47], s6 offen offset:0 sc1
L_HS0:
    s_cmp_eq_u64 s[8:9], 0
    s_cbranch_scc1 L_HS1
    buffer_load_dwordx3 v[148:150], v13, s[44:47], s6 offen offset:1024 sc1
L_HS1:
    s_cmp_eq_u64 s[14:15], 0
    s_cbranch_scc1 L_HS2
    buffer_load_dwordx3 v[152:154], v13, s[44:47], s6 offen offset:2048 sc1
L_HS2:
    s_cmp_eq_u64 s[28:29], 0
    s_cbranch_scc1 L_HS3
    buffer_load_dwordx3 v[156:158], v13, s[44:47], s6 offen offset:3072 sc1
L_HS3:
L_HPW:
    s_add_u32 s16, s16, 1
    s_waitcnt vmcnt(0)
    v_cmp_ne_u32 s[18:19], s56, v146
    v_cmp_ne_u32 s[8:9], s56, v150
    v_cmp_ne_u32 s[14:15], s56, v154
    v_cmp_ne_u32 s[28:29], s56, v158
    s_or_b64 vcc, s[18:19], s[8:9]
    s_or_b64 s[20:21], s[14:15], s[28:29]
    s_or_b64 vcc, vcc, s[20:21]
    s_cbranch_vccz L_HOK
    s_cmp_lt_u32 s16, 0x4000
    s_cbranch_scc1 L_HP
L_HOK:
    v_lshlrev_b32 v224, 16, v144
    v_and_b32 v225, 0xffff0000, v144
    v_lshlrev_b32_e64 v226, 16, v148
    v_and_b32 v227, 0xffff0000, v148
    v_lshlrev_b32_e64 v228, 16, v152
    v_and_b32 v229, 0xffff0000, v152
    v_lshlrev_b32_e64 v230, 16, v156
    v_and_b32 v231, 0xffff0000, v156
    v_add_f32 v224, v224, v226
    v_add_f32 v228, v228, v230
    v_add_f32 v225, v225, v227
    v_add_f32 v229, v229, v231
    v_add_f32 v224, v224, v228
    v_add_f32 v225, v225, v229
    v_mul_f32 v244, v12, v224
    v_mul_f32 v245, v12, v225
    v_exp_f32 v244, v244
    v_exp_f32 v245, v245
    v_lshlrev_b32_e64 v232, 16, v145
    v_and_b32 v233, 0xffff0000, v145
    v_lshlrev_b32_e64 v234, 16, v149
    v_and_b32 v235, 0xffff0000, v149
    v_lshlrev_b32_e64 v236, 16, v153
    v_and_b32 v237, 0xffff0000, v153
    v_lshlrev_b32_e64 v238, 16, v157
    v_and_b32 v239, 0xffff0000, v157
    v_add_f32 v244, 1.0, v244
    v_add_f32 v245, 1.0, v245
    v_rcp_f32 v244, v244
    v_rcp_f32 v245, v245
    v_add_f32 v232, v232, v234
    v_add_f32 v236, v236, v238
    v_add_f32 v233, v233, v235
    v_add_f32 v237, v237, v239
    v_mul_f32 v224, v224, v14
    v_add_f32 v232, v232, v236
    v_mul_f32 v225, v225, v14
    v_add_f32 v233, v233, v237
    v_mul_f32 v224, v224, v244
    v_mul_f32 v225, v225, v245
    v_mul_f32 v224, v224, v232
    v_mul_f32 v225, v225, v233
    v_cvt_pk_bf16_f32 v244, v224, v225
    ds_write_b32 v15, v244 offset:4096
    s_mov_b64 exec, 1
    ds_write_b32 v2, v5 offset:176
    s_mov_b64 exec, -1
LW_14:
    ds_read_b32 v11, v1 offset:176
    s_waitcnt lgkmcnt(0)
    v_cmp_eq_u32_e64 vcc, 0, v11
    s_cbranch_vccnz LW_14
    ds_read_b128 v[224:227], v9 offset:4096
    ds_read_b128 v[228:231], v9 offset:4160
    s_waitcnt lgkmcnt(1)
    v_mfma_f32_16x16x32_bf16 v[16:19], v[112:115], v[224:227], 0
    v_mfma_f32_16x16x32_bf16 v[20:23], v[116:119], v[224:227], 0
    v_mfma_f32_16x16x32_bf16 v[24:27], v[120:123], v[224:227], 0
    v_mfma_f32_16x16x32_bf16 v[28:31], v[124:127], v[224:227], 0
    s_waitcnt lgkmcnt(0)
    v_mfma_f32_16x16x32_bf16 v[16:19], v[128:131], v[228:231], v[16:19]
    v_mfma_f32_16x16x32_bf16 v[20:23], v[132:135], v[228:231], v[20:23]
    v_mfma_f32_16x16x32_bf16 v[24:27], v[136:139], v[228:231], v[24:27]
    v_mfma_f32_16x16x32_bf16 v[28:31], v[140:143], v[228:231], v[28:31]
    s_nop 0
    s_nop 3
    v_cndmask_b32 v16, v16, v18, s[22:23]
    v_cndmask_b32 v20, v20, v22, s[22:23]
    v_cndmask_b32 v24, v24, v26, s[22:23]
    v_cndmask_b32 v28, v28, v30, s[22:23]
    v_cvt_pk_bf16_f32 v48, v16, v20
    v_cvt_pk_bf16_f32 v49, v24, v28
    buffer_store_dwordx4 v[48:51], v10, s[44:47], s4 offen offset:0 sc1
    v_cndmask_b32 v17, v17, v19, s[22:23]
    v_cndmask_b32 v21, v21, v23, s[22:23]
    v_cndmask_b32 v25, v25, v27, s[22:23]
    v_cndmask_b32 v29, v29, v31, s[22:23]
    v_cvt_pk_bf16_f32 v52, v17, v21
    v_cvt_pk_bf16_f32 v53, v25, v29
    buffer_store_dwordx4 v[52:55], v10, s[44:47], s4 offen offset:128 sc1
L_GATHER:
    s_waitcnt lgkmcnt(0)
    s_movk_i32 s4, 0x7ff
    v_bfi_b32 v14, v7, 0, s4
    v_lshrrev_b32 v10, 3, v0
    s_lshl_b32 s4, s3, 3
    v_add_lshl_u32 v10, v10, s4, 15
    v_and_b32 v11, 7, v0
    v_lshlrev_b32 v11, 4, v11
    v_add_u32 v10, v10, v11
    s_lshl_b32 s4, s57, 7
    s_add_u32 s4, s4, 1048576
    s_mov_b32 s11, 0
    v_bfe_u32 v12, v0, 3, 2
    v_lshlrev_b32 v13, 11, v14
    v_lshl_add_u32 v13, v12, 1, v13
    s_lshl_b32 s8, s57, 3
    v_add_u32 v13, s8, v13
    buffer_load_ushort v80, v13, s[48:51], 0 offen
LW_15:
    ds_read_b32 v15, v1 offset:112
    s_waitcnt lgkmcnt(0)
    v_cmp_eq_u32 vcc, 0, v15
    s_cbranch_vccnz LW_15
    s_cmp_eq_u32 s12, 0
    s_cselect_b32 s60, 2, 1
    v_lshrrev_b32 v15, 16, v7
    v_bfe_i32 v82, v15, 15, 1
    v_not_b32_e64 v82, v82
    v_or_b32 v82, 0x8000, v82
    v_xor_b32 v15, v15, v82
    v_lshlrev_b32 v15, 16, v15
    v_mul_f32 v15, 0xbfb8aa3b, v15
    v_exp_f32 v15, v15
    v_lshlrev_b32 v83, 13, v12
    v_add_f32 v15, 1.0, v15
    v_rcp_f32 v15, v15
    v_lshl_add_u32 v83, v14, 2, v83
    v_add_u32 v83, 17408, v83
    v_bfrev_b32 v84, v12
    v_lshrrev_b32 v84, 22, v84
    v_add_u32 v84, v84, v11
    v_lshrrev_b32_e64 v84, 2, v84
    s_lshl_b32 s8, s3, 8
    v_lshl_add_u32 v85, v0, 2, s8
    s_cmp_lg_u32 s12, 0
    s_cbranch_scc1 L_AFT
    s_lshr_b32 s8, s2, 3
    s_and_b32 s9, s2, 7
    s_lshr_b32 s21, s58, 1
    s_add_u32 s21, s21, 0
    v_lshrrev_b32 v101, 3, v0
    v_and_b32 v102, 7, v0
    s_lshl_b32 s20, s8, 5
    s_add_u32 s20, s20, s21
    v_lshrrev_b32_e64 v100, 4, v0
    v_lshl_add_u32 v100, v100, 2, s20
    v_and_b32_e64 v99, 1, v101
    v_lshl_add_u32 v100, v100, 1, v99
    ds_read_u8 v103, v100 offset:1152
    ds_read_u8 v100, v100 offset:1184
    s_mul_i32 s20, s58, 4096
    s_add_u32 s20, s20, 140288
    v_lshl_add_u32 v97, v101, 3, s20
    v_lshl_add_u32 v98, v102, 4, s20
    s_movk_i32 s20, 288
    v_mad_u32_u24 v97, v102, s20, v97
    s_movk_i32 s20, 144
    v_mad_u32_u24 v98, v101, s20, v98
    v_lshlrev_b32_e64 v102, 4, v102
    v_lshl_add_u32 v96, v101, 14, v102
    v_lshl_add_u32 v101, v101, 11, v102
    s_and_b32 s20, s58, 1
    s_lshl_b32 s17, s9, 1
    s_add_u32 s17, s17, s20
    s_lshl_b32 s21, s21, 5
    s_add_u32 s21, s21, s8
    s_lshl_b32 s16, s17, 18
    s_lshl_b32 s20, s21, 7
    s_add_u32 s16, s16, s20
    s_add_u32 s16, s16, 3145728
    s_lshl_b32 s18, s21, 15
    s_lshl_b32 s17, s17, 7
    s_add_u32 s18, s18, s17
    s_add_u32 s19, s18, 0x4000
    s_add_u32 s17, s16, 0x20000
    s_lshl_b32 s20, s9, 5
    s_lshr_b32 s8, s8, 3
    s_add_u32 s20, s20, s8
    s_lshl_b32 s20, s20, 7
    s_add_u32 s20, s20, 983040
    s_mov_b32 s21, 0
    s_waitcnt lgkmcnt(0)
    v_lshl_or_b32 v99, v103, 24, v101
    v_lshl_or_b32 v100, v100, 24, v101
    v_lshlrev_b32 v103, 2, v0
    s_setprio 0
LW_16:
    s_sleep 2
    ds_read_b32 v81, v1 offset:32
    s_waitcnt lgkmcnt(0)
    v_cmp_eq_u32 vcc, 0, v81
    s_cbranch_vccnz LW_16
    s_mov_b32 exec_hi, 0
LT_17:
    buffer_load_dword v101, v103, s[44:47], s20 offen sc1
    s_add_u32 s21, s21, 1
    s_waitcnt vmcnt(0)
    v_cmp_ne_u32_e64 vcc, s63, v101
    s_cbranch_vccz LT_17K
    s_sleep 3
    s_cmp_lt_u32 s21, 0x4000
    s_cbranch_scc1 LT_17
LT_17K:
    s_mov_b32 exec_hi, -1
    buffer_load_dwordx4 v[104:107], v96, s[44:47], s16 offen sc1
    buffer_load_dwordx4 v[108:111], v96, s[44:47], s17 offen sc1
    s_waitcnt vmcnt(1)
    ds_write_b64 v97, v[104:105] offset:0
    ds_write_b64 v97, v[106:107] offset:144
    s_waitcnt vmcnt(0)
    ds_write_b64 v97, v[108:109] offset:64
    ds_write_b64 v97, v[110:111] offset:208
    ds_read_b128 v[112:115], v98 offset:0
    ds_read_b128 v[116:119], v98 offset:1152
    s_waitcnt lgkmcnt(1)
    buffer_store_dwordx4 v[112:115], v99, s[52:55], s18 offen sc1
    s_waitcnt lgkmcnt(0)
    buffer_store_dwordx4 v[116:119], v100, s[52:55], s19 offen sc1
L_AFT:
    s_setprio 0
LW_18:
    s_sleep 1
    ds_read_b32 v81, v2 offset:560
    s_waitcnt lgkmcnt(0)
    v_cmp_eq_u32_e64 vcc, 0, v81
    s_cbranch_vccnz LW_18
    s_setprio 2
L_GGO:
    s_mov_b64 s[8:9], -1
    s_cmp_lt_u32 s3, 3
    s_cselect_b64 s[12:13], -1, 0
    s_add_u32 s5, s4, 0x100000
    v_mov_b32 v148, 0
    v_mov_b32 v149, 0
    v_mov_b32_e64 v150, s56
L_GP:
    s_cmp_eq_u64 s[8:9], 0
    s_cbranch_scc1 L_GS0
    buffer_load_dwordx3 v[144:146], v10, s[44:47], s4 offen sc1
L_GS0:
    s_cmp_eq_u64 s[12:13], 0
    s_cbranch_scc1 L_GS1
    buffer_load_dwordx3 v[148:150], v10, s[44:47], s5 offen sc1
L_GS1:
    s_add_u32 s11, s11, 1
    s_waitcnt vmcnt(0)
    v_cmp_ne_u32 s[8:9], s56, v146
    v_cmp_ne_u32 s[12:13], s56, v150
    s_or_b64 vcc, s[8:9], s[12:13]
    s_cbranch_vccz L_GOT
    s_sleep 2
    s_cmp_lt_u32 s11, 0x4000
    s_cbranch_scc1 L_GP
L_GOT:
    v_lshlrev_b32_e64 v176, 16, v144
    v_and_b32 v177, 0xffff0000, v144
    v_lshlrev_b32_e64 v178, 16, v145
    v_and_b32 v179, 0xffff0000, v145
    v_lshlrev_b32_e64 v180, 16, v148
    v_and_b32 v181, 0xffff0000, v148
    v_lshlrev_b32_e64 v182, 16, v149
    v_and_b32 v183, 0xffff0000, v149
    v_add_f32 v176, v176, v180
    v_add_f32 v177, v177, v181
    v_add_f32 v178, v178, v182
    v_add_f32 v179, v179, v183
    v_permlane32_swap_b32 v176, v177
    s_nop 0
    v_permlane32_swap_b32 v178, v179
    v_add_f32 v176, v176, v177
    v_add_f32 v178, v178, v179
    s_nop 1
    v_permlane16_swap_b32 v176, v178
    v_add_f32 v176, v176, v178
    s_nop 0
    s_nop 0
    v_add_f32_dpp v176, v176, v176 row_ror:8 row_mask:0xf bank_mask:0xf
    ds_write_b32 v85, v176 offset:8192
    s_mov_b64 exec, 1
    ds_write_b32 v2, v5 offset:96
    s_mov_b64 exec, -1
    s_cmp_lg_u32 s3, 0
    s_cbranch_scc1 L_FIN
    v_lshlrev_b32_e64 v80, 16, v80
L_FW:
    ds_read2_b32 v[86:87], v1 offset0:12 offset1:24
    ds_read_b32 v89, v83
    ds_read2st64_b32 v[90:91], v84 offset0:32 offset1:33
    ds_read2st64_b32 v[92:93], v84 offset0:34 offset1:35
    s_waitcnt lgkmcnt(3)
    v_min_u32 v86, v86, v87
    v_cmp_eq_u32 vcc, 0, v86
    s_cbranch_vccnz L_FW
    s_waitcnt lgkmcnt(1)
    v_add_f32 v80, v80, v89
    v_add_f32 v90, v90, v91
    s_waitcnt lgkmcnt(0)
    v_add_f32 v92, v92, v93
    v_add_f32 v90, v90, v92
    v_fma_f32 v80, v90, v15, v80
    v_cvt_pk_bf16_f32 v80, v80, v80
    s_mov_b32 exec_hi, 0
    buffer_store_short v80, v13, s[52:55], 0 offen
    s_mov_b64 exec, -1
    s_branch L_FIN
L_HSC:
    buffer_store_dwordx4 v[216:219], v13, s[44:47], s5 offen sc1
    s_branch L_HSB
L_TRIM:
    v_subrev_u32 v236, s4, v232
    v_subrev_u32 v237, s4, v233
    v_subrev_u32 v238, s4, v234
    v_subrev_u32 v239, s4, v235
    v_min3_u32 v236, v236, v237, v238
    v_min_u32 v236, v236, v239
    s_nop 1
    v_min_u32_dpp v236, v236, v236 row_shr:1 row_mask:0xf bank_mask:0xf
    s_nop 0
    s_nop 0
    v_min_u32_dpp v236, v236, v236 row_shr:2 row_mask:0xf bank_mask:0xf
    s_nop 0
    s_nop 0
    v_min_u32_dpp v236, v236, v236 row_shr:4 row_mask:0xf bank_mask:0xf
    s_nop 0
    s_nop 0
    v_min_u32_dpp v236, v236, v236 row_shr:8 row_mask:0xf bank_mask:0xf
    s_nop 0
    s_nop 0
    v_min_u32_dpp v236, v236, v236 row_bcast:15 row_mask:0xa bank_mask:0xf
    s_nop 0
    s_nop 0
    v_min_u32_dpp v236, v236, v236 row_bcast:31 row_mask:0xc bank_mask:0xf
    s_nop 0
    v_readlane_b32 s5, v236, 63
    s_add_u32 s4, s4, s5
    s_add_u32 s4, s4, 1
    s_branch L_CAND
L_SLOWT:
    v_max3_u32 v228, v232, v233, v234
    v_max_u32 v228, v228, v235
    s_mov_b32 s4, 0
    s_brev_b32 s5, 1
L_BS:
    s_or_b32 s6, s4, s5
    v_cmp_le_u32_e64 vcc, s6, v228
    s_lshr_b32 s5, s5, 1
    s_bcnt1_i32_b64 s7, vcc
    s_cmp_ge_u32 s7, 8
    s_cselect_b32 s4, s6, s4
    s_cmp_lg_u32 s7, 8
    s_cbranch_scc1 L_BS
    v_mbcnt_lo_u32_b32 v229, vcc_lo, 0
    v_mbcnt_hi_u32_b32 v229, vcc_hi, v229
    v_lshlrev_b32 v229, 2, v229
    s_mov_b64 exec, vcc
    ds_write_b32 v229, v0 offset:320
    s_mov_b64 exec, -1
    v_lshrrev_b32 v230, 3, v0
    v_lshlrev_b32_e64 v230, 2, v230
    ds_read_b32 v229, v230 offset:320
    s_waitcnt lgkmcnt(0)
    v_and_b32 v230, 7, v0
    v_lshl_add_u32 v229, v229, 3, v230
    v_lshlrev_b32_e64 v230, 3, v229
    ds_read_b64 v[226:227], v230 offset:4096
    v_and_b32 v230, 1, v229
    v_and_b32 v229, -2, v229
    v_lshl_add_u32 v229, v230, 10, v229
    v_sub_u32 v232, 0xfff, v229
    v_sub_u32 v233, 0xffe, v229
    v_sub_u32 v234, 0xdff, v229
    v_sub_u32 v235, 0xdfe, v229
    s_mov_b32 s5, 0xffff0000
    s_waitcnt lgkmcnt(0)
    v_lshl_or_b32 v232, v226, 16, v232
    v_and_or_b32 v233, v226, s5, v233
    v_lshl_or_b32 v234, v227, 16, v234
    v_and_or_b32 v235, v227, s5, v235
    s_branch L_CAND
L_FIN:
L_END:
    s_endpgm
.section .rodata,"a"
.p2align 6
.amdhsa_kernel parallel_sum__ssm_conv_s4d__moe_arch_mod__prompt_kernel
  .amdhsa_next_free_vgpr 256
  .amdhsa_next_free_sgpr 102
  .amdhsa_accum_offset 256
  .amdhsa_group_segment_fixed_size 0
  .amdhsa_kernarg_size 120
  .amdhsa_user_sgpr_count 2
  .amdhsa_user_sgpr_kernarg_segment_ptr 1
  .amdhsa_system_sgpr_workgroup_id_x 1
  .amdhsa_float_denorm_mode_32 3
.end_amdhsa_kernel
```

```asm
; @launch grid=(256,1,1) block=(512,1,1) lds=156672
.amdgcn_target "amdgcn-amd-amdhsa--gfx950"
.text
.globl parallel_sum__ssm_conv_s4d__moe_arch_mod__prompt_kernel
.p2align 8
.type parallel_sum__ssm_conv_s4d__moe_arch_mod__prompt_kernel,@function
parallel_sum__ssm_conv_s4d__moe_arch_mod__prompt_kernel:
    s_cmp_ge_u32 s2, 256
    s_cbranch_scc1 L_END
    s_load_dwordx16 s[16:31], s[0:1], 0
    s_load_dwordx8 s[32:39], s[0:1], 64
    s_load_dwordx2 s[40:41], s[0:1], 96
    s_load_dwordx2 s[42:43], s[0:1], 112
    s_getpc_b64 s[14:15]
    v_lshrrev_b32_e64 v1, 6, v0
    v_and_b32 v10, 255, v0
    v_and_b32 v0, 63, v0
    v_readfirstlane_b32 s3, v1
    v_lshlrev_b32 v1, 2, v0
    v_mov_b32 v2, 0
    ds_write2st64_b32 v1, v2, v2 offset0:0 offset1:2
    s_and_b32 s5, s2, 7
    s_lshr_b32 s6, s2, 3
    s_lshl_b32 s57, s5, 5
    s_add_u32 s57, s57, s6
    s_and_b32 s58, s3, 3
    s_lshl_b32 s7, s57, 2
    s_add_u32 s7, s7, s58
    s_lshl_b32 s7, s7, 8
    v_add_u32 v15, s7, v1
    s_mov_b32 s60, 0
    s_lshl_b32 s4, s57, 3
    s_cmp_lt_u32 s3, 4
    s_cbranch_scc1 L_F0
    s_and_b32 s8, s6, 15
    s_lshl_b32 s8, s8, 2
    s_add_u32 s8, s8, s58
    s_lshl_b32 s8, s8, 9
    s_mov_b32 s69, s8
    v_lshl_add_u32 v2, v0, 7, s8
    v_min_u32 v2, L_END-parallel_sum__ssm_conv_s4d__moe_arch_mod__prompt_kernel-128, v2
    s_mov_b64 exec, 0xf
    global_load_dword v255, v2, s[14:15]
    s_mov_b64 exec, -1
    v_lshlrev_b32 v3, 12, v10
    v_add_u32_e64 v3, s4, v3
    s_lshl_b32 s8, s5, 5
    s_add_u32 s8, s8, s58
    s_lshl_b32 s8, s8, 7
    s_add_u32 s8, s8, 983040
    v_lshl_add_u32 v2, v0, 9, s8
    s_lshl_b32 s59, s5, 2
    s_add_u32 s59, s59, s58
    s_lshl_b32 s59, s59, 5
    s_add_u32 s59, s59, s6
    s_lshl_b32 s59, s59, 9
    s_add_u32 s59, s59, 7340032
    s_sub_u32 s8, s59, 512
    v_lshl_add_u32 v4, v0, 7, s8
    v_cmp_lt_u32 vcc, 3, v0
    s_nop 0
    s_nop 0
    v_cndmask_b32 v2, v2, v4, vcc
    s_lshl_b32 s8, s2, 6
    s_add_u32 s8, s8, 7864320
    v_writelane_b32 v2, s8, 3
    s_waitcnt lgkmcnt(0)
    s_cmp_ge_u32 s6, 32
    s_cbranch_scc1 L_NFP
    s_mov_b64 exec, 127
    global_load_dword v255, v2, s[42:43]
    s_mov_b64 exec, -1
L_NFP:
    global_load_dword v224, v15, s[18:19]
    global_load_dword v225, v15, s[20:21]
    global_load_dword v226, v15, s[22:23]
    global_load_dword v227, v15, s[24:25]
    s_add_u32 s6, s26, s4
    s_addc_u32 s7, s27, 0
    s_load_dwordx2 s[64:65], s[6:7], 0
    s_add_u32 s6, s28, s4
    s_addc_u32 s7, s29, 0
    s_load_dwordx2 s[66:67], s[6:7], 0
    s_barrier
    s_mov_b64 s[26:27], s[14:15]
    s_mov_b32 s61, 0x100000
    s_mov_b32 s62, 0x200000
    s_mov_b32 s63, 0x300000
    s_mov_b32 s44, s42
    s_and_b32 s45, s43, 0xffff
    s_mov_b32 s46, 0x1000000
    s_mov_b32 s47, 0x20000
    s_mov_b32 s48, s16
    s_and_b32 s49, s17, 0xffff
    s_mov_b32 s50, 0x400000
    s_mov_b32 s51, 0x20000
    s_mov_b32 s52, s40
    s_and_b32 s53, s41, 0xffff
    s_mov_b32 s54, 0x400000
    s_mov_b32 s55, 0x20000
    s_setprio 2
    s_mul_i32 s8, s58, 17408
    s_add_u32 s8, s8, 52224
    s_mul_i32 s10, s58, 4608
    s_add_u32 s10, s10, 121856
    s_mul_i32 s11, s58, 8704
    s_add_u32 s11, s11, 17408
    s_movk_i32 s9, 544
    s_sub_u32 m0, s8, 48064
    v_lshl_add_u32 v15, v0, 3, s10
    v_and_b32 v16, 15, v0
    v_lshrrev_b32 v17, 4, v0
    v_lshlrev_b32 v18, 4, v17
    v_mad_u32_u24 v12, v16, s9, v18
    v_add_u32 v14, s11, v12
    v_add_u32 v12, s8, v12
    v_add_u32 v11, s8, v18
    v_cmp_gt_u32 vcc, 3, v16
    s_nop 0
    s_nop 0
    v_cndmask_b32 v19, 12, 4, vcc
    v_cmp_eq_u32 vcc, 3, v16
    s_nop 1
    v_cndmask_b32 v19, v19, 28, vcc
    v_mad_u32_u24 v13, v19, s9, v12
    v_and_b32_e64 v20, 3, v16
    s_sub_u32 s11, s11, 17408
    s_lshl_b32 s4, s58, 2
    v_mov_b32 v4, s4
    v_mov_b32 v5, 1
    v_lshlrev_b32 v6, 2, v20
    s_movk_i32 s9, 2368
    v_lshrrev_b32 v18, 2, v0
    v_lshl_add_u32 v19, v20, 3, s8
    v_mad_u32_u24 v200, v18, s9, v19
    s_movk_i32 s4, 160
    v_mad_u32_u24 v202, v18, s4, v19
    v_lshrrev_b32 v18, 3, v0
    v_and_b32_e64 v19, 7, v0
    v_lshl_add_u32 v19, v19, 3, s8
    v_mad_u32_u24 v201, v18, s9, v19
    v_lshrrev_b32 v18, 5, v0
    v_lshlrev_b32 v18, 8, v18
    v_lshl_add_u32 v18, v16, 4, v18
    v_add_u32 v18, s8, v18
    v_and_b32 v19, 1, v17
    v_lshl_add_u32 v203, v19, 3, v18
    v_lshl_add_u32 v46, v19, 9, v18
    v_and_b32 v18, 1, v16
    s_movk_i32 s4, 640
    v_mul_u32_u24_e64 v18, s4, v18
    v_lshl_add_u32 v18, v17, 5, v18
    v_and_b32_e64 v19, 14, v16
    v_add3_u32 v47, v18, v19, s8
    v_mov_b32 v35, s8
    v_mov_b32 v252, 0
    v_mov_b32 v253, 0
    v_lshlrev_b32 v7, 4, v17
    v_lshlrev_b32 v18, 5, v16
    v_sub_u32 v7, v7, v18
    s_add_u32 s4, s10, 480
    v_add_u32 v7, s4, v7
    s_lshl_b32 s4, s58, 13
    s_add_u32 s4, s4, 17408
    v_lshlrev_b32_e64 v18, 6, v16
    v_bfe_u32 v22, v16, 1, 2
    v_xor_b32_e64 v22, v22, v17
    v_lshl_add_u32 v18, v22, 4, v18
    v_add_u32 v8, s4, v18
    v_sub_u32 v22, 20, v16
    v_lshlrev_b32_e64 v23, 3, v17
    v_mov_b32 v24, 0x7f
    v_lshlrev_b32 v24, v22, v24
    v_subrev_u32 v22, 1, v22
    v_mov_b32 v25, 0x1ff
    v_lshlrev_b32 v25, v22, v25
    v_lshrrev_b32 v24, v23, v24
    v_lshrrev_b32 v25, v23, v25
    v_add_u32 v18, 1, v16
    v_and_b32 v22, 3, v18
    v_and_b32 v18, 28, v18
    v_lshl_add_u32 v26, v17, 3, v18
    v_lshl_add_u32 v26, v26, 1, s8
    v_mad_u32_u24 v1, v22, s9, v26
    v_lshlrev_b32 v26, 2, v17
    v_sub_u32 v18, v18, v26
    v_lshl_add_u32 v18, v18, 1, s8
    s_movk_i32 s4, 160
    v_mad_u32_u24 v2, v22, s4, v18
    s_mov_b32 s15, 0x3f800000
    v_bfe_i32 v27, v24, 0, 1
    v_bfe_i32 v28, v24, 1, 1
    v_and_b32 v27, 0x3f80, v27
    v_bfi_b32 v244, s15, v28, v27
    v_bfe_i32 v27, v24, 2, 1
    v_bfe_i32 v28, v24, 3, 1
    v_and_b32 v27, 0x3f80, v27
    v_bfi_b32 v245, s15, v28, v27
    v_bfe_i32 v27, v24, 4, 1
    v_bfe_i32 v28, v24, 5, 1
    v_and_b32 v27, 0x3f80, v27
    v_bfi_b32 v246, s15, v28, v27
    v_bfe_i32 v27, v24, 6, 1
    v_bfe_i32 v28, v24, 7, 1
    v_and_b32 v27, 0x3f80, v27
    v_bfi_b32 v247, s15, v28, v27
    v_bfe_i32 v27, v25, 0, 1
    v_bfe_i32 v28, v25, 1, 1
    v_and_b32 v27, 0x3f80, v27
    v_bfi_b32 v248, s15, v28, v27
    v_bfe_i32 v27, v25, 2, 1
    v_bfe_i32 v28, v25, 3, 1
    v_and_b32 v27, 0x3f80, v27
    v_bfi_b32 v249, s15, v28, v27
    v_bfe_i32 v27, v25, 4, 1
    v_bfe_i32 v28, v25, 5, 1
    v_and_b32 v27, 0x3f80, v27
    v_bfi_b32 v250, s15, v28, v27
    v_bfe_i32 v27, v25, 6, 1
    v_bfe_i32 v28, v25, 7, 1
    v_and_b32 v27, 0x3f80, v27
    v_bfi_b32 v251, s15, v28, v27
    v_lshlrev_b32 v33, 4, v10
    v_lshlrev_b32 v32, 2, v10
    v_sub_u32 v32, 122876, v32
    s_mov_b32 s31, s59
    s_lshl_b32 s13, s57, 14
    s_add_u32 s13, s13, 3145728
    s_and_b32 s12, s2, 7
    s_lshl_b32 s12, s12, 12
    s_lshl_b32 s4, s58, 7
    s_add_u32 s12, s12, s4
    s_lshr_b32 s4, s2, 3
    s_lshl_b32 s4, s4, 2
    s_add_u32 s12, s12, s4
    s_add_u32 s12, s12, 983040
    v_and_b32 v9, 0x30, v10
    v_lshlrev_b32 v10, 3, v10
    v_xor_b32 v9, v9, v10
    v_add_u32 v9, 17408, v9
    s_mov_b32 s30, 0
    s_brev_b32 s68, 1
    s_mov_b32 s32, s13
    s_add_u32 s33, s13, 0x1000
    s_add_u32 s34, s13, 0x2000
    s_add_u32 s35, s13, 0x3000
    s_waitcnt lgkmcnt(0)
    s_lshl_b32 s4, s58, 4
    s_lshr_b64 s[6:7], s[64:65], s4
    s_lshl_b32 s6, s6, 16
    v_mov_b32 v228, s6
    v_mul_f32 v228, 0x3fb8aa3b, v228
    v_exp_f32 v228, v228
    s_nop 0
    v_cvt_pk_bf16_f32 v228, v228, v228
    v_and_b32 v228, 0xffff0000, v228
    s_lshl_b32 s4, s58, 12
    v_lshl_add_u32 v254, v0, 7, s4
    s_waitcnt vmcnt(0)
    s_mov_b32 exec_hi, 0
    buffer_load_dword v255, v254, s[44:47], s13 offen
    s_mov_b32 exec_hi, -1
    v_lshlrev_b32_e64 v236, 16, v224
    v_and_b32 v237, 0xffff0000, v224
    v_lshlrev_b32_e64 v238, 16, v225
    v_and_b32 v239, 0xffff0000, v225
    v_mul_f32 v236, 0x3fb8aa3b, v236
    v_mul_f32 v237, 0x3fb8aa3b, v237
    v_exp_f32 v236, v236
    v_exp_f32 v237, v237
    v_mul_f32 v238, v238, v228
    v_mul_f32 v239, v239, v228
    v_mul_f32 v232, 0x3e22f983, v238
    v_mul_f32 v233, 0x3e22f983, v239
    v_cvt_pk_bf16_f32 v238, v236, v237
    v_lshlrev_b32_e64 v236, 16, v238
    v_and_b32 v237, 0xffff0000, v238
    v_mul_f32 v236, v236, v228
    v_mul_f32 v237, v237, v228
    v_mul_f32 v230, 0xbfb8aa3b, v236
    v_mul_f32 v231, 0xbfb8aa3b, v237
    v_add_f32_e64 v228, v228, v228
    v_mul_f32 v28, 0x42000000, v230
    v_mul_f32 v30, 0x42000000, v232
    v_mul_f32 v29, 0x42000000, v231
    v_mul_f32 v31, 0x42000000, v233
    v_exp_f32 v20, v230
    v_fract_f32 v22, v232
    v_exp_f32 v28, v28
    v_fract_f32 v30, v30
    v_exp_f32 v21, v231
    v_fract_f32 v23, v233
    v_exp_f32 v29, v29
    v_fract_f32 v31, v31
    v_cos_f32 v16, v22
    v_lshlrev_b32 v240, 16, v226
    v_sin_f32_e64 v17, v22
    v_and_b32 v242, 0xffff0000, v226
    v_cos_f32 v18, v23
    v_lshlrev_b32 v241, 16, v227
    v_sin_f32_e64 v19, v23
    v_and_b32 v243, 0xffff0000, v227
    v_cos_f32 v24, v30
    v_mul_f32 v240, v240, v228
    v_sin_f32 v25, v30
    v_mul_f32 v241, v241, v228
    v_cos_f32 v26, v31
    v_mul_f32 v242, v242, v228
    v_sin_f32 v27, v31
    v_mul_f32 v243, v243, v228
    v_mul_f32 v16, v16, v20
    v_mul_f32 v17, v17, v20
    v_mul_f32 v18, v18, v21
    v_mul_f32 v19, v19, v21
    v_mul_f32 v24, v24, v28
    v_mul_f32 v25, v25, v28
    v_mul_f32 v26, v26, v29
    v_mul_f32 v27, v27, v29
    v_mov_b32 v112, 0x3c00
    v_mov_b32 v113, 0x3c00
    v_pk_mul_f32 v[20:21], v[16:17], v[16:17] op_sel_hi:[1,0]
    v_pk_mul_f32 v[22:23], v[18:19], v[18:19] op_sel_hi:[1,0]
    v_pk_mul_f32 v[28:29], v[24:25], v[24:25] op_sel_hi:[1,0]
    v_pk_mul_f32 v[30:31], v[26:27], v[26:27] op_sel_hi:[1,0]
    v_cvt_pk_f16_f32 v114, v16, v17
    v_cvt_pk_f16_f32 v115, v18, v19
    v_cvt_pk_f16_f32 v40, v24, v25
    v_cvt_pk_f16_f32 v41, v26, v27
    v_pk_fma_f32 v[16:17], v[16:17], v[16:17], v[20:21] op_sel:[1,1,0] op_sel_hi:[0,1,1] neg_lo:[1,0,0]
    v_pk_fma_f32 v[18:19], v[18:19], v[18:19], v[22:23] op_sel:[1,1,0] op_sel_hi:[0,1,1] neg_lo:[1,0,0]
    v_pk_fma_f32 v[24:25], v[24:25], v[24:25], v[28:29] op_sel:[1,1,0] op_sel_hi:[0,1,1] neg_lo:[1,0,0]
    v_pk_fma_f32 v[26:27], v[26:27], v[26:27], v[30:31] op_sel:[1,1,0] op_sel_hi:[0,1,1] neg_lo:[1,0,0]
    v_pk_mul_f32 v[20:21], v[16:17], v[16:17] op_sel_hi:[1,0]
    v_pk_mul_f32 v[22:23], v[18:19], v[18:19] op_sel_hi:[1,0]
    v_pk_mul_f32 v[28:29], v[24:25], v[24:25] op_sel_hi:[1,0]
    v_pk_mul_f32 v[30:31], v[26:27], v[26:27] op_sel_hi:[1,0]
    v_cvt_pk_f16_f32 v116, v16, v17
    v_cvt_pk_f16_f32 v117, v18, v19
    v_cvt_pk_f16_f32 v42, v24, v25
    v_cvt_pk_f16_f32 v43, v26, v27
    v_pk_fma_f32 v[16:17], v[16:17], v[16:17], v[20:21] op_sel:[1,1,0] op_sel_hi:[0,1,1] neg_lo:[1,0,0]
    v_pk_fma_f32 v[18:19], v[18:19], v[18:19], v[22:23] op_sel:[1,1,0] op_sel_hi:[0,1,1] neg_lo:[1,0,0]
    v_pk_fma_f32 v[24:25], v[24:25], v[24:25], v[28:29] op_sel:[1,1,0] op_sel_hi:[0,1,1] neg_lo:[1,0,0]
    v_pk_fma_f32 v[26:27], v[26:27], v[26:27], v[30:31] op_sel:[1,1,0] op_sel_hi:[0,1,1] neg_lo:[1,0,0]
    v_cvt_pk_f16_f32 v80, v240, -v241
    v_cvt_pk_f16_f32 v81, v242, -v243
    v_pk_mul_f32 v[20:21], v[16:17], v[16:17] op_sel_hi:[1,0]
    v_pk_mul_f32 v[22:23], v[18:19], v[18:19] op_sel_hi:[1,0]
    v_pk_mul_f32 v[28:29], v[24:25], v[24:25] op_sel_hi:[1,0]
    v_pk_mul_f32 v[30:31], v[26:27], v[26:27] op_sel_hi:[1,0]
    v_cvt_pk_f16_f32 v120, v16, v17
    v_cvt_pk_f16_f32 v121, v18, v19
    v_cvt_pk_f16_f32 v44, v24, v25
    v_cvt_pk_f16_f32 v45, v26, v27
    v_pk_fma_f32 v[16:17], v[16:17], v[16:17], v[20:21] op_sel:[1,1,0] op_sel_hi:[0,1,1] neg_lo:[1,0,0]
    v_pk_fma_f32 v[18:19], v[18:19], v[18:19], v[22:23] op_sel:[1,1,0] op_sel_hi:[0,1,1] neg_lo:[1,0,0]
    v_pk_fma_f32 v[24:25], v[24:25], v[24:25], v[28:29] op_sel:[1,1,0] op_sel_hi:[0,1,1] neg_lo:[1,0,0]
    v_pk_fma_f32 v[26:27], v[26:27], v[26:27], v[30:31] op_sel:[1,1,0] op_sel_hi:[0,1,1] neg_lo:[1,0,0]
    v_pk_mul_f16 v118, v116, v114 op_sel_hi:[1,0]
    v_pk_mul_f16 v119, v117, v115 op_sel_hi:[1,0]
    v_pk_mul_f16 v122, v120, v114 op_sel_hi:[1,0]
    v_pk_mul_f16 v123, v121, v115 op_sel_hi:[1,0]
    v_pk_fma_f16 v118, v116, v114, v118 op_sel:[1,1,0] op_sel_hi:[0,1,1] neg_lo:[1,0,0]
    v_pk_fma_f16 v119, v117, v115, v119 op_sel:[1,1,0] op_sel_hi:[0,1,1] neg_lo:[1,0,0]
    v_pk_fma_f16 v122, v120, v114, v122 op_sel:[1,1,0] op_sel_hi:[0,1,1] neg_lo:[1,0,0]
    v_pk_fma_f16 v123, v121, v115, v123 op_sel:[1,1,0] op_sel_hi:[0,1,1] neg_lo:[1,0,0]
    v_pk_mul_f32 v[20:21], v[16:17], v[16:17] op_sel_hi:[1,0]
    v_pk_mul_f32 v[22:23], v[18:19], v[18:19] op_sel_hi:[1,0]
    v_cvt_pk_f16_f32 v128, v16, v17
    v_cvt_pk_f16_f32 v129, v18, v19
    v_cvt_pk_f16_f32 v134, v24, v25
    v_cvt_pk_f16_f32 v135, v26, v27
    v_pk_fma_f32 v[16:17], v[16:17], v[16:17], v[20:21] op_sel:[1,1,0] op_sel_hi:[0,1,1] neg_lo:[1,0,0]
    v_pk_fma_f32 v[18:19], v[18:19], v[18:19], v[22:23] op_sel:[1,1,0] op_sel_hi:[0,1,1] neg_lo:[1,0,0]
    ds_write_addtid_b32 v112 offset:48064
    ds_write_addtid_b32 v113 offset:48320
    ds_write_addtid_b32 v114 offset:48608
    ds_write_addtid_b32 v115 offset:48864
    ds_write_addtid_b32 v116 offset:49152
    ds_write_addtid_b32 v117 offset:49408
    ds_write_addtid_b32 v120 offset:50240
    ds_write_addtid_b32 v121 offset:50496
    ds_write_addtid_b32 v118 offset:49696
    ds_write_addtid_b32 v119 offset:49952
    ds_write_addtid_b32 v122 offset:50784
    ds_write_addtid_b32 v123 offset:51040
    ds_write_addtid_b32 v128 offset:56768
    ds_write_addtid_b32 v129 offset:57024
    ds_write_addtid_b32 v134 offset:52416
    ds_write_addtid_b32 v135 offset:52672
    ds_write_addtid_b32 v44 offset:63296
    ds_write_addtid_b32 v45 offset:63552
    v_pk_mul_f16 v124, v120, v116 op_sel_hi:[1,0]
    v_pk_mul_f16 v125, v121, v117 op_sel_hi:[1,0]
    v_pk_mul_f16 v126, v120, v118 op_sel_hi:[1,0]
    v_pk_mul_f16 v127, v121, v119 op_sel_hi:[1,0]
    v_pk_fma_f16 v124, v120, v116, v124 op_sel:[1,1,0] op_sel_hi:[0,1,1] neg_lo:[1,0,0]
    v_pk_fma_f16 v125, v121, v117, v125 op_sel:[1,1,0] op_sel_hi:[0,1,1] neg_lo:[1,0,0]
    v_pk_fma_f16 v126, v120, v118, v126 op_sel:[1,1,0] op_sel_hi:[0,1,1] neg_lo:[1,0,0]
    v_pk_fma_f16 v127, v121, v119, v127 op_sel:[1,1,0] op_sel_hi:[0,1,1] neg_lo:[1,0,0]
    v_pk_mul_f16 v132, v128, v116 op_sel_hi:[1,0]
    v_pk_mul_f16 v133, v129, v117 op_sel_hi:[1,0]
    v_pk_mul_f16 v136, v134, v116 op_sel_hi:[1,0]
    v_pk_mul_f16 v137, v135, v117 op_sel_hi:[1,0]
    v_pk_fma_f16 v132, v128, v116, v132 op_sel:[1,1,0] op_sel_hi:[0,1,1] neg_lo:[1,0,0]
    v_pk_fma_f16 v133, v129, v117, v133 op_sel:[1,1,0] op_sel_hi:[0,1,1] neg_lo:[1,0,0]
    v_pk_fma_f16 v136, v134, v116, v136 op_sel:[1,1,0] op_sel_hi:[0,1,1] neg_lo:[1,0,0]
    v_pk_fma_f16 v137, v135, v117, v137 op_sel:[1,1,0] op_sel_hi:[0,1,1] neg_lo:[1,0,0]
    v_pk_mul_f16 v138, v134, v120 op_sel_hi:[1,0]
    v_pk_mul_f16 v139, v135, v121 op_sel_hi:[1,0]
    v_pk_mul_f16 v140, v134, v124 op_sel_hi:[1,0]
    v_pk_mul_f16 v141, v135, v125 op_sel_hi:[1,0]
    v_pk_fma_f16 v138, v134, v120, v138 op_sel:[1,1,0] op_sel_hi:[0,1,1] neg_lo:[1,0,0]
    v_pk_fma_f16 v139, v135, v121, v139 op_sel:[1,1,0] op_sel_hi:[0,1,1] neg_lo:[1,0,0]
    v_pk_fma_f16 v140, v134, v124, v140 op_sel:[1,1,0] op_sel_hi:[0,1,1] neg_lo:[1,0,0]
    v_pk_fma_f16 v141, v135, v125, v141 op_sel:[1,1,0] op_sel_hi:[0,1,1] neg_lo:[1,0,0]
    v_pk_mul_f16 v142, v134, v128 op_sel_hi:[1,0]
    v_pk_mul_f16 v143, v135, v129 op_sel_hi:[1,0]
    v_pk_mul_f16 v144, v134, v132 op_sel_hi:[1,0]
    v_pk_mul_f16 v145, v135, v133 op_sel_hi:[1,0]
    v_pk_fma_f16 v142, v134, v128, v142 op_sel:[1,1,0] op_sel_hi:[0,1,1] neg_lo:[1,0,0]
    v_pk_fma_f16 v143, v135, v129, v143 op_sel:[1,1,0] op_sel_hi:[0,1,1] neg_lo:[1,0,0]
    v_pk_fma_f16 v144, v134, v132, v144 op_sel:[1,1,0] op_sel_hi:[0,1,1] neg_lo:[1,0,0]
    v_pk_fma_f16 v145, v135, v133, v145 op_sel:[1,1,0] op_sel_hi:[0,1,1] neg_lo:[1,0,0]
    ds_write_addtid_b32 v124 offset:51328
    ds_write_addtid_b32 v125 offset:51584
    ds_write_addtid_b32 v126 offset:51872
    ds_write_addtid_b32 v127 offset:52128
    ds_write_addtid_b32 v132 offset:57856
    ds_write_addtid_b32 v133 offset:58112
    ds_write_addtid_b32 v136 offset:52960
    ds_write_addtid_b32 v137 offset:53216
    ds_write_addtid_b32 v138 offset:53504
    ds_write_addtid_b32 v139 offset:53760
    ds_write_addtid_b32 v138 offset:54592
    ds_write_addtid_b32 v139 offset:54848
    ds_write_addtid_b32 v140 offset:54048
    ds_write_addtid_b32 v141 offset:54304
    ds_write_addtid_b32 v140 offset:55136
    ds_write_addtid_b32 v141 offset:55392
    ds_write_addtid_b32 v142 offset:55680
    ds_write_addtid_b32 v143 offset:55936
    ds_write_addtid_b32 v144 offset:56224
    ds_write_addtid_b32 v145 offset:56480
    ds_read_b128 v[168:171], v12 offset:0
    ds_read_b128 v[172:175], v12 offset:64
    ds_read_b128 v[176:179], v12 offset:128
    ds_read_b128 v[180:183], v12 offset:192
    ds_read_b128 v[184:187], v12 offset:256
    ds_read_b128 v[188:191], v12 offset:320
    ds_read_b128 v[192:195], v12 offset:384
    ds_read_b128 v[196:199], v12 offset:448
    s_mov_b32 m0, s11
    s_nop 0
    v_cvt_pk_f16_f32 v38, v16, v17
    v_cvt_pk_f16_f32 v39, v18, v19
    v_pk_mul_f16 v82, v80, v128 op_sel_hi:[1,0]
    v_pk_mul_f16 v83, v81, v129 op_sel_hi:[1,0]
    v_pk_mul_f16 v88, v80, v40 op_sel_hi:[1,0]
    v_pk_mul_f16 v89, v81, v41 op_sel_hi:[1,0]
    v_pk_fma_f16 v82, v80, v128, v82 op_sel:[1,1,0] op_sel_hi:[0,1,1] neg_hi:[1,0,0]
    v_pk_fma_f16 v83, v81, v129, v83 op_sel:[1,1,0] op_sel_hi:[0,1,1] neg_hi:[1,0,0]
    v_pk_fma_f16 v88, v80, v40, v88 op_sel:[1,1,0] op_sel_hi:[0,1,1] neg_hi:[1,0,0]
    v_pk_fma_f16 v89, v81, v41, v89 op_sel:[1,1,0] op_sel_hi:[0,1,1] neg_hi:[1,0,0]
    v_pk_mul_f16 v84, v80, v38 op_sel_hi:[1,0]
    v_pk_mul_f16 v85, v81, v39 op_sel_hi:[1,0]
    v_pk_mul_f16 v86, v82, v38 op_sel_hi:[1,0]
    v_pk_mul_f16 v87, v83, v39 op_sel_hi:[1,0]
    v_pk_fma_f16 v84, v80, v38, v84 op_sel:[1,1,0] op_sel_hi:[0,1,1] neg_hi:[1,0,0]
    v_pk_fma_f16 v85, v81, v39, v85 op_sel:[1,1,0] op_sel_hi:[0,1,1] neg_hi:[1,0,0]
    v_pk_fma_f16 v86, v82, v38, v86 op_sel:[1,1,0] op_sel_hi:[0,1,1] neg_hi:[1,0,0]
    v_pk_fma_f16 v87, v83, v39, v87 op_sel:[1,1,0] op_sel_hi:[0,1,1] neg_hi:[1,0,0]
    v_pk_mul_f16 v90, v82, v40 op_sel_hi:[1,0]
    v_pk_mul_f16 v91, v83, v41 op_sel_hi:[1,0]
    v_pk_mul_f16 v96, v80, v42 op_sel_hi:[1,0]
    v_pk_mul_f16 v97, v81, v43 op_sel_hi:[1,0]
    v_pk_fma_f16 v90, v82, v40, v90 op_sel:[1,1,0] op_sel_hi:[0,1,1] neg_hi:[1,0,0]
    v_pk_fma_f16 v91, v83, v41, v91 op_sel:[1,1,0] op_sel_hi:[0,1,1] neg_hi:[1,0,0]
    v_pk_fma_f16 v96, v80, v42, v96 op_sel:[1,1,0] op_sel_hi:[0,1,1] neg_hi:[1,0,0]
    v_pk_fma_f16 v97, v81, v43, v97 op_sel:[1,1,0] op_sel_hi:[0,1,1] neg_hi:[1,0,0]
    v_pk_mul_f16 v92, v84, v40 op_sel_hi:[1,0]
    v_pk_mul_f16 v93, v85, v41 op_sel_hi:[1,0]
    v_pk_mul_f16 v94, v86, v40 op_sel_hi:[1,0]
    v_pk_mul_f16 v95, v87, v41 op_sel_hi:[1,0]
    v_pk_fma_f16 v92, v84, v40, v92 op_sel:[1,1,0] op_sel_hi:[0,1,1] neg_hi:[1,0,0]
    v_pk_fma_f16 v93, v85, v41, v93 op_sel:[1,1,0] op_sel_hi:[0,1,1] neg_hi:[1,0,0]
    v_pk_fma_f16 v94, v86, v40, v94 op_sel:[1,1,0] op_sel_hi:[0,1,1] neg_hi:[1,0,0]
    v_pk_fma_f16 v95, v87, v41, v95 op_sel:[1,1,0] op_sel_hi:[0,1,1] neg_hi:[1,0,0]
    ds_write_addtid_b32 v80 offset:17408
    ds_write_addtid_b32 v81 offset:17664
    ds_write_addtid_b32 v82 offset:17952
    ds_write_addtid_b32 v83 offset:18208
    ds_write_addtid_b32 v84 offset:18496
    ds_write_addtid_b32 v85 offset:18752
    ds_write_addtid_b32 v86 offset:19040
    ds_write_addtid_b32 v87 offset:19296
    ds_write_addtid_b32 v88 offset:19584
    ds_write_addtid_b32 v89 offset:19840
    ds_write_addtid_b32 v90 offset:20128
    ds_write_addtid_b32 v91 offset:20384
    ds_write_addtid_b32 v92 offset:20672
    ds_write_addtid_b32 v93 offset:20928
    ds_write_addtid_b32 v94 offset:21216
    ds_write_addtid_b32 v95 offset:21472
    ds_write_addtid_b32 v96 offset:21760
    ds_write_addtid_b32 v97 offset:22016
    v_pk_mul_f16 v98, v82, v42 op_sel_hi:[1,0]
    v_pk_mul_f16 v99, v83, v43 op_sel_hi:[1,0]
    v_pk_mul_f16 v104, v88, v42 op_sel_hi:[1,0]
    v_pk_mul_f16 v105, v89, v43 op_sel_hi:[1,0]
    v_pk_fma_f16 v98, v82, v42, v98 op_sel:[1,1,0] op_sel_hi:[0,1,1] neg_hi:[1,0,0]
    v_pk_fma_f16 v99, v83, v43, v99 op_sel:[1,1,0] op_sel_hi:[0,1,1] neg_hi:[1,0,0]
    v_pk_fma_f16 v104, v88, v42, v104 op_sel:[1,1,0] op_sel_hi:[0,1,1] neg_hi:[1,0,0]
    v_pk_fma_f16 v105, v89, v43, v105 op_sel:[1,1,0] op_sel_hi:[0,1,1] neg_hi:[1,0,0]
    v_pk_mul_f16 v100, v84, v42 op_sel_hi:[1,0]
    v_pk_mul_f16 v101, v85, v43 op_sel_hi:[1,0]
    v_pk_mul_f16 v102, v86, v42 op_sel_hi:[1,0]
    v_pk_mul_f16 v103, v87, v43 op_sel_hi:[1,0]
    v_pk_fma_f16 v100, v84, v42, v100 op_sel:[1,1,0] op_sel_hi:[0,1,1] neg_hi:[1,0,0]
    v_pk_fma_f16 v101, v85, v43, v101 op_sel:[1,1,0] op_sel_hi:[0,1,1] neg_hi:[1,0,0]
    v_pk_fma_f16 v102, v86, v42, v102 op_sel:[1,1,0] op_sel_hi:[0,1,1] neg_hi:[1,0,0]
    v_pk_fma_f16 v103, v87, v43, v103 op_sel:[1,1,0] op_sel_hi:[0,1,1] neg_hi:[1,0,0]
    v_pk_mul_f16 v106, v90, v42 op_sel_hi:[1,0]
    v_pk_mul_f16 v107, v91, v43 op_sel_hi:[1,0]
    v_pk_mul_f16 v108, v92, v42 op_sel_hi:[1,0]
    v_pk_mul_f16 v109, v93, v43 op_sel_hi:[1,0]
    v_pk_fma_f16 v106, v90, v42, v106 op_sel:[1,1,0] op_sel_hi:[0,1,1] neg_hi:[1,0,0]
    v_pk_fma_f16 v107, v91, v43, v107 op_sel:[1,1,0] op_sel_hi:[0,1,1] neg_hi:[1,0,0]
    v_pk_fma_f16 v108, v92, v42, v108 op_sel:[1,1,0] op_sel_hi:[0,1,1] neg_hi:[1,0,0]
    v_pk_fma_f16 v109, v93, v43, v109 op_sel:[1,1,0] op_sel_hi:[0,1,1] neg_hi:[1,0,0]
    v_pk_mul_f16 v110, v94, v42 op_sel_hi:[1,0]
    v_pk_mul_f16 v111, v95, v43 op_sel_hi:[1,0]
    v_pk_mul_f16 v130, v128, v114 op_sel_hi:[1,0]
    v_pk_mul_f16 v131, v129, v115 op_sel_hi:[1,0]
    v_pk_fma_f16 v110, v94, v42, v110 op_sel:[1,1,0] op_sel_hi:[0,1,1] neg_hi:[1,0,0]
    v_pk_fma_f16 v111, v95, v43, v111 op_sel:[1,1,0] op_sel_hi:[0,1,1] neg_hi:[1,0,0]
    v_pk_fma_f16 v130, v128, v114, v130 op_sel:[1,1,0] op_sel_hi:[0,1,1] neg_lo:[1,0,0]
    v_pk_fma_f16 v131, v129, v115, v131 op_sel:[1,1,0] op_sel_hi:[0,1,1] neg_lo:[1,0,0]
    ds_write_addtid_b32 v98 offset:22304
    ds_write_addtid_b32 v99 offset:22560
    ds_write_addtid_b32 v100 offset:22848
    ds_write_addtid_b32 v101 offset:23104
    ds_write_addtid_b32 v102 offset:23392
    ds_write_addtid_b32 v103 offset:23648
    ds_write_addtid_b32 v104 offset:23936
    ds_write_addtid_b32 v105 offset:24192
    ds_write_addtid_b32 v106 offset:24480
    ds_write_addtid_b32 v107 offset:24736
    ds_write_addtid_b32 v108 offset:25024
    ds_write_addtid_b32 v109 offset:25280
    ds_write_addtid_b32 v110 offset:25568
    ds_write_addtid_b32 v111 offset:25824
    ds_read_b128 v[48:51], v14 offset:0
    ds_read_b128 v[52:55], v14 offset:64
    ds_read_b128 v[56:59], v14 offset:128
    ds_read_b128 v[60:63], v14 offset:192
    ds_read_b128 v[64:67], v14 offset:256
    ds_read_b128 v[68:71], v14 offset:320
    ds_read_b128 v[72:75], v14 offset:384
    ds_read_b128 v[76:79], v14 offset:448
    ds_read_b128 v[80:83], v11 offset:15232
    ds_read_b128 v[84:87], v11 offset:15296
    ds_read_b128 v[88:91], v11 offset:15360
    ds_read_b128 v[92:95], v11 offset:15424
    ds_read_b128 v[96:99], v11 offset:15488
    ds_read_b128 v[100:103], v11 offset:15552
    ds_read_b128 v[104:107], v11 offset:15616
    ds_read_b128 v[108:111], v11 offset:15680
    s_sub_u32 m0, s8, 48064
    v_pk_mul_f32 v[28:29], v[24:25], v[24:25] op_sel_hi:[1,0]
    v_pk_mul_f32 v[30:31], v[26:27], v[26:27] op_sel_hi:[1,0]
    v_pk_fma_f32 v[24:25], v[24:25], v[24:25], v[28:29] op_sel:[1,1,0] op_sel_hi:[0,1,1] neg_lo:[1,0,0]
    v_pk_fma_f32 v[26:27], v[26:27], v[26:27], v[30:31] op_sel:[1,1,0] op_sel_hi:[0,1,1] neg_lo:[1,0,0]
    v_cvt_pk_f16_f32 v146, v24, v25
    v_cvt_pk_f16_f32 v147, v26, v27
    v_pk_mul_f32 v[28:29], v[24:25], v[24:25] op_sel_hi:[1,0]
    v_pk_mul_f32 v[30:31], v[26:27], v[26:27] op_sel_hi:[1,0]
    v_pk_fma_f32 v[24:25], v[24:25], v[24:25], v[28:29] op_sel:[1,1,0] op_sel_hi:[0,1,1] neg_lo:[1,0,0]
    v_pk_fma_f32 v[26:27], v[26:27], v[26:27], v[30:31] op_sel:[1,1,0] op_sel_hi:[0,1,1] neg_lo:[1,0,0]
    v_cvt_pk_f16_f32 v166, v24, v25
    v_cvt_pk_f16_f32 v167, v26, v27
    s_waitcnt lgkmcnt(8)
    s_nop 0
    v_mfma_f32_16x16x32_f16 v[204:207], v[168:171], v[48:51], 0
    v_pk_mul_f16 v152, v146, v134 op_sel_hi:[1,0]
    v_pk_mul_f16 v153, v147, v135 op_sel_hi:[1,0]
    v_pk_mul_f16 v148, v146, v120 op_sel_hi:[1,0]
    v_pk_mul_f16 v149, v147, v121 op_sel_hi:[1,0]
    v_mfma_f32_16x16x32_f16 v[204:207], v[172:175], v[52:55], v[204:207]
    v_pk_fma_f16 v152, v146, v134, v152 op_sel:[1,1,0] op_sel_hi:[0,1,1] neg_lo:[1,0,0]
    v_pk_fma_f16 v153, v147, v135, v153 op_sel:[1,1,0] op_sel_hi:[0,1,1] neg_lo:[1,0,0]
    v_pk_fma_f16 v148, v146, v120, v148 op_sel:[1,1,0] op_sel_hi:[0,1,1] neg_lo:[1,0,0]
    v_pk_fma_f16 v149, v147, v121, v149 op_sel:[1,1,0] op_sel_hi:[0,1,1] neg_lo:[1,0,0]
    v_mfma_f32_16x16x32_f16 v[204:207], v[176:179], v[56:59], v[204:207]
    v_pk_mul_f16 v150, v146, v128 op_sel_hi:[1,0]
    v_pk_mul_f16 v151, v147, v129 op_sel_hi:[1,0]
    v_pk_mul_f16 v158, v128, v166 op_sel_hi:[1,0]
    v_pk_mul_f16 v159, v129, v167 op_sel_hi:[1,0]
    v_mfma_f32_16x16x32_f16 v[204:207], v[180:183], v[60:63], v[204:207]
    v_pk_fma_f16 v150, v146, v128, v150 op_sel:[1,1,0] op_sel_hi:[0,1,1] neg_lo:[1,0,0]
    v_pk_fma_f16 v151, v147, v129, v151 op_sel:[1,1,0] op_sel_hi:[0,1,1] neg_lo:[1,0,0]
    v_pk_fma_f16 v158, v128, v166, v158 op_sel:[1,1,0] op_sel_hi:[0,1,1] neg_lo:[1,0,0]
    v_pk_fma_f16 v159, v129, v167, v159 op_sel:[1,1,0] op_sel_hi:[0,1,1] neg_lo:[1,0,0]
    v_mfma_f32_16x16x32_f16 v[204:207], v[184:187], v[64:67], v[204:207]
    v_pk_mul_f16 v154, v152, v120 op_sel_hi:[1,0]
    v_pk_mul_f16 v155, v153, v121 op_sel_hi:[1,0]
    v_pk_mul_f16 v156, v152, v128 op_sel_hi:[1,0]
    v_pk_mul_f16 v157, v153, v129 op_sel_hi:[1,0]
    v_mfma_f32_16x16x32_f16 v[204:207], v[188:191], v[68:71], v[204:207]
    v_pk_fma_f16 v154, v152, v120, v154 op_sel:[1,1,0] op_sel_hi:[0,1,1] neg_lo:[1,0,0]
    v_pk_fma_f16 v155, v153, v121, v155 op_sel:[1,1,0] op_sel_hi:[0,1,1] neg_lo:[1,0,0]
    v_pk_fma_f16 v156, v152, v128, v156 op_sel:[1,1,0] op_sel_hi:[0,1,1] neg_lo:[1,0,0]
    v_pk_fma_f16 v157, v153, v129, v157 op_sel:[1,1,0] op_sel_hi:[0,1,1] neg_lo:[1,0,0]
    v_mfma_f32_16x16x32_f16 v[204:207], v[192:195], v[72:75], v[204:207]
    v_pk_mul_f16 v160, v142, v166 op_sel_hi:[1,0]
    v_pk_mul_f16 v161, v143, v167 op_sel_hi:[1,0]
    v_pk_mul_f16 v162, v150, v166 op_sel_hi:[1,0]
    v_pk_mul_f16 v163, v151, v167 op_sel_hi:[1,0]
    v_mfma_f32_16x16x32_f16 v[204:207], v[196:199], v[76:79], v[204:207]
    v_pk_fma_f16 v160, v142, v166, v160 op_sel:[1,1,0] op_sel_hi:[0,1,1] neg_lo:[1,0,0]
    v_pk_fma_f16 v161, v143, v167, v161 op_sel:[1,1,0] op_sel_hi:[0,1,1] neg_lo:[1,0,0]
    v_pk_fma_f16 v162, v150, v166, v162 op_sel:[1,1,0] op_sel_hi:[0,1,1] neg_lo:[1,0,0]
    v_pk_fma_f16 v163, v151, v167, v163 op_sel:[1,1,0] op_sel_hi:[0,1,1] neg_lo:[1,0,0]
    v_pk_mul_f16 v164, v156, v166 op_sel_hi:[1,0]
    v_pk_mul_f16 v165, v157, v167 op_sel_hi:[1,0]
    v_pk_fma_f16 v164, v156, v166, v164 op_sel:[1,1,0] op_sel_hi:[0,1,1] neg_lo:[1,0,0]
    v_pk_fma_f16 v165, v157, v167, v165 op_sel:[1,1,0] op_sel_hi:[0,1,1] neg_lo:[1,0,0]
    ds_write_addtid_b32 v130 offset:57312
    ds_write_addtid_b32 v131 offset:57568
    ds_write_addtid_b32 v146 offset:58944
    ds_write_addtid_b32 v147 offset:59200
    ds_write_addtid_b32 v152 offset:61120
    ds_write_addtid_b32 v153 offset:61376
    ds_write_addtid_b32 v148 offset:59488
    ds_write_addtid_b32 v149 offset:59744
    ds_write_addtid_b32 v150 offset:60032
    ds_write_addtid_b32 v151 offset:60288
    ds_write_addtid_b32 v158 offset:64928
    ds_write_addtid_b32 v159 offset:65184
    ds_write_addtid_b32 v154 offset:61664
    ds_write_addtid_b32 v155 offset:61920
    ds_write_addtid_b32 v156 offset:62208
    ds_write_addtid_b32 v157 offset:62464
    ds_write_addtid_b32 v160 offset:58400
    ds_write_addtid_b32 v161 offset:58656
    ds_write_addtid_b32 v162 offset:60576
    ds_write_addtid_b32 v163 offset:60832
    ds_write_addtid_b32 v164 offset:62752
    ds_write_addtid_b32 v165 offset:63008
    ds_read_b128 v[112:115], v13 offset:0
    ds_read_b128 v[116:119], v13 offset:64
    ds_read_b128 v[120:123], v13 offset:128
    ds_read_b128 v[124:127], v13 offset:192
    ds_read_b128 v[128:131], v13 offset:256
    ds_read_b128 v[132:135], v13 offset:320
    ds_read_b128 v[136:139], v13 offset:384
    ds_read_b128 v[140:143], v13 offset:448
    s_mov_b64 exec, 0xffff
    ds_write_b64 v200, v[252:253]
    s_mov_b32 exec_lo, -1
    ds_write_b64 v201, v[252:253] offset:2080
    ds_write_b64 v202, v[252:253] offset:9472
    s_mov_b64 exec, -1
    ds_read_b32 v34, v6 offset:128
    s_buffer_load_dwordx8 s[16:23], s[44:47], s31
L_XI1:
    v_pk_mul_f16 v220, v48, v80 op_sel_hi:[1,0]
    v_pk_mul_f16 v221, v49, v81 op_sel_hi:[1,0]
    v_pk_mul_f16 v222, v50, v82 op_sel_hi:[1,0]
    v_pk_mul_f16 v223, v51, v83 op_sel_hi:[1,0]
    v_pk_fma_f16 v80, v48, v80, v220 op_sel:[1,1,0] op_sel_hi:[0,1,1] neg_hi:[1,0,0]
    v_pk_fma_f16 v81, v49, v81, v221 op_sel:[1,1,0] op_sel_hi:[0,1,1] neg_hi:[1,0,0]
    v_pk_fma_f16 v82, v50, v82, v222 op_sel:[1,1,0] op_sel_hi:[0,1,1] neg_hi:[1,0,0]
    v_pk_fma_f16 v83, v51, v83, v223 op_sel:[1,1,0] op_sel_hi:[0,1,1] neg_hi:[1,0,0]
    v_pk_mul_f16 v220, v52, v84 op_sel_hi:[1,0]
    v_pk_mul_f16 v221, v53, v85 op_sel_hi:[1,0]
    v_mfma_f32_16x16x32_f16 v[208:211], v[168:171], v[80:83], 0
    v_pk_mul_f16 v222, v54, v86 op_sel_hi:[1,0]
    v_pk_mul_f16 v223, v55, v87 op_sel_hi:[1,0]
    v_pk_fma_f16 v84, v52, v84, v220 op_sel:[1,1,0] op_sel_hi:[0,1,1] neg_hi:[1,0,0]
    v_pk_fma_f16 v85, v53, v85, v221 op_sel:[1,1,0] op_sel_hi:[0,1,1] neg_hi:[1,0,0]
    v_pk_fma_f16 v86, v54, v86, v222 op_sel:[1,1,0] op_sel_hi:[0,1,1] neg_hi:[1,0,0]
    v_pk_fma_f16 v87, v55, v87, v223 op_sel:[1,1,0] op_sel_hi:[0,1,1] neg_hi:[1,0,0]
    s_waitcnt lgkmcnt(9)
    s_nop 0
    v_pk_mul_f16 v220, v56, v88 op_sel_hi:[1,0]
    v_pk_mul_f16 v221, v57, v89 op_sel_hi:[1,0]
    v_mfma_f32_16x16x32_f16 v[208:211], v[172:175], v[84:87], v[208:211]
    v_pk_mul_f16 v222, v58, v90 op_sel_hi:[1,0]
    v_pk_mul_f16 v223, v59, v91 op_sel_hi:[1,0]
    v_pk_fma_f16 v88, v56, v88, v220 op_sel:[1,1,0] op_sel_hi:[0,1,1] neg_hi:[1,0,0]
    v_mfma_f32_16x16x32_f16 v[212:215], v[112:115], v[48:51], 0
    v_pk_fma_f16 v89, v57, v89, v221 op_sel:[1,1,0] op_sel_hi:[0,1,1] neg_hi:[1,0,0]
    v_pk_fma_f16 v90, v58, v90, v222 op_sel:[1,1,0] op_sel_hi:[0,1,1] neg_hi:[1,0,0]
    v_pk_fma_f16 v91, v59, v91, v223 op_sel:[1,1,0] op_sel_hi:[0,1,1] neg_hi:[1,0,0]
    v_mfma_f32_16x16x32_f16 v[216:219], v[112:115], v[80:83], 0
    v_pk_mul_f16 v220, v60, v92 op_sel_hi:[1,0]
    v_pk_mul_f16 v221, v61, v93 op_sel_hi:[1,0]
    v_mfma_f32_16x16x32_f16 v[208:211], v[176:179], v[88:91], v[208:211]
    v_pk_mul_f16 v222, v62, v94 op_sel_hi:[1,0]
    v_pk_mul_f16 v223, v63, v95 op_sel_hi:[1,0]
    v_pk_fma_f16 v92, v60, v92, v220 op_sel:[1,1,0] op_sel_hi:[0,1,1] neg_hi:[1,0,0]
    v_mfma_f32_16x16x32_f16 v[212:215], v[116:119], v[52:55], v[212:215]
    v_pk_fma_f16 v93, v61, v93, v221 op_sel:[1,1,0] op_sel_hi:[0,1,1] neg_hi:[1,0,0]
    v_pk_fma_f16 v94, v62, v94, v222 op_sel:[1,1,0] op_sel_hi:[0,1,1] neg_hi:[1,0,0]
    v_pk_fma_f16 v95, v63, v95, v223 op_sel:[1,1,0] op_sel_hi:[0,1,1] neg_hi:[1,0,0]
    v_mfma_f32_16x16x32_f16 v[216:219], v[116:119], v[84:87], v[216:219]
    s_waitcnt lgkmcnt(7)
    s_nop 0
    v_pk_mul_f16 v220, v64, v96 op_sel_hi:[1,0]
    v_pk_mul_f16 v221, v65, v97 op_sel_hi:[1,0]
    v_mfma_f32_16x16x32_f16 v[208:211], v[180:183], v[92:95], v[208:211]
    v_pk_mul_f16 v222, v66, v98 op_sel_hi:[1,0]
    v_pk_mul_f16 v223, v67, v99 op_sel_hi:[1,0]
    v_pk_fma_f16 v96, v64, v96, v220 op_sel:[1,1,0] op_sel_hi:[0,1,1] neg_hi:[1,0,0]
    v_mfma_f32_16x16x32_f16 v[212:215], v[120:123], v[56:59], v[212:215]
    v_pk_fma_f16 v97, v65, v97, v221 op_sel:[1,1,0] op_sel_hi:[0,1,1] neg_hi:[1,0,0]
    v_pk_fma_f16 v98, v66, v98, v222 op_sel:[1,1,0] op_sel_hi:[0,1,1] neg_hi:[1,0,0]
    v_pk_fma_f16 v99, v67, v99, v223 op_sel:[1,1,0] op_sel_hi:[0,1,1] neg_hi:[1,0,0]
    v_mfma_f32_16x16x32_f16 v[216:219], v[120:123], v[88:91], v[216:219]
    v_pk_mul_f16 v220, v68, v100 op_sel_hi:[1,0]
    v_pk_mul_f16 v221, v69, v101 op_sel_hi:[1,0]
    v_mfma_f32_16x16x32_f16 v[208:211], v[184:187], v[96:99], v[208:211]
    v_pk_mul_f16 v222, v70, v102 op_sel_hi:[1,0]
    v_pk_mul_f16 v223, v71, v103 op_sel_hi:[1,0]
    v_pk_fma_f16 v100, v68, v100, v220 op_sel:[1,1,0] op_sel_hi:[0,1,1] neg_hi:[1,0,0]
    v_mfma_f32_16x16x32_f16 v[212:215], v[124:127], v[60:63], v[212:215]
    v_pk_fma_f16 v101, v69, v101, v221 op_sel:[1,1,0] op_sel_hi:[0,1,1] neg_hi:[1,0,0]
    v_pk_fma_f16 v102, v70, v102, v222 op_sel:[1,1,0] op_sel_hi:[0,1,1] neg_hi:[1,0,0]
    v_pk_fma_f16 v103, v71, v103, v223 op_sel:[1,1,0] op_sel_hi:[0,1,1] neg_hi:[1,0,0]
    v_mfma_f32_16x16x32_f16 v[216:219], v[124:127], v[92:95], v[216:219]
    s_waitcnt lgkmcnt(5)
    s_nop 0
    v_pk_mul_f16 v220, v72, v104 op_sel_hi:[1,0]
    v_pk_mul_f16 v221, v73, v105 op_sel_hi:[1,0]
    v_mfma_f32_16x16x32_f16 v[208:211], v[188:191], v[100:103], v[208:211]
    v_pk_mul_f16 v222, v74, v106 op_sel_hi:[1,0]
    v_pk_mul_f16 v223, v75, v107 op_sel_hi:[1,0]
    v_pk_fma_f16 v104, v72, v104, v220 op_sel:[1,1,0] op_sel_hi:[0,1,1] neg_hi:[1,0,0]
    v_mfma_f32_16x16x32_f16 v[212:215], v[128:131], v[64:67], v[212:215]
    v_pk_fma_f16 v105, v73, v105, v221 op_sel:[1,1,0] op_sel_hi:[0,1,1] neg_hi:[1,0,0]
    v_pk_fma_f16 v106, v74, v106, v222 op_sel:[1,1,0] op_sel_hi:[0,1,1] neg_hi:[1,0,0]
    v_pk_fma_f16 v107, v75, v107, v223 op_sel:[1,1,0] op_sel_hi:[0,1,1] neg_hi:[1,0,0]
    v_mfma_f32_16x16x32_f16 v[216:219], v[128:131], v[96:99], v[216:219]
    v_pk_mul_f16 v220, v76, v108 op_sel_hi:[1,0]
    v_pk_mul_f16 v221, v77, v109 op_sel_hi:[1,0]
    v_mfma_f32_16x16x32_f16 v[208:211], v[192:195], v[104:107], v[208:211]
    v_pk_mul_f16 v222, v78, v110 op_sel_hi:[1,0]
    v_pk_mul_f16 v223, v79, v111 op_sel_hi:[1,0]
    v_pk_fma_f16 v108, v76, v108, v220 op_sel:[1,1,0] op_sel_hi:[0,1,1] neg_hi:[1,0,0]
    v_mfma_f32_16x16x32_f16 v[212:215], v[132:135], v[68:71], v[212:215]
    v_pk_fma_f16 v109, v77, v109, v221 op_sel:[1,1,0] op_sel_hi:[0,1,1] neg_hi:[1,0,0]
    v_pk_fma_f16 v110, v78, v110, v222 op_sel:[1,1,0] op_sel_hi:[0,1,1] neg_hi:[1,0,0]
    v_pk_fma_f16 v111, v79, v111, v223 op_sel:[1,1,0] op_sel_hi:[0,1,1] neg_hi:[1,0,0]
    v_mfma_f32_16x16x32_f16 v[216:219], v[132:135], v[100:103], v[216:219]
    s_waitcnt lgkmcnt(3)
    s_nop 0
    v_mfma_f32_16x16x32_f16 v[208:211], v[196:199], v[108:111], v[208:211]
    v_mfma_f32_16x16x32_f16 v[212:215], v[136:139], v[72:75], v[212:215]
    v_mfma_f32_16x16x32_f16 v[216:219], v[136:139], v[104:107], v[216:219]
    v_mfma_f32_16x16x32_f16 v[212:215], v[140:143], v[76:79], v[212:215]
    v_mfma_f32_16x16x32_f16 v[216:219], v[140:143], v[108:111], v[216:219]
    s_waitcnt lgkmcnt(0)
    v_readfirstlane_b32 s28, v34
    s_add_u32 s31, s31, 64
    s_mov_b32 s29, s28
    s_cmp_eq_u32 s28, 0
    s_cbranch_scc1 L_XE1
    s_xor_b64 s[16:17], s[16:17], s[28:29]
    s_xor_b64 s[18:19], s[18:19], s[28:29]
    s_xor_b64 s[20:21], s[20:21], s[28:29]
    s_xor_b64 s[22:23], s[22:23], s[28:29]
    s_or_b64 s[16:17], s[16:17], s[18:19]
    s_or_b64 s[20:21], s[20:21], s[22:23]
    s_or_b64 s[16:17], s[16:17], s[20:21]
    s_cbranch_scc1 L_XE1
    s_setprio 3
    buffer_load_dwordx4 v[16:19], v33, s[44:47], s32 offen sc1
    buffer_load_dwordx4 v[20:23], v33, s[44:47], s33 offen sc1
    buffer_load_dwordx4 v[24:27], v33, s[44:47], s34 offen sc1
    buffer_load_dwordx4 v[28:31], v33, s[44:47], s35 offen sc1
    s_mov_b64 exec, 1
    ds_write_b32 v4, v5 offset:544
    s_mov_b64 exec, -1
    s_setprio 2
    s_mov_b32 s30, 1
L_XE1:
    s_cmp_lg_u32 s30, 0
    s_cbranch_scc1 L_XI2
    ds_read_b32 v34, v6 offset:128
    s_buffer_load_dwordx8 s[16:23], s[44:47], s31
L_XI2:
    s_lshl_b32 s4, s58, 4
    s_lshr_b64 s[6:7], s[66:67], s4
    s_lshl_b32 s6, s6, 16
    v_permlane32_swap_b32 v204, v208
    v_permlane32_swap_b32 v205, v209
    v_permlane32_swap_b32 v206, v210
    v_permlane32_swap_b32 v207, v211
    v_cvt_pk_bf16_f32 v220, v215, v219
    s_mov_b64 exec, 1
    v_add_f32 v204, s6, v204
    v_add_f32_e64 v204, 1.0, v204
    s_mov_b64 exec, -1
    v_permlane32_swap_b32 v212, v216
    v_permlane32_swap_b32 v213, v217
    v_permlane32_swap_b32 v214, v218
    ds_write_b16 v47, v220 offset:9504
    ds_write_b16_d16_hi v47, v220 offset:9520
    ds_write_b16 v47, v220 offset:9662
    ds_write_b16_d16_hi v47, v220 offset:9678
    ds_write_b16 v47, v220 offset:9820
    ds_write_b16_d16_hi v47, v220 offset:9836
    ds_write_b16 v47, v220 offset:9978
    ds_write_b16_d16_hi v47, v220 offset:9994
    v_cvt_pk_bf16_f32 v48, v204, v205
    v_cvt_pk_bf16_f32 v49, v206, v207
    v_cvt_pk_bf16_f32 v50, v205, v206
    v_cvt_pk_bf16_f32 v51, v207, v212
    v_cvt_pk_bf16_f32 v52, v206, v207
    v_cvt_pk_bf16_f32 v53, v212, v213
    v_cvt_pk_bf16_f32 v54, v207, v212
    v_cvt_pk_bf16_f32 v55, v213, v214
    v_cvt_pk_bf16_f32 v56, v208, v208
    v_cvt_pk_bf16_f32 v57, v209, v210
    v_cvt_pk_bf16_f32 v58, v208, v209
    v_cvt_pk_bf16_f32 v59, v210, v210
    v_cvt_pk_bf16_f32 v60, v209, v210
    v_cvt_pk_bf16_f32 v61, v210, v210
    v_cvt_pk_bf16_f32 v62, v210, v210
    v_cvt_pk_bf16_f32 v63, v210, v211
    v_cvt_pk_bf16_f32 v64, v216, v216
    v_cvt_pk_bf16_f32 v65, v216, v217
    v_cvt_pk_bf16_f32 v66, v217, v217
    v_cvt_pk_bf16_f32 v67, v218, v218
    v_cvt_pk_bf16_f32 v68, v216, v216
    v_cvt_pk_bf16_f32 v69, v217, v217
    v_cvt_pk_bf16_f32 v70, v217, v218
    v_cvt_pk_bf16_f32 v71, v218, v218
    v_cvt_pk_bf16_f32 v72, v216, v217
    v_cvt_pk_bf16_f32 v73, v217, v217
    v_cvt_pk_bf16_f32 v74, v218, v218
    v_cvt_pk_bf16_f32 v75, v218, v218
    v_cvt_pk_bf16_f32 v76, v217, v217
    v_cvt_pk_bf16_f32 v77, v217, v218
    v_cvt_pk_bf16_f32 v78, v218, v218
    v_cvt_pk_bf16_f32 v79, v218, v218
    v_cvt_pk_bf16_f32 v80, v252, v204
    v_mov_b32 v81, v50
    v_mov_b32 v82, v79
    v_cvt_pk_bf16_f32 v83, v218, v252
    s_cmp_lg_u32 s30, 0
    s_cbranch_scc1 L_XE2
    s_waitcnt lgkmcnt(0)
    v_readfirstlane_b32 s28, v34
    s_add_u32 s31, s31, 64
    s_mov_b32 s29, s28
    s_cmp_eq_u32 s28, 0
    s_cbranch_scc1 L_XE2
    s_xor_b64 s[16:17], s[16:17], s[28:29]
    s_xor_b64 s[18:19], s[18:19], s[28:29]
    s_xor_b64 s[20:21], s[20:21], s[28:29]
    s_xor_b64 s[22:23], s[22:23], s[28:29]
    s_or_b64 s[16:17], s[16:17], s[18:19]
    s_or_b64 s[20:21], s[20:21], s[22:23]
    s_or_b64 s[16:17], s[16:17], s[20:21]
    s_cbranch_scc1 L_XE2
    s_setprio 3
    buffer_load_dwordx4 v[16:19], v33, s[44:47], s32 offen sc1
    buffer_load_dwordx4 v[20:23], v33, s[44:47], s33 offen sc1
    buffer_load_dwordx4 v[24:27], v33, s[44:47], s34 offen sc1
    buffer_load_dwordx4 v[28:31], v33, s[44:47], s35 offen sc1
    s_mov_b64 exec, 1
    ds_write_b32 v4, v5 offset:544
    s_mov_b64 exec, -1
    s_setprio 2
    s_mov_b32 s30, 1
L_XE2:
    s_nop 0
    ds_write_b64 v203, v[48:49] offset:32
    ds_write_b64 v203, v[50:51] offset:2400
    ds_write_b64 v203, v[52:53] offset:4768
    ds_write_b64 v203, v[54:55] offset:7136
    ds_write_b64 v203, v[56:57] offset:544
    ds_write_b64 v203, v[58:59] offset:2912
    ds_write_b64 v203, v[60:61] offset:5280
    ds_write_b64 v203, v[62:63] offset:7648
    ds_write_b128 v46, v[64:67] offset:1056
    ds_write_b128 v46, v[68:71] offset:3424
    ds_write_b128 v46, v[72:75] offset:5792
    ds_write_b128 v46, v[76:79] offset:8160
    s_mov_b64 exec, 1
    ds_write_b32 v35, v80 offset:2396
    ds_write_b32 v35, v48 offset:4764
    ds_write_b64 v35, v[80:81] offset:7128
    s_brev_b64 exec, 1
    ds_write_b64 v35, v[78:79] offset:2080
    ds_write_b32 v35, v83 offset:2088
    ds_write_b64 v35, v[78:79] offset:4448
    ds_write_b64 v35, v[82:83] offset:6816
    ds_write_b32 v35, v79 offset:9184
    s_mov_b64 exec, -1
LW_1:
    ds_read_b32 v34, v6 offset:128
    s_waitcnt lgkmcnt(0)
    v_cmp_eq_u32 vcc, 0, v34
    s_cbranch_vccnz LW_1
    s_cmp_lg_u32 s30, 0
    s_cbranch_scc1 L_XS1
    s_buffer_load_dwordx8 s[16:23], s[44:47], s31
L_XS1:
    v_readfirstlane_b32 s28, v34
    ds_write_b64 v15, v[252:253] offset:4096
    s_mov_b32 s5, 0
    s_mov_b32 s29, s28
    s_nop 0
    ds_read_b64 v[48:49], v1 offset:0
    ds_read_b64 v[50:51], v1 offset:8
    ds_read_b64 v[52:53], v1 offset:64
    ds_read_b64 v[54:55], v1 offset:72
    ds_read_b64 v[56:57], v1 offset:128
    ds_read_b64 v[58:59], v1 offset:136
    ds_read_b64 v[60:61], v1 offset:192
    ds_read_b64 v[62:63], v1 offset:200
    ds_read_b64 v[64:65], v1 offset:256
    ds_read_b64 v[66:67], v1 offset:264
    ds_read_b64 v[68:69], v1 offset:320
    ds_read_b64 v[70:71], v1 offset:328
    ds_read_b64 v[72:73], v1 offset:384
    ds_read_b64 v[74:75], v1 offset:392
    ds_read_b64 v[76:77], v1 offset:448
    ds_read_b64 v[78:79], v1 offset:456
    ds_read_b64 v[80:81], v1 offset:512
    ds_read_b64 v[82:83], v1 offset:520
    ds_read_b64 v[84:85], v1 offset:576
    ds_read_b64 v[86:87], v1 offset:584
    ds_read_b64 v[88:89], v1 offset:640
    ds_read_b64 v[90:91], v1 offset:648
    ds_read_b64 v[92:93], v1 offset:704
    ds_read_b64 v[94:95], v1 offset:712
    ds_read_b64 v[96:97], v1 offset:768
    ds_read_b64 v[98:99], v1 offset:776
    ds_read_b64 v[100:101], v1 offset:832
    ds_read_b64 v[102:103], v1 offset:840
    ds_read_b64 v[104:105], v1 offset:896
    ds_read_b64 v[106:107], v1 offset:904
    ds_read_b64 v[108:109], v1 offset:960
    ds_read_b64 v[110:111], v1 offset:968
    ds_read_b64 v[112:113], v1 offset:1024
    ds_read_b64 v[114:115], v1 offset:1032
    ds_read_b64 v[116:117], v1 offset:1088
    ds_read_b64 v[118:119], v1 offset:1096
    ds_read_b64 v[120:121], v1 offset:1152
    ds_read_b64 v[122:123], v1 offset:1160
    ds_read_b64 v[124:125], v1 offset:1216
    ds_read_b64 v[126:127], v1 offset:1224
    s_cmp_lg_u32 s30, 0
    s_cbranch_scc1 L_XA
    s_waitcnt lgkmcnt(0)
    s_xor_b64 s[16:17], s[16:17], s[28:29]
    s_xor_b64 s[18:19], s[18:19], s[28:29]
    s_xor_b64 s[20:21], s[20:21], s[28:29]
    s_xor_b64 s[22:23], s[22:23], s[28:29]
    s_or_b64 s[16:17], s[16:17], s[18:19]
    s_or_b64 s[20:21], s[20:21], s[22:23]
    s_or_b64 s[16:17], s[16:17], s[20:21]
    s_cbranch_scc1 L_XF
    s_setprio 3
    buffer_load_dwordx4 v[16:19], v33, s[44:47], s32 offen sc1
    buffer_load_dwordx4 v[20:23], v33, s[44:47], s33 offen sc1
    buffer_load_dwordx4 v[24:27], v33, s[44:47], s34 offen sc1
    buffer_load_dwordx4 v[28:31], v33, s[44:47], s35 offen sc1
    s_mov_b64 exec, 1
    ds_write_b32 v4, v5 offset:544
    s_mov_b64 exec, -1
    s_setprio 2
L_XA:
    s_nop 0
    ds_read_b64 v[128:129], v1 offset:1280
    ds_read_b64 v[130:131], v1 offset:1288
    ds_read_b64 v[132:133], v1 offset:1344
    ds_read_b64 v[134:135], v1 offset:1352
    ds_read_b64 v[136:137], v1 offset:1408
    ds_read_b64 v[138:139], v1 offset:1416
    ds_read_b64 v[140:141], v1 offset:1472
    ds_read_b64 v[142:143], v1 offset:1480
    ds_read_b64 v[144:145], v1 offset:1536
    ds_read_b64 v[146:147], v1 offset:1544
    ds_read_b64 v[148:149], v1 offset:1600
    ds_read_b64 v[150:151], v1 offset:1608
    ds_read_b64 v[152:153], v1 offset:1664
    ds_read_b64 v[154:155], v1 offset:1672
    ds_read_b64 v[156:157], v1 offset:1728
    ds_read_b64 v[158:159], v1 offset:1736
    ds_read_b64 v[160:161], v1 offset:1792
    ds_read_b64 v[162:163], v1 offset:1800
    ds_read_b64 v[164:165], v1 offset:1856
    ds_read_b64 v[166:167], v1 offset:1864
    ds_read_b64 v[168:169], v1 offset:1920
    ds_read_b64 v[170:171], v1 offset:1928
    ds_read_b64 v[172:173], v1 offset:1984
    ds_read_b64 v[174:175], v1 offset:1992
    ds_read_b64 v[176:177], v1 offset:2048
    ds_read_b64 v[178:179], v1 offset:2056
L_XBACK:
    s_waitcnt vmcnt(3)
    v_lshlrev_b32 v36, 16, v16
    v_and_b32 v37, 0xffff0000, v16
    v_lshlrev_b32_e64 v38, 16, v17
    v_and_b32 v39, 0xffff0000, v17
    v_lshlrev_b32_e64 v40, 16, v18
    v_and_b32 v41, 0xffff0000, v18
    v_lshlrev_b32_e64 v42, 16, v19
    v_and_b32 v43, 0xffff0000, v19
L_MSW:
    ds_read_b32 v11, v4 offset:528
    ds_read_b64 v[12:13], v10 offset:9216
    s_waitcnt lgkmcnt(0)
    v_cmp_eq_u32 vcc, 0, v11
    s_cbranch_vccnz L_MSW
    v_lshlrev_b32 v44, 16, v13
    v_and_b32 v45, 0xffff0000, v13
    v_rcp_f32 v44, v44
    v_rcp_f32 v45, v45
    v_lshlrev_b32_e64 v46, 16, v12
    v_and_b32 v47, 0xffff0000, v12
    v_pk_mul_f32 v[46:47], v[46:47], v[44:45]
    v_pk_fma_f32 v[36:37], v[36:37], v[44:45], v[46:47] op_sel:[0,0,0] op_sel_hi:[1,0,0] neg_lo:[0,0,1] neg_hi:[0,0,1]
    v_pk_fma_f32 v[40:41], v[40:41], v[44:45], v[46:47] op_sel:[0,1,1] op_sel_hi:[1,1,1] neg_lo:[0,0,1] neg_hi:[0,0,1]
    v_pk_fma_f32 v[38:39], v[38:39], v[44:45], v[46:47] op_sel:[0,0,0] op_sel_hi:[1,0,0] neg_lo:[0,0,1] neg_hi:[0,0,1]
    v_pk_fma_f32 v[42:43], v[42:43], v[44:45], v[46:47] op_sel:[0,1,1] op_sel_hi:[1,1,1] neg_lo:[0,0,1] neg_hi:[0,0,1]
    v_cvt_pk_bf16_f32 v36, v40, v36
    v_cvt_pk_bf16_f32 v37, v41, v37
    v_cvt_pk_bf16_f32 v38, v42, v38
    v_cvt_pk_bf16_f32 v39, v43, v39
    ds_write2st64_b32 v32, v36, v37 offset0:12 offset1:30
    ds_write2st64_b32 v32, v38, v39 offset0:48 offset1:66
    s_mov_b64 exec, 1
    ds_write_b32 v4, v11 offset:0
    s_mov_b64 exec, -1
L_XRW:
    ds_read_b32 v15, v6 offset:0
    ds_read_b128 v[180:183], v7 offset:4032
    ds_read_b128 v[184:187], v7 offset:3584
    ds_read_b128 v[188:191], v7 offset:3600
    ds_read_b128 v[192:195], v7 offset:3968
    ds_read_b128 v[196:199], v7 offset:3072
    ds_read_b128 v[200:203], v7 offset:3088
    s_waitcnt lgkmcnt(6)
    v_cmp_eq_u32 vcc, 0, v15
    s_cbranch_vccnz L_XRW
    v_cmp_ne_u32_e64 vcc, 2, v15
    s_cmp_eq_u32 vcc_lo, 0
    s_cselect_b32 s14, 2, 1
    s_waitcnt lgkmcnt(5)
    v_mfma_f32_16x16x32_bf16 v[204:207], v[76:79], v[180:183], 0
    ds_read_b64 v[12:13], v10 offset:11264
    s_waitcnt vmcnt(2)
    v_mfma_f32_16x16x32_bf16 v[208:211], v[108:111], v[180:183], 0
    v_lshlrev_b32 v36, 16, v20
    v_and_b32 v37, 0xffff0000, v20
    v_mfma_f32_16x16x32_bf16 v[212:215], v[140:143], v[180:183], 0
    v_lshlrev_b32_e64 v38, 16, v21
    v_and_b32 v39, 0xffff0000, v21
    v_mfma_f32_16x16x32_bf16 v[216:219], v[172:175], v[180:183], 0
    v_lshlrev_b32 v40, 16, v22
    s_waitcnt lgkmcnt(5)
    v_mfma_f32_16x16x32_bf16 v[220:223], v[184:187], v[244:247], 0
    ds_read_b128 v[180:183], v7 offset:3904
    s_waitcnt lgkmcnt(5)
    v_mfma_f32_16x16x32_bf16 v[224:227], v[188:191], v[248:251], 0
    ds_read_b128 v[184:187], v7 offset:3840
    s_waitcnt lgkmcnt(3)
    v_mfma_f32_16x16x32_bf16 v[204:207], v[72:75], v[192:195], v[204:207]
    ds_read_b128 v[188:191], v7 offset:3776
    v_and_b32 v41, 0xffff0000, v22
    v_mfma_f32_16x16x32_bf16 v[208:211], v[104:107], v[192:195], v[208:211]
    v_cvt_pk_bf16_f32 v236, v223, v222
    v_cvt_pk_bf16_f32 v237, v221, v220
    v_mfma_f32_16x16x32_bf16 v[212:215], v[136:139], v[192:195], v[212:215]
    v_cvt_pk_bf16_f32 v238, v227, v226
    v_cvt_pk_bf16_f32 v239, v225, v224
    v_mfma_f32_16x16x32_bf16 v[216:219], v[168:171], v[192:195], v[216:219]
    v_lshlrev_b32_e64 v42, 16, v23
    v_and_b32 v43, 0xffff0000, v23
    v_mfma_f32_16x16x32_bf16 v[228:231], v[196:199], v[244:247], 0
    ds_read_b128 v[192:195], v7 offset:3712
    s_waitcnt lgkmcnt(3)
    v_mfma_f32_16x16x32_bf16 v[232:235], v[200:203], v[248:251], 0
    ds_read_b128 v[196:199], v7 offset:3648
    v_lshlrev_b32 v44, 16, v13
    v_mfma_f32_16x16x32_bf16 v[204:207], v[68:71], v[180:183], v[204:207]
    v_and_b32 v45, 0xffff0000, v13
    ds_read_b128 v[200:203], v7 offset:3584
    v_mfma_f32_16x16x32_bf16 v[208:211], v[100:103], v[180:183], v[208:211]
    v_cvt_pk_bf16_f32 v240, v231, v230
    v_cvt_pk_bf16_f32 v241, v229, v228
    v_mfma_f32_16x16x32_bf16 v[212:215], v[132:135], v[180:183], v[212:215]
    v_cvt_pk_bf16_f32 v242, v235, v234
    v_cvt_pk_bf16_f32 v243, v233, v232
    v_mfma_f32_16x16x32_bf16 v[216:219], v[164:167], v[180:183], v[216:219]
    v_rcp_f32 v44, v44
    s_waitcnt lgkmcnt(3)
    v_mfma_f32_16x16x32_bf16 v[204:207], v[64:67], v[184:187], v[204:207]
    v_rcp_f32_e64 v45, v45
    v_mfma_f32_16x16x32_bf16 v[208:211], v[96:99], v[184:187], v[208:211]
    v_lshlrev_b32_e64 v46, 16, v12
    v_and_b32 v47, 0xffff0000, v12
    v_mfma_f32_16x16x32_bf16 v[212:215], v[128:131], v[184:187], v[212:215]
    v_mul_f32 v46, v46, v44
    v_mul_f32 v47, v47, v45
    v_mfma_f32_16x16x32_bf16 v[216:219], v[160:163], v[184:187], v[216:219]
    ds_read_b128 v[180:183], v7 offset:3520
    v_fma_f32 v36, v36, v44, -v46
    v_mfma_f32_16x16x32_bf16 v[204:207], v[60:63], v[188:191], v[204:207]
    v_fma_f32 v40, v40, v45, -v47
    v_fma_f32 v37, v37, v44, -v46
    v_mfma_f32_16x16x32_bf16 v[208:211], v[92:95], v[188:191], v[208:211]
    v_fma_f32 v41, v41, v45, -v47
    v_fma_f32 v38, v38, v44, -v46
    v_mfma_f32_16x16x32_bf16 v[212:215], v[124:127], v[188:191], v[212:215]
    v_fma_f32 v42, v42, v45, -v47
    v_fma_f32 v39, v39, v44, -v46
    v_mfma_f32_16x16x32_bf16 v[216:219], v[156:159], v[188:191], v[216:219]
    ds_read_b128 v[184:187], v7 offset:3456
    s_waitcnt lgkmcnt(2)
    s_nop 0
    v_mfma_f32_16x16x32_bf16 v[204:207], v[56:59], v[192:195], v[204:207]
    v_fma_f32 v43, v43, v45, -v47
    v_cvt_pk_bf16_f32 v36, v40, v36
    v_mfma_f32_16x16x32_bf16 v[208:211], v[88:91], v[192:195], v[208:211]
    v_cvt_pk_bf16_f32 v37, v41, v37
    v_cvt_pk_bf16_f32 v38, v42, v38
    v_mfma_f32_16x16x32_bf16 v[212:215], v[120:123], v[192:195], v[212:215]
    v_cvt_pk_bf16_f32 v39, v43, v39
    ds_read_b128 v[188:191], v7 offset:3392
    v_mfma_f32_16x16x32_bf16 v[216:219], v[152:155], v[192:195], v[216:219]
    ds_write2st64_b32 v32, v36, v37 offset0:8 offset1:26
    v_mfma_f32_16x16x32_bf16 v[204:207], v[52:55], v[196:199], v[204:207]
    ds_write2st64_b32 v32, v38, v39 offset0:44 offset1:62
    v_mfma_f32_16x16x32_bf16 v[208:211], v[84:87], v[196:199], v[208:211]
    ds_write_b32 v4, v5 offset:160
    ds_read_b64 v[12:13], v10 offset:13312
    v_mfma_f32_16x16x32_bf16 v[212:215], v[116:119], v[196:199], v[212:215]
    s_waitcnt vmcnt(0)
    v_lshlrev_b32 v36, 16, v24
    v_mfma_f32_16x16x32_bf16 v[216:219], v[148:151], v[196:199], v[216:219]
    ds_read_b128 v[192:195], v7 offset:3328
    v_and_b32 v37, 0xffff0000, v24
    v_mfma_f32_16x16x32_bf16 v[204:207], v[48:51], v[200:203], v[204:207]
    v_lshlrev_b32_e64 v38, 16, v25
    v_and_b32 v39, 0xffff0000, v25
    v_mfma_f32_16x16x32_bf16 v[208:211], v[80:83], v[200:203], v[208:211]
    v_lshlrev_b32_e64 v40, 16, v26
    v_and_b32 v41, 0xffff0000, v26
    v_mfma_f32_16x16x32_bf16 v[212:215], v[112:115], v[200:203], v[212:215]
    v_lshlrev_b32_e64 v42, 16, v27
    v_and_b32 v43, 0xffff0000, v27
    v_mfma_f32_16x16x32_bf16 v[216:219], v[144:147], v[200:203], v[216:219]
    ds_write_b128 v8, v[204:207] offset:0
    v_mfma_f32_16x16x32_bf16 v[220:223], v[176:179], v[200:203], 0
    ds_read_b128 v[196:199], v7 offset:3264
    s_waitcnt lgkmcnt(3)
    v_mfma_f32_16x16x32_bf16 v[208:211], v[76:79], v[180:183], v[208:211]
    ds_read_b32 v11, v6 offset:160
    v_lshlrev_b32 v44, 16, v13
    v_mfma_f32_16x16x32_bf16 v[212:215], v[108:111], v[180:183], v[212:215]
    v_and_b32 v45, 0xffff0000, v13
    ds_read_b128 v[200:203], v7 offset:3200
    v_mfma_f32_16x16x32_bf16 v[216:219], v[140:143], v[180:183], v[216:219]
    v_rcp_f32_e64 v44, v44
    v_mfma_f32_16x16x32_bf16 v[220:223], v[172:175], v[180:183], v[220:223]
    v_rcp_f32_e64 v45, v45
    v_mfma_f32_16x16x32_bf16 v[208:211], v[72:75], v[184:187], v[208:211]
    v_lshlrev_b32_e64 v46, 16, v12
    v_and_b32 v47, 0xffff0000, v12
    v_mfma_f32_16x16x32_bf16 v[212:215], v[104:107], v[184:187], v[212:215]
    v_mul_f32 v46, v46, v44
    v_mul_f32 v47, v47, v45
    v_mfma_f32_16x16x32_bf16 v[216:219], v[136:139], v[184:187], v[216:219]
    s_waitcnt lgkmcnt(1)
    v_cmp_eq_u32 vcc, 0, v11
    v_mfma_f32_16x16x32_bf16 v[220:223], v[168:171], v[184:187], v[220:223]
    s_cbranch_vccnz L_SLOW3
L_BACK3:
    s_nop 0
    ds_read_b128 v[180:183], v7 offset:3136
    v_mfma_f32_16x16x32_bf16 v[208:211], v[68:71], v[188:191], v[208:211]
    v_fma_f32 v36, v36, v44, -v46
    v_fma_f32 v40, v40, v45, -v47
    v_mfma_f32_16x16x32_bf16 v[212:215], v[100:103], v[188:191], v[212:215]
    v_fma_f32 v37, v37, v44, -v46
    v_fma_f32 v41, v41, v45, -v47
    v_mfma_f32_16x16x32_bf16 v[216:219], v[132:135], v[188:191], v[216:219]
    ds_read_b128 v[184:187], v7 offset:3072
    v_fma_f32 v38, v38, v44, -v46
    v_mfma_f32_16x16x32_bf16 v[220:223], v[164:167], v[188:191], v[220:223]
    v_fma_f32 v42, v42, v45, -v47
    v_fma_f32 v39, v39, v44, -v46
    v_mfma_f32_16x16x32_bf16 v[208:211], v[64:67], v[192:195], v[208:211]
    v_fma_f32 v43, v43, v45, -v47
    v_cvt_pk_bf16_f32 v36, v40, v36
    v_mfma_f32_16x16x32_bf16 v[212:215], v[96:99], v[192:195], v[212:215]
    v_cvt_pk_bf16_f32 v37, v41, v37
    v_cvt_pk_bf16_f32 v38, v42, v38
    v_mfma_f32_16x16x32_bf16 v[216:219], v[128:131], v[192:195], v[216:219]
    v_cvt_pk_bf16_f32 v39, v43, v39
    ds_read_b128 v[188:191], v7 offset:3008
    v_mfma_f32_16x16x32_bf16 v[220:223], v[160:163], v[192:195], v[220:223]
    ds_write2st64_b32 v32, v36, v37 offset0:4 offset1:22
    v_mfma_f32_16x16x32_bf16 v[208:211], v[60:63], v[196:199], v[208:211]
    ds_write2st64_b32 v32, v38, v39 offset0:40 offset1:58
    v_mfma_f32_16x16x32_bf16 v[212:215], v[92:95], v[196:199], v[212:215]
    v_lshlrev_b32_e64 v36, 16, v16
    v_and_b32 v37, 0xffff0000, v16
    v_mfma_f32_16x16x32_bf16 v[216:219], v[124:127], v[196:199], v[216:219]
    v_lshlrev_b32_e64 v38, 16, v17
    v_and_b32 v39, 0xffff0000, v17
    v_mfma_f32_16x16x32_bf16 v[220:223], v[156:159], v[196:199], v[220:223]
    ds_read_b128 v[192:195], v7 offset:2560
    s_waitcnt lgkmcnt(4)
    v_mfma_f32_16x16x32_bf16 v[208:211], v[56:59], v[200:203], v[208:211]
    ds_read_b128 v[196:199], v7 offset:2576
    v_lshlrev_b32 v40, 16, v18
    v_mfma_f32_16x16x32_bf16 v[212:215], v[88:91], v[200:203], v[212:215]
    v_and_b32 v41, 0xffff0000, v18
    v_lshlrev_b32_e64 v42, 16, v19
    v_mfma_f32_16x16x32_bf16 v[216:219], v[120:123], v[200:203], v[216:219]
    v_and_b32 v43, 0xffff0000, v19
    v_mfma_f32_16x16x32_bf16 v[220:223], v[152:155], v[200:203], v[220:223]
    v_mfma_f32_16x16x32_bf16 v[208:211], v[52:55], v[180:183], v[208:211]
    ds_read_b128 v[200:203], v7 offset:2944
    v_mfma_f32_16x16x32_bf16 v[212:215], v[84:87], v[180:183], v[212:215]
    v_mfma_f32_16x16x32_bf16 v[216:219], v[116:119], v[180:183], v[216:219]
    v_mfma_f32_16x16x32_bf16 v[220:223], v[148:151], v[180:183], v[220:223]
    v_mfma_f32_16x16x32_bf16 v[208:211], v[48:51], v[184:187], v[208:211]
    ds_read_b128 v[180:183], v7 offset:2880
    v_mfma_f32_16x16x32_bf16 v[212:215], v[80:83], v[184:187], v[212:215]
    v_mfma_f32_16x16x32_bf16 v[216:219], v[112:115], v[184:187], v[216:219]
    v_mfma_f32_16x16x32_bf16 v[220:223], v[144:147], v[184:187], v[220:223]
    v_mfma_f32_16x16x32_bf16 v[224:227], v[176:179], v[184:187], 0
    s_waitcnt lgkmcnt(1)
    s_nop 0
    v_mfma_f32_16x16x32_bf16 v[212:215], v[76:79], v[188:191], v[212:215]
    ds_read_b128 v[184:187], v7 offset:2816
    v_mfma_f32_16x16x32_bf16 v[216:219], v[108:111], v[188:191], v[216:219]
    ds_write_b128 v8, v[208:211] offset:1024
    v_mfma_f32_16x16x32_bf16 v[220:223], v[140:143], v[188:191], v[220:223]
    ds_write_b32 v4, v5 offset:144
    v_mfma_f32_16x16x32_bf16 v[224:227], v[172:175], v[188:191], v[224:227]
    v_mfma_f32_16x16x32_bf16 v[228:231], v[192:195], v[244:247], 0
    ds_read_b128 v[188:191], v7 offset:2048
    v_mfma_f32_16x16x32_bf16 v[232:235], v[196:199], v[248:251], 0
    ds_read_b128 v[192:195], v7 offset:2064
    v_mfma_f32_16x16x32_bf16 v[212:215], v[72:75], v[200:203], v[212:215]
    ds_read_b32 v11, v6 offset:144
    ds_read_b128 v[196:199], v7 offset:2752
    v_mfma_f32_16x16x32_bf16 v[216:219], v[104:107], v[200:203], v[216:219]
    v_mfma_f32_16x16x32_bf16 v[220:223], v[136:139], v[200:203], v[220:223]
    v_cvt_pk_bf16_f32 v252, v231, v230
    v_cvt_pk_bf16_f32 v253, v229, v228
    v_mfma_f32_16x16x32_bf16 v[224:227], v[168:171], v[200:203], v[224:227]
    v_cvt_pk_bf16_f32 v254, v235, v234
    s_waitcnt lgkmcnt(4)
    s_nop 0
    v_mfma_f32_16x16x32_bf16 v[212:215], v[68:71], v[180:183], v[212:215]
    ds_read_b128 v[200:203], v7 offset:2688
    v_cvt_pk_bf16_f32 v255, v233, v232
    v_mfma_f32_16x16x32_bf16 v[216:219], v[100:103], v[180:183], v[216:219]
    v_mfma_f32_16x16x32_bf16 v[220:223], v[132:135], v[180:183], v[220:223]
    s_waitcnt lgkmcnt(1)
    v_cmp_eq_u32 vcc, 0, v11
    v_mfma_f32_16x16x32_bf16 v[224:227], v[164:167], v[180:183], v[224:227]
    s_cbranch_vccnz L_SLOW0
L_BACK0:
    s_nop 0
    ds_read_b64 v[204:205], v9 offset:0
    v_mfma_f32_16x16x32_bf16 v[212:215], v[64:67], v[184:187], v[212:215]
    ds_read_b64 v[206:207], v9 offset:8192
    ds_read_b64 v[208:209], v9 offset:16384
    v_mfma_f32_16x16x32_bf16 v[216:219], v[96:99], v[184:187], v[216:219]
    ds_read_b64 v[210:211], v9 offset:24576
    ds_read_b128 v[180:183], v7 offset:2624
    v_mfma_f32_16x16x32_bf16 v[220:223], v[128:131], v[184:187], v[220:223]
    v_mfma_f32_16x16x32_bf16 v[224:227], v[160:163], v[184:187], v[224:227]
    v_mfma_f32_16x16x32_bf16 v[228:231], v[188:191], v[244:247], 0
    ds_read_b128 v[184:187], v7 offset:2560
    v_mfma_f32_16x16x32_bf16 v[232:235], v[192:195], v[248:251], 0
    ds_read_b128 v[188:191], v7 offset:2496
    v_mfma_f32_16x16x32_bf16 v[212:215], v[60:63], v[196:199], v[212:215]
    ds_read_b128 v[192:195], v7 offset:2432
    v_mfma_f32_16x16x32_bf16 v[216:219], v[92:95], v[196:199], v[216:219]
    s_waitcnt lgkmcnt(3)
    v_add_f32 v36, v204, v36
    v_mfma_f32_16x16x32_bf16 v[220:223], v[124:127], v[196:199], v[220:223]
    v_cvt_pk_bf16_f32 v248, v231, v230
    v_cvt_pk_bf16_f32 v249, v229, v228
    v_mfma_f32_16x16x32_bf16 v[224:227], v[156:159], v[196:199], v[224:227]
    v_cvt_pk_bf16_f32 v250, v235, v234
    v_cvt_pk_bf16_f32 v251, v233, v232
    v_mfma_f32_16x16x32_bf16 v[212:215], v[56:59], v[200:203], v[212:215]
    v_add_f32 v37, v206, v37
    v_add_f32 v38, v208, v38
    v_mfma_f32_16x16x32_bf16 v[216:219], v[88:91], v[200:203], v[216:219]
    v_add_f32 v39, v210, v39
    v_add_f32 v40, v205, v40
    v_mfma_f32_16x16x32_bf16 v[220:223], v[120:123], v[200:203], v[220:223]
    v_add_f32 v41, v207, v41
    v_add_f32 v42, v209, v42
    v_mfma_f32_16x16x32_bf16 v[224:227], v[152:155], v[200:203], v[224:227]
    ds_read_b128 v[196:199], v7 offset:2368
    v_add_f32_e64 v43, v211, v43
    v_mfma_f32_16x16x32_bf16 v[212:215], v[52:55], v[180:183], v[212:215]
    v_cvt_pk_bf16_f32 v204, v36, v37
    v_cvt_pk_bf16_f32 v205, v38, v39
    v_mfma_f32_16x16x32_bf16 v[216:219], v[84:87], v[180:183], v[216:219]
    v_cvt_pk_bf16_f32 v206, v40, v41
    v_cvt_pk_bf16_f32 v207, v42, v43
    v_mfma_f32_16x16x32_bf16 v[220:223], v[116:119], v[180:183], v[220:223]
    buffer_store_dwordx4 v[204:207], v33, s[44:47], s32 offen
    v_mfma_f32_16x16x32_bf16 v[224:227], v[148:151], v[180:183], v[224:227]
    ds_read_b128 v[200:203], v7 offset:2304
    s_waitcnt lgkmcnt(2)
    v_mfma_f32_16x16x32_bf16 v[212:215], v[48:51], v[184:187], v[212:215]
    v_mov_b32 v208, -1
    v_mov_b32_e64 v209, -1
    v_mfma_f32_16x16x32_bf16 v[216:219], v[80:83], v[184:187], v[216:219]
    v_mov_b32 v210, -1
    v_mov_b32 v211, -1
    v_mfma_f32_16x16x32_bf16 v[220:223], v[112:115], v[184:187], v[220:223]
    ds_read_b64 v[12:13], v10 offset:15360
    v_lshlrev_b32_e64 v36, 16, v28
    v_mfma_f32_16x16x32_bf16 v[224:227], v[144:147], v[184:187], v[224:227]
    ds_write_b128 v8, v[212:215] offset:2048
    v_mfma_f32_16x16x32_bf16 v[228:231], v[176:179], v[184:187], 0
    ds_read_b64 v[180:181], v2 offset:9496
    ds_read_b64 v[182:183], v2 offset:10136
    v_mfma_f32_16x16x32_bf16 v[216:219], v[76:79], v[188:191], v[216:219]
    ds_read_b128 v[184:187], v7 offset:2240
    v_and_b32 v37, 0xffff0000, v28
    v_mfma_f32_16x16x32_bf16 v[220:223], v[108:111], v[188:191], v[220:223]
    v_lshlrev_b32_e64 v38, 16, v29
    v_and_b32 v39, 0xffff0000, v29
    v_mfma_f32_16x16x32_bf16 v[224:227], v[140:143], v[188:191], v[224:227]
    v_lshlrev_b32_e64 v40, 16, v30
    v_and_b32 v41, 0xffff0000, v30
    v_mfma_f32_16x16x32_bf16 v[228:231], v[172:175], v[188:191], v[228:231]
    v_lshlrev_b32_e64 v42, 16, v31
    v_and_b32 v43, 0xffff0000, v31
    v_mfma_f32_16x16x32_bf16 v[216:219], v[72:75], v[192:195], v[216:219]
    ds_read_b128 v[188:191], v7 offset:2176
    s_waitcnt lgkmcnt(4)
    v_mfma_f32_16x16x32_bf16 v[220:223], v[104:107], v[192:195], v[220:223]
    v_lshlrev_b32 v44, 16, v13
    v_and_b32 v45, 0xffff0000, v13
    v_mfma_f32_16x16x32_bf16 v[224:227], v[136:139], v[192:195], v[224:227]
    v_rcp_f32_e64 v44, v44
    v_mfma_f32_16x16x32_bf16 v[228:231], v[168:171], v[192:195], v[228:231]
    v_rcp_f32_e64 v45, v45
    v_mfma_f32_16x16x32_bf16 v[216:219], v[68:71], v[196:199], v[216:219]
    ds_read_b128 v[192:195], v7 offset:2112
    v_lshlrev_b32_e64 v46, 16, v12
    v_mfma_f32_16x16x32_bf16 v[220:223], v[100:103], v[196:199], v[220:223]
    v_and_b32 v47, 0xffff0000, v12
    v_mul_f32_e64 v46, v46, v44
    v_mfma_f32_16x16x32_bf16 v[224:227], v[132:135], v[196:199], v[224:227]
    v_mul_f32_e64 v47, v47, v45
    v_fma_f32 v36, v36, v44, -v46
    v_mfma_f32_16x16x32_bf16 v[228:231], v[164:167], v[196:199], v[228:231]
    v_fma_f32 v40, v40, v45, -v47
    v_fma_f32 v37, v37, v44, -v46
    v_mfma_f32_16x16x32_bf16 v[216:219], v[64:67], v[200:203], v[216:219]
    ds_read_b128 v[196:199], v7 offset:2048
    v_fma_f32 v41, v41, v45, -v47
    v_mfma_f32_16x16x32_bf16 v[220:223], v[96:99], v[200:203], v[220:223]
    v_fma_f32 v38, v38, v44, -v46
    v_fma_f32 v42, v42, v45, -v47
    v_mfma_f32_16x16x32_bf16 v[224:227], v[128:131], v[200:203], v[224:227]
    v_fma_f32 v39, v39, v44, -v46
    v_fma_f32 v43, v43, v45, -v47
    v_mfma_f32_16x16x32_bf16 v[228:231], v[160:163], v[200:203], v[228:231]
    v_cvt_pk_bf16_f32 v36, v40, v36
    s_waitcnt lgkmcnt(1)
    s_nop 0
    v_mfma_f32_16x16x32_bf16 v[220:223], v[236:239], v[180:183], v[220:223]
    v_cvt_pk_bf16_f32 v37, v41, v37
    v_cvt_pk_bf16_f32 v38, v42, v38
    v_mfma_f32_16x16x32_bf16 v[224:227], v[240:243], v[180:183], v[224:227]
    ds_read_b128 v[200:203], v7 offset:1984
    v_cvt_pk_bf16_f32 v39, v43, v39
    v_mfma_f32_16x16x32_bf16 v[216:219], v[60:63], v[184:187], v[216:219]
    ds_write2st64_b32 v32, v36, v37 offset0:0 offset1:18
    v_mfma_f32_16x16x32_bf16 v[220:223], v[92:95], v[184:187], v[220:223]
    ds_write2st64_b32 v32, v38, v39 offset0:36 offset1:54
    v_mfma_f32_16x16x32_bf16 v[224:227], v[124:127], v[184:187], v[224:227]
    v_lshlrev_b32_e64 v36, 16, v20
    v_and_b32 v37, 0xffff0000, v20
    v_mfma_f32_16x16x32_bf16 v[228:231], v[156:159], v[184:187], v[228:231]
    ds_read_b128 v[180:183], v7 offset:1920
    v_lshlrev_b32_e64 v38, 16, v21
    v_mfma_f32_16x16x32_bf16 v[216:219], v[56:59], v[188:191], v[216:219]
    v_and_b32 v39, 0xffff0000, v21
    v_lshlrev_b32_e64 v40, 16, v22
    v_mfma_f32_16x16x32_bf16 v[220:223], v[88:91], v[188:191], v[220:223]
    v_and_b32 v41, 0xffff0000, v22
    v_lshlrev_b32_e64 v42, 16, v23
    v_mfma_f32_16x16x32_bf16 v[224:227], v[120:123], v[188:191], v[224:227]
    v_and_b32 v43, 0xffff0000, v23
    ds_read_b128 v[184:187], v7 offset:1856
    v_mfma_f32_16x16x32_bf16 v[228:231], v[152:155], v[188:191], v[228:231]
    v_mfma_f32_16x16x32_bf16 v[216:219], v[52:55], v[192:195], v[216:219]
    ds_read_b128 v[188:191], v7 offset:1792
    v_mfma_f32_16x16x32_bf16 v[220:223], v[84:87], v[192:195], v[220:223]
    v_mfma_f32_16x16x32_bf16 v[224:227], v[116:119], v[192:195], v[224:227]
    v_mfma_f32_16x16x32_bf16 v[228:231], v[148:151], v[192:195], v[228:231]
    s_waitcnt lgkmcnt(2)
    s_nop 0
    v_mfma_f32_16x16x32_bf16 v[216:219], v[48:51], v[196:199], v[216:219]
    ds_read_b64 v[192:193], v2 offset:9528
    ds_read_b64 v[194:195], v2 offset:10168
    v_mfma_f32_16x16x32_bf16 v[220:223], v[80:83], v[196:199], v[220:223]
    v_mfma_f32_16x16x32_bf16 v[224:227], v[112:115], v[196:199], v[224:227]
    v_mfma_f32_16x16x32_bf16 v[228:231], v[144:147], v[196:199], v[228:231]
    v_mfma_f32_16x16x32_bf16 v[232:235], v[176:179], v[196:199], 0
    v_mfma_f32_16x16x32_bf16 v[220:223], v[76:79], v[200:203], v[220:223]
    ds_read_b128 v[196:199], v7 offset:1728
    v_mfma_f32_16x16x32_bf16 v[224:227], v[108:111], v[200:203], v[224:227]
    ds_write_b128 v8, v[216:219] offset:3072
    v_mfma_f32_16x16x32_bf16 v[228:231], v[140:143], v[200:203], v[228:231]
    ds_write_b32 v4, v5 offset:16
    v_mfma_f32_16x16x32_bf16 v[232:235], v[172:175], v[200:203], v[232:235]
    v_mfma_f32_16x16x32_bf16 v[220:223], v[72:75], v[180:183], v[220:223]
    ds_read_b128 v[200:203], v7 offset:1664
    v_mfma_f32_16x16x32_bf16 v[224:227], v[104:107], v[180:183], v[224:227]
    s_lshr_b32 s8, s2, 3
    s_and_b32 s9, s2, 7
    v_mfma_f32_16x16x32_bf16 v[228:231], v[136:139], v[180:183], v[228:231]
    ds_read_b32 v11, v6 offset:16
    s_lshr_b32 s21, s58, 1
    v_mfma_f32_16x16x32_bf16 v[232:235], v[168:171], v[180:183], v[232:235]
    s_add_u32 s21, s21, 2
    s_waitcnt lgkmcnt(3)
    v_mfma_f32_16x16x32_bf16 v[220:223], v[68:71], v[184:187], v[220:223]
    ds_read_b128 v[168:171], v7 offset:1600
    ds_read_b128 v[180:183], v7 offset:1536
    v_mfma_f32_16x16x32_bf16 v[224:227], v[100:103], v[184:187], v[224:227]
    v_lshrrev_b32 v177, 3, v0
    v_and_b32_e64 v178, 7, v0
    v_mfma_f32_16x16x32_bf16 v[228:231], v[132:135], v[184:187], v[228:231]
    s_lshl_b32 s20, s8, 5
    s_add_u32 s20, s20, s21
    v_mfma_f32_16x16x32_bf16 v[232:235], v[164:167], v[184:187], v[232:235]
    v_lshrrev_b32_e64 v176, 4, v0
    v_lshl_add_u32 v176, v176, 2, s20
    v_mfma_f32_16x16x32_bf16 v[220:223], v[64:67], v[188:191], v[220:223]
    s_waitcnt lgkmcnt(2)
    v_cmp_eq_u32 vcc, 0, v11
    v_mfma_f32_16x16x32_bf16 v[224:227], v[96:99], v[188:191], v[224:227]
    s_cbranch_vccnz L_SLOW1
L_BACK1:
    s_nop 0
    ds_read_b64 v[212:213], v9 offset:2048
    v_mfma_f32_16x16x32_bf16 v[228:231], v[128:131], v[188:191], v[228:231]
    ds_read_b64 v[214:215], v9 offset:10240
    ds_read_b64 v[216:217], v9 offset:18432
    v_mfma_f32_16x16x32_bf16 v[232:235], v[160:163], v[188:191], v[232:235]
    ds_read_b64 v[218:219], v9 offset:26624
    ds_read_b32 v11, v6 offset:112
    v_mfma_f32_16x16x32_bf16 v[224:227], v[236:239], v[192:195], v[224:227]
    ds_read_b128 v[164:167], v7 offset:1472
    ds_read_b128 v[160:163], v7 offset:1408
    v_mfma_f32_16x16x32_bf16 v[220:223], v[60:63], v[196:199], v[220:223]
    ds_read_b128 v[184:187], v7 offset:1344
    ds_read_b128 v[188:191], v7 offset:1280
    v_mfma_f32_16x16x32_bf16 v[224:227], v[92:95], v[196:199], v[224:227]
    ds_read_b128 v[192:195], v7 offset:1216
    v_and_b32_e64 v175, 1, v177
    v_mfma_f32_16x16x32_bf16 v[228:231], v[124:127], v[196:199], v[228:231]
    v_lshl_add_u32 v176, v176, 1, v175
    v_mfma_f32_16x16x32_bf16 v[232:235], v[156:159], v[196:199], v[232:235]
    v_mfma_f32_16x16x32_bf16 v[220:223], v[56:59], v[200:203], v[220:223]
    s_waitcnt lgkmcnt(5)
    v_cmp_eq_u32 vcc, 0, v11
    v_mfma_f32_16x16x32_bf16 v[224:227], v[88:91], v[200:203], v[224:227]
    s_cbranch_vccnz L_SLOW4
L_BACK4:
    v_add_f32 v36, v212, v36
    v_mfma_f32_16x16x32_bf16 v[228:231], v[120:123], v[200:203], v[228:231]
    v_add_f32 v37, v214, v37
    v_add_f32 v38, v216, v38
    v_mfma_f32_16x16x32_bf16 v[232:235], v[152:155], v[200:203], v[232:235]
    v_add_f32 v39, v218, v39
    v_add_f32 v40, v213, v40
    v_mfma_f32_16x16x32_bf16 v[220:223], v[52:55], v[168:171], v[220:223]
    v_add_f32 v41, v215, v41
    v_add_f32 v42, v217, v42
    v_mfma_f32_16x16x32_bf16 v[224:227], v[84:87], v[168:171], v[224:227]
    v_add_f32_e64 v43, v219, v43
    v_cvt_pk_bf16_f32 v212, v36, v37
    v_mfma_f32_16x16x32_bf16 v[228:231], v[116:119], v[168:171], v[228:231]
    v_cvt_pk_bf16_f32 v213, v38, v39
    v_cvt_pk_bf16_f32 v214, v40, v41
    v_mfma_f32_16x16x32_bf16 v[232:235], v[148:151], v[168:171], v[232:235]
    v_cvt_pk_bf16_f32 v215, v42, v43
    ds_read_b128 v[156:159], v7 offset:1152
    v_mfma_f32_16x16x32_bf16 v[220:223], v[48:51], v[180:183], v[220:223]
    buffer_store_dwordx4 v[212:215], v33, s[44:47], s33 offen
    v_mfma_f32_16x16x32_bf16 v[224:227], v[80:83], v[180:183], v[224:227]
    v_lshlrev_b32_e64 v36, 16, v24
    v_and_b32 v37, 0xffff0000, v24
    v_mfma_f32_16x16x32_bf16 v[228:231], v[112:115], v[180:183], v[228:231]
    buffer_store_dwordx4 v[208:211], v33, s[44:47], s34 offen
    v_mfma_f32_16x16x32_bf16 v[232:235], v[144:147], v[180:183], v[232:235]
    buffer_store_dwordx4 v[208:211], v33, s[44:47], s35 offen
    s_waitcnt lgkmcnt(1)
    v_mfma_f32_16x16x32_bf16 v[224:227], v[76:79], v[164:167], v[224:227]
    ds_write_b128 v8, v[220:223] offset:4096
    v_mfma_f32_16x16x32_bf16 v[228:231], v[108:111], v[164:167], v[228:231]
    ds_read_b128 v[152:155], v7 offset:1088
    v_lshlrev_b32 v38, 16, v25
    v_mfma_f32_16x16x32_bf16 v[232:235], v[140:143], v[164:167], v[232:235]
    v_and_b32 v39, 0xffff0000, v25
    v_lshlrev_b32_e64 v40, 16, v26
    v_mfma_f32_16x16x32_bf16 v[224:227], v[72:75], v[160:163], v[224:227]
    ds_read_b128 v[148:151], v7 offset:1024
    v_and_b32 v41, 0xffff0000, v26
    v_mfma_f32_16x16x32_bf16 v[228:231], v[104:107], v[160:163], v[228:231]
    v_lshlrev_b32_e64 v42, 16, v27
    v_and_b32 v43, 0xffff0000, v27
    v_mfma_f32_16x16x32_bf16 v[232:235], v[136:139], v[160:163], v[232:235]
    ds_read_b128 v[144:147], v7 offset:960
    ds_read_b128 v[140:143], v7 offset:896
    v_mfma_f32_16x16x32_bf16 v[224:227], v[68:71], v[184:187], v[224:227]
    ds_read_b64 v[136:137], v2 offset:9496
    ds_read_b64 v[138:139], v2 offset:10136
    v_mfma_f32_16x16x32_bf16 v[228:231], v[100:103], v[184:187], v[228:231]
    ds_read_b128 v[196:199], v7 offset:832
    ds_read_b128 v[200:203], v7 offset:768
    v_mfma_f32_16x16x32_bf16 v[232:235], v[132:135], v[184:187], v[232:235]
    ds_read_b128 v[168:171], v7 offset:704
    ds_read_b64 v[180:181], v2 offset:9528
    ds_read_b64 v[182:183], v2 offset:10168
    v_mfma_f32_16x16x32_bf16 v[224:227], v[64:67], v[188:191], v[224:227]
    ds_read_b128 v[132:135], v7 offset:640
    ds_read_b128 v[164:167], v7 offset:576
    v_mfma_f32_16x16x32_bf16 v[228:231], v[96:99], v[188:191], v[228:231]
    ds_read_b64 v[160:161], v2 offset:9560
    ds_read_b64 v[162:163], v2 offset:10200
    v_mfma_f32_16x16x32_bf16 v[232:235], v[128:131], v[188:191], v[232:235]
    ds_read_b128 v[184:187], v7 offset:512
    ds_read_u8 v179, v176 offset:1152
    v_mfma_f32_16x16x32_bf16 v[224:227], v[60:63], v[192:195], v[224:227]
    ds_read_b128 v[128:131], v7 offset:448
    ds_read_b128 v[188:191], v7 offset:384
    v_mfma_f32_16x16x32_bf16 v[228:231], v[92:95], v[192:195], v[228:231]
    ds_read_u8 v176, v176 offset:1184
    s_mul_i32 s20, s58, 17408
    v_mfma_f32_16x16x32_bf16 v[232:235], v[124:127], v[192:195], v[232:235]
    s_add_u32 s20, s20, 52224
    s_waitcnt lgkmcnt(9)
    s_nop 0
    v_mfma_f32_16x16x32_bf16 v[224:227], v[56:59], v[156:159], v[224:227]
    ds_read_b128 v[124:127], v7 offset:320
    ds_read_b64 v[192:193], v2 offset:9592
    ds_read_b64 v[194:195], v2 offset:10232
    v_mfma_f32_16x16x32_bf16 v[228:231], v[88:91], v[156:159], v[228:231]
    v_lshl_add_u32 v173, v177, 3, s20
    v_lshl_add_u32 v174, v178, 4, s20
    v_mfma_f32_16x16x32_bf16 v[232:235], v[120:123], v[156:159], v[232:235]
    s_movk_i32 s20, 288
    s_nop 0
    v_mad_u32_u24 v173, v178, s20, v173
    v_mfma_f32_16x16x32_bf16 v[224:227], v[52:55], v[152:155], v[224:227]
    ds_read_b128 v[120:123], v7 offset:256
    ds_read_b128 v[156:159], v7 offset:192
    v_mfma_f32_16x16x32_bf16 v[228:231], v[84:87], v[152:155], v[228:231]
    s_movk_i32 s20, 144
    v_mad_u32_u24 v174, v177, s20, v174
    v_mfma_f32_16x16x32_bf16 v[232:235], v[116:119], v[152:155], v[232:235]
    v_lshlrev_b32 v178, 4, v178
    v_lshl_add_u32 v172, v177, 14, v178
    v_mfma_f32_16x16x32_bf16 v[224:227], v[48:51], v[148:151], v[224:227]
    ds_read_b128 v[116:119], v7 offset:128
    ds_read_b128 v[152:155], v7 offset:64
    v_mfma_f32_16x16x32_bf16 v[228:231], v[80:83], v[148:151], v[228:231]
    v_lshl_add_u32 v177, v177, 11, v178
    s_and_b32 s20, s58, 1
    v_mfma_f32_16x16x32_bf16 v[232:235], v[112:115], v[148:151], v[232:235]
    s_lshl_b32 s17, s9, 1
    s_add_u32 s17, s17, s20
    s_nop 0
    v_mfma_f32_16x16x32_bf16 v[228:231], v[76:79], v[144:147], v[228:231]
    ds_write_b128 v8, v[224:227] offset:5120
    v_mfma_f32_16x16x32_bf16 v[232:235], v[108:111], v[144:147], v[232:235]
    ds_write_b32 v4, v5 offset:32
    ds_read_b128 v[112:115], v7 offset:0
    v_mfma_f32_16x16x32_bf16 v[228:231], v[72:75], v[140:143], v[228:231]
    s_lshl_b32 s21, s21, 5
    s_add_u32 s21, s21, s8
    v_mfma_f32_16x16x32_bf16 v[232:235], v[104:107], v[140:143], v[232:235]
    s_lshl_b32 s16, s17, 18
    s_lshl_b32 s20, s21, 7
    v_mfma_f32_16x16x32_bf16 v[228:231], v[252:255], v[136:139], v[228:231]
    s_waitcnt vmcnt(0)
    s_add_u32 s16, s16, s20
    v_mfma_f32_16x16x32_bf16 v[232:235], v[248:251], v[136:139], v[232:235]
    ds_read_b32 v11, v6 offset:32
    s_add_u32 s16, s16, 3145728
    v_mfma_f32_16x16x32_bf16 v[228:231], v[68:71], v[196:199], v[228:231]
    s_mov_b64 exec, 1
    buffer_store_dword v34, off, s[44:47], s12 offset:0
    s_mov_b64 exec, -1
    v_mfma_f32_16x16x32_bf16 v[232:235], v[100:103], v[196:199], v[232:235]
    s_lshl_b32 s18, s21, 15
    s_lshl_b32 s17, s17, 7
    v_mfma_f32_16x16x32_bf16 v[228:231], v[64:67], v[200:203], v[228:231]
    s_add_u32 s18, s18, s17
    s_add_u32 s19, s18, 0x4000
    v_mfma_f32_16x16x32_bf16 v[232:235], v[96:99], v[200:203], v[232:235]
    s_add_u32 s17, s16, 0x20000
    s_lshl_b32 s20, s9, 5
    v_mfma_f32_16x16x32_bf16 v[228:231], v[60:63], v[168:171], v[228:231]
    s_lshr_b32 s8, s8, 3
    s_add_u32 s20, s20, s8
    v_mfma_f32_16x16x32_bf16 v[232:235], v[92:95], v[168:171], v[232:235]
    s_waitcnt lgkmcnt(0)
    v_cmp_eq_u32 vcc, 0, v11
    v_mfma_f32_16x16x32_bf16 v[228:231], v[240:243], v[180:183], v[228:231]
    s_cbranch_vccnz L_SLOW2
L_BACK2:
    s_nop 0
    ds_read_b64 v[220:221], v9 offset:4096
    v_mfma_f32_16x16x32_bf16 v[232:235], v[252:255], v[180:183], v[232:235]
    ds_read_b64 v[222:223], v9 offset:12288
    ds_read_b64 v[224:225], v9 offset:20480
    v_mfma_f32_16x16x32_bf16 v[228:231], v[56:59], v[132:135], v[228:231]
    ds_read_b64 v[226:227], v9 offset:28672
    s_lshl_b32 s20, s20, 7
    v_mfma_f32_16x16x32_bf16 v[232:235], v[88:91], v[132:135], v[232:235]
    s_add_u32 s20, s20, 983552
    s_mov_b32 s21, 0
    v_mfma_f32_16x16x32_bf16 v[228:231], v[52:55], v[164:167], v[228:231]
    v_lshl_or_b32 v175, v179, 24, v177
    v_lshl_or_b32 v176, v176, 24, v177
    v_mfma_f32_16x16x32_bf16 v[232:235], v[84:87], v[164:167], v[232:235]
    v_lshlrev_b32_e64 v179, 2, v0
    s_sub_u32 s22, s20, 512
    v_mfma_f32_16x16x32_bf16 v[228:231], v[236:239], v[160:163], v[228:231]
    v_mov_b32_e64 v177, v34
    v_mfma_f32_16x16x32_bf16 v[232:235], v[240:243], v[160:163], v[232:235]
    v_mfma_f32_16x16x32_bf16 v[228:231], v[48:51], v[184:187], v[228:231]
    s_waitcnt lgkmcnt(0)
    v_add_f32 v36, v220, v36
    v_mfma_f32_16x16x32_bf16 v[232:235], v[80:83], v[184:187], v[232:235]
    v_add_f32 v37, v222, v37
    v_add_f32 v38, v224, v38
    v_mfma_f32_16x16x32_bf16 v[232:235], v[76:79], v[128:131], v[232:235]
    v_add_f32 v39, v226, v39
    v_add_f32 v40, v221, v40
    v_mfma_f32_16x16x32_bf16 v[232:235], v[72:75], v[188:191], v[232:235]
    ds_write_b128 v8, v[228:231] offset:6144
    v_mfma_f32_16x16x32_bf16 v[232:235], v[68:71], v[124:127], v[232:235]
    s_mov_b32 exec_hi, 0
    buffer_load_dword v177, v179, s[44:47], s22 offen sc1
    s_mov_b32 exec_hi, -1
    v_mfma_f32_16x16x32_bf16 v[232:235], v[236:239], v[192:195], v[232:235]
    v_add_f32 v41, v223, v41
    v_add_f32 v42, v225, v42
    v_mfma_f32_16x16x32_bf16 v[232:235], v[64:67], v[120:123], v[232:235]
    v_add_f32_e64 v43, v227, v43
    v_cvt_pk_bf16_f32 v220, v36, v37
    v_mfma_f32_16x16x32_bf16 v[232:235], v[60:63], v[156:159], v[232:235]
    v_cvt_pk_bf16_f32 v221, v38, v39
    v_cvt_pk_bf16_f32 v222, v40, v41
    v_mfma_f32_16x16x32_bf16 v[232:235], v[56:59], v[116:119], v[232:235]
    v_cvt_pk_bf16_f32 v223, v42, v43
    v_mfma_f32_16x16x32_bf16 v[232:235], v[52:55], v[152:155], v[232:235]
    buffer_store_dwordx4 v[220:223], v33, s[44:47], s34 offen
    v_mfma_f32_16x16x32_bf16 v[232:235], v[48:51], v[112:115], v[232:235]
    v_lshlrev_b32_e64 v36, 16, v28
    v_and_b32 v37, 0xffff0000, v28
    v_lshlrev_b32_e64 v38, 16, v29
    v_and_b32 v39, 0xffff0000, v29
    v_lshlrev_b32_e64 v40, 16, v30
    v_and_b32 v41, 0xffff0000, v30
    v_lshlrev_b32_e64 v42, 16, v31
    v_and_b32 v43, 0xffff0000, v31
    ds_write_b128 v8, v[232:235] offset:7168
    ds_write_b32 v4, v5 offset:48
L_Y3W:
    ds_read_b32 v14, v6 offset:48
    ds_read_b64 v[228:229], v9 offset:6144
    ds_read_b64 v[230:231], v9 offset:14336
    ds_read_b64 v[232:233], v9 offset:22528
    ds_read_b64 v[234:235], v9 offset:30720
    s_waitcnt lgkmcnt(4)
    v_cmp_eq_u32 vcc, 0, v14
    s_cbranch_vccnz L_Y3W
    s_waitcnt lgkmcnt(0)
    v_add_f32 v36, v228, v36
    v_add_f32 v37, v230, v37
    v_add_f32 v38, v232, v38
    v_add_f32 v39, v234, v39
    v_add_f32 v40, v229, v40
    v_add_f32 v41, v231, v41
    v_add_f32 v42, v233, v42
    v_add_f32 v43, v235, v43
    v_cvt_pk_bf16_f32 v228, v36, v37
    v_cvt_pk_bf16_f32 v229, v38, v39
    v_cvt_pk_bf16_f32 v230, v40, v41
    v_cvt_pk_bf16_f32 v231, v42, v43
    buffer_store_dwordx4 v[228:231], v33, s[44:47], s35 offen
    s_cmp_lg_u32 s14, 2
    s_cbranch_scc1 L_CNL
    s_waitcnt vmcnt(2)
    v_cmp_ne_u32_e64 vcc, v34, v177
    s_cbranch_vccnz L_FAW
L_FAK:
    buffer_load_dwordx4 v[48:51], v172, s[44:47], s16 offen sc1
    buffer_load_dwordx4 v[52:55], v172, s[44:47], s17 offen sc1
    s_waitcnt vmcnt(2)
    s_mov_b64 exec, 1
    buffer_store_dword v34, off, s[44:47], s12 offset:512
    s_mov_b64 exec, -1
    s_waitcnt vmcnt(1)
L_DP:
    v_max3_u32 v56, v48, v49, v50
    v_max3_u32 v57, v52, v53, v54
    v_max_u32 v56, v56, v51
    v_max_u32 v57, v57, v55
    v_cmp_eq_u32 s[8:9], -1, v56
    v_cmp_eq_u32 s[10:11], -1, v57
    s_or_b64 vcc, s[8:9], s[10:11]
    s_cbranch_vccnz L_DR
L_DOK:
    s_mov_b64 exec, 1
    ds_write_b32 v4, v5 offset:560
    s_mov_b64 exec, -1
    ds_write_b64 v173, v[48:49] offset:0
    ds_write_b64 v173, v[50:51] offset:144
    ds_write_b64 v173, v[52:53] offset:64
    ds_write_b64 v173, v[54:55] offset:208
    ds_read_b128 v[56:59], v174 offset:0
    ds_read_b128 v[60:63], v174 offset:1152
    s_waitcnt lgkmcnt(1)
    buffer_store_dwordx4 v[56:59], v175, s[52:55], s18 offen sc1
    s_waitcnt lgkmcnt(0)
    buffer_store_dwordx4 v[60:63], v176, s[52:55], s19 offen sc1
    s_branch L_FIN
L_DR:
    s_add_u32 s21, s21, 1
    s_cmp_ge_u32 s21, 48
    s_cbranch_scc1 L_DF
    s_cmp_eq_u64 s[8:9], 0
    s_cbranch_scc1 L_DS0
    buffer_load_dwordx4 v[48:51], v172, s[44:47], s16 offen sc1
L_DS0:
    s_cmp_eq_u64 s[10:11], 0
    s_cbranch_scc1 L_DS1
    buffer_load_dwordx4 v[52:55], v172, s[44:47], s17 offen sc1
L_DS1:
    s_waitcnt vmcnt(0)
    s_branch L_DP
L_DF:
    s_mov_b32 s21, 0
    s_mov_b32 exec_hi, 0
LT_2:
    buffer_load_dword v177, v179, s[44:47], s20 offen sc1
    s_add_u32 s21, s21, 1
    s_waitcnt vmcnt(0)
    v_cmp_ne_u32_e64 vcc, v34, v177
    s_cbranch_vccz LT_2K
    s_sleep 1
    s_cmp_lt_u32 s21, 0x4000
    s_cbranch_scc1 LT_2
LT_2K:
    s_mov_b32 exec_hi, -1
    buffer_load_dwordx4 v[48:51], v172, s[44:47], s16 offen sc1
    buffer_load_dwordx4 v[52:55], v172, s[44:47], s17 offen sc1
    s_waitcnt vmcnt(0)
    s_branch L_DOK
L_FAW:
    s_mov_b32 s23, 0
    s_mov_b32 exec_hi, 0
LT_3:
    buffer_load_dword v177, v179, s[44:47], s22 offen sc1
    s_add_u32 s23, s23, 1
    s_waitcnt vmcnt(0)
    v_cmp_ne_u32_e64 vcc, v34, v177
    s_cbranch_vccz LT_3K
    s_sleep 1
    s_cmp_lt_u32 s23, 0x4000
    s_cbranch_scc1 LT_3
LT_3K:
    s_mov_b32 exec_hi, -1
    s_branch L_FAK
    s_branch L_FIN
L_CNL:
    s_mov_b64 exec, 1
    ds_write_b32 v4, v5 offset:560
    s_mov_b64 exec, -1
    ds_read_b64 v[12:13], v10 offset:1152
    s_waitcnt lgkmcnt(0)
    v_lshlrev_b32 v14, 24, v12
    v_and_or_b32 v14, v14, s68, v3
    v_lshlrev_b32_e64 v15, 16, v12
    v_and_or_b32 v15, v15, s68, v3
    buffer_store_dwordx2 v[204:205], v14, s[52:55], s60 offen offset:0
    buffer_store_dwordx2 v[206:207], v15, s[52:55], s60 offen offset:2048
    v_lshlrev_b32_e64 v14, 8, v12
    v_and_or_b32 v14, v14, s68, v3
    v_and_or_b32 v15, v12, s68, v3
    buffer_store_dwordx2 v[212:213], v14, s[52:55], s61 offen offset:0
    buffer_store_dwordx2 v[214:215], v15, s[52:55], s61 offen offset:2048
    v_lshlrev_b32_e64 v14, 24, v13
    v_and_or_b32 v14, v14, s68, v3
    v_lshlrev_b32_e64 v15, 16, v13
    v_and_or_b32 v15, v15, s68, v3
    buffer_store_dwordx2 v[220:221], v14, s[52:55], s62 offen offset:0
    buffer_store_dwordx2 v[222:223], v15, s[52:55], s62 offen offset:2048
    v_lshlrev_b32_e64 v14, 8, v13
    v_and_or_b32 v14, v14, s68, v3
    v_and_or_b32 v15, v13, s68, v3
    buffer_store_dwordx2 v[228:229], v14, s[52:55], s63 offen offset:0
    buffer_store_dwordx2 v[230:231], v15, s[52:55], s63 offen offset:2048
    s_branch L_FIN
L_SLOW0:
LW_4:
    ds_read_b32 v11, v6 offset:144
    s_waitcnt lgkmcnt(0)
    v_cmp_eq_u32_e64 vcc, 0, v11
    s_cbranch_vccnz LW_4
    s_branch L_BACK0
L_SLOW1:
LW_5:
    ds_read_b32 v11, v6 offset:16
    s_waitcnt lgkmcnt(0)
    v_cmp_eq_u32 vcc, 0, v11
    s_cbranch_vccnz LW_5
    s_branch L_BACK1
L_SLOW2:
LW_6:
    ds_read_b32 v11, v6 offset:32
    s_waitcnt lgkmcnt(0)
    v_cmp_eq_u32 vcc, 0, v11
    s_cbranch_vccnz LW_6
    s_branch L_BACK2
L_SLOW3:
LW_7:
    ds_read_b32 v11, v6 offset:160
    s_waitcnt lgkmcnt(0)
    v_cmp_eq_u32 vcc, 0, v11
    s_cbranch_vccnz LW_7
    s_branch L_BACK3
L_SLOW4:
LW_8:
    ds_read_b32 v11, v6 offset:112
    s_waitcnt lgkmcnt(0)
    v_cmp_eq_u32_e64 vcc, 0, v11
    s_cbranch_vccnz LW_8
    s_branch L_BACK4
L_XF:
    s_add_u32 s31, s31, 64
    s_buffer_load_dwordx8 s[16:23], s[44:47], s31
    ds_read_b64 v[128:129], v1 offset:1280
    ds_read_b64 v[130:131], v1 offset:1288
    ds_read_b64 v[132:133], v1 offset:1344
    ds_read_b64 v[134:135], v1 offset:1352
    ds_read_b64 v[136:137], v1 offset:1408
    ds_read_b64 v[138:139], v1 offset:1416
    ds_read_b64 v[140:141], v1 offset:1472
    ds_read_b64 v[142:143], v1 offset:1480
    ds_read_b64 v[144:145], v1 offset:1536
    ds_read_b64 v[146:147], v1 offset:1544
    ds_read_b64 v[148:149], v1 offset:1600
    ds_read_b64 v[150:151], v1 offset:1608
    ds_read_b64 v[152:153], v1 offset:1664
    ds_read_b64 v[154:155], v1 offset:1672
    ds_read_b64 v[156:157], v1 offset:1728
    ds_read_b64 v[158:159], v1 offset:1736
    ds_read_b64 v[160:161], v1 offset:1792
    ds_read_b64 v[162:163], v1 offset:1800
    ds_read_b64 v[164:165], v1 offset:1856
    ds_read_b64 v[166:167], v1 offset:1864
    ds_read_b64 v[168:169], v1 offset:1920
    ds_read_b64 v[170:171], v1 offset:1928
    ds_read_b64 v[172:173], v1 offset:1984
    ds_read_b64 v[174:175], v1 offset:1992
    ds_read_b64 v[176:177], v1 offset:2048
    ds_read_b64 v[178:179], v1 offset:2056
    s_branch L_XC
L_XP:
    s_sleep 2
    ds_read_b32 v11, v4 offset:528
    s_cmp_ge_u32 s5, 2
    s_cbranch_scc1 L_XG
    s_add_u32 s31, s31, 64
    s_buffer_load_dwordx8 s[16:23], s[44:47], s31
    s_branch L_XH
L_XG:
    s_buffer_load_dwordx8 s[16:23], s[44:47], s31 glc
L_XH:
    s_add_u32 s5, s5, 1
    s_waitcnt lgkmcnt(0)
    v_cmp_eq_u32 vcc, 1, v11
    s_cbranch_vccnz L_XSLOW
    s_cmp_ge_u32 s5, 0x4000
    s_cbranch_scc1 L_XSLOW
L_XC:
    s_waitcnt lgkmcnt(0)
    s_xor_b64 s[16:17], s[16:17], s[28:29]
    s_xor_b64 s[18:19], s[18:19], s[28:29]
    s_xor_b64 s[20:21], s[20:21], s[28:29]
    s_xor_b64 s[22:23], s[22:23], s[28:29]
    s_or_b64 s[16:17], s[16:17], s[18:19]
    s_or_b64 s[20:21], s[20:21], s[22:23]
    s_or_b64 s[16:17], s[16:17], s[20:21]
    s_cbranch_scc1 L_XP
    s_setprio 3
    buffer_load_dwordx4 v[16:19], v33, s[44:47], s32 offen sc1
    buffer_load_dwordx4 v[20:23], v33, s[44:47], s33 offen sc1
    buffer_load_dwordx4 v[24:27], v33, s[44:47], s34 offen sc1
    buffer_load_dwordx4 v[28:31], v33, s[44:47], s35 offen sc1
    s_mov_b64 exec, 1
    ds_write_b32 v4, v5 offset:544
    s_mov_b64 exec, -1
    s_setprio 2
    s_branch L_XBACK
L_XSLOW:
    s_nop 0
    buffer_load_dwordx2 v[16:17], v3, s[48:51], s60 offen offset:0
    buffer_load_dwordx2 v[18:19], v3, s[48:51], s60 offen offset:2048
    buffer_load_dwordx2 v[20:21], v3, s[48:51], s61 offen offset:0
    buffer_load_dwordx2 v[22:23], v3, s[48:51], s61 offen offset:2048
    buffer_load_dwordx2 v[24:25], v3, s[48:51], s62 offen offset:0
    buffer_load_dwordx2 v[26:27], v3, s[48:51], s62 offen offset:2048
    buffer_load_dwordx2 v[28:29], v3, s[48:51], s63 offen offset:0
    buffer_load_dwordx2 v[30:31], v3, s[48:51], s63 offen offset:2048
    s_waitcnt vmcnt(0)
    s_branch L_XBACK
L_F0:
    s_setprio 2
    s_mov_b32 s61, 7864320
    s_lshl_b32 s7, s2, 2
    s_add_u32 s7, s7, s3
    s_lshl_b32 s13, s2, 6
    s_add_u32 s13, s13, 7864320
    s_lshl_b32 s8, s7, 12
    v_and_b32 v10, 31, v0
    v_lshlrev_b32 v10, 4, v10
    v_lshrrev_b32 v11, 5, v0
    v_lshl_add_u32 v11, v11, 11, v10
    v_add_u32 v11, s8, v11
    s_cmp_lt_u32 s6, 28
    s_cselect_b32 s69, 1, 0
    s_lshr_b32 s8, s6, 2
    s_add_u32 s9, s5, 3
    s_and_b32 s9, s9, 7
    s_min_u32 s9, s9, 6
    s_cmp_lt_u32 s6, 28
    s_cselect_b32 s8, s8, s9
    s_mul_i32 s59, s5, 7
    s_add_u32 s59, s59, s8
    s_and_b32 s68, s6, 3
    s_lshl_b32 s8, s68, 2
    s_add_u32 s8, s8, s3
    s_lshl_b32 s8, s8, 6
    s_xor_b32 s9, s69, 1
    s_lshl_b32 s9, s9, 5
    s_add_u32 s8, s8, s9
    v_lshrrev_b32_e64 v12, 4, v0
    v_lshl_add_u32 v12, v12, 3, s8
    v_lshlrev_b32 v9, 1, v12
    s_movk_i32 s10, 7168
    v_mul_u32_u24 v14, s10, v12
    v_and_b32 v12, 7, v0
    v_lshl_add_u32 v14, v12, 4, v14
    s_lshl_b32 s8, s59, 7
    v_add_u32 v14, s8, v14
    v_and_b32 v12, 8, v0
    v_cmp_ne_u32_e64 vcc, 0, v12
    s_waitcnt lgkmcnt(0)
    global_load_dwordx4 v[16:19], v11, s[16:17] offset:0
    global_load_dwordx4 v[20:23], v11, s[16:17] offset:512
    global_load_dwordx4 v[24:27], v11, s[16:17] offset:1024
    global_load_dwordx4 v[28:31], v11, s[16:17] offset:1536
    s_load_dword s56, s[42:43], 0
    global_load_dwordx4 v[32:35], v10, s[32:33] offset:0
    global_load_dwordx4 v[36:39], v10, s[32:33] offset:512
    global_load_dwordx4 v[40:43], v10, s[32:33] offset:1024
    global_load_dwordx4 v[44:47], v10, s[32:33] offset:1536
    v_mov_b32 v12, s34
    v_mov_b32 v13, s35
    v_mov_b32 v10, s36
    v_mov_b32 v11, s37
    v_cndmask_b32 v12, v12, v10, vcc
    v_cndmask_b32 v13, v13, v11, vcc
    v_add_co_u32 v220, vcc, v12, v14
    s_movk_i32 s20, 7168
    s_mov_b32 s21, 0
    v_addc_co_u32 v221, vcc, 0, v13, vcc
    s_barrier
    s_mov_b32 s48, s16
    s_and_b32 s49, s17, 0xffff
    s_mov_b32 s50, 0x400000
    s_mov_b32 s51, 0x20000
    s_mov_b32 s52, s40
    s_and_b32 s53, s41, 0xffff
    s_mov_b32 s54, 0x400000
    s_mov_b32 s55, 0x20000
    s_lshl_b32 s8, s6, 17
    s_lshl_b32 s9, s3, 15
    s_add_u32 s8, s8, s9
    s_lshl_b32 s9, s5, 8
    s_add_u32 s8, s8, s9
    s_add_u32 s9, s8, 4096
    v_lshrrev_b32 v10, 4, v0
    v_and_b32 v11, 15, v0
    v_lshlrev_b32_e64 v11, 4, v11
    v_lshl_add_u32 v14, v10, 13, v11
    buffer_load_dwordx4 v[64:67], v14, s[48:51], s8 offen offset:0
    buffer_load_dwordx4 v[68:71], v14, s[48:51], s8 offen offset:2048
    buffer_load_dwordx4 v[72:75], v14, s[48:51], s9 offen offset:0
    buffer_load_dwordx4 v[76:79], v14, s[48:51], s9 offen offset:2048
    s_mul_i32 s8, s3, 4608
    s_add_u32 s8, s8, 121856
    s_movk_i32 s9, 1088
    v_mad_u32_u24 v96, v10, s9, v11
    v_add_u32 v96, s8, v96
    v_and_b32 v10, 7, v0
    v_lshrrev_b32_e64 v11, 3, v0
    s_movk_i32 s9, 544
    v_lshl_add_u32 v97, v11, 3, s8
    v_mad_u32_u24 v97, v10, s9, v97
    v_lshlrev_b32_e64 v98, 4, v10
    v_lshl_add_u32 v98, v11, 14, v98
    s_lshl_b32 s18, s5, 19
    s_lshl_b32 s9, s6, 9
    s_add_u32 s18, s18, s9
    s_lshl_b32 s9, s3, 7
    s_add_u32 s18, s18, s9
    s_add_u32 s18, s18, 3145728
    s_getreg_b32 s19, hwreg(HW_REG_XCC_ID, 0, 4)
    s_mov_b32 s22, 179200
    s_cmp_eq_u32 s69, 1
    s_cselect_b32 s22, s22, 0xfffbbc00
    s_cselect_b32 s23, 0, -1
    s_lshl_b32 s62, s5, 2
    s_bfe_u32 s9, s6, 0x20001
    s_add_u32 s62, s62, s9
    s_lshl_b32 s62, s62, 12
    s_lshr_b32 s9, s6, 3
    s_lshl_b32 s9, s9, 1
    s_add_u32 s62, s62, s9
    s_and_b32 s9, s6, 1
    s_add_u32 s62, s62, s9
    s_lshl_b32 s62, s62, 2
    s_add_u32 s62, s62, 7340032
    s_lshl_b32 s19, s19, 1
    s_lshl_b32 s9, s5, 2
    s_lshl_b32 s40, 15, s9
    s_mov_b32 s41, s40
    s_mov_b32 s44, s42
    s_and_b32 s45, s43, 0xffff
    s_mov_b32 s46, 0x1000000
    s_mov_b32 s47, 0x20000
    s_mov_b32 s24, s38
    s_and_b32 s25, s39, 0xffff
    s_mov_b32 s26, 0x700000
    s_mov_b32 s27, 0x20000
    s_lshl_b32 s7, s3, 2
    v_mov_b32 v2, s7
    v_and_b32 v11, 3, v0
    v_lshlrev_b32 v1, 2, v11
    v_mov_b32 v5, 1
    s_lshl_b32 s8, s3, 6
    v_add_u32 v14, s8, v0
    v_lshlrev_b32 v226, 4, v14
    v_lshlrev_b32 v105, 4, v11
    v_lshrrev_b32_e64 v63, 2, v0
    v_lshl_add_u32 v63, v63, 14, v105
    s_lshl_b32 s4, s5, 14
    v_add_u32 v223, 0, v226
    s_mov_b32 s5, 7868416
    s_mov_b32 s6, 7872512
    s_mov_b32 s7, 7876608
    s_cmp_lg_u32 s3, 0
    s_cbranch_scc1 L_NOZ
    v_lshlrev_b32 v224, 4, v0
    v_mov_b32 v228, 0
    v_mov_b32 v229, 0
    v_mov_b32 v230, 0
    v_mov_b32_e64 v231, 0
    ds_write_b128 v224, v[228:231] offset:1024
    ds_write_b128 v224, v[228:231] offset:2048
    ds_write_b128 v224, v[228:231] offset:3072
L_NOZ:
    s_lshl_b32 s4, s3, 6
    v_add_u32 v14, s4, v0
    v_lshlrev_b32_e64 v15, 4, v14
    s_mov_b32 s64, 0x05040100
    s_mov_b32 s65, 0x07060302
    v_lshlrev_b32 v224, 4, v0
    v_and_b32 v10, 15, v0
    v_lshlrev_b32 v10, 2, v10
    v_and_b32 v11, 48, v0
    s_movk_i32 s4, 0xfff
    v_lshlrev_b32 v248, 1, v14
    v_sub_u32 v248, s4, v248
    v_subrev_u32 v249, 1, v248
    v_subrev_u32 v250, 512, v248
    v_subrev_u32 v251, 513, v248
    v_subrev_u32 v252, 1024, v248
    v_subrev_u32 v253, 1025, v248
    v_subrev_u32 v254, 1536, v248
    v_subrev_u32 v255, 1537, v248
    v_lshlrev_b32 v227, 3, v14
    v_lshrrev_b32 v225, 4, v14
    v_lshlrev_b32 v225, 2, v225
    v_lshlrev_b32_e64 v14, 2, v14
    s_mov_b32 s16, 0
    s_mov_b32 s17, 0xffff0000
    v_lshlrev_b32 v3, 3, v11
    s_lshl_b32 s8, s3, 12
    s_add_u32 s8, s8, 140288
    v_add_u32 v3, s8, v3
    v_lshrrev_b32 v12, 5, v0
    v_lshlrev_b32_e64 v4, 7, v12
    v_bfe_u32 v12, v0, 4, 1
    v_lshl_add_u32 v4, v12, 3, v4
    v_bfe_u32 v12, v0, 3, 1
    v_lshl_add_u32 v4, v12, 9, v4
    v_and_b32_e64 v12, 7, v0
    v_lshl_add_u32 v4, v12, 4, v4
    s_lshl_b32 s8, s3, 10
    s_add_u32 s8, s8, 140288
    v_add_u32 v4, s8, v4
    v_bfe_u32 v12, v0, 4, 1
    v_lshlrev_b32 v12, 16, v12
    v_lshrrev_b32 v13, 5, v0
    v_lshl_add_u32 v12, v13, 12, v12
    v_lshl_add_u32 v222, v10, 1, v12
    s_lshl_b32 s10, s59, 17
    s_lshl_b32 s11, s68, 9
    s_add_u32 s10, s10, s11
    s_lshl_b32 s11, s3, 7
    s_add_u32 s10, s10, s11
    s_mov_b32 s8, 0x3f803f80
    s_waitcnt vmcnt(8)
    v_dot2_f32_bf16 v48, v16, s8, 0
    v_dot2_f32_bf16 v49, v16, v16, 0
    v_dot2_f32_bf16 v48, v17, s8, v48
    v_dot2_f32_bf16 v49, v17, v17, v49
    v_dot2_f32_bf16 v48, v18, s8, v48
    v_dot2_f32_bf16 v49, v18, v18, v49
    v_dot2_f32_bf16 v48, v19, s8, v48
    v_dot2_f32_bf16 v49, v19, v19, v49
    v_dot2_f32_bf16 v48, v20, s8, v48
    v_dot2_f32_bf16 v49, v20, v20, v49
    v_dot2_f32_bf16 v48, v21, s8, v48
    v_dot2_f32_bf16 v49, v21, v21, v49
    v_dot2_f32_bf16 v48, v22, s8, v48
    v_dot2_f32_bf16 v49, v22, v22, v49
    v_dot2_f32_bf16 v48, v23, s8, v48
    v_dot2_f32_bf16 v49, v23, v23, v49
    v_dot2_f32_bf16 v48, v24, s8, v48
    v_dot2_f32_bf16 v49, v24, v24, v49
    v_dot2_f32_bf16 v48, v25, s8, v48
    v_dot2_f32_bf16 v49, v25, v25, v49
    v_dot2_f32_bf16 v48, v26, s8, v48
    v_dot2_f32_bf16 v49, v26, v26, v49
    v_dot2_f32_bf16 v48, v27, s8, v48
    v_dot2_f32_bf16 v49, v27, v27, v49
    v_dot2_f32_bf16 v48, v28, s8, v48
    v_dot2_f32_bf16 v49, v28, v28, v49
    v_dot2_f32_bf16 v48, v29, s8, v48
    v_dot2_f32_bf16 v49, v29, v29, v49
    v_dot2_f32_bf16 v48, v30, s8, v48
    v_dot2_f32_bf16 v49, v30, v30, v49
    v_dot2_f32_bf16 v48, v31, s8, v48
    v_dot2_f32_bf16 v49, v31, v31, v49
    s_waitcnt lgkmcnt(0)
    s_mul_i32 s56, s56, 0x9E3779B1
    s_add_u32 s56, s56, 0x7F4A7C15
    s_or_b32 s56, s56, 1
    s_andn2_b32 s56, s56, 0x1e
    s_or_b32 s63, s19, s56
    v_mov_b32 v59, s63
    s_waitcnt vmcnt(4)
    v_dot2_f32_bf16 v50, v16, v32, 0
    v_dot2_f32_bf16 v51, v32, s8, 0
    v_dot2_f32_bf16 v50, v17, v33, v50
    v_dot2_f32_bf16 v51, v33, s8, v51
    v_dot2_f32_bf16 v50, v18, v34, v50
    v_dot2_f32_bf16 v51, v34, s8, v51
    v_dot2_f32_bf16 v50, v19, v35, v50
    v_dot2_f32_bf16 v51, v35, s8, v51
    v_dot2_f32_bf16 v50, v20, v36, v50
    v_dot2_f32_bf16 v51, v36, s8, v51
    v_dot2_f32_bf16 v50, v21, v37, v50
    v_dot2_f32_bf16 v51, v37, s8, v51
    v_dot2_f32_bf16 v50, v22, v38, v50
    v_dot2_f32_bf16 v51, v38, s8, v51
    v_dot2_f32_bf16 v50, v23, v39, v50
    v_dot2_f32_bf16 v51, v39, s8, v51
    v_dot2_f32_bf16 v50, v24, v40, v50
    v_dot2_f32_bf16 v51, v40, s8, v51
    v_dot2_f32_bf16 v50, v25, v41, v50
    v_dot2_f32_bf16 v51, v41, s8, v51
    v_dot2_f32_bf16 v50, v26, v42, v50
    v_dot2_f32_bf16 v51, v42, s8, v51
    v_dot2_f32_bf16 v50, v27, v43, v50
    v_dot2_f32_bf16 v51, v43, s8, v51
    v_dot2_f32_bf16 v50, v28, v44, v50
    v_dot2_f32_bf16 v51, v44, s8, v51
    v_dot2_f32_bf16 v50, v29, v45, v50
    v_dot2_f32_bf16 v51, v45, s8, v51
    v_dot2_f32_bf16 v50, v30, v46, v50
    v_dot2_f32_bf16 v51, v46, s8, v51
    v_dot2_f32_bf16 v50, v31, v47, v50
    v_dot2_f32_bf16 v51, v47, s8, v51
    s_nop 0
    s_nop 0
    v_add_f32_dpp v48, v48, v48 row_shr:1 row_mask:0xf bank_mask:0xf
    v_add_f32_dpp v49, v49, v49 row_shr:1 row_mask:0xf bank_mask:0xf
    v_add_f32_dpp v50, v50, v50 row_shr:1 row_mask:0xf bank_mask:0xf
    v_add_f32_dpp v51, v51, v51 row_shr:1 row_mask:0xf bank_mask:0xf
    v_add_f32_dpp v48, v48, v48 row_shr:2 row_mask:0xf bank_mask:0xf
    v_add_f32_dpp v49, v49, v49 row_shr:2 row_mask:0xf bank_mask:0xf
    v_add_f32_dpp v50, v50, v50 row_shr:2 row_mask:0xf bank_mask:0xf
    v_add_f32_dpp v51, v51, v51 row_shr:2 row_mask:0xf bank_mask:0xf
    v_add_f32_dpp v48, v48, v48 row_shr:4 row_mask:0xf bank_mask:0xf
    v_add_f32_dpp v49, v49, v49 row_shr:4 row_mask:0xf bank_mask:0xf
    v_add_f32_dpp v50, v50, v50 row_shr:4 row_mask:0xf bank_mask:0xf
    v_add_f32_dpp v51, v51, v51 row_shr:4 row_mask:0xf bank_mask:0xf
    v_add_f32_dpp v48, v48, v48 row_shr:8 row_mask:0xf bank_mask:0xf
    v_add_f32_dpp v49, v49, v49 row_shr:8 row_mask:0xf bank_mask:0xf
    v_add_f32_dpp v50, v50, v50 row_shr:8 row_mask:0xf bank_mask:0xf
    v_add_f32_dpp v51, v51, v51 row_shr:8 row_mask:0xf bank_mask:0xf
    v_add_f32_dpp v48, v48, v48 row_bcast:15 row_mask:0xa bank_mask:0xf
    v_add_f32_dpp v49, v49, v49 row_bcast:15 row_mask:0xa bank_mask:0xf
    v_add_f32_dpp v50, v50, v50 row_bcast:15 row_mask:0xa bank_mask:0xf
    v_add_f32_dpp v51, v51, v51 row_bcast:15 row_mask:0xa bank_mask:0xf
    v_mul_f32 v48, 0x3a800000, v48
    v_mul_f32 v49, 0x3a800000, v49
    v_cvt_pk_bf16_f32 v52, v48, v48
    v_fma_f32 v49, -v48, v48, v49
    v_max_f32_e64 v49, 0, v49
    v_and_b32 v53, 0xffff0000, v52
    v_cvt_pk_bf16_f32 v49, v49, v49
    v_and_b32 v49, 0xffff0000, v49
    v_add_f32 v49, 0x3727c5ac, v49
    v_fma_f32 v50, -v53, v51, v50
    v_cvt_pk_bf16_f32 v49, v49, v49
    v_and_b32 v49, 0xffff0000, v49
    v_sqrt_f32 v49, v49
    v_lshlrev_b32 v104, 2, v2
    v_mov_b32 v61, 0
    v_and_b32 v62, 62, v0
    v_mad_u32_u24 v62, v62, 3, v0
    v_lshlrev_b32_e64 v62, 6, v62
    v_cvt_pk_bf16_f32 v54, v49, v49
    v_and_b32 v49, 0xffff0000, v54
    v_rcp_f32 v49, v49
    s_nop 0
    v_mul_f32_e64 v50, v50, v49
    v_cvt_pk_bf16_f32 v50, v50, v50
    v_bfe_i32 v51, v50, 15, 1
    v_or_b32 v51, 0x80008000, v51
    v_xor_b32_e64 v55, v50, v51
    s_mov_b32 s8, 0xffff
    v_mov_b32_dpp v56, v52 row_bcast:31 row_mask:0x8 bank_mask:0xf
    v_mov_b32_dpp v57, v54 row_bcast:31 row_mask:0x8 bank_mask:0xf
    v_mov_b32_dpp v58, v55 row_bcast:31 row_mask:0x8 bank_mask:0xf
    v_bfi_b32 v56, s8, v56, v52
    v_bfi_b32 v57, s8, v57, v54
    v_bfi_b32 v58, s8, v58, v55
    s_brev_b64 exec, 1
    ds_write_b128 v104, v[56:59] offset:576
    ds_add_rtn_u32 v60, v61, v5 offset:512
    s_mov_b64 exec, -1
    s_waitcnt lgkmcnt(0)
    v_readlane_b32 s8, v60, 63
    s_cmp_lg_u32 s8, 3
    s_cbranch_scc1 L_NOPUB
    s_bfm_b64 exec, 4, 0
    ds_read_b128 v[52:55], v105 offset:576
    s_waitcnt lgkmcnt(0)
    buffer_store_dwordx4 v[52:55], v63, s[44:47], s13 offen sc1
    ds_write_b32 v61, v5 offset:516
    s_mov_b64 exec, -1
    s_waitcnt vmcnt(1)
    s_branch L_PUB2
L_NOPUB:
    s_waitcnt vmcnt(0)
L_PUB2:
    s_nop 0
    ds_write_b128 v96, v[64:67] offset:0
    ds_write_b128 v96, v[68:71] offset:272
    ds_write_b128 v96, v[72:75] offset:544
    ds_write_b128 v96, v[76:79] offset:816
    ds_read_b64 v[80:81], v97 offset:0
    ds_read_b64 v[82:83], v97 offset:272
    ds_read_b64 v[84:85], v97 offset:64
    ds_read_b64 v[86:87], v97 offset:336
    ds_read_b64 v[88:89], v97 offset:128
    ds_read_b64 v[90:91], v97 offset:400
    ds_read_b64 v[92:93], v97 offset:192
    ds_read_b64 v[94:95], v97 offset:464
    s_waitcnt lgkmcnt(6)
    buffer_store_dwordx4 v[80:83], v98, s[44:47], s18 offen
    s_add_u32 s18, s18, 0x20000
    s_waitcnt lgkmcnt(4)
    buffer_store_dwordx4 v[84:87], v98, s[44:47], s18 offen
    s_add_u32 s18, s18, 0x20000
    s_waitcnt lgkmcnt(2)
    buffer_store_dwordx4 v[88:91], v98, s[44:47], s18 offen
    s_add_u32 s18, s18, 0x20000
    s_waitcnt lgkmcnt(0)
    buffer_store_dwordx4 v[92:95], v98, s[44:47], s18 offen
    s_add_u32 s18, s18, 0x20000
    s_mov_b64 exec, 1
    ds_write_b32 v2, v59 offset:128
    s_mov_b64 exec, -1
LW_9:
    ds_read_b32 v60, v61 offset:516
    s_waitcnt lgkmcnt(0)
    v_cmp_eq_u32_e64 vcc, 0, v60
    s_cbranch_vccnz LW_9
    s_waitcnt vmcnt(0)
    s_mov_b64 exec, 1
    ds_add_rtn_u32 v60, v61, v5 offset:520
    s_waitcnt lgkmcnt(0)
    v_readfirstlane_b32 s8, v60
    s_cmp_lg_u32 s8, 3
    s_mov_b64 exec, -1
    s_cbranch_scc1 L_NOXF
    s_nop 0
    buffer_store_dword v59, v62, s[44:47], s62 offen offset:0
    buffer_store_dword v59, v62, s[44:47], s62 offen offset:128
    buffer_store_dword v59, v62, s[44:47], s62 offen offset:256
L_NOXF:
    global_load_dwordx4 v[112:115], v[220:221], off
    v_lshl_add_u64 v[220:221], s[20:21], 0, v[220:221]
    global_load_dwordx4 v[116:119], v[220:221], off
    v_lshl_add_u64 v[220:221], s[20:21], 0, v[220:221]
    global_load_dwordx4 v[120:123], v[220:221], off
    v_lshl_add_u64 v[220:221], s[20:21], 0, v[220:221]
    global_load_dwordx4 v[124:127], v[220:221], off
    v_lshl_add_u64 v[220:221], s[20:21], 0, v[220:221]
    s_waitcnt vmcnt(3)
    s_nop 0
    global_load_dwordx4 v[128:131], v[220:221], off
    v_lshl_add_u64 v[220:221], s[20:21], 0, v[220:221]
    buffer_load_dwordx4 v[32:35], v223, s[44:47], s61 offen sc1
    buffer_load_dwordx4 v[36:39], v223, s[44:47], s5 offen sc1
    buffer_load_dwordx4 v[40:43], v223, s[44:47], s6 offen sc1
    buffer_load_dwordx4 v[44:47], v223, s[44:47], s7 offen sc1
    s_waitcnt vmcnt(0)
    s_branch L_KPW
L_KP:
    s_sleep 1
L_KQ2:
    s_mov_b64 exec, s[30:31]
    s_cbranch_execz L_KS0
    buffer_load_dwordx4 v[32:35], v223, s[44:47], s61 offen sc1
L_KS0:
    s_mov_b64 exec, s[8:9]
    s_cbranch_execz L_KS1
    buffer_load_dwordx4 v[36:39], v223, s[44:47], s5 offen sc1
L_KS1:
    s_mov_b64 exec, s[14:15]
    s_cbranch_execz L_KS2
    buffer_load_dwordx4 v[40:43], v223, s[44:47], s6 offen sc1
L_KS2:
    s_mov_b64 exec, s[28:29]
    s_cbranch_execz L_KS3
    buffer_load_dwordx4 v[44:47], v223, s[44:47], s7 offen sc1
L_KS3:
    s_mov_b64 exec, -1
    s_waitcnt vmcnt(0)
L_KPW:
    s_add_u32 s16, s16, 1
    v_xor_b32 v16, s63, v35
    v_xor_b32 v17, s63, v39
    v_xor_b32 v18, s63, v43
    v_xor_b32 v19, s63, v47
    v_cmp_lt_u32 s[30:31], 31, v16
    v_cmp_lt_u32 s[8:9], 31, v17
    v_cmp_lt_u32 s[14:15], 31, v18
    v_cmp_lt_u32 s[28:29], 31, v19
    v_or3_b32 v16, v16, v17, v18
    s_or_b64 vcc, s[30:31], s[8:9]
    s_or_b64 s[66:67], s[14:15], s[28:29]
    s_or_b64 vcc, vcc, s[66:67]
    s_cbranch_vccz L_KPOK
    s_cmp_lt_u32 s16, 0x4000
    s_cbranch_scc1 L_KP
L_KPOK:
    v_or_b32 v16, v16, v19
    v_cmp_ne_u32 vcc, 0, v16
    s_and_b64 vcc, vcc, s[40:41]
    s_cselect_b32 s8, 1, 2
    v_mov_b32 v16, s8
    ds_read_b32 v17, v1 offset:544
    ds_write2st64_b64 v227, v[32:33], v[36:37] offset0:18 offset1:22
    ds_write2st64_b64 v227, v[40:41], v[44:45] offset0:26 offset1:30
    s_mov_b64 exec, 1
    ds_write_b32 v2, v16 offset:528
    s_mov_b64 exec, -1
    v_lshl_or_b32 v248, v34, 16, v248
    v_and_or_b32 v249, v34, s17, v249
    v_lshl_or_b32 v250, v38, 16, v250
    v_and_or_b32 v251, v38, s17, v251
    v_lshl_or_b32 v252, v42, 16, v252
    v_and_or_b32 v253, v42, s17, v253
    v_lshl_or_b32 v254, v46, 16, v254
    v_and_or_b32 v255, v46, s17, v255
    s_waitcnt lgkmcnt(3)
    v_cmp_eq_u32 s[66:67], 0, v17
    s_cmp_lg_u32 s66, 0
    s_cbranch_scc1 L_NB0
    s_nop 0
    global_load_dwordx4 v[132:135], v[220:221], off
    v_lshl_add_u64 v[220:221], s[20:21], 0, v[220:221]
    global_load_dwordx4 v[136:139], v[220:221], off
    v_lshl_add_u64 v[220:221], s[20:21], 0, v[220:221]
    global_load_dwordx4 v[140:143], v[220:221], off
    v_lshl_add_u64 v[220:221], s[22:23], 0, v[220:221]
    global_load_dwordx4 v[144:147], v[220:221], off
    v_lshl_add_u64 v[220:221], s[20:21], 0, v[220:221]
L_NB0:
    v_max_u32 v226, v248, v249
    v_min_u32 v227, v248, v249
    v_max_u32 v228, v252, v253
    v_min_u32 v229, v252, v253
    v_med3_u32 v227, v226, v227, v250
    v_med3_u32 v229, v228, v229, v254
    v_max_u32 v226, v226, v250
    v_max_u32 v228, v228, v254
    v_med3_u32 v227, v226, v227, v251
    v_med3_u32 v229, v228, v229, v255
    v_max_u32 v226, v226, v251
    v_max_u32 v228, v228, v255
    v_min_u32 v230, v226, v228
    v_max_u32 v226, v226, v228
    v_max3_u32 v227, v227, v229, v230
    ds_write_b32 v14, v226 offset:8192
    ds_read_b32 v17, v1 offset:544
    v_add_u32 v15, 4096, v15
    v_max_u32_dpp v226, v226, v226 row_shr:1 row_mask:0xf bank_mask:0xf
    v_max_u32_dpp v227, v227, v227 row_shr:1 row_mask:0xf bank_mask:0xf
    ds_write2_b32 v15, v34, v38 offset0:0 offset1:1
    v_max_u32_dpp v226, v226, v226 row_shr:2 row_mask:0xf bank_mask:0xf
    v_max_u32_dpp v227, v227, v227 row_shr:2 row_mask:0xf bank_mask:0xf
    ds_write2_b32 v15, v42, v46 offset0:2 offset1:3
    v_max_u32_dpp v226, v226, v226 row_shr:4 row_mask:0xf bank_mask:0xf
    v_max_u32_dpp v227, v227, v227 row_shr:4 row_mask:0xf bank_mask:0xf
    s_nop 0
    s_nop 0
    v_max_u32_dpp v226, v226, v226 row_shr:8 row_mask:0xf bank_mask:0xf
    v_max_u32_dpp v227, v227, v227 row_shr:8 row_mask:0xf bank_mask:0xf
    s_mov_b32 exec_lo, 0x80008000
    s_mov_b32 exec_hi, 0x80008000
    ds_write2_b32 v225, v226, v227 offset0:96 offset1:112
    s_mov_b64 exec, 1
    ds_write_b32 v2, v16 offset:64
    s_mov_b64 exec, -1
    s_waitcnt lgkmcnt(4)
    v_cmp_eq_u32 vcc, 0, v17
    s_mov_b32 s67, vcc_lo
    s_cbranch_vccnz L_NB1
    s_cmp_eq_u32 s66, 0
    s_cbranch_scc1 L_NB2
    global_load_dwordx4 v[132:135], v[220:221], off
    v_lshl_add_u64 v[220:221], s[20:21], 0, v[220:221]
    global_load_dwordx4 v[136:139], v[220:221], off
    v_lshl_add_u64 v[220:221], s[20:21], 0, v[220:221]
    global_load_dwordx4 v[140:143], v[220:221], off
    v_lshl_add_u64 v[220:221], s[22:23], 0, v[220:221]
    global_load_dwordx4 v[144:147], v[220:221], off
    v_lshl_add_u64 v[220:221], s[20:21], 0, v[220:221]
L_NB2:
    global_load_dwordx4 v[148:151], v[220:221], off
    v_lshl_add_u64 v[220:221], s[20:21], 0, v[220:221]
    global_load_dwordx4 v[152:155], v[220:221], off
    v_lshl_add_u64 v[220:221], s[20:21], 0, v[220:221]
    global_load_dwordx4 v[156:159], v[220:221], off
    v_lshl_add_u64 v[220:221], s[20:21], 0, v[220:221]
    global_load_dwordx4 v[160:163], v[220:221], off
    v_lshl_add_u64 v[220:221], s[20:21], 0, v[220:221]
L_NB1:
LW_10:
    ds_read_b32 v225, v1 offset:64
    s_waitcnt lgkmcnt(0)
    v_cmp_eq_u32_e64 vcc, 0, v225
    s_cbranch_vccnz LW_10
    v_cmp_ne_u32 s[12:13], 2, v225
    ds_read2_b32 v[226:227], v10 offset0:96 offset1:112
    ds_read_b128 v[228:231], v11 offset:384
    ds_read_b128 v[232:235], v224 offset:8192
    s_waitcnt lgkmcnt(1)
    v_cmp_gt_u32 vcc, v228, v226
    v_cmp_gt_u32 s[8:9], v229, v226
    v_cmp_gt_u32 s[14:15], v230, v226
    v_cmp_gt_u32 s[28:29], v231, v226
    v_cndmask_b32 v236, 0, 1, vcc
    v_cndmask_b32 v237, 0, 1, s[8:9]
    v_addc_co_u32 v236, vcc, 0, v236, s[14:15]
    v_addc_co_u32 v236, vcc, v237, v236, s[28:29]
    v_mov_b32 v237, v236
    s_nop 1
    v_permlane32_swap_b32 v236, v237
    v_add_u32 v236, v236, v237
    v_mov_b32 v237, v236
    s_nop 1
    v_permlane16_swap_b32 v236, v237
    v_add_u32 v236, v236, v237
    v_cmp_eq_u32 vcc, 7, v236
    s_ff1_i32_b32 s5, vcc_lo
    v_readlane_b32 s4, v226, s5
    s_waitcnt lgkmcnt(0)
    s_nop 0
    v_cmp_le_u32 vcc, s4, v227
    s_cbranch_vccnz L_SLOWT
L_CAND:
    v_cmp_le_u32 s[8:9], s4, v232
    v_cmp_le_u32 s[14:15], s4, v233
    v_cmp_le_u32 s[28:29], s4, v234
    v_cmp_le_u32 s[30:31], s4, v235
    s_bcnt1_i32_b64 s5, s[8:9]
    s_bcnt1_i32_b64 s6, s[14:15]
    s_bcnt1_i32_b64 s7, s[28:29]
    s_bcnt1_i32_b64 s16, s[30:31]
    s_add_u32 s6, s6, s5
    s_add_u32 s7, s7, s6
    s_add_u32 s16, s16, s7
    s_cmp_gt_u32 s16, 16
    s_cbranch_scc1 L_TRIM
    v_mbcnt_lo_u32_b32 v236, s8, 0
    v_mbcnt_hi_u32_b32 v236, s9, v236
    v_add_lshl_u32 v236, v236, 0, 2
    s_mov_b64 exec, s[8:9]
    ds_write_b32 v236, v232 offset:192
    s_mov_b64 exec, -1
    v_mbcnt_lo_u32_b32 v237, s14, 0
    v_mbcnt_hi_u32_b32 v237, s15, v237
    v_add_lshl_u32 v237, v237, s5, 2
    s_mov_b64 exec, s[14:15]
    ds_write_b32 v237, v233 offset:192
    s_mov_b64 exec, -1
    v_mbcnt_lo_u32_b32 v238, s28, 0
    v_mbcnt_hi_u32_b32 v238, s29, v238
    v_add_lshl_u32 v238, v238, s6, 2
    s_mov_b64 exec, s[28:29]
    ds_write_b32 v238, v234 offset:192
    s_mov_b64 exec, -1
    v_mbcnt_lo_u32_b32 v239, s30, 0
    v_mbcnt_hi_u32_b32 v239, s31, v239
    v_add_lshl_u32 v239, v239, s7, 2
    s_mov_b64 exec, s[30:31]
    ds_write_b32 v239, v235 offset:192
    s_mov_b64 exec, -1
    s_cmp_eq_u32 s67, 0
    s_cbranch_scc1 L_NB3
    s_nop 0
    global_load_dwordx4 v[132:135], v[220:221], off
    v_lshl_add_u64 v[220:221], s[20:21], 0, v[220:221]
    global_load_dwordx4 v[136:139], v[220:221], off
    v_lshl_add_u64 v[220:221], s[20:21], 0, v[220:221]
    global_load_dwordx4 v[140:143], v[220:221], off
    v_lshl_add_u64 v[220:221], s[22:23], 0, v[220:221]
    global_load_dwordx4 v[144:147], v[220:221], off
    v_lshl_add_u64 v[220:221], s[20:21], 0, v[220:221]
    global_load_dwordx4 v[148:151], v[220:221], off
    v_lshl_add_u64 v[220:221], s[20:21], 0, v[220:221]
    global_load_dwordx4 v[152:155], v[220:221], off
    v_lshl_add_u64 v[220:221], s[20:21], 0, v[220:221]
    global_load_dwordx4 v[156:159], v[220:221], off
    v_lshl_add_u64 v[220:221], s[20:21], 0, v[220:221]
    global_load_dwordx4 v[160:163], v[220:221], off
    v_lshl_add_u64 v[220:221], s[20:21], 0, v[220:221]
L_NB3:
    global_load_dwordx4 v[164:167], v[220:221], off
    v_lshl_add_u64 v[220:221], s[20:21], 0, v[220:221]
    global_load_dwordx4 v[168:171], v[220:221], off
    v_lshl_add_u64 v[220:221], s[20:21], 0, v[220:221]
    global_load_dwordx4 v[172:175], v[220:221], off
    s_movk_i32 s4, 0x7ff
    ds_read_b32 v16, v10 offset:192
    ds_read_b128 v[20:23], v11 offset:192
    s_cmp_lg_u32 s69, 1
    s_waitcnt lgkmcnt(1)
    v_bfi_b32 v14, v16, 0, s4
    s_cbranch_scc1 L_NOXS
    v_lshl_add_u32 v15, v14, 11, v9
    buffer_load_dwordx4 v[208:211], v15, s[48:51], 0 offen
    buffer_load_dwordx4 v[212:215], v15, s[48:51], 0 offen offset:64
    v_lshrrev_b32 v15, 1, v14
    v_lshlrev_b32 v15, 3, v15
    ds_read_b64 v[8:9], v15 offset:9216
L_NOXS:
    s_waitcnt lgkmcnt(0)
    v_cmp_gt_u32 vcc, v20, v16
    v_cmp_gt_u32 s[8:9], v21, v16
    v_cmp_gt_u32 s[14:15], v22, v16
    v_cmp_gt_u32 s[28:29], v23, v16
    v_cndmask_b32 v24, 0, 1, vcc
    v_cndmask_b32 v25, 0, 1, s[8:9]
    v_addc_co_u32 v24, vcc, 0, v24, s[14:15]
    v_addc_co_u32 v24, vcc, v25, v24, s[28:29]
    v_mov_b32 v25, v24
    s_nop 1
    v_permlane32_swap_b32 v24, v25
    v_add_u32 v24, v24, v25
    v_mov_b32 v25, v24
    s_nop 1
    v_permlane16_swap_b32 v24, v25
    v_add_u32 v24, v24, v25
    v_cmp_gt_u32 s[30:31], 8, v24
    v_lshlrev_b32 v15, 2, v24
    v_and_b32 v10, 7, v0
    v_lshlrev_b32_e64 v10, 2, v10
    v_bfe_u32 v20, v14, 1, 8
    v_lshrrev_b32 v21, 9, v14
    v_lshlrev_b32 v20, 3, v20
    v_lshl_add_u32 v20, v21, 1, v20
    v_and_b32 v14, 1, v14
    v_add_u32 v20, v20, v14
    v_mov_b32 v22, 0x80
    s_mov_b64 exec, s[30:31]
    ds_write_b32 v15, v16 offset:256
    s_cmp_lg_u32 s3, 0
    s_cbranch_scc1 L_NOSEL
    ds_write_b8 v20, v22 offset:1152
    s_cmp_lg_u32 s2, 255
    s_cbranch_scc1 L_NOSEL
    s_mov_b64 exec, 1
    v_mov_b32 v22, s56
    buffer_store_dword v22, v2, s[44:47], 0 offen sc1
L_NOSEL:
    s_mov_b64 exec, -1
    ds_read_b32 v7, v10 offset:256
    s_mov_b64 exec, 1
    ds_write_b32 v2, v5 offset:112
    s_mov_b64 exec, -1
    s_movk_i32 s4, 0x7ff
    v_lshrrev_b32 v221, 3, v0
    s_lshl_b32 s8, s3, 3
    v_add_lshl_u32 v221, v221, s8, 15
    v_and_b32 v225, 7, v0
    v_lshlrev_b32 v225, 4, v225
    v_add_u32_e64 v221, v221, v225
    v_bfe_u32 v226, v0, 3, 2
    v_bfrev_b32 v220, v226
    v_lshrrev_b32 v220, 22, v220
    v_add_u32 v220, v220, v225
    v_lshrrev_b32_e64 v220, 2, v220
    s_lshl_b32 s8, s57, 3
    s_mov_b32 s32, 0
    s_waitcnt lgkmcnt(1)
    v_bfi_b32 v224, v7, 0, s4
    v_lshlrev_b32_e64 v223, 11, v224
    v_lshl_add_u32 v223, v226, 1, v223
    v_add_u32_e64 v223, s8, v223
    buffer_load_ushort v246, v223, s[48:51], 0 offen
    v_lshlrev_b32_e64 v247, 13, v226
    v_lshl_add_u32 v247, v224, 2, v247
    v_lshrrev_b32 v225, 1, v224
    v_and_b32 v225, 0x30, v225
    v_xor_b32_e64 v247, v247, v225
    v_add_u32 v247, 17408, v247
LW_11:
    ds_read_b32 v224, v1 offset:112
    s_waitcnt lgkmcnt(0)
    v_cmp_eq_u32 vcc, 0, v224
    s_cbranch_vccnz LW_11
    s_lshr_b32 s8, s2, 3
    s_and_b32 s9, s2, 7
    s_lshr_b32 s39, s58, 1
    s_add_u32 s39, s39, 0
    v_lshrrev_b32 v253, 3, v0
    v_and_b32 v254, 7, v0
    s_lshl_b32 s38, s8, 5
    s_add_u32 s38, s38, s39
    v_lshrrev_b32 v252, 4, v0
    v_lshl_add_u32 v252, v252, 2, s38
    v_and_b32_e64 v251, 1, v253
    v_lshl_add_u32 v252, v252, 1, v251
    ds_read_u8 v255, v252 offset:1152
    ds_read_u8 v252, v252 offset:1184
    s_mul_i32 s38, s58, 4096
    s_add_u32 s38, s38, 140288
    v_lshl_add_u32 v249, v253, 3, s38
    v_lshl_add_u32 v250, v254, 4, s38
    s_movk_i32 s38, 288
    v_mad_u32_u24 v249, v254, s38, v249
    s_movk_i32 s38, 144
    v_mad_u32_u24 v250, v253, s38, v250
    v_lshlrev_b32_e64 v254, 4, v254
    v_lshl_add_u32 v248, v253, 14, v254
    v_lshl_add_u32 v253, v253, 11, v254
    s_and_b32 s38, s58, 1
    s_lshl_b32 s35, s9, 1
    s_add_u32 s35, s35, s38
    s_lshl_b32 s39, s39, 5
    s_add_u32 s39, s39, s8
    s_lshl_b32 s34, s35, 18
    s_lshl_b32 s38, s39, 7
    s_add_u32 s34, s34, s38
    s_add_u32 s34, s34, 3145728
    s_lshl_b32 s36, s39, 15
    s_lshl_b32 s35, s35, 7
    s_add_u32 s36, s36, s35
    s_add_u32 s37, s36, 0x4000
    s_add_u32 s35, s34, 0x20000
    s_lshl_b32 s38, s9, 5
    s_lshr_b32 s8, s8, 3
    s_add_u32 s38, s38, s8
    s_lshl_b32 s38, s38, 7
    s_add_u32 s38, s38, 983040
    s_mov_b32 s39, 0
    s_waitcnt lgkmcnt(0)
    v_lshl_or_b32 v251, v255, 24, v253
    v_lshl_or_b32 v252, v252, 24, v253
    v_lshlrev_b32 v255, 2, v0
    v_lshrrev_b32_e64 v254, 16, v7
    v_bfe_i32 v224, v254, 15, 1
    v_not_b32_e64 v224, v224
    v_or_b32 v224, 0x8000, v224
    v_xor_b32 v254, v254, v224
    v_lshlrev_b32 v254, 16, v254
    v_mul_f32 v254, 0xbfb8aa3b, v254
    v_exp_f32 v254, v254
    v_mov_b32 v253, s63
    v_add_f32 v254, 1.0, v254
    v_rcp_f32 v254, v254
    s_cmp_lg_u32 s69, 1
    s_cbranch_scc1 L_GATHER
    v_lshl_add_u32 v3, v24, 4, v3
    v_lshlrev_b32 v14, 4, v14
    v_lshlrev_b32_e64 v13, 4, v0
    s_lshl_b32 s4, s59, 14
    s_add_u32 s4, s4, 65536
    s_lshl_b32 s6, s3, 12
    s_add_u32 s6, s6, s4
    s_lshl_b32 s5, s68, 10
    s_add_u32 s5, s5, s6
    v_mov_b32 v218, s56
    v_lshrrev_b32 v6, v14, v9
    v_lshrrev_b32 v8, v14, v8
    v_lshlrev_b32 v6, 16, v6
    v_xor_b32 v8, 0x8000, v8
    v_rcp_f32_e64 v6, v6
    v_perm_b32 v240, v8, v8, s64
    v_perm_b32 v241, v8, v8, s64
    v_perm_b32 v242, v8, v8, s64
    v_perm_b32 v243, v8, v8, s64
    s_add_u32 s11, s10, 0
    s_nop 0
    buffer_load_dwordx2 v[176:177], v222, s[24:27], s11 offen
    s_add_u32 s11, s10, 16384
    buffer_load_dwordx2 v[178:179], v222, s[24:27], s11 offen
    s_add_u32 s11, s10, 2048
    buffer_load_dwordx2 v[180:181], v222, s[24:27], s11 offen
    s_add_u32 s11, s10, 18432
    buffer_load_dwordx2 v[182:183], v222, s[24:27], s11 offen
    s_add_u32 s11, s10, 32768
    buffer_load_dwordx2 v[184:185], v222, s[24:27], s11 offen
    s_add_u32 s11, s10, 49152
    buffer_load_dwordx2 v[186:187], v222, s[24:27], s11 offen
    s_add_u32 s11, s10, 34816
    buffer_load_dwordx2 v[188:189], v222, s[24:27], s11 offen
    s_add_u32 s11, s10, 51200
    buffer_load_dwordx2 v[190:191], v222, s[24:27], s11 offen
    s_waitcnt vmcnt(19)
    s_nop 0
    v_perm_b32 v48, v116, v112, s64
    v_perm_b32 v52, v116, v112, s65
    v_perm_b32 v49, v124, v120, s64
    v_perm_b32 v53, v124, v120, s65
    v_perm_b32 v50, v132, v128, s64
    v_perm_b32 v54, v132, v128, s65
    v_perm_b32 v51, v140, v136, s64
    v_perm_b32 v55, v140, v136, s65
    v_perm_b32 v56, v117, v113, s64
    v_perm_b32 v60, v117, v113, s65
    v_perm_b32 v57, v125, v121, s64
    v_perm_b32 v61, v125, v121, s65
    v_perm_b32 v58, v133, v129, s64
    v_perm_b32 v62, v133, v129, s65
    v_perm_b32 v59, v141, v137, s64
    v_perm_b32 v63, v141, v137, s65
    v_perm_b32 v64, v118, v114, s64
    v_perm_b32 v68, v118, v114, s65
    v_perm_b32 v65, v126, v122, s64
    v_perm_b32 v69, v126, v122, s65
    v_perm_b32 v66, v134, v130, s64
    v_perm_b32 v70, v134, v130, s65
    v_perm_b32 v67, v142, v138, s64
    v_perm_b32 v71, v142, v138, s65
    v_perm_b32 v72, v119, v115, s64
    v_perm_b32 v76, v119, v115, s65
    v_perm_b32 v73, v127, v123, s64
    v_perm_b32 v77, v127, v123, s65
    v_perm_b32 v74, v135, v131, s64
    v_perm_b32 v78, v135, v131, s65
    v_perm_b32 v75, v143, v139, s64
    v_perm_b32 v79, v143, v139, s65
    s_waitcnt vmcnt(11)
    s_nop 0
    v_mfma_f32_16x16x32_bf16 v[16:19], v[48:51], v[240:243], 0
    v_perm_b32 v80, v148, v144, s64
    v_perm_b32 v84, v148, v144, s65
    v_perm_b32 v81, v156, v152, s64
    v_perm_b32 v85, v156, v152, s65
    v_mfma_f32_16x16x32_bf16 v[20:23], v[52:55], v[240:243], 0
    v_perm_b32 v82, v164, v160, s64
    v_perm_b32 v86, v164, v160, s65
    v_perm_b32 v83, v172, v168, s64
    v_perm_b32 v87, v172, v168, s65
    v_mfma_f32_16x16x32_bf16 v[24:27], v[56:59], v[240:243], 0
    v_perm_b32 v88, v149, v145, s64
    v_perm_b32 v92, v149, v145, s65
    v_perm_b32 v89, v157, v153, s64
    v_perm_b32 v93, v157, v153, s65
    v_mfma_f32_16x16x32_bf16 v[28:31], v[60:63], v[240:243], 0
    v_perm_b32 v90, v165, v161, s64
    v_perm_b32 v94, v165, v161, s65
    v_perm_b32 v91, v173, v169, s64
    v_perm_b32 v95, v173, v169, s65
    v_mfma_f32_16x16x32_bf16 v[32:35], v[64:67], v[240:243], 0
    v_perm_b32 v96, v150, v146, s64
    v_perm_b32 v100, v150, v146, s65
    v_perm_b32 v97, v158, v154, s64
    v_perm_b32 v101, v158, v154, s65
    v_mfma_f32_16x16x32_bf16 v[36:39], v[68:71], v[240:243], 0
    v_perm_b32 v98, v166, v162, s64
    v_perm_b32 v102, v166, v162, s65
    v_perm_b32 v99, v174, v170, s64
    v_perm_b32 v103, v174, v170, s65
    v_mfma_f32_16x16x32_bf16 v[40:43], v[72:75], v[240:243], 0
    v_perm_b32 v104, v151, v147, s64
    v_perm_b32 v108, v151, v147, s65
    v_perm_b32 v105, v159, v155, s64
    v_perm_b32 v109, v159, v155, s65
    v_mfma_f32_16x16x32_bf16 v[44:47], v[76:79], v[240:243], 0
    v_perm_b32 v106, v167, v163, s64
    v_perm_b32 v110, v167, v163, s65
    v_perm_b32 v107, v175, v171, s64
    v_perm_b32 v111, v175, v171, s65
    v_mfma_f32_16x16x32_bf16 v[16:19], v[80:83], v[240:243], v[16:19]
    v_mfma_f32_16x16x32_bf16 v[20:23], v[84:87], v[240:243], v[20:23]
    v_mfma_f32_16x16x32_bf16 v[24:27], v[88:91], v[240:243], v[24:27]
    v_mfma_f32_16x16x32_bf16 v[28:31], v[92:95], v[240:243], v[28:31]
    v_mfma_f32_16x16x32_bf16 v[32:35], v[96:99], v[240:243], v[32:35]
    v_mfma_f32_16x16x32_bf16 v[36:39], v[100:103], v[240:243], v[36:39]
    v_mfma_f32_16x16x32_bf16 v[40:43], v[104:107], v[240:243], v[40:43]
    v_mfma_f32_16x16x32_bf16 v[44:47], v[108:111], v[240:243], v[44:47]
    s_waitcnt vmcnt(9)
    s_nop 0
    v_mfma_f32_16x16x32_bf16 v[16:19], v[48:51], v[208:211], v[16:19]
    s_add_u32 s11, s10, 8192
    buffer_load_dwordx2 v[192:193], v222, s[24:27], s11 offen
    v_mfma_f32_16x16x32_bf16 v[20:23], v[52:55], v[208:211], v[20:23]
    s_add_u32 s11, s10, 24576
    buffer_load_dwordx2 v[194:195], v222, s[24:27], s11 offen
    v_mfma_f32_16x16x32_bf16 v[24:27], v[56:59], v[208:211], v[24:27]
    s_add_u32 s11, s10, 10240
    buffer_load_dwordx2 v[196:197], v222, s[24:27], s11 offen
    v_mfma_f32_16x16x32_bf16 v[28:31], v[60:63], v[208:211], v[28:31]
    s_add_u32 s11, s10, 26624
    buffer_load_dwordx2 v[198:199], v222, s[24:27], s11 offen
    v_mfma_f32_16x16x32_bf16 v[32:35], v[64:67], v[208:211], v[32:35]
    s_add_u32 s11, s10, 40960
    buffer_load_dwordx2 v[200:201], v222, s[24:27], s11 offen
    v_mfma_f32_16x16x32_bf16 v[36:39], v[68:71], v[208:211], v[36:39]
    s_add_u32 s11, s10, 57344
    buffer_load_dwordx2 v[202:203], v222, s[24:27], s11 offen
    v_mfma_f32_16x16x32_bf16 v[40:43], v[72:75], v[208:211], v[40:43]
    s_add_u32 s11, s10, 43008
    buffer_load_dwordx2 v[204:205], v222, s[24:27], s11 offen
    v_mfma_f32_16x16x32_bf16 v[44:47], v[76:79], v[208:211], v[44:47]
    s_add_u32 s11, s10, 59392
    buffer_load_dwordx2 v[206:207], v222, s[24:27], s11 offen
    v_mfma_f32_16x16x32_bf16 v[16:19], v[80:83], v[212:215], v[16:19]
    v_mfma_f32_16x16x32_bf16 v[20:23], v[84:87], v[212:215], v[20:23]
    v_mfma_f32_16x16x32_bf16 v[24:27], v[88:91], v[212:215], v[24:27]
    v_mfma_f32_16x16x32_bf16 v[28:31], v[92:95], v[212:215], v[28:31]
    v_mfma_f32_16x16x32_bf16 v[32:35], v[96:99], v[212:215], v[32:35]
    v_mfma_f32_16x16x32_bf16 v[36:39], v[100:103], v[212:215], v[36:39]
    v_mfma_f32_16x16x32_bf16 v[40:43], v[104:107], v[212:215], v[40:43]
    v_mfma_f32_16x16x32_bf16 v[44:47], v[108:111], v[212:215], v[44:47]
    s_mov_b64 exec, s[30:31]
    s_nop 0
    ds_write_b128 v3, v[16:19] offset:0
    ds_write_b128 v3, v[20:23] offset:512
    ds_write_b128 v3, v[24:27] offset:1024
    ds_write_b128 v3, v[28:31] offset:1536
    ds_write_b128 v3, v[32:35] offset:2048
    ds_write_b128 v3, v[36:39] offset:2560
    ds_write_b128 v3, v[40:43] offset:3072
    ds_write_b128 v3, v[44:47] offset:3584
    ds_write_b32 v15, v6 offset:288
    s_mov_b64 exec, 1
    ds_write_b32 v2, v5 offset:80
    s_mov_b64 exec, -1
    ds_read_b32 v6, v10 offset:288
LW_12:
    ds_read_b32 v11, v1 offset:80
    s_waitcnt lgkmcnt(0)
    v_cmp_eq_u32_e64 vcc, 0, v11
    s_cbranch_vccnz LW_12
    ds_read_b64 v[224:225], v4 offset:0
    ds_read_b64 v[226:227], v4 offset:256
    ds_read_b64 v[228:229], v4 offset:4096
    ds_read_b64 v[230:231], v4 offset:4352
    ds_read_b64 v[232:233], v4 offset:8192
    ds_read_b64 v[234:235], v4 offset:8448
    ds_read_b64 v[236:237], v4 offset:12288
    ds_read_b64 v[238:239], v4 offset:12544
    s_waitcnt lgkmcnt(4)
    v_add_f32 v224, v224, v228
    v_add_f32 v225, v225, v229
    v_add_f32 v226, v226, v230
    v_add_f32 v227, v227, v231
    s_waitcnt lgkmcnt(0)
    v_add_f32 v232, v232, v236
    v_add_f32 v233, v233, v237
    v_add_f32 v234, v234, v238
    v_add_f32 v235, v235, v239
    v_add_f32 v224, v224, v232
    v_add_f32 v225, v225, v233
    v_add_f32 v226, v226, v234
    v_add_f32_e64 v227, v227, v235
    s_cmp_eq_u32 s12, 0
    v_cvt_pk_bf16_f32 v216, v224, v225
    v_cvt_pk_bf16_f32 v217, v226, v227
    s_cbranch_scc0 L_HSC
    buffer_store_dwordx4 v[216:219], v13, s[44:47], s5 offen
L_HSB:
    v_bfe_u32 v10, v0, 3, 1
    v_lshrrev_b32 v11, 4, v0
    v_cmp_ne_u32 s[22:23], 0, v10
    v_lshlrev_b32_e64 v15, 2, v10
    v_lshl_add_u32 v15, v11, 3, v15
    v_lshlrev_b32_e64 v10, 8, v10
    v_lshl_add_u32 v10, v11, 9, v10
    v_lshlrev_b32 v9, 4, v11
    v_and_b32 v11, 7, v0
    v_lshl_add_u32 v10, v11, 4, v10
    s_movk_i32 s5, 144
    v_mad_u32_u24 v15, v11, s5, v15
    v_mad_u32_u24 v9, v11, s5, v9
    s_lshl_b32 s5, s3, 5
    v_add_u32 v15, s5, v15
    s_lshl_b32 s4, s59, 15
    s_lshl_b32 s5, s68, 13
    s_add_u32 s4, s4, s5
    s_lshl_b32 s5, s3, 11
    s_add_u32 s4, s4, s5
    s_add_u32 s4, s4, 1048576
    v_mul_f32 v12, 0xbfb8aa3b, v6
    v_mul_f32 v14, v6, v6
    v_mov_b32 v50, s56
    v_mov_b32_e64 v54, s56
    s_mov_b32 s16, 0
    s_waitcnt vmcnt(9)
    v_perm_b32 v112, v178, v176, s64
    v_perm_b32 v116, v178, v176, s65
    v_perm_b32 v113, v182, v180, s64
    v_perm_b32 v117, v182, v180, s65
    v_perm_b32 v114, v186, v184, s64
    v_perm_b32 v118, v186, v184, s65
    v_perm_b32 v115, v190, v188, s64
    v_perm_b32 v119, v190, v188, s65
    v_perm_b32 v120, v179, v177, s64
    v_perm_b32 v124, v179, v177, s65
    v_perm_b32 v121, v183, v181, s64
    v_perm_b32 v125, v183, v181, s65
    v_perm_b32 v122, v187, v185, s64
    v_perm_b32 v126, v187, v185, s65
    v_perm_b32 v123, v191, v189, s64
    v_perm_b32 v127, v191, v189, s65
    buffer_load_dwordx3 v[144:146], v13, s[44:47], s6 offen offset:0 sc1
    buffer_load_dwordx3 v[148:150], v13, s[44:47], s6 offen offset:1024 sc1
    buffer_load_dwordx3 v[152:154], v13, s[44:47], s6 offen offset:2048 sc1
    buffer_load_dwordx3 v[156:158], v13, s[44:47], s6 offen offset:3072 sc1
    s_waitcnt vmcnt(5)
    s_nop 0
    v_perm_b32 v128, v194, v192, s64
    v_perm_b32 v132, v194, v192, s65
    v_perm_b32 v129, v198, v196, s64
    v_perm_b32 v133, v198, v196, s65
    v_perm_b32 v130, v202, v200, s64
    v_perm_b32 v134, v202, v200, s65
    v_perm_b32 v131, v206, v204, s64
    v_perm_b32 v135, v206, v204, s65
    v_perm_b32 v136, v195, v193, s64
    v_perm_b32 v140, v195, v193, s65
    v_perm_b32 v137, v199, v197, s64
    v_perm_b32 v141, v199, v197, s65
    v_perm_b32 v138, v203, v201, s64
    v_perm_b32 v142, v203, v201, s65
    v_perm_b32 v139, v207, v205, s64
    v_perm_b32 v143, v207, v205, s65
    s_branch L_HPW
L_HP:
    s_sleep 3
    s_cmp_eq_u64 s[18:19], 0
    s_cbranch_scc1 L_HS0
    buffer_load_dwordx3 v[144:146], v13, s[44:47], s6 offen offset:0 sc1
L_HS0:
    s_cmp_eq_u64 s[8:9], 0
    s_cbranch_scc1 L_HS1
    buffer_load_dwordx3 v[148:150], v13, s[44:47], s6 offen offset:1024 sc1
L_HS1:
    s_cmp_eq_u64 s[14:15], 0
    s_cbranch_scc1 L_HS2
    buffer_load_dwordx3 v[152:154], v13, s[44:47], s6 offen offset:2048 sc1
L_HS2:
    s_cmp_eq_u64 s[28:29], 0
    s_cbranch_scc1 L_HS3
    buffer_load_dwordx3 v[156:158], v13, s[44:47], s6 offen offset:3072 sc1
L_HS3:
L_HPW:
    s_add_u32 s16, s16, 1
    s_waitcnt vmcnt(0)
    v_cmp_ne_u32 s[18:19], s56, v146
    v_cmp_ne_u32 s[8:9], s56, v150
    v_cmp_ne_u32 s[14:15], s56, v154
    v_cmp_ne_u32 s[28:29], s56, v158
    s_or_b64 vcc, s[18:19], s[8:9]
    s_or_b64 s[20:21], s[14:15], s[28:29]
    s_or_b64 vcc, vcc, s[20:21]
    s_cbranch_vccz L_HOK
    s_cmp_lt_u32 s16, 0x4000
    s_cbranch_scc1 L_HP
L_HOK:
    s_mov_b32 exec_hi, 0
    buffer_load_dword v253, v255, s[44:47], s38 offen sc1
    s_mov_b32 exec_hi, -1
    v_lshlrev_b32 v224, 16, v144
    v_and_b32 v225, 0xffff0000, v144
    v_lshlrev_b32_e64 v226, 16, v148
    v_and_b32 v227, 0xffff0000, v148
    v_lshlrev_b32_e64 v228, 16, v152
    v_and_b32 v229, 0xffff0000, v152
    v_lshlrev_b32_e64 v230, 16, v156
    v_and_b32 v231, 0xffff0000, v156
    v_add_f32 v224, v224, v226
    v_add_f32 v228, v228, v230
    v_add_f32 v225, v225, v227
    v_add_f32 v229, v229, v231
    v_add_f32 v224, v224, v228
    v_add_f32 v225, v225, v229
    v_mul_f32 v244, v12, v224
    v_mul_f32 v245, v12, v225
    v_exp_f32 v244, v244
    v_exp_f32 v245, v245
    v_lshlrev_b32_e64 v232, 16, v145
    v_and_b32 v233, 0xffff0000, v145
    v_lshlrev_b32_e64 v234, 16, v149
    v_and_b32 v235, 0xffff0000, v149
    v_lshlrev_b32_e64 v236, 16, v153
    v_and_b32 v237, 0xffff0000, v153
    v_lshlrev_b32_e64 v238, 16, v157
    v_and_b32 v239, 0xffff0000, v157
    v_add_f32 v244, 1.0, v244
    v_add_f32 v245, 1.0, v245
    v_rcp_f32 v244, v244
    v_rcp_f32 v245, v245
    v_add_f32 v232, v232, v234
    v_add_f32 v236, v236, v238
    v_add_f32 v233, v233, v235
    v_add_f32 v237, v237, v239
    v_mul_f32 v224, v224, v14
    v_add_f32 v232, v232, v236
    v_mul_f32 v225, v225, v14
    v_add_f32 v233, v233, v237
    v_mul_f32 v224, v224, v244
    v_mul_f32 v225, v225, v245
    v_mul_f32 v224, v224, v232
    v_mul_f32 v225, v225, v233
    v_cvt_pk_bf16_f32 v244, v224, v225
    ds_write_b32 v15, v244 offset:4096
    s_mov_b64 exec, 1
    ds_write_b32 v2, v5 offset:176
    s_mov_b64 exec, -1
LW_13:
    ds_read_b32 v11, v1 offset:176
    s_waitcnt lgkmcnt(0)
    v_cmp_eq_u32_e64 vcc, 0, v11
    s_cbranch_vccnz LW_13
    ds_read_b128 v[224:227], v9 offset:4096
    ds_read_b128 v[228:231], v9 offset:4160
    s_waitcnt lgkmcnt(1)
    v_mfma_f32_16x16x32_bf16 v[16:19], v[112:115], v[224:227], 0
    v_mfma_f32_16x16x32_bf16 v[20:23], v[116:119], v[224:227], 0
    v_mfma_f32_16x16x32_bf16 v[24:27], v[120:123], v[224:227], 0
    v_mfma_f32_16x16x32_bf16 v[28:31], v[124:127], v[224:227], 0
    s_waitcnt lgkmcnt(0)
    v_mfma_f32_16x16x32_bf16 v[16:19], v[128:131], v[228:231], v[16:19]
    v_mfma_f32_16x16x32_bf16 v[20:23], v[132:135], v[228:231], v[20:23]
    v_mfma_f32_16x16x32_bf16 v[24:27], v[136:139], v[228:231], v[24:27]
    v_mfma_f32_16x16x32_bf16 v[28:31], v[140:143], v[228:231], v[28:31]
    s_waitcnt vmcnt(0)
    v_cmp_ne_u32_e64 vcc, s63, v253
    s_or_b64 vcc, vcc, s[12:13]
    s_cbranch_vccnz L_EAN
    s_mov_b32 s32, 1
    buffer_load_dwordx4 v[96:99], v248, s[44:47], s34 offen sc1
    buffer_load_dwordx4 v[100:103], v248, s[44:47], s35 offen sc1
L_EAN:
    s_nop 0
    s_nop 0
    v_cndmask_b32 v16, v16, v18, s[22:23]
    v_cndmask_b32 v20, v20, v22, s[22:23]
    v_cndmask_b32 v24, v24, v26, s[22:23]
    v_cndmask_b32 v28, v28, v30, s[22:23]
    v_cvt_pk_bf16_f32 v48, v16, v20
    v_cvt_pk_bf16_f32 v49, v24, v28
    buffer_store_dwordx4 v[48:51], v10, s[44:47], s4 offen offset:0 sc1
    v_cndmask_b32 v17, v17, v19, s[22:23]
    v_cndmask_b32 v21, v21, v23, s[22:23]
    v_cndmask_b32 v25, v25, v27, s[22:23]
    v_cndmask_b32 v29, v29, v31, s[22:23]
    v_cvt_pk_bf16_f32 v52, v17, v21
    v_cvt_pk_bf16_f32 v53, v25, v29
    buffer_store_dwordx4 v[52:55], v10, s[44:47], s4 offen offset:128 sc1
    s_cmp_eq_u32 s32, 0
    s_cbranch_scc1 L_GATHER
    s_waitcnt vmcnt(2)
    s_nop 0
    ds_write_b64 v249, v[96:97] offset:0
    ds_write_b64 v249, v[98:99] offset:144
    ds_write_b64 v249, v[100:101] offset:64
    ds_write_b64 v249, v[102:103] offset:208
    ds_read_b128 v[104:107], v250 offset:0
    ds_read_b128 v[108:111], v250 offset:1152
    s_waitcnt lgkmcnt(1)
    buffer_store_dwordx4 v[104:107], v251, s[52:55], s36 offen sc1
    s_waitcnt lgkmcnt(0)
    buffer_store_dwordx4 v[108:111], v252, s[52:55], s37 offen sc1
    s_branch L_AFT
L_GATHER:
    s_cmp_lg_u32 s12, 0
    s_cbranch_scc1 L_AFT
    s_setprio 0
LW_14:
    s_sleep 2
    ds_read_b32 v81, v1 offset:32
    s_waitcnt lgkmcnt(0)
    v_cmp_eq_u32_e64 vcc, 0, v81
    s_cbranch_vccnz LW_14
    s_mov_b32 exec_hi, 0
LT_15:
    buffer_load_dword v253, v255, s[44:47], s38 offen sc1
    s_add_u32 s39, s39, 1
    s_waitcnt vmcnt(0)
    v_cmp_ne_u32_e64 vcc, s63, v253
    s_cbranch_vccz LT_15K
    s_sleep 3
    s_cmp_lt_u32 s39, 0x4000
    s_cbranch_scc1 LT_15
LT_15K:
    s_mov_b32 exec_hi, -1
    buffer_load_dwordx4 v[96:99], v248, s[44:47], s34 offen sc1
    buffer_load_dwordx4 v[100:103], v248, s[44:47], s35 offen sc1
    s_waitcnt vmcnt(1)
    ds_write_b64 v249, v[96:97] offset:0
    ds_write_b64 v249, v[98:99] offset:144
    s_waitcnt vmcnt(0)
    ds_write_b64 v249, v[100:101] offset:64
    ds_write_b64 v249, v[102:103] offset:208
    ds_read_b128 v[104:107], v250 offset:0
    ds_read_b128 v[108:111], v250 offset:1152
    s_waitcnt lgkmcnt(1)
    buffer_store_dwordx4 v[104:107], v251, s[52:55], s36 offen sc1
    s_waitcnt lgkmcnt(0)
    buffer_store_dwordx4 v[108:111], v252, s[52:55], s37 offen sc1
L_AFT:
    s_setprio 0
    s_lshl_b32 s4, s57, 7
    s_add_u32 s4, s4, 1048576
    s_mov_b32 s11, 0
    s_lshl_b32 s8, s3, 8
    v_lshl_add_u32 v85, v0, 2, s8
LW_16:
    s_sleep 1
    ds_read_b32 v81, v1 offset:560
    s_waitcnt lgkmcnt(0)
    v_cmp_eq_u32 vcc, 0, v81
    s_cbranch_vccnz LW_16
    s_setprio 2
L_GGO:
    s_mov_b64 s[8:9], -1
    s_cmp_lt_u32 s3, 3
    s_cselect_b64 s[12:13], -1, 0
    s_add_u32 s5, s4, 0x100000
    v_mov_b32 v148, 0
    v_mov_b32 v149, 0
    v_mov_b32_e64 v150, s56
L_GP:
    s_mov_b64 exec, s[8:9]
    s_cbranch_execz L_GS0
    buffer_load_dwordx3 v[144:146], v221, s[44:47], s4 offen sc1
L_GS0:
    s_mov_b64 exec, s[12:13]
    s_cbranch_execz L_GS1
    buffer_load_dwordx3 v[148:150], v221, s[44:47], s5 offen sc1
L_GS1:
    s_mov_b64 exec, -1
    s_add_u32 s11, s11, 1
    s_waitcnt vmcnt(0)
    v_cmp_ne_u32 s[8:9], s56, v146
    v_cmp_ne_u32 s[12:13], s56, v150
    s_or_b64 vcc, s[8:9], s[12:13]
    s_cbranch_vccz L_GOT
    s_sleep 2
    s_cmp_lt_u32 s11, 0x4000
    s_cbranch_scc1 L_GP
L_GOT:
    v_lshlrev_b32 v176, 16, v144
    v_and_b32 v177, 0xffff0000, v144
    v_lshlrev_b32_e64 v178, 16, v145
    v_and_b32 v179, 0xffff0000, v145
    v_lshlrev_b32_e64 v180, 16, v148
    v_and_b32 v181, 0xffff0000, v148
    v_lshlrev_b32_e64 v182, 16, v149
    v_and_b32 v183, 0xffff0000, v149
    v_add_f32 v176, v176, v180
    v_add_f32 v177, v177, v181
    v_add_f32 v178, v178, v182
    v_add_f32 v179, v179, v183
    v_permlane32_swap_b32 v176, v177
    s_nop 0
    v_permlane32_swap_b32 v178, v179
    v_add_f32 v176, v176, v177
    v_add_f32 v178, v178, v179
    s_nop 1
    v_permlane16_swap_b32 v176, v178
    v_add_f32 v176, v176, v178
    s_nop 0
    s_nop 0
    v_add_f32_dpp v176, v176, v176 row_ror:8 row_mask:0xf bank_mask:0xf
    ds_write_b32 v85, v176 offset:8192
    s_mov_b64 exec, 1
    ds_write_b32 v2, v5 offset:96
    s_mov_b64 exec, -1
    s_cmp_lg_u32 s3, 0
    s_cbranch_scc1 L_FIN
    v_lshlrev_b32_e64 v80, 16, v246
L_FW:
    ds_read2_b32 v[86:87], v1 offset0:12 offset1:24
    ds_read_b32 v89, v247
    ds_read2st64_b32 v[90:91], v220 offset0:32 offset1:33
    ds_read2st64_b32 v[92:93], v220 offset0:34 offset1:35
    s_waitcnt lgkmcnt(3)
    v_min_u32 v86, v86, v87
    v_cmp_eq_u32 vcc, 0, v86
    s_cbranch_vccnz L_FW
    s_waitcnt lgkmcnt(1)
    v_add_f32 v80, v80, v89
    v_add_f32 v90, v90, v91
    s_waitcnt lgkmcnt(0)
    v_add_f32 v92, v92, v93
    v_add_f32 v90, v90, v92
    v_fma_f32 v80, v90, v254, v80
    v_cvt_pk_bf16_f32 v80, v80, v80
    s_mov_b32 exec_hi, 0
    buffer_store_short v80, v223, s[52:55], 0 offen
    s_mov_b64 exec, -1
    s_branch L_FIN
L_HSC:
    buffer_store_dwordx4 v[216:219], v13, s[44:47], s5 offen sc1
    s_branch L_HSB
L_TRIM:
    v_subrev_u32 v236, s4, v232
    v_subrev_u32 v237, s4, v233
    v_subrev_u32 v238, s4, v234
    v_subrev_u32 v239, s4, v235
    v_min3_u32 v236, v236, v237, v238
    v_min_u32 v236, v236, v239
    s_nop 1
    v_min_u32_dpp v236, v236, v236 row_shr:1 row_mask:0xf bank_mask:0xf
    s_nop 0
    s_nop 0
    v_min_u32_dpp v236, v236, v236 row_shr:2 row_mask:0xf bank_mask:0xf
    s_nop 0
    s_nop 0
    v_min_u32_dpp v236, v236, v236 row_shr:4 row_mask:0xf bank_mask:0xf
    s_nop 0
    s_nop 0
    v_min_u32_dpp v236, v236, v236 row_shr:8 row_mask:0xf bank_mask:0xf
    s_nop 0
    s_nop 0
    v_min_u32_dpp v236, v236, v236 row_bcast:15 row_mask:0xa bank_mask:0xf
    s_nop 0
    s_nop 0
    v_min_u32_dpp v236, v236, v236 row_bcast:31 row_mask:0xc bank_mask:0xf
    s_nop 0
    v_readlane_b32 s5, v236, 63
    s_add_u32 s4, s4, s5
    s_add_u32 s4, s4, 1
    s_branch L_CAND
L_SLOWT:
    v_max3_u32 v228, v232, v233, v234
    v_max_u32 v228, v228, v235
    s_mov_b32 s4, 0
    s_brev_b32 s5, 1
L_BS:
    s_or_b32 s6, s4, s5
    v_cmp_le_u32_e64 vcc, s6, v228
    s_lshr_b32 s5, s5, 1
    s_bcnt1_i32_b64 s7, vcc
    s_cmp_ge_u32 s7, 8
    s_cselect_b32 s4, s6, s4
    s_cmp_lg_u32 s7, 8
    s_cbranch_scc1 L_BS
    v_mbcnt_lo_u32_b32 v229, vcc_lo, 0
    v_mbcnt_hi_u32_b32 v229, vcc_hi, v229
    v_lshlrev_b32 v229, 2, v229
    s_mov_b64 exec, vcc
    ds_write_b32 v229, v0 offset:320
    s_mov_b64 exec, -1
    v_lshrrev_b32 v230, 3, v0
    v_lshlrev_b32_e64 v230, 2, v230
    ds_read_b32 v229, v230 offset:320
    s_waitcnt lgkmcnt(0)
    v_and_b32 v230, 7, v0
    v_lshl_add_u32 v229, v229, 3, v230
    v_lshlrev_b32_e64 v230, 3, v229
    ds_read_b64 v[226:227], v230 offset:4096
    v_and_b32 v230, 1, v229
    v_and_b32 v229, -2, v229
    v_lshl_add_u32 v229, v230, 10, v229
    v_sub_u32 v232, 0xfff, v229
    v_sub_u32 v233, 0xffe, v229
    v_sub_u32 v234, 0xdff, v229
    v_sub_u32 v235, 0xdfe, v229
    s_mov_b32 s5, 0xffff0000
    s_waitcnt lgkmcnt(0)
    v_lshl_or_b32 v232, v226, 16, v232
    v_and_or_b32 v233, v226, s5, v233
    v_lshl_or_b32 v234, v227, 16, v234
    v_and_or_b32 v235, v227, s5, v235
    s_branch L_CAND
L_FIN:
L_END:
    s_endpgm
.section .rodata,"a"
.p2align 6
.amdhsa_kernel parallel_sum__ssm_conv_s4d__moe_arch_mod__prompt_kernel
  .amdhsa_next_free_vgpr 256
  .amdhsa_next_free_sgpr 102
  .amdhsa_accum_offset 256
  .amdhsa_group_segment_fixed_size 0
  .amdhsa_kernarg_size 120
  .amdhsa_user_sgpr_count 2
  .amdhsa_user_sgpr_kernarg_segment_ptr 1
  .amdhsa_system_sgpr_workgroup_id_x 1
  .amdhsa_float_denorm_mode_32 3
.end_amdhsa_kernel
```

```asm
; @launch grid=(256,1,1) block=(512,1,1) lds=156672
.amdgcn_target "amdgcn-amd-amdhsa--gfx950"
.text
.globl parallel_sum__ssm_conv_s4d__moe_arch_mod__prompt_kernel
.p2align 8
.type parallel_sum__ssm_conv_s4d__moe_arch_mod__prompt_kernel,@function
parallel_sum__ssm_conv_s4d__moe_arch_mod__prompt_kernel:
    s_cmp_ge_u32 s2, 256
    s_cbranch_scc1 L_END
    s_load_dwordx16 s[16:31], s[0:1], 0
    s_load_dwordx8 s[32:39], s[0:1], 64
    s_load_dwordx2 s[40:41], s[0:1], 96
    s_load_dwordx2 s[42:43], s[0:1], 112
    s_getpc_b64 s[14:15]
    v_lshrrev_b32_e64 v1, 6, v0
    v_and_b32 v10, 255, v0
    v_and_b32 v0, 63, v0
    v_readfirstlane_b32 s3, v1
    v_lshlrev_b32 v1, 2, v0
    v_mov_b32 v2, 0
    ds_write2st64_b32 v1, v2, v2 offset0:0 offset1:2
    s_and_b32 s5, s2, 7
    s_lshr_b32 s6, s2, 3
    s_lshl_b32 s57, s5, 5
    s_add_u32 s57, s57, s6
    s_and_b32 s58, s3, 3
    s_lshl_b32 s7, s57, 2
    s_add_u32 s7, s7, s58
    s_lshl_b32 s7, s7, 8
    v_add_u32 v15, s7, v1
    s_mov_b32 s60, 0
    s_lshl_b32 s4, s57, 3
    s_cmp_lt_u32 s3, 4
    s_cbranch_scc1 L_F0
    s_and_b32 s8, s6, 15
    s_lshl_b32 s8, s8, 2
    s_add_u32 s8, s8, s58
    s_lshl_b32 s8, s8, 9
    s_mov_b32 s69, s8
    v_lshl_add_u32 v2, v0, 7, s8
    v_min_u32 v2, L_END-parallel_sum__ssm_conv_s4d__moe_arch_mod__prompt_kernel-128, v2
    s_mov_b64 exec, 0xf
    global_load_dword v229, v2, s[14:15]
    s_mov_b64 exec, -1
    v_lshlrev_b32 v3, 12, v10
    v_add_u32_e64 v3, s4, v3
    s_lshl_b32 s8, s5, 5
    s_add_u32 s8, s8, s58
    s_lshl_b32 s8, s8, 7
    s_add_u32 s8, s8, 983040
    v_lshl_add_u32 v2, v0, 9, s8
    s_lshl_b32 s59, s5, 2
    s_add_u32 s59, s59, s58
    s_lshl_b32 s59, s59, 5
    s_add_u32 s59, s59, s6
    s_lshl_b32 s59, s59, 9
    s_add_u32 s59, s59, 7340032
    s_sub_u32 s8, s59, 512
    v_lshl_add_u32 v4, v0, 7, s8
    v_cmp_lt_u32 vcc, 3, v0
    s_nop 0
    s_nop 0
    v_cndmask_b32 v2, v2, v4, vcc
    s_lshl_b32 s8, s2, 6
    s_add_u32 s8, s8, 7864320
    v_writelane_b32 v2, s8, 3
    s_waitcnt lgkmcnt(0)
    s_cmp_ge_u32 s6, 32
    s_cbranch_scc1 L_NFP
    s_mov_b64 exec, 127
    global_load_dword v229, v2, s[42:43]
    s_mov_b64 exec, -1
L_NFP:
    global_load_dword v224, v15, s[18:19]
    global_load_dword v225, v15, s[20:21]
    global_load_dword v226, v15, s[22:23]
    global_load_dword v227, v15, s[24:25]
    s_add_u32 s6, s26, s4
    s_addc_u32 s7, s27, 0
    s_load_dwordx2 s[64:65], s[6:7], 0
    s_add_u32 s6, s28, s4
    s_addc_u32 s7, s29, 0
    s_load_dwordx2 s[66:67], s[6:7], 0
    s_barrier
    s_mov_b64 s[26:27], s[14:15]
    s_mov_b32 s61, 0x100000
    s_mov_b32 s62, 0x200000
    s_mov_b32 s63, 0x300000
    s_mov_b32 s44, s42
    s_and_b32 s45, s43, 0xffff
    s_mov_b32 s46, 0x1000000
    s_mov_b32 s47, 0x20000
    s_mov_b32 s48, s16
    s_and_b32 s49, s17, 0xffff
    s_mov_b32 s50, 0x400000
    s_mov_b32 s51, 0x20000
    s_mov_b32 s52, s40
    s_and_b32 s53, s41, 0xffff
    s_mov_b32 s54, 0x400000
    s_mov_b32 s55, 0x20000
    s_setprio 2
    s_lshr_b32 s8, s2, 3
    s_and_b32 s9, s2, 7
    s_lshr_b32 s41, s58, 1
    s_add_u32 s41, s41, 2
    v_lshrrev_b32 v172, 3, v0
    v_and_b32 v173, 7, v0
    s_lshl_b32 s40, s8, 5
    s_add_u32 s40, s40, s41
    v_lshrrev_b32_e64 v239, 4, v0
    v_lshl_add_u32 v239, v239, 2, s40
    v_and_b32_e64 v238, 1, v172
    v_lshl_add_u32 v239, v239, 1, v238
    s_mul_i32 s40, s58, 17408
    s_add_u32 s40, s40, 52224
    v_lshl_add_u32 v236, v172, 3, s40
    v_lshl_add_u32 v237, v173, 4, s40
    s_movk_i32 s40, 288
    v_mad_u32_u24 v236, v173, s40, v236
    s_movk_i32 s40, 144
    v_mad_u32_u24 v237, v172, s40, v237
    v_lshlrev_b32_e64 v173, 4, v173
    v_lshl_add_u32 v35, v172, 14, v173
    v_lshl_add_u32 v238, v172, 11, v173
    s_and_b32 s40, s58, 1
    s_lshl_b32 s37, s9, 1
    s_add_u32 s37, s37, s40
    s_lshl_b32 s41, s41, 5
    s_add_u32 s41, s41, s8
    s_lshl_b32 s36, s37, 18
    s_lshl_b32 s40, s41, 7
    s_add_u32 s36, s36, s40
    s_add_u32 s36, s36, 3145728
    s_lshl_b32 s38, s41, 15
    s_lshl_b32 s37, s37, 7
    s_add_u32 s38, s38, s37
    s_add_u32 s39, s38, 0x4000
    s_add_u32 s37, s36, 0x20000
    s_lshl_b32 s40, s9, 5
    s_lshr_b32 s8, s8, 3
    s_add_u32 s40, s40, s8
    s_lshl_b32 s40, s40, 7
    s_add_u32 s40, s40, 983552
    s_mov_b32 s41, 0
    s_sub_u32 s42, s40, 512
    s_mul_i32 s8, s58, 17408
    s_add_u32 s8, s8, 52224
    s_mul_i32 s10, s58, 4608
    s_add_u32 s10, s10, 121856
    s_mul_i32 s11, s58, 8704
    s_add_u32 s11, s11, 17408
    s_movk_i32 s9, 544
    s_sub_u32 m0, s8, 48064
    v_lshl_add_u32 v15, v0, 3, s10
    v_and_b32 v16, 15, v0
    v_lshrrev_b32 v17, 4, v0
    v_lshlrev_b32 v18, 4, v17
    v_mad_u32_u24 v12, v16, s9, v18
    v_add_u32 v14, s11, v12
    v_add_u32 v12, s8, v12
    v_add_u32 v11, s8, v18
    v_cmp_gt_u32 vcc, 3, v16
    s_nop 0
    s_nop 0
    v_cndmask_b32 v19, 12, 4, vcc
    v_cmp_eq_u32 vcc, 3, v16
    s_nop 1
    v_cndmask_b32 v19, v19, 28, vcc
    v_mad_u32_u24 v13, v19, s9, v12
    v_and_b32_e64 v20, 3, v16
    s_sub_u32 s11, s11, 17408
    s_lshl_b32 s4, s58, 2
    v_mov_b32 v4, s4
    v_mov_b32 v5, 1
    v_lshlrev_b32 v6, 2, v20
    s_movk_i32 s9, 2368
    v_lshrrev_b32 v18, 2, v0
    v_lshl_add_u32 v19, v20, 3, s8
    v_mad_u32_u24 v200, v18, s9, v19
    s_movk_i32 s4, 160
    v_mad_u32_u24 v202, v18, s4, v19
    v_lshrrev_b32 v18, 3, v0
    v_and_b32_e64 v19, 7, v0
    v_lshl_add_u32 v19, v19, 3, s8
    v_mad_u32_u24 v201, v18, s9, v19
    v_lshrrev_b32 v18, 5, v0
    v_lshlrev_b32 v18, 8, v18
    v_lshl_add_u32 v18, v16, 4, v18
    v_add_u32 v18, s8, v18
    v_and_b32 v19, 1, v17
    v_lshl_add_u32 v203, v19, 3, v18
    v_lshlrev_b32 v46, 5, v19
    v_and_b32 v18, 1, v16
    s_movk_i32 s4, 640
    v_mul_u32_u24 v18, s4, v18
    v_lshl_add_u32 v46, v18, 1, v46
    v_lshl_add_u32 v18, v17, 5, v18
    v_and_b32_e64 v19, 14, v16
    v_add3_u32 v47, v18, v19, s8
    v_add3_u32 v46, v46, v19, s8
    v_lshrrev_b32_e64 v18, 5, v0
    v_lshl_add_u32 v46, v18, 4, v46
    v_mov_b32 v234, 0
    v_mov_b32 v235, 0
    v_lshlrev_b32 v7, 4, v17
    v_lshlrev_b32 v18, 5, v16
    v_sub_u32_e64 v7, v7, v18
    s_add_u32 s4, s10, 480
    v_add_u32 v7, s4, v7
    s_lshl_b32 s4, s58, 13
    s_add_u32 s4, s4, 17408
    v_lshlrev_b32_e64 v18, 6, v16
    v_bfe_u32 v22, v16, 1, 2
    v_xor_b32_e64 v22, v22, v17
    v_lshl_add_u32 v18, v22, 4, v18
    v_add_u32 v8, s4, v18
    v_sub_u32 v22, 20, v16
    v_lshlrev_b32_e64 v23, 3, v17
    v_mov_b32 v24, 0x7f
    v_lshlrev_b32 v24, v22, v24
    v_subrev_u32 v22, 1, v22
    v_mov_b32 v25, 0x1ff
    v_lshlrev_b32 v25, v22, v25
    v_lshrrev_b32 v24, v23, v24
    v_lshrrev_b32 v25, v23, v25
    v_add_u32 v18, 1, v16
    v_and_b32 v22, 3, v18
    v_and_b32 v18, 28, v18
    v_lshl_add_u32 v26, v17, 3, v18
    v_lshl_add_u32 v26, v26, 1, s8
    v_mad_u32_u24 v1, v22, s9, v26
    v_lshlrev_b32 v26, 2, v17
    v_sub_u32 v18, v18, v26
    v_lshl_add_u32 v18, v18, 1, s8
    s_movk_i32 s4, 160
    v_mad_u32_u24 v2, v22, s4, v18
    s_mov_b32 s15, 0x3f800000
    v_sub_u32_e64 v22, 18, v16
    v_lshlrev_b32 v26, v22, 7
    v_add_u32_e64 v22, 3, v22
    v_lshlrev_b32 v27, v22, 31
    v_and_b32 v24, 0xff, v24
    v_and_b32 v25, 0xff, v25
    v_bfe_u32 v26, v26, v23, 8
    v_bfe_u32 v27, v27, v23, 8
    v_lshl_or_b32 v24, v24, 15, v24
    v_lshl_or_b32 v25, v25, 15, v25
    v_lshl_or_b32 v26, v26, 15, v26
    v_lshl_or_b32 v27, v27, 15, v27
    v_and_b32 v244, 0x10001, v24
    v_and_b32 v248, 0x10001, v25
    v_and_b32 v240, 0x10001, v26
    v_and_b32 v252, 0x10001, v27
    v_mul_u32_u24 v244, 0x3f80, v244
    v_mul_u32_u24 v248, 0x3f80, v248
    v_mul_u32_u24 v240, 0x3f80, v240
    v_mul_u32_u24 v252, 0x3f80, v252
    v_and_b32 v245, 0x40004, v24
    v_and_b32 v249, 0x40004, v25
    v_and_b32 v241, 0x40004, v26
    v_and_b32 v253, 0x40004, v27
    v_mul_u32_u24 v245, 0xfe0, v245
    v_mul_u32_u24 v249, 0xfe0, v249
    v_mul_u32_u24 v241, 0xfe0, v241
    v_mul_u32_u24 v253, 0xfe0, v253
    v_and_b32 v246, 0x100010, v24
    v_and_b32 v250, 0x100010, v25
    v_and_b32 v242, 0x100010, v26
    v_and_b32 v254, 0x100010, v27
    v_mul_u32_u24 v246, 0x3f8, v246
    v_mul_u32_u24 v250, 0x3f8, v250
    v_mul_u32_u24 v242, 0x3f8, v242
    v_mul_u32_u24 v254, 0x3f8, v254
    v_and_b32 v247, 0x400040, v24
    v_and_b32 v251, 0x400040, v25
    v_and_b32 v243, 0x400040, v26
    v_and_b32 v255, 0x400040, v27
    v_mul_u32_u24 v247, 0xfe, v247
    v_mul_u32_u24 v251, 0xfe, v251
    v_mul_u32_u24 v243, 0xfe, v243
    v_mul_u32_u24 v255, 0xfe, v255
    v_lshlrev_b32 v33, 4, v10
    v_lshlrev_b32 v32, 2, v10
    v_sub_u32 v32, 122876, v32
    s_mov_b32 s31, s59
    s_lshl_b32 s13, s57, 14
    s_add_u32 s13, s13, 3145728
    s_and_b32 s12, s2, 7
    s_lshl_b32 s12, s12, 12
    s_lshl_b32 s4, s58, 7
    s_add_u32 s12, s12, s4
    s_lshr_b32 s4, s2, 3
    s_lshl_b32 s4, s4, 2
    s_add_u32 s12, s12, s4
    s_add_u32 s12, s12, 983040
    v_and_b32 v9, 0x30, v10
    v_lshlrev_b32 v10, 3, v10
    v_xor_b32 v9, v9, v10
    v_add_u32 v9, 17408, v9
    s_mov_b32 s30, 0
    s_brev_b32 s68, 1
    s_mov_b32 s32, s13
    s_add_u32 s33, s13, 0x1000
    s_add_u32 s34, s13, 0x2000
    s_add_u32 s35, s13, 0x3000
    s_waitcnt lgkmcnt(0)
    s_lshl_b32 s4, s58, 4
    s_lshr_b64 s[6:7], s[64:65], s4
    s_lshl_b32 s6, s6, 16
    v_mov_b32 v228, s6
    v_mul_f32 v228, 0x3fb8aa3b, v228
    v_exp_f32 v228, v228
    s_nop 0
    v_cvt_pk_bf16_f32 v228, v228, v228
    v_and_b32 v228, 0xffff0000, v228
    s_lshl_b32 s4, s58, 12
    v_lshl_add_u32 v18, v0, 7, s4
    s_waitcnt vmcnt(0)
    s_mov_b32 exec_hi, 0
    buffer_load_dword v229, v18, s[44:47], s13 offen
    s_mov_b32 exec_hi, -1
    v_lshlrev_b32_e64 v48, 16, v224
    v_and_b32 v49, 0xffff0000, v224
    v_lshlrev_b32_e64 v50, 16, v225
    v_and_b32 v51, 0xffff0000, v225
    v_mul_f32 v48, 0x3fb8aa3b, v48
    v_mul_f32 v49, 0x3fb8aa3b, v49
    v_exp_f32 v48, v48
    v_exp_f32 v49, v49
    v_mul_f32 v50, v50, v228
    v_mul_f32 v51, v51, v228
    v_mul_f32 v232, 0x3e22f983, v50
    v_mul_f32 v233, 0x3e22f983, v51
    v_cvt_pk_bf16_f32 v50, v48, v49
    v_lshlrev_b32_e64 v48, 16, v50
    v_and_b32 v49, 0xffff0000, v50
    v_mul_f32 v48, v48, v228
    v_mul_f32 v49, v49, v228
    v_mul_f32 v230, 0xbfb8aa3b, v48
    v_mul_f32 v231, 0xbfb8aa3b, v49
    v_add_f32_e64 v228, v228, v228
    v_mul_f32 v28, 0x42000000, v230
    v_mul_f32 v30, 0x42000000, v232
    v_mul_f32 v29, 0x42000000, v231
    v_mul_f32 v31, 0x42000000, v233
    v_exp_f32 v20, v230
    v_fract_f32 v22, v232
    v_exp_f32 v28, v28
    v_fract_f32 v30, v30
    v_exp_f32 v21, v231
    v_fract_f32 v23, v233
    v_exp_f32 v29, v29
    v_fract_f32 v31, v31
    v_cos_f32 v16, v22
    v_lshlrev_b32 v204, 16, v226
    v_sin_f32_e64 v17, v22
    v_and_b32 v206, 0xffff0000, v226
    v_cos_f32 v18, v23
    v_lshlrev_b32 v205, 16, v227
    v_sin_f32_e64 v19, v23
    v_and_b32 v207, 0xffff0000, v227
    v_cos_f32 v24, v30
    v_mul_f32 v204, v204, v228
    v_sin_f32 v25, v30
    v_mul_f32 v205, v205, v228
    v_cos_f32 v26, v31
    v_mul_f32 v206, v206, v228
    v_sin_f32 v27, v31
    v_mul_f32 v207, v207, v228
    v_mul_f32 v16, v16, v20
    v_mul_f32 v17, v17, v20
    v_mul_f32 v18, v18, v21
    v_mul_f32 v19, v19, v21
    v_mul_f32 v24, v24, v28
    v_mul_f32 v25, v25, v28
    v_mul_f32 v26, v26, v29
    v_mul_f32 v27, v27, v29
    v_mov_b32 v112, 0x3c00
    v_mov_b32 v113, 0x3c00
    v_pk_mul_f32 v[20:21], v[16:17], v[16:17] op_sel_hi:[1,0]
    v_pk_mul_f32 v[22:23], v[18:19], v[18:19] op_sel_hi:[1,0]
    v_pk_mul_f32 v[28:29], v[24:25], v[24:25] op_sel_hi:[1,0]
    v_pk_mul_f32 v[30:31], v[26:27], v[26:27] op_sel_hi:[1,0]
    v_cvt_pk_f16_f32 v114, v16, v17
    v_cvt_pk_f16_f32 v115, v18, v19
    v_cvt_pk_f16_f32 v40, v24, v25
    v_cvt_pk_f16_f32 v41, v26, v27
    v_pk_fma_f32 v[16:17], v[16:17], v[16:17], v[20:21] op_sel:[1,1,0] op_sel_hi:[0,1,1] neg_lo:[1,0,0]
    v_pk_fma_f32 v[18:19], v[18:19], v[18:19], v[22:23] op_sel:[1,1,0] op_sel_hi:[0,1,1] neg_lo:[1,0,0]
    v_pk_fma_f32 v[24:25], v[24:25], v[24:25], v[28:29] op_sel:[1,1,0] op_sel_hi:[0,1,1] neg_lo:[1,0,0]
    v_pk_fma_f32 v[26:27], v[26:27], v[26:27], v[30:31] op_sel:[1,1,0] op_sel_hi:[0,1,1] neg_lo:[1,0,0]
    v_pk_mul_f32 v[20:21], v[16:17], v[16:17] op_sel_hi:[1,0]
    v_pk_mul_f32 v[22:23], v[18:19], v[18:19] op_sel_hi:[1,0]
    v_pk_mul_f32 v[28:29], v[24:25], v[24:25] op_sel_hi:[1,0]
    v_pk_mul_f32 v[30:31], v[26:27], v[26:27] op_sel_hi:[1,0]
    v_cvt_pk_f16_f32 v116, v16, v17
    v_cvt_pk_f16_f32 v117, v18, v19
    v_cvt_pk_f16_f32 v42, v24, v25
    v_cvt_pk_f16_f32 v43, v26, v27
    v_pk_fma_f32 v[16:17], v[16:17], v[16:17], v[20:21] op_sel:[1,1,0] op_sel_hi:[0,1,1] neg_lo:[1,0,0]
    v_pk_fma_f32 v[18:19], v[18:19], v[18:19], v[22:23] op_sel:[1,1,0] op_sel_hi:[0,1,1] neg_lo:[1,0,0]
    v_pk_fma_f32 v[24:25], v[24:25], v[24:25], v[28:29] op_sel:[1,1,0] op_sel_hi:[0,1,1] neg_lo:[1,0,0]
    v_pk_fma_f32 v[26:27], v[26:27], v[26:27], v[30:31] op_sel:[1,1,0] op_sel_hi:[0,1,1] neg_lo:[1,0,0]
    v_cvt_pk_f16_f32 v80, v204, -v205
    v_cvt_pk_f16_f32 v81, v206, -v207
    v_pk_mul_f32 v[20:21], v[16:17], v[16:17] op_sel_hi:[1,0]
    v_pk_mul_f32 v[22:23], v[18:19], v[18:19] op_sel_hi:[1,0]
    v_pk_mul_f32 v[28:29], v[24:25], v[24:25] op_sel_hi:[1,0]
    v_pk_mul_f32 v[30:31], v[26:27], v[26:27] op_sel_hi:[1,0]
    v_cvt_pk_f16_f32 v120, v16, v17
    v_cvt_pk_f16_f32 v121, v18, v19
    v_cvt_pk_f16_f32 v44, v24, v25
    v_cvt_pk_f16_f32 v45, v26, v27
    v_pk_fma_f32 v[16:17], v[16:17], v[16:17], v[20:21] op_sel:[1,1,0] op_sel_hi:[0,1,1] neg_lo:[1,0,0]
    v_pk_fma_f32 v[18:19], v[18:19], v[18:19], v[22:23] op_sel:[1,1,0] op_sel_hi:[0,1,1] neg_lo:[1,0,0]
    v_pk_fma_f32 v[24:25], v[24:25], v[24:25], v[28:29] op_sel:[1,1,0] op_sel_hi:[0,1,1] neg_lo:[1,0,0]
    v_pk_fma_f32 v[26:27], v[26:27], v[26:27], v[30:31] op_sel:[1,1,0] op_sel_hi:[0,1,1] neg_lo:[1,0,0]
    v_pk_mul_f16 v118, v116, v114 op_sel_hi:[1,0]
    v_pk_mul_f16 v119, v117, v115 op_sel_hi:[1,0]
    v_pk_mul_f16 v122, v120, v114 op_sel_hi:[1,0]
    v_pk_mul_f16 v123, v121, v115 op_sel_hi:[1,0]
    v_pk_fma_f16 v118, v116, v114, v118 op_sel:[1,1,0] op_sel_hi:[0,1,1] neg_lo:[1,0,0]
    v_pk_fma_f16 v119, v117, v115, v119 op_sel:[1,1,0] op_sel_hi:[0,1,1] neg_lo:[1,0,0]
    v_pk_fma_f16 v122, v120, v114, v122 op_sel:[1,1,0] op_sel_hi:[0,1,1] neg_lo:[1,0,0]
    v_pk_fma_f16 v123, v121, v115, v123 op_sel:[1,1,0] op_sel_hi:[0,1,1] neg_lo:[1,0,0]
    v_pk_mul_f32 v[20:21], v[16:17], v[16:17] op_sel_hi:[1,0]
    v_pk_mul_f32 v[22:23], v[18:19], v[18:19] op_sel_hi:[1,0]
    v_cvt_pk_f16_f32 v128, v16, v17
    v_cvt_pk_f16_f32 v129, v18, v19
    v_cvt_pk_f16_f32 v134, v24, v25
    v_cvt_pk_f16_f32 v135, v26, v27
    v_pk_fma_f32 v[16:17], v[16:17], v[16:17], v[20:21] op_sel:[1,1,0] op_sel_hi:[0,1,1] neg_lo:[1,0,0]
    v_pk_fma_f32 v[18:19], v[18:19], v[18:19], v[22:23] op_sel:[1,1,0] op_sel_hi:[0,1,1] neg_lo:[1,0,0]
    ds_write_addtid_b32 v112 offset:48064
    ds_write_addtid_b32 v113 offset:48320
    ds_write_addtid_b32 v114 offset:48608
    ds_write_addtid_b32 v115 offset:48864
    ds_write_addtid_b32 v116 offset:49152
    ds_write_addtid_b32 v117 offset:49408
    ds_write_addtid_b32 v120 offset:50240
    ds_write_addtid_b32 v121 offset:50496
    ds_write_addtid_b32 v118 offset:49696
    ds_write_addtid_b32 v119 offset:49952
    ds_write_addtid_b32 v122 offset:50784
    ds_write_addtid_b32 v123 offset:51040
    ds_write_addtid_b32 v128 offset:56768
    ds_write_addtid_b32 v129 offset:57024
    ds_write_addtid_b32 v134 offset:52416
    ds_write_addtid_b32 v135 offset:52672
    ds_write_addtid_b32 v44 offset:63296
    ds_write_addtid_b32 v45 offset:63552
    v_pk_mul_f16 v124, v120, v116 op_sel_hi:[1,0]
    v_pk_mul_f16 v125, v121, v117 op_sel_hi:[1,0]
    v_pk_mul_f16 v126, v120, v118 op_sel_hi:[1,0]
    v_pk_mul_f16 v127, v121, v119 op_sel_hi:[1,0]
    v_pk_fma_f16 v124, v120, v116, v124 op_sel:[1,1,0] op_sel_hi:[0,1,1] neg_lo:[1,0,0]
    v_pk_fma_f16 v125, v121, v117, v125 op_sel:[1,1,0] op_sel_hi:[0,1,1] neg_lo:[1,0,0]
    v_pk_fma_f16 v126, v120, v118, v126 op_sel:[1,1,0] op_sel_hi:[0,1,1] neg_lo:[1,0,0]
    v_pk_fma_f16 v127, v121, v119, v127 op_sel:[1,1,0] op_sel_hi:[0,1,1] neg_lo:[1,0,0]
    v_pk_mul_f16 v132, v128, v116 op_sel_hi:[1,0]
    v_pk_mul_f16 v133, v129, v117 op_sel_hi:[1,0]
    v_pk_mul_f16 v136, v134, v116 op_sel_hi:[1,0]
    v_pk_mul_f16 v137, v135, v117 op_sel_hi:[1,0]
    v_pk_fma_f16 v132, v128, v116, v132 op_sel:[1,1,0] op_sel_hi:[0,1,1] neg_lo:[1,0,0]
    v_pk_fma_f16 v133, v129, v117, v133 op_sel:[1,1,0] op_sel_hi:[0,1,1] neg_lo:[1,0,0]
    v_pk_fma_f16 v136, v134, v116, v136 op_sel:[1,1,0] op_sel_hi:[0,1,1] neg_lo:[1,0,0]
    v_pk_fma_f16 v137, v135, v117, v137 op_sel:[1,1,0] op_sel_hi:[0,1,1] neg_lo:[1,0,0]
    v_pk_mul_f16 v138, v134, v120 op_sel_hi:[1,0]
    v_pk_mul_f16 v139, v135, v121 op_sel_hi:[1,0]
    v_pk_mul_f16 v140, v134, v124 op_sel_hi:[1,0]
    v_pk_mul_f16 v141, v135, v125 op_sel_hi:[1,0]
    v_pk_fma_f16 v138, v134, v120, v138 op_sel:[1,1,0] op_sel_hi:[0,1,1] neg_lo:[1,0,0]
    v_pk_fma_f16 v139, v135, v121, v139 op_sel:[1,1,0] op_sel_hi:[0,1,1] neg_lo:[1,0,0]
    v_pk_fma_f16 v140, v134, v124, v140 op_sel:[1,1,0] op_sel_hi:[0,1,1] neg_lo:[1,0,0]
    v_pk_fma_f16 v141, v135, v125, v141 op_sel:[1,1,0] op_sel_hi:[0,1,1] neg_lo:[1,0,0]
    v_pk_mul_f16 v142, v134, v128 op_sel_hi:[1,0]
    v_pk_mul_f16 v143, v135, v129 op_sel_hi:[1,0]
    v_pk_mul_f16 v144, v134, v132 op_sel_hi:[1,0]
    v_pk_mul_f16 v145, v135, v133 op_sel_hi:[1,0]
    v_pk_fma_f16 v142, v134, v128, v142 op_sel:[1,1,0] op_sel_hi:[0,1,1] neg_lo:[1,0,0]
    v_pk_fma_f16 v143, v135, v129, v143 op_sel:[1,1,0] op_sel_hi:[0,1,1] neg_lo:[1,0,0]
    v_pk_fma_f16 v144, v134, v132, v144 op_sel:[1,1,0] op_sel_hi:[0,1,1] neg_lo:[1,0,0]
    v_pk_fma_f16 v145, v135, v133, v145 op_sel:[1,1,0] op_sel_hi:[0,1,1] neg_lo:[1,0,0]
    ds_write_addtid_b32 v124 offset:51328
    ds_write_addtid_b32 v125 offset:51584
    ds_write_addtid_b32 v126 offset:51872
    ds_write_addtid_b32 v127 offset:52128
    ds_write_addtid_b32 v132 offset:57856
    ds_write_addtid_b32 v133 offset:58112
    ds_write_addtid_b32 v136 offset:52960
    ds_write_addtid_b32 v137 offset:53216
    ds_write_addtid_b32 v138 offset:53504
    ds_write_addtid_b32 v139 offset:53760
    ds_write_addtid_b32 v138 offset:54592
    ds_write_addtid_b32 v139 offset:54848
    ds_write_addtid_b32 v140 offset:54048
    ds_write_addtid_b32 v141 offset:54304
    ds_write_addtid_b32 v140 offset:55136
    ds_write_addtid_b32 v141 offset:55392
    ds_write_addtid_b32 v142 offset:55680
    ds_write_addtid_b32 v143 offset:55936
    ds_write_addtid_b32 v144 offset:56224
    ds_write_addtid_b32 v145 offset:56480
    ds_read_b128 v[168:171], v12 offset:0
    ds_read_b128 v[172:175], v12 offset:64
    ds_read_b128 v[176:179], v12 offset:128
    ds_read_b128 v[180:183], v12 offset:192
    ds_read_b128 v[184:187], v12 offset:256
    ds_read_b128 v[188:191], v12 offset:320
    ds_read_b128 v[192:195], v12 offset:384
    ds_read_b128 v[196:199], v12 offset:448
    s_mov_b32 m0, s11
    s_nop 0
    v_cvt_pk_f16_f32 v38, v16, v17
    v_cvt_pk_f16_f32 v39, v18, v19
    v_pk_mul_f16 v82, v80, v128 op_sel_hi:[1,0]
    v_pk_mul_f16 v83, v81, v129 op_sel_hi:[1,0]
    v_pk_mul_f16 v88, v80, v40 op_sel_hi:[1,0]
    v_pk_mul_f16 v89, v81, v41 op_sel_hi:[1,0]
    v_pk_fma_f16 v82, v80, v128, v82 op_sel:[1,1,0] op_sel_hi:[0,1,1] neg_hi:[1,0,0]
    v_pk_fma_f16 v83, v81, v129, v83 op_sel:[1,1,0] op_sel_hi:[0,1,1] neg_hi:[1,0,0]
    v_pk_fma_f16 v88, v80, v40, v88 op_sel:[1,1,0] op_sel_hi:[0,1,1] neg_hi:[1,0,0]
    v_pk_fma_f16 v89, v81, v41, v89 op_sel:[1,1,0] op_sel_hi:[0,1,1] neg_hi:[1,0,0]
    v_pk_mul_f16 v84, v80, v38 op_sel_hi:[1,0]
    v_pk_mul_f16 v85, v81, v39 op_sel_hi:[1,0]
    v_pk_mul_f16 v86, v82, v38 op_sel_hi:[1,0]
    v_pk_mul_f16 v87, v83, v39 op_sel_hi:[1,0]
    v_pk_fma_f16 v84, v80, v38, v84 op_sel:[1,1,0] op_sel_hi:[0,1,1] neg_hi:[1,0,0]
    v_pk_fma_f16 v85, v81, v39, v85 op_sel:[1,1,0] op_sel_hi:[0,1,1] neg_hi:[1,0,0]
    v_pk_fma_f16 v86, v82, v38, v86 op_sel:[1,1,0] op_sel_hi:[0,1,1] neg_hi:[1,0,0]
    v_pk_fma_f16 v87, v83, v39, v87 op_sel:[1,1,0] op_sel_hi:[0,1,1] neg_hi:[1,0,0]
    v_pk_mul_f16 v90, v82, v40 op_sel_hi:[1,0]
    v_pk_mul_f16 v91, v83, v41 op_sel_hi:[1,0]
    v_pk_mul_f16 v96, v80, v42 op_sel_hi:[1,0]
    v_pk_mul_f16 v97, v81, v43 op_sel_hi:[1,0]
    v_pk_fma_f16 v90, v82, v40, v90 op_sel:[1,1,0] op_sel_hi:[0,1,1] neg_hi:[1,0,0]
    v_pk_fma_f16 v91, v83, v41, v91 op_sel:[1,1,0] op_sel_hi:[0,1,1] neg_hi:[1,0,0]
    v_pk_fma_f16 v96, v80, v42, v96 op_sel:[1,1,0] op_sel_hi:[0,1,1] neg_hi:[1,0,0]
    v_pk_fma_f16 v97, v81, v43, v97 op_sel:[1,1,0] op_sel_hi:[0,1,1] neg_hi:[1,0,0]
    v_pk_mul_f16 v92, v84, v40 op_sel_hi:[1,0]
    v_pk_mul_f16 v93, v85, v41 op_sel_hi:[1,0]
    v_pk_mul_f16 v94, v86, v40 op_sel_hi:[1,0]
    v_pk_mul_f16 v95, v87, v41 op_sel_hi:[1,0]
    v_pk_fma_f16 v92, v84, v40, v92 op_sel:[1,1,0] op_sel_hi:[0,1,1] neg_hi:[1,0,0]
    v_pk_fma_f16 v93, v85, v41, v93 op_sel:[1,1,0] op_sel_hi:[0,1,1] neg_hi:[1,0,0]
    v_pk_fma_f16 v94, v86, v40, v94 op_sel:[1,1,0] op_sel_hi:[0,1,1] neg_hi:[1,0,0]
    v_pk_fma_f16 v95, v87, v41, v95 op_sel:[1,1,0] op_sel_hi:[0,1,1] neg_hi:[1,0,0]
    ds_write_addtid_b32 v80 offset:17408
    ds_write_addtid_b32 v81 offset:17664
    ds_write_addtid_b32 v82 offset:17952
    ds_write_addtid_b32 v83 offset:18208
    ds_write_addtid_b32 v84 offset:18496
    ds_write_addtid_b32 v85 offset:18752
    ds_write_addtid_b32 v86 offset:19040
    ds_write_addtid_b32 v87 offset:19296
    ds_write_addtid_b32 v88 offset:19584
    ds_write_addtid_b32 v89 offset:19840
    ds_write_addtid_b32 v90 offset:20128
    ds_write_addtid_b32 v91 offset:20384
    ds_write_addtid_b32 v92 offset:20672
    ds_write_addtid_b32 v93 offset:20928
    ds_write_addtid_b32 v94 offset:21216
    ds_write_addtid_b32 v95 offset:21472
    ds_write_addtid_b32 v96 offset:21760
    ds_write_addtid_b32 v97 offset:22016
    v_pk_mul_f16 v98, v82, v42 op_sel_hi:[1,0]
    v_pk_mul_f16 v99, v83, v43 op_sel_hi:[1,0]
    v_pk_mul_f16 v104, v88, v42 op_sel_hi:[1,0]
    v_pk_mul_f16 v105, v89, v43 op_sel_hi:[1,0]
    v_pk_fma_f16 v98, v82, v42, v98 op_sel:[1,1,0] op_sel_hi:[0,1,1] neg_hi:[1,0,0]
    v_pk_fma_f16 v99, v83, v43, v99 op_sel:[1,1,0] op_sel_hi:[0,1,1] neg_hi:[1,0,0]
    v_pk_fma_f16 v104, v88, v42, v104 op_sel:[1,1,0] op_sel_hi:[0,1,1] neg_hi:[1,0,0]
    v_pk_fma_f16 v105, v89, v43, v105 op_sel:[1,1,0] op_sel_hi:[0,1,1] neg_hi:[1,0,0]
    v_pk_mul_f16 v100, v84, v42 op_sel_hi:[1,0]
    v_pk_mul_f16 v101, v85, v43 op_sel_hi:[1,0]
    v_pk_mul_f16 v102, v86, v42 op_sel_hi:[1,0]
    v_pk_mul_f16 v103, v87, v43 op_sel_hi:[1,0]
    v_pk_fma_f16 v100, v84, v42, v100 op_sel:[1,1,0] op_sel_hi:[0,1,1] neg_hi:[1,0,0]
    v_pk_fma_f16 v101, v85, v43, v101 op_sel:[1,1,0] op_sel_hi:[0,1,1] neg_hi:[1,0,0]
    v_pk_fma_f16 v102, v86, v42, v102 op_sel:[1,1,0] op_sel_hi:[0,1,1] neg_hi:[1,0,0]
    v_pk_fma_f16 v103, v87, v43, v103 op_sel:[1,1,0] op_sel_hi:[0,1,1] neg_hi:[1,0,0]
    v_pk_mul_f16 v106, v90, v42 op_sel_hi:[1,0]
    v_pk_mul_f16 v107, v91, v43 op_sel_hi:[1,0]
    v_pk_mul_f16 v108, v92, v42 op_sel_hi:[1,0]
    v_pk_mul_f16 v109, v93, v43 op_sel_hi:[1,0]
    v_pk_fma_f16 v106, v90, v42, v106 op_sel:[1,1,0] op_sel_hi:[0,1,1] neg_hi:[1,0,0]
    v_pk_fma_f16 v107, v91, v43, v107 op_sel:[1,1,0] op_sel_hi:[0,1,1] neg_hi:[1,0,0]
    v_pk_fma_f16 v108, v92, v42, v108 op_sel:[1,1,0] op_sel_hi:[0,1,1] neg_hi:[1,0,0]
    v_pk_fma_f16 v109, v93, v43, v109 op_sel:[1,1,0] op_sel_hi:[0,1,1] neg_hi:[1,0,0]
    v_pk_mul_f16 v110, v94, v42 op_sel_hi:[1,0]
    v_pk_mul_f16 v111, v95, v43 op_sel_hi:[1,0]
    v_pk_mul_f16 v130, v128, v114 op_sel_hi:[1,0]
    v_pk_mul_f16 v131, v129, v115 op_sel_hi:[1,0]
    v_pk_fma_f16 v110, v94, v42, v110 op_sel:[1,1,0] op_sel_hi:[0,1,1] neg_hi:[1,0,0]
    v_pk_fma_f16 v111, v95, v43, v111 op_sel:[1,1,0] op_sel_hi:[0,1,1] neg_hi:[1,0,0]
    v_pk_fma_f16 v130, v128, v114, v130 op_sel:[1,1,0] op_sel_hi:[0,1,1] neg_lo:[1,0,0]
    v_pk_fma_f16 v131, v129, v115, v131 op_sel:[1,1,0] op_sel_hi:[0,1,1] neg_lo:[1,0,0]
    ds_write_addtid_b32 v98 offset:22304
    ds_write_addtid_b32 v99 offset:22560
    ds_write_addtid_b32 v100 offset:22848
    ds_write_addtid_b32 v101 offset:23104
    ds_write_addtid_b32 v102 offset:23392
    ds_write_addtid_b32 v103 offset:23648
    ds_write_addtid_b32 v104 offset:23936
    ds_write_addtid_b32 v105 offset:24192
    ds_write_addtid_b32 v106 offset:24480
    ds_write_addtid_b32 v107 offset:24736
    ds_write_addtid_b32 v108 offset:25024
    ds_write_addtid_b32 v109 offset:25280
    ds_write_addtid_b32 v110 offset:25568
    ds_write_addtid_b32 v111 offset:25824
    ds_read_b128 v[48:51], v14 offset:0
    ds_read_b128 v[52:55], v14 offset:64
    ds_read_b128 v[56:59], v14 offset:128
    ds_read_b128 v[60:63], v14 offset:192
    ds_read_b128 v[64:67], v14 offset:256
    ds_read_b128 v[68:71], v14 offset:320
    ds_read_b128 v[72:75], v14 offset:384
    ds_read_b128 v[76:79], v14 offset:448
    ds_read_b128 v[80:83], v11 offset:15232
    ds_read_b128 v[84:87], v11 offset:15296
    ds_read_b128 v[88:91], v11 offset:15360
    ds_read_b128 v[92:95], v11 offset:15424
    ds_read_b128 v[96:99], v11 offset:15488
    ds_read_b128 v[100:103], v11 offset:15552
    ds_read_b128 v[104:107], v11 offset:15616
    ds_read_b128 v[108:111], v11 offset:15680
    s_sub_u32 m0, s8, 48064
    v_pk_mul_f32 v[28:29], v[24:25], v[24:25] op_sel_hi:[1,0]
    v_pk_mul_f32 v[30:31], v[26:27], v[26:27] op_sel_hi:[1,0]
    v_pk_fma_f32 v[24:25], v[24:25], v[24:25], v[28:29] op_sel:[1,1,0] op_sel_hi:[0,1,1] neg_lo:[1,0,0]
    v_pk_fma_f32 v[26:27], v[26:27], v[26:27], v[30:31] op_sel:[1,1,0] op_sel_hi:[0,1,1] neg_lo:[1,0,0]
    v_cvt_pk_f16_f32 v146, v24, v25
    v_cvt_pk_f16_f32 v147, v26, v27
    v_pk_mul_f32 v[28:29], v[24:25], v[24:25] op_sel_hi:[1,0]
    v_pk_mul_f32 v[30:31], v[26:27], v[26:27] op_sel_hi:[1,0]
    v_pk_fma_f32 v[24:25], v[24:25], v[24:25], v[28:29] op_sel:[1,1,0] op_sel_hi:[0,1,1] neg_lo:[1,0,0]
    v_pk_fma_f32 v[26:27], v[26:27], v[26:27], v[30:31] op_sel:[1,1,0] op_sel_hi:[0,1,1] neg_lo:[1,0,0]
    v_cvt_pk_f16_f32 v166, v24, v25
    v_cvt_pk_f16_f32 v167, v26, v27
    s_waitcnt lgkmcnt(8)
    s_nop 0
    v_mfma_f32_16x16x32_f16 v[204:207], v[168:171], v[48:51], 0
    v_pk_mul_f16 v152, v146, v134 op_sel_hi:[1,0]
    v_pk_mul_f16 v153, v147, v135 op_sel_hi:[1,0]
    v_pk_mul_f16 v148, v146, v120 op_sel_hi:[1,0]
    v_pk_mul_f16 v149, v147, v121 op_sel_hi:[1,0]
    v_mfma_f32_16x16x32_f16 v[204:207], v[172:175], v[52:55], v[204:207]
    v_pk_fma_f16 v152, v146, v134, v152 op_sel:[1,1,0] op_sel_hi:[0,1,1] neg_lo:[1,0,0]
    v_pk_fma_f16 v153, v147, v135, v153 op_sel:[1,1,0] op_sel_hi:[0,1,1] neg_lo:[1,0,0]
    v_pk_fma_f16 v148, v146, v120, v148 op_sel:[1,1,0] op_sel_hi:[0,1,1] neg_lo:[1,0,0]
    v_pk_fma_f16 v149, v147, v121, v149 op_sel:[1,1,0] op_sel_hi:[0,1,1] neg_lo:[1,0,0]
    v_mfma_f32_16x16x32_f16 v[204:207], v[176:179], v[56:59], v[204:207]
    v_pk_mul_f16 v150, v146, v128 op_sel_hi:[1,0]
    v_pk_mul_f16 v151, v147, v129 op_sel_hi:[1,0]
    v_pk_mul_f16 v158, v128, v166 op_sel_hi:[1,0]
    v_pk_mul_f16 v159, v129, v167 op_sel_hi:[1,0]
    v_mfma_f32_16x16x32_f16 v[204:207], v[180:183], v[60:63], v[204:207]
    v_pk_fma_f16 v150, v146, v128, v150 op_sel:[1,1,0] op_sel_hi:[0,1,1] neg_lo:[1,0,0]
    v_pk_fma_f16 v151, v147, v129, v151 op_sel:[1,1,0] op_sel_hi:[0,1,1] neg_lo:[1,0,0]
    v_pk_fma_f16 v158, v128, v166, v158 op_sel:[1,1,0] op_sel_hi:[0,1,1] neg_lo:[1,0,0]
    v_pk_fma_f16 v159, v129, v167, v159 op_sel:[1,1,0] op_sel_hi:[0,1,1] neg_lo:[1,0,0]
    v_mfma_f32_16x16x32_f16 v[204:207], v[184:187], v[64:67], v[204:207]
    v_pk_mul_f16 v154, v152, v120 op_sel_hi:[1,0]
    v_pk_mul_f16 v155, v153, v121 op_sel_hi:[1,0]
    v_pk_mul_f16 v156, v152, v128 op_sel_hi:[1,0]
    v_pk_mul_f16 v157, v153, v129 op_sel_hi:[1,0]
    v_mfma_f32_16x16x32_f16 v[204:207], v[188:191], v[68:71], v[204:207]
    v_pk_fma_f16 v154, v152, v120, v154 op_sel:[1,1,0] op_sel_hi:[0,1,1] neg_lo:[1,0,0]
    v_pk_fma_f16 v155, v153, v121, v155 op_sel:[1,1,0] op_sel_hi:[0,1,1] neg_lo:[1,0,0]
    v_pk_fma_f16 v156, v152, v128, v156 op_sel:[1,1,0] op_sel_hi:[0,1,1] neg_lo:[1,0,0]
    v_pk_fma_f16 v157, v153, v129, v157 op_sel:[1,1,0] op_sel_hi:[0,1,1] neg_lo:[1,0,0]
    v_mfma_f32_16x16x32_f16 v[204:207], v[192:195], v[72:75], v[204:207]
    v_pk_mul_f16 v160, v142, v166 op_sel_hi:[1,0]
    v_pk_mul_f16 v161, v143, v167 op_sel_hi:[1,0]
    v_pk_mul_f16 v162, v150, v166 op_sel_hi:[1,0]
    v_pk_mul_f16 v163, v151, v167 op_sel_hi:[1,0]
    v_mfma_f32_16x16x32_f16 v[204:207], v[196:199], v[76:79], v[204:207]
    v_pk_fma_f16 v160, v142, v166, v160 op_sel:[1,1,0] op_sel_hi:[0,1,1] neg_lo:[1,0,0]
    v_pk_fma_f16 v161, v143, v167, v161 op_sel:[1,1,0] op_sel_hi:[0,1,1] neg_lo:[1,0,0]
    v_pk_fma_f16 v162, v150, v166, v162 op_sel:[1,1,0] op_sel_hi:[0,1,1] neg_lo:[1,0,0]
    v_pk_fma_f16 v163, v151, v167, v163 op_sel:[1,1,0] op_sel_hi:[0,1,1] neg_lo:[1,0,0]
    v_pk_mul_f16 v164, v156, v166 op_sel_hi:[1,0]
    v_pk_mul_f16 v165, v157, v167 op_sel_hi:[1,0]
    v_pk_fma_f16 v164, v156, v166, v164 op_sel:[1,1,0] op_sel_hi:[0,1,1] neg_lo:[1,0,0]
    v_pk_fma_f16 v165, v157, v167, v165 op_sel:[1,1,0] op_sel_hi:[0,1,1] neg_lo:[1,0,0]
    ds_write_addtid_b32 v130 offset:57312
    ds_write_addtid_b32 v131 offset:57568
    ds_write_addtid_b32 v146 offset:58944
    ds_write_addtid_b32 v147 offset:59200
    ds_write_addtid_b32 v152 offset:61120
    ds_write_addtid_b32 v153 offset:61376
    ds_write_addtid_b32 v148 offset:59488
    ds_write_addtid_b32 v149 offset:59744
    ds_write_addtid_b32 v150 offset:60032
    ds_write_addtid_b32 v151 offset:60288
    ds_write_addtid_b32 v158 offset:64928
    ds_write_addtid_b32 v159 offset:65184
    ds_write_addtid_b32 v154 offset:61664
    ds_write_addtid_b32 v155 offset:61920
    ds_write_addtid_b32 v156 offset:62208
    ds_write_addtid_b32 v157 offset:62464
    ds_write_addtid_b32 v160 offset:58400
    ds_write_addtid_b32 v161 offset:58656
    ds_write_addtid_b32 v162 offset:60576
    ds_write_addtid_b32 v163 offset:60832
    ds_write_addtid_b32 v164 offset:62752
    ds_write_addtid_b32 v165 offset:63008
    ds_read_b128 v[112:115], v13 offset:0
    ds_read_b128 v[116:119], v13 offset:64
    ds_read_b128 v[120:123], v13 offset:128
    ds_read_b128 v[124:127], v13 offset:192
    ds_read_b128 v[128:131], v13 offset:256
    ds_read_b128 v[132:135], v13 offset:320
    ds_read_b128 v[136:139], v13 offset:384
    ds_read_b128 v[140:143], v13 offset:448
    s_mov_b64 exec, 0xffff
    ds_write_b64 v200, v[234:235]
    s_mov_b32 exec_lo, -1
    ds_write2_b64 v201, v[234:235], v[234:235] offset0:132 offset1:140
    ds_write_b64 v202, v[234:235] offset:9472
    s_mov_b64 exec, -1
    ds_write_b64 v202, v[234:235] offset:10752
    ds_write_b64 v202, v[234:235] offset:10816
    ds_write_b64 v202, v[234:235] offset:10848
    ds_read_b32 v34, v6 offset:128
    s_buffer_load_dwordx8 s[16:23], s[44:47], s31
L_XI1:
    v_pk_mul_f16 v220, v48, v80 op_sel_hi:[1,0]
    v_pk_mul_f16 v221, v49, v81 op_sel_hi:[1,0]
    v_pk_mul_f16 v222, v50, v82 op_sel_hi:[1,0]
    v_pk_mul_f16 v223, v51, v83 op_sel_hi:[1,0]
    v_pk_fma_f16 v80, v48, v80, v220 op_sel:[1,1,0] op_sel_hi:[0,1,1] neg_hi:[1,0,0]
    v_pk_fma_f16 v81, v49, v81, v221 op_sel:[1,1,0] op_sel_hi:[0,1,1] neg_hi:[1,0,0]
    v_pk_fma_f16 v82, v50, v82, v222 op_sel:[1,1,0] op_sel_hi:[0,1,1] neg_hi:[1,0,0]
    v_pk_fma_f16 v83, v51, v83, v223 op_sel:[1,1,0] op_sel_hi:[0,1,1] neg_hi:[1,0,0]
    v_pk_mul_f16 v220, v52, v84 op_sel_hi:[1,0]
    v_pk_mul_f16 v221, v53, v85 op_sel_hi:[1,0]
    v_mfma_f32_16x16x32_f16 v[208:211], v[168:171], v[80:83], 0
    v_pk_mul_f16 v222, v54, v86 op_sel_hi:[1,0]
    v_pk_mul_f16 v223, v55, v87 op_sel_hi:[1,0]
    v_pk_fma_f16 v84, v52, v84, v220 op_sel:[1,1,0] op_sel_hi:[0,1,1] neg_hi:[1,0,0]
    v_pk_fma_f16 v85, v53, v85, v221 op_sel:[1,1,0] op_sel_hi:[0,1,1] neg_hi:[1,0,0]
    v_pk_fma_f16 v86, v54, v86, v222 op_sel:[1,1,0] op_sel_hi:[0,1,1] neg_hi:[1,0,0]
    v_pk_fma_f16 v87, v55, v87, v223 op_sel:[1,1,0] op_sel_hi:[0,1,1] neg_hi:[1,0,0]
    s_waitcnt lgkmcnt(12)
    s_nop 0
    v_pk_mul_f16 v220, v56, v88 op_sel_hi:[1,0]
    v_pk_mul_f16 v221, v57, v89 op_sel_hi:[1,0]
    v_mfma_f32_16x16x32_f16 v[208:211], v[172:175], v[84:87], v[208:211]
    v_pk_mul_f16 v222, v58, v90 op_sel_hi:[1,0]
    v_pk_mul_f16 v223, v59, v91 op_sel_hi:[1,0]
    v_pk_fma_f16 v88, v56, v88, v220 op_sel:[1,1,0] op_sel_hi:[0,1,1] neg_hi:[1,0,0]
    v_mfma_f32_16x16x32_f16 v[212:215], v[112:115], v[48:51], 0
    v_pk_fma_f16 v89, v57, v89, v221 op_sel:[1,1,0] op_sel_hi:[0,1,1] neg_hi:[1,0,0]
    v_pk_fma_f16 v90, v58, v90, v222 op_sel:[1,1,0] op_sel_hi:[0,1,1] neg_hi:[1,0,0]
    v_pk_fma_f16 v91, v59, v91, v223 op_sel:[1,1,0] op_sel_hi:[0,1,1] neg_hi:[1,0,0]
    v_mfma_f32_16x16x32_f16 v[216:219], v[112:115], v[80:83], 0
    v_pk_mul_f16 v220, v60, v92 op_sel_hi:[1,0]
    v_pk_mul_f16 v221, v61, v93 op_sel_hi:[1,0]
    v_mfma_f32_16x16x32_f16 v[208:211], v[176:179], v[88:91], v[208:211]
    v_pk_mul_f16 v222, v62, v94 op_sel_hi:[1,0]
    v_pk_mul_f16 v223, v63, v95 op_sel_hi:[1,0]
    v_pk_fma_f16 v92, v60, v92, v220 op_sel:[1,1,0] op_sel_hi:[0,1,1] neg_hi:[1,0,0]
    v_mfma_f32_16x16x32_f16 v[212:215], v[116:119], v[52:55], v[212:215]
    v_pk_fma_f16 v93, v61, v93, v221 op_sel:[1,1,0] op_sel_hi:[0,1,1] neg_hi:[1,0,0]
    v_pk_fma_f16 v94, v62, v94, v222 op_sel:[1,1,0] op_sel_hi:[0,1,1] neg_hi:[1,0,0]
    v_pk_fma_f16 v95, v63, v95, v223 op_sel:[1,1,0] op_sel_hi:[0,1,1] neg_hi:[1,0,0]
    v_mfma_f32_16x16x32_f16 v[216:219], v[116:119], v[84:87], v[216:219]
    s_waitcnt lgkmcnt(10)
    s_nop 0
    v_pk_mul_f16 v220, v64, v96 op_sel_hi:[1,0]
    v_pk_mul_f16 v221, v65, v97 op_sel_hi:[1,0]
    v_mfma_f32_16x16x32_f16 v[208:211], v[180:183], v[92:95], v[208:211]
    v_pk_mul_f16 v222, v66, v98 op_sel_hi:[1,0]
    v_pk_mul_f16 v223, v67, v99 op_sel_hi:[1,0]
    v_pk_fma_f16 v96, v64, v96, v220 op_sel:[1,1,0] op_sel_hi:[0,1,1] neg_hi:[1,0,0]
    v_mfma_f32_16x16x32_f16 v[212:215], v[120:123], v[56:59], v[212:215]
    v_pk_fma_f16 v97, v65, v97, v221 op_sel:[1,1,0] op_sel_hi:[0,1,1] neg_hi:[1,0,0]
    v_pk_fma_f16 v98, v66, v98, v222 op_sel:[1,1,0] op_sel_hi:[0,1,1] neg_hi:[1,0,0]
    v_pk_fma_f16 v99, v67, v99, v223 op_sel:[1,1,0] op_sel_hi:[0,1,1] neg_hi:[1,0,0]
    v_mfma_f32_16x16x32_f16 v[216:219], v[120:123], v[88:91], v[216:219]
    v_pk_mul_f16 v220, v68, v100 op_sel_hi:[1,0]
    v_pk_mul_f16 v221, v69, v101 op_sel_hi:[1,0]
    v_mfma_f32_16x16x32_f16 v[208:211], v[184:187], v[96:99], v[208:211]
    v_pk_mul_f16 v222, v70, v102 op_sel_hi:[1,0]
    v_pk_mul_f16 v223, v71, v103 op_sel_hi:[1,0]
    v_pk_fma_f16 v100, v68, v100, v220 op_sel:[1,1,0] op_sel_hi:[0,1,1] neg_hi:[1,0,0]
    v_mfma_f32_16x16x32_f16 v[212:215], v[124:127], v[60:63], v[212:215]
    v_pk_fma_f16 v101, v69, v101, v221 op_sel:[1,1,0] op_sel_hi:[0,1,1] neg_hi:[1,0,0]
    v_pk_fma_f16 v102, v70, v102, v222 op_sel:[1,1,0] op_sel_hi:[0,1,1] neg_hi:[1,0,0]
    v_pk_fma_f16 v103, v71, v103, v223 op_sel:[1,1,0] op_sel_hi:[0,1,1] neg_hi:[1,0,0]
    v_mfma_f32_16x16x32_f16 v[216:219], v[124:127], v[92:95], v[216:219]
    s_waitcnt lgkmcnt(8)
    s_nop 0
    v_pk_mul_f16 v220, v72, v104 op_sel_hi:[1,0]
    v_pk_mul_f16 v221, v73, v105 op_sel_hi:[1,0]
    v_mfma_f32_16x16x32_f16 v[208:211], v[188:191], v[100:103], v[208:211]
    v_pk_mul_f16 v222, v74, v106 op_sel_hi:[1,0]
    v_pk_mul_f16 v223, v75, v107 op_sel_hi:[1,0]
    v_pk_fma_f16 v104, v72, v104, v220 op_sel:[1,1,0] op_sel_hi:[0,1,1] neg_hi:[1,0,0]
    v_mfma_f32_16x16x32_f16 v[212:215], v[128:131], v[64:67], v[212:215]
    v_pk_fma_f16 v105, v73, v105, v221 op_sel:[1,1,0] op_sel_hi:[0,1,1] neg_hi:[1,0,0]
    v_pk_fma_f16 v106, v74, v106, v222 op_sel:[1,1,0] op_sel_hi:[0,1,1] neg_hi:[1,0,0]
    v_pk_fma_f16 v107, v75, v107, v223 op_sel:[1,1,0] op_sel_hi:[0,1,1] neg_hi:[1,0,0]
    v_mfma_f32_16x16x32_f16 v[216:219], v[128:131], v[96:99], v[216:219]
    v_pk_mul_f16 v220, v76, v108 op_sel_hi:[1,0]
    v_pk_mul_f16 v221, v77, v109 op_sel_hi:[1,0]
    v_mfma_f32_16x16x32_f16 v[208:211], v[192:195], v[104:107], v[208:211]
    v_pk_mul_f16 v222, v78, v110 op_sel_hi:[1,0]
    v_pk_mul_f16 v223, v79, v111 op_sel_hi:[1,0]
    v_pk_fma_f16 v108, v76, v108, v220 op_sel:[1,1,0] op_sel_hi:[0,1,1] neg_hi:[1,0,0]
    v_mfma_f32_16x16x32_f16 v[212:215], v[132:135], v[68:71], v[212:215]
    v_pk_fma_f16 v109, v77, v109, v221 op_sel:[1,1,0] op_sel_hi:[0,1,1] neg_hi:[1,0,0]
    v_pk_fma_f16 v110, v78, v110, v222 op_sel:[1,1,0] op_sel_hi:[0,1,1] neg_hi:[1,0,0]
    v_pk_fma_f16 v111, v79, v111, v223 op_sel:[1,1,0] op_sel_hi:[0,1,1] neg_hi:[1,0,0]
    v_mfma_f32_16x16x32_f16 v[216:219], v[132:135], v[100:103], v[216:219]
    s_waitcnt lgkmcnt(6)
    s_nop 0
    v_mfma_f32_16x16x32_f16 v[208:211], v[196:199], v[108:111], v[208:211]
    v_mfma_f32_16x16x32_f16 v[212:215], v[136:139], v[72:75], v[212:215]
    v_mfma_f32_16x16x32_f16 v[216:219], v[136:139], v[104:107], v[216:219]
    v_mfma_f32_16x16x32_f16 v[212:215], v[140:143], v[76:79], v[212:215]
    v_mfma_f32_16x16x32_f16 v[216:219], v[140:143], v[108:111], v[216:219]
    s_waitcnt lgkmcnt(0)
    v_readfirstlane_b32 s28, v34
    s_add_u32 s31, s31, 64
    s_mov_b32 s29, s28
    s_cmp_eq_u32 s28, 0
    s_cbranch_scc1 L_XE1
    s_xor_b64 s[16:17], s[16:17], s[28:29]
    s_xor_b64 s[18:19], s[18:19], s[28:29]
    s_xor_b64 s[20:21], s[20:21], s[28:29]
    s_xor_b64 s[22:23], s[22:23], s[28:29]
    s_or_b64 s[16:17], s[16:17], s[18:19]
    s_or_b64 s[20:21], s[20:21], s[22:23]
    s_or_b64 s[16:17], s[16:17], s[20:21]
    s_cbranch_scc1 L_XE1
    s_setprio 3
    buffer_load_dwordx4 v[16:19], v33, s[44:47], s32 offen sc1
    buffer_load_dwordx4 v[20:23], v33, s[44:47], s33 offen sc1
    buffer_load_dwordx4 v[24:27], v33, s[44:47], s34 offen sc1
    buffer_load_dwordx4 v[28:31], v33, s[44:47], s35 offen sc1
    s_mov_b64 exec, 1
    ds_write_b32 v4, v5 offset:544
    s_mov_b64 exec, -1
    s_setprio 2
    s_mov_b32 s30, 1
L_XE1:
    s_cmp_lg_u32 s30, 0
    s_cbranch_scc1 L_XI2
    ds_read_b32 v34, v6 offset:128
    s_buffer_load_dwordx8 s[16:23], s[44:47], s31
L_XI2:
    s_lshl_b32 s4, s58, 4
    s_lshr_b64 s[6:7], s[66:67], s4
    s_lshl_b32 s6, s6, 16
    v_permlane32_swap_b32 v204, v208
    v_permlane32_swap_b32 v205, v209
    v_permlane32_swap_b32 v206, v210
    v_permlane32_swap_b32 v207, v211
    v_cvt_pk_bf16_f32 v220, v215, v219
    s_mov_b64 exec, 1
    v_add_f32 v204, s6, v204
    v_add_f32_e64 v204, 1.0, v204
    s_mov_b64 exec, -1
    v_permlane32_swap_b32 v212, v216
    v_permlane32_swap_b32 v213, v217
    v_permlane32_swap_b32 v214, v218
    ds_write_b16 v47, v220 offset:9504
    ds_write_b16_d16_hi v47, v220 offset:9520
    ds_write_b16 v47, v220 offset:9662
    ds_write_b16_d16_hi v47, v220 offset:9678
    ds_write_b16 v47, v220 offset:9820
    ds_write_b16_d16_hi v47, v220 offset:9836
    ds_write_b16 v47, v220 offset:9978
    ds_write_b16_d16_hi v47, v220 offset:9994
    v_cvt_pk_bf16_f32 v48, v204, v205
    v_cvt_pk_bf16_f32 v49, v206, v207
    v_cvt_pk_bf16_f32 v50, v205, v206
    v_cvt_pk_bf16_f32 v51, v207, v212
    v_cvt_pk_bf16_f32 v52, v206, v207
    v_cvt_pk_bf16_f32 v53, v212, v213
    v_cvt_pk_bf16_f32 v54, v207, v212
    v_cvt_pk_bf16_f32 v55, v213, v214
    v_cvt_pk_bf16_f32 v56, v208, v208
    v_cvt_pk_bf16_f32 v57, v209, v210
    v_cvt_pk_bf16_f32 v58, v208, v209
    v_cvt_pk_bf16_f32 v59, v210, v210
    v_cvt_pk_bf16_f32 v60, v209, v210
    v_cvt_pk_bf16_f32 v61, v210, v210
    v_cvt_pk_bf16_f32 v62, v210, v210
    v_cvt_pk_bf16_f32 v63, v210, v211
    v_cvt_pk_bf16_f32 v64, v217, v218
    v_mov_b32_e64 v71, s8
    v_cvt_pk_bf16_f32 v80, v234, v204
    v_mov_b32_e64 v81, v50
    v_cvt_pk_bf16_f32 v66, v216, v216
    v_cvt_pk_bf16_f32 v67, v216, v234
    v_cvt_pk_bf16_f32 v68, v234, v218
    v_cvt_pk_bf16_f32 v69, v218, v234
    v_cvt_pk_bf16_f32 v70, v218, v218
    s_cmp_lg_u32 s30, 0
    s_cbranch_scc1 L_XE2
    s_waitcnt lgkmcnt(0)
    v_readfirstlane_b32 s28, v34
    s_add_u32 s31, s31, 64
    s_mov_b32 s29, s28
    s_cmp_eq_u32 s28, 0
    s_cbranch_scc1 L_XE2
    s_xor_b64 s[16:17], s[16:17], s[28:29]
    s_xor_b64 s[18:19], s[18:19], s[28:29]
    s_xor_b64 s[20:21], s[20:21], s[28:29]
    s_xor_b64 s[22:23], s[22:23], s[28:29]
    s_or_b64 s[16:17], s[16:17], s[18:19]
    s_or_b64 s[20:21], s[20:21], s[22:23]
    s_or_b64 s[16:17], s[16:17], s[20:21]
    s_cbranch_scc1 L_XE2
    s_setprio 3
    buffer_load_dwordx4 v[16:19], v33, s[44:47], s32 offen sc1
    buffer_load_dwordx4 v[20:23], v33, s[44:47], s33 offen sc1
    buffer_load_dwordx4 v[24:27], v33, s[44:47], s34 offen sc1
    buffer_load_dwordx4 v[28:31], v33, s[44:47], s35 offen sc1
    s_mov_b64 exec, 1
    ds_write_b32 v4, v5 offset:544
    s_mov_b64 exec, -1
    s_setprio 2
    s_mov_b32 s30, 1
L_XE2:
    s_nop 0
    ds_write_b64 v203, v[48:49] offset:32
    ds_write_b64 v203, v[50:51] offset:2400
    ds_write_b64 v203, v[52:53] offset:4768
    ds_write_b64 v203, v[54:55] offset:7136
    ds_write_b64 v203, v[56:57] offset:544
    ds_write_b64 v203, v[58:59] offset:2912
    ds_write_b64 v203, v[60:61] offset:5280
    ds_write_b64 v203, v[62:63] offset:7648
    ds_write_b16 v46, v64 offset:10784
    ds_write_b16_d16_hi v46, v64 offset:11424
    ds_write_b16 v46, v64 offset:10942
    ds_write_b16_d16_hi v46, v64 offset:11582
    ds_write_b16 v46, v64 offset:11100
    ds_write_b16_d16_hi v46, v64 offset:11740
    ds_write_b16 v46, v64 offset:11258
    ds_write_b16_d16_hi v46, v64 offset:11898
    s_mov_b64 exec, 1
    s_nop 0
    ds_write_b32 v71, v80 offset:2396
    ds_write_b32 v71, v48 offset:4764
    ds_write_b64 v71, v[80:81] offset:7128
    ds_write_b64 v71, v[66:67] offset:1056
    ds_write_b32 v71, v66 offset:3424
    ds_write_b16 v71, v66 offset:5792
    ds_write_b16 v71, v66 offset:8158
    ds_write_b16 v71, v56 offset:5278
    ds_write_b16 v71, v56 offset:7644
    s_brev_b64 exec, 1
    s_nop 0
    ds_write_b32 v71, v68 offset:1124
    ds_write_b32 v71, v69 offset:1128
    ds_write_b32 v71, v70 offset:3492
    ds_write_b64 v71, v[68:69] offset:5856
    ds_write_b32 v71, v70 offset:8224
    s_mov_b64 exec, -1
LW_1:
    ds_read_b32 v34, v6 offset:128
    s_waitcnt lgkmcnt(0)
    v_cmp_eq_u32 vcc, 0, v34
    s_cbranch_vccnz LW_1
    s_cmp_lg_u32 s30, 0
    s_cbranch_scc1 L_XS1
    s_buffer_load_dwordx8 s[16:23], s[44:47], s31
L_XS1:
    v_readfirstlane_b32 s28, v34
    ds_write_b64 v15, v[234:235] offset:4096
    s_mov_b32 s5, 0
    s_mov_b32 s29, s28
    s_nop 0
    ds_read_b64 v[48:49], v1 offset:0
    ds_read_b64 v[50:51], v1 offset:8
    ds_read_b64 v[52:53], v1 offset:64
    ds_read_b64 v[54:55], v1 offset:72
    ds_read_b64 v[56:57], v1 offset:128
    ds_read_b64 v[58:59], v1 offset:136
    ds_read_b64 v[60:61], v1 offset:192
    ds_read_b64 v[62:63], v1 offset:200
    ds_read_b64 v[64:65], v1 offset:256
    ds_read_b64 v[66:67], v1 offset:264
    ds_read_b64 v[68:69], v1 offset:320
    ds_read_b64 v[70:71], v1 offset:328
    ds_read_b64 v[72:73], v1 offset:384
    ds_read_b64 v[74:75], v1 offset:392
    ds_read_b64 v[76:77], v1 offset:448
    ds_read_b64 v[78:79], v1 offset:456
    ds_read_b64 v[80:81], v1 offset:512
    ds_read_b64 v[82:83], v1 offset:520
    ds_read_b64 v[84:85], v1 offset:576
    ds_read_b64 v[86:87], v1 offset:584
    ds_read_b64 v[88:89], v1 offset:640
    ds_read_b64 v[90:91], v1 offset:648
    ds_read_b64 v[92:93], v1 offset:704
    ds_read_b64 v[94:95], v1 offset:712
    ds_read_b64 v[96:97], v1 offset:768
    ds_read_b64 v[98:99], v1 offset:776
    ds_read_b64 v[100:101], v1 offset:832
    ds_read_b64 v[102:103], v1 offset:840
    ds_read_b64 v[104:105], v1 offset:896
    ds_read_b64 v[106:107], v1 offset:904
    s_cmp_lg_u32 s30, 0
    s_cbranch_scc1 L_XA
    s_waitcnt lgkmcnt(0)
    s_xor_b64 s[16:17], s[16:17], s[28:29]
    s_xor_b64 s[18:19], s[18:19], s[28:29]
    s_xor_b64 s[20:21], s[20:21], s[28:29]
    s_xor_b64 s[22:23], s[22:23], s[28:29]
    s_or_b64 s[16:17], s[16:17], s[18:19]
    s_or_b64 s[20:21], s[20:21], s[22:23]
    s_or_b64 s[16:17], s[16:17], s[20:21]
    s_cbranch_scc1 L_XF
    s_setprio 3
    buffer_load_dwordx4 v[16:19], v33, s[44:47], s32 offen sc1
    buffer_load_dwordx4 v[20:23], v33, s[44:47], s33 offen sc1
    buffer_load_dwordx4 v[24:27], v33, s[44:47], s34 offen sc1
    buffer_load_dwordx4 v[28:31], v33, s[44:47], s35 offen sc1
    s_mov_b64 exec, 1
    ds_write_b32 v4, v5 offset:544
    s_mov_b64 exec, -1
    s_setprio 2
L_XA:
    s_nop 0
    ds_read_b64 v[108:109], v1 offset:960
    ds_read_b64 v[110:111], v1 offset:968
    ds_read_b64 v[112:113], v1 offset:1024
    ds_read_b64 v[114:115], v1 offset:1032
    ds_read_b64 v[116:117], v1 offset:1088
    ds_read_b64 v[118:119], v1 offset:1096
    ds_read_b64 v[120:121], v2 offset:10776
    ds_read_b64 v[122:123], v2 offset:11416
    ds_read_b64 v[124:125], v2 offset:12056
    ds_read_b64 v[126:127], v2 offset:12696
    ds_read_b64 v[128:129], v2 offset:10808
    ds_read_b64 v[130:131], v2 offset:11448
    ds_read_b64 v[132:133], v2 offset:12088
    ds_read_b64 v[134:135], v2 offset:12728
    ds_read_b64 v[136:137], v2 offset:10840
    ds_read_b64 v[138:139], v2 offset:11480
    ds_read_b64 v[140:141], v2 offset:12120
    ds_read_b64 v[142:143], v2 offset:12760
L_XBACK:
    s_waitcnt vmcnt(3)
    v_lshlrev_b32 v36, 16, v16
    v_and_b32 v37, 0xffff0000, v16
    v_lshlrev_b32_e64 v38, 16, v17
    v_and_b32 v39, 0xffff0000, v17
    v_lshlrev_b32_e64 v40, 16, v18
    v_and_b32 v41, 0xffff0000, v18
    v_lshlrev_b32_e64 v42, 16, v19
    v_and_b32 v43, 0xffff0000, v19
L_MSW:
    ds_read_b32 v11, v4 offset:528
    ds_read_b64 v[12:13], v10 offset:9216
    s_waitcnt lgkmcnt(0)
    v_cmp_eq_u32 vcc, 0, v11
    s_cbranch_vccnz L_MSW
    v_lshlrev_b32 v44, 16, v13
    v_and_b32 v45, 0xffff0000, v13
    v_rcp_f32 v44, v44
    v_rcp_f32 v45, v45
    v_lshlrev_b32_e64 v46, 16, v12
    v_and_b32 v47, 0xffff0000, v12
    v_pk_mul_f32 v[46:47], v[46:47], v[44:45]
    v_pk_fma_f32 v[36:37], v[36:37], v[44:45], v[46:47] op_sel:[0,0,0] op_sel_hi:[1,0,0] neg_lo:[0,0,1] neg_hi:[0,0,1]
    v_pk_fma_f32 v[40:41], v[40:41], v[44:45], v[46:47] op_sel:[0,1,1] op_sel_hi:[1,1,1] neg_lo:[0,0,1] neg_hi:[0,0,1]
    v_pk_fma_f32 v[38:39], v[38:39], v[44:45], v[46:47] op_sel:[0,0,0] op_sel_hi:[1,0,0] neg_lo:[0,0,1] neg_hi:[0,0,1]
    v_pk_fma_f32 v[42:43], v[42:43], v[44:45], v[46:47] op_sel:[0,1,1] op_sel_hi:[1,1,1] neg_lo:[0,0,1] neg_hi:[0,0,1]
    v_cvt_pk_bf16_f32 v36, v40, v36
    v_cvt_pk_bf16_f32 v37, v41, v37
    v_cvt_pk_bf16_f32 v38, v42, v38
    v_cvt_pk_bf16_f32 v39, v43, v39
    ds_write2st64_b32 v32, v36, v37 offset0:12 offset1:30
    ds_write2st64_b32 v32, v38, v39 offset0:48 offset1:66
    s_mov_b64 exec, 1
    ds_write_b32 v4, v11 offset:0
    s_mov_b64 exec, -1
    s_setprio 1
L_XRW:
    s_nop 0
    ds_read_b32 v15, v6 offset:0
    ds_read_b128 v[180:183], v7 offset:4032
    ds_read_b128 v[184:187], v7 offset:3968
    ds_read_b128 v[188:191], v7 offset:3904
    ds_read_b128 v[192:195], v7 offset:3840
    ds_read_b128 v[196:199], v7 offset:3776
    ds_read_b128 v[200:203], v7 offset:3712
    s_waitcnt lgkmcnt(6)
    v_cmp_eq_u32 vcc, 0, v15
    s_cbranch_vccnz L_XRW
    v_cmp_ne_u32_e64 vcc, 2, v15
    s_cmp_eq_u32 vcc_lo, 0
    s_cselect_b32 s14, 2, 1
    s_waitcnt lgkmcnt(5)
    v_mfma_f32_16x16x32_bf16 v[204:207], v[76:79], v[180:183], 0
    ds_read_b64 v[12:13], v10 offset:11264
    s_waitcnt vmcnt(2)
    v_mfma_f32_16x16x32_bf16 v[208:211], v[108:111], v[180:183], 0
    v_lshlrev_b32_e64 v36, 16, v20
    s_waitcnt lgkmcnt(5)
    v_mfma_f32_16x16x32_bf16 v[204:207], v[72:75], v[184:187], v[204:207]
    ds_read_b128 v[180:183], v7 offset:3648
    v_and_b32 v37, 0xffff0000, v20
    v_mfma_f32_16x16x32_bf16 v[208:211], v[104:107], v[184:187], v[208:211]
    v_lshlrev_b32 v38, 16, v21
    s_waitcnt lgkmcnt(5)
    v_mfma_f32_16x16x32_bf16 v[204:207], v[68:71], v[188:191], v[204:207]
    ds_read_b128 v[184:187], v7 offset:3584
    v_and_b32 v39, 0xffff0000, v21
    v_mfma_f32_16x16x32_bf16 v[208:211], v[100:103], v[188:191], v[208:211]
    v_lshlrev_b32 v40, 16, v22
    s_waitcnt lgkmcnt(3)
    v_mfma_f32_16x16x32_bf16 v[204:207], v[64:67], v[192:195], v[204:207]
    ds_read_b128 v[188:191], v7 offset:3520
    v_and_b32 v41, 0xffff0000, v22
    v_mfma_f32_16x16x32_bf16 v[208:211], v[96:99], v[192:195], v[208:211]
    v_lshlrev_b32_e64 v42, 16, v23
    v_and_b32 v43, 0xffff0000, v23
    v_mfma_f32_16x16x32_bf16 v[204:207], v[60:63], v[196:199], v[204:207]
    ds_read_b128 v[192:195], v7 offset:3600
    s_waitcnt lgkmcnt(3)
    v_lshlrev_b32 v44, 16, v13
    v_mfma_f32_16x16x32_bf16 v[208:211], v[92:95], v[196:199], v[208:211]
    v_and_b32 v45, 0xffff0000, v13
    v_mfma_f32_16x16x32_bf16 v[204:207], v[56:59], v[200:203], v[204:207]
    ds_read_b128 v[196:199], v7 offset:3456
    v_mfma_f32_16x16x32_bf16 v[208:211], v[88:91], v[200:203], v[208:211]
    v_rcp_f32_e64 v44, v44
    v_mfma_f32_16x16x32_bf16 v[204:207], v[52:55], v[180:183], v[204:207]
    ds_read_b128 v[200:203], v7 offset:3392
    v_mfma_f32_16x16x32_bf16 v[208:211], v[84:87], v[180:183], v[208:211]
    v_rcp_f32 v45, v45
    s_waitcnt lgkmcnt(3)
    v_mfma_f32_16x16x32_bf16 v[204:207], v[48:51], v[184:187], v[204:207]
    ds_read_b128 v[180:183], v7 offset:3328
    v_lshlrev_b32_e64 v46, 16, v12
    v_mfma_f32_16x16x32_bf16 v[208:211], v[80:83], v[184:187], v[208:211]
    v_and_b32 v47, 0xffff0000, v12
    v_mul_f32_e64 v46, v46, v44
    v_mfma_f32_16x16x32_bf16 v[212:215], v[112:115], v[184:187], 0
    v_mul_f32_e64 v47, v47, v45
    v_fma_f32 v36, v36, v44, -v46
    v_fma_f32 v40, v40, v45, -v47
    v_mfma_f32_16x16x32_bf16 v[220:223], v[116:119], v[184:187], 0
    ds_write_b128 v8, v[204:207] offset:0
    v_mfma_f32_16x16x32_bf16 v[152:155], v[184:187], v[240:243], 0
    v_fma_f32 v37, v37, v44, -v46
    v_fma_f32 v41, v41, v45, -v47
    v_mfma_f32_16x16x32_bf16 v[156:159], v[184:187], v[252:255], 0
    v_fma_f32 v38, v38, v44, -v46
    v_fma_f32 v42, v42, v45, -v47
    v_mfma_f32_16x16x32_bf16 v[168:171], v[184:187], v[244:247], 0
    v_fma_f32 v39, v39, v44, -v46
    v_fma_f32 v43, v43, v45, -v47
    v_mfma_f32_16x16x32_bf16 v[208:211], v[76:79], v[188:191], v[208:211]
    ds_read_b128 v[184:187], v7 offset:3264
    v_cvt_pk_bf16_f32 v154, v155, v154
    v_mfma_f32_16x16x32_bf16 v[212:215], v[108:111], v[188:191], v[212:215]
    v_cvt_pk_bf16_f32 v155, v153, v152
    s_waitcnt lgkmcnt(2)
    s_nop 0
    v_mfma_f32_16x16x32_bf16 v[160:163], v[192:195], v[240:243], 0
    v_cvt_pk_bf16_f32 v157, v157, v156
    v_cvt_pk_bf16_f32 v156, v159, v158
    v_mfma_f32_16x16x32_bf16 v[164:167], v[192:195], v[252:255], 0
    ds_read_b128 v[188:191], v7 offset:3200
    v_cvt_pk_bf16_f32 v176, v171, v170
    v_cvt_pk_bf16_f32 v177, v169, v168
    v_mfma_f32_16x16x32_bf16 v[172:175], v[192:195], v[248:251], 0
    v_cvt_pk_bf16_f32 v36, v40, v36
    v_cvt_pk_bf16_f32 v162, v163, v162
    v_mfma_f32_16x16x32_bf16 v[208:211], v[72:75], v[196:199], v[208:211]
    ds_read_b128 v[192:195], v7 offset:3136
    v_cvt_pk_bf16_f32 v163, v161, v160
    v_mfma_f32_16x16x32_bf16 v[212:215], v[104:107], v[196:199], v[212:215]
    v_cvt_pk_bf16_f32 v165, v165, v164
    v_cvt_pk_bf16_f32 v164, v167, v166
    v_mfma_f32_16x16x32_bf16 v[208:211], v[68:71], v[200:203], v[208:211]
    ds_read_b128 v[196:199], v7 offset:3072
    v_cvt_pk_bf16_f32 v178, v175, v174
    v_mfma_f32_16x16x32_bf16 v[212:215], v[100:103], v[200:203], v[212:215]
    v_cvt_pk_bf16_f32 v179, v173, v172
    v_cvt_pk_bf16_f32 v37, v41, v37
    v_mfma_f32_16x16x32_bf16 v[208:211], v[64:67], v[180:183], v[208:211]
    v_cvt_pk_bf16_f32 v38, v42, v38
    v_cvt_pk_bf16_f32 v39, v43, v39
    v_mfma_f32_16x16x32_bf16 v[212:215], v[96:99], v[180:183], v[212:215]
    ds_write2st64_b32 v32, v36, v37 offset0:8 offset1:26
    v_mfma_f32_16x16x32_bf16 v[212:215], v[154:157], v[120:123], v[212:215]
    ds_write2st64_b32 v32, v38, v39 offset0:44 offset1:62
    ds_write_b32 v4, v5 offset:160
    v_mfma_f32_16x16x32_bf16 v[216:219], v[154:157], v[128:131], 0
    ds_read_b64 v[12:13], v10 offset:13312
    s_waitcnt vmcnt(0)
    v_mfma_f32_16x16x32_bf16 v[220:223], v[154:157], v[136:139], v[220:223]
    v_lshlrev_b32_e64 v36, 16, v24
    s_waitcnt lgkmcnt(4)
    v_mfma_f32_16x16x32_bf16 v[208:211], v[60:63], v[184:187], v[208:211]
    v_and_b32 v37, 0xffff0000, v24
    v_lshlrev_b32_e64 v38, 16, v25
    v_mfma_f32_16x16x32_bf16 v[212:215], v[92:95], v[184:187], v[212:215]
    v_and_b32 v39, 0xffff0000, v25
    v_lshlrev_b32_e64 v40, 16, v26
    v_mfma_f32_16x16x32_bf16 v[212:215], v[162:165], v[124:127], v[212:215]
    ds_read_b32 v11, v6 offset:160
    v_and_b32 v41, 0xffff0000, v26
    v_mfma_f32_16x16x32_bf16 v[216:219], v[162:165], v[132:135], v[216:219]
    v_lshlrev_b32_e64 v42, 16, v27
    v_and_b32 v43, 0xffff0000, v27
    v_mfma_f32_16x16x32_bf16 v[220:223], v[162:165], v[140:143], v[220:223]
    s_waitcnt lgkmcnt(1)
    v_lshlrev_b32 v44, 16, v13
    v_mfma_f32_16x16x32_bf16 v[208:211], v[56:59], v[188:191], v[208:211]
    v_and_b32 v45, 0xffff0000, v13
    v_rcp_f32_e64 v44, v44
    v_mfma_f32_16x16x32_bf16 v[212:215], v[88:91], v[188:191], v[212:215]
    v_rcp_f32_e64 v45, v45
    v_mfma_f32_16x16x32_bf16 v[208:211], v[52:55], v[192:195], v[208:211]
    v_lshlrev_b32_e64 v46, 16, v12
    v_and_b32 v47, 0xffff0000, v12
    v_mfma_f32_16x16x32_bf16 v[212:215], v[84:87], v[192:195], v[212:215]
    s_waitcnt lgkmcnt(0)
    v_cmp_eq_u32 vcc, 0, v11
    v_mfma_f32_16x16x32_bf16 v[208:211], v[48:51], v[196:199], v[208:211]
    s_cbranch_vccnz L_SLOW3
L_BACK3:
    s_nop 0
    ds_read_b128 v[200:203], v7 offset:3008
    v_mfma_f32_16x16x32_bf16 v[212:215], v[80:83], v[196:199], v[212:215]
    ds_read_b128 v[180:183], v7 offset:3088
    ds_read_b128 v[184:187], v7 offset:2944
    v_mfma_f32_16x16x32_bf16 v[216:219], v[112:115], v[196:199], v[216:219]
    ds_read_b128 v[188:191], v7 offset:2880
    ds_read_b128 v[192:195], v7 offset:2816
    v_mfma_f32_16x16x32_bf16 v[224:227], v[116:119], v[196:199], 0
    ds_write_b128 v8, v[208:211] offset:1024
    v_mfma_f32_16x16x32_bf16 v[152:155], v[196:199], v[240:243], 0
    v_mul_f32 v46, v46, v44
    v_mul_f32 v47, v47, v45
    v_fma_f32 v36, v36, v44, -v46
    v_mfma_f32_16x16x32_bf16 v[156:159], v[196:199], v[252:255], 0
    v_fma_f32 v40, v40, v45, -v47
    v_fma_f32 v37, v37, v44, -v46
    v_mfma_f32_16x16x32_bf16 v[168:171], v[196:199], v[244:247], 0
    v_fma_f32 v41, v41, v45, -v47
    s_waitcnt lgkmcnt(5)
    s_nop 0
    v_mfma_f32_16x16x32_bf16 v[212:215], v[76:79], v[200:203], v[212:215]
    ds_read_b128 v[196:199], v7 offset:2752
    v_cvt_pk_bf16_f32 v154, v155, v154
    v_mfma_f32_16x16x32_bf16 v[216:219], v[108:111], v[200:203], v[216:219]
    v_cvt_pk_bf16_f32 v155, v153, v152
    s_waitcnt lgkmcnt(2)
    s_nop 0
    v_mfma_f32_16x16x32_bf16 v[160:163], v[180:183], v[240:243], 0
    ds_read_b128 v[200:203], v7 offset:2688
    v_cvt_pk_bf16_f32 v157, v157, v156
    v_mfma_f32_16x16x32_bf16 v[164:167], v[180:183], v[252:255], 0
    v_cvt_pk_bf16_f32 v156, v159, v158
    v_cvt_pk_bf16_f32 v144, v171, v170
    v_mfma_f32_16x16x32_bf16 v[172:175], v[180:183], v[248:251], 0
    v_cvt_pk_bf16_f32 v145, v169, v168
    v_fma_f32 v38, v38, v44, -v46
    v_mfma_f32_16x16x32_bf16 v[212:215], v[72:75], v[184:187], v[212:215]
    ds_read_b128 v[180:183], v7 offset:2624
    v_cvt_pk_bf16_f32 v162, v163, v162
    v_cvt_pk_bf16_f32 v163, v161, v160
    v_mfma_f32_16x16x32_bf16 v[216:219], v[104:107], v[184:187], v[216:219]
    v_cvt_pk_bf16_f32 v165, v165, v164
    v_cvt_pk_bf16_f32 v164, v167, v166
    v_mfma_f32_16x16x32_bf16 v[212:215], v[68:71], v[188:191], v[212:215]
    ds_read_b128 v[184:187], v7 offset:2560
    v_cvt_pk_bf16_f32 v146, v175, v174
    v_mfma_f32_16x16x32_bf16 v[216:219], v[100:103], v[188:191], v[216:219]
    v_cvt_pk_bf16_f32 v147, v173, v172
    v_fma_f32 v42, v42, v45, -v47
    v_mfma_f32_16x16x32_bf16 v[212:215], v[64:67], v[192:195], v[212:215]
    v_fma_f32 v39, v39, v44, -v46
    v_fma_f32 v43, v43, v45, -v47
    v_mfma_f32_16x16x32_bf16 v[216:219], v[96:99], v[192:195], v[216:219]
    v_cvt_pk_bf16_f32 v36, v40, v36
    s_waitcnt lgkmcnt(2)
    s_nop 0
    v_mfma_f32_16x16x32_bf16 v[212:215], v[60:63], v[196:199], v[212:215]
    v_cvt_pk_bf16_f32 v37, v41, v37
    v_cvt_pk_bf16_f32 v38, v42, v38
    v_mfma_f32_16x16x32_bf16 v[216:219], v[92:95], v[196:199], v[216:219]
    v_cvt_pk_bf16_f32 v39, v43, v39
    ds_read_b128 v[188:191], v7 offset:2496
    v_mfma_f32_16x16x32_bf16 v[216:219], v[154:157], v[120:123], v[216:219]
    ds_write2st64_b32 v32, v36, v37 offset0:4 offset1:22
    ds_read_b128 v[192:195], v7 offset:2576
    v_mfma_f32_16x16x32_bf16 v[220:223], v[154:157], v[128:131], v[220:223]
    ds_write2st64_b32 v32, v38, v39 offset0:40 offset1:58
    v_mfma_f32_16x16x32_bf16 v[224:227], v[154:157], v[136:139], v[224:227]
    ds_write_b32 v4, v5 offset:144
    ds_read_b64 v[12:13], v10 offset:15360
    v_mfma_f32_16x16x32_bf16 v[212:215], v[56:59], v[200:203], v[212:215]
    v_lshlrev_b32_e64 v36, 16, v28
    v_and_b32 v37, 0xffff0000, v28
    v_mfma_f32_16x16x32_bf16 v[216:219], v[88:91], v[200:203], v[216:219]
    v_lshlrev_b32_e64 v38, 16, v29
    v_and_b32 v39, 0xffff0000, v29
    v_mfma_f32_16x16x32_bf16 v[216:219], v[162:165], v[124:127], v[216:219]
    v_lshlrev_b32_e64 v40, 16, v30
    v_and_b32 v41, 0xffff0000, v30
    v_mfma_f32_16x16x32_bf16 v[220:223], v[162:165], v[132:135], v[220:223]
    ds_read_b32 v11, v6 offset:144
    ds_read_b128 v[196:199], v7 offset:2432
    v_mfma_f32_16x16x32_bf16 v[224:227], v[162:165], v[140:143], v[224:227]
    v_lshlrev_b32 v42, 16, v31
    s_waitcnt lgkmcnt(4)
    v_mfma_f32_16x16x32_bf16 v[212:215], v[52:55], v[180:183], v[212:215]
    ds_read_b128 v[200:203], v7 offset:2368
    v_and_b32 v43, 0xffff0000, v31
    s_waitcnt lgkmcnt(3)
    v_mfma_f32_16x16x32_bf16 v[216:219], v[84:87], v[180:183], v[216:219]
    v_lshlrev_b32 v44, 16, v13
    v_and_b32 v45, 0xffff0000, v13
    v_mfma_f32_16x16x32_bf16 v[212:215], v[48:51], v[184:187], v[212:215]
    ds_read_b128 v[180:183], v7 offset:2304
    v_mfma_f32_16x16x32_bf16 v[216:219], v[80:83], v[184:187], v[216:219]
    v_rcp_f32_e64 v44, v44
    v_mfma_f32_16x16x32_bf16 v[220:223], v[112:115], v[184:187], v[220:223]
    s_waitcnt lgkmcnt(2)
    v_cmp_eq_u32 vcc, 0, v11
    v_mfma_f32_16x16x32_bf16 v[228:231], v[116:119], v[184:187], 0
    s_cbranch_vccnz L_SLOW0
L_BACK0:
    s_nop 0
    ds_read_b64 v[204:205], v9 offset:0
    v_mfma_f32_16x16x32_bf16 v[152:155], v[184:187], v[240:243], 0
    ds_read_b64 v[206:207], v9 offset:8192
    ds_read_b64 v[208:209], v9 offset:16384
    v_mfma_f32_16x16x32_bf16 v[156:159], v[184:187], v[252:255], 0
    ds_read_b64 v[210:211], v9 offset:24576
    v_mfma_f32_16x16x32_bf16 v[168:171], v[184:187], v[244:247], 0
    ds_write_b128 v8, v[212:215] offset:2048
    v_mfma_f32_16x16x32_bf16 v[216:219], v[76:79], v[188:191], v[216:219]
    ds_read_b128 v[184:187], v7 offset:2240
    v_cvt_pk_bf16_f32 v154, v155, v154
    v_mfma_f32_16x16x32_bf16 v[220:223], v[108:111], v[188:191], v[220:223]
    v_cvt_pk_bf16_f32 v155, v153, v152
    v_cvt_pk_bf16_f32 v157, v157, v156
    v_mfma_f32_16x16x32_bf16 v[160:163], v[192:195], v[240:243], 0
    ds_read_b128 v[188:191], v7 offset:2176
    v_cvt_pk_bf16_f32 v156, v159, v158
    v_mfma_f32_16x16x32_bf16 v[164:167], v[192:195], v[252:255], 0
    v_cvt_pk_bf16_f32 v148, v171, v170
    v_cvt_pk_bf16_f32 v149, v169, v168
    v_mfma_f32_16x16x32_bf16 v[172:175], v[192:195], v[248:251], 0
    v_rcp_f32_e64 v45, v45
    v_mfma_f32_16x16x32_bf16 v[216:219], v[72:75], v[196:199], v[216:219]
    ds_read_b128 v[192:195], v7 offset:2112
    v_cvt_pk_bf16_f32 v162, v163, v162
    v_mfma_f32_16x16x32_bf16 v[220:223], v[104:107], v[196:199], v[220:223]
    v_cvt_pk_bf16_f32 v163, v161, v160
    s_waitcnt lgkmcnt(2)
    s_nop 0
    v_mfma_f32_16x16x32_bf16 v[216:219], v[68:71], v[200:203], v[216:219]
    ds_read_b128 v[196:199], v7 offset:2048
    v_cvt_pk_bf16_f32 v165, v165, v164
    v_cvt_pk_bf16_f32 v164, v167, v166
    v_mfma_f32_16x16x32_bf16 v[220:223], v[100:103], v[200:203], v[220:223]
    v_cvt_pk_bf16_f32 v150, v175, v174
    v_cvt_pk_bf16_f32 v151, v173, v172
    v_mfma_f32_16x16x32_bf16 v[216:219], v[64:67], v[180:183], v[216:219]
    v_lshlrev_b32_e64 v46, 16, v12
    v_and_b32 v47, 0xffff0000, v12
    v_mfma_f32_16x16x32_bf16 v[220:223], v[96:99], v[180:183], v[220:223]
    v_mul_f32 v46, v46, v44
    v_mul_f32 v47, v47, v45
    v_mfma_f32_16x16x32_bf16 v[216:219], v[60:63], v[184:187], v[216:219]
    v_fma_f32 v36, v36, v44, -v46
    v_fma_f32 v40, v40, v45, -v47
    v_mfma_f32_16x16x32_bf16 v[220:223], v[92:95], v[184:187], v[220:223]
    v_fma_f32 v37, v37, v44, -v46
    v_fma_f32 v41, v41, v45, -v47
    v_mfma_f32_16x16x32_bf16 v[220:223], v[154:157], v[120:123], v[220:223]
    v_fma_f32 v38, v38, v44, -v46
    v_fma_f32 v42, v42, v45, -v47
    v_mfma_f32_16x16x32_bf16 v[224:227], v[154:157], v[128:131], v[224:227]
    ds_read_b128 v[200:203], v7 offset:1984
    v_fma_f32 v39, v39, v44, -v46
    v_mfma_f32_16x16x32_bf16 v[228:231], v[154:157], v[136:139], v[228:231]
    v_fma_f32 v43, v43, v45, -v47
    v_cvt_pk_bf16_f32 v36, v40, v36
    s_waitcnt lgkmcnt(1)
    s_nop 0
    v_mfma_f32_16x16x32_bf16 v[216:219], v[56:59], v[188:191], v[216:219]
    ds_read_b128 v[180:183], v7 offset:2064
    v_cvt_pk_bf16_f32 v37, v41, v37
    v_mfma_f32_16x16x32_bf16 v[220:223], v[88:91], v[188:191], v[220:223]
    v_cvt_pk_bf16_f32 v38, v42, v38
    v_cvt_pk_bf16_f32 v39, v43, v39
    v_mfma_f32_16x16x32_bf16 v[220:223], v[162:165], v[124:127], v[220:223]
    ds_write2st64_b32 v32, v36, v37 offset0:0 offset1:18
    v_mfma_f32_16x16x32_bf16 v[224:227], v[162:165], v[132:135], v[224:227]
    ds_read_b128 v[184:187], v7 offset:1920
    ds_read_b64 v[188:189], v2 offset:9496
    ds_read_b64 v[190:191], v2 offset:10136
    v_mfma_f32_16x16x32_bf16 v[228:231], v[162:165], v[140:143], v[228:231]
    ds_write2st64_b32 v32, v38, v39 offset0:36 offset1:54
    v_mfma_f32_16x16x32_bf16 v[216:219], v[52:55], v[192:195], v[216:219]
    v_lshlrev_b32_e64 v36, 16, v16
    v_and_b32 v37, 0xffff0000, v16
    v_mfma_f32_16x16x32_bf16 v[220:223], v[84:87], v[192:195], v[220:223]
    v_lshlrev_b32_e64 v38, 16, v17
    v_and_b32 v39, 0xffff0000, v17
    v_mfma_f32_16x16x32_bf16 v[216:219], v[48:51], v[196:199], v[216:219]
    ds_read_b128 v[192:195], v7 offset:1856
    v_lshlrev_b32_e64 v40, 16, v18
    v_and_b32 v41, 0xffff0000, v18
    v_mfma_f32_16x16x32_bf16 v[220:223], v[80:83], v[196:199], v[220:223]
    v_lshlrev_b32_e64 v42, 16, v19
    v_and_b32 v43, 0xffff0000, v19
    v_mfma_f32_16x16x32_bf16 v[224:227], v[112:115], v[196:199], v[224:227]
    v_add_f32 v36, v204, v36
    v_add_f32 v37, v206, v37
    v_mfma_f32_16x16x32_bf16 v[232:235], v[116:119], v[196:199], 0
    ds_write_b128 v8, v[216:219] offset:3072
    v_mfma_f32_16x16x32_bf16 v[152:155], v[196:199], v[240:243], 0
    ds_write_b32 v4, v5 offset:16
    ds_read_b128 v[116:119], v7 offset:1792
    v_mfma_f32_16x16x32_bf16 v[156:159], v[196:199], v[252:255], 0
    v_add_f32 v38, v208, v38
    v_add_f32 v39, v210, v39
    v_mfma_f32_16x16x32_bf16 v[168:171], v[196:199], v[244:247], 0
    v_add_f32 v40, v205, v40
    s_waitcnt lgkmcnt(3)
    v_mfma_f32_16x16x32_bf16 v[220:223], v[76:79], v[200:203], v[220:223]
    ds_read_b128 v[196:199], v7 offset:1728
    v_cvt_pk_bf16_f32 v154, v155, v154
    v_mfma_f32_16x16x32_bf16 v[224:227], v[108:111], v[200:203], v[224:227]
    ds_read_b32 v11, v6 offset:16
    v_cvt_pk_bf16_f32 v155, v153, v152
    v_cvt_pk_bf16_f32 v157, v157, v156
    v_mfma_f32_16x16x32_bf16 v[160:163], v[180:183], v[240:243], 0
    ds_read_b128 v[200:203], v7 offset:1664
    v_cvt_pk_bf16_f32 v156, v159, v158
    v_mfma_f32_16x16x32_bf16 v[164:167], v[180:183], v[252:255], 0
    v_cvt_pk_bf16_f32 v244, v171, v170
    v_cvt_pk_bf16_f32 v245, v169, v168
    v_mfma_f32_16x16x32_bf16 v[172:175], v[180:183], v[248:251], 0
    v_add_f32 v41, v207, v41
    v_add_f32 v42, v209, v42
    v_mfma_f32_16x16x32_bf16 v[220:223], v[72:75], v[184:187], v[220:223]
    v_cvt_pk_bf16_f32 v162, v163, v162
    v_cvt_pk_bf16_f32 v163, v161, v160
    v_mfma_f32_16x16x32_bf16 v[224:227], v[104:107], v[184:187], v[224:227]
    v_cvt_pk_bf16_f32 v165, v165, v164
    v_cvt_pk_bf16_f32 v164, v167, v166
    v_mfma_f32_16x16x32_bf16 v[220:223], v[176:179], v[188:191], v[220:223]
    s_waitcnt lgkmcnt(1)
    v_cmp_eq_u32 vcc, 0, v11
    v_mfma_f32_16x16x32_bf16 v[224:227], v[144:147], v[188:191], v[224:227]
    s_cbranch_vccnz L_SLOW1
L_BACK1:
    s_nop 0
    ds_read_b64 v[212:213], v9 offset:2048
    v_mfma_f32_16x16x32_bf16 v[220:223], v[68:71], v[192:195], v[220:223]
    ds_read_b64 v[214:215], v9 offset:10240
    ds_read_b64 v[216:217], v9 offset:18432
    ds_read_b64 v[218:219], v9 offset:26624
    v_mfma_f32_16x16x32_bf16 v[224:227], v[100:103], v[192:195], v[224:227]
    ds_read_b32 v11, v6 offset:112
    ds_read_b128 v[180:183], v7 offset:1600
    v_mfma_f32_16x16x32_bf16 v[220:223], v[64:67], v[116:119], v[220:223]
    ds_read_b128 v[184:187], v7 offset:1536
    v_cvt_pk_bf16_f32 v246, v175, v174
    v_mfma_f32_16x16x32_bf16 v[224:227], v[96:99], v[116:119], v[224:227]
    ds_read_b128 v[192:195], v7 offset:1472
    v_cvt_pk_bf16_f32 v247, v173, v172
    v_mfma_f32_16x16x32_bf16 v[220:223], v[60:63], v[196:199], v[220:223]
    v_add_f32_e64 v43, v211, v43
    v_cvt_pk_bf16_f32 v204, v36, v37
    v_mfma_f32_16x16x32_bf16 v[224:227], v[92:95], v[196:199], v[224:227]
    ds_read_b64 v[116:117], v2 offset:9528
    ds_read_b64 v[118:119], v2 offset:10168
    v_mfma_f32_16x16x32_bf16 v[224:227], v[154:157], v[120:123], v[224:227]
    ds_read_b128 v[196:199], v7 offset:1408
    v_cvt_pk_bf16_f32 v205, v38, v39
    v_mfma_f32_16x16x32_bf16 v[228:231], v[154:157], v[128:131], v[228:231]
    s_waitcnt lgkmcnt(5)
    v_cmp_eq_u32 vcc, 0, v11
    v_mfma_f32_16x16x32_bf16 v[232:235], v[154:157], v[136:139], v[232:235]
    s_cbranch_vccnz L_SLOW4
L_BACK4:
    s_nop 0
    v_cvt_pk_bf16_f32 v206, v40, v41
    v_cvt_pk_bf16_f32 v207, v42, v43
    v_mfma_f32_16x16x32_bf16 v[220:223], v[56:59], v[200:203], v[220:223]
    ds_read_b128 v[136:139], v7 offset:1344
    ds_read_u8 v174, v239 offset:1152
    v_mfma_f32_16x16x32_bf16 v[224:227], v[88:91], v[200:203], v[224:227]
    buffer_store_dwordx4 v[204:207], v33, s[44:47], s32 offen
    v_mfma_f32_16x16x32_bf16 v[224:227], v[162:165], v[124:127], v[224:227]
    ds_read_b128 v[200:203], v7 offset:1280
    v_mov_b32_e64 v208, -1
    v_mfma_f32_16x16x32_bf16 v[228:231], v[162:165], v[132:135], v[228:231]
    v_mov_b32 v209, -1
    v_mov_b32 v210, -1
    v_mfma_f32_16x16x32_bf16 v[232:235], v[162:165], v[140:143], v[232:235]
    v_mov_b32 v211, -1
    v_lshlrev_b32 v36, 16, v20
    v_mfma_f32_16x16x32_bf16 v[220:223], v[52:55], v[180:183], v[220:223]
    ds_read_b128 v[140:143], v7 offset:1216
    v_and_b32 v37, 0xffff0000, v20
    v_mfma_f32_16x16x32_bf16 v[224:227], v[84:87], v[180:183], v[224:227]
    buffer_store_dwordx4 v[208:211], v33, s[44:47], s34 offen
    s_waitcnt lgkmcnt(2)
    v_mfma_f32_16x16x32_bf16 v[220:223], v[48:51], v[184:187], v[220:223]
    ds_read_b128 v[180:183], v7 offset:1536
    v_lshlrev_b32 v38, 16, v21
    v_mfma_f32_16x16x32_bf16 v[224:227], v[80:83], v[184:187], v[224:227]
    buffer_store_dwordx4 v[208:211], v33, s[44:47], s35 offen
    v_mfma_f32_16x16x32_bf16 v[228:231], v[112:115], v[184:187], v[228:231]
    ds_read_b128 v[168:171], v7 offset:1152
    v_and_b32 v39, 0xffff0000, v21
    v_mfma_f32_16x16x32_bf16 v[224:227], v[76:79], v[192:195], v[224:227]
    ds_write_b128 v8, v[220:223] offset:4096
    v_mfma_f32_16x16x32_bf16 v[228:231], v[108:111], v[192:195], v[228:231]
    ds_read_b128 v[184:187], v7 offset:1552
    v_lshlrev_b32_e64 v40, 16, v22
    v_mfma_f32_16x16x32_bf16 v[224:227], v[176:179], v[116:119], v[224:227]
    ds_read_b128 v[192:195], v7 offset:1088
    v_and_b32 v41, 0xffff0000, v22
    v_mfma_f32_16x16x32_bf16 v[224:227], v[72:75], v[196:199], v[224:227]
    v_lshlrev_b32_e64 v42, 16, v23
    v_and_b32 v43, 0xffff0000, v23
    v_mfma_f32_16x16x32_bf16 v[228:231], v[104:107], v[196:199], v[228:231]
    v_add_f32 v36, v212, v36
    v_add_f32 v37, v214, v37
    v_mfma_f32_16x16x32_bf16 v[224:227], v[68:71], v[136:139], v[224:227]
    ds_read_b128 v[196:199], v7 offset:1024
    v_add_f32_e64 v38, v216, v38
    v_mfma_f32_16x16x32_bf16 v[228:231], v[100:103], v[136:139], v[228:231]
    v_add_f32 v39, v218, v39
    s_waitcnt lgkmcnt(3)
    v_mfma_f32_16x16x32_bf16 v[224:227], v[64:67], v[200:203], v[224:227]
    ds_read_b128 v[136:139], v7 offset:960
    v_add_f32_e64 v40, v213, v40
    v_mfma_f32_16x16x32_bf16 v[228:231], v[96:99], v[200:203], v[228:231]
    v_add_f32 v41, v215, v41
    v_add_f32 v42, v217, v42
    v_mfma_f32_16x16x32_bf16 v[224:227], v[60:63], v[140:143], v[224:227]
    ds_read_b128 v[200:203], v7 offset:896
    v_add_f32_e64 v43, v219, v43
    v_mfma_f32_16x16x32_bf16 v[228:231], v[92:95], v[140:143], v[228:231]
    v_cvt_pk_bf16_f32 v212, v36, v37
    v_cvt_pk_bf16_f32 v213, v38, v39
    v_mfma_f32_16x16x32_bf16 v[152:155], v[180:183], v[240:243], 0
    v_cvt_pk_bf16_f32 v214, v40, v41
    v_cvt_pk_bf16_f32 v215, v42, v43
    v_mfma_f32_16x16x32_bf16 v[156:159], v[180:183], v[252:255], 0
    ds_read_b128 v[140:143], v7 offset:832
    ds_read_u8 v239, v239 offset:1184
    v_mfma_f32_16x16x32_bf16 v[224:227], v[56:59], v[168:171], v[224:227]
    buffer_store_dwordx4 v[212:215], v33, s[44:47], s33 offen
    v_mfma_f32_16x16x32_bf16 v[228:231], v[88:91], v[168:171], v[228:231]
    ds_read_b128 v[180:183], v7 offset:768
    s_waitcnt lgkmcnt(4)
    s_nop 0
    v_mfma_f32_16x16x32_bf16 v[160:163], v[184:187], v[240:243], 0
    v_cvt_pk_bf16_f32 v154, v155, v154
    v_cvt_pk_bf16_f32 v155, v153, v152
    v_mfma_f32_16x16x32_bf16 v[164:167], v[184:187], v[252:255], 0
    ds_read_b128 v[168:171], v7 offset:704
    v_cvt_pk_bf16_f32 v157, v157, v156
    v_mfma_f32_16x16x32_bf16 v[224:227], v[52:55], v[192:195], v[224:227]
    v_cvt_pk_bf16_f32 v156, v159, v158
    v_lshlrev_b32_e64 v36, 16, v24
    v_mfma_f32_16x16x32_bf16 v[228:231], v[84:87], v[192:195], v[228:231]
    v_cvt_pk_bf16_f32 v162, v163, v162
    v_cvt_pk_bf16_f32 v163, v161, v160
    v_mfma_f32_16x16x32_bf16 v[224:227], v[48:51], v[196:199], v[224:227]
    v_cvt_pk_bf16_f32 v165, v165, v164
    v_cvt_pk_bf16_f32 v164, v167, v166
    v_mfma_f32_16x16x32_bf16 v[228:231], v[80:83], v[196:199], v[228:231]
    ds_read_b128 v[184:187], v7 offset:640
    v_and_b32 v37, 0xffff0000, v24
    v_mfma_f32_16x16x32_bf16 v[232:235], v[112:115], v[196:199], v[232:235]
    v_lshlrev_b32_e64 v38, 16, v25
    v_and_b32 v39, 0xffff0000, v25
    v_mfma_f32_16x16x32_bf16 v[228:231], v[76:79], v[136:139], v[228:231]
    ds_write_b128 v8, v[224:227] offset:5120
    v_mfma_f32_16x16x32_bf16 v[232:235], v[108:111], v[136:139], v[232:235]
    ds_write_b32 v4, v5 offset:32
    s_waitcnt lgkmcnt(3)
    v_mfma_f32_16x16x32_bf16 v[228:231], v[72:75], v[200:203], v[228:231]
    ds_read_b128 v[112:115], v7 offset:576
    v_lshlrev_b32 v40, 16, v26
    v_mfma_f32_16x16x32_bf16 v[232:235], v[104:107], v[200:203], v[232:235]
    v_and_b32 v41, 0xffff0000, v26
    v_lshlrev_b32_e64 v42, 16, v27
    v_mfma_f32_16x16x32_bf16 v[228:231], v[148:151], v[188:191], v[228:231]
    v_lshl_or_b32 v239, v239, 24, v238
    v_lshl_or_b32 v238, v174, 24, v238
    v_mfma_f32_16x16x32_bf16 v[232:235], v[244:247], v[188:191], v[232:235]
    ds_read_b32 v11, v6 offset:32
    v_lshlrev_b32_e64 v174, 2, v0
    v_mfma_f32_16x16x32_bf16 v[228:231], v[68:71], v[140:143], v[228:231]
    ds_read_b64 v[108:109], v2 offset:9560
    ds_read_b64 v[110:111], v2 offset:10200
    v_mfma_f32_16x16x32_bf16 v[232:235], v[100:103], v[140:143], v[232:235]
    v_mov_b32_e64 v172, v34
    v_and_b32 v43, 0xffff0000, v27
    v_mfma_f32_16x16x32_bf16 v[228:231], v[64:67], v[180:183], v[228:231]
    ds_read_b128 v[104:107], v7 offset:512
    ds_read_b128 v[100:103], v7 offset:1024
    v_mfma_f32_16x16x32_bf16 v[232:235], v[96:99], v[180:183], v[232:235]
    ds_read_b128 v[188:191], v7 offset:448
    ds_read_b128 v[192:195], v7 offset:1040
    v_mfma_f32_16x16x32_bf16 v[228:231], v[60:63], v[168:171], v[228:231]
    ds_read_b128 v[96:99], v7 offset:384
    ds_read_b128 v[196:199], v7 offset:320
    v_mfma_f32_16x16x32_bf16 v[232:235], v[92:95], v[168:171], v[232:235]
    s_waitcnt lgkmcnt(8)
    v_cmp_eq_u32 vcc, 0, v11
    v_mfma_f32_16x16x32_bf16 v[228:231], v[144:147], v[116:119], v[228:231]
    s_cbranch_vccnz L_SLOW2
L_BACK2:
    s_nop 0
    ds_read_b64 v[220:221], v9 offset:4096
    v_mfma_f32_16x16x32_bf16 v[232:235], v[148:151], v[116:119], v[232:235]
    ds_read_b64 v[222:223], v9 offset:12288
    ds_read_b64 v[224:225], v9 offset:20480
    v_mfma_f32_16x16x32_bf16 v[228:231], v[56:59], v[184:187], v[228:231]
    ds_read_b64 v[226:227], v9 offset:28672
    ds_read_b64 v[92:93], v2 offset:9592
    ds_read_b64 v[94:95], v2 offset:10232
    v_mfma_f32_16x16x32_bf16 v[232:235], v[88:91], v[184:187], v[232:235]
    ds_read_b128 v[116:119], v7 offset:256
    ds_read_b128 v[136:139], v7 offset:192
    v_mfma_f32_16x16x32_bf16 v[228:231], v[154:157], v[120:123], v[228:231]
    ds_read_b128 v[88:91], v7 offset:128
    ds_read_b128 v[200:203], v7 offset:64
    v_mfma_f32_16x16x32_bf16 v[232:235], v[154:157], v[128:131], v[232:235]
    ds_read_b128 v[140:143], v7 offset:0
    v_mfma_f32_16x16x32_bf16 v[228:231], v[52:55], v[112:115], v[228:231]
    v_mfma_f32_16x16x32_bf16 v[232:235], v[84:87], v[112:115], v[232:235]
    v_mfma_f32_16x16x32_bf16 v[228:231], v[162:165], v[124:127], v[228:231]
    s_waitcnt lgkmcnt(5)
    v_add_f32 v36, v220, v36
    v_mfma_f32_16x16x32_bf16 v[232:235], v[162:165], v[132:135], v[232:235]
    s_waitcnt vmcnt(0)
    v_add_f32 v37, v222, v37
    v_mfma_f32_16x16x32_bf16 v[228:231], v[176:179], v[108:111], v[228:231]
    s_mov_b64 exec, 1
    buffer_store_dword v34, off, s[44:47], s12 offset:0
    s_mov_b64 exec, -1
    v_mfma_f32_16x16x32_bf16 v[232:235], v[144:147], v[108:111], v[232:235]
    v_add_f32 v38, v224, v38
    v_add_f32 v39, v226, v39
    v_mfma_f32_16x16x32_bf16 v[228:231], v[48:51], v[104:107], v[228:231]
    v_add_f32 v40, v221, v40
    v_add_f32 v41, v223, v41
    v_mfma_f32_16x16x32_bf16 v[232:235], v[80:83], v[104:107], v[232:235]
    v_add_f32 v42, v225, v42
    v_add_f32 v43, v227, v43
    v_mfma_f32_16x16x32_bf16 v[152:155], v[100:103], v[240:243], 0
    v_cvt_pk_bf16_f32 v220, v36, v37
    v_cvt_pk_bf16_f32 v221, v38, v39
    v_mfma_f32_16x16x32_bf16 v[156:159], v[100:103], v[252:255], 0
    ds_write_b128 v8, v[228:231] offset:6144
    v_mfma_f32_16x16x32_bf16 v[232:235], v[76:79], v[188:191], v[232:235]
    v_cvt_pk_bf16_f32 v222, v40, v41
    v_cvt_pk_bf16_f32 v223, v42, v43
    v_mfma_f32_16x16x32_bf16 v[160:163], v[192:195], v[240:243], 0
    v_cvt_pk_bf16_f32 v154, v155, v154
    v_cvt_pk_bf16_f32 v155, v153, v152
    v_mfma_f32_16x16x32_bf16 v[164:167], v[192:195], v[252:255], 0
    v_cvt_pk_bf16_f32 v157, v157, v156
    v_cvt_pk_bf16_f32 v156, v159, v158
    v_mfma_f32_16x16x32_bf16 v[232:235], v[72:75], v[96:99], v[232:235]
    buffer_store_dwordx4 v[220:223], v33, s[44:47], s34 offen
    v_mfma_f32_16x16x32_bf16 v[232:235], v[68:71], v[196:199], v[232:235]
    v_cvt_pk_bf16_f32 v162, v163, v162
    v_cvt_pk_bf16_f32 v163, v161, v160
    v_mfma_f32_16x16x32_bf16 v[232:235], v[176:179], v[92:95], v[232:235]
    v_cvt_pk_bf16_f32 v165, v165, v164
    s_waitcnt lgkmcnt(0)
    v_mfma_f32_16x16x32_bf16 v[232:235], v[64:67], v[116:119], v[232:235]
    v_cvt_pk_bf16_f32 v164, v167, v166
    v_mfma_f32_16x16x32_bf16 v[232:235], v[60:63], v[136:139], v[232:235]
    v_mfma_f32_16x16x32_bf16 v[232:235], v[56:59], v[88:91], v[232:235]
    s_mov_b32 exec_hi, 0
    buffer_load_dword v172, v174, s[44:47], s42 offen sc1
    s_mov_b32 exec_hi, -1
    v_mfma_f32_16x16x32_bf16 v[232:235], v[154:157], v[120:123], v[232:235]
    v_mfma_f32_16x16x32_bf16 v[232:235], v[52:55], v[200:203], v[232:235]
    v_mfma_f32_16x16x32_bf16 v[232:235], v[162:165], v[124:127], v[232:235]
    v_mfma_f32_16x16x32_bf16 v[232:235], v[48:51], v[140:143], v[232:235]
    v_lshlrev_b32 v36, 16, v28
    v_and_b32 v37, 0xffff0000, v28
    v_lshlrev_b32_e64 v38, 16, v29
    v_and_b32 v39, 0xffff0000, v29
    v_lshlrev_b32_e64 v40, 16, v30
    v_and_b32 v41, 0xffff0000, v30
    v_lshlrev_b32_e64 v42, 16, v31
    v_and_b32 v43, 0xffff0000, v31
    ds_write_b128 v8, v[232:235] offset:7168
    ds_write_b32 v4, v5 offset:48
L_Y3W:
    ds_read_b32 v14, v6 offset:48
    ds_read_b64 v[228:229], v9 offset:6144
    ds_read_b64 v[230:231], v9 offset:14336
    ds_read_b64 v[232:233], v9 offset:22528
    ds_read_b64 v[234:235], v9 offset:30720
    s_waitcnt lgkmcnt(4)
    v_cmp_eq_u32 vcc, 0, v14
    s_cbranch_vccnz L_Y3W
    s_waitcnt lgkmcnt(0)
    v_add_f32 v36, v228, v36
    v_add_f32 v37, v230, v37
    v_add_f32 v38, v232, v38
    v_add_f32 v39, v234, v39
    v_add_f32 v40, v229, v40
    v_add_f32 v41, v231, v41
    v_add_f32 v42, v233, v42
    v_add_f32 v43, v235, v43
    v_cvt_pk_bf16_f32 v228, v36, v37
    v_cvt_pk_bf16_f32 v229, v38, v39
    v_cvt_pk_bf16_f32 v230, v40, v41
    v_cvt_pk_bf16_f32 v231, v42, v43
    buffer_store_dwordx4 v[228:231], v33, s[44:47], s35 offen
    s_cmp_lg_u32 s14, 2
    s_cbranch_scc1 L_CNL
    s_waitcnt vmcnt(1)
    v_cmp_ne_u32_e64 vcc, v34, v172
    s_cbranch_vccnz L_FAW
L_FAK:
    buffer_load_dwordx4 v[48:51], v35, s[44:47], s36 offen sc1
    buffer_load_dwordx4 v[52:55], v35, s[44:47], s37 offen sc1
    s_waitcnt vmcnt(2)
    s_mov_b64 exec, 1
    buffer_store_dword v34, off, s[44:47], s12 offset:512
    s_mov_b64 exec, -1
    s_waitcnt vmcnt(1)
L_DP:
    v_max3_u32 v56, v48, v49, v50
    v_max3_u32 v57, v52, v53, v54
    v_max_u32 v56, v56, v51
    v_max_u32 v57, v57, v55
    v_cmp_eq_u32 s[8:9], -1, v56
    v_cmp_eq_u32 s[10:11], -1, v57
    s_or_b64 vcc, s[8:9], s[10:11]
    s_cbranch_vccnz L_DR
L_DOK:
    s_mov_b64 exec, 1
    ds_write_b32 v4, v5 offset:560
    s_mov_b64 exec, -1
    ds_write_b64 v236, v[48:49] offset:0
    ds_write_b64 v236, v[50:51] offset:144
    ds_write_b64 v236, v[52:53] offset:64
    ds_write_b64 v236, v[54:55] offset:208
    ds_read_b128 v[56:59], v237 offset:0
    ds_read_b128 v[60:63], v237 offset:1152
    s_waitcnt lgkmcnt(1)
    buffer_store_dwordx4 v[56:59], v238, s[52:55], s38 offen sc1
    s_waitcnt lgkmcnt(0)
    buffer_store_dwordx4 v[60:63], v239, s[52:55], s39 offen sc1
    v_mov_b32_e64 v11, 2
    s_waitcnt vmcnt(0)
    s_mov_b64 exec, 1
    ds_write_b32 v4, v11 offset:560
    s_mov_b64 exec, -1
    s_branch L_FIN
L_DR:
    s_add_u32 s41, s41, 1
    s_cmp_ge_u32 s41, 48
    s_cbranch_scc1 L_DF
    s_cmp_eq_u64 s[8:9], 0
    s_cbranch_scc1 L_DS0
    buffer_load_dwordx4 v[48:51], v35, s[44:47], s36 offen sc1
L_DS0:
    s_cmp_eq_u64 s[10:11], 0
    s_cbranch_scc1 L_DS1
    buffer_load_dwordx4 v[52:55], v35, s[44:47], s37 offen sc1
L_DS1:
    s_waitcnt vmcnt(0)
    s_branch L_DP
L_DF:
    s_mov_b32 s41, 0
    s_mov_b32 exec_hi, 0
LT_2:
    buffer_load_dword v172, v174, s[44:47], s40 offen sc1
    s_add_u32 s41, s41, 1
    s_waitcnt vmcnt(0)
    v_cmp_ne_u32 vcc, v34, v172
    s_cbranch_vccz LT_2K
    s_sleep 1
    s_cmp_lt_u32 s41, 0x4000
    s_cbranch_scc1 LT_2
LT_2K:
    s_mov_b32 exec_hi, -1
    buffer_load_dwordx4 v[48:51], v35, s[44:47], s36 offen sc1
    buffer_load_dwordx4 v[52:55], v35, s[44:47], s37 offen sc1
    s_waitcnt vmcnt(0)
    s_branch L_DOK
L_FAW:
    s_mov_b32 s43, 0
    s_mov_b32 exec_hi, 0
LT_3:
    buffer_load_dword v172, v174, s[44:47], s42 offen sc1
    s_add_u32 s43, s43, 1
    s_waitcnt vmcnt(0)
    v_cmp_ne_u32_e64 vcc, v34, v172
    s_cbranch_vccz LT_3K
    s_sleep 1
    s_cmp_lt_u32 s43, 0x4000
    s_cbranch_scc1 LT_3
LT_3K:
    s_mov_b32 exec_hi, -1
    s_branch L_FAK
    s_branch L_FIN
L_CNL:
    v_mov_b32 v5, 2
    s_mov_b64 exec, 1
    ds_write_b32 v4, v5 offset:560
    s_mov_b64 exec, -1
    ds_read_b64 v[12:13], v10 offset:1152
    s_waitcnt lgkmcnt(0)
    v_lshlrev_b32_e64 v14, 24, v12
    v_and_or_b32 v14, v14, s68, v3
    v_lshlrev_b32_e64 v15, 16, v12
    v_and_or_b32 v15, v15, s68, v3
    buffer_store_dwordx2 v[204:205], v14, s[52:55], s60 offen offset:0
    buffer_store_dwordx2 v[206:207], v15, s[52:55], s60 offen offset:2048
    v_lshlrev_b32_e64 v14, 8, v12
    v_and_or_b32 v14, v14, s68, v3
    v_and_or_b32 v15, v12, s68, v3
    buffer_store_dwordx2 v[212:213], v14, s[52:55], s61 offen offset:0
    buffer_store_dwordx2 v[214:215], v15, s[52:55], s61 offen offset:2048
    v_lshlrev_b32_e64 v14, 24, v13
    v_and_or_b32 v14, v14, s68, v3
    v_lshlrev_b32_e64 v15, 16, v13
    v_and_or_b32 v15, v15, s68, v3
    buffer_store_dwordx2 v[220:221], v14, s[52:55], s62 offen offset:0
    buffer_store_dwordx2 v[222:223], v15, s[52:55], s62 offen offset:2048
    v_lshlrev_b32_e64 v14, 8, v13
    v_and_or_b32 v14, v14, s68, v3
    v_and_or_b32 v15, v13, s68, v3
    buffer_store_dwordx2 v[228:229], v14, s[52:55], s63 offen offset:0
    buffer_store_dwordx2 v[230:231], v15, s[52:55], s63 offen offset:2048
    s_branch L_FIN
L_SLOW0:
LW_4:
    ds_read_b32 v11, v6 offset:144
    s_waitcnt lgkmcnt(0)
    v_cmp_eq_u32_e64 vcc, 0, v11
    s_cbranch_vccnz LW_4
    s_branch L_BACK0
L_SLOW1:
LW_5:
    ds_read_b32 v11, v6 offset:16
    s_waitcnt lgkmcnt(0)
    v_cmp_eq_u32 vcc, 0, v11
    s_cbranch_vccnz LW_5
    s_branch L_BACK1
L_SLOW2:
LW_6:
    ds_read_b32 v11, v6 offset:32
    s_waitcnt lgkmcnt(0)
    v_cmp_eq_u32 vcc, 0, v11
    s_cbranch_vccnz LW_6
    s_branch L_BACK2
L_SLOW3:
LW_7:
    ds_read_b32 v11, v6 offset:160
    s_waitcnt lgkmcnt(0)
    v_cmp_eq_u32 vcc, 0, v11
    s_cbranch_vccnz LW_7
    s_branch L_BACK3
L_SLOW4:
LW_8:
    ds_read_b32 v11, v6 offset:112
    s_waitcnt lgkmcnt(0)
    v_cmp_eq_u32_e64 vcc, 0, v11
    s_cbranch_vccnz LW_8
    s_branch L_BACK4
L_XF:
    s_add_u32 s31, s31, 64
    s_buffer_load_dwordx8 s[16:23], s[44:47], s31
    ds_read_b64 v[108:109], v1 offset:960
    ds_read_b64 v[110:111], v1 offset:968
    ds_read_b64 v[112:113], v1 offset:1024
    ds_read_b64 v[114:115], v1 offset:1032
    ds_read_b64 v[116:117], v1 offset:1088
    ds_read_b64 v[118:119], v1 offset:1096
    ds_read_b64 v[120:121], v2 offset:10776
    ds_read_b64 v[122:123], v2 offset:11416
    ds_read_b64 v[124:125], v2 offset:12056
    ds_read_b64 v[126:127], v2 offset:12696
    ds_read_b64 v[128:129], v2 offset:10808
    ds_read_b64 v[130:131], v2 offset:11448
    ds_read_b64 v[132:133], v2 offset:12088
    ds_read_b64 v[134:135], v2 offset:12728
    ds_read_b64 v[136:137], v2 offset:10840
    ds_read_b64 v[138:139], v2 offset:11480
    ds_read_b64 v[140:141], v2 offset:12120
    ds_read_b64 v[142:143], v2 offset:12760
    s_branch L_XC
L_XP:
    s_sleep 2
    ds_read_b32 v11, v4 offset:528
    s_cmp_ge_u32 s5, 2
    s_cbranch_scc1 L_XG
    s_add_u32 s31, s31, 64
    s_buffer_load_dwordx8 s[16:23], s[44:47], s31
    s_branch L_XH
L_XG:
    s_buffer_load_dwordx8 s[16:23], s[44:47], s31 glc
L_XH:
    s_add_u32 s5, s5, 1
    s_waitcnt lgkmcnt(0)
    v_cmp_eq_u32 vcc, 1, v11
    s_cbranch_vccnz L_XSLOW
    s_cmp_ge_u32 s5, 0x4000
    s_cbranch_scc1 L_XSLOW
L_XC:
    s_waitcnt lgkmcnt(0)
    s_xor_b64 s[16:17], s[16:17], s[28:29]
    s_xor_b64 s[18:19], s[18:19], s[28:29]
    s_xor_b64 s[20:21], s[20:21], s[28:29]
    s_xor_b64 s[22:23], s[22:23], s[28:29]
    s_or_b64 s[16:17], s[16:17], s[18:19]
    s_or_b64 s[20:21], s[20:21], s[22:23]
    s_or_b64 s[16:17], s[16:17], s[20:21]
    s_cbranch_scc1 L_XP
    s_setprio 3
    buffer_load_dwordx4 v[16:19], v33, s[44:47], s32 offen sc1
    buffer_load_dwordx4 v[20:23], v33, s[44:47], s33 offen sc1
    buffer_load_dwordx4 v[24:27], v33, s[44:47], s34 offen sc1
    buffer_load_dwordx4 v[28:31], v33, s[44:47], s35 offen sc1
    s_mov_b64 exec, 1
    ds_write_b32 v4, v5 offset:544
    s_mov_b64 exec, -1
    s_setprio 2
    s_branch L_XBACK
L_XSLOW:
    s_nop 0
    buffer_load_dwordx2 v[16:17], v3, s[48:51], s60 offen offset:0
    buffer_load_dwordx2 v[18:19], v3, s[48:51], s60 offen offset:2048
    buffer_load_dwordx2 v[20:21], v3, s[48:51], s61 offen offset:0
    buffer_load_dwordx2 v[22:23], v3, s[48:51], s61 offen offset:2048
    buffer_load_dwordx2 v[24:25], v3, s[48:51], s62 offen offset:0
    buffer_load_dwordx2 v[26:27], v3, s[48:51], s62 offen offset:2048
    buffer_load_dwordx2 v[28:29], v3, s[48:51], s63 offen offset:0
    buffer_load_dwordx2 v[30:31], v3, s[48:51], s63 offen offset:2048
    s_waitcnt vmcnt(0)
    s_branch L_XBACK
L_F0:
    s_setprio 2
    s_mov_b32 s61, 7864320
    s_lshl_b32 s7, s2, 2
    s_add_u32 s7, s7, s3
    s_lshl_b32 s13, s2, 6
    s_add_u32 s13, s13, 7864320
    s_lshl_b32 s8, s7, 12
    v_and_b32 v10, 31, v0
    v_lshlrev_b32 v10, 4, v10
    v_lshrrev_b32 v11, 5, v0
    v_lshl_add_u32 v11, v11, 11, v10
    v_add_u32 v11, s8, v11
    s_cmp_lt_u32 s6, 28
    s_cselect_b32 s69, 1, 0
    s_lshr_b32 s8, s6, 2
    s_add_u32 s9, s5, 3
    s_and_b32 s9, s9, 7
    s_min_u32 s9, s9, 6
    s_cmp_lt_u32 s6, 28
    s_cselect_b32 s8, s8, s9
    s_mul_i32 s59, s5, 7
    s_add_u32 s59, s59, s8
    s_and_b32 s68, s6, 3
    s_lshl_b32 s8, s68, 2
    s_add_u32 s8, s8, s3
    s_lshl_b32 s8, s8, 6
    s_xor_b32 s9, s69, 1
    s_lshl_b32 s9, s9, 5
    s_add_u32 s8, s8, s9
    v_lshrrev_b32_e64 v12, 4, v0
    v_lshl_add_u32 v12, v12, 3, s8
    v_lshlrev_b32 v9, 1, v12
    s_movk_i32 s10, 7168
    v_mul_u32_u24 v14, s10, v12
    v_and_b32 v12, 7, v0
    v_lshl_add_u32 v14, v12, 4, v14
    s_lshl_b32 s8, s59, 7
    v_add_u32 v14, s8, v14
    v_and_b32 v12, 8, v0
    v_cmp_ne_u32_e64 vcc, 0, v12
    s_waitcnt lgkmcnt(0)
    global_load_dwordx4 v[16:19], v11, s[16:17] offset:0
    global_load_dwordx4 v[20:23], v11, s[16:17] offset:512
    global_load_dwordx4 v[24:27], v11, s[16:17] offset:1024
    global_load_dwordx4 v[28:31], v11, s[16:17] offset:1536
    s_load_dword s56, s[42:43], 0
    global_load_dwordx4 v[32:35], v10, s[32:33] offset:0
    global_load_dwordx4 v[36:39], v10, s[32:33] offset:512
    global_load_dwordx4 v[40:43], v10, s[32:33] offset:1024
    global_load_dwordx4 v[44:47], v10, s[32:33] offset:1536
    v_mov_b32 v12, s34
    v_mov_b32 v13, s35
    v_mov_b32 v10, s36
    v_mov_b32 v11, s37
    v_cndmask_b32 v12, v12, v10, vcc
    v_cndmask_b32 v13, v13, v11, vcc
    v_add_co_u32 v220, vcc, v12, v14
    s_movk_i32 s20, 7168
    s_mov_b32 s21, 0
    v_addc_co_u32 v221, vcc, 0, v13, vcc
    s_barrier
    s_mov_b32 s48, s16
    s_and_b32 s49, s17, 0xffff
    s_mov_b32 s50, 0x400000
    s_mov_b32 s51, 0x20000
    s_mov_b32 s52, s40
    s_and_b32 s53, s41, 0xffff
    s_mov_b32 s54, 0x400000
    s_mov_b32 s55, 0x20000
    s_lshl_b32 s8, s6, 17
    s_lshl_b32 s9, s3, 15
    s_add_u32 s8, s8, s9
    s_lshl_b32 s9, s5, 8
    s_add_u32 s8, s8, s9
    s_add_u32 s9, s8, 4096
    v_lshrrev_b32 v10, 4, v0
    v_and_b32 v11, 15, v0
    v_lshlrev_b32_e64 v11, 4, v11
    v_lshl_add_u32 v14, v10, 13, v11
    buffer_load_dwordx4 v[64:67], v14, s[48:51], s8 offen offset:0
    buffer_load_dwordx4 v[68:71], v14, s[48:51], s8 offen offset:2048
    buffer_load_dwordx4 v[72:75], v14, s[48:51], s9 offen offset:0
    buffer_load_dwordx4 v[76:79], v14, s[48:51], s9 offen offset:2048
    s_mul_i32 s8, s3, 4608
    s_add_u32 s8, s8, 121856
    s_movk_i32 s9, 1088
    v_mad_u32_u24 v96, v10, s9, v11
    v_add_u32 v96, s8, v96
    v_and_b32 v10, 7, v0
    v_lshrrev_b32_e64 v11, 3, v0
    s_movk_i32 s9, 544
    v_lshl_add_u32 v97, v11, 3, s8
    v_mad_u32_u24 v97, v10, s9, v97
    v_lshlrev_b32_e64 v98, 4, v10
    v_lshl_add_u32 v98, v11, 14, v98
    s_lshl_b32 s18, s5, 19
    s_lshl_b32 s9, s6, 9
    s_add_u32 s18, s18, s9
    s_lshl_b32 s9, s3, 7
    s_add_u32 s18, s18, s9
    s_add_u32 s18, s18, 3145728
    s_getreg_b32 s19, hwreg(HW_REG_XCC_ID, 0, 4)
    s_mov_b32 s22, 179200
    s_cmp_eq_u32 s69, 1
    s_cselect_b32 s22, s22, 0xfffbbc00
    s_cselect_b32 s23, 0, -1
    s_lshl_b32 s62, s5, 2
    s_bfe_u32 s9, s6, 0x20001
    s_add_u32 s62, s62, s9
    s_lshl_b32 s62, s62, 12
    s_lshr_b32 s9, s6, 3
    s_lshl_b32 s9, s9, 1
    s_add_u32 s62, s62, s9
    s_and_b32 s9, s6, 1
    s_add_u32 s62, s62, s9
    s_lshl_b32 s62, s62, 2
    s_add_u32 s62, s62, 7340032
    s_lshl_b32 s19, s19, 1
    s_lshl_b32 s9, s5, 2
    s_lshl_b32 s40, 15, s9
    s_mov_b32 s41, s40
    s_mov_b32 s44, s42
    s_and_b32 s45, s43, 0xffff
    s_mov_b32 s46, 0x1000000
    s_mov_b32 s47, 0x20000
    s_mov_b32 s24, s38
    s_and_b32 s25, s39, 0xffff
    s_mov_b32 s26, 0x700000
    s_mov_b32 s27, 0x20000
    s_lshl_b32 s7, s3, 2
    v_mov_b32 v2, s7
    v_and_b32 v11, 3, v0
    v_lshlrev_b32 v1, 2, v11
    v_mov_b32 v5, 1
    s_lshl_b32 s8, s3, 6
    v_add_u32 v14, s8, v0
    v_lshlrev_b32 v226, 4, v14
    v_lshlrev_b32 v105, 4, v11
    v_lshrrev_b32_e64 v63, 2, v0
    v_lshl_add_u32 v63, v63, 14, v105
    s_lshl_b32 s4, s5, 14
    v_add_u32 v223, 0, v226
    s_mov_b32 s5, 7868416
    s_mov_b32 s6, 7872512
    s_mov_b32 s7, 7876608
    s_cmp_lg_u32 s3, 0
    s_cbranch_scc1 L_NOZ
    v_lshlrev_b32 v224, 4, v0
    v_mov_b32 v228, 0
    v_mov_b32 v229, 0
    v_mov_b32 v230, 0
    v_mov_b32_e64 v231, 0
    ds_write_b128 v224, v[228:231] offset:1024
    ds_write_b128 v224, v[228:231] offset:2048
    ds_write_b128 v224, v[228:231] offset:3072
L_NOZ:
    s_lshl_b32 s4, s3, 6
    v_add_u32 v14, s4, v0
    v_lshlrev_b32_e64 v15, 4, v14
    s_mov_b32 s64, 0x05040100
    s_mov_b32 s65, 0x07060302
    v_lshlrev_b32 v224, 4, v0
    v_and_b32 v10, 15, v0
    v_lshlrev_b32 v10, 2, v10
    v_and_b32 v11, 48, v0
    s_movk_i32 s4, 0xfff
    v_lshlrev_b32 v248, 1, v14
    v_sub_u32 v248, s4, v248
    v_subrev_u32 v249, 1, v248
    v_subrev_u32 v250, 512, v248
    v_subrev_u32 v251, 513, v248
    v_subrev_u32 v252, 1024, v248
    v_subrev_u32 v253, 1025, v248
    v_subrev_u32 v254, 1536, v248
    v_subrev_u32 v255, 1537, v248
    v_lshlrev_b32 v227, 3, v14
    v_lshrrev_b32 v225, 4, v14
    v_lshlrev_b32 v225, 2, v225
    v_lshlrev_b32_e64 v14, 2, v14
    s_mov_b32 s16, 0
    s_mov_b32 s17, 0xffff0000
    v_lshlrev_b32 v3, 3, v11
    s_lshl_b32 s8, s3, 12
    s_add_u32 s8, s8, 140288
    v_add_u32 v3, s8, v3
    v_lshrrev_b32 v12, 5, v0
    v_lshlrev_b32_e64 v4, 7, v12
    v_bfe_u32 v12, v0, 4, 1
    v_lshl_add_u32 v4, v12, 3, v4
    v_bfe_u32 v12, v0, 3, 1
    v_lshl_add_u32 v4, v12, 9, v4
    v_and_b32_e64 v12, 7, v0
    v_lshl_add_u32 v4, v12, 4, v4
    s_lshl_b32 s8, s3, 10
    s_add_u32 s8, s8, 140288
    v_add_u32 v4, s8, v4
    v_bfe_u32 v12, v0, 4, 1
    v_lshlrev_b32 v12, 16, v12
    v_lshrrev_b32 v13, 5, v0
    v_lshl_add_u32 v12, v13, 12, v12
    v_lshl_add_u32 v222, v10, 1, v12
    s_lshl_b32 s10, s59, 17
    s_lshl_b32 s11, s68, 9
    s_add_u32 s10, s10, s11
    s_lshl_b32 s11, s3, 7
    s_add_u32 s10, s10, s11
    s_and_b32 s9, s2, 7
    s_add_u32 s9, s9, 56
    s_cmp_eq_u32 s69, 1
    s_cselect_b32 s33, s59, s9
    s_lshl_b32 s33, s33, 2
    s_add_u32 s33, s33, s68
    s_lshl_b32 s33, s33, 2
    s_add_u32 s33, s33, s3
    s_lshl_b32 s33, s33, 11
    s_add_u32 s33, s33, 1048576
    v_mov_b32_e64 v218, 0
    s_cmp_eq_u32 s69, 1
    s_cselect_b64 exec, -1, 1
    buffer_store_dwordx4 v[216:219], v224, s[44:47], s33 offen offset:0
    buffer_store_dwordx4 v[216:219], v224, s[44:47], s33 offen offset:1024
    s_mov_b64 exec, -1
    s_mov_b32 s8, 0x3f803f80
    s_waitcnt vmcnt(10)
    v_dot2_f32_bf16 v48, v16, s8, 0
    v_dot2_f32_bf16 v49, v16, v16, 0
    v_dot2_f32_bf16 v48, v17, s8, v48
    v_dot2_f32_bf16 v49, v17, v17, v49
    v_dot2_f32_bf16 v48, v18, s8, v48
    v_dot2_f32_bf16 v49, v18, v18, v49
    v_dot2_f32_bf16 v48, v19, s8, v48
    v_dot2_f32_bf16 v49, v19, v19, v49
    v_dot2_f32_bf16 v48, v20, s8, v48
    v_dot2_f32_bf16 v49, v20, v20, v49
    v_dot2_f32_bf16 v48, v21, s8, v48
    v_dot2_f32_bf16 v49, v21, v21, v49
    v_dot2_f32_bf16 v48, v22, s8, v48
    v_dot2_f32_bf16 v49, v22, v22, v49
    v_dot2_f32_bf16 v48, v23, s8, v48
    v_dot2_f32_bf16 v49, v23, v23, v49
    v_dot2_f32_bf16 v48, v24, s8, v48
    v_dot2_f32_bf16 v49, v24, v24, v49
    v_dot2_f32_bf16 v48, v25, s8, v48
    v_dot2_f32_bf16 v49, v25, v25, v49
    v_dot2_f32_bf16 v48, v26, s8, v48
    v_dot2_f32_bf16 v49, v26, v26, v49
    v_dot2_f32_bf16 v48, v27, s8, v48
    v_dot2_f32_bf16 v49, v27, v27, v49
    v_dot2_f32_bf16 v48, v28, s8, v48
    v_dot2_f32_bf16 v49, v28, v28, v49
    v_dot2_f32_bf16 v48, v29, s8, v48
    v_dot2_f32_bf16 v49, v29, v29, v49
    v_dot2_f32_bf16 v48, v30, s8, v48
    v_dot2_f32_bf16 v49, v30, v30, v49
    v_dot2_f32_bf16 v48, v31, s8, v48
    v_dot2_f32_bf16 v49, v31, v31, v49
    s_waitcnt lgkmcnt(0)
    s_mul_i32 s56, s56, 0x9E3779B1
    s_add_u32 s56, s56, 0x7F4A7C15
    s_or_b32 s56, s56, 1
    s_andn2_b32 s56, s56, 0x1e
    s_or_b32 s63, s19, s56
    v_mov_b32 v59, s63
    s_waitcnt vmcnt(6)
    v_dot2_f32_bf16 v50, v16, v32, 0
    v_dot2_f32_bf16 v51, v32, s8, 0
    v_dot2_f32_bf16 v50, v17, v33, v50
    v_dot2_f32_bf16 v51, v33, s8, v51
    v_dot2_f32_bf16 v50, v18, v34, v50
    v_dot2_f32_bf16 v51, v34, s8, v51
    v_dot2_f32_bf16 v50, v19, v35, v50
    v_dot2_f32_bf16 v51, v35, s8, v51
    v_dot2_f32_bf16 v50, v20, v36, v50
    v_dot2_f32_bf16 v51, v36, s8, v51
    v_dot2_f32_bf16 v50, v21, v37, v50
    v_dot2_f32_bf16 v51, v37, s8, v51
    v_dot2_f32_bf16 v50, v22, v38, v50
    v_dot2_f32_bf16 v51, v38, s8, v51
    v_dot2_f32_bf16 v50, v23, v39, v50
    v_dot2_f32_bf16 v51, v39, s8, v51
    v_dot2_f32_bf16 v50, v24, v40, v50
    v_dot2_f32_bf16 v51, v40, s8, v51
    v_dot2_f32_bf16 v50, v25, v41, v50
    v_dot2_f32_bf16 v51, v41, s8, v51
    v_dot2_f32_bf16 v50, v26, v42, v50
    v_dot2_f32_bf16 v51, v42, s8, v51
    v_dot2_f32_bf16 v50, v27, v43, v50
    v_dot2_f32_bf16 v51, v43, s8, v51
    v_dot2_f32_bf16 v50, v28, v44, v50
    v_dot2_f32_bf16 v51, v44, s8, v51
    v_dot2_f32_bf16 v50, v29, v45, v50
    v_dot2_f32_bf16 v51, v45, s8, v51
    v_dot2_f32_bf16 v50, v30, v46, v50
    v_dot2_f32_bf16 v51, v46, s8, v51
    v_dot2_f32_bf16 v50, v31, v47, v50
    v_dot2_f32_bf16 v51, v47, s8, v51
    s_nop 0
    s_nop 0
    v_add_f32_dpp v48, v48, v48 row_shr:1 row_mask:0xf bank_mask:0xf
    v_add_f32_dpp v49, v49, v49 row_shr:1 row_mask:0xf bank_mask:0xf
    v_add_f32_dpp v50, v50, v50 row_shr:1 row_mask:0xf bank_mask:0xf
    v_add_f32_dpp v51, v51, v51 row_shr:1 row_mask:0xf bank_mask:0xf
    v_add_f32_dpp v48, v48, v48 row_shr:2 row_mask:0xf bank_mask:0xf
    v_add_f32_dpp v49, v49, v49 row_shr:2 row_mask:0xf bank_mask:0xf
    v_add_f32_dpp v50, v50, v50 row_shr:2 row_mask:0xf bank_mask:0xf
    v_add_f32_dpp v51, v51, v51 row_shr:2 row_mask:0xf bank_mask:0xf
    v_add_f32_dpp v48, v48, v48 row_shr:4 row_mask:0xf bank_mask:0xf
    v_add_f32_dpp v49, v49, v49 row_shr:4 row_mask:0xf bank_mask:0xf
    v_add_f32_dpp v50, v50, v50 row_shr:4 row_mask:0xf bank_mask:0xf
    v_add_f32_dpp v51, v51, v51 row_shr:4 row_mask:0xf bank_mask:0xf
    v_add_f32_dpp v48, v48, v48 row_shr:8 row_mask:0xf bank_mask:0xf
    v_add_f32_dpp v49, v49, v49 row_shr:8 row_mask:0xf bank_mask:0xf
    v_add_f32_dpp v50, v50, v50 row_shr:8 row_mask:0xf bank_mask:0xf
    v_add_f32_dpp v51, v51, v51 row_shr:8 row_mask:0xf bank_mask:0xf
    v_add_f32_dpp v48, v48, v48 row_bcast:15 row_mask:0xa bank_mask:0xf
    v_add_f32_dpp v49, v49, v49 row_bcast:15 row_mask:0xa bank_mask:0xf
    v_add_f32_dpp v50, v50, v50 row_bcast:15 row_mask:0xa bank_mask:0xf
    v_add_f32_dpp v51, v51, v51 row_bcast:15 row_mask:0xa bank_mask:0xf
    v_mul_f32 v48, 0x3a800000, v48
    v_mul_f32 v49, 0x3a800000, v49
    v_cvt_pk_bf16_f32 v52, v48, v48
    v_fma_f32 v49, -v48, v48, v49
    v_max_f32_e64 v49, 0, v49
    v_and_b32 v53, 0xffff0000, v52
    v_cvt_pk_bf16_f32 v49, v49, v49
    v_and_b32 v49, 0xffff0000, v49
    v_add_f32 v49, 0x3727c5ac, v49
    v_fma_f32 v50, -v53, v51, v50
    v_cvt_pk_bf16_f32 v49, v49, v49
    v_and_b32 v49, 0xffff0000, v49
    v_sqrt_f32 v49, v49
    v_lshlrev_b32 v104, 2, v2
    v_mov_b32 v61, 0
    v_and_b32 v62, 62, v0
    v_mad_u32_u24 v62, v62, 3, v0
    v_lshlrev_b32_e64 v62, 6, v62
    v_cvt_pk_bf16_f32 v54, v49, v49
    v_and_b32 v49, 0xffff0000, v54
    v_rcp_f32 v49, v49
    s_nop 0
    v_mul_f32_e64 v50, v50, v49
    v_cvt_pk_bf16_f32 v50, v50, v50
    v_bfe_i32 v51, v50, 15, 1
    v_or_b32 v51, 0x80008000, v51
    v_xor_b32_e64 v55, v50, v51
    s_mov_b32 s8, 0xffff
    v_mov_b32_dpp v56, v52 row_bcast:31 row_mask:0x8 bank_mask:0xf
    v_mov_b32_dpp v57, v54 row_bcast:31 row_mask:0x8 bank_mask:0xf
    v_mov_b32_dpp v58, v55 row_bcast:31 row_mask:0x8 bank_mask:0xf
    v_bfi_b32 v56, s8, v56, v52
    v_bfi_b32 v57, s8, v57, v54
    v_bfi_b32 v58, s8, v58, v55
    s_brev_b64 exec, 1
    ds_write_b128 v104, v[56:59] offset:576
    ds_add_rtn_u32 v60, v61, v5 offset:512
    s_mov_b64 exec, -1
    s_waitcnt lgkmcnt(0)
    v_readlane_b32 s8, v60, 63
    s_cmp_lg_u32 s8, 3
    s_cbranch_scc1 L_NOPUB
    s_bfm_b64 exec, 4, 0
    ds_read_b128 v[52:55], v105 offset:576
    s_waitcnt lgkmcnt(0)
    buffer_store_dwordx4 v[52:55], v63, s[44:47], s13 offen sc1
    ds_write_b32 v61, v5 offset:516
    s_mov_b64 exec, -1
    s_waitcnt vmcnt(3)
    s_branch L_PUB2
L_NOPUB:
    s_waitcnt vmcnt(2)
L_PUB2:
    s_nop 0
    ds_write_b128 v96, v[64:67] offset:0
    ds_write_b128 v96, v[68:71] offset:272
    ds_write_b128 v96, v[72:75] offset:544
    ds_write_b128 v96, v[76:79] offset:816
    ds_read_b64 v[80:81], v97 offset:0
    ds_read_b64 v[82:83], v97 offset:272
    ds_read_b64 v[84:85], v97 offset:64
    ds_read_b64 v[86:87], v97 offset:336
    ds_read_b64 v[88:89], v97 offset:128
    ds_read_b64 v[90:91], v97 offset:400
    ds_read_b64 v[92:93], v97 offset:192
    ds_read_b64 v[94:95], v97 offset:464
    s_waitcnt lgkmcnt(6)
    buffer_store_dwordx4 v[80:83], v98, s[44:47], s18 offen
    s_add_u32 s18, s18, 0x20000
    s_waitcnt lgkmcnt(4)
    buffer_store_dwordx4 v[84:87], v98, s[44:47], s18 offen
    s_add_u32 s18, s18, 0x20000
    s_waitcnt lgkmcnt(2)
    buffer_store_dwordx4 v[88:91], v98, s[44:47], s18 offen
    s_add_u32 s18, s18, 0x20000
    s_waitcnt lgkmcnt(0)
    buffer_store_dwordx4 v[92:95], v98, s[44:47], s18 offen
    s_add_u32 s18, s18, 0x20000
    s_mov_b64 exec, 1
    ds_write_b32 v2, v59 offset:128
    s_mov_b64 exec, -1
LW_9:
    ds_read_b32 v60, v61 offset:516
    s_waitcnt lgkmcnt(0)
    v_cmp_eq_u32_e64 vcc, 0, v60
    s_cbranch_vccnz LW_9
    s_waitcnt vmcnt(0)
    s_mov_b64 exec, 1
    ds_add_rtn_u32 v60, v61, v5 offset:520
    s_waitcnt lgkmcnt(0)
    v_readfirstlane_b32 s8, v60
    s_cmp_lg_u32 s8, 3
    s_mov_b64 exec, -1
    s_cbranch_scc1 L_NOXF
    s_nop 0
    buffer_store_dword v59, v62, s[44:47], s62 offen offset:0
    buffer_store_dword v59, v62, s[44:47], s62 offen offset:128
    buffer_store_dword v59, v62, s[44:47], s62 offen offset:256
L_NOXF:
    global_load_dwordx4 v[112:115], v[220:221], off
    v_lshl_add_u64 v[220:221], s[20:21], 0, v[220:221]
    global_load_dwordx4 v[116:119], v[220:221], off
    v_lshl_add_u64 v[220:221], s[20:21], 0, v[220:221]
    global_load_dwordx4 v[120:123], v[220:221], off
    v_lshl_add_u64 v[220:221], s[20:21], 0, v[220:221]
    global_load_dwordx4 v[124:127], v[220:221], off
    v_lshl_add_u64 v[220:221], s[20:21], 0, v[220:221]
    buffer_load_dwordx4 v[32:35], v223, s[44:47], s61 offen sc1
    buffer_load_dwordx4 v[36:39], v223, s[44:47], s5 offen sc1
    buffer_load_dwordx4 v[40:43], v223, s[44:47], s6 offen sc1
    buffer_load_dwordx4 v[44:47], v223, s[44:47], s7 offen sc1
    s_waitcnt vmcnt(4)
    global_load_dwordx4 v[128:131], v[220:221], off
    v_lshl_add_u64 v[220:221], s[20:21], 0, v[220:221]
    s_waitcnt vmcnt(1)
    s_branch L_KPW
L_KP:
    s_sleep 1
L_KQ2:
    s_mov_b64 exec, s[30:31]
    s_cbranch_execz L_KS0
    buffer_load_dwordx4 v[32:35], v223, s[44:47], s61 offen sc1
L_KS0:
    s_mov_b64 exec, s[8:9]
    s_cbranch_execz L_KS1
    buffer_load_dwordx4 v[36:39], v223, s[44:47], s5 offen sc1
L_KS1:
    s_mov_b64 exec, s[14:15]
    s_cbranch_execz L_KS2
    buffer_load_dwordx4 v[40:43], v223, s[44:47], s6 offen sc1
L_KS2:
    s_mov_b64 exec, s[28:29]
    s_cbranch_execz L_KS3
    buffer_load_dwordx4 v[44:47], v223, s[44:47], s7 offen sc1
L_KS3:
    s_mov_b64 exec, -1
    s_waitcnt vmcnt(0)
L_KPW:
    s_add_u32 s16, s16, 1
    v_xor_b32 v16, s63, v35
    v_xor_b32 v17, s63, v39
    v_xor_b32 v18, s63, v43
    v_xor_b32_e64 v19, s63, v47
    v_cmp_lt_u32 s[30:31], 31, v16
    v_cmp_lt_u32 s[8:9], 31, v17
    v_cmp_lt_u32 s[14:15], 31, v18
    v_cmp_lt_u32 s[28:29], 31, v19
    v_or3_b32 v16, v16, v17, v18
    s_or_b64 vcc, s[30:31], s[8:9]
    s_or_b64 s[66:67], s[14:15], s[28:29]
    s_or_b64 vcc, vcc, s[66:67]
    s_cbranch_vccz L_KPOK
    s_cmp_lt_u32 s16, 0x4000
    s_cbranch_scc1 L_KP
L_KPOK:
    v_or_b32 v16, v16, v19
    v_cmp_ne_u32 vcc, 0, v16
    s_and_b64 vcc, vcc, s[40:41]
    s_cselect_b32 s8, 1, 2
    v_mov_b32 v16, s8
    ds_read_b32 v17, v1 offset:544
    ds_write2st64_b64 v227, v[32:33], v[36:37] offset0:18 offset1:22
    ds_write2st64_b64 v227, v[40:41], v[44:45] offset0:26 offset1:30
    s_mov_b64 exec, 1
    ds_write_b32 v2, v16 offset:528
    s_mov_b64 exec, -1
    v_lshl_or_b32 v248, v34, 16, v248
    v_and_or_b32 v249, v34, s17, v249
    v_lshl_or_b32 v250, v38, 16, v250
    v_and_or_b32 v251, v38, s17, v251
    v_lshl_or_b32 v252, v42, 16, v252
    v_and_or_b32 v253, v42, s17, v253
    v_lshl_or_b32 v254, v46, 16, v254
    v_and_or_b32 v255, v46, s17, v255
    s_waitcnt lgkmcnt(3)
    v_cmp_eq_u32 s[66:67], 0, v17
    s_cmp_lg_u32 s66, 0
    s_cbranch_scc1 L_NB0
    s_nop 0
    global_load_dwordx4 v[132:135], v[220:221], off
    v_lshl_add_u64 v[220:221], s[20:21], 0, v[220:221]
    global_load_dwordx4 v[136:139], v[220:221], off
    v_lshl_add_u64 v[220:221], s[20:21], 0, v[220:221]
    global_load_dwordx4 v[140:143], v[220:221], off
    v_lshl_add_u64 v[220:221], s[22:23], 0, v[220:221]
L_NB0:
    v_max_u32 v226, v248, v249
    v_min_u32 v227, v248, v249
    v_max_u32 v228, v252, v253
    v_min_u32 v229, v252, v253
    v_med3_u32 v227, v226, v227, v250
    v_med3_u32 v229, v228, v229, v254
    v_max_u32 v226, v226, v250
    v_max_u32 v228, v228, v254
    v_med3_u32 v227, v226, v227, v251
    v_med3_u32 v229, v228, v229, v255
    v_max_u32 v226, v226, v251
    v_max_u32 v228, v228, v255
    v_min_u32 v230, v226, v228
    v_max_u32 v226, v226, v228
    v_max3_u32 v227, v227, v229, v230
    ds_write_b32 v14, v226 offset:8192
    ds_read_b32 v17, v1 offset:544
    v_add_u32 v15, 4096, v15
    v_max_u32_dpp v226, v226, v226 row_shr:1 row_mask:0xf bank_mask:0xf
    v_max_u32_dpp v227, v227, v227 row_shr:1 row_mask:0xf bank_mask:0xf
    ds_write2_b32 v15, v34, v38 offset0:0 offset1:1
    v_max_u32_dpp v226, v226, v226 row_shr:2 row_mask:0xf bank_mask:0xf
    v_max_u32_dpp v227, v227, v227 row_shr:2 row_mask:0xf bank_mask:0xf
    ds_write2_b32 v15, v42, v46 offset0:2 offset1:3
    v_max_u32_dpp v226, v226, v226 row_shr:4 row_mask:0xf bank_mask:0xf
    v_max_u32_dpp v227, v227, v227 row_shr:4 row_mask:0xf bank_mask:0xf
    s_nop 0
    s_nop 0
    v_max_u32_dpp v226, v226, v226 row_shr:8 row_mask:0xf bank_mask:0xf
    v_max_u32_dpp v227, v227, v227 row_shr:8 row_mask:0xf bank_mask:0xf
    s_mov_b32 exec_lo, 0x80008000
    s_mov_b32 exec_hi, 0x80008000
    ds_write2_b32 v225, v226, v227 offset0:96 offset1:112
    s_mov_b64 exec, 1
    ds_write_b32 v2, v16 offset:64
    s_mov_b64 exec, -1
    s_waitcnt lgkmcnt(4)
    v_cmp_eq_u32 vcc, 0, v17
    s_mov_b32 s67, vcc_lo
    s_cbranch_vccnz L_NB1
    s_cmp_eq_u32 s66, 0
    s_cbranch_scc1 L_NB2
    global_load_dwordx4 v[132:135], v[220:221], off
    v_lshl_add_u64 v[220:221], s[20:21], 0, v[220:221]
    global_load_dwordx4 v[136:139], v[220:221], off
    v_lshl_add_u64 v[220:221], s[20:21], 0, v[220:221]
    global_load_dwordx4 v[140:143], v[220:221], off
    v_lshl_add_u64 v[220:221], s[22:23], 0, v[220:221]
L_NB2:
    global_load_dwordx4 v[144:147], v[220:221], off
    v_lshl_add_u64 v[220:221], s[20:21], 0, v[220:221]
    global_load_dwordx4 v[148:151], v[220:221], off
    v_lshl_add_u64 v[220:221], s[20:21], 0, v[220:221]
    global_load_dwordx4 v[152:155], v[220:221], off
    v_lshl_add_u64 v[220:221], s[20:21], 0, v[220:221]
L_NB1:
LW_10:
    ds_read_b32 v225, v1 offset:64
    s_waitcnt lgkmcnt(0)
    v_cmp_eq_u32_e64 vcc, 0, v225
    s_cbranch_vccnz LW_10
    v_cmp_ne_u32 s[12:13], 2, v225
    ds_read2_b32 v[226:227], v10 offset0:96 offset1:112
    ds_read_b128 v[228:231], v11 offset:384
    ds_read_b128 v[232:235], v224 offset:8192
    s_waitcnt lgkmcnt(1)
    v_cmp_gt_u32 vcc, v228, v226
    v_cmp_gt_u32 s[8:9], v229, v226
    v_cmp_gt_u32 s[14:15], v230, v226
    v_cmp_gt_u32 s[28:29], v231, v226
    v_cndmask_b32 v236, 0, 1, vcc
    v_cndmask_b32 v237, 0, 1, s[8:9]
    v_addc_co_u32 v236, vcc, 0, v236, s[14:15]
    v_addc_co_u32 v236, vcc, v237, v236, s[28:29]
    v_mov_b32 v237, v236
    s_nop 1
    v_permlane32_swap_b32 v236, v237
    v_add_u32 v236, v236, v237
    v_mov_b32 v237, v236
    s_nop 1
    v_permlane16_swap_b32 v236, v237
    v_add_u32 v236, v236, v237
    v_cmp_eq_u32 vcc, 7, v236
    s_ff1_i32_b32 s5, vcc_lo
    v_readlane_b32 s4, v226, s5
    s_waitcnt lgkmcnt(0)
    s_nop 0
    v_cmp_le_u32 vcc, s4, v227
    s_cbranch_vccnz L_SLOWT
L_CAND:
    v_cmp_le_u32 s[8:9], s4, v232
    v_cmp_le_u32 s[14:15], s4, v233
    v_cmp_le_u32 s[28:29], s4, v234
    v_cmp_le_u32 s[30:31], s4, v235
    s_bcnt1_i32_b64 s5, s[8:9]
    s_bcnt1_i32_b64 s6, s[14:15]
    s_bcnt1_i32_b64 s7, s[28:29]
    s_bcnt1_i32_b64 s16, s[30:31]
    s_add_u32 s6, s6, s5
    s_add_u32 s7, s7, s6
    s_add_u32 s16, s16, s7
    s_cmp_gt_u32 s16, 16
    s_cbranch_scc1 L_TRIM
    v_mbcnt_lo_u32_b32 v236, s8, 0
    v_mbcnt_hi_u32_b32 v236, s9, v236
    v_add_lshl_u32 v236, v236, 0, 2
    s_mov_b64 exec, s[8:9]
    ds_write_b32 v236, v232 offset:192
    s_mov_b64 exec, -1
    v_mbcnt_lo_u32_b32 v237, s14, 0
    v_mbcnt_hi_u32_b32 v237, s15, v237
    v_add_lshl_u32 v237, v237, s5, 2
    s_mov_b64 exec, s[14:15]
    ds_write_b32 v237, v233 offset:192
    s_mov_b64 exec, -1
    v_mbcnt_lo_u32_b32 v238, s28, 0
    v_mbcnt_hi_u32_b32 v238, s29, v238
    v_add_lshl_u32 v238, v238, s6, 2
    s_mov_b64 exec, s[28:29]
    ds_write_b32 v238, v234 offset:192
    s_mov_b64 exec, -1
    v_mbcnt_lo_u32_b32 v239, s30, 0
    v_mbcnt_hi_u32_b32 v239, s31, v239
    v_add_lshl_u32 v239, v239, s7, 2
    s_mov_b64 exec, s[30:31]
    ds_write_b32 v239, v235 offset:192
    s_mov_b64 exec, -1
    s_cmp_eq_u32 s67, 0
    s_cbranch_scc1 L_NB3
    s_nop 0
    global_load_dwordx4 v[132:135], v[220:221], off
    v_lshl_add_u64 v[220:221], s[20:21], 0, v[220:221]
    global_load_dwordx4 v[136:139], v[220:221], off
    v_lshl_add_u64 v[220:221], s[20:21], 0, v[220:221]
    global_load_dwordx4 v[140:143], v[220:221], off
    v_lshl_add_u64 v[220:221], s[22:23], 0, v[220:221]
    global_load_dwordx4 v[144:147], v[220:221], off
    v_lshl_add_u64 v[220:221], s[20:21], 0, v[220:221]
    global_load_dwordx4 v[148:151], v[220:221], off
    v_lshl_add_u64 v[220:221], s[20:21], 0, v[220:221]
    global_load_dwordx4 v[152:155], v[220:221], off
    v_lshl_add_u64 v[220:221], s[20:21], 0, v[220:221]
L_NB3:
    global_load_dwordx4 v[156:159], v[220:221], off
    v_lshl_add_u64 v[220:221], s[20:21], 0, v[220:221]
    global_load_dwordx4 v[160:163], v[220:221], off
    v_lshl_add_u64 v[220:221], s[20:21], 0, v[220:221]
    global_load_dwordx4 v[164:167], v[220:221], off
    v_lshl_add_u64 v[220:221], s[20:21], 0, v[220:221]
    global_load_dwordx4 v[168:171], v[220:221], off
    v_lshl_add_u64 v[220:221], s[20:21], 0, v[220:221]
    global_load_dwordx4 v[172:175], v[220:221], off
    s_movk_i32 s4, 0x7ff
    ds_read_b32 v16, v10 offset:192
    ds_read_b128 v[20:23], v11 offset:192
    s_cmp_lg_u32 s69, 1
    s_waitcnt lgkmcnt(1)
    v_bfi_b32 v14, v16, 0, s4
    s_cbranch_scc1 L_NOXS
    v_lshl_add_u32 v15, v14, 11, v9
    buffer_load_dwordx4 v[208:211], v15, s[48:51], 0 offen
    buffer_load_dwordx4 v[212:215], v15, s[48:51], 0 offen offset:64
    v_lshrrev_b32 v15, 1, v14
    v_lshlrev_b32 v15, 3, v15
    ds_read_b64 v[8:9], v15 offset:9216
L_NOXS:
    s_waitcnt lgkmcnt(0)
    v_cmp_gt_u32 vcc, v20, v16
    v_cmp_gt_u32 s[8:9], v21, v16
    v_cmp_gt_u32 s[14:15], v22, v16
    v_cmp_gt_u32 s[28:29], v23, v16
    v_cndmask_b32 v24, 0, 1, vcc
    v_cndmask_b32 v25, 0, 1, s[8:9]
    v_addc_co_u32 v24, vcc, 0, v24, s[14:15]
    v_addc_co_u32 v24, vcc, v25, v24, s[28:29]
    v_mov_b32 v25, v24
    s_nop 1
    v_permlane32_swap_b32 v24, v25
    v_add_u32 v24, v24, v25
    v_mov_b32 v25, v24
    s_nop 1
    v_permlane16_swap_b32 v24, v25
    v_add_u32 v24, v24, v25
    v_cmp_gt_u32 s[30:31], 8, v24
    v_lshlrev_b32 v15, 2, v24
    v_and_b32 v10, 7, v0
    v_lshlrev_b32_e64 v10, 2, v10
    v_bfe_u32 v20, v14, 1, 8
    v_lshrrev_b32 v21, 9, v14
    v_lshlrev_b32 v20, 3, v20
    v_lshl_add_u32 v20, v21, 1, v20
    v_and_b32 v14, 1, v14
    v_add_u32 v20, v20, v14
    v_mov_b32 v22, 0x80
    s_mov_b64 exec, s[30:31]
    ds_write_b32 v15, v16 offset:256
    s_cmp_lg_u32 s3, 0
    s_cbranch_scc1 L_NOSEL
    ds_write_b8 v20, v22 offset:1152
    s_cmp_lg_u32 s2, 255
    s_cbranch_scc1 L_NOSEL
    s_mov_b64 exec, 1
    v_mov_b32 v22, s56
    buffer_store_dword v22, v2, s[44:47], 0 offen sc1
L_NOSEL:
    s_mov_b64 exec, -1
    ds_read_b32 v7, v10 offset:256
    s_mov_b64 exec, 1
    ds_write_b32 v2, v5 offset:112
    s_mov_b64 exec, -1
    s_movk_i32 s4, 0x7ff
    v_bfe_u32 v226, v0, 3, 2
    s_lshl_b32 s8, s57, 3
    s_mov_b32 s32, 0
    s_waitcnt lgkmcnt(1)
    v_bfi_b32 v224, v7, 0, s4
    v_lshlrev_b32 v223, 11, v224
    v_lshl_add_u32 v223, v226, 1, v223
    v_add_u32_e64 v223, s8, v223
    buffer_load_ushort v246, v223, s[48:51], 0 offen
    s_cmp_lg_u32 s69, 1
    s_cbranch_scc1 L_NF
    v_lshl_add_u32 v3, v24, 4, v3
    v_lshlrev_b32 v14, 4, v14
    v_lshlrev_b32_e64 v13, 4, v0
    s_lshl_b32 s4, s59, 14
    s_add_u32 s4, s4, 65536
    s_lshl_b32 s6, s3, 12
    s_add_u32 s6, s6, s4
    s_lshl_b32 s5, s68, 10
    s_add_u32 s5, s5, s6
    v_mov_b32 v218, s56
    v_lshrrev_b32 v6, v14, v9
    v_lshrrev_b32 v8, v14, v8
    v_lshlrev_b32 v6, 16, v6
    v_xor_b32 v8, 0x8000, v8
    v_rcp_f32_e64 v6, v6
    v_perm_b32 v240, v8, v8, s64
    v_perm_b32 v241, v8, v8, s64
    v_perm_b32 v242, v8, v8, s64
    v_perm_b32 v243, v8, v8, s64
    s_add_u32 s11, s10, 0
    s_nop 0
    buffer_load_dwordx2 v[176:177], v222, s[24:27], s11 offen
    s_add_u32 s11, s10, 16384
    buffer_load_dwordx2 v[178:179], v222, s[24:27], s11 offen
    s_add_u32 s11, s10, 2048
    buffer_load_dwordx2 v[180:181], v222, s[24:27], s11 offen
    s_add_u32 s11, s10, 18432
    buffer_load_dwordx2 v[182:183], v222, s[24:27], s11 offen
    s_add_u32 s11, s10, 32768
    buffer_load_dwordx2 v[184:185], v222, s[24:27], s11 offen
    s_add_u32 s11, s10, 49152
    buffer_load_dwordx2 v[186:187], v222, s[24:27], s11 offen
    s_add_u32 s11, s10, 34816
    buffer_load_dwordx2 v[188:189], v222, s[24:27], s11 offen
    s_add_u32 s11, s10, 51200
    buffer_load_dwordx2 v[190:191], v222, s[24:27], s11 offen
    s_waitcnt vmcnt(19)
    s_nop 0
    v_perm_b32 v48, v116, v112, s64
    v_perm_b32 v52, v116, v112, s65
    v_perm_b32 v49, v124, v120, s64
    v_perm_b32 v53, v124, v120, s65
    v_perm_b32 v50, v132, v128, s64
    v_perm_b32 v54, v132, v128, s65
    v_perm_b32 v51, v140, v136, s64
    v_perm_b32 v55, v140, v136, s65
    v_perm_b32 v56, v117, v113, s64
    v_perm_b32 v60, v117, v113, s65
    v_perm_b32 v57, v125, v121, s64
    v_perm_b32 v61, v125, v121, s65
    v_perm_b32 v58, v133, v129, s64
    v_perm_b32 v62, v133, v129, s65
    v_perm_b32 v59, v141, v137, s64
    v_perm_b32 v63, v141, v137, s65
    v_perm_b32 v64, v118, v114, s64
    v_perm_b32 v68, v118, v114, s65
    v_perm_b32 v65, v126, v122, s64
    v_perm_b32 v69, v126, v122, s65
    v_perm_b32 v66, v134, v130, s64
    v_perm_b32 v70, v134, v130, s65
    v_perm_b32 v67, v142, v138, s64
    v_perm_b32 v71, v142, v138, s65
    v_perm_b32 v72, v119, v115, s64
    v_perm_b32 v76, v119, v115, s65
    v_perm_b32 v73, v127, v123, s64
    v_perm_b32 v77, v127, v123, s65
    v_perm_b32 v74, v135, v131, s64
    v_perm_b32 v78, v135, v131, s65
    v_perm_b32 v75, v143, v139, s64
    v_perm_b32 v79, v143, v139, s65
    s_waitcnt vmcnt(11)
    s_nop 0
    v_mfma_f32_16x16x32_bf16 v[16:19], v[48:51], v[240:243], 0
    v_perm_b32 v80, v148, v144, s64
    v_perm_b32 v84, v148, v144, s65
    v_perm_b32 v81, v156, v152, s64
    v_perm_b32 v85, v156, v152, s65
    v_mfma_f32_16x16x32_bf16 v[20:23], v[52:55], v[240:243], 0
    v_perm_b32 v82, v164, v160, s64
    v_perm_b32 v86, v164, v160, s65
    v_perm_b32 v83, v172, v168, s64
    v_perm_b32 v87, v172, v168, s65
    v_mfma_f32_16x16x32_bf16 v[24:27], v[56:59], v[240:243], 0
    v_perm_b32 v88, v149, v145, s64
    v_perm_b32 v92, v149, v145, s65
    v_perm_b32 v89, v157, v153, s64
    v_perm_b32 v93, v157, v153, s65
    v_mfma_f32_16x16x32_bf16 v[28:31], v[60:63], v[240:243], 0
    v_perm_b32 v90, v165, v161, s64
    v_perm_b32 v94, v165, v161, s65
    v_perm_b32 v91, v173, v169, s64
    v_perm_b32 v95, v173, v169, s65
    v_mfma_f32_16x16x32_bf16 v[32:35], v[64:67], v[240:243], 0
    v_perm_b32 v96, v150, v146, s64
    v_perm_b32 v100, v150, v146, s65
    v_perm_b32 v97, v158, v154, s64
    v_perm_b32 v101, v158, v154, s65
    v_mfma_f32_16x16x32_bf16 v[36:39], v[68:71], v[240:243], 0
    v_perm_b32 v98, v166, v162, s64
    v_perm_b32 v102, v166, v162, s65
    v_perm_b32 v99, v174, v170, s64
    v_perm_b32 v103, v174, v170, s65
    v_mfma_f32_16x16x32_bf16 v[40:43], v[72:75], v[240:243], 0
    v_perm_b32 v104, v151, v147, s64
    v_perm_b32 v108, v151, v147, s65
    v_perm_b32 v105, v159, v155, s64
    v_perm_b32 v109, v159, v155, s65
    v_mfma_f32_16x16x32_bf16 v[44:47], v[76:79], v[240:243], 0
    v_perm_b32 v106, v167, v163, s64
    v_perm_b32 v110, v167, v163, s65
    v_perm_b32 v107, v175, v171, s64
    v_perm_b32 v111, v175, v171, s65
    v_mfma_f32_16x16x32_bf16 v[16:19], v[80:83], v[240:243], v[16:19]
    v_mfma_f32_16x16x32_bf16 v[20:23], v[84:87], v[240:243], v[20:23]
    v_mfma_f32_16x16x32_bf16 v[24:27], v[88:91], v[240:243], v[24:27]
    v_mfma_f32_16x16x32_bf16 v[28:31], v[92:95], v[240:243], v[28:31]
    v_mfma_f32_16x16x32_bf16 v[32:35], v[96:99], v[240:243], v[32:35]
    v_mfma_f32_16x16x32_bf16 v[36:39], v[100:103], v[240:243], v[36:39]
    v_mfma_f32_16x16x32_bf16 v[40:43], v[104:107], v[240:243], v[40:43]
    v_mfma_f32_16x16x32_bf16 v[44:47], v[108:111], v[240:243], v[44:47]
    s_waitcnt vmcnt(9)
    s_nop 0
    v_mfma_f32_16x16x32_bf16 v[16:19], v[48:51], v[208:211], v[16:19]
    s_add_u32 s11, s10, 8192
    buffer_load_dwordx2 v[192:193], v222, s[24:27], s11 offen
    v_mfma_f32_16x16x32_bf16 v[20:23], v[52:55], v[208:211], v[20:23]
    s_add_u32 s11, s10, 24576
    buffer_load_dwordx2 v[194:195], v222, s[24:27], s11 offen
    v_mfma_f32_16x16x32_bf16 v[24:27], v[56:59], v[208:211], v[24:27]
    s_add_u32 s11, s10, 10240
    buffer_load_dwordx2 v[196:197], v222, s[24:27], s11 offen
    v_mfma_f32_16x16x32_bf16 v[28:31], v[60:63], v[208:211], v[28:31]
    s_add_u32 s11, s10, 26624
    buffer_load_dwordx2 v[198:199], v222, s[24:27], s11 offen
    v_mfma_f32_16x16x32_bf16 v[32:35], v[64:67], v[208:211], v[32:35]
    s_add_u32 s11, s10, 40960
    buffer_load_dwordx2 v[200:201], v222, s[24:27], s11 offen
    v_mfma_f32_16x16x32_bf16 v[36:39], v[68:71], v[208:211], v[36:39]
    s_add_u32 s11, s10, 57344
    buffer_load_dwordx2 v[202:203], v222, s[24:27], s11 offen
    v_mfma_f32_16x16x32_bf16 v[40:43], v[72:75], v[208:211], v[40:43]
    s_add_u32 s11, s10, 43008
    buffer_load_dwordx2 v[204:205], v222, s[24:27], s11 offen
    v_mfma_f32_16x16x32_bf16 v[44:47], v[76:79], v[208:211], v[44:47]
    s_add_u32 s11, s10, 59392
    buffer_load_dwordx2 v[206:207], v222, s[24:27], s11 offen
    v_mfma_f32_16x16x32_bf16 v[16:19], v[80:83], v[212:215], v[16:19]
    v_mfma_f32_16x16x32_bf16 v[20:23], v[84:87], v[212:215], v[20:23]
    v_mfma_f32_16x16x32_bf16 v[24:27], v[88:91], v[212:215], v[24:27]
    v_mfma_f32_16x16x32_bf16 v[28:31], v[92:95], v[212:215], v[28:31]
    v_mfma_f32_16x16x32_bf16 v[32:35], v[96:99], v[212:215], v[32:35]
    v_mfma_f32_16x16x32_bf16 v[36:39], v[100:103], v[212:215], v[36:39]
    v_mfma_f32_16x16x32_bf16 v[40:43], v[104:107], v[212:215], v[40:43]
    v_mfma_f32_16x16x32_bf16 v[44:47], v[108:111], v[212:215], v[44:47]
    s_mov_b64 exec, s[30:31]
    s_nop 0
    ds_write_b128 v3, v[16:19] offset:0
    ds_write_b128 v3, v[20:23] offset:512
    ds_write_b128 v3, v[24:27] offset:1024
    ds_write_b128 v3, v[28:31] offset:1536
    ds_write_b128 v3, v[32:35] offset:2048
    ds_write_b128 v3, v[36:39] offset:2560
    ds_write_b128 v3, v[40:43] offset:3072
    ds_write_b128 v3, v[44:47] offset:3584
    ds_write_b32 v15, v6 offset:288
    s_mov_b64 exec, 1
    ds_write_b32 v2, v5 offset:80
    s_mov_b64 exec, -1
    ds_read_b32 v6, v10 offset:288
LW_11:
    ds_read_b32 v11, v1 offset:80
    s_waitcnt lgkmcnt(0)
    v_cmp_eq_u32_e64 vcc, 0, v11
    s_cbranch_vccnz LW_11
    ds_read_b64 v[224:225], v4 offset:0
    ds_read_b64 v[226:227], v4 offset:256
    ds_read_b64 v[228:229], v4 offset:4096
    ds_read_b64 v[230:231], v4 offset:4352
    ds_read_b64 v[232:233], v4 offset:8192
    ds_read_b64 v[234:235], v4 offset:8448
    ds_read_b64 v[236:237], v4 offset:12288
    ds_read_b64 v[238:239], v4 offset:12544
    s_waitcnt lgkmcnt(4)
    v_add_f32 v224, v224, v228
    v_add_f32 v225, v225, v229
    v_add_f32 v226, v226, v230
    v_add_f32 v227, v227, v231
    s_waitcnt lgkmcnt(0)
    v_add_f32 v232, v232, v236
    v_add_f32 v233, v233, v237
    v_add_f32 v234, v234, v238
    v_add_f32 v235, v235, v239
    v_add_f32 v224, v224, v232
    v_add_f32 v225, v225, v233
    v_add_f32 v226, v226, v234
    v_add_f32_e64 v227, v227, v235
    s_cmp_eq_u32 s12, 0
    v_cvt_pk_bf16_f32 v216, v224, v225
    v_cvt_pk_bf16_f32 v217, v226, v227
    s_cbranch_scc0 L_HSC
    buffer_store_dwordx4 v[216:219], v13, s[44:47], s5 offen
L_HSB:
    v_bfe_u32 v10, v0, 3, 1
    v_lshrrev_b32 v11, 4, v0
    v_cmp_ne_u32 s[22:23], 0, v10
    v_lshlrev_b32_e64 v15, 2, v10
    v_lshl_add_u32 v15, v11, 3, v15
    v_lshlrev_b32_e64 v10, 8, v10
    v_lshl_add_u32 v10, v11, 9, v10
    v_lshlrev_b32 v9, 4, v11
    v_and_b32 v11, 7, v0
    v_lshl_add_u32 v10, v11, 4, v10
    s_movk_i32 s5, 144
    v_mad_u32_u24 v15, v11, s5, v15
    v_mad_u32_u24 v9, v11, s5, v9
    s_lshl_b32 s5, s3, 5
    v_add_u32 v15, s5, v15
    s_lshl_b32 s4, s59, 15
    s_lshl_b32 s5, s68, 13
    s_add_u32 s4, s4, s5
    s_lshl_b32 s5, s3, 11
    s_add_u32 s4, s4, s5
    s_add_u32 s4, s4, 1048576
    v_mul_f32 v12, 0xbfb8aa3b, v6
    v_mul_f32 v14, v6, v6
    v_mov_b32 v50, s56
    v_mov_b32_e64 v54, s56
    s_mov_b32 s16, 0
    s_waitcnt vmcnt(9)
    v_perm_b32 v112, v178, v176, s64
    v_perm_b32 v116, v178, v176, s65
    v_perm_b32 v113, v182, v180, s64
    v_perm_b32 v117, v182, v180, s65
    v_perm_b32 v114, v186, v184, s64
    v_perm_b32 v118, v186, v184, s65
    v_perm_b32 v115, v190, v188, s64
    v_perm_b32 v119, v190, v188, s65
    v_perm_b32 v120, v179, v177, s64
    v_perm_b32 v124, v179, v177, s65
    v_perm_b32 v121, v183, v181, s64
    v_perm_b32 v125, v183, v181, s65
    v_perm_b32 v122, v187, v185, s64
    v_perm_b32 v126, v187, v185, s65
    v_perm_b32 v123, v191, v189, s64
    v_perm_b32 v127, v191, v189, s65
    buffer_load_dwordx3 v[144:146], v13, s[44:47], s6 offen offset:0 sc1
    buffer_load_dwordx3 v[148:150], v13, s[44:47], s6 offen offset:1024 sc1
    buffer_load_dwordx3 v[152:154], v13, s[44:47], s6 offen offset:2048 sc1
    buffer_load_dwordx3 v[156:158], v13, s[44:47], s6 offen offset:3072 sc1
    v_lshrrev_b32 v221, 3, v0
    s_lshl_b32 s8, s3, 3
    v_add_lshl_u32 v221, v221, s8, 15
    v_and_b32 v225, 7, v0
    v_lshlrev_b32 v225, 4, v225
    v_add_u32_e64 v221, v221, v225
    v_bfe_u32 v226, v0, 3, 2
    v_bfrev_b32 v220, v226
    v_lshrrev_b32 v220, 22, v220
    v_add_u32 v220, v220, v225
    v_lshrrev_b32 v220, 2, v220
    v_lshrrev_b32 v224, 11, v223
    v_lshlrev_b32 v247, 13, v226
    v_lshl_add_u32 v247, v224, 2, v247
    v_lshrrev_b32 v225, 1, v224
    v_and_b32 v225, 0x30, v225
    v_xor_b32_e64 v247, v247, v225
    v_add_u32 v247, 17408, v247
LW_12:
    ds_read_b32 v224, v1 offset:112
    s_waitcnt lgkmcnt(0)
    v_cmp_eq_u32 vcc, 0, v224
    s_cbranch_vccnz LW_12
    s_lshr_b32 s8, s2, 3
    s_and_b32 s9, s2, 7
    s_lshr_b32 s39, s58, 1
    s_add_u32 s39, s39, 0
    v_lshrrev_b32 v253, 3, v0
    v_and_b32 v254, 7, v0
    s_lshl_b32 s38, s8, 5
    s_add_u32 s38, s38, s39
    v_lshrrev_b32 v252, 4, v0
    v_lshl_add_u32 v252, v252, 2, s38
    v_and_b32_e64 v251, 1, v253
    v_lshl_add_u32 v252, v252, 1, v251
    ds_read_u8 v255, v252 offset:1152
    ds_read_u8 v252, v252 offset:1184
    s_mul_i32 s38, s58, 4096
    s_add_u32 s38, s38, 140288
    v_lshl_add_u32 v249, v253, 3, s38
    v_lshl_add_u32 v250, v254, 4, s38
    s_movk_i32 s38, 288
    v_mad_u32_u24 v249, v254, s38, v249
    s_movk_i32 s38, 144
    v_mad_u32_u24 v250, v253, s38, v250
    v_lshlrev_b32_e64 v254, 4, v254
    v_lshl_add_u32 v248, v253, 14, v254
    v_lshl_add_u32 v253, v253, 11, v254
    s_and_b32 s38, s58, 1
    s_lshl_b32 s35, s9, 1
    s_add_u32 s35, s35, s38
    s_lshl_b32 s39, s39, 5
    s_add_u32 s39, s39, s8
    s_lshl_b32 s34, s35, 18
    s_lshl_b32 s38, s39, 7
    s_add_u32 s34, s34, s38
    s_add_u32 s34, s34, 3145728
    s_lshl_b32 s36, s39, 15
    s_lshl_b32 s35, s35, 7
    s_add_u32 s36, s36, s35
    s_add_u32 s37, s36, 0x4000
    s_add_u32 s35, s34, 0x20000
    s_lshl_b32 s38, s9, 5
    s_lshr_b32 s8, s8, 3
    s_add_u32 s38, s38, s8
    s_lshl_b32 s38, s38, 7
    s_add_u32 s38, s38, 983040
    s_mov_b32 s39, 0
    s_waitcnt lgkmcnt(0)
    v_lshl_or_b32 v251, v255, 24, v253
    v_lshl_or_b32 v252, v252, 24, v253
    v_lshlrev_b32 v255, 2, v0
    v_lshrrev_b32_e64 v254, 16, v7
    v_bfe_i32 v224, v254, 15, 1
    v_not_b32_e64 v224, v224
    v_or_b32 v224, 0x8000, v224
    v_xor_b32 v254, v254, v224
    v_lshlrev_b32 v254, 16, v254
    v_mul_f32 v254, 0xbfb8aa3b, v254
    v_exp_f32 v254, v254
    v_mov_b32 v253, s63
    v_add_f32 v254, 1.0, v254
    v_rcp_f32_e64 v254, v254
    s_waitcnt vmcnt(5)
    v_perm_b32 v128, v194, v192, s64
    v_perm_b32 v132, v194, v192, s65
    v_perm_b32 v129, v198, v196, s64
    v_perm_b32 v133, v198, v196, s65
    v_perm_b32 v130, v202, v200, s64
    v_perm_b32 v134, v202, v200, s65
    v_perm_b32 v131, v206, v204, s64
    v_perm_b32 v135, v206, v204, s65
    v_perm_b32 v136, v195, v193, s64
    v_perm_b32 v140, v195, v193, s65
    v_perm_b32 v137, v199, v197, s64
    v_perm_b32 v141, v199, v197, s65
    v_perm_b32 v138, v203, v201, s64
    v_perm_b32 v142, v203, v201, s65
    v_perm_b32 v139, v207, v205, s64
    v_perm_b32 v143, v207, v205, s65
    s_branch L_HPW
L_HP:
    s_sleep 1
    s_cmp_eq_u64 s[18:19], 0
    s_cbranch_scc1 L_HS0
    buffer_load_dwordx3 v[144:146], v13, s[44:47], s6 offen offset:0 sc1
L_HS0:
    s_cmp_eq_u64 s[8:9], 0
    s_cbranch_scc1 L_HS1
    buffer_load_dwordx3 v[148:150], v13, s[44:47], s6 offen offset:1024 sc1
L_HS1:
    s_cmp_eq_u64 s[14:15], 0
    s_cbranch_scc1 L_HS2
    buffer_load_dwordx3 v[152:154], v13, s[44:47], s6 offen offset:2048 sc1
L_HS2:
    s_cmp_eq_u64 s[28:29], 0
    s_cbranch_scc1 L_HS3
    buffer_load_dwordx3 v[156:158], v13, s[44:47], s6 offen offset:3072 sc1
L_HS3:
L_HPW:
    s_add_u32 s16, s16, 1
    s_waitcnt vmcnt(0)
    v_cmp_ne_u32 s[18:19], s56, v146
    v_cmp_ne_u32 s[8:9], s56, v150
    v_cmp_ne_u32 s[14:15], s56, v154
    v_cmp_ne_u32 s[28:29], s56, v158
    s_or_b64 vcc, s[18:19], s[8:9]
    s_or_b64 s[20:21], s[14:15], s[28:29]
    s_or_b64 vcc, vcc, s[20:21]
    s_cbranch_vccz L_HOK
    s_cmp_lt_u32 s16, 0x4000
    s_cbranch_scc1 L_HP
L_HOK:
    s_mov_b32 exec_hi, 0
    buffer_load_dword v253, v255, s[44:47], s38 offen sc1
    s_mov_b32 exec_hi, -1
    v_lshlrev_b32 v224, 16, v144
    v_and_b32 v225, 0xffff0000, v144
    v_lshlrev_b32_e64 v226, 16, v148
    v_and_b32 v227, 0xffff0000, v148
    v_lshlrev_b32_e64 v228, 16, v152
    v_and_b32 v229, 0xffff0000, v152
    v_lshlrev_b32_e64 v230, 16, v156
    v_and_b32 v231, 0xffff0000, v156
    v_add_f32 v224, v224, v226
    v_add_f32 v228, v228, v230
    v_add_f32 v225, v225, v227
    v_add_f32 v229, v229, v231
    v_add_f32 v224, v224, v228
    v_add_f32 v225, v225, v229
    v_mul_f32 v244, v12, v224
    v_mul_f32 v245, v12, v225
    v_exp_f32 v244, v244
    v_exp_f32 v245, v245
    v_lshlrev_b32_e64 v232, 16, v145
    v_and_b32 v233, 0xffff0000, v145
    v_lshlrev_b32_e64 v234, 16, v149
    v_and_b32 v235, 0xffff0000, v149
    v_lshlrev_b32_e64 v236, 16, v153
    v_and_b32 v237, 0xffff0000, v153
    v_lshlrev_b32_e64 v238, 16, v157
    v_and_b32 v239, 0xffff0000, v157
    v_add_f32 v244, 1.0, v244
    v_add_f32 v245, 1.0, v245
    v_rcp_f32 v244, v244
    v_rcp_f32 v245, v245
    v_add_f32 v232, v232, v234
    v_add_f32 v236, v236, v238
    v_add_f32 v233, v233, v235
    v_add_f32 v237, v237, v239
    v_mul_f32 v224, v224, v14
    v_add_f32 v232, v232, v236
    v_mul_f32 v225, v225, v14
    v_add_f32 v233, v233, v237
    v_mul_f32 v224, v224, v244
    v_mul_f32 v225, v225, v245
    v_mul_f32 v224, v224, v232
    v_mul_f32 v225, v225, v233
    v_cvt_pk_bf16_f32 v244, v224, v225
    ds_write_b32 v15, v244 offset:4096
    s_mov_b64 exec, 1
    ds_write_b32 v2, v5 offset:176
    s_mov_b64 exec, -1
LW_13:
    ds_read_b32 v11, v1 offset:176
    s_waitcnt lgkmcnt(0)
    v_cmp_eq_u32_e64 vcc, 0, v11
    s_cbranch_vccnz LW_13
    ds_read_b128 v[224:227], v9 offset:4096
    ds_read_b128 v[228:231], v9 offset:4160
    s_waitcnt lgkmcnt(1)
    v_mfma_f32_16x16x32_bf16 v[16:19], v[112:115], v[224:227], 0
    v_mfma_f32_16x16x32_bf16 v[20:23], v[116:119], v[224:227], 0
    v_mfma_f32_16x16x32_bf16 v[24:27], v[120:123], v[224:227], 0
    v_mfma_f32_16x16x32_bf16 v[28:31], v[124:127], v[224:227], 0
    s_waitcnt lgkmcnt(0)
    v_mfma_f32_16x16x32_bf16 v[16:19], v[128:131], v[228:231], v[16:19]
    v_mfma_f32_16x16x32_bf16 v[20:23], v[132:135], v[228:231], v[20:23]
    v_mfma_f32_16x16x32_bf16 v[24:27], v[136:139], v[228:231], v[24:27]
    v_mfma_f32_16x16x32_bf16 v[28:31], v[140:143], v[228:231], v[28:31]
    s_waitcnt vmcnt(0)
    v_cmp_ne_u32_e64 vcc, s63, v253
    s_or_b64 vcc, vcc, s[12:13]
    s_cbranch_vccnz L_EAN
    s_mov_b32 s32, 1
    buffer_load_dwordx4 v[96:99], v248, s[44:47], s34 offen sc1
    buffer_load_dwordx4 v[100:103], v248, s[44:47], s35 offen sc1
L_EAN:
    s_nop 0
    s_nop 0
    v_cndmask_b32 v16, v16, v18, s[22:23]
    v_cndmask_b32 v20, v20, v22, s[22:23]
    v_cndmask_b32 v24, v24, v26, s[22:23]
    v_cndmask_b32 v28, v28, v30, s[22:23]
    v_cvt_pk_bf16_f32 v48, v16, v20
    v_cvt_pk_bf16_f32 v49, v24, v28
    buffer_store_dwordx4 v[48:51], v10, s[44:47], s4 offen offset:0 sc1
    v_cndmask_b32 v17, v17, v19, s[22:23]
    v_cndmask_b32 v21, v21, v23, s[22:23]
    v_cndmask_b32 v25, v25, v27, s[22:23]
    v_cndmask_b32 v29, v29, v31, s[22:23]
    v_cvt_pk_bf16_f32 v52, v17, v21
    v_cvt_pk_bf16_f32 v53, v25, v29
    buffer_store_dwordx4 v[52:55], v10, s[44:47], s4 offen offset:128 sc1
    s_cmp_eq_u32 s32, 0
    s_cbranch_scc1 L_GATHER
    s_waitcnt vmcnt(2)
    s_nop 0
    ds_write_b64 v249, v[96:97] offset:0
    ds_write_b64 v249, v[98:99] offset:144
    ds_write_b64 v249, v[100:101] offset:64
    ds_write_b64 v249, v[102:103] offset:208
    ds_read_b128 v[104:107], v250 offset:0
    ds_read_b128 v[108:111], v250 offset:1152
    s_waitcnt lgkmcnt(1)
    buffer_store_dwordx4 v[104:107], v251, s[52:55], s36 offen sc1
    s_waitcnt lgkmcnt(0)
    buffer_store_dwordx4 v[108:111], v252, s[52:55], s37 offen sc1
    s_branch L_AFT
L_GATHER:
    s_cmp_lg_u32 s12, 0
    s_cbranch_scc1 L_AFT
    s_setprio 0
LW_14:
    s_sleep 2
    ds_read_b32 v81, v1 offset:32
    s_waitcnt lgkmcnt(0)
    v_cmp_eq_u32_e64 vcc, 0, v81
    s_cbranch_vccnz LW_14
    s_mov_b32 exec_hi, 0
LT_15:
    buffer_load_dword v253, v255, s[44:47], s38 offen sc1
    s_add_u32 s39, s39, 1
    s_waitcnt vmcnt(0)
    v_cmp_ne_u32_e64 vcc, s63, v253
    s_cbranch_vccz LT_15K
    s_sleep 3
    s_cmp_lt_u32 s39, 0x4000
    s_cbranch_scc1 LT_15
LT_15K:
    s_mov_b32 exec_hi, -1
    buffer_load_dwordx4 v[96:99], v248, s[44:47], s34 offen sc1
    buffer_load_dwordx4 v[100:103], v248, s[44:47], s35 offen sc1
    s_waitcnt vmcnt(1)
    ds_write_b64 v249, v[96:97] offset:0
    ds_write_b64 v249, v[98:99] offset:144
    s_waitcnt vmcnt(0)
    ds_write_b64 v249, v[100:101] offset:64
    ds_write_b64 v249, v[102:103] offset:208
    ds_read_b128 v[104:107], v250 offset:0
    ds_read_b128 v[108:111], v250 offset:1152
    s_waitcnt lgkmcnt(1)
    buffer_store_dwordx4 v[104:107], v251, s[52:55], s36 offen sc1
    s_waitcnt lgkmcnt(0)
    buffer_store_dwordx4 v[108:111], v252, s[52:55], s37 offen sc1
L_AFT:
    s_setprio 0
    s_lshl_b32 s4, s57, 7
    s_add_u32 s4, s4, 1048576
    s_mov_b32 s11, 0
    s_lshl_b32 s8, s3, 8
    v_lshl_add_u32 v85, v0, 2, s8
LW_16:
    s_sleep 1
    ds_read_b32 v81, v1 offset:560
    s_waitcnt lgkmcnt(0)
    v_cmp_eq_u32 vcc, 0, v81
    s_cbranch_vccnz LW_16
    s_setprio 2
L_GGO:
    s_mov_b64 s[8:9], -1
    s_cmp_lt_u32 s3, 3
    s_cselect_b64 s[12:13], -1, 0
    s_add_u32 s5, s4, 0x100000
    v_mov_b32 v148, 0
    v_mov_b32 v149, 0
    v_mov_b32_e64 v150, s56
L_GP:
    s_mov_b64 exec, s[8:9]
    s_cbranch_execz L_GS0
    buffer_load_dwordx3 v[144:146], v221, s[44:47], s4 offen sc1
L_GS0:
    s_mov_b64 exec, s[12:13]
    s_cbranch_execz L_GS1
    buffer_load_dwordx3 v[148:150], v221, s[44:47], s5 offen sc1
L_GS1:
    s_mov_b64 exec, -1
    s_add_u32 s11, s11, 1
    s_waitcnt vmcnt(0)
    v_cmp_ne_u32 s[8:9], s56, v146
    v_cmp_ne_u32 s[12:13], s56, v150
    s_or_b64 vcc, s[8:9], s[12:13]
    s_cbranch_vccz L_GOT
    s_branch L_AH1
L_AH0:
    s_sleep 1
L_AH1:
    ds_read_b32 v81, v1 offset:560
    s_waitcnt lgkmcnt(0)
    v_cmp_gt_u32_e64 vcc, 2, v81
    s_cbranch_vccnz L_AH0
    s_sleep 2
    s_cmp_lt_u32 s11, 0x4000
    s_cbranch_scc1 L_GP
L_GOT:
    v_lshlrev_b32 v176, 16, v144
    v_and_b32 v177, 0xffff0000, v144
    v_lshlrev_b32_e64 v178, 16, v145
    v_and_b32 v179, 0xffff0000, v145
    v_lshlrev_b32_e64 v180, 16, v148
    v_and_b32 v181, 0xffff0000, v148
    v_lshlrev_b32_e64 v182, 16, v149
    v_and_b32 v183, 0xffff0000, v149
    v_add_f32 v176, v176, v180
    v_add_f32 v177, v177, v181
    v_add_f32 v178, v178, v182
    v_add_f32 v179, v179, v183
    v_permlane32_swap_b32 v176, v177
    s_nop 0
    v_permlane32_swap_b32 v178, v179
    v_add_f32 v176, v176, v177
    v_add_f32 v178, v178, v179
    s_nop 1
    v_permlane16_swap_b32 v176, v178
    v_add_f32 v176, v176, v178
    s_nop 0
    s_nop 0
    v_add_f32_dpp v176, v176, v176 row_ror:8 row_mask:0xf bank_mask:0xf
    ds_write_b32 v85, v176 offset:8192
    s_mov_b64 exec, 1
    ds_write_b32 v2, v5 offset:96
    s_mov_b64 exec, -1
    s_cmp_lg_u32 s3, 0
    s_cbranch_scc1 L_FIN
    v_lshlrev_b32_e64 v80, 16, v246
L_FW:
    ds_read2_b32 v[86:87], v1 offset0:12 offset1:24
    ds_read_b32 v89, v247
    ds_read2st64_b32 v[90:91], v220 offset0:32 offset1:33
    ds_read2st64_b32 v[92:93], v220 offset0:34 offset1:35
    s_waitcnt lgkmcnt(3)
    v_min_u32 v86, v86, v87
    v_cmp_eq_u32 vcc, 0, v86
    s_cbranch_vccnz L_FW
    s_waitcnt lgkmcnt(1)
    v_add_f32 v80, v80, v89
    v_add_f32 v90, v90, v91
    s_waitcnt lgkmcnt(0)
    v_add_f32 v92, v92, v93
    v_add_f32 v90, v90, v92
    v_fma_f32 v80, v90, v254, v80
    v_cvt_pk_bf16_f32 v80, v80, v80
    s_mov_b32 exec_hi, 0
    buffer_store_short v80, v223, s[52:55], 0 offen
    s_mov_b64 exec, -1
    s_branch L_FIN
L_HSC:
    buffer_store_dwordx4 v[216:219], v13, s[44:47], s5 offen sc1
    s_branch L_HSB
L_NF:
    v_lshrrev_b32 v221, 3, v0
    s_lshl_b32 s8, s3, 3
    v_add_lshl_u32 v221, v221, s8, 15
    v_and_b32 v225, 7, v0
    v_lshlrev_b32 v225, 4, v225
    v_add_u32_e64 v221, v221, v225
    v_bfe_u32 v226, v0, 3, 2
    v_bfrev_b32 v220, v226
    v_lshrrev_b32 v220, 22, v220
    v_add_u32 v220, v220, v225
    v_lshrrev_b32 v220, 2, v220
    v_lshrrev_b32 v224, 11, v223
    v_lshlrev_b32 v247, 13, v226
    v_lshl_add_u32 v247, v224, 2, v247
    v_lshrrev_b32 v225, 1, v224
    v_and_b32 v225, 0x30, v225
    v_xor_b32_e64 v247, v247, v225
    v_add_u32 v247, 17408, v247
LW_17:
    ds_read_b32 v224, v1 offset:112
    s_waitcnt lgkmcnt(0)
    v_cmp_eq_u32 vcc, 0, v224
    s_cbranch_vccnz LW_17
    s_lshr_b32 s8, s2, 3
    s_and_b32 s9, s2, 7
    s_lshr_b32 s39, s58, 1
    s_add_u32 s39, s39, 0
    v_lshrrev_b32 v253, 3, v0
    v_and_b32 v254, 7, v0
    s_lshl_b32 s38, s8, 5
    s_add_u32 s38, s38, s39
    v_lshrrev_b32 v252, 4, v0
    v_lshl_add_u32 v252, v252, 2, s38
    v_and_b32_e64 v251, 1, v253
    v_lshl_add_u32 v252, v252, 1, v251
    ds_read_u8 v255, v252 offset:1152
    ds_read_u8 v252, v252 offset:1184
    s_mul_i32 s38, s58, 4096
    s_add_u32 s38, s38, 140288
    v_lshl_add_u32 v249, v253, 3, s38
    v_lshl_add_u32 v250, v254, 4, s38
    s_movk_i32 s38, 288
    v_mad_u32_u24 v249, v254, s38, v249
    s_movk_i32 s38, 144
    v_mad_u32_u24 v250, v253, s38, v250
    v_lshlrev_b32_e64 v254, 4, v254
    v_lshl_add_u32 v248, v253, 14, v254
    v_lshl_add_u32 v253, v253, 11, v254
    s_and_b32 s38, s58, 1
    s_lshl_b32 s35, s9, 1
    s_add_u32 s35, s35, s38
    s_lshl_b32 s39, s39, 5
    s_add_u32 s39, s39, s8
    s_lshl_b32 s34, s35, 18
    s_lshl_b32 s38, s39, 7
    s_add_u32 s34, s34, s38
    s_add_u32 s34, s34, 3145728
    s_lshl_b32 s36, s39, 15
    s_lshl_b32 s35, s35, 7
    s_add_u32 s36, s36, s35
    s_add_u32 s37, s36, 0x4000
    s_add_u32 s35, s34, 0x20000
    s_lshl_b32 s38, s9, 5
    s_lshr_b32 s8, s8, 3
    s_add_u32 s38, s38, s8
    s_lshl_b32 s38, s38, 7
    s_add_u32 s38, s38, 983040
    s_mov_b32 s39, 0
    s_waitcnt lgkmcnt(0)
    v_lshl_or_b32 v251, v255, 24, v253
    v_lshl_or_b32 v252, v252, 24, v253
    v_lshlrev_b32 v255, 2, v0
    v_lshrrev_b32_e64 v254, 16, v7
    v_bfe_i32 v224, v254, 15, 1
    v_not_b32_e64 v224, v224
    v_or_b32 v224, 0x8000, v224
    v_xor_b32 v254, v254, v224
    v_lshlrev_b32 v254, 16, v254
    v_mul_f32 v254, 0xbfb8aa3b, v254
    v_exp_f32 v254, v254
    v_mov_b32 v253, s63
    v_add_f32 v254, 1.0, v254
    v_rcp_f32 v254, v254
    s_branch L_GATHER
L_TRIM:
    v_subrev_u32 v236, s4, v232
    v_subrev_u32 v237, s4, v233
    v_subrev_u32 v238, s4, v234
    v_subrev_u32_e64 v239, s4, v235
    v_min3_u32 v236, v236, v237, v238
    v_min_u32 v236, v236, v239
    s_nop 1
    v_min_u32_dpp v236, v236, v236 row_shr:1 row_mask:0xf bank_mask:0xf
    s_nop 0
    s_nop 0
    v_min_u32_dpp v236, v236, v236 row_shr:2 row_mask:0xf bank_mask:0xf
    s_nop 0
    s_nop 0
    v_min_u32_dpp v236, v236, v236 row_shr:4 row_mask:0xf bank_mask:0xf
    s_nop 0
    s_nop 0
    v_min_u32_dpp v236, v236, v236 row_shr:8 row_mask:0xf bank_mask:0xf
    s_nop 0
    s_nop 0
    v_min_u32_dpp v236, v236, v236 row_bcast:15 row_mask:0xa bank_mask:0xf
    s_nop 0
    s_nop 0
    v_min_u32_dpp v236, v236, v236 row_bcast:31 row_mask:0xc bank_mask:0xf
    s_nop 0
    v_readlane_b32 s5, v236, 63
    s_add_u32 s4, s4, s5
    s_add_u32 s4, s4, 1
    s_branch L_CAND
L_SLOWT:
    v_max3_u32 v228, v232, v233, v234
    v_max_u32 v228, v228, v235
    s_mov_b32 s4, 0
    s_brev_b32 s5, 1
L_BS:
    s_or_b32 s6, s4, s5
    v_cmp_le_u32_e64 vcc, s6, v228
    s_lshr_b32 s5, s5, 1
    s_bcnt1_i32_b64 s7, vcc
    s_cmp_ge_u32 s7, 8
    s_cselect_b32 s4, s6, s4
    s_cmp_lg_u32 s7, 8
    s_cbranch_scc1 L_BS
    v_mbcnt_lo_u32_b32 v229, vcc_lo, 0
    v_mbcnt_hi_u32_b32 v229, vcc_hi, v229
    v_lshlrev_b32 v229, 2, v229
    s_mov_b64 exec, vcc
    ds_write_b32 v229, v0 offset:320
    s_mov_b64 exec, -1
    v_lshrrev_b32 v230, 3, v0
    v_lshlrev_b32_e64 v230, 2, v230
    ds_read_b32 v229, v230 offset:320
    s_waitcnt lgkmcnt(0)
    v_and_b32 v230, 7, v0
    v_lshl_add_u32 v229, v229, 3, v230
    v_lshlrev_b32_e64 v230, 3, v229
    ds_read_b64 v[226:227], v230 offset:4096
    v_and_b32 v230, 1, v229
    v_and_b32 v229, -2, v229
    v_lshl_add_u32 v229, v230, 10, v229
    v_sub_u32 v232, 0xfff, v229
    v_sub_u32 v233, 0xffe, v229
    v_sub_u32 v234, 0xdff, v229
    v_sub_u32 v235, 0xdfe, v229
    s_mov_b32 s5, 0xffff0000
    s_waitcnt lgkmcnt(0)
    v_lshl_or_b32 v232, v226, 16, v232
    v_and_or_b32 v233, v226, s5, v233
    v_lshl_or_b32 v234, v227, 16, v234
    v_and_or_b32 v235, v227, s5, v235
    s_branch L_CAND
L_FIN:
L_END:
    s_endpgm
.section .rodata,"a"
.p2align 6
.amdhsa_kernel parallel_sum__ssm_conv_s4d__moe_arch_mod__prompt_kernel
  .amdhsa_next_free_vgpr 256
  .amdhsa_next_free_sgpr 102
  .amdhsa_accum_offset 256
  .amdhsa_group_segment_fixed_size 0
  .amdhsa_kernarg_size 120
  .amdhsa_user_sgpr_count 2
  .amdhsa_user_sgpr_kernarg_segment_ptr 1
  .amdhsa_system_sgpr_workgroup_id_x 1
  .amdhsa_float_denorm_mode_32 3
.end_amdhsa_kernel
```

```asm
; @launch grid=(256,1,1) block=(512,1,1) lds=156672
.amdgcn_target "amdgcn-amd-amdhsa--gfx950"
.text
.globl parallel_sum__ssm_conv_s4d__moe_arch_mod__prompt_kernel
.p2align 8
.type parallel_sum__ssm_conv_s4d__moe_arch_mod__prompt_kernel,@function
parallel_sum__ssm_conv_s4d__moe_arch_mod__prompt_kernel:
    s_cmp_ge_u32 s2, 256
    s_cbranch_scc1 L_END
    s_load_dwordx16 s[16:31], s[0:1], 0
    s_load_dwordx8 s[32:39], s[0:1], 64
    s_load_dwordx2 s[40:41], s[0:1], 96
    s_load_dwordx2 s[42:43], s[0:1], 112
    s_getpc_b64 s[14:15]
    v_lshrrev_b32_e64 v1, 6, v0
    v_and_b32 v10, 255, v0
    v_and_b32 v0, 63, v0
    v_readfirstlane_b32 s3, v1
    v_lshlrev_b32 v1, 2, v0
    v_mov_b32 v2, 0
    ds_write2st64_b32 v1, v2, v2 offset0:0 offset1:2
    s_and_b32 s5, s2, 7
    s_lshr_b32 s6, s2, 3
    s_lshl_b32 s57, s5, 5
    s_add_u32 s57, s57, s6
    s_and_b32 s58, s3, 3
    s_lshl_b32 s7, s57, 2
    s_add_u32 s7, s7, s58
    s_lshl_b32 s7, s7, 8
    v_add_u32 v15, s7, v1
    s_mov_b32 s60, 0
    s_lshl_b32 s4, s57, 3
    s_cmp_lt_u32 s3, 4
    s_cbranch_scc1 L_F0
    s_and_b32 s8, s6, 15
    s_lshl_b32 s8, s8, 2
    s_add_u32 s8, s8, s58
    s_lshl_b32 s8, s8, 9
    s_mov_b32 s69, s8
    v_lshl_add_u32 v2, v0, 7, s8
    v_min_u32 v2, L_END-parallel_sum__ssm_conv_s4d__moe_arch_mod__prompt_kernel-128, v2
    s_mov_b64 exec, 0xf
    global_load_dword v229, v2, s[14:15]
    s_mov_b64 exec, -1
    v_lshlrev_b32 v3, 12, v10
    v_add_u32_e64 v3, s4, v3
    s_lshl_b32 s8, s5, 5
    s_add_u32 s8, s8, s58
    s_lshl_b32 s8, s8, 7
    s_add_u32 s8, s8, 983040
    v_lshl_add_u32 v2, v0, 9, s8
    s_lshl_b32 s59, s5, 2
    s_add_u32 s59, s59, s58
    s_lshl_b32 s59, s59, 5
    s_add_u32 s59, s59, s6
    s_lshl_b32 s59, s59, 9
    s_add_u32 s59, s59, 7340032
    s_sub_u32 s8, s59, 512
    v_lshl_add_u32 v4, v0, 7, s8
    v_cmp_lt_u32 vcc, 3, v0
    s_nop 0
    s_nop 0
    v_cndmask_b32 v2, v2, v4, vcc
    s_lshl_b32 s8, s2, 6
    s_add_u32 s8, s8, 7864320
    v_writelane_b32 v2, s8, 3
    s_waitcnt lgkmcnt(0)
    s_cmp_ge_u32 s6, 32
    s_cbranch_scc1 L_NFP
    s_mov_b64 exec, 127
    global_load_dword v229, v2, s[42:43]
    s_mov_b64 exec, -1
L_NFP:
    global_load_dword v224, v15, s[18:19]
    global_load_dword v225, v15, s[20:21]
    global_load_dword v226, v15, s[22:23]
    global_load_dword v227, v15, s[24:25]
    s_add_u32 s6, s26, s4
    s_addc_u32 s7, s27, 0
    s_load_dwordx2 s[64:65], s[6:7], 0
    s_add_u32 s6, s28, s4
    s_addc_u32 s7, s29, 0
    s_load_dwordx2 s[66:67], s[6:7], 0
    s_barrier
    s_mov_b64 s[26:27], s[14:15]
    s_mov_b32 s61, 0x100000
    s_mov_b32 s62, 0x200000
    s_mov_b32 s63, 0x300000
    s_mov_b32 s44, s42
    s_and_b32 s45, s43, 0xffff
    s_mov_b32 s46, 0x1000000
    s_mov_b32 s47, 0x20000
    s_mov_b32 s48, s16
    s_and_b32 s49, s17, 0xffff
    s_mov_b32 s50, 0x400000
    s_mov_b32 s51, 0x20000
    s_mov_b32 s52, s40
    s_and_b32 s53, s41, 0xffff
    s_mov_b32 s54, 0x400000
    s_mov_b32 s55, 0x20000
    s_setprio 2
    s_lshr_b32 s8, s2, 3
    s_and_b32 s9, s2, 7
    s_lshr_b32 s41, s58, 1
    s_add_u32 s41, s41, 2
    v_lshrrev_b32 v172, 3, v0
    v_and_b32 v173, 7, v0
    s_lshl_b32 s40, s8, 5
    s_add_u32 s40, s40, s41
    v_lshrrev_b32_e64 v239, 4, v0
    v_lshl_add_u32 v239, v239, 2, s40
    v_and_b32_e64 v238, 1, v172
    v_lshl_add_u32 v239, v239, 1, v238
    s_mul_i32 s40, s58, 17408
    s_add_u32 s40, s40, 52224
    v_lshl_add_u32 v236, v172, 3, s40
    v_lshl_add_u32 v237, v173, 4, s40
    s_movk_i32 s40, 288
    v_mad_u32_u24 v236, v173, s40, v236
    s_movk_i32 s40, 144
    v_mad_u32_u24 v237, v172, s40, v237
    v_lshlrev_b32_e64 v173, 4, v173
    v_lshl_add_u32 v35, v172, 14, v173
    v_lshl_add_u32 v238, v172, 11, v173
    s_and_b32 s40, s58, 1
    s_lshl_b32 s37, s9, 1
    s_add_u32 s37, s37, s40
    s_lshl_b32 s41, s41, 5
    s_add_u32 s41, s41, s8
    s_lshl_b32 s36, s37, 18
    s_lshl_b32 s40, s41, 7
    s_add_u32 s36, s36, s40
    s_add_u32 s36, s36, 3145728
    s_lshl_b32 s38, s41, 15
    s_lshl_b32 s37, s37, 7
    s_add_u32 s38, s38, s37
    s_add_u32 s39, s38, 0x4000
    s_add_u32 s37, s36, 0x20000
    s_lshl_b32 s40, s9, 5
    s_lshr_b32 s8, s8, 3
    s_add_u32 s40, s40, s8
    s_lshl_b32 s40, s40, 7
    s_add_u32 s40, s40, 983552
    s_mov_b32 s41, 0
    s_sub_u32 s42, s40, 512
    s_mul_i32 s8, s58, 17408
    s_add_u32 s8, s8, 52224
    s_mul_i32 s10, s58, 4608
    s_add_u32 s10, s10, 121856
    s_mul_i32 s11, s58, 8704
    s_add_u32 s11, s11, 17408
    s_movk_i32 s9, 544
    s_sub_u32 m0, s8, 48064
    v_lshl_add_u32 v15, v0, 3, s10
    v_and_b32 v16, 15, v0
    v_lshrrev_b32 v17, 4, v0
    v_lshlrev_b32 v18, 4, v17
    v_mad_u32_u24 v12, v16, s9, v18
    v_add_u32 v14, s11, v12
    v_add_u32 v12, s8, v12
    v_add_u32 v11, s8, v18
    v_cmp_gt_u32 vcc, 3, v16
    s_nop 0
    s_nop 0
    v_cndmask_b32 v19, 12, 4, vcc
    v_cmp_eq_u32 vcc, 3, v16
    s_nop 1
    v_cndmask_b32 v19, v19, 28, vcc
    v_mad_u32_u24 v13, v19, s9, v12
    v_and_b32_e64 v20, 3, v16
    s_sub_u32 s11, s11, 17408
    s_lshl_b32 s4, s58, 2
    v_mov_b32 v4, s4
    v_mov_b32 v5, 1
    v_lshlrev_b32 v6, 2, v20
    s_movk_i32 s9, 2368
    v_lshrrev_b32 v18, 2, v0
    v_lshl_add_u32 v19, v20, 3, s8
    v_mad_u32_u24 v200, v18, s9, v19
    s_movk_i32 s4, 160
    v_mad_u32_u24 v202, v18, s4, v19
    v_lshrrev_b32 v18, 3, v0
    v_and_b32_e64 v19, 7, v0
    v_lshl_add_u32 v19, v19, 3, s8
    v_mad_u32_u24 v201, v18, s9, v19
    v_lshrrev_b32 v18, 5, v0
    v_lshlrev_b32 v18, 8, v18
    v_lshl_add_u32 v18, v16, 4, v18
    v_add_u32 v18, s8, v18
    v_and_b32 v19, 1, v17
    v_lshl_add_u32 v203, v19, 3, v18
    v_lshlrev_b32 v46, 5, v19
    v_and_b32 v18, 1, v16
    s_movk_i32 s4, 640
    v_mul_u32_u24 v18, s4, v18
    v_lshl_add_u32 v46, v18, 1, v46
    v_lshl_add_u32 v18, v17, 5, v18
    v_and_b32_e64 v19, 14, v16
    v_add3_u32 v47, v18, v19, s8
    v_add3_u32 v46, v46, v19, s8
    v_lshrrev_b32_e64 v18, 5, v0
    v_lshl_add_u32 v46, v18, 4, v46
    v_mov_b32 v234, 0
    v_mov_b32 v235, 0
    v_lshlrev_b32 v7, 4, v17
    v_lshlrev_b32 v18, 5, v16
    v_sub_u32_e64 v7, v7, v18
    s_add_u32 s4, s10, 480
    v_add_u32 v7, s4, v7
    s_lshl_b32 s4, s58, 13
    s_add_u32 s4, s4, 17408
    v_lshlrev_b32_e64 v18, 6, v16
    v_bfe_u32 v22, v16, 1, 2
    v_xor_b32_e64 v22, v22, v17
    v_lshl_add_u32 v18, v22, 4, v18
    v_add_u32 v8, s4, v18
    v_sub_u32 v22, 20, v16
    v_lshlrev_b32_e64 v23, 3, v17
    v_mov_b32 v24, 0x7f
    v_lshlrev_b32 v24, v22, v24
    v_subrev_u32 v22, 1, v22
    v_mov_b32 v25, 0x1ff
    v_lshlrev_b32 v25, v22, v25
    v_lshrrev_b32 v24, v23, v24
    v_lshrrev_b32 v25, v23, v25
    v_add_u32 v18, 1, v16
    v_and_b32 v22, 3, v18
    v_and_b32 v18, 28, v18
    v_lshl_add_u32 v26, v17, 3, v18
    v_lshl_add_u32 v26, v26, 1, s8
    v_mad_u32_u24 v1, v22, s9, v26
    v_lshlrev_b32 v26, 2, v17
    v_sub_u32 v18, v18, v26
    v_lshl_add_u32 v18, v18, 1, s8
    s_movk_i32 s4, 160
    v_mad_u32_u24 v2, v22, s4, v18
    s_mov_b32 s15, 0x3f800000
    v_sub_u32_e64 v22, 18, v16
    v_lshlrev_b32 v26, v22, 7
    v_add_u32_e64 v22, 3, v22
    v_lshlrev_b32 v27, v22, 31
    v_and_b32 v24, 0xff, v24
    v_and_b32 v25, 0xff, v25
    v_bfe_u32 v26, v26, v23, 8
    v_bfe_u32 v27, v27, v23, 8
    v_lshl_or_b32 v24, v24, 15, v24
    v_lshl_or_b32 v25, v25, 15, v25
    v_lshl_or_b32 v26, v26, 15, v26
    v_lshl_or_b32 v27, v27, 15, v27
    v_and_b32 v244, 0x10001, v24
    v_and_b32 v248, 0x10001, v25
    v_and_b32 v240, 0x10001, v26
    v_and_b32 v252, 0x10001, v27
    v_mul_u32_u24 v244, 0x3f80, v244
    v_mul_u32_u24 v248, 0x3f80, v248
    v_mul_u32_u24 v240, 0x3f80, v240
    v_mul_u32_u24 v252, 0x3f80, v252
    v_and_b32 v245, 0x40004, v24
    v_and_b32 v249, 0x40004, v25
    v_and_b32 v241, 0x40004, v26
    v_and_b32 v253, 0x40004, v27
    v_mul_u32_u24 v245, 0xfe0, v245
    v_mul_u32_u24 v249, 0xfe0, v249
    v_mul_u32_u24 v241, 0xfe0, v241
    v_mul_u32_u24 v253, 0xfe0, v253
    v_and_b32 v246, 0x100010, v24
    v_and_b32 v250, 0x100010, v25
    v_and_b32 v242, 0x100010, v26
    v_and_b32 v254, 0x100010, v27
    v_mul_u32_u24 v246, 0x3f8, v246
    v_mul_u32_u24 v250, 0x3f8, v250
    v_mul_u32_u24 v242, 0x3f8, v242
    v_mul_u32_u24 v254, 0x3f8, v254
    v_and_b32 v247, 0x400040, v24
    v_and_b32 v251, 0x400040, v25
    v_and_b32 v243, 0x400040, v26
    v_and_b32 v255, 0x400040, v27
    v_mul_u32_u24 v247, 0xfe, v247
    v_mul_u32_u24 v251, 0xfe, v251
    v_mul_u32_u24 v243, 0xfe, v243
    v_mul_u32_u24 v255, 0xfe, v255
    v_lshlrev_b32 v33, 4, v10
    v_lshlrev_b32 v32, 2, v10
    v_sub_u32 v32, 122876, v32
    s_mov_b32 s31, s59
    s_lshl_b32 s13, s57, 14
    s_add_u32 s13, s13, 3145728
    s_and_b32 s12, s2, 7
    s_lshl_b32 s12, s12, 12
    s_lshl_b32 s4, s58, 7
    s_add_u32 s12, s12, s4
    s_lshr_b32 s4, s2, 3
    s_lshl_b32 s4, s4, 2
    s_add_u32 s12, s12, s4
    s_add_u32 s12, s12, 983040
    v_and_b32 v9, 0x30, v10
    v_lshlrev_b32 v10, 3, v10
    v_xor_b32 v9, v9, v10
    v_add_u32 v9, 17408, v9
    s_mov_b32 s30, 0
    s_brev_b32 s68, 1
    s_mov_b32 s32, s13
    s_add_u32 s33, s13, 0x1000
    s_add_u32 s34, s13, 0x2000
    s_add_u32 s35, s13, 0x3000
    s_waitcnt lgkmcnt(0)
    s_lshl_b32 s4, s58, 4
    s_lshr_b64 s[6:7], s[64:65], s4
    s_lshl_b32 s6, s6, 16
    v_mov_b32 v228, s6
    v_mul_f32 v228, 0x3fb8aa3b, v228
    v_exp_f32 v228, v228
    s_nop 0
    v_cvt_pk_bf16_f32 v228, v228, v228
    v_and_b32 v228, 0xffff0000, v228
    s_lshl_b32 s4, s58, 12
    v_lshl_add_u32 v18, v0, 7, s4
    s_waitcnt vmcnt(0)
    s_mov_b32 exec_hi, 0
    buffer_load_dword v229, v18, s[44:47], s13 offen
    s_mov_b32 exec_hi, -1
    v_lshlrev_b32_e64 v48, 16, v224
    v_and_b32 v49, 0xffff0000, v224
    v_lshlrev_b32_e64 v50, 16, v225
    v_and_b32 v51, 0xffff0000, v225
    v_mul_f32 v48, 0x3fb8aa3b, v48
    v_mul_f32 v49, 0x3fb8aa3b, v49
    v_exp_f32 v48, v48
    v_exp_f32 v49, v49
    v_mul_f32 v50, v50, v228
    v_mul_f32 v51, v51, v228
    v_mul_f32 v232, 0x3e22f983, v50
    v_mul_f32 v233, 0x3e22f983, v51
    v_cvt_pk_bf16_f32 v50, v48, v49
    v_lshlrev_b32_e64 v48, 16, v50
    v_and_b32 v49, 0xffff0000, v50
    v_mul_f32 v48, v48, v228
    v_mul_f32 v49, v49, v228
    v_mul_f32 v230, 0xbfb8aa3b, v48
    v_mul_f32 v231, 0xbfb8aa3b, v49
    v_add_f32_e64 v228, v228, v228
    v_mul_f32 v28, 0x42000000, v230
    v_mul_f32 v30, 0x42000000, v232
    v_mul_f32 v29, 0x42000000, v231
    v_mul_f32 v31, 0x42000000, v233
    v_exp_f32 v20, v230
    v_fract_f32 v22, v232
    v_exp_f32 v28, v28
    v_fract_f32 v30, v30
    v_exp_f32 v21, v231
    v_fract_f32 v23, v233
    v_exp_f32 v29, v29
    v_fract_f32 v31, v31
    v_cos_f32 v16, v22
    v_lshlrev_b32 v204, 16, v226
    v_sin_f32_e64 v17, v22
    v_and_b32 v206, 0xffff0000, v226
    v_cos_f32 v18, v23
    v_lshlrev_b32 v205, 16, v227
    v_sin_f32_e64 v19, v23
    v_and_b32 v207, 0xffff0000, v227
    v_cos_f32 v24, v30
    v_mul_f32 v204, v204, v228
    v_sin_f32 v25, v30
    v_mul_f32 v205, v205, v228
    v_cos_f32 v26, v31
    v_mul_f32 v206, v206, v228
    v_sin_f32 v27, v31
    v_mul_f32 v207, v207, v228
    v_mul_f32 v16, v16, v20
    v_mul_f32 v17, v17, v20
    v_mul_f32 v18, v18, v21
    v_mul_f32 v19, v19, v21
    v_mul_f32 v24, v24, v28
    v_mul_f32 v25, v25, v28
    v_mul_f32 v26, v26, v29
    v_mul_f32 v27, v27, v29
    v_mov_b32 v112, 0x3c00
    v_mov_b32 v113, 0x3c00
    v_pk_mul_f32 v[20:21], v[16:17], v[16:17] op_sel_hi:[1,0]
    v_pk_mul_f32 v[22:23], v[18:19], v[18:19] op_sel_hi:[1,0]
    v_pk_mul_f32 v[28:29], v[24:25], v[24:25] op_sel_hi:[1,0]
    v_pk_mul_f32 v[30:31], v[26:27], v[26:27] op_sel_hi:[1,0]
    v_cvt_pk_f16_f32 v114, v16, v17
    v_cvt_pk_f16_f32 v115, v18, v19
    v_cvt_pk_f16_f32 v40, v24, v25
    v_cvt_pk_f16_f32 v41, v26, v27
    v_pk_fma_f32 v[16:17], v[16:17], v[16:17], v[20:21] op_sel:[1,1,0] op_sel_hi:[0,1,1] neg_lo:[1,0,0]
    v_pk_fma_f32 v[18:19], v[18:19], v[18:19], v[22:23] op_sel:[1,1,0] op_sel_hi:[0,1,1] neg_lo:[1,0,0]
    v_pk_fma_f32 v[24:25], v[24:25], v[24:25], v[28:29] op_sel:[1,1,0] op_sel_hi:[0,1,1] neg_lo:[1,0,0]
    v_pk_fma_f32 v[26:27], v[26:27], v[26:27], v[30:31] op_sel:[1,1,0] op_sel_hi:[0,1,1] neg_lo:[1,0,0]
    v_pk_mul_f32 v[20:21], v[16:17], v[16:17] op_sel_hi:[1,0]
    v_pk_mul_f32 v[22:23], v[18:19], v[18:19] op_sel_hi:[1,0]
    v_pk_mul_f32 v[28:29], v[24:25], v[24:25] op_sel_hi:[1,0]
    v_pk_mul_f32 v[30:31], v[26:27], v[26:27] op_sel_hi:[1,0]
    v_cvt_pk_f16_f32 v116, v16, v17
    v_cvt_pk_f16_f32 v117, v18, v19
    v_cvt_pk_f16_f32 v42, v24, v25
    v_cvt_pk_f16_f32 v43, v26, v27
    v_pk_fma_f32 v[16:17], v[16:17], v[16:17], v[20:21] op_sel:[1,1,0] op_sel_hi:[0,1,1] neg_lo:[1,0,0]
    v_pk_fma_f32 v[18:19], v[18:19], v[18:19], v[22:23] op_sel:[1,1,0] op_sel_hi:[0,1,1] neg_lo:[1,0,0]
    v_pk_fma_f32 v[24:25], v[24:25], v[24:25], v[28:29] op_sel:[1,1,0] op_sel_hi:[0,1,1] neg_lo:[1,0,0]
    v_pk_fma_f32 v[26:27], v[26:27], v[26:27], v[30:31] op_sel:[1,1,0] op_sel_hi:[0,1,1] neg_lo:[1,0,0]
    v_cvt_pk_f16_f32 v80, v204, -v205
    v_cvt_pk_f16_f32 v81, v206, -v207
    v_pk_mul_f32 v[20:21], v[16:17], v[16:17] op_sel_hi:[1,0]
    v_pk_mul_f32 v[22:23], v[18:19], v[18:19] op_sel_hi:[1,0]
    v_pk_mul_f32 v[28:29], v[24:25], v[24:25] op_sel_hi:[1,0]
    v_pk_mul_f32 v[30:31], v[26:27], v[26:27] op_sel_hi:[1,0]
    v_cvt_pk_f16_f32 v120, v16, v17
    v_cvt_pk_f16_f32 v121, v18, v19
    v_cvt_pk_f16_f32 v44, v24, v25
    v_cvt_pk_f16_f32 v45, v26, v27
    v_pk_fma_f32 v[16:17], v[16:17], v[16:17], v[20:21] op_sel:[1,1,0] op_sel_hi:[0,1,1] neg_lo:[1,0,0]
    v_pk_fma_f32 v[18:19], v[18:19], v[18:19], v[22:23] op_sel:[1,1,0] op_sel_hi:[0,1,1] neg_lo:[1,0,0]
    v_pk_fma_f32 v[24:25], v[24:25], v[24:25], v[28:29] op_sel:[1,1,0] op_sel_hi:[0,1,1] neg_lo:[1,0,0]
    v_pk_fma_f32 v[26:27], v[26:27], v[26:27], v[30:31] op_sel:[1,1,0] op_sel_hi:[0,1,1] neg_lo:[1,0,0]
    v_pk_mul_f16 v118, v116, v114 op_sel_hi:[1,0]
    v_pk_mul_f16 v119, v117, v115 op_sel_hi:[1,0]
    v_pk_mul_f16 v122, v120, v114 op_sel_hi:[1,0]
    v_pk_mul_f16 v123, v121, v115 op_sel_hi:[1,0]
    v_pk_fma_f16 v118, v116, v114, v118 op_sel:[1,1,0] op_sel_hi:[0,1,1] neg_lo:[1,0,0]
    v_pk_fma_f16 v119, v117, v115, v119 op_sel:[1,1,0] op_sel_hi:[0,1,1] neg_lo:[1,0,0]
    v_pk_fma_f16 v122, v120, v114, v122 op_sel:[1,1,0] op_sel_hi:[0,1,1] neg_lo:[1,0,0]
    v_pk_fma_f16 v123, v121, v115, v123 op_sel:[1,1,0] op_sel_hi:[0,1,1] neg_lo:[1,0,0]
    v_pk_mul_f32 v[20:21], v[16:17], v[16:17] op_sel_hi:[1,0]
    v_pk_mul_f32 v[22:23], v[18:19], v[18:19] op_sel_hi:[1,0]
    v_cvt_pk_f16_f32 v128, v16, v17
    v_cvt_pk_f16_f32 v129, v18, v19
    v_cvt_pk_f16_f32 v134, v24, v25
    v_cvt_pk_f16_f32 v135, v26, v27
    v_pk_fma_f32 v[16:17], v[16:17], v[16:17], v[20:21] op_sel:[1,1,0] op_sel_hi:[0,1,1] neg_lo:[1,0,0]
    v_pk_fma_f32 v[18:19], v[18:19], v[18:19], v[22:23] op_sel:[1,1,0] op_sel_hi:[0,1,1] neg_lo:[1,0,0]
    ds_write_addtid_b32 v112 offset:48064
    ds_write_addtid_b32 v113 offset:48320
    ds_write_addtid_b32 v114 offset:48608
    ds_write_addtid_b32 v115 offset:48864
    ds_write_addtid_b32 v116 offset:49152
    ds_write_addtid_b32 v117 offset:49408
    ds_write_addtid_b32 v120 offset:50240
    ds_write_addtid_b32 v121 offset:50496
    ds_write_addtid_b32 v118 offset:49696
    ds_write_addtid_b32 v119 offset:49952
    ds_write_addtid_b32 v122 offset:50784
    ds_write_addtid_b32 v123 offset:51040
    ds_write_addtid_b32 v128 offset:56768
    ds_write_addtid_b32 v129 offset:57024
    ds_write_addtid_b32 v134 offset:52416
    ds_write_addtid_b32 v135 offset:52672
    ds_write_addtid_b32 v44 offset:63296
    ds_write_addtid_b32 v45 offset:63552
    v_pk_mul_f16 v124, v120, v116 op_sel_hi:[1,0]
    v_pk_mul_f16 v125, v121, v117 op_sel_hi:[1,0]
    v_pk_mul_f16 v126, v120, v118 op_sel_hi:[1,0]
    v_pk_mul_f16 v127, v121, v119 op_sel_hi:[1,0]
    v_pk_fma_f16 v124, v120, v116, v124 op_sel:[1,1,0] op_sel_hi:[0,1,1] neg_lo:[1,0,0]
    v_pk_fma_f16 v125, v121, v117, v125 op_sel:[1,1,0] op_sel_hi:[0,1,1] neg_lo:[1,0,0]
    v_pk_fma_f16 v126, v120, v118, v126 op_sel:[1,1,0] op_sel_hi:[0,1,1] neg_lo:[1,0,0]
    v_pk_fma_f16 v127, v121, v119, v127 op_sel:[1,1,0] op_sel_hi:[0,1,1] neg_lo:[1,0,0]
    v_pk_mul_f16 v132, v128, v116 op_sel_hi:[1,0]
    v_pk_mul_f16 v133, v129, v117 op_sel_hi:[1,0]
    v_pk_mul_f16 v136, v134, v116 op_sel_hi:[1,0]
    v_pk_mul_f16 v137, v135, v117 op_sel_hi:[1,0]
    v_pk_fma_f16 v132, v128, v116, v132 op_sel:[1,1,0] op_sel_hi:[0,1,1] neg_lo:[1,0,0]
    v_pk_fma_f16 v133, v129, v117, v133 op_sel:[1,1,0] op_sel_hi:[0,1,1] neg_lo:[1,0,0]
    v_pk_fma_f16 v136, v134, v116, v136 op_sel:[1,1,0] op_sel_hi:[0,1,1] neg_lo:[1,0,0]
    v_pk_fma_f16 v137, v135, v117, v137 op_sel:[1,1,0] op_sel_hi:[0,1,1] neg_lo:[1,0,0]
    v_pk_mul_f16 v138, v134, v120 op_sel_hi:[1,0]
    v_pk_mul_f16 v139, v135, v121 op_sel_hi:[1,0]
    v_pk_mul_f16 v140, v134, v124 op_sel_hi:[1,0]
    v_pk_mul_f16 v141, v135, v125 op_sel_hi:[1,0]
    v_pk_fma_f16 v138, v134, v120, v138 op_sel:[1,1,0] op_sel_hi:[0,1,1] neg_lo:[1,0,0]
    v_pk_fma_f16 v139, v135, v121, v139 op_sel:[1,1,0] op_sel_hi:[0,1,1] neg_lo:[1,0,0]
    v_pk_fma_f16 v140, v134, v124, v140 op_sel:[1,1,0] op_sel_hi:[0,1,1] neg_lo:[1,0,0]
    v_pk_fma_f16 v141, v135, v125, v141 op_sel:[1,1,0] op_sel_hi:[0,1,1] neg_lo:[1,0,0]
    v_pk_mul_f16 v142, v134, v128 op_sel_hi:[1,0]
    v_pk_mul_f16 v143, v135, v129 op_sel_hi:[1,0]
    v_pk_mul_f16 v144, v134, v132 op_sel_hi:[1,0]
    v_pk_mul_f16 v145, v135, v133 op_sel_hi:[1,0]
    v_pk_fma_f16 v142, v134, v128, v142 op_sel:[1,1,0] op_sel_hi:[0,1,1] neg_lo:[1,0,0]
    v_pk_fma_f16 v143, v135, v129, v143 op_sel:[1,1,0] op_sel_hi:[0,1,1] neg_lo:[1,0,0]
    v_pk_fma_f16 v144, v134, v132, v144 op_sel:[1,1,0] op_sel_hi:[0,1,1] neg_lo:[1,0,0]
    v_pk_fma_f16 v145, v135, v133, v145 op_sel:[1,1,0] op_sel_hi:[0,1,1] neg_lo:[1,0,0]
    ds_write_addtid_b32 v124 offset:51328
    ds_write_addtid_b32 v125 offset:51584
    ds_write_addtid_b32 v126 offset:51872
    ds_write_addtid_b32 v127 offset:52128
    ds_write_addtid_b32 v132 offset:57856
    ds_write_addtid_b32 v133 offset:58112
    ds_write_addtid_b32 v136 offset:52960
    ds_write_addtid_b32 v137 offset:53216
    ds_write_addtid_b32 v138 offset:53504
    ds_write_addtid_b32 v139 offset:53760
    ds_write_addtid_b32 v138 offset:54592
    ds_write_addtid_b32 v139 offset:54848
    ds_write_addtid_b32 v140 offset:54048
    ds_write_addtid_b32 v141 offset:54304
    ds_write_addtid_b32 v140 offset:55136
    ds_write_addtid_b32 v141 offset:55392
    ds_write_addtid_b32 v142 offset:55680
    ds_write_addtid_b32 v143 offset:55936
    ds_write_addtid_b32 v144 offset:56224
    ds_write_addtid_b32 v145 offset:56480
    ds_read_b128 v[168:171], v12 offset:0
    ds_read_b128 v[172:175], v12 offset:64
    ds_read_b128 v[176:179], v12 offset:128
    ds_read_b128 v[180:183], v12 offset:192
    ds_read_b128 v[184:187], v12 offset:256
    ds_read_b128 v[188:191], v12 offset:320
    ds_read_b128 v[192:195], v12 offset:384
    ds_read_b128 v[196:199], v12 offset:448
    s_mov_b32 m0, s11
    s_nop 0
    v_cvt_pk_f16_f32 v38, v16, v17
    v_cvt_pk_f16_f32 v39, v18, v19
    v_pk_mul_f16 v82, v80, v128 op_sel_hi:[1,0]
    v_pk_mul_f16 v83, v81, v129 op_sel_hi:[1,0]
    v_pk_mul_f16 v88, v80, v40 op_sel_hi:[1,0]
    v_pk_mul_f16 v89, v81, v41 op_sel_hi:[1,0]
    v_pk_fma_f16 v82, v80, v128, v82 op_sel:[1,1,0] op_sel_hi:[0,1,1] neg_hi:[1,0,0]
    v_pk_fma_f16 v83, v81, v129, v83 op_sel:[1,1,0] op_sel_hi:[0,1,1] neg_hi:[1,0,0]
    v_pk_fma_f16 v88, v80, v40, v88 op_sel:[1,1,0] op_sel_hi:[0,1,1] neg_hi:[1,0,0]
    v_pk_fma_f16 v89, v81, v41, v89 op_sel:[1,1,0] op_sel_hi:[0,1,1] neg_hi:[1,0,0]
    v_pk_mul_f16 v84, v80, v38 op_sel_hi:[1,0]
    v_pk_mul_f16 v85, v81, v39 op_sel_hi:[1,0]
    v_pk_mul_f16 v86, v82, v38 op_sel_hi:[1,0]
    v_pk_mul_f16 v87, v83, v39 op_sel_hi:[1,0]
    v_pk_fma_f16 v84, v80, v38, v84 op_sel:[1,1,0] op_sel_hi:[0,1,1] neg_hi:[1,0,0]
    v_pk_fma_f16 v85, v81, v39, v85 op_sel:[1,1,0] op_sel_hi:[0,1,1] neg_hi:[1,0,0]
    v_pk_fma_f16 v86, v82, v38, v86 op_sel:[1,1,0] op_sel_hi:[0,1,1] neg_hi:[1,0,0]
    v_pk_fma_f16 v87, v83, v39, v87 op_sel:[1,1,0] op_sel_hi:[0,1,1] neg_hi:[1,0,0]
    v_pk_mul_f16 v90, v82, v40 op_sel_hi:[1,0]
    v_pk_mul_f16 v91, v83, v41 op_sel_hi:[1,0]
    v_pk_mul_f16 v96, v80, v42 op_sel_hi:[1,0]
    v_pk_mul_f16 v97, v81, v43 op_sel_hi:[1,0]
    v_pk_fma_f16 v90, v82, v40, v90 op_sel:[1,1,0] op_sel_hi:[0,1,1] neg_hi:[1,0,0]
    v_pk_fma_f16 v91, v83, v41, v91 op_sel:[1,1,0] op_sel_hi:[0,1,1] neg_hi:[1,0,0]
    v_pk_fma_f16 v96, v80, v42, v96 op_sel:[1,1,0] op_sel_hi:[0,1,1] neg_hi:[1,0,0]
    v_pk_fma_f16 v97, v81, v43, v97 op_sel:[1,1,0] op_sel_hi:[0,1,1] neg_hi:[1,0,0]
    v_pk_mul_f16 v92, v84, v40 op_sel_hi:[1,0]
    v_pk_mul_f16 v93, v85, v41 op_sel_hi:[1,0]
    v_pk_mul_f16 v94, v86, v40 op_sel_hi:[1,0]
    v_pk_mul_f16 v95, v87, v41 op_sel_hi:[1,0]
    v_pk_fma_f16 v92, v84, v40, v92 op_sel:[1,1,0] op_sel_hi:[0,1,1] neg_hi:[1,0,0]
    v_pk_fma_f16 v93, v85, v41, v93 op_sel:[1,1,0] op_sel_hi:[0,1,1] neg_hi:[1,0,0]
    v_pk_fma_f16 v94, v86, v40, v94 op_sel:[1,1,0] op_sel_hi:[0,1,1] neg_hi:[1,0,0]
    v_pk_fma_f16 v95, v87, v41, v95 op_sel:[1,1,0] op_sel_hi:[0,1,1] neg_hi:[1,0,0]
    ds_write_addtid_b32 v80 offset:17408
    ds_write_addtid_b32 v81 offset:17664
    ds_write_addtid_b32 v82 offset:17952
    ds_write_addtid_b32 v83 offset:18208
    ds_write_addtid_b32 v84 offset:18496
    ds_write_addtid_b32 v85 offset:18752
    ds_write_addtid_b32 v86 offset:19040
    ds_write_addtid_b32 v87 offset:19296
    ds_write_addtid_b32 v88 offset:19584
    ds_write_addtid_b32 v89 offset:19840
    ds_write_addtid_b32 v90 offset:20128
    ds_write_addtid_b32 v91 offset:20384
    ds_write_addtid_b32 v92 offset:20672
    ds_write_addtid_b32 v93 offset:20928
    ds_write_addtid_b32 v94 offset:21216
    ds_write_addtid_b32 v95 offset:21472
    ds_write_addtid_b32 v96 offset:21760
    ds_write_addtid_b32 v97 offset:22016
    v_pk_mul_f16 v98, v82, v42 op_sel_hi:[1,0]
    v_pk_mul_f16 v99, v83, v43 op_sel_hi:[1,0]
    v_pk_mul_f16 v104, v88, v42 op_sel_hi:[1,0]
    v_pk_mul_f16 v105, v89, v43 op_sel_hi:[1,0]
    v_pk_fma_f16 v98, v82, v42, v98 op_sel:[1,1,0] op_sel_hi:[0,1,1] neg_hi:[1,0,0]
    v_pk_fma_f16 v99, v83, v43, v99 op_sel:[1,1,0] op_sel_hi:[0,1,1] neg_hi:[1,0,0]
    v_pk_fma_f16 v104, v88, v42, v104 op_sel:[1,1,0] op_sel_hi:[0,1,1] neg_hi:[1,0,0]
    v_pk_fma_f16 v105, v89, v43, v105 op_sel:[1,1,0] op_sel_hi:[0,1,1] neg_hi:[1,0,0]
    v_pk_mul_f16 v100, v84, v42 op_sel_hi:[1,0]
    v_pk_mul_f16 v101, v85, v43 op_sel_hi:[1,0]
    v_pk_mul_f16 v102, v86, v42 op_sel_hi:[1,0]
    v_pk_mul_f16 v103, v87, v43 op_sel_hi:[1,0]
    v_pk_fma_f16 v100, v84, v42, v100 op_sel:[1,1,0] op_sel_hi:[0,1,1] neg_hi:[1,0,0]
    v_pk_fma_f16 v101, v85, v43, v101 op_sel:[1,1,0] op_sel_hi:[0,1,1] neg_hi:[1,0,0]
    v_pk_fma_f16 v102, v86, v42, v102 op_sel:[1,1,0] op_sel_hi:[0,1,1] neg_hi:[1,0,0]
    v_pk_fma_f16 v103, v87, v43, v103 op_sel:[1,1,0] op_sel_hi:[0,1,1] neg_hi:[1,0,0]
    v_pk_mul_f16 v106, v90, v42 op_sel_hi:[1,0]
    v_pk_mul_f16 v107, v91, v43 op_sel_hi:[1,0]
    v_pk_mul_f16 v108, v92, v42 op_sel_hi:[1,0]
    v_pk_mul_f16 v109, v93, v43 op_sel_hi:[1,0]
    v_pk_fma_f16 v106, v90, v42, v106 op_sel:[1,1,0] op_sel_hi:[0,1,1] neg_hi:[1,0,0]
    v_pk_fma_f16 v107, v91, v43, v107 op_sel:[1,1,0] op_sel_hi:[0,1,1] neg_hi:[1,0,0]
    v_pk_fma_f16 v108, v92, v42, v108 op_sel:[1,1,0] op_sel_hi:[0,1,1] neg_hi:[1,0,0]
    v_pk_fma_f16 v109, v93, v43, v109 op_sel:[1,1,0] op_sel_hi:[0,1,1] neg_hi:[1,0,0]
    v_pk_mul_f16 v110, v94, v42 op_sel_hi:[1,0]
    v_pk_mul_f16 v111, v95, v43 op_sel_hi:[1,0]
    v_pk_mul_f16 v130, v128, v114 op_sel_hi:[1,0]
    v_pk_mul_f16 v131, v129, v115 op_sel_hi:[1,0]
    v_pk_fma_f16 v110, v94, v42, v110 op_sel:[1,1,0] op_sel_hi:[0,1,1] neg_hi:[1,0,0]
    v_pk_fma_f16 v111, v95, v43, v111 op_sel:[1,1,0] op_sel_hi:[0,1,1] neg_hi:[1,0,0]
    v_pk_fma_f16 v130, v128, v114, v130 op_sel:[1,1,0] op_sel_hi:[0,1,1] neg_lo:[1,0,0]
    v_pk_fma_f16 v131, v129, v115, v131 op_sel:[1,1,0] op_sel_hi:[0,1,1] neg_lo:[1,0,0]
    ds_write_addtid_b32 v98 offset:22304
    ds_write_addtid_b32 v99 offset:22560
    ds_write_addtid_b32 v100 offset:22848
    ds_write_addtid_b32 v101 offset:23104
    ds_write_addtid_b32 v102 offset:23392
    ds_write_addtid_b32 v103 offset:23648
    ds_write_addtid_b32 v104 offset:23936
    ds_write_addtid_b32 v105 offset:24192
    ds_write_addtid_b32 v106 offset:24480
    ds_write_addtid_b32 v107 offset:24736
    ds_write_addtid_b32 v108 offset:25024
    ds_write_addtid_b32 v109 offset:25280
    ds_write_addtid_b32 v110 offset:25568
    ds_write_addtid_b32 v111 offset:25824
    ds_read_b128 v[48:51], v14 offset:0
    ds_read_b128 v[52:55], v14 offset:64
    ds_read_b128 v[56:59], v14 offset:128
    ds_read_b128 v[60:63], v14 offset:192
    ds_read_b128 v[64:67], v14 offset:256
    ds_read_b128 v[68:71], v14 offset:320
    ds_read_b128 v[72:75], v14 offset:384
    ds_read_b128 v[76:79], v14 offset:448
    ds_read_b128 v[80:83], v11 offset:15232
    ds_read_b128 v[84:87], v11 offset:15296
    ds_read_b128 v[88:91], v11 offset:15360
    ds_read_b128 v[92:95], v11 offset:15424
    ds_read_b128 v[96:99], v11 offset:15488
    ds_read_b128 v[100:103], v11 offset:15552
    ds_read_b128 v[104:107], v11 offset:15616
    ds_read_b128 v[108:111], v11 offset:15680
    s_sub_u32 m0, s8, 48064
    v_pk_mul_f32 v[28:29], v[24:25], v[24:25] op_sel_hi:[1,0]
    v_pk_mul_f32 v[30:31], v[26:27], v[26:27] op_sel_hi:[1,0]
    v_pk_fma_f32 v[24:25], v[24:25], v[24:25], v[28:29] op_sel:[1,1,0] op_sel_hi:[0,1,1] neg_lo:[1,0,0]
    v_pk_fma_f32 v[26:27], v[26:27], v[26:27], v[30:31] op_sel:[1,1,0] op_sel_hi:[0,1,1] neg_lo:[1,0,0]
    v_cvt_pk_f16_f32 v146, v24, v25
    v_cvt_pk_f16_f32 v147, v26, v27
    v_pk_mul_f32 v[28:29], v[24:25], v[24:25] op_sel_hi:[1,0]
    v_pk_mul_f32 v[30:31], v[26:27], v[26:27] op_sel_hi:[1,0]
    v_pk_fma_f32 v[24:25], v[24:25], v[24:25], v[28:29] op_sel:[1,1,0] op_sel_hi:[0,1,1] neg_lo:[1,0,0]
    v_pk_fma_f32 v[26:27], v[26:27], v[26:27], v[30:31] op_sel:[1,1,0] op_sel_hi:[0,1,1] neg_lo:[1,0,0]
    v_cvt_pk_f16_f32 v166, v24, v25
    v_cvt_pk_f16_f32 v167, v26, v27
    s_waitcnt lgkmcnt(8)
    s_nop 0
    v_mfma_f32_16x16x32_f16 v[204:207], v[168:171], v[48:51], 0
    v_pk_mul_f16 v152, v146, v134 op_sel_hi:[1,0]
    v_pk_mul_f16 v153, v147, v135 op_sel_hi:[1,0]
    v_pk_mul_f16 v148, v146, v120 op_sel_hi:[1,0]
    v_pk_mul_f16 v149, v147, v121 op_sel_hi:[1,0]
    v_mfma_f32_16x16x32_f16 v[204:207], v[172:175], v[52:55], v[204:207]
    v_pk_fma_f16 v152, v146, v134, v152 op_sel:[1,1,0] op_sel_hi:[0,1,1] neg_lo:[1,0,0]
    v_pk_fma_f16 v153, v147, v135, v153 op_sel:[1,1,0] op_sel_hi:[0,1,1] neg_lo:[1,0,0]
    v_pk_fma_f16 v148, v146, v120, v148 op_sel:[1,1,0] op_sel_hi:[0,1,1] neg_lo:[1,0,0]
    v_pk_fma_f16 v149, v147, v121, v149 op_sel:[1,1,0] op_sel_hi:[0,1,1] neg_lo:[1,0,0]
    v_mfma_f32_16x16x32_f16 v[204:207], v[176:179], v[56:59], v[204:207]
    v_pk_mul_f16 v150, v146, v128 op_sel_hi:[1,0]
    v_pk_mul_f16 v151, v147, v129 op_sel_hi:[1,0]
    v_pk_mul_f16 v158, v128, v166 op_sel_hi:[1,0]
    v_pk_mul_f16 v159, v129, v167 op_sel_hi:[1,0]
    v_mfma_f32_16x16x32_f16 v[204:207], v[180:183], v[60:63], v[204:207]
    v_pk_fma_f16 v150, v146, v128, v150 op_sel:[1,1,0] op_sel_hi:[0,1,1] neg_lo:[1,0,0]
    v_pk_fma_f16 v151, v147, v129, v151 op_sel:[1,1,0] op_sel_hi:[0,1,1] neg_lo:[1,0,0]
    v_pk_fma_f16 v158, v128, v166, v158 op_sel:[1,1,0] op_sel_hi:[0,1,1] neg_lo:[1,0,0]
    v_pk_fma_f16 v159, v129, v167, v159 op_sel:[1,1,0] op_sel_hi:[0,1,1] neg_lo:[1,0,0]
    v_mfma_f32_16x16x32_f16 v[204:207], v[184:187], v[64:67], v[204:207]
    v_pk_mul_f16 v154, v152, v120 op_sel_hi:[1,0]
    v_pk_mul_f16 v155, v153, v121 op_sel_hi:[1,0]
    v_pk_mul_f16 v156, v152, v128 op_sel_hi:[1,0]
    v_pk_mul_f16 v157, v153, v129 op_sel_hi:[1,0]
    v_mfma_f32_16x16x32_f16 v[204:207], v[188:191], v[68:71], v[204:207]
    v_pk_fma_f16 v154, v152, v120, v154 op_sel:[1,1,0] op_sel_hi:[0,1,1] neg_lo:[1,0,0]
    v_pk_fma_f16 v155, v153, v121, v155 op_sel:[1,1,0] op_sel_hi:[0,1,1] neg_lo:[1,0,0]
    v_pk_fma_f16 v156, v152, v128, v156 op_sel:[1,1,0] op_sel_hi:[0,1,1] neg_lo:[1,0,0]
    v_pk_fma_f16 v157, v153, v129, v157 op_sel:[1,1,0] op_sel_hi:[0,1,1] neg_lo:[1,0,0]
    v_mfma_f32_16x16x32_f16 v[204:207], v[192:195], v[72:75], v[204:207]
    v_pk_mul_f16 v160, v142, v166 op_sel_hi:[1,0]
    v_pk_mul_f16 v161, v143, v167 op_sel_hi:[1,0]
    v_pk_mul_f16 v162, v150, v166 op_sel_hi:[1,0]
    v_pk_mul_f16 v163, v151, v167 op_sel_hi:[1,0]
    v_mfma_f32_16x16x32_f16 v[204:207], v[196:199], v[76:79], v[204:207]
    v_pk_fma_f16 v160, v142, v166, v160 op_sel:[1,1,0] op_sel_hi:[0,1,1] neg_lo:[1,0,0]
    v_pk_fma_f16 v161, v143, v167, v161 op_sel:[1,1,0] op_sel_hi:[0,1,1] neg_lo:[1,0,0]
    v_pk_fma_f16 v162, v150, v166, v162 op_sel:[1,1,0] op_sel_hi:[0,1,1] neg_lo:[1,0,0]
    v_pk_fma_f16 v163, v151, v167, v163 op_sel:[1,1,0] op_sel_hi:[0,1,1] neg_lo:[1,0,0]
    v_pk_mul_f16 v164, v156, v166 op_sel_hi:[1,0]
    v_pk_mul_f16 v165, v157, v167 op_sel_hi:[1,0]
    v_pk_fma_f16 v164, v156, v166, v164 op_sel:[1,1,0] op_sel_hi:[0,1,1] neg_lo:[1,0,0]
    v_pk_fma_f16 v165, v157, v167, v165 op_sel:[1,1,0] op_sel_hi:[0,1,1] neg_lo:[1,0,0]
    ds_write_addtid_b32 v130 offset:57312
    ds_write_addtid_b32 v131 offset:57568
    ds_write_addtid_b32 v146 offset:58944
    ds_write_addtid_b32 v147 offset:59200
    ds_write_addtid_b32 v152 offset:61120
    ds_write_addtid_b32 v153 offset:61376
    ds_write_addtid_b32 v148 offset:59488
    ds_write_addtid_b32 v149 offset:59744
    ds_write_addtid_b32 v150 offset:60032
    ds_write_addtid_b32 v151 offset:60288
    ds_write_addtid_b32 v158 offset:64928
    ds_write_addtid_b32 v159 offset:65184
    ds_write_addtid_b32 v154 offset:61664
    ds_write_addtid_b32 v155 offset:61920
    ds_write_addtid_b32 v156 offset:62208
    ds_write_addtid_b32 v157 offset:62464
    ds_write_addtid_b32 v160 offset:58400
    ds_write_addtid_b32 v161 offset:58656
    ds_write_addtid_b32 v162 offset:60576
    ds_write_addtid_b32 v163 offset:60832
    ds_write_addtid_b32 v164 offset:62752
    ds_write_addtid_b32 v165 offset:63008
    ds_read_b128 v[112:115], v13 offset:0
    ds_read_b128 v[116:119], v13 offset:64
    ds_read_b128 v[120:123], v13 offset:128
    ds_read_b128 v[124:127], v13 offset:192
    ds_read_b128 v[128:131], v13 offset:256
    ds_read_b128 v[132:135], v13 offset:320
    ds_read_b128 v[136:139], v13 offset:384
    ds_read_b128 v[140:143], v13 offset:448
    s_mov_b64 exec, 0xffff
    ds_write_b64 v200, v[234:235]
    s_mov_b32 exec_lo, -1
    ds_write2_b64 v201, v[234:235], v[234:235] offset0:132 offset1:140
    ds_write_b64 v202, v[234:235] offset:9472
    s_mov_b64 exec, -1
    ds_write_b64 v202, v[234:235] offset:10752
    ds_write_b64 v202, v[234:235] offset:10816
    ds_write_b64 v202, v[234:235] offset:10848
    ds_read_b32 v34, v6 offset:128
    s_buffer_load_dwordx8 s[16:23], s[44:47], s31
L_XI1:
    v_pk_mul_f16 v220, v48, v80 op_sel_hi:[1,0]
    v_pk_mul_f16 v221, v49, v81 op_sel_hi:[1,0]
    v_pk_mul_f16 v222, v50, v82 op_sel_hi:[1,0]
    v_pk_mul_f16 v223, v51, v83 op_sel_hi:[1,0]
    v_pk_fma_f16 v80, v48, v80, v220 op_sel:[1,1,0] op_sel_hi:[0,1,1] neg_hi:[1,0,0]
    v_pk_fma_f16 v81, v49, v81, v221 op_sel:[1,1,0] op_sel_hi:[0,1,1] neg_hi:[1,0,0]
    v_pk_fma_f16 v82, v50, v82, v222 op_sel:[1,1,0] op_sel_hi:[0,1,1] neg_hi:[1,0,0]
    v_pk_fma_f16 v83, v51, v83, v223 op_sel:[1,1,0] op_sel_hi:[0,1,1] neg_hi:[1,0,0]
    v_pk_mul_f16 v220, v52, v84 op_sel_hi:[1,0]
    v_pk_mul_f16 v221, v53, v85 op_sel_hi:[1,0]
    v_mfma_f32_16x16x32_f16 v[208:211], v[168:171], v[80:83], 0
    v_pk_mul_f16 v222, v54, v86 op_sel_hi:[1,0]
    v_pk_mul_f16 v223, v55, v87 op_sel_hi:[1,0]
    v_pk_fma_f16 v84, v52, v84, v220 op_sel:[1,1,0] op_sel_hi:[0,1,1] neg_hi:[1,0,0]
    v_pk_fma_f16 v85, v53, v85, v221 op_sel:[1,1,0] op_sel_hi:[0,1,1] neg_hi:[1,0,0]
    v_pk_fma_f16 v86, v54, v86, v222 op_sel:[1,1,0] op_sel_hi:[0,1,1] neg_hi:[1,0,0]
    v_pk_fma_f16 v87, v55, v87, v223 op_sel:[1,1,0] op_sel_hi:[0,1,1] neg_hi:[1,0,0]
    s_waitcnt lgkmcnt(12)
    s_nop 0
    v_pk_mul_f16 v220, v56, v88 op_sel_hi:[1,0]
    v_pk_mul_f16 v221, v57, v89 op_sel_hi:[1,0]
    v_mfma_f32_16x16x32_f16 v[208:211], v[172:175], v[84:87], v[208:211]
    v_pk_mul_f16 v222, v58, v90 op_sel_hi:[1,0]
    v_pk_mul_f16 v223, v59, v91 op_sel_hi:[1,0]
    v_pk_fma_f16 v88, v56, v88, v220 op_sel:[1,1,0] op_sel_hi:[0,1,1] neg_hi:[1,0,0]
    v_mfma_f32_16x16x32_f16 v[212:215], v[112:115], v[48:51], 0
    v_pk_fma_f16 v89, v57, v89, v221 op_sel:[1,1,0] op_sel_hi:[0,1,1] neg_hi:[1,0,0]
    v_pk_fma_f16 v90, v58, v90, v222 op_sel:[1,1,0] op_sel_hi:[0,1,1] neg_hi:[1,0,0]
    v_pk_fma_f16 v91, v59, v91, v223 op_sel:[1,1,0] op_sel_hi:[0,1,1] neg_hi:[1,0,0]
    v_mfma_f32_16x16x32_f16 v[216:219], v[112:115], v[80:83], 0
    v_pk_mul_f16 v220, v60, v92 op_sel_hi:[1,0]
    v_pk_mul_f16 v221, v61, v93 op_sel_hi:[1,0]
    v_mfma_f32_16x16x32_f16 v[208:211], v[176:179], v[88:91], v[208:211]
    v_pk_mul_f16 v222, v62, v94 op_sel_hi:[1,0]
    v_pk_mul_f16 v223, v63, v95 op_sel_hi:[1,0]
    v_pk_fma_f16 v92, v60, v92, v220 op_sel:[1,1,0] op_sel_hi:[0,1,1] neg_hi:[1,0,0]
    v_mfma_f32_16x16x32_f16 v[212:215], v[116:119], v[52:55], v[212:215]
    v_pk_fma_f16 v93, v61, v93, v221 op_sel:[1,1,0] op_sel_hi:[0,1,1] neg_hi:[1,0,0]
    v_pk_fma_f16 v94, v62, v94, v222 op_sel:[1,1,0] op_sel_hi:[0,1,1] neg_hi:[1,0,0]
    v_pk_fma_f16 v95, v63, v95, v223 op_sel:[1,1,0] op_sel_hi:[0,1,1] neg_hi:[1,0,0]
    v_mfma_f32_16x16x32_f16 v[216:219], v[116:119], v[84:87], v[216:219]
    s_waitcnt lgkmcnt(10)
    s_nop 0
    v_pk_mul_f16 v220, v64, v96 op_sel_hi:[1,0]
    v_pk_mul_f16 v221, v65, v97 op_sel_hi:[1,0]
    v_mfma_f32_16x16x32_f16 v[208:211], v[180:183], v[92:95], v[208:211]
    v_pk_mul_f16 v222, v66, v98 op_sel_hi:[1,0]
    v_pk_mul_f16 v223, v67, v99 op_sel_hi:[1,0]
    v_pk_fma_f16 v96, v64, v96, v220 op_sel:[1,1,0] op_sel_hi:[0,1,1] neg_hi:[1,0,0]
    v_mfma_f32_16x16x32_f16 v[212:215], v[120:123], v[56:59], v[212:215]
    v_pk_fma_f16 v97, v65, v97, v221 op_sel:[1,1,0] op_sel_hi:[0,1,1] neg_hi:[1,0,0]
    v_pk_fma_f16 v98, v66, v98, v222 op_sel:[1,1,0] op_sel_hi:[0,1,1] neg_hi:[1,0,0]
    v_pk_fma_f16 v99, v67, v99, v223 op_sel:[1,1,0] op_sel_hi:[0,1,1] neg_hi:[1,0,0]
    v_mfma_f32_16x16x32_f16 v[216:219], v[120:123], v[88:91], v[216:219]
    v_pk_mul_f16 v220, v68, v100 op_sel_hi:[1,0]
    v_pk_mul_f16 v221, v69, v101 op_sel_hi:[1,0]
    v_mfma_f32_16x16x32_f16 v[208:211], v[184:187], v[96:99], v[208:211]
    v_pk_mul_f16 v222, v70, v102 op_sel_hi:[1,0]
    v_pk_mul_f16 v223, v71, v103 op_sel_hi:[1,0]
    v_pk_fma_f16 v100, v68, v100, v220 op_sel:[1,1,0] op_sel_hi:[0,1,1] neg_hi:[1,0,0]
    v_mfma_f32_16x16x32_f16 v[212:215], v[124:127], v[60:63], v[212:215]
    v_pk_fma_f16 v101, v69, v101, v221 op_sel:[1,1,0] op_sel_hi:[0,1,1] neg_hi:[1,0,0]
    v_pk_fma_f16 v102, v70, v102, v222 op_sel:[1,1,0] op_sel_hi:[0,1,1] neg_hi:[1,0,0]
    v_pk_fma_f16 v103, v71, v103, v223 op_sel:[1,1,0] op_sel_hi:[0,1,1] neg_hi:[1,0,0]
    v_mfma_f32_16x16x32_f16 v[216:219], v[124:127], v[92:95], v[216:219]
    s_waitcnt lgkmcnt(8)
    s_nop 0
    v_pk_mul_f16 v220, v72, v104 op_sel_hi:[1,0]
    v_pk_mul_f16 v221, v73, v105 op_sel_hi:[1,0]
    v_mfma_f32_16x16x32_f16 v[208:211], v[188:191], v[100:103], v[208:211]
    v_pk_mul_f16 v222, v74, v106 op_sel_hi:[1,0]
    v_pk_mul_f16 v223, v75, v107 op_sel_hi:[1,0]
    v_pk_fma_f16 v104, v72, v104, v220 op_sel:[1,1,0] op_sel_hi:[0,1,1] neg_hi:[1,0,0]
    v_mfma_f32_16x16x32_f16 v[212:215], v[128:131], v[64:67], v[212:215]
    v_pk_fma_f16 v105, v73, v105, v221 op_sel:[1,1,0] op_sel_hi:[0,1,1] neg_hi:[1,0,0]
    v_pk_fma_f16 v106, v74, v106, v222 op_sel:[1,1,0] op_sel_hi:[0,1,1] neg_hi:[1,0,0]
    v_pk_fma_f16 v107, v75, v107, v223 op_sel:[1,1,0] op_sel_hi:[0,1,1] neg_hi:[1,0,0]
    v_mfma_f32_16x16x32_f16 v[216:219], v[128:131], v[96:99], v[216:219]
    v_pk_mul_f16 v220, v76, v108 op_sel_hi:[1,0]
    v_pk_mul_f16 v221, v77, v109 op_sel_hi:[1,0]
    v_mfma_f32_16x16x32_f16 v[208:211], v[192:195], v[104:107], v[208:211]
    v_pk_mul_f16 v222, v78, v110 op_sel_hi:[1,0]
    v_pk_mul_f16 v223, v79, v111 op_sel_hi:[1,0]
    v_pk_fma_f16 v108, v76, v108, v220 op_sel:[1,1,0] op_sel_hi:[0,1,1] neg_hi:[1,0,0]
    v_mfma_f32_16x16x32_f16 v[212:215], v[132:135], v[68:71], v[212:215]
    v_pk_fma_f16 v109, v77, v109, v221 op_sel:[1,1,0] op_sel_hi:[0,1,1] neg_hi:[1,0,0]
    v_pk_fma_f16 v110, v78, v110, v222 op_sel:[1,1,0] op_sel_hi:[0,1,1] neg_hi:[1,0,0]
    v_pk_fma_f16 v111, v79, v111, v223 op_sel:[1,1,0] op_sel_hi:[0,1,1] neg_hi:[1,0,0]
    v_mfma_f32_16x16x32_f16 v[216:219], v[132:135], v[100:103], v[216:219]
    s_waitcnt lgkmcnt(6)
    s_nop 0
    v_mfma_f32_16x16x32_f16 v[208:211], v[196:199], v[108:111], v[208:211]
    v_mfma_f32_16x16x32_f16 v[212:215], v[136:139], v[72:75], v[212:215]
    v_mfma_f32_16x16x32_f16 v[216:219], v[136:139], v[104:107], v[216:219]
    v_mfma_f32_16x16x32_f16 v[212:215], v[140:143], v[76:79], v[212:215]
    v_mfma_f32_16x16x32_f16 v[216:219], v[140:143], v[108:111], v[216:219]
    s_waitcnt lgkmcnt(0)
    v_readfirstlane_b32 s28, v34
    s_add_u32 s31, s31, 64
    s_mov_b32 s29, s28
    s_cmp_eq_u32 s28, 0
    s_cbranch_scc1 L_XE1
    s_xor_b64 s[16:17], s[16:17], s[28:29]
    s_xor_b64 s[18:19], s[18:19], s[28:29]
    s_xor_b64 s[20:21], s[20:21], s[28:29]
    s_xor_b64 s[22:23], s[22:23], s[28:29]
    s_or_b64 s[16:17], s[16:17], s[18:19]
    s_or_b64 s[20:21], s[20:21], s[22:23]
    s_or_b64 s[16:17], s[16:17], s[20:21]
    s_cbranch_scc1 L_XE1
    s_setprio 3
    buffer_load_dwordx4 v[16:19], v33, s[44:47], s32 offen sc1
    buffer_load_dwordx4 v[20:23], v33, s[44:47], s33 offen sc1
    buffer_load_dwordx4 v[24:27], v33, s[44:47], s34 offen sc1
    buffer_load_dwordx4 v[28:31], v33, s[44:47], s35 offen sc1
    s_mov_b64 exec, 1
    ds_write_b32 v4, v5 offset:544
    s_mov_b64 exec, -1
    s_setprio 2
    s_mov_b32 s30, 1
L_XE1:
    s_cmp_lg_u32 s30, 0
    s_cbranch_scc1 L_XI2
    ds_read_b32 v34, v6 offset:128
    s_buffer_load_dwordx8 s[16:23], s[44:47], s31
L_XI2:
    s_lshl_b32 s4, s58, 4
    s_lshr_b64 s[6:7], s[66:67], s4
    s_lshl_b32 s6, s6, 16
    v_permlane32_swap_b32 v204, v208
    v_permlane32_swap_b32 v205, v209
    v_permlane32_swap_b32 v206, v210
    v_permlane32_swap_b32 v207, v211
    v_cvt_pk_bf16_f32 v220, v215, v219
    s_mov_b64 exec, 1
    v_add_f32 v204, s6, v204
    v_add_f32_e64 v204, 1.0, v204
    s_mov_b64 exec, -1
    v_permlane32_swap_b32 v212, v216
    v_permlane32_swap_b32 v213, v217
    v_permlane32_swap_b32 v214, v218
    ds_write_b16 v47, v220 offset:9504
    ds_write_b16_d16_hi v47, v220 offset:9520
    ds_write_b16 v47, v220 offset:9662
    ds_write_b16_d16_hi v47, v220 offset:9678
    ds_write_b16 v47, v220 offset:9820
    ds_write_b16_d16_hi v47, v220 offset:9836
    ds_write_b16 v47, v220 offset:9978
    ds_write_b16_d16_hi v47, v220 offset:9994
    v_cvt_pk_bf16_f32 v48, v204, v205
    v_cvt_pk_bf16_f32 v49, v206, v207
    v_cvt_pk_bf16_f32 v50, v205, v206
    v_cvt_pk_bf16_f32 v51, v207, v212
    v_cvt_pk_bf16_f32 v52, v206, v207
    v_cvt_pk_bf16_f32 v53, v212, v213
    v_cvt_pk_bf16_f32 v54, v207, v212
    v_cvt_pk_bf16_f32 v55, v213, v214
    v_cvt_pk_bf16_f32 v56, v208, v208
    v_cvt_pk_bf16_f32 v57, v209, v210
    v_cvt_pk_bf16_f32 v58, v208, v209
    v_cvt_pk_bf16_f32 v59, v210, v210
    v_cvt_pk_bf16_f32 v60, v209, v210
    v_cvt_pk_bf16_f32 v61, v210, v210
    v_cvt_pk_bf16_f32 v62, v210, v210
    v_cvt_pk_bf16_f32 v63, v210, v211
    v_cvt_pk_bf16_f32 v64, v217, v218
    v_mov_b32_e64 v71, s8
    v_cvt_pk_bf16_f32 v80, v234, v204
    v_mov_b32_e64 v81, v50
    v_cvt_pk_bf16_f32 v66, v216, v216
    v_cvt_pk_bf16_f32 v67, v216, v234
    v_cvt_pk_bf16_f32 v68, v234, v218
    v_cvt_pk_bf16_f32 v69, v218, v234
    v_cvt_pk_bf16_f32 v70, v218, v218
    s_cmp_lg_u32 s30, 0
    s_cbranch_scc1 L_XE2
    s_waitcnt lgkmcnt(0)
    v_readfirstlane_b32 s28, v34
    s_add_u32 s31, s31, 64
    s_mov_b32 s29, s28
    s_cmp_eq_u32 s28, 0
    s_cbranch_scc1 L_XE2
    s_xor_b64 s[16:17], s[16:17], s[28:29]
    s_xor_b64 s[18:19], s[18:19], s[28:29]
    s_xor_b64 s[20:21], s[20:21], s[28:29]
    s_xor_b64 s[22:23], s[22:23], s[28:29]
    s_or_b64 s[16:17], s[16:17], s[18:19]
    s_or_b64 s[20:21], s[20:21], s[22:23]
    s_or_b64 s[16:17], s[16:17], s[20:21]
    s_cbranch_scc1 L_XE2
    s_setprio 3
    buffer_load_dwordx4 v[16:19], v33, s[44:47], s32 offen sc1
    buffer_load_dwordx4 v[20:23], v33, s[44:47], s33 offen sc1
    buffer_load_dwordx4 v[24:27], v33, s[44:47], s34 offen sc1
    buffer_load_dwordx4 v[28:31], v33, s[44:47], s35 offen sc1
    s_mov_b64 exec, 1
    ds_write_b32 v4, v5 offset:544
    s_mov_b64 exec, -1
    s_setprio 2
    s_mov_b32 s30, 1
L_XE2:
    s_nop 0
    ds_write_b64 v203, v[48:49] offset:32
    ds_write_b64 v203, v[50:51] offset:2400
    ds_write_b64 v203, v[52:53] offset:4768
    ds_write_b64 v203, v[54:55] offset:7136
    ds_write_b64 v203, v[56:57] offset:544
    ds_write_b64 v203, v[58:59] offset:2912
    ds_write_b64 v203, v[60:61] offset:5280
    ds_write_b64 v203, v[62:63] offset:7648
    ds_write_b16 v46, v64 offset:10784
    ds_write_b16_d16_hi v46, v64 offset:11424
    ds_write_b16 v46, v64 offset:10942
    ds_write_b16_d16_hi v46, v64 offset:11582
    ds_write_b16 v46, v64 offset:11100
    ds_write_b16_d16_hi v46, v64 offset:11740
    ds_write_b16 v46, v64 offset:11258
    ds_write_b16_d16_hi v46, v64 offset:11898
    s_mov_b64 exec, 1
    s_nop 0
    ds_write_b32 v71, v80 offset:2396
    ds_write_b32 v71, v48 offset:4764
    ds_write_b64 v71, v[80:81] offset:7128
    ds_write_b64 v71, v[66:67] offset:1056
    ds_write_b32 v71, v66 offset:3424
    ds_write_b16 v71, v66 offset:5792
    ds_write_b16 v71, v66 offset:8158
    ds_write_b16 v71, v56 offset:5278
    ds_write_b16 v71, v56 offset:7644
    s_brev_b64 exec, 1
    s_nop 0
    ds_write_b32 v71, v68 offset:1124
    ds_write_b32 v71, v69 offset:1128
    ds_write_b32 v71, v70 offset:3492
    ds_write_b64 v71, v[68:69] offset:5856
    ds_write_b32 v71, v70 offset:8224
    s_mov_b64 exec, -1
LW_1:
    ds_read_b32 v34, v6 offset:128
    s_waitcnt lgkmcnt(0)
    v_cmp_eq_u32 vcc, 0, v34
    s_cbranch_vccnz LW_1
    s_cmp_lg_u32 s30, 0
    s_cbranch_scc1 L_XS1
    s_buffer_load_dwordx8 s[16:23], s[44:47], s31
L_XS1:
    v_readfirstlane_b32 s28, v34
    ds_write_b64 v15, v[234:235] offset:4096
    s_mov_b32 s5, 0
    s_mov_b32 s29, s28
    s_nop 0
    ds_read_b64 v[48:49], v1 offset:0
    ds_read_b64 v[50:51], v1 offset:8
    ds_read_b64 v[52:53], v1 offset:64
    ds_read_b64 v[54:55], v1 offset:72
    ds_read_b64 v[56:57], v1 offset:128
    ds_read_b64 v[58:59], v1 offset:136
    ds_read_b64 v[60:61], v1 offset:192
    ds_read_b64 v[62:63], v1 offset:200
    ds_read_b64 v[64:65], v1 offset:256
    ds_read_b64 v[66:67], v1 offset:264
    ds_read_b64 v[68:69], v1 offset:320
    ds_read_b64 v[70:71], v1 offset:328
    ds_read_b64 v[72:73], v1 offset:384
    ds_read_b64 v[74:75], v1 offset:392
    ds_read_b64 v[76:77], v1 offset:448
    ds_read_b64 v[78:79], v1 offset:456
    ds_read_b64 v[80:81], v1 offset:512
    ds_read_b64 v[82:83], v1 offset:520
    ds_read_b64 v[84:85], v1 offset:576
    ds_read_b64 v[86:87], v1 offset:584
    s_cmp_lg_u32 s30, 0
    s_cbranch_scc1 L_XA
    s_waitcnt lgkmcnt(0)
    s_xor_b64 s[16:17], s[16:17], s[28:29]
    s_xor_b64 s[18:19], s[18:19], s[28:29]
    s_xor_b64 s[20:21], s[20:21], s[28:29]
    s_xor_b64 s[22:23], s[22:23], s[28:29]
    s_or_b64 s[16:17], s[16:17], s[18:19]
    s_or_b64 s[20:21], s[20:21], s[22:23]
    s_or_b64 s[16:17], s[16:17], s[20:21]
    s_cbranch_scc1 L_XF
    s_setprio 3
    buffer_load_dwordx4 v[16:19], v33, s[44:47], s32 offen sc1
    buffer_load_dwordx4 v[20:23], v33, s[44:47], s33 offen sc1
    buffer_load_dwordx4 v[24:27], v33, s[44:47], s34 offen sc1
    buffer_load_dwordx4 v[28:31], v33, s[44:47], s35 offen sc1
    s_mov_b64 exec, 1
    ds_write_b32 v4, v5 offset:544
    s_mov_b64 exec, -1
    s_setprio 2
L_XA:
    s_nop 0
    ds_read_b64 v[88:89], v1 offset:640
    ds_read_b64 v[90:91], v1 offset:648
    ds_read_b64 v[92:93], v1 offset:704
    ds_read_b64 v[94:95], v1 offset:712
    ds_read_b64 v[96:97], v1 offset:768
    ds_read_b64 v[98:99], v1 offset:776
    ds_read_b64 v[100:101], v1 offset:832
    ds_read_b64 v[102:103], v1 offset:840
    ds_read_b64 v[104:105], v1 offset:896
    ds_read_b64 v[106:107], v1 offset:904
    ds_read_b64 v[108:109], v1 offset:960
    ds_read_b64 v[110:111], v1 offset:968
    ds_read_b64 v[112:113], v1 offset:1024
    ds_read_b64 v[114:115], v1 offset:1032
    ds_read_b64 v[116:117], v1 offset:1088
    ds_read_b64 v[118:119], v1 offset:1096
    ds_read_b64 v[120:121], v2 offset:10776
    ds_read_b64 v[122:123], v2 offset:11416
    ds_read_b64 v[124:125], v2 offset:12056
    ds_read_b64 v[126:127], v2 offset:12696
    ds_read_b64 v[128:129], v2 offset:10808
    ds_read_b64 v[130:131], v2 offset:11448
    ds_read_b64 v[132:133], v2 offset:12088
    ds_read_b64 v[134:135], v2 offset:12728
    ds_read_b64 v[136:137], v2 offset:10840
    ds_read_b64 v[138:139], v2 offset:11480
    ds_read_b64 v[140:141], v2 offset:12120
    ds_read_b64 v[142:143], v2 offset:12760
L_XBACK:
    s_waitcnt vmcnt(3)
    v_lshlrev_b32 v36, 16, v16
    v_and_b32 v37, 0xffff0000, v16
    v_lshlrev_b32_e64 v38, 16, v17
    v_and_b32 v39, 0xffff0000, v17
    v_lshlrev_b32_e64 v40, 16, v18
    v_and_b32 v41, 0xffff0000, v18
    v_lshlrev_b32_e64 v42, 16, v19
    v_and_b32 v43, 0xffff0000, v19
L_MSW:
    ds_read_b32 v11, v4 offset:528
    ds_read_b64 v[12:13], v10 offset:9216
    s_waitcnt lgkmcnt(0)
    v_cmp_eq_u32 vcc, 0, v11
    s_cbranch_vccnz L_MSW
    v_lshlrev_b32 v44, 16, v13
    v_and_b32 v45, 0xffff0000, v13
    v_rcp_f32 v44, v44
    v_rcp_f32 v45, v45
    v_lshlrev_b32_e64 v46, 16, v12
    v_and_b32 v47, 0xffff0000, v12
    v_pk_mul_f32 v[46:47], v[46:47], v[44:45]
    v_pk_fma_f32 v[36:37], v[36:37], v[44:45], v[46:47] op_sel:[0,0,0] op_sel_hi:[1,0,0] neg_lo:[0,0,1] neg_hi:[0,0,1]
    v_pk_fma_f32 v[40:41], v[40:41], v[44:45], v[46:47] op_sel:[0,1,1] op_sel_hi:[1,1,1] neg_lo:[0,0,1] neg_hi:[0,0,1]
    v_pk_fma_f32 v[38:39], v[38:39], v[44:45], v[46:47] op_sel:[0,0,0] op_sel_hi:[1,0,0] neg_lo:[0,0,1] neg_hi:[0,0,1]
    v_pk_fma_f32 v[42:43], v[42:43], v[44:45], v[46:47] op_sel:[0,1,1] op_sel_hi:[1,1,1] neg_lo:[0,0,1] neg_hi:[0,0,1]
    v_cvt_pk_bf16_f32 v36, v40, v36
    v_cvt_pk_bf16_f32 v37, v41, v37
    v_cvt_pk_bf16_f32 v38, v42, v38
    v_cvt_pk_bf16_f32 v39, v43, v39
    ds_write2st64_b32 v32, v36, v37 offset0:12 offset1:30
    ds_write2st64_b32 v32, v38, v39 offset0:48 offset1:66
    s_mov_b64 exec, 1
    ds_write_b32 v4, v11 offset:0
    s_mov_b64 exec, -1
    s_setprio 1
L_XRW:
    s_nop 0
    ds_read_b32 v15, v6 offset:0
    ds_read_b128 v[180:183], v7 offset:4032
    ds_read_b128 v[184:187], v7 offset:3968
    ds_read_b128 v[188:191], v7 offset:3904
    ds_read_b128 v[192:195], v7 offset:3840
    ds_read_b128 v[196:199], v7 offset:3776
    ds_read_b128 v[200:203], v7 offset:3712
    s_waitcnt lgkmcnt(6)
    v_cmp_eq_u32 vcc, 0, v15
    s_cbranch_vccnz L_XRW
    v_cmp_ne_u32_e64 vcc, 2, v15
    s_cmp_eq_u32 vcc_lo, 0
    s_cselect_b32 s14, 2, 1
    s_waitcnt lgkmcnt(5)
    v_mfma_f32_16x16x32_bf16 v[204:207], v[76:79], v[180:183], 0
    ds_read_b64 v[12:13], v10 offset:11264
    s_waitcnt vmcnt(2)
    v_mfma_f32_16x16x32_bf16 v[208:211], v[108:111], v[180:183], 0
    v_lshlrev_b32_e64 v36, 16, v20
    s_waitcnt lgkmcnt(5)
    v_mfma_f32_16x16x32_bf16 v[204:207], v[72:75], v[184:187], v[204:207]
    ds_read_b128 v[180:183], v7 offset:3648
    v_and_b32 v37, 0xffff0000, v20
    v_mfma_f32_16x16x32_bf16 v[208:211], v[104:107], v[184:187], v[208:211]
    v_lshlrev_b32 v38, 16, v21
    s_waitcnt lgkmcnt(5)
    v_mfma_f32_16x16x32_bf16 v[204:207], v[68:71], v[188:191], v[204:207]
    ds_read_b128 v[184:187], v7 offset:3584
    v_and_b32 v39, 0xffff0000, v21
    v_mfma_f32_16x16x32_bf16 v[208:211], v[100:103], v[188:191], v[208:211]
    v_lshlrev_b32 v40, 16, v22
    s_waitcnt lgkmcnt(3)
    v_mfma_f32_16x16x32_bf16 v[204:207], v[64:67], v[192:195], v[204:207]
    ds_read_b128 v[188:191], v7 offset:3520
    v_and_b32 v41, 0xffff0000, v22
    v_mfma_f32_16x16x32_bf16 v[208:211], v[96:99], v[192:195], v[208:211]
    v_lshlrev_b32_e64 v42, 16, v23
    v_and_b32 v43, 0xffff0000, v23
    v_mfma_f32_16x16x32_bf16 v[204:207], v[60:63], v[196:199], v[204:207]
    ds_read_b128 v[192:195], v7 offset:3600
    s_waitcnt lgkmcnt(3)
    v_lshlrev_b32 v44, 16, v13
    v_mfma_f32_16x16x32_bf16 v[208:211], v[92:95], v[196:199], v[208:211]
    v_and_b32 v45, 0xffff0000, v13
    v_mfma_f32_16x16x32_bf16 v[204:207], v[56:59], v[200:203], v[204:207]
    ds_read_b128 v[196:199], v7 offset:3456
    v_mfma_f32_16x16x32_bf16 v[208:211], v[88:91], v[200:203], v[208:211]
    v_rcp_f32_e64 v44, v44
    v_mfma_f32_16x16x32_bf16 v[204:207], v[52:55], v[180:183], v[204:207]
    ds_read_b128 v[200:203], v7 offset:3392
    v_mfma_f32_16x16x32_bf16 v[208:211], v[84:87], v[180:183], v[208:211]
    v_rcp_f32 v45, v45
    s_waitcnt lgkmcnt(3)
    v_mfma_f32_16x16x32_bf16 v[204:207], v[48:51], v[184:187], v[204:207]
    ds_read_b128 v[180:183], v7 offset:3328
    v_lshlrev_b32_e64 v46, 16, v12
    v_mfma_f32_16x16x32_bf16 v[208:211], v[80:83], v[184:187], v[208:211]
    v_and_b32 v47, 0xffff0000, v12
    v_mul_f32_e64 v46, v46, v44
    v_mfma_f32_16x16x32_bf16 v[212:215], v[112:115], v[184:187], 0
    v_mul_f32_e64 v47, v47, v45
    v_fma_f32 v36, v36, v44, -v46
    v_fma_f32 v40, v40, v45, -v47
    v_mfma_f32_16x16x32_bf16 v[220:223], v[116:119], v[184:187], 0
    ds_write_b128 v8, v[204:207] offset:0
    v_mfma_f32_16x16x32_bf16 v[152:155], v[184:187], v[240:243], 0
    v_fma_f32 v37, v37, v44, -v46
    v_fma_f32 v41, v41, v45, -v47
    v_mfma_f32_16x16x32_bf16 v[156:159], v[184:187], v[252:255], 0
    v_fma_f32 v38, v38, v44, -v46
    v_fma_f32 v42, v42, v45, -v47
    v_mfma_f32_16x16x32_bf16 v[168:171], v[184:187], v[244:247], 0
    v_fma_f32 v39, v39, v44, -v46
    v_fma_f32 v43, v43, v45, -v47
    v_mfma_f32_16x16x32_bf16 v[208:211], v[76:79], v[188:191], v[208:211]
    ds_read_b128 v[184:187], v7 offset:3264
    v_cvt_pk_bf16_f32 v154, v155, v154
    v_mfma_f32_16x16x32_bf16 v[212:215], v[108:111], v[188:191], v[212:215]
    v_cvt_pk_bf16_f32 v155, v153, v152
    s_waitcnt lgkmcnt(2)
    s_nop 0
    v_mfma_f32_16x16x32_bf16 v[160:163], v[192:195], v[240:243], 0
    v_cvt_pk_bf16_f32 v157, v157, v156
    v_cvt_pk_bf16_f32 v156, v159, v158
    v_mfma_f32_16x16x32_bf16 v[164:167], v[192:195], v[252:255], 0
    ds_read_b128 v[188:191], v7 offset:3200
    v_cvt_pk_bf16_f32 v176, v171, v170
    v_cvt_pk_bf16_f32 v177, v169, v168
    v_mfma_f32_16x16x32_bf16 v[172:175], v[192:195], v[248:251], 0
    v_cvt_pk_bf16_f32 v36, v40, v36
    v_cvt_pk_bf16_f32 v162, v163, v162
    v_mfma_f32_16x16x32_bf16 v[208:211], v[72:75], v[196:199], v[208:211]
    ds_read_b128 v[192:195], v7 offset:3136
    v_cvt_pk_bf16_f32 v163, v161, v160
    v_mfma_f32_16x16x32_bf16 v[212:215], v[104:107], v[196:199], v[212:215]
    v_cvt_pk_bf16_f32 v165, v165, v164
    v_cvt_pk_bf16_f32 v164, v167, v166
    v_mfma_f32_16x16x32_bf16 v[208:211], v[68:71], v[200:203], v[208:211]
    ds_read_b128 v[196:199], v7 offset:3072
    v_cvt_pk_bf16_f32 v178, v175, v174
    v_mfma_f32_16x16x32_bf16 v[212:215], v[100:103], v[200:203], v[212:215]
    v_cvt_pk_bf16_f32 v179, v173, v172
    v_cvt_pk_bf16_f32 v37, v41, v37
    v_mfma_f32_16x16x32_bf16 v[208:211], v[64:67], v[180:183], v[208:211]
    v_cvt_pk_bf16_f32 v38, v42, v38
    v_cvt_pk_bf16_f32 v39, v43, v39
    v_mfma_f32_16x16x32_bf16 v[212:215], v[96:99], v[180:183], v[212:215]
    ds_write2st64_b32 v32, v36, v37 offset0:8 offset1:26
    v_mfma_f32_16x16x32_bf16 v[212:215], v[154:157], v[120:123], v[212:215]
    ds_write2st64_b32 v32, v38, v39 offset0:44 offset1:62
    ds_write_b32 v4, v5 offset:160
    v_mfma_f32_16x16x32_bf16 v[216:219], v[154:157], v[128:131], 0
    ds_read_b64 v[12:13], v10 offset:13312
    s_waitcnt vmcnt(0)
    v_mfma_f32_16x16x32_bf16 v[220:223], v[154:157], v[136:139], v[220:223]
    v_lshlrev_b32_e64 v36, 16, v24
    s_waitcnt lgkmcnt(4)
    v_mfma_f32_16x16x32_bf16 v[208:211], v[60:63], v[184:187], v[208:211]
    v_and_b32 v37, 0xffff0000, v24
    v_lshlrev_b32_e64 v38, 16, v25
    v_mfma_f32_16x16x32_bf16 v[212:215], v[92:95], v[184:187], v[212:215]
    v_and_b32 v39, 0xffff0000, v25
    v_lshlrev_b32_e64 v40, 16, v26
    v_mfma_f32_16x16x32_bf16 v[212:215], v[162:165], v[124:127], v[212:215]
    ds_read_b32 v11, v6 offset:160
    v_and_b32 v41, 0xffff0000, v26
    v_mfma_f32_16x16x32_bf16 v[216:219], v[162:165], v[132:135], v[216:219]
    v_lshlrev_b32_e64 v42, 16, v27
    v_and_b32 v43, 0xffff0000, v27
    v_mfma_f32_16x16x32_bf16 v[220:223], v[162:165], v[140:143], v[220:223]
    s_waitcnt lgkmcnt(1)
    v_lshlrev_b32 v44, 16, v13
    v_mfma_f32_16x16x32_bf16 v[208:211], v[56:59], v[188:191], v[208:211]
    v_and_b32 v45, 0xffff0000, v13
    v_rcp_f32_e64 v44, v44
    v_mfma_f32_16x16x32_bf16 v[212:215], v[88:91], v[188:191], v[212:215]
    v_rcp_f32_e64 v45, v45
    v_mfma_f32_16x16x32_bf16 v[208:211], v[52:55], v[192:195], v[208:211]
    v_lshlrev_b32_e64 v46, 16, v12
    v_and_b32 v47, 0xffff0000, v12
    v_mfma_f32_16x16x32_bf16 v[212:215], v[84:87], v[192:195], v[212:215]
    s_waitcnt lgkmcnt(0)
    v_cmp_eq_u32 vcc, 0, v11
    v_mfma_f32_16x16x32_bf16 v[208:211], v[48:51], v[196:199], v[208:211]
    s_cbranch_vccnz L_SLOW3
L_BACK3:
    s_nop 0
    ds_read_b128 v[200:203], v7 offset:3008
    v_mfma_f32_16x16x32_bf16 v[212:215], v[80:83], v[196:199], v[212:215]
    ds_read_b128 v[180:183], v7 offset:3088
    ds_read_b128 v[184:187], v7 offset:2944
    v_mfma_f32_16x16x32_bf16 v[216:219], v[112:115], v[196:199], v[216:219]
    ds_read_b128 v[188:191], v7 offset:2880
    ds_read_b128 v[192:195], v7 offset:2816
    v_mfma_f32_16x16x32_bf16 v[224:227], v[116:119], v[196:199], 0
    ds_write_b128 v8, v[208:211] offset:1024
    v_mfma_f32_16x16x32_bf16 v[152:155], v[196:199], v[240:243], 0
    v_mul_f32 v46, v46, v44
    v_mul_f32 v47, v47, v45
    v_fma_f32 v36, v36, v44, -v46
    v_mfma_f32_16x16x32_bf16 v[156:159], v[196:199], v[252:255], 0
    v_fma_f32 v40, v40, v45, -v47
    v_fma_f32 v37, v37, v44, -v46
    v_mfma_f32_16x16x32_bf16 v[168:171], v[196:199], v[244:247], 0
    v_fma_f32 v41, v41, v45, -v47
    s_waitcnt lgkmcnt(5)
    s_nop 0
    v_mfma_f32_16x16x32_bf16 v[212:215], v[76:79], v[200:203], v[212:215]
    ds_read_b128 v[196:199], v7 offset:2752
    v_cvt_pk_bf16_f32 v154, v155, v154
    v_mfma_f32_16x16x32_bf16 v[216:219], v[108:111], v[200:203], v[216:219]
    v_cvt_pk_bf16_f32 v155, v153, v152
    s_waitcnt lgkmcnt(2)
    s_nop 0
    v_mfma_f32_16x16x32_bf16 v[160:163], v[180:183], v[240:243], 0
    ds_read_b128 v[200:203], v7 offset:2688
    v_cvt_pk_bf16_f32 v157, v157, v156
    v_mfma_f32_16x16x32_bf16 v[164:167], v[180:183], v[252:255], 0
    v_cvt_pk_bf16_f32 v156, v159, v158
    v_cvt_pk_bf16_f32 v144, v171, v170
    v_mfma_f32_16x16x32_bf16 v[172:175], v[180:183], v[248:251], 0
    v_cvt_pk_bf16_f32 v145, v169, v168
    v_fma_f32 v38, v38, v44, -v46
    v_mfma_f32_16x16x32_bf16 v[212:215], v[72:75], v[184:187], v[212:215]
    ds_read_b128 v[180:183], v7 offset:2624
    v_cvt_pk_bf16_f32 v162, v163, v162
    v_cvt_pk_bf16_f32 v163, v161, v160
    v_mfma_f32_16x16x32_bf16 v[216:219], v[104:107], v[184:187], v[216:219]
    v_cvt_pk_bf16_f32 v165, v165, v164
    v_cvt_pk_bf16_f32 v164, v167, v166
    v_mfma_f32_16x16x32_bf16 v[212:215], v[68:71], v[188:191], v[212:215]
    ds_read_b128 v[184:187], v7 offset:2560
    v_cvt_pk_bf16_f32 v146, v175, v174
    v_mfma_f32_16x16x32_bf16 v[216:219], v[100:103], v[188:191], v[216:219]
    v_cvt_pk_bf16_f32 v147, v173, v172
    v_fma_f32 v42, v42, v45, -v47
    v_mfma_f32_16x16x32_bf16 v[212:215], v[64:67], v[192:195], v[212:215]
    v_fma_f32 v39, v39, v44, -v46
    v_fma_f32 v43, v43, v45, -v47
    v_mfma_f32_16x16x32_bf16 v[216:219], v[96:99], v[192:195], v[216:219]
    v_cvt_pk_bf16_f32 v36, v40, v36
    s_waitcnt lgkmcnt(2)
    s_nop 0
    v_mfma_f32_16x16x32_bf16 v[212:215], v[60:63], v[196:199], v[212:215]
    v_cvt_pk_bf16_f32 v37, v41, v37
    v_cvt_pk_bf16_f32 v38, v42, v38
    v_mfma_f32_16x16x32_bf16 v[216:219], v[92:95], v[196:199], v[216:219]
    v_cvt_pk_bf16_f32 v39, v43, v39
    ds_read_b128 v[188:191], v7 offset:2496
    v_mfma_f32_16x16x32_bf16 v[216:219], v[154:157], v[120:123], v[216:219]
    ds_write2st64_b32 v32, v36, v37 offset0:4 offset1:22
    ds_read_b128 v[192:195], v7 offset:2576
    v_mfma_f32_16x16x32_bf16 v[220:223], v[154:157], v[128:131], v[220:223]
    ds_write2st64_b32 v32, v38, v39 offset0:40 offset1:58
    v_mfma_f32_16x16x32_bf16 v[224:227], v[154:157], v[136:139], v[224:227]
    ds_write_b32 v4, v5 offset:144
    ds_read_b64 v[12:13], v10 offset:15360
    v_mfma_f32_16x16x32_bf16 v[212:215], v[56:59], v[200:203], v[212:215]
    v_lshlrev_b32_e64 v36, 16, v28
    v_and_b32 v37, 0xffff0000, v28
    v_mfma_f32_16x16x32_bf16 v[216:219], v[88:91], v[200:203], v[216:219]
    v_lshlrev_b32_e64 v38, 16, v29
    v_and_b32 v39, 0xffff0000, v29
    v_mfma_f32_16x16x32_bf16 v[216:219], v[162:165], v[124:127], v[216:219]
    v_lshlrev_b32_e64 v40, 16, v30
    v_and_b32 v41, 0xffff0000, v30
    v_mfma_f32_16x16x32_bf16 v[220:223], v[162:165], v[132:135], v[220:223]
    ds_read_b32 v11, v6 offset:144
    ds_read_b128 v[196:199], v7 offset:2432
    v_mfma_f32_16x16x32_bf16 v[224:227], v[162:165], v[140:143], v[224:227]
    v_lshlrev_b32 v42, 16, v31
    s_waitcnt lgkmcnt(4)
    v_mfma_f32_16x16x32_bf16 v[212:215], v[52:55], v[180:183], v[212:215]
    ds_read_b128 v[200:203], v7 offset:2368
    v_and_b32 v43, 0xffff0000, v31
    s_waitcnt lgkmcnt(3)
    v_mfma_f32_16x16x32_bf16 v[216:219], v[84:87], v[180:183], v[216:219]
    v_lshlrev_b32 v44, 16, v13
    v_and_b32 v45, 0xffff0000, v13
    v_mfma_f32_16x16x32_bf16 v[212:215], v[48:51], v[184:187], v[212:215]
    ds_read_b128 v[180:183], v7 offset:2304
    v_mfma_f32_16x16x32_bf16 v[216:219], v[80:83], v[184:187], v[216:219]
    v_rcp_f32_e64 v44, v44
    v_mfma_f32_16x16x32_bf16 v[220:223], v[112:115], v[184:187], v[220:223]
    s_waitcnt lgkmcnt(2)
    v_cmp_eq_u32 vcc, 0, v11
    v_mfma_f32_16x16x32_bf16 v[228:231], v[116:119], v[184:187], 0
    s_cbranch_vccnz L_SLOW0
L_BACK0:
    s_nop 0
    ds_read_b64 v[204:205], v9 offset:0
    v_mfma_f32_16x16x32_bf16 v[152:155], v[184:187], v[240:243], 0
    ds_read_b64 v[206:207], v9 offset:8192
    ds_read_b64 v[208:209], v9 offset:16384
    v_mfma_f32_16x16x32_bf16 v[156:159], v[184:187], v[252:255], 0
    ds_read_b64 v[210:211], v9 offset:24576
    v_mfma_f32_16x16x32_bf16 v[168:171], v[184:187], v[244:247], 0
    ds_write_b128 v8, v[212:215] offset:2048
    v_mfma_f32_16x16x32_bf16 v[216:219], v[76:79], v[188:191], v[216:219]
    ds_read_b128 v[184:187], v7 offset:2240
    v_cvt_pk_bf16_f32 v154, v155, v154
    v_mfma_f32_16x16x32_bf16 v[220:223], v[108:111], v[188:191], v[220:223]
    v_cvt_pk_bf16_f32 v155, v153, v152
    v_cvt_pk_bf16_f32 v157, v157, v156
    v_mfma_f32_16x16x32_bf16 v[160:163], v[192:195], v[240:243], 0
    ds_read_b128 v[188:191], v7 offset:2176
    v_cvt_pk_bf16_f32 v156, v159, v158
    v_mfma_f32_16x16x32_bf16 v[164:167], v[192:195], v[252:255], 0
    v_cvt_pk_bf16_f32 v148, v171, v170
    v_cvt_pk_bf16_f32 v149, v169, v168
    v_mfma_f32_16x16x32_bf16 v[172:175], v[192:195], v[248:251], 0
    v_rcp_f32_e64 v45, v45
    v_mfma_f32_16x16x32_bf16 v[216:219], v[72:75], v[196:199], v[216:219]
    ds_read_b128 v[192:195], v7 offset:2112
    v_cvt_pk_bf16_f32 v162, v163, v162
    v_mfma_f32_16x16x32_bf16 v[220:223], v[104:107], v[196:199], v[220:223]
    v_cvt_pk_bf16_f32 v163, v161, v160
    s_waitcnt lgkmcnt(2)
    s_nop 0
    v_mfma_f32_16x16x32_bf16 v[216:219], v[68:71], v[200:203], v[216:219]
    ds_read_b128 v[196:199], v7 offset:2048
    v_cvt_pk_bf16_f32 v165, v165, v164
    v_cvt_pk_bf16_f32 v164, v167, v166
    v_mfma_f32_16x16x32_bf16 v[220:223], v[100:103], v[200:203], v[220:223]
    v_cvt_pk_bf16_f32 v150, v175, v174
    v_cvt_pk_bf16_f32 v151, v173, v172
    v_mfma_f32_16x16x32_bf16 v[216:219], v[64:67], v[180:183], v[216:219]
    v_lshlrev_b32_e64 v46, 16, v12
    v_and_b32 v47, 0xffff0000, v12
    v_mfma_f32_16x16x32_bf16 v[220:223], v[96:99], v[180:183], v[220:223]
    v_mul_f32 v46, v46, v44
    v_mul_f32 v47, v47, v45
    v_mfma_f32_16x16x32_bf16 v[216:219], v[60:63], v[184:187], v[216:219]
    v_fma_f32 v36, v36, v44, -v46
    v_fma_f32 v40, v40, v45, -v47
    v_mfma_f32_16x16x32_bf16 v[220:223], v[92:95], v[184:187], v[220:223]
    v_fma_f32 v37, v37, v44, -v46
    v_fma_f32 v41, v41, v45, -v47
    v_mfma_f32_16x16x32_bf16 v[220:223], v[154:157], v[120:123], v[220:223]
    v_fma_f32 v38, v38, v44, -v46
    v_fma_f32 v42, v42, v45, -v47
    v_mfma_f32_16x16x32_bf16 v[224:227], v[154:157], v[128:131], v[224:227]
    ds_read_b128 v[200:203], v7 offset:1984
    v_fma_f32 v39, v39, v44, -v46
    v_mfma_f32_16x16x32_bf16 v[228:231], v[154:157], v[136:139], v[228:231]
    v_fma_f32 v43, v43, v45, -v47
    v_cvt_pk_bf16_f32 v36, v40, v36
    s_waitcnt lgkmcnt(1)
    s_nop 0
    v_mfma_f32_16x16x32_bf16 v[216:219], v[56:59], v[188:191], v[216:219]
    ds_read_b128 v[180:183], v7 offset:2064
    v_cvt_pk_bf16_f32 v37, v41, v37
    v_mfma_f32_16x16x32_bf16 v[220:223], v[88:91], v[188:191], v[220:223]
    v_cvt_pk_bf16_f32 v38, v42, v38
    v_cvt_pk_bf16_f32 v39, v43, v39
    v_mfma_f32_16x16x32_bf16 v[220:223], v[162:165], v[124:127], v[220:223]
    ds_write2st64_b32 v32, v36, v37 offset0:0 offset1:18
    v_mfma_f32_16x16x32_bf16 v[224:227], v[162:165], v[132:135], v[224:227]
    ds_read_b128 v[184:187], v7 offset:1920
    ds_read_b64 v[188:189], v2 offset:9496
    ds_read_b64 v[190:191], v2 offset:10136
    v_mfma_f32_16x16x32_bf16 v[228:231], v[162:165], v[140:143], v[228:231]
    ds_write2st64_b32 v32, v38, v39 offset0:36 offset1:54
    v_mfma_f32_16x16x32_bf16 v[216:219], v[52:55], v[192:195], v[216:219]
    v_lshlrev_b32_e64 v36, 16, v16
    v_and_b32 v37, 0xffff0000, v16
    v_mfma_f32_16x16x32_bf16 v[220:223], v[84:87], v[192:195], v[220:223]
    v_lshlrev_b32_e64 v38, 16, v17
    v_and_b32 v39, 0xffff0000, v17
    v_mfma_f32_16x16x32_bf16 v[216:219], v[48:51], v[196:199], v[216:219]
    ds_read_b128 v[192:195], v7 offset:1856
    v_lshlrev_b32_e64 v40, 16, v18
    v_and_b32 v41, 0xffff0000, v18
    v_mfma_f32_16x16x32_bf16 v[220:223], v[80:83], v[196:199], v[220:223]
    v_lshlrev_b32_e64 v42, 16, v19
    v_and_b32 v43, 0xffff0000, v19
    v_mfma_f32_16x16x32_bf16 v[224:227], v[112:115], v[196:199], v[224:227]
    v_add_f32 v36, v204, v36
    v_add_f32 v37, v206, v37
    v_mfma_f32_16x16x32_bf16 v[232:235], v[116:119], v[196:199], 0
    ds_write_b128 v8, v[216:219] offset:3072
    v_mfma_f32_16x16x32_bf16 v[152:155], v[196:199], v[240:243], 0
    ds_write_b32 v4, v5 offset:16
    ds_read_b128 v[116:119], v7 offset:1792
    v_mfma_f32_16x16x32_bf16 v[156:159], v[196:199], v[252:255], 0
    v_add_f32 v38, v208, v38
    v_add_f32 v39, v210, v39
    v_mfma_f32_16x16x32_bf16 v[168:171], v[196:199], v[244:247], 0
    v_add_f32 v40, v205, v40
    s_waitcnt lgkmcnt(3)
    v_mfma_f32_16x16x32_bf16 v[220:223], v[76:79], v[200:203], v[220:223]
    ds_read_b128 v[196:199], v7 offset:1728
    v_cvt_pk_bf16_f32 v154, v155, v154
    v_mfma_f32_16x16x32_bf16 v[224:227], v[108:111], v[200:203], v[224:227]
    ds_read_b32 v11, v6 offset:16
    v_cvt_pk_bf16_f32 v155, v153, v152
    v_cvt_pk_bf16_f32 v157, v157, v156
    v_mfma_f32_16x16x32_bf16 v[160:163], v[180:183], v[240:243], 0
    ds_read_b128 v[200:203], v7 offset:1664
    v_cvt_pk_bf16_f32 v156, v159, v158
    v_mfma_f32_16x16x32_bf16 v[164:167], v[180:183], v[252:255], 0
    v_cvt_pk_bf16_f32 v244, v171, v170
    v_cvt_pk_bf16_f32 v245, v169, v168
    v_mfma_f32_16x16x32_bf16 v[172:175], v[180:183], v[248:251], 0
    v_add_f32 v41, v207, v41
    v_add_f32 v42, v209, v42
    v_mfma_f32_16x16x32_bf16 v[220:223], v[72:75], v[184:187], v[220:223]
    v_cvt_pk_bf16_f32 v162, v163, v162
    v_cvt_pk_bf16_f32 v163, v161, v160
    v_mfma_f32_16x16x32_bf16 v[224:227], v[104:107], v[184:187], v[224:227]
    v_cvt_pk_bf16_f32 v165, v165, v164
    v_cvt_pk_bf16_f32 v164, v167, v166
    v_mfma_f32_16x16x32_bf16 v[220:223], v[176:179], v[188:191], v[220:223]
    s_waitcnt lgkmcnt(1)
    v_cmp_eq_u32 vcc, 0, v11
    v_mfma_f32_16x16x32_bf16 v[224:227], v[144:147], v[188:191], v[224:227]
    s_cbranch_vccnz L_SLOW1
L_BACK1:
    s_nop 0
    ds_read_b64 v[212:213], v9 offset:2048
    v_mfma_f32_16x16x32_bf16 v[220:223], v[68:71], v[192:195], v[220:223]
    ds_read_b64 v[214:215], v9 offset:10240
    ds_read_b64 v[216:217], v9 offset:18432
    ds_read_b64 v[218:219], v9 offset:26624
    v_mfma_f32_16x16x32_bf16 v[224:227], v[100:103], v[192:195], v[224:227]
    ds_read_b32 v11, v6 offset:112
    ds_read_b128 v[180:183], v7 offset:1600
    v_mfma_f32_16x16x32_bf16 v[220:223], v[64:67], v[116:119], v[220:223]
    ds_read_b128 v[184:187], v7 offset:1536
    v_cvt_pk_bf16_f32 v246, v175, v174
    v_mfma_f32_16x16x32_bf16 v[224:227], v[96:99], v[116:119], v[224:227]
    ds_read_b128 v[192:195], v7 offset:1472
    v_cvt_pk_bf16_f32 v247, v173, v172
    v_mfma_f32_16x16x32_bf16 v[220:223], v[60:63], v[196:199], v[220:223]
    v_add_f32_e64 v43, v211, v43
    v_cvt_pk_bf16_f32 v204, v36, v37
    v_mfma_f32_16x16x32_bf16 v[224:227], v[92:95], v[196:199], v[224:227]
    ds_read_b64 v[116:117], v2 offset:9528
    ds_read_b64 v[118:119], v2 offset:10168
    v_mfma_f32_16x16x32_bf16 v[224:227], v[154:157], v[120:123], v[224:227]
    ds_read_b128 v[196:199], v7 offset:1408
    v_cvt_pk_bf16_f32 v205, v38, v39
    v_mfma_f32_16x16x32_bf16 v[228:231], v[154:157], v[128:131], v[228:231]
    s_waitcnt lgkmcnt(5)
    v_cmp_eq_u32 vcc, 0, v11
    v_mfma_f32_16x16x32_bf16 v[232:235], v[154:157], v[136:139], v[232:235]
    s_cbranch_vccnz L_SLOW4
L_BACK4:
    s_nop 0
    v_cvt_pk_bf16_f32 v206, v40, v41
    v_cvt_pk_bf16_f32 v207, v42, v43
    v_mfma_f32_16x16x32_bf16 v[220:223], v[56:59], v[200:203], v[220:223]
    ds_read_b128 v[136:139], v7 offset:1344
    ds_read_u8 v174, v239 offset:1152
    v_mfma_f32_16x16x32_bf16 v[224:227], v[88:91], v[200:203], v[224:227]
    buffer_store_dwordx4 v[204:207], v33, s[44:47], s32 offen
    v_mfma_f32_16x16x32_bf16 v[224:227], v[162:165], v[124:127], v[224:227]
    ds_read_b128 v[200:203], v7 offset:1280
    v_mov_b32_e64 v208, -1
    v_mfma_f32_16x16x32_bf16 v[228:231], v[162:165], v[132:135], v[228:231]
    v_mov_b32 v209, -1
    v_mov_b32 v210, -1
    v_mfma_f32_16x16x32_bf16 v[232:235], v[162:165], v[140:143], v[232:235]
    v_mov_b32 v211, -1
    v_lshlrev_b32 v36, 16, v20
    v_mfma_f32_16x16x32_bf16 v[220:223], v[52:55], v[180:183], v[220:223]
    ds_read_b128 v[140:143], v7 offset:1216
    v_and_b32 v37, 0xffff0000, v20
    v_mfma_f32_16x16x32_bf16 v[224:227], v[84:87], v[180:183], v[224:227]
    buffer_store_dwordx4 v[208:211], v33, s[44:47], s34 offen
    s_waitcnt lgkmcnt(2)
    v_mfma_f32_16x16x32_bf16 v[220:223], v[48:51], v[184:187], v[220:223]
    ds_read_b128 v[180:183], v7 offset:1536
    v_lshlrev_b32 v38, 16, v21
    v_mfma_f32_16x16x32_bf16 v[224:227], v[80:83], v[184:187], v[224:227]
    buffer_store_dwordx4 v[208:211], v33, s[44:47], s35 offen
    v_mfma_f32_16x16x32_bf16 v[228:231], v[112:115], v[184:187], v[228:231]
    ds_read_b128 v[168:171], v7 offset:1152
    v_and_b32 v39, 0xffff0000, v21
    v_mfma_f32_16x16x32_bf16 v[224:227], v[76:79], v[192:195], v[224:227]
    ds_write_b128 v8, v[220:223] offset:4096
    v_mfma_f32_16x16x32_bf16 v[228:231], v[108:111], v[192:195], v[228:231]
    ds_read_b128 v[184:187], v7 offset:1552
    v_lshlrev_b32_e64 v40, 16, v22
    v_mfma_f32_16x16x32_bf16 v[224:227], v[176:179], v[116:119], v[224:227]
    ds_read_b128 v[192:195], v7 offset:1088
    v_and_b32 v41, 0xffff0000, v22
    v_mfma_f32_16x16x32_bf16 v[224:227], v[72:75], v[196:199], v[224:227]
    v_lshlrev_b32_e64 v42, 16, v23
    v_and_b32 v43, 0xffff0000, v23
    v_mfma_f32_16x16x32_bf16 v[228:231], v[104:107], v[196:199], v[228:231]
    v_add_f32 v36, v212, v36
    v_add_f32 v37, v214, v37
    v_mfma_f32_16x16x32_bf16 v[224:227], v[68:71], v[136:139], v[224:227]
    ds_read_b128 v[196:199], v7 offset:1024
    v_add_f32_e64 v38, v216, v38
    v_mfma_f32_16x16x32_bf16 v[228:231], v[100:103], v[136:139], v[228:231]
    v_add_f32 v39, v218, v39
    s_waitcnt lgkmcnt(3)
    v_mfma_f32_16x16x32_bf16 v[224:227], v[64:67], v[200:203], v[224:227]
    ds_read_b128 v[136:139], v7 offset:960
    v_add_f32_e64 v40, v213, v40
    v_mfma_f32_16x16x32_bf16 v[228:231], v[96:99], v[200:203], v[228:231]
    v_add_f32 v41, v215, v41
    v_add_f32 v42, v217, v42
    v_mfma_f32_16x16x32_bf16 v[224:227], v[60:63], v[140:143], v[224:227]
    ds_read_b128 v[200:203], v7 offset:896
    v_add_f32_e64 v43, v219, v43
    v_mfma_f32_16x16x32_bf16 v[228:231], v[92:95], v[140:143], v[228:231]
    v_cvt_pk_bf16_f32 v212, v36, v37
    v_cvt_pk_bf16_f32 v213, v38, v39
    v_mfma_f32_16x16x32_bf16 v[152:155], v[180:183], v[240:243], 0
    v_cvt_pk_bf16_f32 v214, v40, v41
    v_cvt_pk_bf16_f32 v215, v42, v43
    v_mfma_f32_16x16x32_bf16 v[156:159], v[180:183], v[252:255], 0
    ds_read_b128 v[140:143], v7 offset:832
    ds_read_u8 v239, v239 offset:1184
    v_mfma_f32_16x16x32_bf16 v[224:227], v[56:59], v[168:171], v[224:227]
    buffer_store_dwordx4 v[212:215], v33, s[44:47], s33 offen
    v_mfma_f32_16x16x32_bf16 v[228:231], v[88:91], v[168:171], v[228:231]
    ds_read_b128 v[180:183], v7 offset:768
    s_waitcnt lgkmcnt(4)
    s_nop 0
    v_mfma_f32_16x16x32_bf16 v[160:163], v[184:187], v[240:243], 0
    v_cvt_pk_bf16_f32 v154, v155, v154
    v_cvt_pk_bf16_f32 v155, v153, v152
    v_mfma_f32_16x16x32_bf16 v[164:167], v[184:187], v[252:255], 0
    ds_read_b128 v[168:171], v7 offset:704
    v_cvt_pk_bf16_f32 v157, v157, v156
    v_mfma_f32_16x16x32_bf16 v[224:227], v[52:55], v[192:195], v[224:227]
    v_cvt_pk_bf16_f32 v156, v159, v158
    v_lshlrev_b32_e64 v36, 16, v24
    v_mfma_f32_16x16x32_bf16 v[228:231], v[84:87], v[192:195], v[228:231]
    v_cvt_pk_bf16_f32 v162, v163, v162
    v_cvt_pk_bf16_f32 v163, v161, v160
    v_mfma_f32_16x16x32_bf16 v[224:227], v[48:51], v[196:199], v[224:227]
    v_cvt_pk_bf16_f32 v165, v165, v164
    v_cvt_pk_bf16_f32 v164, v167, v166
    v_mfma_f32_16x16x32_bf16 v[228:231], v[80:83], v[196:199], v[228:231]
    ds_read_b128 v[184:187], v7 offset:640
    v_and_b32 v37, 0xffff0000, v24
    v_mfma_f32_16x16x32_bf16 v[232:235], v[112:115], v[196:199], v[232:235]
    v_lshlrev_b32_e64 v38, 16, v25
    v_and_b32 v39, 0xffff0000, v25
    v_mfma_f32_16x16x32_bf16 v[228:231], v[76:79], v[136:139], v[228:231]
    ds_write_b128 v8, v[224:227] offset:5120
    v_mfma_f32_16x16x32_bf16 v[232:235], v[108:111], v[136:139], v[232:235]
    ds_write_b32 v4, v5 offset:32
    s_waitcnt lgkmcnt(3)
    v_mfma_f32_16x16x32_bf16 v[228:231], v[72:75], v[200:203], v[228:231]
    ds_read_b128 v[112:115], v7 offset:576
    v_lshlrev_b32 v40, 16, v26
    v_mfma_f32_16x16x32_bf16 v[232:235], v[104:107], v[200:203], v[232:235]
    v_and_b32 v41, 0xffff0000, v26
    v_lshlrev_b32_e64 v42, 16, v27
    v_mfma_f32_16x16x32_bf16 v[228:231], v[148:151], v[188:191], v[228:231]
    v_lshl_or_b32 v239, v239, 24, v238
    v_lshl_or_b32 v238, v174, 24, v238
    v_mfma_f32_16x16x32_bf16 v[232:235], v[244:247], v[188:191], v[232:235]
    ds_read_b32 v11, v6 offset:32
    v_lshlrev_b32_e64 v174, 2, v0
    v_mfma_f32_16x16x32_bf16 v[228:231], v[68:71], v[140:143], v[228:231]
    ds_read_b64 v[108:109], v2 offset:9560
    ds_read_b64 v[110:111], v2 offset:10200
    v_mfma_f32_16x16x32_bf16 v[232:235], v[100:103], v[140:143], v[232:235]
    v_mov_b32_e64 v172, v34
    v_and_b32 v43, 0xffff0000, v27
    v_mfma_f32_16x16x32_bf16 v[228:231], v[64:67], v[180:183], v[228:231]
    ds_read_b128 v[104:107], v7 offset:512
    ds_read_b128 v[100:103], v7 offset:1024
    v_mfma_f32_16x16x32_bf16 v[232:235], v[96:99], v[180:183], v[232:235]
    ds_read_b128 v[188:191], v7 offset:448
    ds_read_b128 v[192:195], v7 offset:1040
    v_mfma_f32_16x16x32_bf16 v[228:231], v[60:63], v[168:171], v[228:231]
    ds_read_b128 v[96:99], v7 offset:384
    ds_read_b128 v[196:199], v7 offset:320
    v_mfma_f32_16x16x32_bf16 v[232:235], v[92:95], v[168:171], v[232:235]
    s_waitcnt lgkmcnt(8)
    v_cmp_eq_u32 vcc, 0, v11
    v_mfma_f32_16x16x32_bf16 v[228:231], v[144:147], v[116:119], v[228:231]
    s_cbranch_vccnz L_SLOW2
L_BACK2:
    s_nop 0
    ds_read_b64 v[220:221], v9 offset:4096
    v_mfma_f32_16x16x32_bf16 v[232:235], v[148:151], v[116:119], v[232:235]
    ds_read_b64 v[222:223], v9 offset:12288
    ds_read_b64 v[224:225], v9 offset:20480
    v_mfma_f32_16x16x32_bf16 v[228:231], v[56:59], v[184:187], v[228:231]
    ds_read_b64 v[226:227], v9 offset:28672
    ds_read_b64 v[92:93], v2 offset:9592
    ds_read_b64 v[94:95], v2 offset:10232
    v_mfma_f32_16x16x32_bf16 v[232:235], v[88:91], v[184:187], v[232:235]
    ds_read_b128 v[116:119], v7 offset:256
    ds_read_b128 v[136:139], v7 offset:192
    v_mfma_f32_16x16x32_bf16 v[228:231], v[154:157], v[120:123], v[228:231]
    ds_read_b128 v[88:91], v7 offset:128
    ds_read_b128 v[200:203], v7 offset:64
    v_mfma_f32_16x16x32_bf16 v[232:235], v[154:157], v[128:131], v[232:235]
    ds_read_b128 v[140:143], v7 offset:0
    v_mfma_f32_16x16x32_bf16 v[228:231], v[52:55], v[112:115], v[228:231]
    v_mfma_f32_16x16x32_bf16 v[232:235], v[84:87], v[112:115], v[232:235]
    v_mfma_f32_16x16x32_bf16 v[228:231], v[162:165], v[124:127], v[228:231]
    s_waitcnt lgkmcnt(5)
    v_add_f32 v36, v220, v36
    v_mfma_f32_16x16x32_bf16 v[232:235], v[162:165], v[132:135], v[232:235]
    s_waitcnt vmcnt(0)
    v_add_f32 v37, v222, v37
    v_mfma_f32_16x16x32_bf16 v[228:231], v[176:179], v[108:111], v[228:231]
    s_mov_b64 exec, 1
    buffer_store_dword v34, off, s[44:47], s12 offset:0
    s_mov_b64 exec, -1
    v_mfma_f32_16x16x32_bf16 v[232:235], v[144:147], v[108:111], v[232:235]
    v_add_f32 v38, v224, v38
    v_add_f32 v39, v226, v39
    v_mfma_f32_16x16x32_bf16 v[228:231], v[48:51], v[104:107], v[228:231]
    v_add_f32 v40, v221, v40
    v_add_f32 v41, v223, v41
    v_mfma_f32_16x16x32_bf16 v[232:235], v[80:83], v[104:107], v[232:235]
    v_add_f32 v42, v225, v42
    v_add_f32 v43, v227, v43
    v_mfma_f32_16x16x32_bf16 v[152:155], v[100:103], v[240:243], 0
    v_cvt_pk_bf16_f32 v220, v36, v37
    v_cvt_pk_bf16_f32 v221, v38, v39
    v_mfma_f32_16x16x32_bf16 v[156:159], v[100:103], v[252:255], 0
    ds_write_b128 v8, v[228:231] offset:6144
    v_mfma_f32_16x16x32_bf16 v[232:235], v[76:79], v[188:191], v[232:235]
    v_cvt_pk_bf16_f32 v222, v40, v41
    v_cvt_pk_bf16_f32 v223, v42, v43
    v_mfma_f32_16x16x32_bf16 v[160:163], v[192:195], v[240:243], 0
    v_cvt_pk_bf16_f32 v154, v155, v154
    v_cvt_pk_bf16_f32 v155, v153, v152
    v_mfma_f32_16x16x32_bf16 v[164:167], v[192:195], v[252:255], 0
    v_cvt_pk_bf16_f32 v157, v157, v156
    v_cvt_pk_bf16_f32 v156, v159, v158
    v_mfma_f32_16x16x32_bf16 v[232:235], v[72:75], v[96:99], v[232:235]
    buffer_store_dwordx4 v[220:223], v33, s[44:47], s34 offen
    v_mfma_f32_16x16x32_bf16 v[232:235], v[68:71], v[196:199], v[232:235]
    v_cvt_pk_bf16_f32 v162, v163, v162
    v_cvt_pk_bf16_f32 v163, v161, v160
    v_mfma_f32_16x16x32_bf16 v[232:235], v[176:179], v[92:95], v[232:235]
    v_cvt_pk_bf16_f32 v165, v165, v164
    s_waitcnt lgkmcnt(0)
    v_mfma_f32_16x16x32_bf16 v[232:235], v[64:67], v[116:119], v[232:235]
    v_cvt_pk_bf16_f32 v164, v167, v166
    v_mfma_f32_16x16x32_bf16 v[232:235], v[60:63], v[136:139], v[232:235]
    v_mfma_f32_16x16x32_bf16 v[232:235], v[56:59], v[88:91], v[232:235]
    s_mov_b32 exec_hi, 0
    buffer_load_dword v172, v174, s[44:47], s42 offen sc1
    s_mov_b32 exec_hi, -1
    v_mfma_f32_16x16x32_bf16 v[232:235], v[154:157], v[120:123], v[232:235]
    v_mfma_f32_16x16x32_bf16 v[232:235], v[52:55], v[200:203], v[232:235]
    v_mfma_f32_16x16x32_bf16 v[232:235], v[162:165], v[124:127], v[232:235]
    v_mfma_f32_16x16x32_bf16 v[232:235], v[48:51], v[140:143], v[232:235]
    v_lshlrev_b32 v36, 16, v28
    v_and_b32 v37, 0xffff0000, v28
    v_lshlrev_b32_e64 v38, 16, v29
    v_and_b32 v39, 0xffff0000, v29
    v_lshlrev_b32_e64 v40, 16, v30
    v_and_b32 v41, 0xffff0000, v30
    v_lshlrev_b32_e64 v42, 16, v31
    v_and_b32 v43, 0xffff0000, v31
    ds_write_b128 v8, v[232:235] offset:7168
    ds_write_b32 v4, v5 offset:48
L_Y3W:
    ds_read_b32 v14, v6 offset:48
    ds_read_b64 v[228:229], v9 offset:6144
    ds_read_b64 v[230:231], v9 offset:14336
    ds_read_b64 v[232:233], v9 offset:22528
    ds_read_b64 v[234:235], v9 offset:30720
    s_waitcnt lgkmcnt(4)
    v_cmp_eq_u32 vcc, 0, v14
    s_cbranch_vccnz L_Y3W
    s_waitcnt lgkmcnt(0)
    v_add_f32 v36, v228, v36
    v_add_f32 v37, v230, v37
    v_add_f32 v38, v232, v38
    v_add_f32 v39, v234, v39
    v_add_f32 v40, v229, v40
    v_add_f32 v41, v231, v41
    v_add_f32 v42, v233, v42
    v_add_f32 v43, v235, v43
    v_cvt_pk_bf16_f32 v228, v36, v37
    v_cvt_pk_bf16_f32 v229, v38, v39
    v_cvt_pk_bf16_f32 v230, v40, v41
    v_cvt_pk_bf16_f32 v231, v42, v43
    buffer_store_dwordx4 v[228:231], v33, s[44:47], s35 offen
    s_cmp_lg_u32 s14, 2
    s_cbranch_scc1 L_CNL
    s_waitcnt vmcnt(1)
    v_cmp_ne_u32_e64 vcc, v34, v172
    s_cbranch_vccnz L_FAW
L_FAK:
    buffer_load_dwordx4 v[48:51], v35, s[44:47], s36 offen sc1
    buffer_load_dwordx4 v[52:55], v35, s[44:47], s37 offen sc1
    s_waitcnt vmcnt(2)
    s_mov_b64 exec, 1
    buffer_store_dword v34, off, s[44:47], s12 offset:512
    s_mov_b64 exec, -1
    s_waitcnt vmcnt(1)
L_DP:
    v_max3_u32 v56, v48, v49, v50
    v_max3_u32 v57, v52, v53, v54
    v_max_u32 v56, v56, v51
    v_max_u32 v57, v57, v55
    v_cmp_eq_u32 s[8:9], -1, v56
    v_cmp_eq_u32 s[10:11], -1, v57
    s_or_b64 vcc, s[8:9], s[10:11]
    s_cbranch_vccnz L_DR
L_DOK:
    s_mov_b64 exec, 1
    ds_write_b32 v4, v5 offset:560
    s_mov_b64 exec, -1
    ds_write_b64 v236, v[48:49] offset:0
    ds_write_b64 v236, v[50:51] offset:144
    ds_write_b64 v236, v[52:53] offset:64
    ds_write_b64 v236, v[54:55] offset:208
    ds_read_b128 v[56:59], v237 offset:0
    ds_read_b128 v[60:63], v237 offset:1152
    s_waitcnt lgkmcnt(1)
    buffer_store_dwordx4 v[56:59], v238, s[52:55], s38 offen sc1
    s_waitcnt lgkmcnt(0)
    buffer_store_dwordx4 v[60:63], v239, s[52:55], s39 offen sc1
    v_mov_b32_e64 v11, 2
    s_waitcnt vmcnt(0)
    s_mov_b64 exec, 1
    ds_write_b32 v4, v11 offset:560
    s_mov_b64 exec, -1
    s_branch L_FIN
L_DR:
    s_add_u32 s41, s41, 1
    s_cmp_ge_u32 s41, 48
    s_cbranch_scc1 L_DF
    s_cmp_eq_u64 s[8:9], 0
    s_cbranch_scc1 L_DS0
    buffer_load_dwordx4 v[48:51], v35, s[44:47], s36 offen sc1
L_DS0:
    s_cmp_eq_u64 s[10:11], 0
    s_cbranch_scc1 L_DS1
    buffer_load_dwordx4 v[52:55], v35, s[44:47], s37 offen sc1
L_DS1:
    s_waitcnt vmcnt(0)
    s_branch L_DP
L_DF:
    s_mov_b32 s41, 0
    s_mov_b32 exec_hi, 0
LT_2:
    buffer_load_dword v172, v174, s[44:47], s40 offen sc1
    s_add_u32 s41, s41, 1
    s_waitcnt vmcnt(0)
    v_cmp_ne_u32 vcc, v34, v172
    s_cbranch_vccz LT_2K
    s_sleep 1
    s_cmp_lt_u32 s41, 0x4000
    s_cbranch_scc1 LT_2
LT_2K:
    s_mov_b32 exec_hi, -1
    buffer_load_dwordx4 v[48:51], v35, s[44:47], s36 offen sc1
    buffer_load_dwordx4 v[52:55], v35, s[44:47], s37 offen sc1
    s_waitcnt vmcnt(0)
    s_branch L_DOK
L_FAW:
    s_mov_b32 s43, 0
    s_mov_b32 exec_hi, 0
LT_3:
    buffer_load_dword v172, v174, s[44:47], s42 offen sc1
    s_add_u32 s43, s43, 1
    s_waitcnt vmcnt(0)
    v_cmp_ne_u32_e64 vcc, v34, v172
    s_cbranch_vccz LT_3K
    s_sleep 1
    s_cmp_lt_u32 s43, 0x4000
    s_cbranch_scc1 LT_3
LT_3K:
    s_mov_b32 exec_hi, -1
    s_branch L_FAK
    s_branch L_FIN
L_CNL:
    v_mov_b32 v5, 2
    s_mov_b64 exec, 1
    ds_write_b32 v4, v5 offset:560
    s_mov_b64 exec, -1
    ds_read_b64 v[12:13], v10 offset:1152
    s_waitcnt lgkmcnt(0)
    v_lshlrev_b32_e64 v14, 24, v12
    v_and_or_b32 v14, v14, s68, v3
    v_lshlrev_b32_e64 v15, 16, v12
    v_and_or_b32 v15, v15, s68, v3
    buffer_store_dwordx2 v[204:205], v14, s[52:55], s60 offen offset:0
    buffer_store_dwordx2 v[206:207], v15, s[52:55], s60 offen offset:2048
    v_lshlrev_b32_e64 v14, 8, v12
    v_and_or_b32 v14, v14, s68, v3
    v_and_or_b32 v15, v12, s68, v3
    buffer_store_dwordx2 v[212:213], v14, s[52:55], s61 offen offset:0
    buffer_store_dwordx2 v[214:215], v15, s[52:55], s61 offen offset:2048
    v_lshlrev_b32_e64 v14, 24, v13
    v_and_or_b32 v14, v14, s68, v3
    v_lshlrev_b32_e64 v15, 16, v13
    v_and_or_b32 v15, v15, s68, v3
    buffer_store_dwordx2 v[220:221], v14, s[52:55], s62 offen offset:0
    buffer_store_dwordx2 v[222:223], v15, s[52:55], s62 offen offset:2048
    v_lshlrev_b32_e64 v14, 8, v13
    v_and_or_b32 v14, v14, s68, v3
    v_and_or_b32 v15, v13, s68, v3
    buffer_store_dwordx2 v[228:229], v14, s[52:55], s63 offen offset:0
    buffer_store_dwordx2 v[230:231], v15, s[52:55], s63 offen offset:2048
    s_branch L_FIN
L_SLOW0:
LW_4:
    ds_read_b32 v11, v6 offset:144
    s_waitcnt lgkmcnt(0)
    v_cmp_eq_u32_e64 vcc, 0, v11
    s_cbranch_vccnz LW_4
    s_branch L_BACK0
L_SLOW1:
LW_5:
    ds_read_b32 v11, v6 offset:16
    s_waitcnt lgkmcnt(0)
    v_cmp_eq_u32 vcc, 0, v11
    s_cbranch_vccnz LW_5
    s_branch L_BACK1
L_SLOW2:
LW_6:
    ds_read_b32 v11, v6 offset:32
    s_waitcnt lgkmcnt(0)
    v_cmp_eq_u32 vcc, 0, v11
    s_cbranch_vccnz LW_6
    s_branch L_BACK2
L_SLOW3:
LW_7:
    ds_read_b32 v11, v6 offset:160
    s_waitcnt lgkmcnt(0)
    v_cmp_eq_u32 vcc, 0, v11
    s_cbranch_vccnz LW_7
    s_branch L_BACK3
L_SLOW4:
LW_8:
    ds_read_b32 v11, v6 offset:112
    s_waitcnt lgkmcnt(0)
    v_cmp_eq_u32_e64 vcc, 0, v11
    s_cbranch_vccnz LW_8
    s_branch L_BACK4
L_XF:
    s_add_u32 s31, s31, 64
    s_buffer_load_dwordx8 s[16:23], s[44:47], s31
    ds_read_b64 v[88:89], v1 offset:640
    ds_read_b64 v[90:91], v1 offset:648
    ds_read_b64 v[92:93], v1 offset:704
    ds_read_b64 v[94:95], v1 offset:712
    ds_read_b64 v[96:97], v1 offset:768
    ds_read_b64 v[98:99], v1 offset:776
    ds_read_b64 v[100:101], v1 offset:832
    ds_read_b64 v[102:103], v1 offset:840
    ds_read_b64 v[104:105], v1 offset:896
    ds_read_b64 v[106:107], v1 offset:904
    ds_read_b64 v[108:109], v1 offset:960
    ds_read_b64 v[110:111], v1 offset:968
    ds_read_b64 v[112:113], v1 offset:1024
    ds_read_b64 v[114:115], v1 offset:1032
    ds_read_b64 v[116:117], v1 offset:1088
    ds_read_b64 v[118:119], v1 offset:1096
    ds_read_b64 v[120:121], v2 offset:10776
    ds_read_b64 v[122:123], v2 offset:11416
    ds_read_b64 v[124:125], v2 offset:12056
    ds_read_b64 v[126:127], v2 offset:12696
    ds_read_b64 v[128:129], v2 offset:10808
    ds_read_b64 v[130:131], v2 offset:11448
    ds_read_b64 v[132:133], v2 offset:12088
    ds_read_b64 v[134:135], v2 offset:12728
    ds_read_b64 v[136:137], v2 offset:10840
    ds_read_b64 v[138:139], v2 offset:11480
    ds_read_b64 v[140:141], v2 offset:12120
    ds_read_b64 v[142:143], v2 offset:12760
    s_branch L_XC
L_XP:
    s_sleep 2
    ds_read_b32 v11, v4 offset:528
    s_cmp_ge_u32 s5, 2
    s_cbranch_scc1 L_XG
    s_add_u32 s31, s31, 64
    s_buffer_load_dwordx8 s[16:23], s[44:47], s31
    s_branch L_XH
L_XG:
    s_buffer_load_dwordx8 s[16:23], s[44:47], s31 glc
L_XH:
    s_add_u32 s5, s5, 1
    s_waitcnt lgkmcnt(0)
    v_cmp_eq_u32 vcc, 1, v11
    s_cbranch_vccnz L_XSLOW
    s_cmp_ge_u32 s5, 0x4000
    s_cbranch_scc1 L_XSLOW
L_XC:
    s_waitcnt lgkmcnt(0)
    s_xor_b64 s[16:17], s[16:17], s[28:29]
    s_xor_b64 s[18:19], s[18:19], s[28:29]
    s_xor_b64 s[20:21], s[20:21], s[28:29]
    s_xor_b64 s[22:23], s[22:23], s[28:29]
    s_or_b64 s[16:17], s[16:17], s[18:19]
    s_or_b64 s[20:21], s[20:21], s[22:23]
    s_or_b64 s[16:17], s[16:17], s[20:21]
    s_cbranch_scc1 L_XP
    s_setprio 3
    buffer_load_dwordx4 v[16:19], v33, s[44:47], s32 offen sc1
    buffer_load_dwordx4 v[20:23], v33, s[44:47], s33 offen sc1
    buffer_load_dwordx4 v[24:27], v33, s[44:47], s34 offen sc1
    buffer_load_dwordx4 v[28:31], v33, s[44:47], s35 offen sc1
    s_mov_b64 exec, 1
    ds_write_b32 v4, v5 offset:544
    s_mov_b64 exec, -1
    s_setprio 2
    s_branch L_XBACK
L_XSLOW:
    s_nop 0
    buffer_load_dwordx2 v[16:17], v3, s[48:51], s60 offen offset:0
    buffer_load_dwordx2 v[18:19], v3, s[48:51], s60 offen offset:2048
    buffer_load_dwordx2 v[20:21], v3, s[48:51], s61 offen offset:0
    buffer_load_dwordx2 v[22:23], v3, s[48:51], s61 offen offset:2048
    buffer_load_dwordx2 v[24:25], v3, s[48:51], s62 offen offset:0
    buffer_load_dwordx2 v[26:27], v3, s[48:51], s62 offen offset:2048
    buffer_load_dwordx2 v[28:29], v3, s[48:51], s63 offen offset:0
    buffer_load_dwordx2 v[30:31], v3, s[48:51], s63 offen offset:2048
    s_waitcnt vmcnt(0)
    s_branch L_XBACK
L_F0:
    s_setprio 2
    s_mov_b32 s61, 7864320
    s_lshl_b32 s7, s2, 2
    s_add_u32 s7, s7, s3
    s_lshl_b32 s13, s2, 6
    s_add_u32 s13, s13, 7864320
    s_lshl_b32 s8, s7, 12
    v_and_b32 v10, 31, v0
    v_lshlrev_b32 v10, 4, v10
    v_lshrrev_b32 v11, 5, v0
    v_lshl_add_u32 v11, v11, 11, v10
    v_add_u32 v11, s8, v11
    s_cmp_lt_u32 s6, 28
    s_cselect_b32 s69, 1, 0
    s_lshr_b32 s8, s6, 2
    s_add_u32 s9, s5, 3
    s_and_b32 s9, s9, 7
    s_min_u32 s9, s9, 6
    s_cmp_lt_u32 s6, 28
    s_cselect_b32 s8, s8, s9
    s_mul_i32 s59, s5, 7
    s_add_u32 s59, s59, s8
    s_and_b32 s68, s6, 3
    s_lshl_b32 s8, s68, 2
    s_add_u32 s8, s8, s3
    s_lshl_b32 s8, s8, 6
    s_xor_b32 s9, s69, 1
    s_lshl_b32 s9, s9, 5
    s_add_u32 s8, s8, s9
    v_lshrrev_b32_e64 v12, 4, v0
    v_lshl_add_u32 v12, v12, 3, s8
    v_lshlrev_b32 v9, 1, v12
    s_movk_i32 s10, 7168
    v_mul_u32_u24 v14, s10, v12
    v_and_b32 v12, 7, v0
    v_lshl_add_u32 v14, v12, 4, v14
    s_lshl_b32 s8, s59, 7
    v_add_u32 v14, s8, v14
    v_and_b32 v12, 8, v0
    v_cmp_ne_u32_e64 vcc, 0, v12
    s_waitcnt lgkmcnt(0)
    global_load_dwordx4 v[16:19], v11, s[16:17] offset:0
    global_load_dwordx4 v[20:23], v11, s[16:17] offset:512
    global_load_dwordx4 v[24:27], v11, s[16:17] offset:1024
    global_load_dwordx4 v[28:31], v11, s[16:17] offset:1536
    s_load_dword s56, s[42:43], 0
    global_load_dwordx4 v[32:35], v10, s[32:33] offset:0
    global_load_dwordx4 v[36:39], v10, s[32:33] offset:512
    global_load_dwordx4 v[40:43], v10, s[32:33] offset:1024
    global_load_dwordx4 v[44:47], v10, s[32:33] offset:1536
    v_mov_b32 v12, s34
    v_mov_b32 v13, s35
    v_mov_b32 v10, s36
    v_mov_b32 v11, s37
    v_cndmask_b32 v12, v12, v10, vcc
    v_cndmask_b32 v13, v13, v11, vcc
    v_add_co_u32 v220, vcc, v12, v14
    s_movk_i32 s20, 7168
    s_mov_b32 s21, 0
    v_addc_co_u32 v221, vcc, 0, v13, vcc
    s_barrier
    s_mov_b32 s48, s16
    s_and_b32 s49, s17, 0xffff
    s_mov_b32 s50, 0x400000
    s_mov_b32 s51, 0x20000
    s_mov_b32 s52, s40
    s_and_b32 s53, s41, 0xffff
    s_mov_b32 s54, 0x400000
    s_mov_b32 s55, 0x20000
    s_lshl_b32 s8, s6, 17
    s_lshl_b32 s9, s3, 15
    s_add_u32 s8, s8, s9
    s_lshl_b32 s9, s5, 8
    s_add_u32 s8, s8, s9
    s_add_u32 s9, s8, 4096
    v_lshrrev_b32 v10, 4, v0
    v_and_b32 v11, 15, v0
    v_lshlrev_b32_e64 v11, 4, v11
    v_lshl_add_u32 v14, v10, 13, v11
    buffer_load_dwordx4 v[64:67], v14, s[48:51], s8 offen offset:0
    buffer_load_dwordx4 v[68:71], v14, s[48:51], s8 offen offset:2048
    buffer_load_dwordx4 v[72:75], v14, s[48:51], s9 offen offset:0
    buffer_load_dwordx4 v[76:79], v14, s[48:51], s9 offen offset:2048
    s_mul_i32 s8, s3, 4608
    s_add_u32 s8, s8, 121856
    s_movk_i32 s9, 1088
    v_mad_u32_u24 v96, v10, s9, v11
    v_add_u32 v96, s8, v96
    v_and_b32 v10, 7, v0
    v_lshrrev_b32_e64 v11, 3, v0
    s_movk_i32 s9, 544
    v_lshl_add_u32 v97, v11, 3, s8
    v_mad_u32_u24 v97, v10, s9, v97
    v_lshlrev_b32_e64 v98, 4, v10
    v_lshl_add_u32 v98, v11, 14, v98
    s_lshl_b32 s18, s5, 19
    s_lshl_b32 s9, s6, 9
    s_add_u32 s18, s18, s9
    s_lshl_b32 s9, s3, 7
    s_add_u32 s18, s18, s9
    s_add_u32 s18, s18, 3145728
    s_getreg_b32 s19, hwreg(HW_REG_XCC_ID, 0, 4)
    s_mov_b32 s22, 179200
    s_cmp_eq_u32 s69, 1
    s_cselect_b32 s22, s22, 0xfffbbc00
    s_cselect_b32 s23, 0, -1
    s_lshl_b32 s62, s5, 2
    s_bfe_u32 s9, s6, 0x20001
    s_add_u32 s62, s62, s9
    s_lshl_b32 s62, s62, 12
    s_lshr_b32 s9, s6, 3
    s_lshl_b32 s9, s9, 1
    s_add_u32 s62, s62, s9
    s_and_b32 s9, s6, 1
    s_add_u32 s62, s62, s9
    s_lshl_b32 s62, s62, 2
    s_add_u32 s62, s62, 7340032
    s_lshl_b32 s19, s19, 1
    s_lshl_b32 s9, s5, 2
    s_lshl_b32 s40, 15, s9
    s_mov_b32 s41, s40
    s_mov_b32 s44, s42
    s_and_b32 s45, s43, 0xffff
    s_mov_b32 s46, 0x1000000
    s_mov_b32 s47, 0x20000
    s_mov_b32 s24, s38
    s_and_b32 s25, s39, 0xffff
    s_mov_b32 s26, 0x700000
    s_mov_b32 s27, 0x20000
    s_lshl_b32 s7, s3, 2
    v_mov_b32 v2, s7
    v_and_b32 v11, 3, v0
    v_lshlrev_b32 v1, 2, v11
    v_mov_b32 v5, 1
    s_lshl_b32 s8, s3, 6
    v_add_u32 v14, s8, v0
    v_lshlrev_b32 v226, 4, v14
    v_lshlrev_b32 v105, 4, v11
    v_lshrrev_b32_e64 v63, 2, v0
    v_lshl_add_u32 v63, v63, 14, v105
    s_lshl_b32 s4, s5, 14
    v_add_u32 v223, 0, v226
    s_mov_b32 s5, 7868416
    s_mov_b32 s6, 7872512
    s_mov_b32 s7, 7876608
    s_cmp_lg_u32 s3, 0
    s_cbranch_scc1 L_NOZ
    v_lshlrev_b32 v224, 4, v0
    v_mov_b32 v228, 0
    v_mov_b32 v229, 0
    v_mov_b32 v230, 0
    v_mov_b32_e64 v231, 0
    ds_write_b128 v224, v[228:231] offset:1024
    ds_write_b128 v224, v[228:231] offset:2048
    ds_write_b128 v224, v[228:231] offset:3072
L_NOZ:
    s_lshl_b32 s4, s3, 6
    v_add_u32 v14, s4, v0
    v_lshlrev_b32_e64 v15, 4, v14
    s_mov_b32 s64, 0x05040100
    s_mov_b32 s65, 0x07060302
    v_lshlrev_b32 v224, 4, v0
    v_and_b32 v10, 15, v0
    v_lshlrev_b32 v10, 2, v10
    v_and_b32 v11, 48, v0
    s_movk_i32 s4, 0xfff
    v_lshlrev_b32 v248, 1, v14
    v_sub_u32 v248, s4, v248
    v_subrev_u32 v249, 1, v248
    v_subrev_u32 v250, 512, v248
    v_subrev_u32 v251, 513, v248
    v_subrev_u32 v252, 1024, v248
    v_subrev_u32 v253, 1025, v248
    v_subrev_u32 v254, 1536, v248
    v_subrev_u32 v255, 1537, v248
    v_lshlrev_b32 v227, 3, v14
    v_lshrrev_b32 v225, 4, v14
    v_lshlrev_b32 v225, 2, v225
    v_lshlrev_b32_e64 v14, 2, v14
    s_mov_b32 s16, 0
    s_mov_b32 s17, 0xffff0000
    v_lshlrev_b32 v3, 3, v11
    s_lshl_b32 s8, s3, 12
    s_add_u32 s8, s8, 140288
    v_add_u32 v3, s8, v3
    v_lshrrev_b32 v12, 5, v0
    v_lshlrev_b32_e64 v4, 7, v12
    v_bfe_u32 v12, v0, 4, 1
    v_lshl_add_u32 v4, v12, 3, v4
    v_bfe_u32 v12, v0, 3, 1
    v_lshl_add_u32 v4, v12, 9, v4
    v_and_b32_e64 v12, 7, v0
    v_lshl_add_u32 v4, v12, 4, v4
    s_lshl_b32 s8, s3, 10
    s_add_u32 s8, s8, 140288
    v_add_u32 v4, s8, v4
    v_bfe_u32 v12, v0, 4, 1
    v_lshlrev_b32 v12, 16, v12
    v_lshrrev_b32 v13, 5, v0
    v_lshl_add_u32 v12, v13, 12, v12
    v_lshl_add_u32 v222, v10, 1, v12
    s_lshl_b32 s10, s59, 17
    s_lshl_b32 s11, s68, 9
    s_add_u32 s10, s10, s11
    s_lshl_b32 s11, s3, 7
    s_add_u32 s10, s10, s11
    s_and_b32 s9, s2, 7
    s_add_u32 s9, s9, 56
    s_cmp_eq_u32 s69, 1
    s_cselect_b32 s33, s59, s9
    s_lshl_b32 s33, s33, 2
    s_add_u32 s33, s33, s68
    s_lshl_b32 s33, s33, 2
    s_add_u32 s33, s33, s3
    s_lshl_b32 s33, s33, 11
    s_add_u32 s33, s33, 1048576
    v_mov_b32_e64 v218, 0
    s_cmp_eq_u32 s69, 1
    s_cselect_b64 exec, -1, 1
    buffer_store_dwordx4 v[216:219], v224, s[44:47], s33 offen offset:0
    buffer_store_dwordx4 v[216:219], v224, s[44:47], s33 offen offset:1024
    s_mov_b64 exec, -1
    s_mov_b32 s8, 0x3f803f80
    s_waitcnt vmcnt(10)
    v_dot2_f32_bf16 v48, v16, s8, 0
    v_dot2_f32_bf16 v49, v16, v16, 0
    v_dot2_f32_bf16 v48, v17, s8, v48
    v_dot2_f32_bf16 v49, v17, v17, v49
    v_dot2_f32_bf16 v48, v18, s8, v48
    v_dot2_f32_bf16 v49, v18, v18, v49
    v_dot2_f32_bf16 v48, v19, s8, v48
    v_dot2_f32_bf16 v49, v19, v19, v49
    v_dot2_f32_bf16 v48, v20, s8, v48
    v_dot2_f32_bf16 v49, v20, v20, v49
    v_dot2_f32_bf16 v48, v21, s8, v48
    v_dot2_f32_bf16 v49, v21, v21, v49
    v_dot2_f32_bf16 v48, v22, s8, v48
    v_dot2_f32_bf16 v49, v22, v22, v49
    v_dot2_f32_bf16 v48, v23, s8, v48
    v_dot2_f32_bf16 v49, v23, v23, v49
    v_dot2_f32_bf16 v48, v24, s8, v48
    v_dot2_f32_bf16 v49, v24, v24, v49
    v_dot2_f32_bf16 v48, v25, s8, v48
    v_dot2_f32_bf16 v49, v25, v25, v49
    v_dot2_f32_bf16 v48, v26, s8, v48
    v_dot2_f32_bf16 v49, v26, v26, v49
    v_dot2_f32_bf16 v48, v27, s8, v48
    v_dot2_f32_bf16 v49, v27, v27, v49
    v_dot2_f32_bf16 v48, v28, s8, v48
    v_dot2_f32_bf16 v49, v28, v28, v49
    v_dot2_f32_bf16 v48, v29, s8, v48
    v_dot2_f32_bf16 v49, v29, v29, v49
    v_dot2_f32_bf16 v48, v30, s8, v48
    v_dot2_f32_bf16 v49, v30, v30, v49
    v_dot2_f32_bf16 v48, v31, s8, v48
    v_dot2_f32_bf16 v49, v31, v31, v49
    s_waitcnt lgkmcnt(0)
    s_mul_i32 s56, s56, 0x9E3779B1
    s_add_u32 s56, s56, 0x7F4A7C15
    s_or_b32 s56, s56, 1
    s_andn2_b32 s56, s56, 0x1e
    s_or_b32 s63, s19, s56
    v_mov_b32 v59, s63
    s_waitcnt vmcnt(6)
    v_dot2_f32_bf16 v50, v16, v32, 0
    v_dot2_f32_bf16 v51, v32, s8, 0
    v_dot2_f32_bf16 v50, v17, v33, v50
    v_dot2_f32_bf16 v51, v33, s8, v51
    v_dot2_f32_bf16 v50, v18, v34, v50
    v_dot2_f32_bf16 v51, v34, s8, v51
    v_dot2_f32_bf16 v50, v19, v35, v50
    v_dot2_f32_bf16 v51, v35, s8, v51
    v_dot2_f32_bf16 v50, v20, v36, v50
    v_dot2_f32_bf16 v51, v36, s8, v51
    v_dot2_f32_bf16 v50, v21, v37, v50
    v_dot2_f32_bf16 v51, v37, s8, v51
    v_dot2_f32_bf16 v50, v22, v38, v50
    v_dot2_f32_bf16 v51, v38, s8, v51
    v_dot2_f32_bf16 v50, v23, v39, v50
    v_dot2_f32_bf16 v51, v39, s8, v51
    v_dot2_f32_bf16 v50, v24, v40, v50
    v_dot2_f32_bf16 v51, v40, s8, v51
    v_dot2_f32_bf16 v50, v25, v41, v50
    v_dot2_f32_bf16 v51, v41, s8, v51
    v_dot2_f32_bf16 v50, v26, v42, v50
    v_dot2_f32_bf16 v51, v42, s8, v51
    v_dot2_f32_bf16 v50, v27, v43, v50
    v_dot2_f32_bf16 v51, v43, s8, v51
    v_dot2_f32_bf16 v50, v28, v44, v50
    v_dot2_f32_bf16 v51, v44, s8, v51
    v_dot2_f32_bf16 v50, v29, v45, v50
    v_dot2_f32_bf16 v51, v45, s8, v51
    v_dot2_f32_bf16 v50, v30, v46, v50
    v_dot2_f32_bf16 v51, v46, s8, v51
    v_dot2_f32_bf16 v50, v31, v47, v50
    v_dot2_f32_bf16 v51, v47, s8, v51
    s_nop 0
    s_nop 0
    v_add_f32_dpp v48, v48, v48 row_shr:1 row_mask:0xf bank_mask:0xf
    v_add_f32_dpp v49, v49, v49 row_shr:1 row_mask:0xf bank_mask:0xf
    v_add_f32_dpp v50, v50, v50 row_shr:1 row_mask:0xf bank_mask:0xf
    v_add_f32_dpp v51, v51, v51 row_shr:1 row_mask:0xf bank_mask:0xf
    v_add_f32_dpp v48, v48, v48 row_shr:2 row_mask:0xf bank_mask:0xf
    v_add_f32_dpp v49, v49, v49 row_shr:2 row_mask:0xf bank_mask:0xf
    v_add_f32_dpp v50, v50, v50 row_shr:2 row_mask:0xf bank_mask:0xf
    v_add_f32_dpp v51, v51, v51 row_shr:2 row_mask:0xf bank_mask:0xf
    v_add_f32_dpp v48, v48, v48 row_shr:4 row_mask:0xf bank_mask:0xf
    v_add_f32_dpp v49, v49, v49 row_shr:4 row_mask:0xf bank_mask:0xf
    v_add_f32_dpp v50, v50, v50 row_shr:4 row_mask:0xf bank_mask:0xf
    v_add_f32_dpp v51, v51, v51 row_shr:4 row_mask:0xf bank_mask:0xf
    v_add_f32_dpp v48, v48, v48 row_shr:8 row_mask:0xf bank_mask:0xf
    v_add_f32_dpp v49, v49, v49 row_shr:8 row_mask:0xf bank_mask:0xf
    v_add_f32_dpp v50, v50, v50 row_shr:8 row_mask:0xf bank_mask:0xf
    v_add_f32_dpp v51, v51, v51 row_shr:8 row_mask:0xf bank_mask:0xf
    v_add_f32_dpp v48, v48, v48 row_bcast:15 row_mask:0xa bank_mask:0xf
    v_add_f32_dpp v49, v49, v49 row_bcast:15 row_mask:0xa bank_mask:0xf
    v_add_f32_dpp v50, v50, v50 row_bcast:15 row_mask:0xa bank_mask:0xf
    v_add_f32_dpp v51, v51, v51 row_bcast:15 row_mask:0xa bank_mask:0xf
    v_mul_f32 v48, 0x3a800000, v48
    v_mul_f32 v49, 0x3a800000, v49
    v_cvt_pk_bf16_f32 v52, v48, v48
    v_fma_f32 v49, -v48, v48, v49
    v_max_f32_e64 v49, 0, v49
    v_and_b32 v53, 0xffff0000, v52
    v_cvt_pk_bf16_f32 v49, v49, v49
    v_and_b32 v49, 0xffff0000, v49
    v_add_f32 v49, 0x3727c5ac, v49
    v_fma_f32 v50, -v53, v51, v50
    v_cvt_pk_bf16_f32 v49, v49, v49
    v_and_b32 v49, 0xffff0000, v49
    v_sqrt_f32 v49, v49
    v_lshlrev_b32 v104, 2, v2
    v_mov_b32 v61, 0
    v_and_b32 v62, 62, v0
    v_mad_u32_u24 v62, v62, 3, v0
    v_lshlrev_b32_e64 v62, 6, v62
    v_cvt_pk_bf16_f32 v54, v49, v49
    v_and_b32 v49, 0xffff0000, v54
    v_rcp_f32 v49, v49
    s_nop 0
    v_mul_f32_e64 v50, v50, v49
    v_cvt_pk_bf16_f32 v50, v50, v50
    v_bfe_i32 v51, v50, 15, 1
    v_or_b32 v51, 0x80008000, v51
    v_xor_b32_e64 v55, v50, v51
    s_mov_b32 s8, 0xffff
    v_mov_b32_dpp v56, v52 row_bcast:31 row_mask:0x8 bank_mask:0xf
    v_mov_b32_dpp v57, v54 row_bcast:31 row_mask:0x8 bank_mask:0xf
    v_mov_b32_dpp v58, v55 row_bcast:31 row_mask:0x8 bank_mask:0xf
    v_bfi_b32 v56, s8, v56, v52
    v_bfi_b32 v57, s8, v57, v54
    v_bfi_b32 v58, s8, v58, v55
    s_brev_b64 exec, 1
    ds_write_b128 v104, v[56:59] offset:576
    ds_add_rtn_u32 v60, v61, v5 offset:512
    s_mov_b64 exec, -1
    s_waitcnt lgkmcnt(0)
    v_readlane_b32 s8, v60, 63
    s_cmp_lg_u32 s8, 3
    s_cbranch_scc1 L_NOPUB
    s_bfm_b64 exec, 4, 0
    ds_read_b128 v[52:55], v105 offset:576
    s_waitcnt lgkmcnt(0)
    buffer_store_dwordx4 v[52:55], v63, s[44:47], s13 offen sc1
    ds_write_b32 v61, v5 offset:516
    s_mov_b64 exec, -1
    s_waitcnt vmcnt(3)
    s_branch L_PUB2
L_NOPUB:
    s_waitcnt vmcnt(2)
L_PUB2:
    s_nop 0
    ds_write_b128 v96, v[64:67] offset:0
    ds_write_b128 v96, v[68:71] offset:272
    ds_write_b128 v96, v[72:75] offset:544
    ds_write_b128 v96, v[76:79] offset:816
    ds_read_b64 v[80:81], v97 offset:0
    ds_read_b64 v[82:83], v97 offset:272
    ds_read_b64 v[84:85], v97 offset:64
    ds_read_b64 v[86:87], v97 offset:336
    ds_read_b64 v[88:89], v97 offset:128
    ds_read_b64 v[90:91], v97 offset:400
    ds_read_b64 v[92:93], v97 offset:192
    ds_read_b64 v[94:95], v97 offset:464
    s_waitcnt lgkmcnt(6)
    buffer_store_dwordx4 v[80:83], v98, s[44:47], s18 offen
    s_add_u32 s18, s18, 0x20000
    s_waitcnt lgkmcnt(4)
    buffer_store_dwordx4 v[84:87], v98, s[44:47], s18 offen
    s_add_u32 s18, s18, 0x20000
    s_waitcnt lgkmcnt(2)
    buffer_store_dwordx4 v[88:91], v98, s[44:47], s18 offen
    s_add_u32 s18, s18, 0x20000
    s_waitcnt lgkmcnt(0)
    buffer_store_dwordx4 v[92:95], v98, s[44:47], s18 offen
    s_add_u32 s18, s18, 0x20000
    s_mov_b64 exec, 1
    ds_write_b32 v2, v59 offset:128
    s_mov_b64 exec, -1
LW_9:
    ds_read_b32 v60, v61 offset:516
    s_waitcnt lgkmcnt(0)
    v_cmp_eq_u32_e64 vcc, 0, v60
    s_cbranch_vccnz LW_9
    s_waitcnt vmcnt(0)
    s_mov_b64 exec, 1
    ds_add_rtn_u32 v60, v61, v5 offset:520
    s_waitcnt lgkmcnt(0)
    v_readfirstlane_b32 s8, v60
    s_cmp_lg_u32 s8, 3
    s_mov_b64 exec, -1
    s_cbranch_scc1 L_NOXF
    s_nop 0
    buffer_store_dword v59, v62, s[44:47], s62 offen offset:0
    buffer_store_dword v59, v62, s[44:47], s62 offen offset:128
    buffer_store_dword v59, v62, s[44:47], s62 offen offset:256
L_NOXF:
    global_load_dwordx4 v[112:115], v[220:221], off
    v_lshl_add_u64 v[220:221], s[20:21], 0, v[220:221]
    global_load_dwordx4 v[116:119], v[220:221], off
    v_lshl_add_u64 v[220:221], s[20:21], 0, v[220:221]
    global_load_dwordx4 v[120:123], v[220:221], off
    v_lshl_add_u64 v[220:221], s[20:21], 0, v[220:221]
    global_load_dwordx4 v[124:127], v[220:221], off
    v_lshl_add_u64 v[220:221], s[20:21], 0, v[220:221]
    buffer_load_dwordx4 v[32:35], v223, s[44:47], s61 offen sc1
    buffer_load_dwordx4 v[36:39], v223, s[44:47], s5 offen sc1
    buffer_load_dwordx4 v[40:43], v223, s[44:47], s6 offen sc1
    buffer_load_dwordx4 v[44:47], v223, s[44:47], s7 offen sc1
    s_waitcnt vmcnt(4)
    global_load_dwordx4 v[128:131], v[220:221], off
    v_lshl_add_u64 v[220:221], s[20:21], 0, v[220:221]
    s_waitcnt vmcnt(1)
    s_branch L_KPW
L_KP:
    s_sleep 1
L_KQ2:
    s_mov_b64 exec, s[30:31]
    s_cbranch_execz L_KS0
    buffer_load_dwordx4 v[32:35], v223, s[44:47], s61 offen sc1
L_KS0:
    s_mov_b64 exec, s[8:9]
    s_cbranch_execz L_KS1
    buffer_load_dwordx4 v[36:39], v223, s[44:47], s5 offen sc1
L_KS1:
    s_mov_b64 exec, s[14:15]
    s_cbranch_execz L_KS2
    buffer_load_dwordx4 v[40:43], v223, s[44:47], s6 offen sc1
L_KS2:
    s_mov_b64 exec, s[28:29]
    s_cbranch_execz L_KS3
    buffer_load_dwordx4 v[44:47], v223, s[44:47], s7 offen sc1
L_KS3:
    s_mov_b64 exec, -1
    s_waitcnt vmcnt(0)
L_KPW:
    s_add_u32 s16, s16, 1
    v_xor_b32 v16, s63, v35
    v_xor_b32 v17, s63, v39
    v_xor_b32 v18, s63, v43
    v_xor_b32_e64 v19, s63, v47
    v_cmp_lt_u32 s[30:31], 31, v16
    v_cmp_lt_u32 s[8:9], 31, v17
    v_cmp_lt_u32 s[14:15], 31, v18
    v_cmp_lt_u32 s[28:29], 31, v19
    v_or3_b32 v16, v16, v17, v18
    s_or_b64 vcc, s[30:31], s[8:9]
    s_or_b64 s[66:67], s[14:15], s[28:29]
    s_or_b64 vcc, vcc, s[66:67]
    s_cbranch_vccz L_KPOK
    s_cmp_lt_u32 s16, 0x4000
    s_cbranch_scc1 L_KP
L_KPOK:
    v_or_b32 v16, v16, v19
    v_cmp_ne_u32 vcc, 0, v16
    s_and_b64 vcc, vcc, s[40:41]
    s_cselect_b32 s8, 1, 2
    v_mov_b32 v16, s8
    ds_read_b32 v17, v1 offset:544
    ds_write2st64_b64 v227, v[32:33], v[36:37] offset0:18 offset1:22
    ds_write2st64_b64 v227, v[40:41], v[44:45] offset0:26 offset1:30
    s_mov_b64 exec, 1
    ds_write_b32 v2, v16 offset:528
    s_mov_b64 exec, -1
    v_lshl_or_b32 v248, v34, 16, v248
    v_and_or_b32 v249, v34, s17, v249
    v_lshl_or_b32 v250, v38, 16, v250
    v_and_or_b32 v251, v38, s17, v251
    v_lshl_or_b32 v252, v42, 16, v252
    v_and_or_b32 v253, v42, s17, v253
    v_lshl_or_b32 v254, v46, 16, v254
    v_and_or_b32 v255, v46, s17, v255
    s_waitcnt lgkmcnt(3)
    v_cmp_eq_u32 s[66:67], 0, v17
    s_cmp_lg_u32 s66, 0
    s_cbranch_scc1 L_NB0
    s_nop 0
    global_load_dwordx4 v[132:135], v[220:221], off
    v_lshl_add_u64 v[220:221], s[20:21], 0, v[220:221]
    global_load_dwordx4 v[136:139], v[220:221], off
    v_lshl_add_u64 v[220:221], s[20:21], 0, v[220:221]
    global_load_dwordx4 v[140:143], v[220:221], off
    v_lshl_add_u64 v[220:221], s[22:23], 0, v[220:221]
L_NB0:
    v_max_u32 v226, v248, v249
    v_min_u32 v227, v248, v249
    v_max_u32 v228, v252, v253
    v_min_u32 v229, v252, v253
    v_med3_u32 v227, v226, v227, v250
    v_med3_u32 v229, v228, v229, v254
    v_max_u32 v226, v226, v250
    v_max_u32 v228, v228, v254
    v_med3_u32 v227, v226, v227, v251
    v_med3_u32 v229, v228, v229, v255
    v_max_u32 v226, v226, v251
    v_max_u32 v228, v228, v255
    v_min_u32 v230, v226, v228
    v_max_u32 v226, v226, v228
    v_max3_u32 v227, v227, v229, v230
    ds_write_b32 v14, v226 offset:8192
    ds_read_b32 v17, v1 offset:544
    v_add_u32 v15, 4096, v15
    v_max_u32_dpp v226, v226, v226 row_shr:1 row_mask:0xf bank_mask:0xf
    v_max_u32_dpp v227, v227, v227 row_shr:1 row_mask:0xf bank_mask:0xf
    ds_write2_b32 v15, v34, v38 offset0:0 offset1:1
    v_max_u32_dpp v226, v226, v226 row_shr:2 row_mask:0xf bank_mask:0xf
    v_max_u32_dpp v227, v227, v227 row_shr:2 row_mask:0xf bank_mask:0xf
    ds_write2_b32 v15, v42, v46 offset0:2 offset1:3
    v_max_u32_dpp v226, v226, v226 row_shr:4 row_mask:0xf bank_mask:0xf
    v_max_u32_dpp v227, v227, v227 row_shr:4 row_mask:0xf bank_mask:0xf
    s_nop 0
    s_nop 0
    v_max_u32_dpp v226, v226, v226 row_shr:8 row_mask:0xf bank_mask:0xf
    v_max_u32_dpp v227, v227, v227 row_shr:8 row_mask:0xf bank_mask:0xf
    s_mov_b32 exec_lo, 0x80008000
    s_mov_b32 exec_hi, 0x80008000
    ds_write2_b32 v225, v226, v227 offset0:96 offset1:112
    s_mov_b64 exec, 1
    ds_write_b32 v2, v16 offset:64
    s_mov_b64 exec, -1
    s_waitcnt lgkmcnt(4)
    v_cmp_eq_u32 vcc, 0, v17
    s_mov_b32 s67, vcc_lo
    s_cbranch_vccnz L_NB1
    s_cmp_eq_u32 s66, 0
    s_cbranch_scc1 L_NB2
    global_load_dwordx4 v[132:135], v[220:221], off
    v_lshl_add_u64 v[220:221], s[20:21], 0, v[220:221]
    global_load_dwordx4 v[136:139], v[220:221], off
    v_lshl_add_u64 v[220:221], s[20:21], 0, v[220:221]
    global_load_dwordx4 v[140:143], v[220:221], off
    v_lshl_add_u64 v[220:221], s[22:23], 0, v[220:221]
L_NB2:
    global_load_dwordx4 v[144:147], v[220:221], off
    v_lshl_add_u64 v[220:221], s[20:21], 0, v[220:221]
    global_load_dwordx4 v[148:151], v[220:221], off
    v_lshl_add_u64 v[220:221], s[20:21], 0, v[220:221]
    global_load_dwordx4 v[152:155], v[220:221], off
    v_lshl_add_u64 v[220:221], s[20:21], 0, v[220:221]
L_NB1:
LW_10:
    ds_read_b32 v225, v1 offset:64
    s_waitcnt lgkmcnt(0)
    v_cmp_eq_u32_e64 vcc, 0, v225
    s_cbranch_vccnz LW_10
    v_cmp_ne_u32 s[12:13], 2, v225
    ds_read2_b32 v[226:227], v10 offset0:96 offset1:112
    ds_read_b128 v[228:231], v11 offset:384
    ds_read_b128 v[232:235], v224 offset:8192
    s_waitcnt lgkmcnt(1)
    v_cmp_gt_u32 vcc, v228, v226
    v_cmp_gt_u32 s[8:9], v229, v226
    v_cmp_gt_u32 s[14:15], v230, v226
    v_cmp_gt_u32 s[28:29], v231, v226
    v_cndmask_b32 v236, 0, 1, vcc
    v_cndmask_b32 v237, 0, 1, s[8:9]
    v_addc_co_u32 v236, vcc, 0, v236, s[14:15]
    v_addc_co_u32 v236, vcc, v237, v236, s[28:29]
    v_mov_b32 v237, v236
    s_nop 1
    v_permlane32_swap_b32 v236, v237
    v_add_u32 v236, v236, v237
    v_mov_b32 v237, v236
    s_nop 1
    v_permlane16_swap_b32 v236, v237
    v_add_u32 v236, v236, v237
    v_cmp_eq_u32 vcc, 7, v236
    s_ff1_i32_b32 s5, vcc_lo
    v_readlane_b32 s4, v226, s5
    s_waitcnt lgkmcnt(0)
    s_nop 0
    v_cmp_le_u32 vcc, s4, v227
    s_cbranch_vccnz L_SLOWT
L_CAND:
    v_cmp_le_u32 s[8:9], s4, v232
    v_cmp_le_u32 s[14:15], s4, v233
    v_cmp_le_u32 s[28:29], s4, v234
    v_cmp_le_u32 s[30:31], s4, v235
    s_bcnt1_i32_b64 s5, s[8:9]
    s_bcnt1_i32_b64 s6, s[14:15]
    s_bcnt1_i32_b64 s7, s[28:29]
    s_bcnt1_i32_b64 s16, s[30:31]
    s_add_u32 s6, s6, s5
    s_add_u32 s7, s7, s6
    s_add_u32 s16, s16, s7
    s_cmp_gt_u32 s16, 16
    s_cbranch_scc1 L_TRIM
    v_mbcnt_lo_u32_b32 v236, s8, 0
    v_mbcnt_hi_u32_b32 v236, s9, v236
    v_add_lshl_u32 v236, v236, 0, 2
    s_mov_b64 exec, s[8:9]
    ds_write_b32 v236, v232 offset:192
    s_mov_b64 exec, -1
    v_mbcnt_lo_u32_b32 v237, s14, 0
    v_mbcnt_hi_u32_b32 v237, s15, v237
    v_add_lshl_u32 v237, v237, s5, 2
    s_mov_b64 exec, s[14:15]
    ds_write_b32 v237, v233 offset:192
    s_mov_b64 exec, -1
    v_mbcnt_lo_u32_b32 v238, s28, 0
    v_mbcnt_hi_u32_b32 v238, s29, v238
    v_add_lshl_u32 v238, v238, s6, 2
    s_mov_b64 exec, s[28:29]
    ds_write_b32 v238, v234 offset:192
    s_mov_b64 exec, -1
    v_mbcnt_lo_u32_b32 v239, s30, 0
    v_mbcnt_hi_u32_b32 v239, s31, v239
    v_add_lshl_u32 v239, v239, s7, 2
    s_mov_b64 exec, s[30:31]
    ds_write_b32 v239, v235 offset:192
    s_mov_b64 exec, -1
    s_cmp_eq_u32 s67, 0
    s_cbranch_scc1 L_NB3
    s_nop 0
    global_load_dwordx4 v[132:135], v[220:221], off
    v_lshl_add_u64 v[220:221], s[20:21], 0, v[220:221]
    global_load_dwordx4 v[136:139], v[220:221], off
    v_lshl_add_u64 v[220:221], s[20:21], 0, v[220:221]
    global_load_dwordx4 v[140:143], v[220:221], off
    v_lshl_add_u64 v[220:221], s[22:23], 0, v[220:221]
    global_load_dwordx4 v[144:147], v[220:221], off
    v_lshl_add_u64 v[220:221], s[20:21], 0, v[220:221]
    global_load_dwordx4 v[148:151], v[220:221], off
    v_lshl_add_u64 v[220:221], s[20:21], 0, v[220:221]
    global_load_dwordx4 v[152:155], v[220:221], off
    v_lshl_add_u64 v[220:221], s[20:21], 0, v[220:221]
L_NB3:
    global_load_dwordx4 v[156:159], v[220:221], off
    v_lshl_add_u64 v[220:221], s[20:21], 0, v[220:221]
    global_load_dwordx4 v[160:163], v[220:221], off
    v_lshl_add_u64 v[220:221], s[20:21], 0, v[220:221]
    global_load_dwordx4 v[164:167], v[220:221], off
    v_lshl_add_u64 v[220:221], s[20:21], 0, v[220:221]
    global_load_dwordx4 v[168:171], v[220:221], off
    v_lshl_add_u64 v[220:221], s[20:21], 0, v[220:221]
    global_load_dwordx4 v[172:175], v[220:221], off
    s_movk_i32 s4, 0x7ff
    ds_read_b32 v16, v10 offset:192
    ds_read_b128 v[20:23], v11 offset:192
    s_cmp_lg_u32 s69, 1
    s_waitcnt lgkmcnt(1)
    v_bfi_b32 v14, v16, 0, s4
    s_cbranch_scc1 L_NOXS
    v_lshl_add_u32 v15, v14, 11, v9
    buffer_load_dwordx4 v[208:211], v15, s[48:51], 0 offen
    buffer_load_dwordx4 v[212:215], v15, s[48:51], 0 offen offset:64
    v_lshrrev_b32 v15, 1, v14
    v_lshlrev_b32 v15, 3, v15
    ds_read_b64 v[8:9], v15 offset:9216
L_NOXS:
    s_waitcnt lgkmcnt(0)
    v_cmp_gt_u32 vcc, v20, v16
    v_cmp_gt_u32 s[8:9], v21, v16
    v_cmp_gt_u32 s[14:15], v22, v16
    v_cmp_gt_u32 s[28:29], v23, v16
    v_cndmask_b32 v24, 0, 1, vcc
    v_cndmask_b32 v25, 0, 1, s[8:9]
    v_addc_co_u32 v24, vcc, 0, v24, s[14:15]
    v_addc_co_u32 v24, vcc, v25, v24, s[28:29]
    v_mov_b32 v25, v24
    s_nop 1
    v_permlane32_swap_b32 v24, v25
    v_add_u32 v24, v24, v25
    v_mov_b32 v25, v24
    s_nop 1
    v_permlane16_swap_b32 v24, v25
    v_add_u32 v24, v24, v25
    v_cmp_gt_u32 s[30:31], 8, v24
    v_lshlrev_b32 v15, 2, v24
    v_and_b32 v10, 7, v0
    v_lshlrev_b32_e64 v10, 2, v10
    v_bfe_u32 v20, v14, 1, 8
    v_lshrrev_b32 v21, 9, v14
    v_lshlrev_b32 v20, 3, v20
    v_lshl_add_u32 v20, v21, 1, v20
    v_and_b32 v14, 1, v14
    v_add_u32 v20, v20, v14
    v_mov_b32 v22, 0x80
    s_mov_b64 exec, s[30:31]
    ds_write_b32 v15, v16 offset:256
    s_cmp_lg_u32 s3, 0
    s_cbranch_scc1 L_NOSEL
    ds_write_b8 v20, v22 offset:1152
    s_cmp_lg_u32 s2, 255
    s_cbranch_scc1 L_NOSEL
    s_mov_b64 exec, 1
    v_mov_b32 v22, s56
    buffer_store_dword v22, v2, s[44:47], 0 offen sc1
L_NOSEL:
    s_mov_b64 exec, -1
    ds_read_b32 v7, v10 offset:256
    s_mov_b64 exec, 1
    ds_write_b32 v2, v5 offset:112
    s_mov_b64 exec, -1
    s_movk_i32 s4, 0x7ff
    v_bfe_u32 v226, v0, 3, 2
    s_lshl_b32 s8, s57, 3
    s_mov_b32 s32, 0
    s_waitcnt lgkmcnt(1)
    v_bfi_b32 v224, v7, 0, s4
    v_lshlrev_b32 v223, 11, v224
    v_lshl_add_u32 v223, v226, 1, v223
    v_add_u32_e64 v223, s8, v223
    buffer_load_ushort v246, v223, s[48:51], 0 offen
    s_cmp_lg_u32 s69, 1
    s_cbranch_scc1 L_NF
    v_lshl_add_u32 v3, v24, 4, v3
    v_lshlrev_b32 v14, 4, v14
    v_lshlrev_b32_e64 v13, 4, v0
    s_lshl_b32 s4, s59, 14
    s_add_u32 s4, s4, 65536
    s_lshl_b32 s6, s3, 12
    s_add_u32 s6, s6, s4
    s_lshl_b32 s5, s68, 10
    s_add_u32 s5, s5, s6
    v_mov_b32 v218, s56
    v_lshrrev_b32 v6, v14, v9
    v_lshrrev_b32 v8, v14, v8
    v_lshlrev_b32 v6, 16, v6
    v_xor_b32 v8, 0x8000, v8
    v_rcp_f32_e64 v6, v6
    v_perm_b32 v240, v8, v8, s64
    v_perm_b32 v241, v8, v8, s64
    v_perm_b32 v242, v8, v8, s64
    v_perm_b32 v243, v8, v8, s64
    s_add_u32 s11, s10, 0
    s_nop 0
    buffer_load_dwordx2 v[176:177], v222, s[24:27], s11 offen
    s_add_u32 s11, s10, 16384
    buffer_load_dwordx2 v[178:179], v222, s[24:27], s11 offen
    s_add_u32 s11, s10, 2048
    buffer_load_dwordx2 v[180:181], v222, s[24:27], s11 offen
    s_add_u32 s11, s10, 18432
    buffer_load_dwordx2 v[182:183], v222, s[24:27], s11 offen
    s_add_u32 s11, s10, 32768
    buffer_load_dwordx2 v[184:185], v222, s[24:27], s11 offen
    s_add_u32 s11, s10, 49152
    buffer_load_dwordx2 v[186:187], v222, s[24:27], s11 offen
    s_add_u32 s11, s10, 34816
    buffer_load_dwordx2 v[188:189], v222, s[24:27], s11 offen
    s_add_u32 s11, s10, 51200
    buffer_load_dwordx2 v[190:191], v222, s[24:27], s11 offen
    s_waitcnt vmcnt(19)
    s_nop 0
    v_perm_b32 v48, v116, v112, s64
    v_perm_b32 v52, v116, v112, s65
    v_perm_b32 v49, v124, v120, s64
    v_perm_b32 v53, v124, v120, s65
    v_perm_b32 v50, v132, v128, s64
    v_perm_b32 v54, v132, v128, s65
    v_perm_b32 v51, v140, v136, s64
    v_perm_b32 v55, v140, v136, s65
    v_perm_b32 v56, v117, v113, s64
    v_perm_b32 v60, v117, v113, s65
    v_perm_b32 v57, v125, v121, s64
    v_perm_b32 v61, v125, v121, s65
    v_perm_b32 v58, v133, v129, s64
    v_perm_b32 v62, v133, v129, s65
    v_perm_b32 v59, v141, v137, s64
    v_perm_b32 v63, v141, v137, s65
    v_perm_b32 v64, v118, v114, s64
    v_perm_b32 v68, v118, v114, s65
    v_perm_b32 v65, v126, v122, s64
    v_perm_b32 v69, v126, v122, s65
    v_perm_b32 v66, v134, v130, s64
    v_perm_b32 v70, v134, v130, s65
    v_perm_b32 v67, v142, v138, s64
    v_perm_b32 v71, v142, v138, s65
    v_perm_b32 v72, v119, v115, s64
    v_perm_b32 v76, v119, v115, s65
    v_perm_b32 v73, v127, v123, s64
    v_perm_b32 v77, v127, v123, s65
    v_perm_b32 v74, v135, v131, s64
    v_perm_b32 v78, v135, v131, s65
    v_perm_b32 v75, v143, v139, s64
    v_perm_b32 v79, v143, v139, s65
    s_waitcnt vmcnt(11)
    s_nop 0
    v_mfma_f32_16x16x32_bf16 v[16:19], v[48:51], v[240:243], 0
    v_perm_b32 v80, v148, v144, s64
    v_perm_b32 v84, v148, v144, s65
    v_perm_b32 v81, v156, v152, s64
    v_perm_b32 v85, v156, v152, s65
    v_mfma_f32_16x16x32_bf16 v[20:23], v[52:55], v[240:243], 0
    v_perm_b32 v82, v164, v160, s64
    v_perm_b32 v86, v164, v160, s65
    v_perm_b32 v83, v172, v168, s64
    v_perm_b32 v87, v172, v168, s65
    v_mfma_f32_16x16x32_bf16 v[24:27], v[56:59], v[240:243], 0
    v_perm_b32 v88, v149, v145, s64
    v_perm_b32 v92, v149, v145, s65
    v_perm_b32 v89, v157, v153, s64
    v_perm_b32 v93, v157, v153, s65
    v_mfma_f32_16x16x32_bf16 v[28:31], v[60:63], v[240:243], 0
    v_perm_b32 v90, v165, v161, s64
    v_perm_b32 v94, v165, v161, s65
    v_perm_b32 v91, v173, v169, s64
    v_perm_b32 v95, v173, v169, s65
    v_mfma_f32_16x16x32_bf16 v[32:35], v[64:67], v[240:243], 0
    v_perm_b32 v96, v150, v146, s64
    v_perm_b32 v100, v150, v146, s65
    v_perm_b32 v97, v158, v154, s64
    v_perm_b32 v101, v158, v154, s65
    v_mfma_f32_16x16x32_bf16 v[36:39], v[68:71], v[240:243], 0
    v_perm_b32 v98, v166, v162, s64
    v_perm_b32 v102, v166, v162, s65
    v_perm_b32 v99, v174, v170, s64
    v_perm_b32 v103, v174, v170, s65
    v_mfma_f32_16x16x32_bf16 v[40:43], v[72:75], v[240:243], 0
    v_perm_b32 v104, v151, v147, s64
    v_perm_b32 v108, v151, v147, s65
    v_perm_b32 v105, v159, v155, s64
    v_perm_b32 v109, v159, v155, s65
    v_mfma_f32_16x16x32_bf16 v[44:47], v[76:79], v[240:243], 0
    v_perm_b32 v106, v167, v163, s64
    v_perm_b32 v110, v167, v163, s65
    v_perm_b32 v107, v175, v171, s64
    v_perm_b32 v111, v175, v171, s65
    v_mfma_f32_16x16x32_bf16 v[16:19], v[80:83], v[240:243], v[16:19]
    v_mfma_f32_16x16x32_bf16 v[20:23], v[84:87], v[240:243], v[20:23]
    v_mfma_f32_16x16x32_bf16 v[24:27], v[88:91], v[240:243], v[24:27]
    v_mfma_f32_16x16x32_bf16 v[28:31], v[92:95], v[240:243], v[28:31]
    v_mfma_f32_16x16x32_bf16 v[32:35], v[96:99], v[240:243], v[32:35]
    v_mfma_f32_16x16x32_bf16 v[36:39], v[100:103], v[240:243], v[36:39]
    v_mfma_f32_16x16x32_bf16 v[40:43], v[104:107], v[240:243], v[40:43]
    v_mfma_f32_16x16x32_bf16 v[44:47], v[108:111], v[240:243], v[44:47]
    s_waitcnt vmcnt(9)
    s_nop 0
    v_mfma_f32_16x16x32_bf16 v[16:19], v[48:51], v[208:211], v[16:19]
    s_add_u32 s11, s10, 8192
    buffer_load_dwordx2 v[192:193], v222, s[24:27], s11 offen
    v_mfma_f32_16x16x32_bf16 v[20:23], v[52:55], v[208:211], v[20:23]
    s_add_u32 s11, s10, 24576
    buffer_load_dwordx2 v[194:195], v222, s[24:27], s11 offen
    v_mfma_f32_16x16x32_bf16 v[24:27], v[56:59], v[208:211], v[24:27]
    s_add_u32 s11, s10, 10240
    buffer_load_dwordx2 v[196:197], v222, s[24:27], s11 offen
    v_mfma_f32_16x16x32_bf16 v[28:31], v[60:63], v[208:211], v[28:31]
    s_add_u32 s11, s10, 26624
    buffer_load_dwordx2 v[198:199], v222, s[24:27], s11 offen
    v_mfma_f32_16x16x32_bf16 v[32:35], v[64:67], v[208:211], v[32:35]
    s_add_u32 s11, s10, 40960
    buffer_load_dwordx2 v[200:201], v222, s[24:27], s11 offen
    v_mfma_f32_16x16x32_bf16 v[36:39], v[68:71], v[208:211], v[36:39]
    s_add_u32 s11, s10, 57344
    buffer_load_dwordx2 v[202:203], v222, s[24:27], s11 offen
    v_mfma_f32_16x16x32_bf16 v[40:43], v[72:75], v[208:211], v[40:43]
    s_add_u32 s11, s10, 43008
    buffer_load_dwordx2 v[204:205], v222, s[24:27], s11 offen
    v_mfma_f32_16x16x32_bf16 v[44:47], v[76:79], v[208:211], v[44:47]
    s_add_u32 s11, s10, 59392
    buffer_load_dwordx2 v[206:207], v222, s[24:27], s11 offen
    v_mfma_f32_16x16x32_bf16 v[16:19], v[80:83], v[212:215], v[16:19]
    v_mfma_f32_16x16x32_bf16 v[20:23], v[84:87], v[212:215], v[20:23]
    v_mfma_f32_16x16x32_bf16 v[24:27], v[88:91], v[212:215], v[24:27]
    v_mfma_f32_16x16x32_bf16 v[28:31], v[92:95], v[212:215], v[28:31]
    v_mfma_f32_16x16x32_bf16 v[32:35], v[96:99], v[212:215], v[32:35]
    v_mfma_f32_16x16x32_bf16 v[36:39], v[100:103], v[212:215], v[36:39]
    v_mfma_f32_16x16x32_bf16 v[40:43], v[104:107], v[212:215], v[40:43]
    v_mfma_f32_16x16x32_bf16 v[44:47], v[108:111], v[212:215], v[44:47]
    s_mov_b64 exec, s[30:31]
    s_nop 0
    ds_write_b128 v3, v[16:19] offset:0
    ds_write_b128 v3, v[20:23] offset:512
    ds_write_b128 v3, v[24:27] offset:1024
    ds_write_b128 v3, v[28:31] offset:1536
    ds_write_b128 v3, v[32:35] offset:2048
    ds_write_b128 v3, v[36:39] offset:2560
    ds_write_b128 v3, v[40:43] offset:3072
    ds_write_b128 v3, v[44:47] offset:3584
    ds_write_b32 v15, v6 offset:288
    s_mov_b64 exec, 1
    ds_write_b32 v2, v5 offset:80
    s_mov_b64 exec, -1
    ds_read_b32 v6, v10 offset:288
LW_11:
    ds_read_b32 v11, v1 offset:80
    s_waitcnt lgkmcnt(0)
    v_cmp_eq_u32_e64 vcc, 0, v11
    s_cbranch_vccnz LW_11
    ds_read_b64 v[224:225], v4 offset:0
    ds_read_b64 v[226:227], v4 offset:256
    ds_read_b64 v[228:229], v4 offset:4096
    ds_read_b64 v[230:231], v4 offset:4352
    ds_read_b64 v[232:233], v4 offset:8192
    ds_read_b64 v[234:235], v4 offset:8448
    ds_read_b64 v[236:237], v4 offset:12288
    ds_read_b64 v[238:239], v4 offset:12544
    s_waitcnt lgkmcnt(4)
    v_add_f32 v224, v224, v228
    v_add_f32 v225, v225, v229
    v_add_f32 v226, v226, v230
    v_add_f32 v227, v227, v231
    s_waitcnt lgkmcnt(0)
    v_add_f32 v232, v232, v236
    v_add_f32 v233, v233, v237
    v_add_f32 v234, v234, v238
    v_add_f32 v235, v235, v239
    v_add_f32 v224, v224, v232
    v_add_f32 v225, v225, v233
    v_add_f32 v226, v226, v234
    v_add_f32_e64 v227, v227, v235
    s_cmp_eq_u32 s12, 0
    v_cvt_pk_bf16_f32 v216, v224, v225
    v_cvt_pk_bf16_f32 v217, v226, v227
    s_cbranch_scc0 L_HSC
    buffer_store_dwordx4 v[216:219], v13, s[44:47], s5 offen
L_HSB:
    v_bfe_u32 v10, v0, 3, 1
    v_lshrrev_b32 v11, 4, v0
    v_cmp_ne_u32 s[22:23], 0, v10
    v_lshlrev_b32_e64 v15, 2, v10
    v_lshl_add_u32 v15, v11, 3, v15
    v_lshlrev_b32_e64 v10, 8, v10
    v_lshl_add_u32 v10, v11, 9, v10
    v_lshlrev_b32 v9, 4, v11
    v_and_b32 v11, 7, v0
    v_lshl_add_u32 v10, v11, 4, v10
    s_movk_i32 s5, 144
    v_mad_u32_u24 v15, v11, s5, v15
    v_mad_u32_u24 v9, v11, s5, v9
    s_lshl_b32 s5, s3, 5
    v_add_u32 v15, s5, v15
    s_lshl_b32 s4, s59, 15
    s_lshl_b32 s5, s68, 13
    s_add_u32 s4, s4, s5
    s_lshl_b32 s5, s3, 11
    s_add_u32 s4, s4, s5
    s_add_u32 s4, s4, 1048576
    v_mul_f32 v12, 0xbfb8aa3b, v6
    v_mul_f32 v14, v6, v6
    v_mov_b32 v50, s56
    v_mov_b32_e64 v54, s56
    s_mov_b32 s16, 0
    s_waitcnt vmcnt(9)
    v_perm_b32 v112, v178, v176, s64
    v_perm_b32 v116, v178, v176, s65
    v_perm_b32 v113, v182, v180, s64
    v_perm_b32 v117, v182, v180, s65
    v_perm_b32 v114, v186, v184, s64
    v_perm_b32 v118, v186, v184, s65
    v_perm_b32 v115, v190, v188, s64
    v_perm_b32 v119, v190, v188, s65
    v_perm_b32 v120, v179, v177, s64
    v_perm_b32 v124, v179, v177, s65
    v_perm_b32 v121, v183, v181, s64
    v_perm_b32 v125, v183, v181, s65
    v_perm_b32 v122, v187, v185, s64
    v_perm_b32 v126, v187, v185, s65
    v_perm_b32 v123, v191, v189, s64
    v_perm_b32 v127, v191, v189, s65
    buffer_load_dwordx3 v[144:146], v13, s[44:47], s6 offen offset:0 sc1
    buffer_load_dwordx3 v[148:150], v13, s[44:47], s6 offen offset:1024 sc1
    buffer_load_dwordx3 v[152:154], v13, s[44:47], s6 offen offset:2048 sc1
    buffer_load_dwordx3 v[156:158], v13, s[44:47], s6 offen offset:3072 sc1
    v_lshrrev_b32 v221, 3, v0
    s_lshl_b32 s8, s3, 3
    v_add_lshl_u32 v221, v221, s8, 15
    v_and_b32 v225, 7, v0
    v_lshlrev_b32 v225, 4, v225
    v_add_u32_e64 v221, v221, v225
    v_bfe_u32 v226, v0, 3, 2
    v_bfrev_b32 v220, v226
    v_lshrrev_b32 v220, 22, v220
    v_add_u32 v220, v220, v225
    v_lshrrev_b32 v220, 2, v220
    v_lshrrev_b32 v224, 11, v223
    v_lshlrev_b32 v247, 13, v226
    v_lshl_add_u32 v247, v224, 2, v247
    v_lshrrev_b32 v225, 1, v224
    v_and_b32 v225, 0x30, v225
    v_xor_b32_e64 v247, v247, v225
    v_add_u32 v247, 17408, v247
LW_12:
    ds_read_b32 v224, v1 offset:112
    s_waitcnt lgkmcnt(0)
    v_cmp_eq_u32 vcc, 0, v224
    s_cbranch_vccnz LW_12
    s_lshr_b32 s8, s2, 3
    s_and_b32 s9, s2, 7
    s_lshr_b32 s39, s58, 1
    s_add_u32 s39, s39, 0
    v_lshrrev_b32 v253, 3, v0
    v_and_b32 v254, 7, v0
    s_lshl_b32 s38, s8, 5
    s_add_u32 s38, s38, s39
    v_lshrrev_b32 v252, 4, v0
    v_lshl_add_u32 v252, v252, 2, s38
    v_and_b32_e64 v251, 1, v253
    v_lshl_add_u32 v252, v252, 1, v251
    ds_read_u8 v255, v252 offset:1152
    ds_read_u8 v252, v252 offset:1184
    s_mul_i32 s38, s58, 4096
    s_add_u32 s38, s38, 140288
    v_lshl_add_u32 v249, v253, 3, s38
    v_lshl_add_u32 v250, v254, 4, s38
    s_movk_i32 s38, 288
    v_mad_u32_u24 v249, v254, s38, v249
    s_movk_i32 s38, 144
    v_mad_u32_u24 v250, v253, s38, v250
    v_lshlrev_b32_e64 v254, 4, v254
    v_lshl_add_u32 v248, v253, 14, v254
    v_lshl_add_u32 v253, v253, 11, v254
    s_and_b32 s38, s58, 1
    s_lshl_b32 s35, s9, 1
    s_add_u32 s35, s35, s38
    s_lshl_b32 s39, s39, 5
    s_add_u32 s39, s39, s8
    s_lshl_b32 s34, s35, 18
    s_lshl_b32 s38, s39, 7
    s_add_u32 s34, s34, s38
    s_add_u32 s34, s34, 3145728
    s_lshl_b32 s36, s39, 15
    s_lshl_b32 s35, s35, 7
    s_add_u32 s36, s36, s35
    s_add_u32 s37, s36, 0x4000
    s_add_u32 s35, s34, 0x20000
    s_lshl_b32 s38, s9, 5
    s_lshr_b32 s8, s8, 3
    s_add_u32 s38, s38, s8
    s_lshl_b32 s38, s38, 7
    s_add_u32 s38, s38, 983040
    s_mov_b32 s39, 0
    s_waitcnt lgkmcnt(0)
    v_lshl_or_b32 v251, v255, 24, v253
    v_lshl_or_b32 v252, v252, 24, v253
    v_lshlrev_b32 v255, 2, v0
    v_lshrrev_b32_e64 v254, 16, v7
    v_bfe_i32 v224, v254, 15, 1
    v_not_b32_e64 v224, v224
    v_or_b32 v224, 0x8000, v224
    v_xor_b32 v254, v254, v224
    v_lshlrev_b32 v254, 16, v254
    v_mul_f32 v254, 0xbfb8aa3b, v254
    v_exp_f32 v254, v254
    v_mov_b32 v253, s63
    v_add_f32 v254, 1.0, v254
    v_rcp_f32_e64 v254, v254
    s_waitcnt vmcnt(5)
    v_perm_b32 v128, v194, v192, s64
    v_perm_b32 v132, v194, v192, s65
    v_perm_b32 v129, v198, v196, s64
    v_perm_b32 v133, v198, v196, s65
    v_perm_b32 v130, v202, v200, s64
    v_perm_b32 v134, v202, v200, s65
    v_perm_b32 v131, v206, v204, s64
    v_perm_b32 v135, v206, v204, s65
    v_perm_b32 v136, v195, v193, s64
    v_perm_b32 v140, v195, v193, s65
    v_perm_b32 v137, v199, v197, s64
    v_perm_b32 v141, v199, v197, s65
    v_perm_b32 v138, v203, v201, s64
    v_perm_b32 v142, v203, v201, s65
    v_perm_b32 v139, v207, v205, s64
    v_perm_b32 v143, v207, v205, s65
    s_branch L_HPW
L_HP:
    s_sleep 1
    s_cmp_eq_u64 s[18:19], 0
    s_cbranch_scc1 L_HS0
    buffer_load_dwordx3 v[144:146], v13, s[44:47], s6 offen offset:0 sc1
L_HS0:
    s_cmp_eq_u64 s[8:9], 0
    s_cbranch_scc1 L_HS1
    buffer_load_dwordx3 v[148:150], v13, s[44:47], s6 offen offset:1024 sc1
L_HS1:
    s_cmp_eq_u64 s[14:15], 0
    s_cbranch_scc1 L_HS2
    buffer_load_dwordx3 v[152:154], v13, s[44:47], s6 offen offset:2048 sc1
L_HS2:
    s_cmp_eq_u64 s[28:29], 0
    s_cbranch_scc1 L_HS3
    buffer_load_dwordx3 v[156:158], v13, s[44:47], s6 offen offset:3072 sc1
L_HS3:
L_HPW:
    s_add_u32 s16, s16, 1
    s_waitcnt vmcnt(0)
    v_cmp_ne_u32 s[18:19], s56, v146
    v_cmp_ne_u32 s[8:9], s56, v150
    v_cmp_ne_u32 s[14:15], s56, v154
    v_cmp_ne_u32 s[28:29], s56, v158
    s_or_b64 vcc, s[18:19], s[8:9]
    s_or_b64 s[20:21], s[14:15], s[28:29]
    s_or_b64 vcc, vcc, s[20:21]
    s_cbranch_vccz L_HOK
    s_cmp_lt_u32 s16, 0x4000
    s_cbranch_scc1 L_HP
L_HOK:
    s_mov_b32 exec_hi, 0
    buffer_load_dword v253, v255, s[44:47], s38 offen sc1
    s_mov_b32 exec_hi, -1
    v_lshlrev_b32 v224, 16, v144
    v_and_b32 v225, 0xffff0000, v144
    v_lshlrev_b32_e64 v226, 16, v148
    v_and_b32 v227, 0xffff0000, v148
    v_lshlrev_b32_e64 v228, 16, v152
    v_and_b32 v229, 0xffff0000, v152
    v_lshlrev_b32_e64 v230, 16, v156
    v_and_b32 v231, 0xffff0000, v156
    v_add_f32 v224, v224, v226
    v_add_f32 v228, v228, v230
    v_add_f32 v225, v225, v227
    v_add_f32 v229, v229, v231
    v_add_f32 v224, v224, v228
    v_add_f32 v225, v225, v229
    v_mul_f32 v244, v12, v224
    v_mul_f32 v245, v12, v225
    v_exp_f32 v244, v244
    v_exp_f32 v245, v245
    v_lshlrev_b32_e64 v232, 16, v145
    v_and_b32 v233, 0xffff0000, v145
    v_lshlrev_b32_e64 v234, 16, v149
    v_and_b32 v235, 0xffff0000, v149
    v_lshlrev_b32_e64 v236, 16, v153
    v_and_b32 v237, 0xffff0000, v153
    v_lshlrev_b32_e64 v238, 16, v157
    v_and_b32 v239, 0xffff0000, v157
    v_add_f32 v244, 1.0, v244
    v_add_f32 v245, 1.0, v245
    v_rcp_f32 v244, v244
    v_rcp_f32 v245, v245
    v_add_f32 v232, v232, v234
    v_add_f32 v236, v236, v238
    v_add_f32 v233, v233, v235
    v_add_f32 v237, v237, v239
    v_mul_f32 v224, v224, v14
    v_add_f32 v232, v232, v236
    v_mul_f32 v225, v225, v14
    v_add_f32 v233, v233, v237
    v_mul_f32 v224, v224, v244
    v_mul_f32 v225, v225, v245
    v_mul_f32 v224, v224, v232
    v_mul_f32 v225, v225, v233
    v_cvt_pk_bf16_f32 v244, v224, v225
    ds_write_b32 v15, v244 offset:4096
    s_mov_b64 exec, 1
    ds_write_b32 v2, v5 offset:176
    s_mov_b64 exec, -1
LW_13:
    ds_read_b32 v11, v1 offset:176
    s_waitcnt lgkmcnt(0)
    v_cmp_eq_u32_e64 vcc, 0, v11
    s_cbranch_vccnz LW_13
    ds_read_b128 v[224:227], v9 offset:4096
    ds_read_b128 v[228:231], v9 offset:4160
    s_waitcnt lgkmcnt(1)
    v_mfma_f32_16x16x32_bf16 v[16:19], v[112:115], v[224:227], 0
    v_mfma_f32_16x16x32_bf16 v[20:23], v[116:119], v[224:227], 0
    v_mfma_f32_16x16x32_bf16 v[24:27], v[120:123], v[224:227], 0
    v_mfma_f32_16x16x32_bf16 v[28:31], v[124:127], v[224:227], 0
    s_waitcnt lgkmcnt(0)
    v_mfma_f32_16x16x32_bf16 v[16:19], v[128:131], v[228:231], v[16:19]
    v_mfma_f32_16x16x32_bf16 v[20:23], v[132:135], v[228:231], v[20:23]
    v_mfma_f32_16x16x32_bf16 v[24:27], v[136:139], v[228:231], v[24:27]
    v_mfma_f32_16x16x32_bf16 v[28:31], v[140:143], v[228:231], v[28:31]
    s_waitcnt vmcnt(0)
    v_cmp_ne_u32_e64 vcc, s63, v253
    s_or_b64 vcc, vcc, s[12:13]
    s_cbranch_vccnz L_EAN
    s_mov_b32 s32, 1
    buffer_load_dwordx4 v[96:99], v248, s[44:47], s34 offen sc1
    buffer_load_dwordx4 v[100:103], v248, s[44:47], s35 offen sc1
L_EAN:
    s_nop 0
    s_nop 0
    v_cndmask_b32 v16, v16, v18, s[22:23]
    v_cndmask_b32 v20, v20, v22, s[22:23]
    v_cndmask_b32 v24, v24, v26, s[22:23]
    v_cndmask_b32 v28, v28, v30, s[22:23]
    v_cvt_pk_bf16_f32 v48, v16, v20
    v_cvt_pk_bf16_f32 v49, v24, v28
    buffer_store_dwordx4 v[48:51], v10, s[44:47], s4 offen offset:0 sc1
    v_cndmask_b32 v17, v17, v19, s[22:23]
    v_cndmask_b32 v21, v21, v23, s[22:23]
    v_cndmask_b32 v25, v25, v27, s[22:23]
    v_cndmask_b32 v29, v29, v31, s[22:23]
    v_cvt_pk_bf16_f32 v52, v17, v21
    v_cvt_pk_bf16_f32 v53, v25, v29
    buffer_store_dwordx4 v[52:55], v10, s[44:47], s4 offen offset:128 sc1
    s_cmp_eq_u32 s32, 0
    s_cbranch_scc1 L_GATHER
    s_waitcnt vmcnt(2)
    s_nop 0
    ds_write_b64 v249, v[96:97] offset:0
    ds_write_b64 v249, v[98:99] offset:144
    ds_write_b64 v249, v[100:101] offset:64
    ds_write_b64 v249, v[102:103] offset:208
    ds_read_b128 v[104:107], v250 offset:0
    ds_read_b128 v[108:111], v250 offset:1152
    s_waitcnt lgkmcnt(1)
    buffer_store_dwordx4 v[104:107], v251, s[52:55], s36 offen sc1
    s_waitcnt lgkmcnt(0)
    buffer_store_dwordx4 v[108:111], v252, s[52:55], s37 offen sc1
    s_branch L_AFT
L_GATHER:
    s_cmp_lg_u32 s12, 0
    s_cbranch_scc1 L_AFT
    s_setprio 0
LW_14:
    s_sleep 2
    ds_read_b32 v81, v1 offset:32
    s_waitcnt lgkmcnt(0)
    v_cmp_eq_u32_e64 vcc, 0, v81
    s_cbranch_vccnz LW_14
    s_mov_b32 exec_hi, 0
LT_15:
    buffer_load_dword v253, v255, s[44:47], s38 offen sc1
    s_add_u32 s39, s39, 1
    s_waitcnt vmcnt(0)
    v_cmp_ne_u32_e64 vcc, s63, v253
    s_cbranch_vccz LT_15K
    s_sleep 1
    s_cmp_lt_u32 s39, 0x4000
    s_cbranch_scc1 LT_15
LT_15K:
    s_mov_b32 exec_hi, -1
    buffer_load_dwordx4 v[96:99], v248, s[44:47], s34 offen sc1
    buffer_load_dwordx4 v[100:103], v248, s[44:47], s35 offen sc1
    s_waitcnt vmcnt(1)
    ds_write_b64 v249, v[96:97] offset:0
    ds_write_b64 v249, v[98:99] offset:144
    s_waitcnt vmcnt(0)
    ds_write_b64 v249, v[100:101] offset:64
    ds_write_b64 v249, v[102:103] offset:208
    ds_read_b128 v[104:107], v250 offset:0
    ds_read_b128 v[108:111], v250 offset:1152
    s_waitcnt lgkmcnt(1)
    buffer_store_dwordx4 v[104:107], v251, s[52:55], s36 offen sc1
    s_waitcnt lgkmcnt(0)
    buffer_store_dwordx4 v[108:111], v252, s[52:55], s37 offen sc1
L_AFT:
    s_setprio 0
    s_lshl_b32 s4, s57, 7
    s_add_u32 s4, s4, 1048576
    s_mov_b32 s11, 0
    s_lshl_b32 s8, s3, 8
    v_lshl_add_u32 v85, v0, 2, s8
LW_16:
    s_sleep 1
    ds_read_b32 v81, v1 offset:560
    s_waitcnt lgkmcnt(0)
    v_cmp_eq_u32 vcc, 0, v81
    s_cbranch_vccnz LW_16
    s_setprio 2
L_GGO:
    s_mov_b64 s[8:9], -1
    s_cmp_lt_u32 s3, 3
    s_cselect_b64 s[12:13], -1, 0
    s_add_u32 s5, s4, 0x100000
    v_mov_b32 v148, 0
    v_mov_b32 v149, 0
    v_mov_b32_e64 v150, s56
L_GP:
    s_mov_b64 exec, s[8:9]
    s_cbranch_execz L_GS0
    buffer_load_dwordx3 v[144:146], v221, s[44:47], s4 offen sc1
L_GS0:
    s_mov_b64 exec, s[12:13]
    s_cbranch_execz L_GS1
    buffer_load_dwordx3 v[148:150], v221, s[44:47], s5 offen sc1
L_GS1:
    s_mov_b64 exec, -1
    s_add_u32 s11, s11, 1
    s_waitcnt vmcnt(0)
    v_cmp_ne_u32 s[8:9], s56, v146
    v_cmp_ne_u32 s[12:13], s56, v150
    s_or_b64 vcc, s[8:9], s[12:13]
    s_cbranch_vccz L_GOT
    s_branch L_AH1
L_AH0:
    s_sleep 1
L_AH1:
    ds_read_b32 v81, v1 offset:560
    s_waitcnt lgkmcnt(0)
    v_cmp_gt_u32_e64 vcc, 2, v81
    s_cbranch_vccnz L_AH0
    s_sleep 2
    s_cmp_lt_u32 s11, 0x4000
    s_cbranch_scc1 L_GP
L_GOT:
    v_lshlrev_b32 v176, 16, v144
    v_and_b32 v177, 0xffff0000, v144
    v_lshlrev_b32_e64 v178, 16, v145
    v_and_b32 v179, 0xffff0000, v145
    v_lshlrev_b32_e64 v180, 16, v148
    v_and_b32 v181, 0xffff0000, v148
    v_lshlrev_b32_e64 v182, 16, v149
    v_and_b32 v183, 0xffff0000, v149
    v_add_f32 v176, v176, v180
    v_add_f32 v177, v177, v181
    v_add_f32 v178, v178, v182
    v_add_f32 v179, v179, v183
    v_permlane32_swap_b32 v176, v177
    s_nop 0
    v_permlane32_swap_b32 v178, v179
    v_add_f32 v176, v176, v177
    v_add_f32 v178, v178, v179
    s_nop 1
    v_permlane16_swap_b32 v176, v178
    v_add_f32 v176, v176, v178
    s_nop 0
    s_nop 0
    v_add_f32_dpp v176, v176, v176 row_ror:8 row_mask:0xf bank_mask:0xf
    ds_write_b32 v85, v176 offset:8192
    s_mov_b64 exec, 1
    ds_write_b32 v2, v5 offset:96
    s_mov_b64 exec, -1
    s_cmp_lg_u32 s3, 0
    s_cbranch_scc1 L_FIN
    v_lshlrev_b32_e64 v80, 16, v246
L_FW:
    ds_read2_b32 v[86:87], v1 offset0:12 offset1:24
    ds_read_b32 v89, v247
    ds_read2st64_b32 v[90:91], v220 offset0:32 offset1:33
    ds_read2st64_b32 v[92:93], v220 offset0:34 offset1:35
    s_waitcnt lgkmcnt(3)
    v_min_u32 v86, v86, v87
    v_cmp_eq_u32 vcc, 0, v86
    s_cbranch_vccnz L_FW
    s_waitcnt lgkmcnt(1)
    v_add_f32 v80, v80, v89
    v_add_f32 v90, v90, v91
    s_waitcnt lgkmcnt(0)
    v_add_f32 v92, v92, v93
    v_add_f32 v90, v90, v92
    v_fma_f32 v80, v90, v254, v80
    v_cvt_pk_bf16_f32 v80, v80, v80
    s_mov_b32 exec_hi, 0
    buffer_store_short v80, v223, s[52:55], 0 offen
    s_mov_b64 exec, -1
    s_branch L_FIN
L_HSC:
    buffer_store_dwordx4 v[216:219], v13, s[44:47], s5 offen sc1
    s_branch L_HSB
L_NF:
    v_lshrrev_b32 v221, 3, v0
    s_lshl_b32 s8, s3, 3
    v_add_lshl_u32 v221, v221, s8, 15
    v_and_b32 v225, 7, v0
    v_lshlrev_b32 v225, 4, v225
    v_add_u32_e64 v221, v221, v225
    v_bfe_u32 v226, v0, 3, 2
    v_bfrev_b32 v220, v226
    v_lshrrev_b32 v220, 22, v220
    v_add_u32 v220, v220, v225
    v_lshrrev_b32 v220, 2, v220
    v_lshrrev_b32 v224, 11, v223
    v_lshlrev_b32 v247, 13, v226
    v_lshl_add_u32 v247, v224, 2, v247
    v_lshrrev_b32 v225, 1, v224
    v_and_b32 v225, 0x30, v225
    v_xor_b32_e64 v247, v247, v225
    v_add_u32 v247, 17408, v247
LW_17:
    ds_read_b32 v224, v1 offset:112
    s_waitcnt lgkmcnt(0)
    v_cmp_eq_u32 vcc, 0, v224
    s_cbranch_vccnz LW_17
    s_lshr_b32 s8, s2, 3
    s_and_b32 s9, s2, 7
    s_lshr_b32 s39, s58, 1
    s_add_u32 s39, s39, 0
    v_lshrrev_b32 v253, 3, v0
    v_and_b32 v254, 7, v0
    s_lshl_b32 s38, s8, 5
    s_add_u32 s38, s38, s39
    v_lshrrev_b32 v252, 4, v0
    v_lshl_add_u32 v252, v252, 2, s38
    v_and_b32_e64 v251, 1, v253
    v_lshl_add_u32 v252, v252, 1, v251
    ds_read_u8 v255, v252 offset:1152
    ds_read_u8 v252, v252 offset:1184
    s_mul_i32 s38, s58, 4096
    s_add_u32 s38, s38, 140288
    v_lshl_add_u32 v249, v253, 3, s38
    v_lshl_add_u32 v250, v254, 4, s38
    s_movk_i32 s38, 288
    v_mad_u32_u24 v249, v254, s38, v249
    s_movk_i32 s38, 144
    v_mad_u32_u24 v250, v253, s38, v250
    v_lshlrev_b32_e64 v254, 4, v254
    v_lshl_add_u32 v248, v253, 14, v254
    v_lshl_add_u32 v253, v253, 11, v254
    s_and_b32 s38, s58, 1
    s_lshl_b32 s35, s9, 1
    s_add_u32 s35, s35, s38
    s_lshl_b32 s39, s39, 5
    s_add_u32 s39, s39, s8
    s_lshl_b32 s34, s35, 18
    s_lshl_b32 s38, s39, 7
    s_add_u32 s34, s34, s38
    s_add_u32 s34, s34, 3145728
    s_lshl_b32 s36, s39, 15
    s_lshl_b32 s35, s35, 7
    s_add_u32 s36, s36, s35
    s_add_u32 s37, s36, 0x4000
    s_add_u32 s35, s34, 0x20000
    s_lshl_b32 s38, s9, 5
    s_lshr_b32 s8, s8, 3
    s_add_u32 s38, s38, s8
    s_lshl_b32 s38, s38, 7
    s_add_u32 s38, s38, 983040
    s_mov_b32 s39, 0
    s_waitcnt lgkmcnt(0)
    v_lshl_or_b32 v251, v255, 24, v253
    v_lshl_or_b32 v252, v252, 24, v253
    v_lshlrev_b32 v255, 2, v0
    v_lshrrev_b32_e64 v254, 16, v7
    v_bfe_i32 v224, v254, 15, 1
    v_not_b32_e64 v224, v224
    v_or_b32 v224, 0x8000, v224
    v_xor_b32 v254, v254, v224
    v_lshlrev_b32 v254, 16, v254
    v_mul_f32 v254, 0xbfb8aa3b, v254
    v_exp_f32 v254, v254
    v_mov_b32 v253, s63
    v_add_f32 v254, 1.0, v254
    v_rcp_f32 v254, v254
    s_branch L_GATHER
L_TRIM:
    v_subrev_u32 v236, s4, v232
    v_subrev_u32 v237, s4, v233
    v_subrev_u32 v238, s4, v234
    v_subrev_u32_e64 v239, s4, v235
    v_min3_u32 v236, v236, v237, v238
    v_min_u32 v236, v236, v239
    s_nop 1
    v_min_u32_dpp v236, v236, v236 row_shr:1 row_mask:0xf bank_mask:0xf
    s_nop 0
    s_nop 0
    v_min_u32_dpp v236, v236, v236 row_shr:2 row_mask:0xf bank_mask:0xf
    s_nop 0
    s_nop 0
    v_min_u32_dpp v236, v236, v236 row_shr:4 row_mask:0xf bank_mask:0xf
    s_nop 0
    s_nop 0
    v_min_u32_dpp v236, v236, v236 row_shr:8 row_mask:0xf bank_mask:0xf
    s_nop 0
    s_nop 0
    v_min_u32_dpp v236, v236, v236 row_bcast:15 row_mask:0xa bank_mask:0xf
    s_nop 0
    s_nop 0
    v_min_u32_dpp v236, v236, v236 row_bcast:31 row_mask:0xc bank_mask:0xf
    s_nop 0
    v_readlane_b32 s5, v236, 63
    s_add_u32 s4, s4, s5
    s_add_u32 s4, s4, 1
    s_branch L_CAND
L_SLOWT:
    v_max3_u32 v228, v232, v233, v234
    v_max_u32 v228, v228, v235
    s_mov_b32 s4, 0
    s_brev_b32 s5, 1
L_BS:
    s_or_b32 s6, s4, s5
    v_cmp_le_u32_e64 vcc, s6, v228
    s_lshr_b32 s5, s5, 1
    s_bcnt1_i32_b64 s7, vcc
    s_cmp_ge_u32 s7, 8
    s_cselect_b32 s4, s6, s4
    s_cmp_lg_u32 s7, 8
    s_cbranch_scc1 L_BS
    v_mbcnt_lo_u32_b32 v229, vcc_lo, 0
    v_mbcnt_hi_u32_b32 v229, vcc_hi, v229
    v_lshlrev_b32 v229, 2, v229
    s_mov_b64 exec, vcc
    ds_write_b32 v229, v0 offset:320
    s_mov_b64 exec, -1
    v_lshrrev_b32 v230, 3, v0
    v_lshlrev_b32_e64 v230, 2, v230
    ds_read_b32 v229, v230 offset:320
    s_waitcnt lgkmcnt(0)
    v_and_b32 v230, 7, v0
    v_lshl_add_u32 v229, v229, 3, v230
    v_lshlrev_b32_e64 v230, 3, v229
    ds_read_b64 v[226:227], v230 offset:4096
    v_and_b32 v230, 1, v229
    v_and_b32 v229, -2, v229
    v_lshl_add_u32 v229, v230, 10, v229
    v_sub_u32 v232, 0xfff, v229
    v_sub_u32 v233, 0xffe, v229
    v_sub_u32 v234, 0xdff, v229
    v_sub_u32 v235, 0xdfe, v229
    s_mov_b32 s5, 0xffff0000
    s_waitcnt lgkmcnt(0)
    v_lshl_or_b32 v232, v226, 16, v232
    v_and_or_b32 v233, v226, s5, v233
    v_lshl_or_b32 v234, v227, 16, v234
    v_and_or_b32 v235, v227, s5, v235
    s_branch L_CAND
L_FIN:
L_END:
    s_endpgm
.section .rodata,"a"
.p2align 6
.amdhsa_kernel parallel_sum__ssm_conv_s4d__moe_arch_mod__prompt_kernel
  .amdhsa_next_free_vgpr 256
  .amdhsa_next_free_sgpr 102
  .amdhsa_accum_offset 256
  .amdhsa_group_segment_fixed_size 0
  .amdhsa_kernarg_size 120
  .amdhsa_user_sgpr_count 2
  .amdhsa_user_sgpr_kernarg_segment_ptr 1
  .amdhsa_system_sgpr_workgroup_id_x 1
  .amdhsa_float_denorm_mode_32 3
.end_amdhsa_kernel
```

```asm
; @launch grid=(256,1,1) block=(512,1,1) lds=156672
.amdgcn_target "amdgcn-amd-amdhsa--gfx950"
.text
.globl parallel_sum__ssm_conv_s4d__moe_arch_mod__prompt_kernel
.p2align 8
.type parallel_sum__ssm_conv_s4d__moe_arch_mod__prompt_kernel,@function
parallel_sum__ssm_conv_s4d__moe_arch_mod__prompt_kernel:
    s_cmp_ge_u32 s2, 256
    s_cbranch_scc1 L_END
    s_load_dwordx16 s[16:31], s[0:1], 0
    s_load_dwordx8 s[32:39], s[0:1], 64
    s_load_dwordx2 s[40:41], s[0:1], 96
    s_load_dwordx2 s[42:43], s[0:1], 112
    s_getpc_b64 s[14:15]
    v_lshrrev_b32_e64 v1, 6, v0
    v_and_b32 v10, 255, v0
    v_and_b32 v0, 63, v0
    v_readfirstlane_b32 s3, v1
    v_lshlrev_b32 v1, 2, v0
    v_mov_b32 v2, 0
    ds_write2st64_b32 v1, v2, v2 offset0:0 offset1:2
    s_and_b32 s5, s2, 7
    s_lshr_b32 s6, s2, 3
    s_lshl_b32 s57, s5, 5
    s_add_u32 s57, s57, s6
    s_and_b32 s58, s3, 3
    s_lshl_b32 s7, s57, 2
    s_add_u32 s7, s7, s58
    s_lshl_b32 s7, s7, 8
    v_add_u32 v15, s7, v1
    s_mov_b32 s60, 0
    s_lshl_b32 s4, s57, 3
    s_cmp_lt_u32 s3, 4
    s_cbranch_scc1 L_F0
    s_and_b32 s8, s6, 15
    s_lshl_b32 s8, s8, 2
    s_add_u32 s8, s8, s58
    s_lshl_b32 s8, s8, 9
    s_mov_b32 s69, s8
    v_lshl_add_u32 v2, v0, 7, s8
    v_min_u32 v2, L_END-parallel_sum__ssm_conv_s4d__moe_arch_mod__prompt_kernel-128, v2
    s_mov_b64 exec, 0xf
    global_load_dword v229, v2, s[14:15]
    s_mov_b64 exec, -1
    v_lshlrev_b32 v3, 12, v10
    v_add_u32_e64 v3, s4, v3
    s_lshl_b32 s8, s5, 5
    s_add_u32 s8, s8, s58
    s_lshl_b32 s8, s8, 7
    s_add_u32 s8, s8, 983040
    v_lshl_add_u32 v2, v0, 9, s8
    s_lshl_b32 s59, s5, 2
    s_add_u32 s59, s59, s58
    s_lshl_b32 s59, s59, 5
    s_add_u32 s59, s59, s6
    s_lshl_b32 s59, s59, 9
    s_add_u32 s59, s59, 7340032
    s_sub_u32 s8, s59, 512
    v_lshl_add_u32 v4, v0, 7, s8
    v_cmp_lt_u32 vcc, 3, v0
    s_nop 0
    s_nop 0
    v_cndmask_b32 v2, v2, v4, vcc
    s_lshl_b32 s8, s2, 6
    s_add_u32 s8, s8, 7864320
    v_writelane_b32 v2, s8, 3
    s_waitcnt lgkmcnt(0)
    s_cmp_ge_u32 s6, 32
    s_cbranch_scc1 L_NFP
    s_mov_b64 exec, 127
    global_load_dword v229, v2, s[42:43]
    s_mov_b64 exec, -1
L_NFP:
    global_load_dword v224, v15, s[18:19]
    global_load_dword v225, v15, s[20:21]
    global_load_dword v226, v15, s[22:23]
    global_load_dword v227, v15, s[24:25]
    s_add_u32 s6, s26, s4
    s_addc_u32 s7, s27, 0
    s_load_dwordx2 s[64:65], s[6:7], 0
    s_add_u32 s6, s28, s4
    s_addc_u32 s7, s29, 0
    s_load_dwordx2 s[66:67], s[6:7], 0
    s_barrier
    s_mov_b64 s[26:27], s[14:15]
    s_mov_b32 s61, 0x100000
    s_mov_b32 s62, 0x200000
    s_mov_b32 s63, 0x300000
    s_mov_b32 s44, s42
    s_and_b32 s45, s43, 0xffff
    s_mov_b32 s46, 0x1000000
    s_mov_b32 s47, 0x20000
    s_mov_b32 s48, s16
    s_and_b32 s49, s17, 0xffff
    s_mov_b32 s50, 0x400000
    s_mov_b32 s51, 0x20000
    s_mov_b32 s52, s40
    s_and_b32 s53, s41, 0xffff
    s_mov_b32 s54, 0x400000
    s_mov_b32 s55, 0x20000
    s_setprio 2
    s_lshr_b32 s8, s2, 3
    s_and_b32 s9, s2, 7
    s_lshr_b32 s41, s58, 1
    s_add_u32 s41, s41, 2
    v_lshrrev_b32 v172, 3, v0
    v_and_b32 v173, 7, v0
    s_lshl_b32 s40, s8, 5
    s_add_u32 s40, s40, s41
    v_lshrrev_b32_e64 v239, 4, v0
    v_lshl_add_u32 v239, v239, 2, s40
    v_and_b32_e64 v238, 1, v172
    v_lshl_add_u32 v239, v239, 1, v238
    s_mul_i32 s40, s58, 17408
    s_add_u32 s40, s40, 52224
    v_lshl_add_u32 v236, v172, 3, s40
    v_lshl_add_u32 v237, v173, 4, s40
    s_movk_i32 s40, 288
    v_mad_u32_u24 v236, v173, s40, v236
    s_movk_i32 s40, 144
    v_mad_u32_u24 v237, v172, s40, v237
    v_lshlrev_b32_e64 v173, 4, v173
    v_lshl_add_u32 v35, v172, 14, v173
    v_lshl_add_u32 v238, v172, 11, v173
    s_and_b32 s40, s58, 1
    s_lshl_b32 s37, s9, 1
    s_add_u32 s37, s37, s40
    s_lshl_b32 s41, s41, 5
    s_add_u32 s41, s41, s8
    s_lshl_b32 s36, s37, 18
    s_lshl_b32 s40, s41, 7
    s_add_u32 s36, s36, s40
    s_add_u32 s36, s36, 3145728
    s_lshl_b32 s38, s41, 15
    s_lshl_b32 s37, s37, 7
    s_add_u32 s38, s38, s37
    s_add_u32 s39, s38, 0x4000
    s_add_u32 s37, s36, 0x20000
    s_lshl_b32 s40, s9, 5
    s_lshr_b32 s8, s8, 3
    s_add_u32 s40, s40, s8
    s_lshl_b32 s40, s40, 7
    s_add_u32 s40, s40, 983552
    s_mov_b32 s41, 0
    s_sub_u32 s42, s40, 512
    s_mul_i32 s8, s58, 17408
    s_add_u32 s8, s8, 52224
    s_mul_i32 s10, s58, 4608
    s_add_u32 s10, s10, 121856
    s_mul_i32 s11, s58, 8704
    s_add_u32 s11, s11, 17408
    s_movk_i32 s9, 544
    s_sub_u32 m0, s8, 48064
    v_lshl_add_u32 v15, v0, 3, s10
    v_and_b32 v16, 15, v0
    v_lshrrev_b32 v17, 4, v0
    v_lshlrev_b32 v18, 4, v17
    v_mad_u32_u24 v12, v16, s9, v18
    v_add_u32 v14, s11, v12
    v_add_u32 v12, s8, v12
    v_add_u32 v11, s8, v18
    v_cmp_gt_u32 vcc, 3, v16
    s_nop 0
    s_nop 0
    v_cndmask_b32 v19, 12, 4, vcc
    v_cmp_eq_u32 vcc, 3, v16
    s_nop 1
    v_cndmask_b32 v19, v19, 28, vcc
    v_mad_u32_u24 v13, v19, s9, v12
    v_and_b32_e64 v20, 3, v16
    s_sub_u32 s11, s11, 17408
    s_lshl_b32 s4, s58, 2
    v_mov_b32 v4, s4
    v_mov_b32 v5, 1
    v_lshlrev_b32 v6, 2, v20
    s_movk_i32 s9, 2368
    v_lshrrev_b32 v18, 2, v0
    v_lshl_add_u32 v19, v20, 3, s8
    v_mad_u32_u24 v200, v18, s9, v19
    s_movk_i32 s4, 160
    v_mad_u32_u24 v202, v18, s4, v19
    v_lshrrev_b32 v18, 3, v0
    v_and_b32_e64 v19, 7, v0
    v_lshl_add_u32 v19, v19, 3, s8
    v_mad_u32_u24 v201, v18, s9, v19
    v_lshrrev_b32 v18, 5, v0
    v_lshlrev_b32 v18, 8, v18
    v_lshl_add_u32 v18, v16, 4, v18
    v_add_u32 v18, s8, v18
    v_and_b32 v19, 1, v17
    v_lshl_add_u32 v203, v19, 3, v18
    v_lshlrev_b32 v46, 5, v19
    v_and_b32 v18, 1, v16
    s_movk_i32 s4, 640
    v_mul_u32_u24 v18, s4, v18
    v_lshl_add_u32 v46, v18, 1, v46
    v_lshl_add_u32 v18, v17, 5, v18
    v_and_b32_e64 v19, 14, v16
    v_add3_u32 v47, v18, v19, s8
    v_add3_u32 v46, v46, v19, s8
    v_lshrrev_b32_e64 v18, 5, v0
    v_lshl_add_u32 v46, v18, 4, v46
    v_mov_b32 v234, 0
    v_mov_b32 v235, 0
    v_lshlrev_b32 v7, 4, v17
    v_lshlrev_b32 v18, 5, v16
    v_sub_u32_e64 v7, v7, v18
    s_add_u32 s4, s10, 480
    v_add_u32 v7, s4, v7
    s_lshl_b32 s4, s58, 13
    s_add_u32 s4, s4, 17408
    v_lshlrev_b32_e64 v18, 6, v16
    v_bfe_u32 v22, v16, 1, 2
    v_xor_b32_e64 v22, v22, v17
    v_lshl_add_u32 v18, v22, 4, v18
    v_add_u32 v8, s4, v18
    v_sub_u32 v22, 20, v16
    v_lshlrev_b32_e64 v23, 3, v17
    v_mov_b32 v24, 0x7f
    v_lshlrev_b32 v24, v22, v24
    v_subrev_u32 v22, 1, v22
    v_mov_b32 v25, 0x1ff
    v_lshlrev_b32 v25, v22, v25
    v_lshrrev_b32 v24, v23, v24
    v_lshrrev_b32 v25, v23, v25
    v_add_u32 v18, 1, v16
    v_and_b32 v22, 3, v18
    v_and_b32 v18, 28, v18
    v_lshl_add_u32 v26, v17, 3, v18
    v_lshl_add_u32 v26, v26, 1, s8
    v_mad_u32_u24 v1, v22, s9, v26
    v_lshlrev_b32 v26, 2, v17
    v_sub_u32 v18, v18, v26
    v_lshl_add_u32 v18, v18, 1, s8
    s_movk_i32 s4, 160
    v_mad_u32_u24 v2, v22, s4, v18
    s_mov_b32 s15, 0x3f800000
    v_sub_u32_e64 v22, 18, v16
    v_lshlrev_b32 v26, v22, 7
    v_add_u32_e64 v22, 3, v22
    v_lshlrev_b32 v27, v22, 31
    v_and_b32 v24, 0xff, v24
    v_and_b32 v25, 0xff, v25
    v_bfe_u32 v26, v26, v23, 8
    v_bfe_u32 v27, v27, v23, 8
    v_lshl_or_b32 v24, v24, 15, v24
    v_lshl_or_b32 v25, v25, 15, v25
    v_lshl_or_b32 v26, v26, 15, v26
    v_lshl_or_b32 v27, v27, 15, v27
    v_and_b32 v244, 0x10001, v24
    v_and_b32 v248, 0x10001, v25
    v_and_b32 v240, 0x10001, v26
    v_and_b32 v252, 0x10001, v27
    v_mul_u32_u24 v244, 0x3f80, v244
    v_mul_u32_u24 v248, 0x3f80, v248
    v_mul_u32_u24 v240, 0x3f80, v240
    v_mul_u32_u24 v252, 0x3f80, v252
    v_and_b32 v245, 0x40004, v24
    v_and_b32 v249, 0x40004, v25
    v_and_b32 v241, 0x40004, v26
    v_and_b32 v253, 0x40004, v27
    v_mul_u32_u24 v245, 0xfe0, v245
    v_mul_u32_u24 v249, 0xfe0, v249
    v_mul_u32_u24 v241, 0xfe0, v241
    v_mul_u32_u24 v253, 0xfe0, v253
    v_and_b32 v246, 0x100010, v24
    v_and_b32 v250, 0x100010, v25
    v_and_b32 v242, 0x100010, v26
    v_and_b32 v254, 0x100010, v27
    v_mul_u32_u24 v246, 0x3f8, v246
    v_mul_u32_u24 v250, 0x3f8, v250
    v_mul_u32_u24 v242, 0x3f8, v242
    v_mul_u32_u24 v254, 0x3f8, v254
    v_and_b32 v247, 0x400040, v24
    v_and_b32 v251, 0x400040, v25
    v_and_b32 v243, 0x400040, v26
    v_and_b32 v255, 0x400040, v27
    v_mul_u32_u24 v247, 0xfe, v247
    v_mul_u32_u24 v251, 0xfe, v251
    v_mul_u32_u24 v243, 0xfe, v243
    v_mul_u32_u24 v255, 0xfe, v255
    v_lshlrev_b32 v33, 4, v10
    v_lshlrev_b32 v32, 2, v10
    v_sub_u32 v32, 122876, v32
    s_mov_b32 s31, s59
    s_lshl_b32 s13, s57, 14
    s_add_u32 s13, s13, 3145728
    s_and_b32 s12, s2, 7
    s_lshl_b32 s12, s12, 12
    s_lshl_b32 s4, s58, 7
    s_add_u32 s12, s12, s4
    s_lshr_b32 s4, s2, 3
    s_lshl_b32 s4, s4, 2
    s_add_u32 s12, s12, s4
    s_add_u32 s12, s12, 983040
    v_and_b32 v9, 0x30, v10
    v_lshlrev_b32 v10, 3, v10
    v_xor_b32 v9, v9, v10
    v_add_u32 v9, 17408, v9
    s_mov_b32 s30, 0
    s_brev_b32 s68, 1
    s_mov_b32 s32, s13
    s_add_u32 s33, s13, 0x1000
    s_add_u32 s34, s13, 0x2000
    s_add_u32 s35, s13, 0x3000
    s_waitcnt lgkmcnt(0)
    s_lshl_b32 s4, s58, 4
    s_lshr_b64 s[6:7], s[64:65], s4
    s_lshl_b32 s6, s6, 16
    v_mov_b32 v228, s6
    v_mul_f32 v228, 0x3fb8aa3b, v228
    v_exp_f32 v228, v228
    s_nop 0
    v_cvt_pk_bf16_f32 v228, v228, v228
    v_and_b32 v228, 0xffff0000, v228
    s_lshl_b32 s4, s58, 12
    v_lshl_add_u32 v18, v0, 7, s4
    s_waitcnt vmcnt(0)
    s_mov_b32 exec_hi, 0
    buffer_load_dword v229, v18, s[44:47], s13 offen
    s_mov_b32 exec_hi, -1
    v_lshlrev_b32_e64 v48, 16, v224
    v_and_b32 v49, 0xffff0000, v224
    v_lshlrev_b32_e64 v50, 16, v225
    v_and_b32 v51, 0xffff0000, v225
    v_mul_f32 v48, 0x3fb8aa3b, v48
    v_mul_f32 v49, 0x3fb8aa3b, v49
    v_exp_f32 v48, v48
    v_exp_f32 v49, v49
    v_mul_f32 v50, v50, v228
    v_mul_f32 v51, v51, v228
    v_mul_f32 v232, 0x3e22f983, v50
    v_mul_f32 v233, 0x3e22f983, v51
    v_cvt_pk_bf16_f32 v50, v48, v49
    v_lshlrev_b32_e64 v48, 16, v50
    v_and_b32 v49, 0xffff0000, v50
    v_mul_f32 v48, v48, v228
    v_mul_f32 v49, v49, v228
    v_mul_f32 v230, 0xbfb8aa3b, v48
    v_mul_f32 v231, 0xbfb8aa3b, v49
    v_add_f32_e64 v228, v228, v228
    v_mul_f32 v28, 0x42000000, v230
    v_mul_f32 v30, 0x42000000, v232
    v_mul_f32 v29, 0x42000000, v231
    v_mul_f32 v31, 0x42000000, v233
    v_exp_f32 v20, v230
    v_fract_f32 v22, v232
    v_exp_f32 v28, v28
    v_fract_f32 v30, v30
    v_exp_f32 v21, v231
    v_fract_f32 v23, v233
    v_exp_f32 v29, v29
    v_fract_f32 v31, v31
    v_cos_f32 v16, v22
    v_lshlrev_b32 v204, 16, v226
    v_sin_f32_e64 v17, v22
    v_and_b32 v206, 0xffff0000, v226
    v_cos_f32 v18, v23
    v_lshlrev_b32 v205, 16, v227
    v_sin_f32_e64 v19, v23
    v_and_b32 v207, 0xffff0000, v227
    v_cos_f32 v24, v30
    v_mul_f32 v204, v204, v228
    v_sin_f32 v25, v30
    v_mul_f32 v205, v205, v228
    v_cos_f32 v26, v31
    v_mul_f32 v206, v206, v228
    v_sin_f32 v27, v31
    v_mul_f32 v207, v207, v228
    v_mul_f32 v16, v16, v20
    v_mul_f32 v17, v17, v20
    v_mul_f32 v18, v18, v21
    v_mul_f32 v19, v19, v21
    v_mul_f32 v24, v24, v28
    v_mul_f32 v25, v25, v28
    v_mul_f32 v26, v26, v29
    v_mul_f32 v27, v27, v29
    v_mov_b32 v112, 0x3c00
    v_mov_b32 v113, 0x3c00
    v_pk_mul_f32 v[20:21], v[16:17], v[16:17] op_sel_hi:[1,0]
    v_pk_mul_f32 v[22:23], v[18:19], v[18:19] op_sel_hi:[1,0]
    v_pk_mul_f32 v[28:29], v[24:25], v[24:25] op_sel_hi:[1,0]
    v_pk_mul_f32 v[30:31], v[26:27], v[26:27] op_sel_hi:[1,0]
    v_cvt_pk_f16_f32 v114, v16, v17
    v_cvt_pk_f16_f32 v115, v18, v19
    v_cvt_pk_f16_f32 v40, v24, v25
    v_cvt_pk_f16_f32 v41, v26, v27
    v_pk_fma_f32 v[16:17], v[16:17], v[16:17], v[20:21] op_sel:[1,1,0] op_sel_hi:[0,1,1] neg_lo:[1,0,0]
    v_pk_fma_f32 v[18:19], v[18:19], v[18:19], v[22:23] op_sel:[1,1,0] op_sel_hi:[0,1,1] neg_lo:[1,0,0]
    v_pk_fma_f32 v[24:25], v[24:25], v[24:25], v[28:29] op_sel:[1,1,0] op_sel_hi:[0,1,1] neg_lo:[1,0,0]
    v_pk_fma_f32 v[26:27], v[26:27], v[26:27], v[30:31] op_sel:[1,1,0] op_sel_hi:[0,1,1] neg_lo:[1,0,0]
    v_pk_mul_f32 v[20:21], v[16:17], v[16:17] op_sel_hi:[1,0]
    v_pk_mul_f32 v[22:23], v[18:19], v[18:19] op_sel_hi:[1,0]
    v_pk_mul_f32 v[28:29], v[24:25], v[24:25] op_sel_hi:[1,0]
    v_pk_mul_f32 v[30:31], v[26:27], v[26:27] op_sel_hi:[1,0]
    v_cvt_pk_f16_f32 v116, v16, v17
    v_cvt_pk_f16_f32 v117, v18, v19
    v_cvt_pk_f16_f32 v42, v24, v25
    v_cvt_pk_f16_f32 v43, v26, v27
    v_pk_fma_f32 v[16:17], v[16:17], v[16:17], v[20:21] op_sel:[1,1,0] op_sel_hi:[0,1,1] neg_lo:[1,0,0]
    v_pk_fma_f32 v[18:19], v[18:19], v[18:19], v[22:23] op_sel:[1,1,0] op_sel_hi:[0,1,1] neg_lo:[1,0,0]
    v_pk_fma_f32 v[24:25], v[24:25], v[24:25], v[28:29] op_sel:[1,1,0] op_sel_hi:[0,1,1] neg_lo:[1,0,0]
    v_pk_fma_f32 v[26:27], v[26:27], v[26:27], v[30:31] op_sel:[1,1,0] op_sel_hi:[0,1,1] neg_lo:[1,0,0]
    v_cvt_pk_f16_f32 v80, v204, -v205
    v_cvt_pk_f16_f32 v81, v206, -v207
    v_pk_mul_f32 v[20:21], v[16:17], v[16:17] op_sel_hi:[1,0]
    v_pk_mul_f32 v[22:23], v[18:19], v[18:19] op_sel_hi:[1,0]
    v_pk_mul_f32 v[28:29], v[24:25], v[24:25] op_sel_hi:[1,0]
    v_pk_mul_f32 v[30:31], v[26:27], v[26:27] op_sel_hi:[1,0]
    v_cvt_pk_f16_f32 v120, v16, v17
    v_cvt_pk_f16_f32 v121, v18, v19
    v_cvt_pk_f16_f32 v44, v24, v25
    v_cvt_pk_f16_f32 v45, v26, v27
    v_pk_fma_f32 v[16:17], v[16:17], v[16:17], v[20:21] op_sel:[1,1,0] op_sel_hi:[0,1,1] neg_lo:[1,0,0]
    v_pk_fma_f32 v[18:19], v[18:19], v[18:19], v[22:23] op_sel:[1,1,0] op_sel_hi:[0,1,1] neg_lo:[1,0,0]
    v_pk_fma_f32 v[24:25], v[24:25], v[24:25], v[28:29] op_sel:[1,1,0] op_sel_hi:[0,1,1] neg_lo:[1,0,0]
    v_pk_fma_f32 v[26:27], v[26:27], v[26:27], v[30:31] op_sel:[1,1,0] op_sel_hi:[0,1,1] neg_lo:[1,0,0]
    v_pk_mul_f16 v118, v116, v114 op_sel_hi:[1,0]
    v_pk_mul_f16 v119, v117, v115 op_sel_hi:[1,0]
    v_pk_mul_f16 v122, v120, v114 op_sel_hi:[1,0]
    v_pk_mul_f16 v123, v121, v115 op_sel_hi:[1,0]
    v_pk_fma_f16 v118, v116, v114, v118 op_sel:[1,1,0] op_sel_hi:[0,1,1] neg_lo:[1,0,0]
    v_pk_fma_f16 v119, v117, v115, v119 op_sel:[1,1,0] op_sel_hi:[0,1,1] neg_lo:[1,0,0]
    v_pk_fma_f16 v122, v120, v114, v122 op_sel:[1,1,0] op_sel_hi:[0,1,1] neg_lo:[1,0,0]
    v_pk_fma_f16 v123, v121, v115, v123 op_sel:[1,1,0] op_sel_hi:[0,1,1] neg_lo:[1,0,0]
    v_pk_mul_f32 v[20:21], v[16:17], v[16:17] op_sel_hi:[1,0]
    v_pk_mul_f32 v[22:23], v[18:19], v[18:19] op_sel_hi:[1,0]
    v_cvt_pk_f16_f32 v128, v16, v17
    v_cvt_pk_f16_f32 v129, v18, v19
    v_cvt_pk_f16_f32 v134, v24, v25
    v_cvt_pk_f16_f32 v135, v26, v27
    v_pk_fma_f32 v[16:17], v[16:17], v[16:17], v[20:21] op_sel:[1,1,0] op_sel_hi:[0,1,1] neg_lo:[1,0,0]
    v_pk_fma_f32 v[18:19], v[18:19], v[18:19], v[22:23] op_sel:[1,1,0] op_sel_hi:[0,1,1] neg_lo:[1,0,0]
    ds_write_addtid_b32 v112 offset:48064
    ds_write_addtid_b32 v113 offset:48320
    ds_write_addtid_b32 v114 offset:48608
    ds_write_addtid_b32 v115 offset:48864
    ds_write_addtid_b32 v116 offset:49152
    ds_write_addtid_b32 v117 offset:49408
    ds_write_addtid_b32 v120 offset:50240
    ds_write_addtid_b32 v121 offset:50496
    ds_write_addtid_b32 v118 offset:49696
    ds_write_addtid_b32 v119 offset:49952
    ds_write_addtid_b32 v122 offset:50784
    ds_write_addtid_b32 v123 offset:51040
    ds_write_addtid_b32 v128 offset:56768
    ds_write_addtid_b32 v129 offset:57024
    ds_write_addtid_b32 v134 offset:52416
    ds_write_addtid_b32 v135 offset:52672
    ds_write_addtid_b32 v44 offset:63296
    ds_write_addtid_b32 v45 offset:63552
    v_pk_mul_f16 v124, v120, v116 op_sel_hi:[1,0]
    v_pk_mul_f16 v125, v121, v117 op_sel_hi:[1,0]
    v_pk_mul_f16 v126, v120, v118 op_sel_hi:[1,0]
    v_pk_mul_f16 v127, v121, v119 op_sel_hi:[1,0]
    v_pk_fma_f16 v124, v120, v116, v124 op_sel:[1,1,0] op_sel_hi:[0,1,1] neg_lo:[1,0,0]
    v_pk_fma_f16 v125, v121, v117, v125 op_sel:[1,1,0] op_sel_hi:[0,1,1] neg_lo:[1,0,0]
    v_pk_fma_f16 v126, v120, v118, v126 op_sel:[1,1,0] op_sel_hi:[0,1,1] neg_lo:[1,0,0]
    v_pk_fma_f16 v127, v121, v119, v127 op_sel:[1,1,0] op_sel_hi:[0,1,1] neg_lo:[1,0,0]
    v_pk_mul_f16 v132, v128, v116 op_sel_hi:[1,0]
    v_pk_mul_f16 v133, v129, v117 op_sel_hi:[1,0]
    v_pk_mul_f16 v136, v134, v116 op_sel_hi:[1,0]
    v_pk_mul_f16 v137, v135, v117 op_sel_hi:[1,0]
    v_pk_fma_f16 v132, v128, v116, v132 op_sel:[1,1,0] op_sel_hi:[0,1,1] neg_lo:[1,0,0]
    v_pk_fma_f16 v133, v129, v117, v133 op_sel:[1,1,0] op_sel_hi:[0,1,1] neg_lo:[1,0,0]
    v_pk_fma_f16 v136, v134, v116, v136 op_sel:[1,1,0] op_sel_hi:[0,1,1] neg_lo:[1,0,0]
    v_pk_fma_f16 v137, v135, v117, v137 op_sel:[1,1,0] op_sel_hi:[0,1,1] neg_lo:[1,0,0]
    v_pk_mul_f16 v138, v134, v120 op_sel_hi:[1,0]
    v_pk_mul_f16 v139, v135, v121 op_sel_hi:[1,0]
    v_pk_mul_f16 v140, v134, v124 op_sel_hi:[1,0]
    v_pk_mul_f16 v141, v135, v125 op_sel_hi:[1,0]
    v_pk_fma_f16 v138, v134, v120, v138 op_sel:[1,1,0] op_sel_hi:[0,1,1] neg_lo:[1,0,0]
    v_pk_fma_f16 v139, v135, v121, v139 op_sel:[1,1,0] op_sel_hi:[0,1,1] neg_lo:[1,0,0]
    v_pk_fma_f16 v140, v134, v124, v140 op_sel:[1,1,0] op_sel_hi:[0,1,1] neg_lo:[1,0,0]
    v_pk_fma_f16 v141, v135, v125, v141 op_sel:[1,1,0] op_sel_hi:[0,1,1] neg_lo:[1,0,0]
    v_pk_mul_f16 v142, v134, v128 op_sel_hi:[1,0]
    v_pk_mul_f16 v143, v135, v129 op_sel_hi:[1,0]
    v_pk_mul_f16 v144, v134, v132 op_sel_hi:[1,0]
    v_pk_mul_f16 v145, v135, v133 op_sel_hi:[1,0]
    v_pk_fma_f16 v142, v134, v128, v142 op_sel:[1,1,0] op_sel_hi:[0,1,1] neg_lo:[1,0,0]
    v_pk_fma_f16 v143, v135, v129, v143 op_sel:[1,1,0] op_sel_hi:[0,1,1] neg_lo:[1,0,0]
    v_pk_fma_f16 v144, v134, v132, v144 op_sel:[1,1,0] op_sel_hi:[0,1,1] neg_lo:[1,0,0]
    v_pk_fma_f16 v145, v135, v133, v145 op_sel:[1,1,0] op_sel_hi:[0,1,1] neg_lo:[1,0,0]
    ds_write_addtid_b32 v124 offset:51328
    ds_write_addtid_b32 v125 offset:51584
    ds_write_addtid_b32 v126 offset:51872
    ds_write_addtid_b32 v127 offset:52128
    ds_write_addtid_b32 v132 offset:57856
    ds_write_addtid_b32 v133 offset:58112
    ds_write_addtid_b32 v136 offset:52960
    ds_write_addtid_b32 v137 offset:53216
    ds_write_addtid_b32 v138 offset:53504
    ds_write_addtid_b32 v139 offset:53760
    ds_write_addtid_b32 v138 offset:54592
    ds_write_addtid_b32 v139 offset:54848
    ds_write_addtid_b32 v140 offset:54048
    ds_write_addtid_b32 v141 offset:54304
    ds_write_addtid_b32 v140 offset:55136
    ds_write_addtid_b32 v141 offset:55392
    ds_write_addtid_b32 v142 offset:55680
    ds_write_addtid_b32 v143 offset:55936
    ds_write_addtid_b32 v144 offset:56224
    ds_write_addtid_b32 v145 offset:56480
    ds_read_b128 v[168:171], v12 offset:0
    ds_read_b128 v[172:175], v12 offset:64
    ds_read_b128 v[176:179], v12 offset:128
    ds_read_b128 v[180:183], v12 offset:192
    ds_read_b128 v[184:187], v12 offset:256
    ds_read_b128 v[188:191], v12 offset:320
    ds_read_b128 v[192:195], v12 offset:384
    ds_read_b128 v[196:199], v12 offset:448
    s_mov_b32 m0, s11
    s_nop 0
    v_cvt_pk_f16_f32 v38, v16, v17
    v_cvt_pk_f16_f32 v39, v18, v19
    v_pk_mul_f16 v82, v80, v128 op_sel_hi:[1,0]
    v_pk_mul_f16 v83, v81, v129 op_sel_hi:[1,0]
    v_pk_mul_f16 v88, v80, v40 op_sel_hi:[1,0]
    v_pk_mul_f16 v89, v81, v41 op_sel_hi:[1,0]
    v_pk_fma_f16 v82, v80, v128, v82 op_sel:[1,1,0] op_sel_hi:[0,1,1] neg_hi:[1,0,0]
    v_pk_fma_f16 v83, v81, v129, v83 op_sel:[1,1,0] op_sel_hi:[0,1,1] neg_hi:[1,0,0]
    v_pk_fma_f16 v88, v80, v40, v88 op_sel:[1,1,0] op_sel_hi:[0,1,1] neg_hi:[1,0,0]
    v_pk_fma_f16 v89, v81, v41, v89 op_sel:[1,1,0] op_sel_hi:[0,1,1] neg_hi:[1,0,0]
    v_pk_mul_f16 v84, v80, v38 op_sel_hi:[1,0]
    v_pk_mul_f16 v85, v81, v39 op_sel_hi:[1,0]
    v_pk_mul_f16 v86, v82, v38 op_sel_hi:[1,0]
    v_pk_mul_f16 v87, v83, v39 op_sel_hi:[1,0]
    v_pk_fma_f16 v84, v80, v38, v84 op_sel:[1,1,0] op_sel_hi:[0,1,1] neg_hi:[1,0,0]
    v_pk_fma_f16 v85, v81, v39, v85 op_sel:[1,1,0] op_sel_hi:[0,1,1] neg_hi:[1,0,0]
    v_pk_fma_f16 v86, v82, v38, v86 op_sel:[1,1,0] op_sel_hi:[0,1,1] neg_hi:[1,0,0]
    v_pk_fma_f16 v87, v83, v39, v87 op_sel:[1,1,0] op_sel_hi:[0,1,1] neg_hi:[1,0,0]
    v_pk_mul_f16 v90, v82, v40 op_sel_hi:[1,0]
    v_pk_mul_f16 v91, v83, v41 op_sel_hi:[1,0]
    v_pk_mul_f16 v96, v80, v42 op_sel_hi:[1,0]
    v_pk_mul_f16 v97, v81, v43 op_sel_hi:[1,0]
    v_pk_fma_f16 v90, v82, v40, v90 op_sel:[1,1,0] op_sel_hi:[0,1,1] neg_hi:[1,0,0]
    v_pk_fma_f16 v91, v83, v41, v91 op_sel:[1,1,0] op_sel_hi:[0,1,1] neg_hi:[1,0,0]
    v_pk_fma_f16 v96, v80, v42, v96 op_sel:[1,1,0] op_sel_hi:[0,1,1] neg_hi:[1,0,0]
    v_pk_fma_f16 v97, v81, v43, v97 op_sel:[1,1,0] op_sel_hi:[0,1,1] neg_hi:[1,0,0]
    v_pk_mul_f16 v92, v84, v40 op_sel_hi:[1,0]
    v_pk_mul_f16 v93, v85, v41 op_sel_hi:[1,0]
    v_pk_mul_f16 v94, v86, v40 op_sel_hi:[1,0]
    v_pk_mul_f16 v95, v87, v41 op_sel_hi:[1,0]
    v_pk_fma_f16 v92, v84, v40, v92 op_sel:[1,1,0] op_sel_hi:[0,1,1] neg_hi:[1,0,0]
    v_pk_fma_f16 v93, v85, v41, v93 op_sel:[1,1,0] op_sel_hi:[0,1,1] neg_hi:[1,0,0]
    v_pk_fma_f16 v94, v86, v40, v94 op_sel:[1,1,0] op_sel_hi:[0,1,1] neg_hi:[1,0,0]
    v_pk_fma_f16 v95, v87, v41, v95 op_sel:[1,1,0] op_sel_hi:[0,1,1] neg_hi:[1,0,0]
    ds_write_addtid_b32 v80 offset:17408
    ds_write_addtid_b32 v81 offset:17664
    ds_write_addtid_b32 v82 offset:17952
    ds_write_addtid_b32 v83 offset:18208
    ds_write_addtid_b32 v84 offset:18496
    ds_write_addtid_b32 v85 offset:18752
    ds_write_addtid_b32 v86 offset:19040
    ds_write_addtid_b32 v87 offset:19296
    ds_write_addtid_b32 v88 offset:19584
    ds_write_addtid_b32 v89 offset:19840
    ds_write_addtid_b32 v90 offset:20128
    ds_write_addtid_b32 v91 offset:20384
    ds_write_addtid_b32 v92 offset:20672
    ds_write_addtid_b32 v93 offset:20928
    ds_write_addtid_b32 v94 offset:21216
    ds_write_addtid_b32 v95 offset:21472
    ds_write_addtid_b32 v96 offset:21760
    ds_write_addtid_b32 v97 offset:22016
    v_pk_mul_f16 v98, v82, v42 op_sel_hi:[1,0]
    v_pk_mul_f16 v99, v83, v43 op_sel_hi:[1,0]
    v_pk_mul_f16 v104, v88, v42 op_sel_hi:[1,0]
    v_pk_mul_f16 v105, v89, v43 op_sel_hi:[1,0]
    v_pk_fma_f16 v98, v82, v42, v98 op_sel:[1,1,0] op_sel_hi:[0,1,1] neg_hi:[1,0,0]
    v_pk_fma_f16 v99, v83, v43, v99 op_sel:[1,1,0] op_sel_hi:[0,1,1] neg_hi:[1,0,0]
    v_pk_fma_f16 v104, v88, v42, v104 op_sel:[1,1,0] op_sel_hi:[0,1,1] neg_hi:[1,0,0]
    v_pk_fma_f16 v105, v89, v43, v105 op_sel:[1,1,0] op_sel_hi:[0,1,1] neg_hi:[1,0,0]
    v_pk_mul_f16 v100, v84, v42 op_sel_hi:[1,0]
    v_pk_mul_f16 v101, v85, v43 op_sel_hi:[1,0]
    v_pk_mul_f16 v102, v86, v42 op_sel_hi:[1,0]
    v_pk_mul_f16 v103, v87, v43 op_sel_hi:[1,0]
    v_pk_fma_f16 v100, v84, v42, v100 op_sel:[1,1,0] op_sel_hi:[0,1,1] neg_hi:[1,0,0]
    v_pk_fma_f16 v101, v85, v43, v101 op_sel:[1,1,0] op_sel_hi:[0,1,1] neg_hi:[1,0,0]
    v_pk_fma_f16 v102, v86, v42, v102 op_sel:[1,1,0] op_sel_hi:[0,1,1] neg_hi:[1,0,0]
    v_pk_fma_f16 v103, v87, v43, v103 op_sel:[1,1,0] op_sel_hi:[0,1,1] neg_hi:[1,0,0]
    v_pk_mul_f16 v106, v90, v42 op_sel_hi:[1,0]
    v_pk_mul_f16 v107, v91, v43 op_sel_hi:[1,0]
    v_pk_mul_f16 v108, v92, v42 op_sel_hi:[1,0]
    v_pk_mul_f16 v109, v93, v43 op_sel_hi:[1,0]
    v_pk_fma_f16 v106, v90, v42, v106 op_sel:[1,1,0] op_sel_hi:[0,1,1] neg_hi:[1,0,0]
    v_pk_fma_f16 v107, v91, v43, v107 op_sel:[1,1,0] op_sel_hi:[0,1,1] neg_hi:[1,0,0]
    v_pk_fma_f16 v108, v92, v42, v108 op_sel:[1,1,0] op_sel_hi:[0,1,1] neg_hi:[1,0,0]
    v_pk_fma_f16 v109, v93, v43, v109 op_sel:[1,1,0] op_sel_hi:[0,1,1] neg_hi:[1,0,0]
    v_pk_mul_f16 v110, v94, v42 op_sel_hi:[1,0]
    v_pk_mul_f16 v111, v95, v43 op_sel_hi:[1,0]
    v_pk_mul_f16 v130, v128, v114 op_sel_hi:[1,0]
    v_pk_mul_f16 v131, v129, v115 op_sel_hi:[1,0]
    v_pk_fma_f16 v110, v94, v42, v110 op_sel:[1,1,0] op_sel_hi:[0,1,1] neg_hi:[1,0,0]
    v_pk_fma_f16 v111, v95, v43, v111 op_sel:[1,1,0] op_sel_hi:[0,1,1] neg_hi:[1,0,0]
    v_pk_fma_f16 v130, v128, v114, v130 op_sel:[1,1,0] op_sel_hi:[0,1,1] neg_lo:[1,0,0]
    v_pk_fma_f16 v131, v129, v115, v131 op_sel:[1,1,0] op_sel_hi:[0,1,1] neg_lo:[1,0,0]
    ds_write_addtid_b32 v98 offset:22304
    ds_write_addtid_b32 v99 offset:22560
    ds_write_addtid_b32 v100 offset:22848
    ds_write_addtid_b32 v101 offset:23104
    ds_write_addtid_b32 v102 offset:23392
    ds_write_addtid_b32 v103 offset:23648
    ds_write_addtid_b32 v104 offset:23936
    ds_write_addtid_b32 v105 offset:24192
    ds_write_addtid_b32 v106 offset:24480
    ds_write_addtid_b32 v107 offset:24736
    ds_write_addtid_b32 v108 offset:25024
    ds_write_addtid_b32 v109 offset:25280
    ds_write_addtid_b32 v110 offset:25568
    ds_write_addtid_b32 v111 offset:25824
    ds_read_b128 v[48:51], v14 offset:0
    ds_read_b128 v[52:55], v14 offset:64
    ds_read_b128 v[56:59], v14 offset:128
    ds_read_b128 v[60:63], v14 offset:192
    ds_read_b128 v[64:67], v14 offset:256
    ds_read_b128 v[68:71], v14 offset:320
    ds_read_b128 v[72:75], v14 offset:384
    ds_read_b128 v[76:79], v14 offset:448
    ds_read_b128 v[80:83], v11 offset:15232
    ds_read_b128 v[84:87], v11 offset:15296
    ds_read_b128 v[88:91], v11 offset:15360
    ds_read_b128 v[92:95], v11 offset:15424
    ds_read_b128 v[96:99], v11 offset:15488
    ds_read_b128 v[100:103], v11 offset:15552
    ds_read_b128 v[104:107], v11 offset:15616
    ds_read_b128 v[108:111], v11 offset:15680
    s_sub_u32 m0, s8, 48064
    v_pk_mul_f32 v[28:29], v[24:25], v[24:25] op_sel_hi:[1,0]
    v_pk_mul_f32 v[30:31], v[26:27], v[26:27] op_sel_hi:[1,0]
    v_pk_fma_f32 v[24:25], v[24:25], v[24:25], v[28:29] op_sel:[1,1,0] op_sel_hi:[0,1,1] neg_lo:[1,0,0]
    v_pk_fma_f32 v[26:27], v[26:27], v[26:27], v[30:31] op_sel:[1,1,0] op_sel_hi:[0,1,1] neg_lo:[1,0,0]
    v_cvt_pk_f16_f32 v146, v24, v25
    v_cvt_pk_f16_f32 v147, v26, v27
    v_pk_mul_f32 v[28:29], v[24:25], v[24:25] op_sel_hi:[1,0]
    v_pk_mul_f32 v[30:31], v[26:27], v[26:27] op_sel_hi:[1,0]
    v_pk_fma_f32 v[24:25], v[24:25], v[24:25], v[28:29] op_sel:[1,1,0] op_sel_hi:[0,1,1] neg_lo:[1,0,0]
    v_pk_fma_f32 v[26:27], v[26:27], v[26:27], v[30:31] op_sel:[1,1,0] op_sel_hi:[0,1,1] neg_lo:[1,0,0]
    v_cvt_pk_f16_f32 v166, v24, v25
    v_cvt_pk_f16_f32 v167, v26, v27
    s_waitcnt lgkmcnt(8)
    s_nop 0
    v_mfma_f32_16x16x32_f16 v[204:207], v[168:171], v[48:51], 0
    v_pk_mul_f16 v152, v146, v134 op_sel_hi:[1,0]
    v_pk_mul_f16 v153, v147, v135 op_sel_hi:[1,0]
    v_pk_mul_f16 v148, v146, v120 op_sel_hi:[1,0]
    v_pk_mul_f16 v149, v147, v121 op_sel_hi:[1,0]
    v_mfma_f32_16x16x32_f16 v[204:207], v[172:175], v[52:55], v[204:207]
    v_pk_fma_f16 v152, v146, v134, v152 op_sel:[1,1,0] op_sel_hi:[0,1,1] neg_lo:[1,0,0]
    v_pk_fma_f16 v153, v147, v135, v153 op_sel:[1,1,0] op_sel_hi:[0,1,1] neg_lo:[1,0,0]
    v_pk_fma_f16 v148, v146, v120, v148 op_sel:[1,1,0] op_sel_hi:[0,1,1] neg_lo:[1,0,0]
    v_pk_fma_f16 v149, v147, v121, v149 op_sel:[1,1,0] op_sel_hi:[0,1,1] neg_lo:[1,0,0]
    v_mfma_f32_16x16x32_f16 v[204:207], v[176:179], v[56:59], v[204:207]
    v_pk_mul_f16 v150, v146, v128 op_sel_hi:[1,0]
    v_pk_mul_f16 v151, v147, v129 op_sel_hi:[1,0]
    v_pk_mul_f16 v158, v128, v166 op_sel_hi:[1,0]
    v_pk_mul_f16 v159, v129, v167 op_sel_hi:[1,0]
    v_mfma_f32_16x16x32_f16 v[204:207], v[180:183], v[60:63], v[204:207]
    v_pk_fma_f16 v150, v146, v128, v150 op_sel:[1,1,0] op_sel_hi:[0,1,1] neg_lo:[1,0,0]
    v_pk_fma_f16 v151, v147, v129, v151 op_sel:[1,1,0] op_sel_hi:[0,1,1] neg_lo:[1,0,0]
    v_pk_fma_f16 v158, v128, v166, v158 op_sel:[1,1,0] op_sel_hi:[0,1,1] neg_lo:[1,0,0]
    v_pk_fma_f16 v159, v129, v167, v159 op_sel:[1,1,0] op_sel_hi:[0,1,1] neg_lo:[1,0,0]
    v_mfma_f32_16x16x32_f16 v[204:207], v[184:187], v[64:67], v[204:207]
    v_pk_mul_f16 v154, v152, v120 op_sel_hi:[1,0]
    v_pk_mul_f16 v155, v153, v121 op_sel_hi:[1,0]
    v_pk_mul_f16 v156, v152, v128 op_sel_hi:[1,0]
    v_pk_mul_f16 v157, v153, v129 op_sel_hi:[1,0]
    v_mfma_f32_16x16x32_f16 v[204:207], v[188:191], v[68:71], v[204:207]
    v_pk_fma_f16 v154, v152, v120, v154 op_sel:[1,1,0] op_sel_hi:[0,1,1] neg_lo:[1,0,0]
    v_pk_fma_f16 v155, v153, v121, v155 op_sel:[1,1,0] op_sel_hi:[0,1,1] neg_lo:[1,0,0]
    v_pk_fma_f16 v156, v152, v128, v156 op_sel:[1,1,0] op_sel_hi:[0,1,1] neg_lo:[1,0,0]
    v_pk_fma_f16 v157, v153, v129, v157 op_sel:[1,1,0] op_sel_hi:[0,1,1] neg_lo:[1,0,0]
    v_mfma_f32_16x16x32_f16 v[204:207], v[192:195], v[72:75], v[204:207]
    v_pk_mul_f16 v160, v142, v166 op_sel_hi:[1,0]
    v_pk_mul_f16 v161, v143, v167 op_sel_hi:[1,0]
    v_pk_mul_f16 v162, v150, v166 op_sel_hi:[1,0]
    v_pk_mul_f16 v163, v151, v167 op_sel_hi:[1,0]
    v_mfma_f32_16x16x32_f16 v[204:207], v[196:199], v[76:79], v[204:207]
    v_pk_fma_f16 v160, v142, v166, v160 op_sel:[1,1,0] op_sel_hi:[0,1,1] neg_lo:[1,0,0]
    v_pk_fma_f16 v161, v143, v167, v161 op_sel:[1,1,0] op_sel_hi:[0,1,1] neg_lo:[1,0,0]
    v_pk_fma_f16 v162, v150, v166, v162 op_sel:[1,1,0] op_sel_hi:[0,1,1] neg_lo:[1,0,0]
    v_pk_fma_f16 v163, v151, v167, v163 op_sel:[1,1,0] op_sel_hi:[0,1,1] neg_lo:[1,0,0]
    v_pk_mul_f16 v164, v156, v166 op_sel_hi:[1,0]
    v_pk_mul_f16 v165, v157, v167 op_sel_hi:[1,0]
    v_pk_fma_f16 v164, v156, v166, v164 op_sel:[1,1,0] op_sel_hi:[0,1,1] neg_lo:[1,0,0]
    v_pk_fma_f16 v165, v157, v167, v165 op_sel:[1,1,0] op_sel_hi:[0,1,1] neg_lo:[1,0,0]
    ds_write_addtid_b32 v130 offset:57312
    ds_write_addtid_b32 v131 offset:57568
    ds_write_addtid_b32 v146 offset:58944
    ds_write_addtid_b32 v147 offset:59200
    ds_write_addtid_b32 v152 offset:61120
    ds_write_addtid_b32 v153 offset:61376
    ds_write_addtid_b32 v148 offset:59488
    ds_write_addtid_b32 v149 offset:59744
    ds_write_addtid_b32 v150 offset:60032
    ds_write_addtid_b32 v151 offset:60288
    ds_write_addtid_b32 v158 offset:64928
    ds_write_addtid_b32 v159 offset:65184
    ds_write_addtid_b32 v154 offset:61664
    ds_write_addtid_b32 v155 offset:61920
    ds_write_addtid_b32 v156 offset:62208
    ds_write_addtid_b32 v157 offset:62464
    ds_write_addtid_b32 v160 offset:58400
    ds_write_addtid_b32 v161 offset:58656
    ds_write_addtid_b32 v162 offset:60576
    ds_write_addtid_b32 v163 offset:60832
    ds_write_addtid_b32 v164 offset:62752
    ds_write_addtid_b32 v165 offset:63008
    ds_read_b128 v[112:115], v13 offset:0
    ds_read_b128 v[116:119], v13 offset:64
    ds_read_b128 v[120:123], v13 offset:128
    ds_read_b128 v[124:127], v13 offset:192
    ds_read_b128 v[128:131], v13 offset:256
    ds_read_b128 v[132:135], v13 offset:320
    ds_read_b128 v[136:139], v13 offset:384
    ds_read_b128 v[140:143], v13 offset:448
    s_mov_b64 exec, 0xffff
    ds_write_b64 v200, v[234:235]
    s_mov_b32 exec_lo, -1
    ds_write2_b64 v201, v[234:235], v[234:235] offset0:132 offset1:140
    ds_write_b64 v202, v[234:235] offset:9472
    s_mov_b64 exec, -1
    ds_write_b64 v202, v[234:235] offset:10752
    ds_write_b64 v202, v[234:235] offset:10816
    ds_write_b64 v202, v[234:235] offset:10848
    ds_read_b32 v34, v6 offset:128
    s_buffer_load_dwordx8 s[16:23], s[44:47], s31
L_XI1:
    v_pk_mul_f16 v220, v48, v80 op_sel_hi:[1,0]
    v_pk_mul_f16 v221, v49, v81 op_sel_hi:[1,0]
    v_pk_mul_f16 v222, v50, v82 op_sel_hi:[1,0]
    v_pk_mul_f16 v223, v51, v83 op_sel_hi:[1,0]
    v_pk_fma_f16 v80, v48, v80, v220 op_sel:[1,1,0] op_sel_hi:[0,1,1] neg_hi:[1,0,0]
    v_pk_fma_f16 v81, v49, v81, v221 op_sel:[1,1,0] op_sel_hi:[0,1,1] neg_hi:[1,0,0]
    v_pk_fma_f16 v82, v50, v82, v222 op_sel:[1,1,0] op_sel_hi:[0,1,1] neg_hi:[1,0,0]
    v_pk_fma_f16 v83, v51, v83, v223 op_sel:[1,1,0] op_sel_hi:[0,1,1] neg_hi:[1,0,0]
    v_pk_mul_f16 v220, v52, v84 op_sel_hi:[1,0]
    v_pk_mul_f16 v221, v53, v85 op_sel_hi:[1,0]
    v_mfma_f32_16x16x32_f16 v[208:211], v[168:171], v[80:83], 0
    v_pk_mul_f16 v222, v54, v86 op_sel_hi:[1,0]
    v_pk_mul_f16 v223, v55, v87 op_sel_hi:[1,0]
    v_pk_fma_f16 v84, v52, v84, v220 op_sel:[1,1,0] op_sel_hi:[0,1,1] neg_hi:[1,0,0]
    v_pk_fma_f16 v85, v53, v85, v221 op_sel:[1,1,0] op_sel_hi:[0,1,1] neg_hi:[1,0,0]
    v_pk_fma_f16 v86, v54, v86, v222 op_sel:[1,1,0] op_sel_hi:[0,1,1] neg_hi:[1,0,0]
    v_pk_fma_f16 v87, v55, v87, v223 op_sel:[1,1,0] op_sel_hi:[0,1,1] neg_hi:[1,0,0]
    s_waitcnt lgkmcnt(12)
    s_nop 0
    v_pk_mul_f16 v220, v56, v88 op_sel_hi:[1,0]
    v_pk_mul_f16 v221, v57, v89 op_sel_hi:[1,0]
    v_mfma_f32_16x16x32_f16 v[208:211], v[172:175], v[84:87], v[208:211]
    v_pk_mul_f16 v222, v58, v90 op_sel_hi:[1,0]
    v_pk_mul_f16 v223, v59, v91 op_sel_hi:[1,0]
    v_pk_fma_f16 v88, v56, v88, v220 op_sel:[1,1,0] op_sel_hi:[0,1,1] neg_hi:[1,0,0]
    v_mfma_f32_16x16x32_f16 v[212:215], v[112:115], v[48:51], 0
    v_pk_fma_f16 v89, v57, v89, v221 op_sel:[1,1,0] op_sel_hi:[0,1,1] neg_hi:[1,0,0]
    v_pk_fma_f16 v90, v58, v90, v222 op_sel:[1,1,0] op_sel_hi:[0,1,1] neg_hi:[1,0,0]
    v_pk_fma_f16 v91, v59, v91, v223 op_sel:[1,1,0] op_sel_hi:[0,1,1] neg_hi:[1,0,0]
    v_mfma_f32_16x16x32_f16 v[216:219], v[112:115], v[80:83], 0
    v_pk_mul_f16 v220, v60, v92 op_sel_hi:[1,0]
    v_pk_mul_f16 v221, v61, v93 op_sel_hi:[1,0]
    v_mfma_f32_16x16x32_f16 v[208:211], v[176:179], v[88:91], v[208:211]
    v_pk_mul_f16 v222, v62, v94 op_sel_hi:[1,0]
    v_pk_mul_f16 v223, v63, v95 op_sel_hi:[1,0]
    v_pk_fma_f16 v92, v60, v92, v220 op_sel:[1,1,0] op_sel_hi:[0,1,1] neg_hi:[1,0,0]
    v_mfma_f32_16x16x32_f16 v[212:215], v[116:119], v[52:55], v[212:215]
    v_pk_fma_f16 v93, v61, v93, v221 op_sel:[1,1,0] op_sel_hi:[0,1,1] neg_hi:[1,0,0]
    v_pk_fma_f16 v94, v62, v94, v222 op_sel:[1,1,0] op_sel_hi:[0,1,1] neg_hi:[1,0,0]
    v_pk_fma_f16 v95, v63, v95, v223 op_sel:[1,1,0] op_sel_hi:[0,1,1] neg_hi:[1,0,0]
    v_mfma_f32_16x16x32_f16 v[216:219], v[116:119], v[84:87], v[216:219]
    s_waitcnt lgkmcnt(10)
    s_nop 0
    v_pk_mul_f16 v220, v64, v96 op_sel_hi:[1,0]
    v_pk_mul_f16 v221, v65, v97 op_sel_hi:[1,0]
    v_mfma_f32_16x16x32_f16 v[208:211], v[180:183], v[92:95], v[208:211]
    v_pk_mul_f16 v222, v66, v98 op_sel_hi:[1,0]
    v_pk_mul_f16 v223, v67, v99 op_sel_hi:[1,0]
    v_pk_fma_f16 v96, v64, v96, v220 op_sel:[1,1,0] op_sel_hi:[0,1,1] neg_hi:[1,0,0]
    v_mfma_f32_16x16x32_f16 v[212:215], v[120:123], v[56:59], v[212:215]
    v_pk_fma_f16 v97, v65, v97, v221 op_sel:[1,1,0] op_sel_hi:[0,1,1] neg_hi:[1,0,0]
    v_pk_fma_f16 v98, v66, v98, v222 op_sel:[1,1,0] op_sel_hi:[0,1,1] neg_hi:[1,0,0]
    v_pk_fma_f16 v99, v67, v99, v223 op_sel:[1,1,0] op_sel_hi:[0,1,1] neg_hi:[1,0,0]
    v_mfma_f32_16x16x32_f16 v[216:219], v[120:123], v[88:91], v[216:219]
    v_pk_mul_f16 v220, v68, v100 op_sel_hi:[1,0]
    v_pk_mul_f16 v221, v69, v101 op_sel_hi:[1,0]
    v_mfma_f32_16x16x32_f16 v[208:211], v[184:187], v[96:99], v[208:211]
    v_pk_mul_f16 v222, v70, v102 op_sel_hi:[1,0]
    v_pk_mul_f16 v223, v71, v103 op_sel_hi:[1,0]
    v_pk_fma_f16 v100, v68, v100, v220 op_sel:[1,1,0] op_sel_hi:[0,1,1] neg_hi:[1,0,0]
    v_mfma_f32_16x16x32_f16 v[212:215], v[124:127], v[60:63], v[212:215]
    v_pk_fma_f16 v101, v69, v101, v221 op_sel:[1,1,0] op_sel_hi:[0,1,1] neg_hi:[1,0,0]
    v_pk_fma_f16 v102, v70, v102, v222 op_sel:[1,1,0] op_sel_hi:[0,1,1] neg_hi:[1,0,0]
    v_pk_fma_f16 v103, v71, v103, v223 op_sel:[1,1,0] op_sel_hi:[0,1,1] neg_hi:[1,0,0]
    v_mfma_f32_16x16x32_f16 v[216:219], v[124:127], v[92:95], v[216:219]
    s_waitcnt lgkmcnt(8)
    s_nop 0
    v_pk_mul_f16 v220, v72, v104 op_sel_hi:[1,0]
    v_pk_mul_f16 v221, v73, v105 op_sel_hi:[1,0]
    v_mfma_f32_16x16x32_f16 v[208:211], v[188:191], v[100:103], v[208:211]
    v_pk_mul_f16 v222, v74, v106 op_sel_hi:[1,0]
    v_pk_mul_f16 v223, v75, v107 op_sel_hi:[1,0]
    v_pk_fma_f16 v104, v72, v104, v220 op_sel:[1,1,0] op_sel_hi:[0,1,1] neg_hi:[1,0,0]
    v_mfma_f32_16x16x32_f16 v[212:215], v[128:131], v[64:67], v[212:215]
    v_pk_fma_f16 v105, v73, v105, v221 op_sel:[1,1,0] op_sel_hi:[0,1,1] neg_hi:[1,0,0]
    v_pk_fma_f16 v106, v74, v106, v222 op_sel:[1,1,0] op_sel_hi:[0,1,1] neg_hi:[1,0,0]
    v_pk_fma_f16 v107, v75, v107, v223 op_sel:[1,1,0] op_sel_hi:[0,1,1] neg_hi:[1,0,0]
    v_mfma_f32_16x16x32_f16 v[216:219], v[128:131], v[96:99], v[216:219]
    v_pk_mul_f16 v220, v76, v108 op_sel_hi:[1,0]
    v_pk_mul_f16 v221, v77, v109 op_sel_hi:[1,0]
    v_mfma_f32_16x16x32_f16 v[208:211], v[192:195], v[104:107], v[208:211]
    v_pk_mul_f16 v222, v78, v110 op_sel_hi:[1,0]
    v_pk_mul_f16 v223, v79, v111 op_sel_hi:[1,0]
    v_pk_fma_f16 v108, v76, v108, v220 op_sel:[1,1,0] op_sel_hi:[0,1,1] neg_hi:[1,0,0]
    v_mfma_f32_16x16x32_f16 v[212:215], v[132:135], v[68:71], v[212:215]
    v_pk_fma_f16 v109, v77, v109, v221 op_sel:[1,1,0] op_sel_hi:[0,1,1] neg_hi:[1,0,0]
    v_pk_fma_f16 v110, v78, v110, v222 op_sel:[1,1,0] op_sel_hi:[0,1,1] neg_hi:[1,0,0]
    v_pk_fma_f16 v111, v79, v111, v223 op_sel:[1,1,0] op_sel_hi:[0,1,1] neg_hi:[1,0,0]
    v_mfma_f32_16x16x32_f16 v[216:219], v[132:135], v[100:103], v[216:219]
    s_waitcnt lgkmcnt(6)
    s_nop 0
    v_mfma_f32_16x16x32_f16 v[208:211], v[196:199], v[108:111], v[208:211]
    v_mfma_f32_16x16x32_f16 v[212:215], v[136:139], v[72:75], v[212:215]
    v_mfma_f32_16x16x32_f16 v[216:219], v[136:139], v[104:107], v[216:219]
    v_mfma_f32_16x16x32_f16 v[212:215], v[140:143], v[76:79], v[212:215]
    v_mfma_f32_16x16x32_f16 v[216:219], v[140:143], v[108:111], v[216:219]
    s_waitcnt lgkmcnt(0)
    v_readfirstlane_b32 s28, v34
    s_add_u32 s31, s31, 64
    s_mov_b32 s29, s28
    s_cmp_eq_u32 s28, 0
    s_cbranch_scc1 L_XE1
    s_xor_b64 s[16:17], s[16:17], s[28:29]
    s_xor_b64 s[18:19], s[18:19], s[28:29]
    s_xor_b64 s[20:21], s[20:21], s[28:29]
    s_xor_b64 s[22:23], s[22:23], s[28:29]
    s_or_b64 s[16:17], s[16:17], s[18:19]
    s_or_b64 s[20:21], s[20:21], s[22:23]
    s_or_b64 s[16:17], s[16:17], s[20:21]
    s_cbranch_scc1 L_XE1
    s_setprio 3
    buffer_load_dwordx4 v[16:19], v33, s[44:47], s32 offen sc1
    buffer_load_dwordx4 v[20:23], v33, s[44:47], s33 offen sc1
    buffer_load_dwordx4 v[24:27], v33, s[44:47], s34 offen sc1
    buffer_load_dwordx4 v[28:31], v33, s[44:47], s35 offen sc1
    s_mov_b64 exec, 1
    ds_write_b32 v4, v5 offset:544
    s_mov_b64 exec, -1
    s_setprio 2
    s_mov_b32 s30, 1
L_XE1:
    s_cmp_lg_u32 s30, 0
    s_cbranch_scc1 L_XI2
    ds_read_b32 v34, v6 offset:128
    s_buffer_load_dwordx8 s[16:23], s[44:47], s31
L_XI2:
    s_lshl_b32 s4, s58, 4
    s_lshr_b64 s[6:7], s[66:67], s4
    s_lshl_b32 s6, s6, 16
    v_permlane32_swap_b32 v204, v208
    v_permlane32_swap_b32 v205, v209
    v_permlane32_swap_b32 v206, v210
    v_permlane32_swap_b32 v207, v211
    v_cvt_pk_bf16_f32 v220, v215, v219
    s_mov_b64 exec, 1
    v_add_f32 v204, s6, v204
    v_add_f32_e64 v204, 1.0, v204
    s_mov_b64 exec, -1
    v_permlane32_swap_b32 v212, v216
    v_permlane32_swap_b32 v213, v217
    v_permlane32_swap_b32 v214, v218
    ds_write_b16 v47, v220 offset:9504
    ds_write_b16_d16_hi v47, v220 offset:9520
    ds_write_b16 v47, v220 offset:9662
    ds_write_b16_d16_hi v47, v220 offset:9678
    ds_write_b16 v47, v220 offset:9820
    ds_write_b16_d16_hi v47, v220 offset:9836
    ds_write_b16 v47, v220 offset:9978
    ds_write_b16_d16_hi v47, v220 offset:9994
    v_cvt_pk_bf16_f32 v48, v204, v205
    v_cvt_pk_bf16_f32 v49, v206, v207
    v_cvt_pk_bf16_f32 v50, v205, v206
    v_cvt_pk_bf16_f32 v51, v207, v212
    v_cvt_pk_bf16_f32 v52, v206, v207
    v_cvt_pk_bf16_f32 v53, v212, v213
    v_cvt_pk_bf16_f32 v54, v207, v212
    v_cvt_pk_bf16_f32 v55, v213, v214
    v_cvt_pk_bf16_f32 v56, v208, v208
    v_cvt_pk_bf16_f32 v57, v209, v210
    v_cvt_pk_bf16_f32 v58, v208, v209
    v_cvt_pk_bf16_f32 v59, v210, v210
    v_cvt_pk_bf16_f32 v60, v209, v210
    v_cvt_pk_bf16_f32 v61, v210, v210
    v_cvt_pk_bf16_f32 v62, v210, v210
    v_cvt_pk_bf16_f32 v63, v210, v211
    v_cvt_pk_bf16_f32 v64, v217, v218
    v_mov_b32_e64 v71, s8
    v_cvt_pk_bf16_f32 v80, v234, v204
    v_mov_b32_e64 v81, v50
    v_cvt_pk_bf16_f32 v66, v216, v216
    v_cvt_pk_bf16_f32 v67, v216, v234
    v_cvt_pk_bf16_f32 v68, v234, v218
    v_cvt_pk_bf16_f32 v69, v218, v234
    v_cvt_pk_bf16_f32 v70, v218, v218
    s_cmp_lg_u32 s30, 0
    s_cbranch_scc1 L_XE2
    s_waitcnt lgkmcnt(0)
    v_readfirstlane_b32 s28, v34
    s_add_u32 s31, s31, 64
    s_mov_b32 s29, s28
    s_cmp_eq_u32 s28, 0
    s_cbranch_scc1 L_XE2
    s_xor_b64 s[16:17], s[16:17], s[28:29]
    s_xor_b64 s[18:19], s[18:19], s[28:29]
    s_xor_b64 s[20:21], s[20:21], s[28:29]
    s_xor_b64 s[22:23], s[22:23], s[28:29]
    s_or_b64 s[16:17], s[16:17], s[18:19]
    s_or_b64 s[20:21], s[20:21], s[22:23]
    s_or_b64 s[16:17], s[16:17], s[20:21]
    s_cbranch_scc1 L_XE2
    s_setprio 3
    buffer_load_dwordx4 v[16:19], v33, s[44:47], s32 offen sc1
    buffer_load_dwordx4 v[20:23], v33, s[44:47], s33 offen sc1
    buffer_load_dwordx4 v[24:27], v33, s[44:47], s34 offen sc1
    buffer_load_dwordx4 v[28:31], v33, s[44:47], s35 offen sc1
    s_mov_b64 exec, 1
    ds_write_b32 v4, v5 offset:544
    s_mov_b64 exec, -1
    s_setprio 2
    s_mov_b32 s30, 1
L_XE2:
    s_nop 0
    ds_write_b64 v203, v[48:49] offset:32
    ds_write_b64 v203, v[50:51] offset:2400
    ds_write_b64 v203, v[52:53] offset:4768
    ds_write_b64 v203, v[54:55] offset:7136
    ds_write_b64 v203, v[56:57] offset:544
    ds_write_b64 v203, v[58:59] offset:2912
    ds_write_b64 v203, v[60:61] offset:5280
    ds_write_b64 v203, v[62:63] offset:7648
    ds_write_b16 v46, v64 offset:10784
    ds_write_b16_d16_hi v46, v64 offset:11424
    ds_write_b16 v46, v64 offset:10942
    ds_write_b16_d16_hi v46, v64 offset:11582
    ds_write_b16 v46, v64 offset:11100
    ds_write_b16_d16_hi v46, v64 offset:11740
    ds_write_b16 v46, v64 offset:11258
    ds_write_b16_d16_hi v46, v64 offset:11898
    s_mov_b64 exec, 1
    s_nop 0
    ds_write_b32 v71, v80 offset:2396
    ds_write_b32 v71, v48 offset:4764
    ds_write_b64 v71, v[80:81] offset:7128
    ds_write_b64 v71, v[66:67] offset:1056
    ds_write_b32 v71, v66 offset:3424
    ds_write_b16 v71, v66 offset:5792
    ds_write_b16 v71, v66 offset:8158
    ds_write_b16 v71, v56 offset:5278
    ds_write_b16 v71, v56 offset:7644
    s_brev_b64 exec, 1
    s_nop 0
    ds_write_b32 v71, v68 offset:1124
    ds_write_b32 v71, v69 offset:1128
    ds_write_b32 v71, v70 offset:3492
    ds_write_b64 v71, v[68:69] offset:5856
    ds_write_b32 v71, v70 offset:8224
    s_mov_b64 exec, -1
LW_1:
    ds_read_b32 v34, v6 offset:128
    s_waitcnt lgkmcnt(0)
    v_cmp_eq_u32 vcc, 0, v34
    s_cbranch_vccnz LW_1
    s_cmp_lg_u32 s30, 0
    s_cbranch_scc1 L_XS1
    s_buffer_load_dwordx8 s[16:23], s[44:47], s31
L_XS1:
    v_readfirstlane_b32 s28, v34
    ds_write_b64 v15, v[234:235] offset:4096
    s_mov_b32 s5, 0
    s_mov_b32 s29, s28
    s_nop 0
    ds_read_b64 v[48:49], v1 offset:0
    ds_read_b64 v[50:51], v1 offset:8
    ds_read_b64 v[52:53], v1 offset:64
    ds_read_b64 v[54:55], v1 offset:72
    ds_read_b64 v[56:57], v1 offset:128
    ds_read_b64 v[58:59], v1 offset:136
    ds_read_b64 v[60:61], v1 offset:192
    ds_read_b64 v[62:63], v1 offset:200
    ds_read_b64 v[64:65], v1 offset:256
    ds_read_b64 v[66:67], v1 offset:264
    ds_read_b64 v[68:69], v1 offset:320
    ds_read_b64 v[70:71], v1 offset:328
    ds_read_b64 v[72:73], v1 offset:384
    ds_read_b64 v[74:75], v1 offset:392
    ds_read_b64 v[76:77], v1 offset:448
    ds_read_b64 v[78:79], v1 offset:456
    ds_read_b64 v[80:81], v1 offset:512
    ds_read_b64 v[82:83], v1 offset:520
    ds_read_b64 v[84:85], v1 offset:576
    ds_read_b64 v[86:87], v1 offset:584
    ds_read_b64 v[88:89], v1 offset:640
    ds_read_b64 v[90:91], v1 offset:648
    ds_read_b64 v[92:93], v1 offset:704
    ds_read_b64 v[94:95], v1 offset:712
    ds_read_b64 v[96:97], v1 offset:768
    ds_read_b64 v[98:99], v1 offset:776
    ds_read_b64 v[100:101], v1 offset:832
    ds_read_b64 v[102:103], v1 offset:840
    ds_read_b64 v[104:105], v1 offset:896
    ds_read_b64 v[106:107], v1 offset:904
    s_cmp_lg_u32 s30, 0
    s_cbranch_scc1 L_XA
    s_waitcnt lgkmcnt(0)
    s_xor_b64 s[16:17], s[16:17], s[28:29]
    s_xor_b64 s[18:19], s[18:19], s[28:29]
    s_xor_b64 s[20:21], s[20:21], s[28:29]
    s_xor_b64 s[22:23], s[22:23], s[28:29]
    s_or_b64 s[16:17], s[16:17], s[18:19]
    s_or_b64 s[20:21], s[20:21], s[22:23]
    s_or_b64 s[16:17], s[16:17], s[20:21]
    s_cbranch_scc1 L_XF
    s_setprio 3
    buffer_load_dwordx4 v[16:19], v33, s[44:47], s32 offen sc1
    buffer_load_dwordx4 v[20:23], v33, s[44:47], s33 offen sc1
    buffer_load_dwordx4 v[24:27], v33, s[44:47], s34 offen sc1
    buffer_load_dwordx4 v[28:31], v33, s[44:47], s35 offen sc1
    s_mov_b64 exec, 1
    ds_write_b32 v4, v5 offset:544
    s_mov_b64 exec, -1
    s_setprio 2
L_XA:
    s_nop 0
    ds_read_b64 v[108:109], v1 offset:960
    ds_read_b64 v[110:111], v1 offset:968
    ds_read_b64 v[112:113], v1 offset:1024
    ds_read_b64 v[114:115], v1 offset:1032
    ds_read_b64 v[116:117], v1 offset:1088
    ds_read_b64 v[118:119], v1 offset:1096
    ds_read_b64 v[120:121], v2 offset:10776
    ds_read_b64 v[122:123], v2 offset:11416
    ds_read_b64 v[124:125], v2 offset:12056
    ds_read_b64 v[126:127], v2 offset:12696
    ds_read_b64 v[128:129], v2 offset:10808
    ds_read_b64 v[130:131], v2 offset:11448
    ds_read_b64 v[132:133], v2 offset:12088
    ds_read_b64 v[134:135], v2 offset:12728
    ds_read_b64 v[136:137], v2 offset:10840
    ds_read_b64 v[138:139], v2 offset:11480
    ds_read_b64 v[140:141], v2 offset:12120
    ds_read_b64 v[142:143], v2 offset:12760
L_XBACK:
    s_waitcnt vmcnt(3)
    v_lshlrev_b32 v36, 16, v16
    v_and_b32 v37, 0xffff0000, v16
    v_lshlrev_b32_e64 v38, 16, v17
    v_and_b32 v39, 0xffff0000, v17
    v_lshlrev_b32_e64 v40, 16, v18
    v_and_b32 v41, 0xffff0000, v18
    v_lshlrev_b32_e64 v42, 16, v19
    v_and_b32 v43, 0xffff0000, v19
L_MSW:
    ds_read_b32 v11, v4 offset:528
    ds_read_b64 v[12:13], v10 offset:9216
    s_waitcnt lgkmcnt(0)
    v_cmp_eq_u32 vcc, 0, v11
    s_cbranch_vccnz L_MSW
    v_lshlrev_b32 v44, 16, v13
    v_and_b32 v45, 0xffff0000, v13
    v_rcp_f32 v44, v44
    v_rcp_f32 v45, v45
    v_lshlrev_b32_e64 v46, 16, v12
    v_and_b32 v47, 0xffff0000, v12
    v_pk_mul_f32 v[46:47], v[46:47], v[44:45]
    v_pk_fma_f32 v[36:37], v[36:37], v[44:45], v[46:47] op_sel:[0,0,0] op_sel_hi:[1,0,0] neg_lo:[0,0,1] neg_hi:[0,0,1]
    v_pk_fma_f32 v[40:41], v[40:41], v[44:45], v[46:47] op_sel:[0,1,1] op_sel_hi:[1,1,1] neg_lo:[0,0,1] neg_hi:[0,0,1]
    v_pk_fma_f32 v[38:39], v[38:39], v[44:45], v[46:47] op_sel:[0,0,0] op_sel_hi:[1,0,0] neg_lo:[0,0,1] neg_hi:[0,0,1]
    v_pk_fma_f32 v[42:43], v[42:43], v[44:45], v[46:47] op_sel:[0,1,1] op_sel_hi:[1,1,1] neg_lo:[0,0,1] neg_hi:[0,0,1]
    v_cvt_pk_bf16_f32 v36, v40, v36
    v_cvt_pk_bf16_f32 v37, v41, v37
    v_cvt_pk_bf16_f32 v38, v42, v38
    v_cvt_pk_bf16_f32 v39, v43, v39
    ds_write2st64_b32 v32, v36, v37 offset0:12 offset1:30
    ds_write2st64_b32 v32, v38, v39 offset0:48 offset1:66
    s_mov_b64 exec, 1
    ds_write_b32 v4, v11 offset:0
    s_mov_b64 exec, -1
L_XRW:
    ds_read_b32 v15, v6 offset:0
    ds_read_b128 v[180:183], v7 offset:4032
    ds_read_b128 v[184:187], v7 offset:3968
    ds_read_b128 v[188:191], v7 offset:3904
    ds_read_b128 v[192:195], v7 offset:3840
    ds_read_b128 v[196:199], v7 offset:3776
    ds_read_b128 v[200:203], v7 offset:3712
    s_waitcnt lgkmcnt(6)
    v_cmp_eq_u32 vcc, 0, v15
    s_cbranch_vccnz L_XRW
    v_cmp_ne_u32_e64 vcc, 2, v15
    s_cmp_eq_u32 vcc_lo, 0
    s_cselect_b32 s14, 2, 1
    s_waitcnt lgkmcnt(5)
    v_mfma_f32_16x16x32_bf16 v[204:207], v[76:79], v[180:183], 0
    ds_read_b64 v[12:13], v10 offset:11264
    s_waitcnt vmcnt(2)
    v_mfma_f32_16x16x32_bf16 v[208:211], v[108:111], v[180:183], 0
    v_lshlrev_b32_e64 v36, 16, v20
    s_waitcnt lgkmcnt(5)
    v_mfma_f32_16x16x32_bf16 v[204:207], v[72:75], v[184:187], v[204:207]
    ds_read_b128 v[180:183], v7 offset:3648
    v_and_b32 v37, 0xffff0000, v20
    v_mfma_f32_16x16x32_bf16 v[208:211], v[104:107], v[184:187], v[208:211]
    v_lshlrev_b32 v38, 16, v21
    s_waitcnt lgkmcnt(5)
    v_mfma_f32_16x16x32_bf16 v[204:207], v[68:71], v[188:191], v[204:207]
    ds_read_b128 v[184:187], v7 offset:3584
    v_and_b32 v39, 0xffff0000, v21
    v_mfma_f32_16x16x32_bf16 v[208:211], v[100:103], v[188:191], v[208:211]
    v_lshlrev_b32 v40, 16, v22
    s_waitcnt lgkmcnt(3)
    v_mfma_f32_16x16x32_bf16 v[204:207], v[64:67], v[192:195], v[204:207]
    ds_read_b128 v[188:191], v7 offset:3520
    v_and_b32 v41, 0xffff0000, v22
    v_mfma_f32_16x16x32_bf16 v[208:211], v[96:99], v[192:195], v[208:211]
    v_lshlrev_b32_e64 v42, 16, v23
    v_and_b32 v43, 0xffff0000, v23
    v_mfma_f32_16x16x32_bf16 v[204:207], v[60:63], v[196:199], v[204:207]
    ds_read_b128 v[192:195], v7 offset:3600
    s_waitcnt lgkmcnt(3)
    v_lshlrev_b32 v44, 16, v13
    v_mfma_f32_16x16x32_bf16 v[208:211], v[92:95], v[196:199], v[208:211]
    v_and_b32 v45, 0xffff0000, v13
    v_mfma_f32_16x16x32_bf16 v[204:207], v[56:59], v[200:203], v[204:207]
    ds_read_b128 v[196:199], v7 offset:3456
    v_mfma_f32_16x16x32_bf16 v[208:211], v[88:91], v[200:203], v[208:211]
    v_rcp_f32_e64 v44, v44
    v_mfma_f32_16x16x32_bf16 v[204:207], v[52:55], v[180:183], v[204:207]
    ds_read_b128 v[200:203], v7 offset:3392
    v_mfma_f32_16x16x32_bf16 v[208:211], v[84:87], v[180:183], v[208:211]
    v_rcp_f32 v45, v45
    s_waitcnt lgkmcnt(3)
    v_mfma_f32_16x16x32_bf16 v[204:207], v[48:51], v[184:187], v[204:207]
    ds_read_b128 v[180:183], v7 offset:3328
    v_lshlrev_b32_e64 v46, 16, v12
    v_mfma_f32_16x16x32_bf16 v[208:211], v[80:83], v[184:187], v[208:211]
    v_and_b32 v47, 0xffff0000, v12
    v_mul_f32_e64 v46, v46, v44
    v_mfma_f32_16x16x32_bf16 v[212:215], v[112:115], v[184:187], 0
    v_mul_f32_e64 v47, v47, v45
    v_fma_f32 v36, v36, v44, -v46
    v_fma_f32 v40, v40, v45, -v47
    v_mfma_f32_16x16x32_bf16 v[220:223], v[116:119], v[184:187], 0
    ds_write_b128 v8, v[204:207] offset:0
    v_mfma_f32_16x16x32_bf16 v[152:155], v[184:187], v[240:243], 0
    v_fma_f32 v37, v37, v44, -v46
    v_fma_f32 v41, v41, v45, -v47
    v_mfma_f32_16x16x32_bf16 v[156:159], v[184:187], v[252:255], 0
    v_fma_f32 v38, v38, v44, -v46
    v_fma_f32 v42, v42, v45, -v47
    v_mfma_f32_16x16x32_bf16 v[168:171], v[184:187], v[244:247], 0
    v_fma_f32 v39, v39, v44, -v46
    v_fma_f32 v43, v43, v45, -v47
    v_mfma_f32_16x16x32_bf16 v[208:211], v[76:79], v[188:191], v[208:211]
    ds_read_b128 v[184:187], v7 offset:3264
    v_cvt_pk_bf16_f32 v154, v155, v154
    v_mfma_f32_16x16x32_bf16 v[212:215], v[108:111], v[188:191], v[212:215]
    v_cvt_pk_bf16_f32 v155, v153, v152
    s_waitcnt lgkmcnt(2)
    s_nop 0
    v_mfma_f32_16x16x32_bf16 v[160:163], v[192:195], v[240:243], 0
    v_cvt_pk_bf16_f32 v157, v157, v156
    v_cvt_pk_bf16_f32 v156, v159, v158
    v_mfma_f32_16x16x32_bf16 v[164:167], v[192:195], v[252:255], 0
    ds_read_b128 v[188:191], v7 offset:3200
    v_cvt_pk_bf16_f32 v176, v171, v170
    v_cvt_pk_bf16_f32 v177, v169, v168
    v_mfma_f32_16x16x32_bf16 v[172:175], v[192:195], v[248:251], 0
    v_cvt_pk_bf16_f32 v36, v40, v36
    v_cvt_pk_bf16_f32 v162, v163, v162
    v_mfma_f32_16x16x32_bf16 v[208:211], v[72:75], v[196:199], v[208:211]
    ds_read_b128 v[192:195], v7 offset:3136
    v_cvt_pk_bf16_f32 v163, v161, v160
    v_mfma_f32_16x16x32_bf16 v[212:215], v[104:107], v[196:199], v[212:215]
    v_cvt_pk_bf16_f32 v165, v165, v164
    v_cvt_pk_bf16_f32 v164, v167, v166
    v_mfma_f32_16x16x32_bf16 v[208:211], v[68:71], v[200:203], v[208:211]
    ds_read_b128 v[196:199], v7 offset:3072
    v_cvt_pk_bf16_f32 v178, v175, v174
    v_mfma_f32_16x16x32_bf16 v[212:215], v[100:103], v[200:203], v[212:215]
    v_cvt_pk_bf16_f32 v179, v173, v172
    v_cvt_pk_bf16_f32 v37, v41, v37
    v_mfma_f32_16x16x32_bf16 v[208:211], v[64:67], v[180:183], v[208:211]
    v_cvt_pk_bf16_f32 v38, v42, v38
    v_cvt_pk_bf16_f32 v39, v43, v39
    v_mfma_f32_16x16x32_bf16 v[212:215], v[96:99], v[180:183], v[212:215]
    ds_write2st64_b32 v32, v36, v37 offset0:8 offset1:26
    v_mfma_f32_16x16x32_bf16 v[212:215], v[154:157], v[120:123], v[212:215]
    ds_write2st64_b32 v32, v38, v39 offset0:44 offset1:62
    ds_write_b32 v4, v5 offset:160
    v_mfma_f32_16x16x32_bf16 v[216:219], v[154:157], v[128:131], 0
    ds_read_b64 v[12:13], v10 offset:13312
    s_waitcnt vmcnt(0)
    v_mfma_f32_16x16x32_bf16 v[220:223], v[154:157], v[136:139], v[220:223]
    v_lshlrev_b32_e64 v36, 16, v24
    s_waitcnt lgkmcnt(4)
    v_mfma_f32_16x16x32_bf16 v[208:211], v[60:63], v[184:187], v[208:211]
    v_and_b32 v37, 0xffff0000, v24
    v_lshlrev_b32_e64 v38, 16, v25
    v_mfma_f32_16x16x32_bf16 v[212:215], v[92:95], v[184:187], v[212:215]
    v_and_b32 v39, 0xffff0000, v25
    v_lshlrev_b32_e64 v40, 16, v26
    v_mfma_f32_16x16x32_bf16 v[212:215], v[162:165], v[124:127], v[212:215]
    ds_read_b32 v11, v6 offset:160
    v_and_b32 v41, 0xffff0000, v26
    v_mfma_f32_16x16x32_bf16 v[216:219], v[162:165], v[132:135], v[216:219]
    v_lshlrev_b32_e64 v42, 16, v27
    v_and_b32 v43, 0xffff0000, v27
    v_mfma_f32_16x16x32_bf16 v[220:223], v[162:165], v[140:143], v[220:223]
    s_waitcnt lgkmcnt(1)
    v_lshlrev_b32 v44, 16, v13
    v_mfma_f32_16x16x32_bf16 v[208:211], v[56:59], v[188:191], v[208:211]
    v_and_b32 v45, 0xffff0000, v13
    v_rcp_f32_e64 v44, v44
    v_mfma_f32_16x16x32_bf16 v[212:215], v[88:91], v[188:191], v[212:215]
    v_rcp_f32_e64 v45, v45
    v_mfma_f32_16x16x32_bf16 v[208:211], v[52:55], v[192:195], v[208:211]
    v_lshlrev_b32_e64 v46, 16, v12
    v_and_b32 v47, 0xffff0000, v12
    v_mfma_f32_16x16x32_bf16 v[212:215], v[84:87], v[192:195], v[212:215]
    s_waitcnt lgkmcnt(0)
    v_cmp_eq_u32 vcc, 0, v11
    v_mfma_f32_16x16x32_bf16 v[208:211], v[48:51], v[196:199], v[208:211]
    s_cbranch_vccnz L_SLOW3
L_BACK3:
    s_nop 0
    ds_read_b128 v[200:203], v7 offset:3008
    v_mfma_f32_16x16x32_bf16 v[212:215], v[80:83], v[196:199], v[212:215]
    ds_read_b128 v[180:183], v7 offset:3088
    ds_read_b128 v[184:187], v7 offset:2944
    v_mfma_f32_16x16x32_bf16 v[216:219], v[112:115], v[196:199], v[216:219]
    ds_read_b128 v[188:191], v7 offset:2880
    ds_read_b128 v[192:195], v7 offset:2816
    v_mfma_f32_16x16x32_bf16 v[224:227], v[116:119], v[196:199], 0
    ds_write_b128 v8, v[208:211] offset:1024
    v_mfma_f32_16x16x32_bf16 v[152:155], v[196:199], v[240:243], 0
    v_mul_f32 v46, v46, v44
    v_mul_f32 v47, v47, v45
    v_fma_f32 v36, v36, v44, -v46
    v_mfma_f32_16x16x32_bf16 v[156:159], v[196:199], v[252:255], 0
    v_fma_f32 v40, v40, v45, -v47
    v_fma_f32 v37, v37, v44, -v46
    v_mfma_f32_16x16x32_bf16 v[168:171], v[196:199], v[244:247], 0
    v_fma_f32 v41, v41, v45, -v47
    s_waitcnt lgkmcnt(5)
    s_nop 0
    v_mfma_f32_16x16x32_bf16 v[212:215], v[76:79], v[200:203], v[212:215]
    ds_read_b128 v[196:199], v7 offset:2752
    v_cvt_pk_bf16_f32 v154, v155, v154
    v_mfma_f32_16x16x32_bf16 v[216:219], v[108:111], v[200:203], v[216:219]
    v_cvt_pk_bf16_f32 v155, v153, v152
    s_waitcnt lgkmcnt(2)
    s_nop 0
    v_mfma_f32_16x16x32_bf16 v[160:163], v[180:183], v[240:243], 0
    ds_read_b128 v[200:203], v7 offset:2688
    v_cvt_pk_bf16_f32 v157, v157, v156
    v_mfma_f32_16x16x32_bf16 v[164:167], v[180:183], v[252:255], 0
    v_cvt_pk_bf16_f32 v156, v159, v158
    v_cvt_pk_bf16_f32 v144, v171, v170
    v_mfma_f32_16x16x32_bf16 v[172:175], v[180:183], v[248:251], 0
    v_cvt_pk_bf16_f32 v145, v169, v168
    v_fma_f32 v38, v38, v44, -v46
    v_mfma_f32_16x16x32_bf16 v[212:215], v[72:75], v[184:187], v[212:215]
    ds_read_b128 v[180:183], v7 offset:2624
    v_cvt_pk_bf16_f32 v162, v163, v162
    v_cvt_pk_bf16_f32 v163, v161, v160
    v_mfma_f32_16x16x32_bf16 v[216:219], v[104:107], v[184:187], v[216:219]
    v_cvt_pk_bf16_f32 v165, v165, v164
    v_cvt_pk_bf16_f32 v164, v167, v166
    v_mfma_f32_16x16x32_bf16 v[212:215], v[68:71], v[188:191], v[212:215]
    ds_read_b128 v[184:187], v7 offset:2560
    v_cvt_pk_bf16_f32 v146, v175, v174
    v_mfma_f32_16x16x32_bf16 v[216:219], v[100:103], v[188:191], v[216:219]
    v_cvt_pk_bf16_f32 v147, v173, v172
    v_fma_f32 v42, v42, v45, -v47
    v_mfma_f32_16x16x32_bf16 v[212:215], v[64:67], v[192:195], v[212:215]
    v_fma_f32 v39, v39, v44, -v46
    v_fma_f32 v43, v43, v45, -v47
    v_mfma_f32_16x16x32_bf16 v[216:219], v[96:99], v[192:195], v[216:219]
    v_cvt_pk_bf16_f32 v36, v40, v36
    s_waitcnt lgkmcnt(2)
    s_nop 0
    v_mfma_f32_16x16x32_bf16 v[212:215], v[60:63], v[196:199], v[212:215]
    v_cvt_pk_bf16_f32 v37, v41, v37
    v_cvt_pk_bf16_f32 v38, v42, v38
    v_mfma_f32_16x16x32_bf16 v[216:219], v[92:95], v[196:199], v[216:219]
    v_cvt_pk_bf16_f32 v39, v43, v39
    ds_read_b128 v[188:191], v7 offset:2496
    v_mfma_f32_16x16x32_bf16 v[216:219], v[154:157], v[120:123], v[216:219]
    ds_write2st64_b32 v32, v36, v37 offset0:4 offset1:22
    ds_read_b128 v[192:195], v7 offset:2576
    v_mfma_f32_16x16x32_bf16 v[220:223], v[154:157], v[128:131], v[220:223]
    ds_write2st64_b32 v32, v38, v39 offset0:40 offset1:58
    v_mfma_f32_16x16x32_bf16 v[224:227], v[154:157], v[136:139], v[224:227]
    ds_write_b32 v4, v5 offset:144
    ds_read_b64 v[12:13], v10 offset:15360
    v_mfma_f32_16x16x32_bf16 v[212:215], v[56:59], v[200:203], v[212:215]
    v_lshlrev_b32_e64 v36, 16, v28
    v_and_b32 v37, 0xffff0000, v28
    v_mfma_f32_16x16x32_bf16 v[216:219], v[88:91], v[200:203], v[216:219]
    v_lshlrev_b32_e64 v38, 16, v29
    v_and_b32 v39, 0xffff0000, v29
    v_mfma_f32_16x16x32_bf16 v[216:219], v[162:165], v[124:127], v[216:219]
    v_lshlrev_b32_e64 v40, 16, v30
    v_and_b32 v41, 0xffff0000, v30
    v_mfma_f32_16x16x32_bf16 v[220:223], v[162:165], v[132:135], v[220:223]
    ds_read_b32 v11, v6 offset:144
    ds_read_b128 v[196:199], v7 offset:2432
    v_mfma_f32_16x16x32_bf16 v[224:227], v[162:165], v[140:143], v[224:227]
    v_lshlrev_b32 v42, 16, v31
    s_waitcnt lgkmcnt(4)
    v_mfma_f32_16x16x32_bf16 v[212:215], v[52:55], v[180:183], v[212:215]
    ds_read_b128 v[200:203], v7 offset:2368
    v_and_b32 v43, 0xffff0000, v31
    s_waitcnt lgkmcnt(3)
    v_mfma_f32_16x16x32_bf16 v[216:219], v[84:87], v[180:183], v[216:219]
    v_lshlrev_b32 v44, 16, v13
    v_and_b32 v45, 0xffff0000, v13
    v_mfma_f32_16x16x32_bf16 v[212:215], v[48:51], v[184:187], v[212:215]
    ds_read_b128 v[180:183], v7 offset:2304
    v_mfma_f32_16x16x32_bf16 v[216:219], v[80:83], v[184:187], v[216:219]
    v_rcp_f32_e64 v44, v44
    v_mfma_f32_16x16x32_bf16 v[220:223], v[112:115], v[184:187], v[220:223]
    s_waitcnt lgkmcnt(2)
    v_cmp_eq_u32 vcc, 0, v11
    v_mfma_f32_16x16x32_bf16 v[228:231], v[116:119], v[184:187], 0
    s_cbranch_vccnz L_SLOW0
L_BACK0:
    s_nop 0
    ds_read_b64 v[204:205], v9 offset:0
    v_mfma_f32_16x16x32_bf16 v[152:155], v[184:187], v[240:243], 0
    ds_read_b64 v[206:207], v9 offset:8192
    ds_read_b64 v[208:209], v9 offset:16384
    v_mfma_f32_16x16x32_bf16 v[156:159], v[184:187], v[252:255], 0
    ds_read_b64 v[210:211], v9 offset:24576
    v_mfma_f32_16x16x32_bf16 v[168:171], v[184:187], v[244:247], 0
    ds_write_b128 v8, v[212:215] offset:2048
    v_mfma_f32_16x16x32_bf16 v[216:219], v[76:79], v[188:191], v[216:219]
    ds_read_b128 v[184:187], v7 offset:2240
    v_cvt_pk_bf16_f32 v154, v155, v154
    v_mfma_f32_16x16x32_bf16 v[220:223], v[108:111], v[188:191], v[220:223]
    v_cvt_pk_bf16_f32 v155, v153, v152
    v_cvt_pk_bf16_f32 v157, v157, v156
    v_mfma_f32_16x16x32_bf16 v[160:163], v[192:195], v[240:243], 0
    ds_read_b128 v[188:191], v7 offset:2176
    v_cvt_pk_bf16_f32 v156, v159, v158
    v_mfma_f32_16x16x32_bf16 v[164:167], v[192:195], v[252:255], 0
    v_cvt_pk_bf16_f32 v148, v171, v170
    v_cvt_pk_bf16_f32 v149, v169, v168
    v_mfma_f32_16x16x32_bf16 v[172:175], v[192:195], v[248:251], 0
    v_rcp_f32_e64 v45, v45
    v_mfma_f32_16x16x32_bf16 v[216:219], v[72:75], v[196:199], v[216:219]
    ds_read_b128 v[192:195], v7 offset:2112
    v_cvt_pk_bf16_f32 v162, v163, v162
    v_mfma_f32_16x16x32_bf16 v[220:223], v[104:107], v[196:199], v[220:223]
    v_cvt_pk_bf16_f32 v163, v161, v160
    s_waitcnt lgkmcnt(2)
    s_nop 0
    v_mfma_f32_16x16x32_bf16 v[216:219], v[68:71], v[200:203], v[216:219]
    ds_read_b128 v[196:199], v7 offset:2048
    v_cvt_pk_bf16_f32 v165, v165, v164
    v_cvt_pk_bf16_f32 v164, v167, v166
    v_mfma_f32_16x16x32_bf16 v[220:223], v[100:103], v[200:203], v[220:223]
    v_cvt_pk_bf16_f32 v150, v175, v174
    v_cvt_pk_bf16_f32 v151, v173, v172
    v_mfma_f32_16x16x32_bf16 v[216:219], v[64:67], v[180:183], v[216:219]
    v_lshlrev_b32_e64 v46, 16, v12
    v_and_b32 v47, 0xffff0000, v12
    v_mfma_f32_16x16x32_bf16 v[220:223], v[96:99], v[180:183], v[220:223]
    v_mul_f32 v46, v46, v44
    v_mul_f32 v47, v47, v45
    v_mfma_f32_16x16x32_bf16 v[216:219], v[60:63], v[184:187], v[216:219]
    v_fma_f32 v36, v36, v44, -v46
    v_fma_f32 v40, v40, v45, -v47
    v_mfma_f32_16x16x32_bf16 v[220:223], v[92:95], v[184:187], v[220:223]
    v_fma_f32 v37, v37, v44, -v46
    v_fma_f32 v41, v41, v45, -v47
    v_mfma_f32_16x16x32_bf16 v[220:223], v[154:157], v[120:123], v[220:223]
    v_fma_f32 v38, v38, v44, -v46
    v_fma_f32 v42, v42, v45, -v47
    v_mfma_f32_16x16x32_bf16 v[224:227], v[154:157], v[128:131], v[224:227]
    ds_read_b128 v[200:203], v7 offset:1984
    v_fma_f32 v39, v39, v44, -v46
    v_mfma_f32_16x16x32_bf16 v[228:231], v[154:157], v[136:139], v[228:231]
    v_fma_f32 v43, v43, v45, -v47
    v_cvt_pk_bf16_f32 v36, v40, v36
    s_waitcnt lgkmcnt(1)
    s_nop 0
    v_mfma_f32_16x16x32_bf16 v[216:219], v[56:59], v[188:191], v[216:219]
    ds_read_b128 v[180:183], v7 offset:2064
    v_cvt_pk_bf16_f32 v37, v41, v37
    v_mfma_f32_16x16x32_bf16 v[220:223], v[88:91], v[188:191], v[220:223]
    v_cvt_pk_bf16_f32 v38, v42, v38
    v_cvt_pk_bf16_f32 v39, v43, v39
    v_mfma_f32_16x16x32_bf16 v[220:223], v[162:165], v[124:127], v[220:223]
    ds_write2st64_b32 v32, v36, v37 offset0:0 offset1:18
    v_mfma_f32_16x16x32_bf16 v[224:227], v[162:165], v[132:135], v[224:227]
    ds_read_b128 v[184:187], v7 offset:1920
    ds_read_b64 v[188:189], v2 offset:9496
    ds_read_b64 v[190:191], v2 offset:10136
    v_mfma_f32_16x16x32_bf16 v[228:231], v[162:165], v[140:143], v[228:231]
    ds_write2st64_b32 v32, v38, v39 offset0:36 offset1:54
    v_mfma_f32_16x16x32_bf16 v[216:219], v[52:55], v[192:195], v[216:219]
    v_lshlrev_b32_e64 v36, 16, v16
    v_and_b32 v37, 0xffff0000, v16
    v_mfma_f32_16x16x32_bf16 v[220:223], v[84:87], v[192:195], v[220:223]
    v_lshlrev_b32_e64 v38, 16, v17
    v_and_b32 v39, 0xffff0000, v17
    v_mfma_f32_16x16x32_bf16 v[216:219], v[48:51], v[196:199], v[216:219]
    ds_read_b128 v[192:195], v7 offset:1856
    v_lshlrev_b32_e64 v40, 16, v18
    v_and_b32 v41, 0xffff0000, v18
    v_mfma_f32_16x16x32_bf16 v[220:223], v[80:83], v[196:199], v[220:223]
    v_lshlrev_b32_e64 v42, 16, v19
    v_and_b32 v43, 0xffff0000, v19
    v_mfma_f32_16x16x32_bf16 v[224:227], v[112:115], v[196:199], v[224:227]
    v_add_f32 v36, v204, v36
    v_add_f32 v37, v206, v37
    v_mfma_f32_16x16x32_bf16 v[232:235], v[116:119], v[196:199], 0
    ds_write_b128 v8, v[216:219] offset:3072
    v_mfma_f32_16x16x32_bf16 v[152:155], v[196:199], v[240:243], 0
    ds_write_b32 v4, v5 offset:16
    ds_read_b128 v[116:119], v7 offset:1792
    v_mfma_f32_16x16x32_bf16 v[156:159], v[196:199], v[252:255], 0
    v_add_f32 v38, v208, v38
    v_add_f32 v39, v210, v39
    v_mfma_f32_16x16x32_bf16 v[168:171], v[196:199], v[244:247], 0
    v_add_f32 v40, v205, v40
    s_waitcnt lgkmcnt(3)
    v_mfma_f32_16x16x32_bf16 v[220:223], v[76:79], v[200:203], v[220:223]
    ds_read_b128 v[196:199], v7 offset:1728
    v_cvt_pk_bf16_f32 v154, v155, v154
    v_mfma_f32_16x16x32_bf16 v[224:227], v[108:111], v[200:203], v[224:227]
    ds_read_b32 v11, v6 offset:16
    v_cvt_pk_bf16_f32 v155, v153, v152
    v_cvt_pk_bf16_f32 v157, v157, v156
    v_mfma_f32_16x16x32_bf16 v[160:163], v[180:183], v[240:243], 0
    ds_read_b128 v[200:203], v7 offset:1664
    v_cvt_pk_bf16_f32 v156, v159, v158
    v_mfma_f32_16x16x32_bf16 v[164:167], v[180:183], v[252:255], 0
    v_cvt_pk_bf16_f32 v244, v171, v170
    v_cvt_pk_bf16_f32 v245, v169, v168
    v_mfma_f32_16x16x32_bf16 v[172:175], v[180:183], v[248:251], 0
    v_add_f32 v41, v207, v41
    v_add_f32 v42, v209, v42
    v_mfma_f32_16x16x32_bf16 v[220:223], v[72:75], v[184:187], v[220:223]
    v_cvt_pk_bf16_f32 v162, v163, v162
    v_cvt_pk_bf16_f32 v163, v161, v160
    v_mfma_f32_16x16x32_bf16 v[224:227], v[104:107], v[184:187], v[224:227]
    v_cvt_pk_bf16_f32 v165, v165, v164
    v_cvt_pk_bf16_f32 v164, v167, v166
    v_mfma_f32_16x16x32_bf16 v[220:223], v[176:179], v[188:191], v[220:223]
    s_waitcnt lgkmcnt(1)
    v_cmp_eq_u32 vcc, 0, v11
    v_mfma_f32_16x16x32_bf16 v[224:227], v[144:147], v[188:191], v[224:227]
    s_cbranch_vccnz L_SLOW1
L_BACK1:
    s_nop 0
    ds_read_b64 v[212:213], v9 offset:2048
    v_mfma_f32_16x16x32_bf16 v[220:223], v[68:71], v[192:195], v[220:223]
    ds_read_b64 v[214:215], v9 offset:10240
    ds_read_b64 v[216:217], v9 offset:18432
    ds_read_b64 v[218:219], v9 offset:26624
    v_mfma_f32_16x16x32_bf16 v[224:227], v[100:103], v[192:195], v[224:227]
    ds_read_b32 v11, v6 offset:112
    ds_read_b128 v[180:183], v7 offset:1600
    v_mfma_f32_16x16x32_bf16 v[220:223], v[64:67], v[116:119], v[220:223]
    ds_read_b128 v[184:187], v7 offset:1536
    v_cvt_pk_bf16_f32 v246, v175, v174
    v_mfma_f32_16x16x32_bf16 v[224:227], v[96:99], v[116:119], v[224:227]
    ds_read_b128 v[192:195], v7 offset:1472
    v_cvt_pk_bf16_f32 v247, v173, v172
    v_mfma_f32_16x16x32_bf16 v[220:223], v[60:63], v[196:199], v[220:223]
    v_add_f32_e64 v43, v211, v43
    v_cvt_pk_bf16_f32 v204, v36, v37
    v_mfma_f32_16x16x32_bf16 v[224:227], v[92:95], v[196:199], v[224:227]
    ds_read_b64 v[116:117], v2 offset:9528
    ds_read_b64 v[118:119], v2 offset:10168
    v_mfma_f32_16x16x32_bf16 v[224:227], v[154:157], v[120:123], v[224:227]
    ds_read_b128 v[196:199], v7 offset:1408
    v_cvt_pk_bf16_f32 v205, v38, v39
    v_mfma_f32_16x16x32_bf16 v[228:231], v[154:157], v[128:131], v[228:231]
    s_waitcnt lgkmcnt(5)
    v_cmp_eq_u32 vcc, 0, v11
    v_mfma_f32_16x16x32_bf16 v[232:235], v[154:157], v[136:139], v[232:235]
    s_cbranch_vccnz L_SLOW4
L_BACK4:
    s_nop 0
    v_cvt_pk_bf16_f32 v206, v40, v41
    v_cvt_pk_bf16_f32 v207, v42, v43
    v_mfma_f32_16x16x32_bf16 v[220:223], v[56:59], v[200:203], v[220:223]
    ds_read_b128 v[136:139], v7 offset:1344
    ds_read_u8 v174, v239 offset:1152
    v_mfma_f32_16x16x32_bf16 v[224:227], v[88:91], v[200:203], v[224:227]
    buffer_store_dwordx4 v[204:207], v33, s[44:47], s32 offen
    v_mfma_f32_16x16x32_bf16 v[224:227], v[162:165], v[124:127], v[224:227]
    ds_read_b128 v[200:203], v7 offset:1280
    v_mov_b32_e64 v208, -1
    v_mfma_f32_16x16x32_bf16 v[228:231], v[162:165], v[132:135], v[228:231]
    v_mov_b32 v209, -1
    v_mov_b32 v210, -1
    v_mfma_f32_16x16x32_bf16 v[232:235], v[162:165], v[140:143], v[232:235]
    v_mov_b32 v211, -1
    v_lshlrev_b32 v36, 16, v20
    v_mfma_f32_16x16x32_bf16 v[220:223], v[52:55], v[180:183], v[220:223]
    ds_read_b128 v[140:143], v7 offset:1216
    v_and_b32 v37, 0xffff0000, v20
    v_mfma_f32_16x16x32_bf16 v[224:227], v[84:87], v[180:183], v[224:227]
    buffer_store_dwordx4 v[208:211], v33, s[44:47], s34 offen
    s_waitcnt lgkmcnt(2)
    v_mfma_f32_16x16x32_bf16 v[220:223], v[48:51], v[184:187], v[220:223]
    ds_read_b128 v[180:183], v7 offset:1536
    v_lshlrev_b32 v38, 16, v21
    v_mfma_f32_16x16x32_bf16 v[224:227], v[80:83], v[184:187], v[224:227]
    buffer_store_dwordx4 v[208:211], v33, s[44:47], s35 offen
    v_mfma_f32_16x16x32_bf16 v[228:231], v[112:115], v[184:187], v[228:231]
    ds_read_b128 v[168:171], v7 offset:1152
    v_and_b32 v39, 0xffff0000, v21
    v_mfma_f32_16x16x32_bf16 v[224:227], v[76:79], v[192:195], v[224:227]
    ds_write_b128 v8, v[220:223] offset:4096
    v_mfma_f32_16x16x32_bf16 v[228:231], v[108:111], v[192:195], v[228:231]
    ds_read_b128 v[184:187], v7 offset:1552
    v_lshlrev_b32_e64 v40, 16, v22
    v_mfma_f32_16x16x32_bf16 v[224:227], v[176:179], v[116:119], v[224:227]
    ds_read_b128 v[192:195], v7 offset:1088
    v_and_b32 v41, 0xffff0000, v22
    v_mfma_f32_16x16x32_bf16 v[224:227], v[72:75], v[196:199], v[224:227]
    v_lshlrev_b32_e64 v42, 16, v23
    v_and_b32 v43, 0xffff0000, v23
    v_mfma_f32_16x16x32_bf16 v[228:231], v[104:107], v[196:199], v[228:231]
    v_add_f32 v36, v212, v36
    v_add_f32 v37, v214, v37
    v_mfma_f32_16x16x32_bf16 v[224:227], v[68:71], v[136:139], v[224:227]
    ds_read_b128 v[196:199], v7 offset:1024
    v_add_f32_e64 v38, v216, v38
    v_mfma_f32_16x16x32_bf16 v[228:231], v[100:103], v[136:139], v[228:231]
    v_add_f32 v39, v218, v39
    s_waitcnt lgkmcnt(3)
    v_mfma_f32_16x16x32_bf16 v[224:227], v[64:67], v[200:203], v[224:227]
    ds_read_b128 v[136:139], v7 offset:960
    v_add_f32_e64 v40, v213, v40
    v_mfma_f32_16x16x32_bf16 v[228:231], v[96:99], v[200:203], v[228:231]
    v_add_f32 v41, v215, v41
    v_add_f32 v42, v217, v42
    v_mfma_f32_16x16x32_bf16 v[224:227], v[60:63], v[140:143], v[224:227]
    ds_read_b128 v[200:203], v7 offset:896
    v_add_f32_e64 v43, v219, v43
    v_mfma_f32_16x16x32_bf16 v[228:231], v[92:95], v[140:143], v[228:231]
    v_cvt_pk_bf16_f32 v212, v36, v37
    v_cvt_pk_bf16_f32 v213, v38, v39
    v_mfma_f32_16x16x32_bf16 v[152:155], v[180:183], v[240:243], 0
    v_cvt_pk_bf16_f32 v214, v40, v41
    v_cvt_pk_bf16_f32 v215, v42, v43
    v_mfma_f32_16x16x32_bf16 v[156:159], v[180:183], v[252:255], 0
    ds_read_b128 v[140:143], v7 offset:832
    ds_read_u8 v239, v239 offset:1184
    v_mfma_f32_16x16x32_bf16 v[224:227], v[56:59], v[168:171], v[224:227]
    buffer_store_dwordx4 v[212:215], v33, s[44:47], s33 offen
    v_mfma_f32_16x16x32_bf16 v[228:231], v[88:91], v[168:171], v[228:231]
    ds_read_b128 v[180:183], v7 offset:768
    s_waitcnt lgkmcnt(4)
    s_nop 0
    v_mfma_f32_16x16x32_bf16 v[160:163], v[184:187], v[240:243], 0
    v_cvt_pk_bf16_f32 v154, v155, v154
    v_cvt_pk_bf16_f32 v155, v153, v152
    v_mfma_f32_16x16x32_bf16 v[164:167], v[184:187], v[252:255], 0
    ds_read_b128 v[168:171], v7 offset:704
    v_cvt_pk_bf16_f32 v157, v157, v156
    v_mfma_f32_16x16x32_bf16 v[224:227], v[52:55], v[192:195], v[224:227]
    v_cvt_pk_bf16_f32 v156, v159, v158
    v_lshlrev_b32_e64 v36, 16, v24
    v_mfma_f32_16x16x32_bf16 v[228:231], v[84:87], v[192:195], v[228:231]
    v_cvt_pk_bf16_f32 v162, v163, v162
    v_cvt_pk_bf16_f32 v163, v161, v160
    v_mfma_f32_16x16x32_bf16 v[224:227], v[48:51], v[196:199], v[224:227]
    v_cvt_pk_bf16_f32 v165, v165, v164
    v_cvt_pk_bf16_f32 v164, v167, v166
    v_mfma_f32_16x16x32_bf16 v[228:231], v[80:83], v[196:199], v[228:231]
    ds_read_b128 v[184:187], v7 offset:640
    v_and_b32 v37, 0xffff0000, v24
    v_mfma_f32_16x16x32_bf16 v[232:235], v[112:115], v[196:199], v[232:235]
    v_lshlrev_b32_e64 v38, 16, v25
    v_and_b32 v39, 0xffff0000, v25
    v_mfma_f32_16x16x32_bf16 v[228:231], v[76:79], v[136:139], v[228:231]
    ds_write_b128 v8, v[224:227] offset:5120
    v_mfma_f32_16x16x32_bf16 v[232:235], v[108:111], v[136:139], v[232:235]
    ds_write_b32 v4, v5 offset:32
    s_waitcnt lgkmcnt(3)
    v_mfma_f32_16x16x32_bf16 v[228:231], v[72:75], v[200:203], v[228:231]
    ds_read_b128 v[112:115], v7 offset:576
    v_lshlrev_b32 v40, 16, v26
    v_mfma_f32_16x16x32_bf16 v[232:235], v[104:107], v[200:203], v[232:235]
    v_and_b32 v41, 0xffff0000, v26
    v_lshlrev_b32_e64 v42, 16, v27
    v_mfma_f32_16x16x32_bf16 v[228:231], v[148:151], v[188:191], v[228:231]
    v_lshl_or_b32 v239, v239, 24, v238
    v_lshl_or_b32 v238, v174, 24, v238
    v_mfma_f32_16x16x32_bf16 v[232:235], v[244:247], v[188:191], v[232:235]
    ds_read_b32 v11, v6 offset:32
    v_lshlrev_b32_e64 v174, 2, v0
    v_mfma_f32_16x16x32_bf16 v[228:231], v[68:71], v[140:143], v[228:231]
    ds_read_b64 v[108:109], v2 offset:9560
    ds_read_b64 v[110:111], v2 offset:10200
    v_mfma_f32_16x16x32_bf16 v[232:235], v[100:103], v[140:143], v[232:235]
    v_mov_b32_e64 v172, v34
    v_and_b32 v43, 0xffff0000, v27
    v_mfma_f32_16x16x32_bf16 v[228:231], v[64:67], v[180:183], v[228:231]
    ds_read_b128 v[104:107], v7 offset:512
    ds_read_b128 v[100:103], v7 offset:1024
    v_mfma_f32_16x16x32_bf16 v[232:235], v[96:99], v[180:183], v[232:235]
    ds_read_b128 v[188:191], v7 offset:448
    ds_read_b128 v[192:195], v7 offset:1040
    v_mfma_f32_16x16x32_bf16 v[228:231], v[60:63], v[168:171], v[228:231]
    ds_read_b128 v[96:99], v7 offset:384
    ds_read_b128 v[196:199], v7 offset:320
    v_mfma_f32_16x16x32_bf16 v[232:235], v[92:95], v[168:171], v[232:235]
    s_waitcnt lgkmcnt(8)
    v_cmp_eq_u32 vcc, 0, v11
    v_mfma_f32_16x16x32_bf16 v[228:231], v[144:147], v[116:119], v[228:231]
    s_cbranch_vccnz L_SLOW2
L_BACK2:
    s_nop 0
    ds_read_b64 v[220:221], v9 offset:4096
    v_mfma_f32_16x16x32_bf16 v[232:235], v[148:151], v[116:119], v[232:235]
    ds_read_b64 v[222:223], v9 offset:12288
    ds_read_b64 v[224:225], v9 offset:20480
    v_mfma_f32_16x16x32_bf16 v[228:231], v[56:59], v[184:187], v[228:231]
    ds_read_b64 v[226:227], v9 offset:28672
    ds_read_b64 v[92:93], v2 offset:9592
    ds_read_b64 v[94:95], v2 offset:10232
    v_mfma_f32_16x16x32_bf16 v[232:235], v[88:91], v[184:187], v[232:235]
    ds_read_b128 v[116:119], v7 offset:256
    ds_read_b128 v[136:139], v7 offset:192
    v_mfma_f32_16x16x32_bf16 v[228:231], v[154:157], v[120:123], v[228:231]
    ds_read_b128 v[88:91], v7 offset:128
    ds_read_b128 v[200:203], v7 offset:64
    v_mfma_f32_16x16x32_bf16 v[232:235], v[154:157], v[128:131], v[232:235]
    ds_read_b128 v[140:143], v7 offset:0
    v_mfma_f32_16x16x32_bf16 v[228:231], v[52:55], v[112:115], v[228:231]
    v_mfma_f32_16x16x32_bf16 v[232:235], v[84:87], v[112:115], v[232:235]
    v_mfma_f32_16x16x32_bf16 v[228:231], v[162:165], v[124:127], v[228:231]
    s_waitcnt lgkmcnt(5)
    v_add_f32 v36, v220, v36
    v_mfma_f32_16x16x32_bf16 v[232:235], v[162:165], v[132:135], v[232:235]
    s_waitcnt vmcnt(0)
    v_add_f32 v37, v222, v37
    v_mfma_f32_16x16x32_bf16 v[228:231], v[176:179], v[108:111], v[228:231]
    s_mov_b64 exec, 1
    buffer_store_dword v34, off, s[44:47], s12 offset:0
    s_mov_b64 exec, -1
    v_mfma_f32_16x16x32_bf16 v[232:235], v[144:147], v[108:111], v[232:235]
    v_add_f32 v38, v224, v38
    v_add_f32 v39, v226, v39
    v_mfma_f32_16x16x32_bf16 v[228:231], v[48:51], v[104:107], v[228:231]
    v_add_f32 v40, v221, v40
    v_add_f32 v41, v223, v41
    v_mfma_f32_16x16x32_bf16 v[232:235], v[80:83], v[104:107], v[232:235]
    v_add_f32 v42, v225, v42
    v_add_f32 v43, v227, v43
    v_mfma_f32_16x16x32_bf16 v[152:155], v[100:103], v[240:243], 0
    v_cvt_pk_bf16_f32 v220, v36, v37
    v_cvt_pk_bf16_f32 v221, v38, v39
    v_mfma_f32_16x16x32_bf16 v[156:159], v[100:103], v[252:255], 0
    ds_write_b128 v8, v[228:231] offset:6144
    v_mfma_f32_16x16x32_bf16 v[232:235], v[76:79], v[188:191], v[232:235]
    v_cvt_pk_bf16_f32 v222, v40, v41
    v_cvt_pk_bf16_f32 v223, v42, v43
    v_mfma_f32_16x16x32_bf16 v[160:163], v[192:195], v[240:243], 0
    v_cvt_pk_bf16_f32 v154, v155, v154
    v_cvt_pk_bf16_f32 v155, v153, v152
    v_mfma_f32_16x16x32_bf16 v[164:167], v[192:195], v[252:255], 0
    v_cvt_pk_bf16_f32 v157, v157, v156
    v_cvt_pk_bf16_f32 v156, v159, v158
    v_mfma_f32_16x16x32_bf16 v[232:235], v[72:75], v[96:99], v[232:235]
    buffer_store_dwordx4 v[220:223], v33, s[44:47], s34 offen
    v_mfma_f32_16x16x32_bf16 v[232:235], v[68:71], v[196:199], v[232:235]
    v_cvt_pk_bf16_f32 v162, v163, v162
    v_cvt_pk_bf16_f32 v163, v161, v160
    v_mfma_f32_16x16x32_bf16 v[232:235], v[176:179], v[92:95], v[232:235]
    v_cvt_pk_bf16_f32 v165, v165, v164
    s_waitcnt lgkmcnt(0)
    v_mfma_f32_16x16x32_bf16 v[232:235], v[64:67], v[116:119], v[232:235]
    v_cvt_pk_bf16_f32 v164, v167, v166
    v_mfma_f32_16x16x32_bf16 v[232:235], v[60:63], v[136:139], v[232:235]
    v_mfma_f32_16x16x32_bf16 v[232:235], v[56:59], v[88:91], v[232:235]
    s_mov_b32 exec_hi, 0
    buffer_load_dword v172, v174, s[44:47], s42 offen sc1
    s_mov_b32 exec_hi, -1
    v_mfma_f32_16x16x32_bf16 v[232:235], v[154:157], v[120:123], v[232:235]
    v_mfma_f32_16x16x32_bf16 v[232:235], v[52:55], v[200:203], v[232:235]
    v_mfma_f32_16x16x32_bf16 v[232:235], v[162:165], v[124:127], v[232:235]
    v_mfma_f32_16x16x32_bf16 v[232:235], v[48:51], v[140:143], v[232:235]
    v_lshlrev_b32 v36, 16, v28
    v_and_b32 v37, 0xffff0000, v28
    v_lshlrev_b32_e64 v38, 16, v29
    v_and_b32 v39, 0xffff0000, v29
    v_lshlrev_b32_e64 v40, 16, v30
    v_and_b32 v41, 0xffff0000, v30
    v_lshlrev_b32_e64 v42, 16, v31
    v_and_b32 v43, 0xffff0000, v31
    ds_write_b128 v8, v[232:235] offset:7168
    ds_write_b32 v4, v5 offset:48
L_Y3W:
    ds_read_b32 v14, v6 offset:48
    ds_read_b64 v[228:229], v9 offset:6144
    ds_read_b64 v[230:231], v9 offset:14336
    ds_read_b64 v[232:233], v9 offset:22528
    ds_read_b64 v[234:235], v9 offset:30720
    s_waitcnt lgkmcnt(4)
    v_cmp_eq_u32 vcc, 0, v14
    s_cbranch_vccnz L_Y3W
    s_waitcnt lgkmcnt(0)
    v_add_f32 v36, v228, v36
    v_add_f32 v37, v230, v37
    v_add_f32 v38, v232, v38
    v_add_f32 v39, v234, v39
    v_add_f32 v40, v229, v40
    v_add_f32 v41, v231, v41
    v_add_f32 v42, v233, v42
    v_add_f32 v43, v235, v43
    v_cvt_pk_bf16_f32 v228, v36, v37
    v_cvt_pk_bf16_f32 v229, v38, v39
    v_cvt_pk_bf16_f32 v230, v40, v41
    v_cvt_pk_bf16_f32 v231, v42, v43
    buffer_store_dwordx4 v[228:231], v33, s[44:47], s35 offen
    s_cmp_lg_u32 s14, 2
    s_cbranch_scc1 L_CNL
    s_waitcnt vmcnt(1)
    v_cmp_ne_u32_e64 vcc, v34, v172
    s_cbranch_vccnz L_FAW
L_FAK:
    buffer_load_dwordx4 v[48:51], v35, s[44:47], s36 offen sc1
    buffer_load_dwordx4 v[52:55], v35, s[44:47], s37 offen sc1
    s_waitcnt vmcnt(2)
    s_mov_b64 exec, 1
    buffer_store_dword v34, off, s[44:47], s12 offset:512
    s_mov_b64 exec, -1
    s_waitcnt vmcnt(1)
L_DP:
    v_max3_u32 v56, v48, v49, v50
    v_max3_u32 v57, v52, v53, v54
    v_max_u32 v56, v56, v51
    v_max_u32 v57, v57, v55
    v_cmp_eq_u32 s[8:9], -1, v56
    v_cmp_eq_u32 s[10:11], -1, v57
    s_or_b64 vcc, s[8:9], s[10:11]
    s_cbranch_vccnz L_DR
L_DOK:
    s_mov_b64 exec, 1
    ds_write_b32 v4, v5 offset:560
    s_mov_b64 exec, -1
    ds_write_b64 v236, v[48:49] offset:0
    ds_write_b64 v236, v[50:51] offset:144
    ds_write_b64 v236, v[52:53] offset:64
    ds_write_b64 v236, v[54:55] offset:208
    ds_read_b128 v[56:59], v237 offset:0
    ds_read_b128 v[60:63], v237 offset:1152
    s_waitcnt lgkmcnt(1)
    buffer_store_dwordx4 v[56:59], v238, s[52:55], s38 offen sc1
    s_waitcnt lgkmcnt(0)
    buffer_store_dwordx4 v[60:63], v239, s[52:55], s39 offen sc1
    v_mov_b32_e64 v11, 2
    s_waitcnt vmcnt(0)
    s_mov_b64 exec, 1
    ds_write_b32 v4, v11 offset:560
    s_mov_b64 exec, -1
    s_branch L_FIN
L_DR:
    s_add_u32 s41, s41, 1
    s_cmp_ge_u32 s41, 48
    s_cbranch_scc1 L_DF
    s_cmp_eq_u64 s[8:9], 0
    s_cbranch_scc1 L_DS0
    buffer_load_dwordx4 v[48:51], v35, s[44:47], s36 offen sc1
L_DS0:
    s_cmp_eq_u64 s[10:11], 0
    s_cbranch_scc1 L_DS1
    buffer_load_dwordx4 v[52:55], v35, s[44:47], s37 offen sc1
L_DS1:
    s_waitcnt vmcnt(0)
    s_branch L_DP
L_DF:
    s_mov_b32 s41, 0
    s_mov_b32 exec_hi, 0
LT_2:
    buffer_load_dword v172, v174, s[44:47], s40 offen sc1
    s_add_u32 s41, s41, 1
    s_waitcnt vmcnt(0)
    v_cmp_ne_u32 vcc, v34, v172
    s_cbranch_vccz LT_2K
    s_sleep 1
    s_cmp_lt_u32 s41, 0x4000
    s_cbranch_scc1 LT_2
LT_2K:
    s_mov_b32 exec_hi, -1
    buffer_load_dwordx4 v[48:51], v35, s[44:47], s36 offen sc1
    buffer_load_dwordx4 v[52:55], v35, s[44:47], s37 offen sc1
    s_waitcnt vmcnt(0)
    s_branch L_DOK
L_FAW:
    s_mov_b32 s43, 0
    s_mov_b32 exec_hi, 0
LT_3:
    buffer_load_dword v172, v174, s[44:47], s42 offen sc1
    s_add_u32 s43, s43, 1
    s_waitcnt vmcnt(0)
    v_cmp_ne_u32_e64 vcc, v34, v172
    s_cbranch_vccz LT_3K
    s_sleep 1
    s_cmp_lt_u32 s43, 0x4000
    s_cbranch_scc1 LT_3
LT_3K:
    s_mov_b32 exec_hi, -1
    s_branch L_FAK
    s_branch L_FIN
L_CNL:
    v_mov_b32 v5, 2
    s_mov_b64 exec, 1
    ds_write_b32 v4, v5 offset:560
    s_mov_b64 exec, -1
    ds_read_b64 v[12:13], v10 offset:1152
    s_waitcnt lgkmcnt(0)
    v_lshlrev_b32_e64 v14, 24, v12
    v_and_or_b32 v14, v14, s68, v3
    v_lshlrev_b32_e64 v15, 16, v12
    v_and_or_b32 v15, v15, s68, v3
    buffer_store_dwordx2 v[204:205], v14, s[52:55], s60 offen offset:0
    buffer_store_dwordx2 v[206:207], v15, s[52:55], s60 offen offset:2048
    v_lshlrev_b32_e64 v14, 8, v12
    v_and_or_b32 v14, v14, s68, v3
    v_and_or_b32 v15, v12, s68, v3
    buffer_store_dwordx2 v[212:213], v14, s[52:55], s61 offen offset:0
    buffer_store_dwordx2 v[214:215], v15, s[52:55], s61 offen offset:2048
    v_lshlrev_b32_e64 v14, 24, v13
    v_and_or_b32 v14, v14, s68, v3
    v_lshlrev_b32_e64 v15, 16, v13
    v_and_or_b32 v15, v15, s68, v3
    buffer_store_dwordx2 v[220:221], v14, s[52:55], s62 offen offset:0
    buffer_store_dwordx2 v[222:223], v15, s[52:55], s62 offen offset:2048
    v_lshlrev_b32_e64 v14, 8, v13
    v_and_or_b32 v14, v14, s68, v3
    v_and_or_b32 v15, v13, s68, v3
    buffer_store_dwordx2 v[228:229], v14, s[52:55], s63 offen offset:0
    buffer_store_dwordx2 v[230:231], v15, s[52:55], s63 offen offset:2048
    s_branch L_FIN
L_SLOW0:
LW_4:
    ds_read_b32 v11, v6 offset:144
    s_waitcnt lgkmcnt(0)
    v_cmp_eq_u32_e64 vcc, 0, v11
    s_cbranch_vccnz LW_4
    s_branch L_BACK0
L_SLOW1:
LW_5:
    ds_read_b32 v11, v6 offset:16
    s_waitcnt lgkmcnt(0)
    v_cmp_eq_u32 vcc, 0, v11
    s_cbranch_vccnz LW_5
    s_branch L_BACK1
L_SLOW2:
LW_6:
    ds_read_b32 v11, v6 offset:32
    s_waitcnt lgkmcnt(0)
    v_cmp_eq_u32 vcc, 0, v11
    s_cbranch_vccnz LW_6
    s_branch L_BACK2
L_SLOW3:
LW_7:
    ds_read_b32 v11, v6 offset:160
    s_waitcnt lgkmcnt(0)
    v_cmp_eq_u32 vcc, 0, v11
    s_cbranch_vccnz LW_7
    s_branch L_BACK3
L_SLOW4:
LW_8:
    ds_read_b32 v11, v6 offset:112
    s_waitcnt lgkmcnt(0)
    v_cmp_eq_u32_e64 vcc, 0, v11
    s_cbranch_vccnz LW_8
    s_branch L_BACK4
L_XF:
    s_add_u32 s31, s31, 64
    s_buffer_load_dwordx8 s[16:23], s[44:47], s31
    ds_read_b64 v[108:109], v1 offset:960
    ds_read_b64 v[110:111], v1 offset:968
    ds_read_b64 v[112:113], v1 offset:1024
    ds_read_b64 v[114:115], v1 offset:1032
    ds_read_b64 v[116:117], v1 offset:1088
    ds_read_b64 v[118:119], v1 offset:1096
    ds_read_b64 v[120:121], v2 offset:10776
    ds_read_b64 v[122:123], v2 offset:11416
    ds_read_b64 v[124:125], v2 offset:12056
    ds_read_b64 v[126:127], v2 offset:12696
    ds_read_b64 v[128:129], v2 offset:10808
    ds_read_b64 v[130:131], v2 offset:11448
    ds_read_b64 v[132:133], v2 offset:12088
    ds_read_b64 v[134:135], v2 offset:12728
    ds_read_b64 v[136:137], v2 offset:10840
    ds_read_b64 v[138:139], v2 offset:11480
    ds_read_b64 v[140:141], v2 offset:12120
    ds_read_b64 v[142:143], v2 offset:12760
    s_branch L_XC
L_XP:
    s_sleep 2
    ds_read_b32 v11, v4 offset:528
    s_cmp_ge_u32 s5, 2
    s_cbranch_scc1 L_XG
    s_add_u32 s31, s31, 64
    s_buffer_load_dwordx8 s[16:23], s[44:47], s31
    s_branch L_XH
L_XG:
    s_buffer_load_dwordx8 s[16:23], s[44:47], s31 glc
L_XH:
    s_add_u32 s5, s5, 1
    s_waitcnt lgkmcnt(0)
    v_cmp_eq_u32 vcc, 1, v11
    s_cbranch_vccnz L_XSLOW
    s_cmp_ge_u32 s5, 0x4000
    s_cbranch_scc1 L_XSLOW
L_XC:
    s_waitcnt lgkmcnt(0)
    s_xor_b64 s[16:17], s[16:17], s[28:29]
    s_xor_b64 s[18:19], s[18:19], s[28:29]
    s_xor_b64 s[20:21], s[20:21], s[28:29]
    s_xor_b64 s[22:23], s[22:23], s[28:29]
    s_or_b64 s[16:17], s[16:17], s[18:19]
    s_or_b64 s[20:21], s[20:21], s[22:23]
    s_or_b64 s[16:17], s[16:17], s[20:21]
    s_cbranch_scc1 L_XP
    s_setprio 3
    buffer_load_dwordx4 v[16:19], v33, s[44:47], s32 offen sc1
    buffer_load_dwordx4 v[20:23], v33, s[44:47], s33 offen sc1
    buffer_load_dwordx4 v[24:27], v33, s[44:47], s34 offen sc1
    buffer_load_dwordx4 v[28:31], v33, s[44:47], s35 offen sc1
    s_mov_b64 exec, 1
    ds_write_b32 v4, v5 offset:544
    s_mov_b64 exec, -1
    s_setprio 2
    s_branch L_XBACK
L_XSLOW:
    s_nop 0
    buffer_load_dwordx2 v[16:17], v3, s[48:51], s60 offen offset:0
    buffer_load_dwordx2 v[18:19], v3, s[48:51], s60 offen offset:2048
    buffer_load_dwordx2 v[20:21], v3, s[48:51], s61 offen offset:0
    buffer_load_dwordx2 v[22:23], v3, s[48:51], s61 offen offset:2048
    buffer_load_dwordx2 v[24:25], v3, s[48:51], s62 offen offset:0
    buffer_load_dwordx2 v[26:27], v3, s[48:51], s62 offen offset:2048
    buffer_load_dwordx2 v[28:29], v3, s[48:51], s63 offen offset:0
    buffer_load_dwordx2 v[30:31], v3, s[48:51], s63 offen offset:2048
    s_waitcnt vmcnt(0)
    s_branch L_XBACK
L_F0:
    s_setprio 2
    s_mov_b32 s61, 7864320
    s_lshl_b32 s7, s2, 2
    s_add_u32 s7, s7, s3
    s_lshl_b32 s13, s2, 6
    s_add_u32 s13, s13, 7864320
    s_lshl_b32 s8, s7, 12
    v_and_b32 v10, 31, v0
    v_lshlrev_b32 v10, 4, v10
    v_lshrrev_b32 v11, 5, v0
    v_lshl_add_u32 v11, v11, 11, v10
    v_add_u32 v11, s8, v11
    s_cmp_lt_u32 s6, 28
    s_cselect_b32 s69, 1, 0
    s_lshr_b32 s8, s6, 2
    s_add_u32 s9, s5, 3
    s_and_b32 s9, s9, 7
    s_min_u32 s9, s9, 6
    s_cmp_lt_u32 s6, 28
    s_cselect_b32 s8, s8, s9
    s_mul_i32 s59, s5, 7
    s_add_u32 s59, s59, s8
    s_and_b32 s68, s6, 3
    s_lshl_b32 s8, s68, 2
    s_add_u32 s8, s8, s3
    s_lshl_b32 s8, s8, 6
    s_xor_b32 s9, s69, 1
    s_lshl_b32 s9, s9, 5
    s_add_u32 s8, s8, s9
    v_lshrrev_b32_e64 v12, 4, v0
    v_lshl_add_u32 v12, v12, 3, s8
    v_lshlrev_b32 v9, 1, v12
    s_movk_i32 s10, 7168
    v_mul_u32_u24 v14, s10, v12
    v_and_b32 v12, 7, v0
    v_lshl_add_u32 v14, v12, 4, v14
    s_lshl_b32 s8, s59, 7
    v_add_u32 v14, s8, v14
    v_and_b32 v12, 8, v0
    v_cmp_ne_u32_e64 vcc, 0, v12
    s_waitcnt lgkmcnt(0)
    global_load_dwordx4 v[16:19], v11, s[16:17] offset:0
    global_load_dwordx4 v[20:23], v11, s[16:17] offset:512
    global_load_dwordx4 v[24:27], v11, s[16:17] offset:1024
    global_load_dwordx4 v[28:31], v11, s[16:17] offset:1536
    s_load_dword s56, s[42:43], 0
    global_load_dwordx4 v[32:35], v10, s[32:33] offset:0
    global_load_dwordx4 v[36:39], v10, s[32:33] offset:512
    global_load_dwordx4 v[40:43], v10, s[32:33] offset:1024
    global_load_dwordx4 v[44:47], v10, s[32:33] offset:1536
    v_mov_b32 v12, s34
    v_mov_b32 v13, s35
    v_mov_b32 v10, s36
    v_mov_b32 v11, s37
    v_cndmask_b32 v12, v12, v10, vcc
    v_cndmask_b32 v13, v13, v11, vcc
    v_add_co_u32 v220, vcc, v12, v14
    s_movk_i32 s20, 7168
    s_mov_b32 s21, 0
    v_addc_co_u32 v221, vcc, 0, v13, vcc
    s_barrier
    s_mov_b32 s48, s16
    s_and_b32 s49, s17, 0xffff
    s_mov_b32 s50, 0x400000
    s_mov_b32 s51, 0x20000
    s_mov_b32 s52, s40
    s_and_b32 s53, s41, 0xffff
    s_mov_b32 s54, 0x400000
    s_mov_b32 s55, 0x20000
    s_lshl_b32 s8, s6, 17
    s_lshl_b32 s9, s3, 15
    s_add_u32 s8, s8, s9
    s_lshl_b32 s9, s5, 8
    s_add_u32 s8, s8, s9
    s_add_u32 s9, s8, 4096
    v_lshrrev_b32 v10, 4, v0
    v_and_b32 v11, 15, v0
    v_lshlrev_b32_e64 v11, 4, v11
    v_lshl_add_u32 v14, v10, 13, v11
    buffer_load_dwordx4 v[64:67], v14, s[48:51], s8 offen offset:0
    buffer_load_dwordx4 v[68:71], v14, s[48:51], s8 offen offset:2048
    buffer_load_dwordx4 v[72:75], v14, s[48:51], s9 offen offset:0
    buffer_load_dwordx4 v[76:79], v14, s[48:51], s9 offen offset:2048
    s_mul_i32 s8, s3, 4608
    s_add_u32 s8, s8, 121856
    s_movk_i32 s9, 1088
    v_mad_u32_u24 v96, v10, s9, v11
    v_add_u32 v96, s8, v96
    v_and_b32 v10, 7, v0
    v_lshrrev_b32_e64 v11, 3, v0
    s_movk_i32 s9, 544
    v_lshl_add_u32 v97, v11, 3, s8
    v_mad_u32_u24 v97, v10, s9, v97
    v_lshlrev_b32_e64 v98, 4, v10
    v_lshl_add_u32 v98, v11, 14, v98
    s_lshl_b32 s18, s5, 19
    s_lshl_b32 s9, s6, 9
    s_add_u32 s18, s18, s9
    s_lshl_b32 s9, s3, 7
    s_add_u32 s18, s18, s9
    s_add_u32 s18, s18, 3145728
    s_getreg_b32 s19, hwreg(HW_REG_XCC_ID, 0, 4)
    s_mov_b32 s22, 179200
    s_cmp_eq_u32 s69, 1
    s_cselect_b32 s22, s22, 0xfffbbc00
    s_cselect_b32 s23, 0, -1
    s_lshl_b32 s62, s5, 2
    s_bfe_u32 s9, s6, 0x20001
    s_add_u32 s62, s62, s9
    s_lshl_b32 s62, s62, 12
    s_lshr_b32 s9, s6, 3
    s_lshl_b32 s9, s9, 1
    s_add_u32 s62, s62, s9
    s_and_b32 s9, s6, 1
    s_add_u32 s62, s62, s9
    s_lshl_b32 s62, s62, 2
    s_add_u32 s62, s62, 7340032
    s_lshl_b32 s19, s19, 1
    s_lshl_b32 s9, s5, 2
    s_lshl_b32 s40, 15, s9
    s_mov_b32 s41, s40
    s_mov_b32 s44, s42
    s_and_b32 s45, s43, 0xffff
    s_mov_b32 s46, 0x1000000
    s_mov_b32 s47, 0x20000
    s_mov_b32 s24, s38
    s_and_b32 s25, s39, 0xffff
    s_mov_b32 s26, 0x700000
    s_mov_b32 s27, 0x20000
    s_lshl_b32 s7, s3, 2
    v_mov_b32 v2, s7
    v_and_b32 v11, 3, v0
    v_lshlrev_b32 v1, 2, v11
    v_mov_b32 v5, 1
    s_lshl_b32 s8, s3, 6
    v_add_u32 v14, s8, v0
    v_lshlrev_b32 v226, 4, v14
    v_lshlrev_b32 v105, 4, v11
    v_lshrrev_b32_e64 v63, 2, v0
    v_lshl_add_u32 v63, v63, 14, v105
    s_lshl_b32 s4, s5, 14
    v_add_u32 v223, 0, v226
    s_mov_b32 s5, 7868416
    s_mov_b32 s6, 7872512
    s_mov_b32 s7, 7876608
    s_cmp_lg_u32 s3, 0
    s_cbranch_scc1 L_NOZ
    v_lshlrev_b32 v224, 4, v0
    v_mov_b32 v228, 0
    v_mov_b32 v229, 0
    v_mov_b32 v230, 0
    v_mov_b32_e64 v231, 0
    ds_write_b128 v224, v[228:231] offset:1024
    ds_write_b128 v224, v[228:231] offset:2048
    ds_write_b128 v224, v[228:231] offset:3072
L_NOZ:
    s_lshl_b32 s4, s3, 6
    v_add_u32 v14, s4, v0
    v_lshlrev_b32_e64 v15, 4, v14
    s_mov_b32 s64, 0x05040100
    s_mov_b32 s65, 0x07060302
    v_lshlrev_b32 v224, 4, v0
    v_and_b32 v10, 15, v0
    v_lshlrev_b32 v10, 2, v10
    v_and_b32 v11, 48, v0
    s_movk_i32 s4, 0xfff
    v_lshlrev_b32 v248, 1, v14
    v_sub_u32 v248, s4, v248
    v_subrev_u32 v249, 1, v248
    v_subrev_u32 v250, 512, v248
    v_subrev_u32 v251, 513, v248
    v_subrev_u32 v252, 1024, v248
    v_subrev_u32 v253, 1025, v248
    v_subrev_u32 v254, 1536, v248
    v_subrev_u32 v255, 1537, v248
    v_lshlrev_b32 v227, 3, v14
    v_lshrrev_b32 v225, 4, v14
    v_lshlrev_b32 v225, 2, v225
    v_lshlrev_b32_e64 v14, 2, v14
    s_mov_b32 s16, 0
    s_mov_b32 s17, 0xffff0000
    v_lshlrev_b32 v3, 3, v11
    s_lshl_b32 s8, s3, 12
    s_add_u32 s8, s8, 140288
    v_add_u32 v3, s8, v3
    v_lshrrev_b32 v12, 5, v0
    v_lshlrev_b32_e64 v4, 7, v12
    v_bfe_u32 v12, v0, 4, 1
    v_lshl_add_u32 v4, v12, 3, v4
    v_bfe_u32 v12, v0, 3, 1
    v_lshl_add_u32 v4, v12, 9, v4
    v_and_b32_e64 v12, 7, v0
    v_lshl_add_u32 v4, v12, 4, v4
    s_lshl_b32 s8, s3, 10
    s_add_u32 s8, s8, 140288
    v_add_u32 v4, s8, v4
    v_bfe_u32 v12, v0, 4, 1
    v_lshlrev_b32 v12, 16, v12
    v_lshrrev_b32 v13, 5, v0
    v_lshl_add_u32 v12, v13, 12, v12
    v_lshl_add_u32 v222, v10, 1, v12
    s_lshl_b32 s10, s59, 17
    s_lshl_b32 s11, s68, 9
    s_add_u32 s10, s10, s11
    s_lshl_b32 s11, s3, 7
    s_add_u32 s10, s10, s11
    s_and_b32 s9, s2, 7
    s_add_u32 s9, s9, 56
    s_cmp_eq_u32 s69, 1
    s_cselect_b32 s33, s59, s9
    s_lshl_b32 s33, s33, 2
    s_add_u32 s33, s33, s68
    s_lshl_b32 s33, s33, 2
    s_add_u32 s33, s33, s3
    s_lshl_b32 s33, s33, 11
    s_add_u32 s33, s33, 1048576
    v_mov_b32_e64 v218, 0
    s_cmp_eq_u32 s69, 1
    s_cselect_b64 exec, -1, 1
    buffer_store_dwordx4 v[216:219], v224, s[44:47], s33 offen offset:0
    buffer_store_dwordx4 v[216:219], v224, s[44:47], s33 offen offset:1024
    s_mov_b64 exec, -1
    s_mov_b32 s8, 0x3f803f80
    s_waitcnt vmcnt(10)
    v_dot2_f32_bf16 v48, v16, s8, 0
    v_dot2_f32_bf16 v49, v16, v16, 0
    v_dot2_f32_bf16 v48, v17, s8, v48
    v_dot2_f32_bf16 v49, v17, v17, v49
    v_dot2_f32_bf16 v48, v18, s8, v48
    v_dot2_f32_bf16 v49, v18, v18, v49
    v_dot2_f32_bf16 v48, v19, s8, v48
    v_dot2_f32_bf16 v49, v19, v19, v49
    v_dot2_f32_bf16 v48, v20, s8, v48
    v_dot2_f32_bf16 v49, v20, v20, v49
    v_dot2_f32_bf16 v48, v21, s8, v48
    v_dot2_f32_bf16 v49, v21, v21, v49
    v_dot2_f32_bf16 v48, v22, s8, v48
    v_dot2_f32_bf16 v49, v22, v22, v49
    v_dot2_f32_bf16 v48, v23, s8, v48
    v_dot2_f32_bf16 v49, v23, v23, v49
    v_dot2_f32_bf16 v48, v24, s8, v48
    v_dot2_f32_bf16 v49, v24, v24, v49
    v_dot2_f32_bf16 v48, v25, s8, v48
    v_dot2_f32_bf16 v49, v25, v25, v49
    v_dot2_f32_bf16 v48, v26, s8, v48
    v_dot2_f32_bf16 v49, v26, v26, v49
    v_dot2_f32_bf16 v48, v27, s8, v48
    v_dot2_f32_bf16 v49, v27, v27, v49
    v_dot2_f32_bf16 v48, v28, s8, v48
    v_dot2_f32_bf16 v49, v28, v28, v49
    v_dot2_f32_bf16 v48, v29, s8, v48
    v_dot2_f32_bf16 v49, v29, v29, v49
    v_dot2_f32_bf16 v48, v30, s8, v48
    v_dot2_f32_bf16 v49, v30, v30, v49
    v_dot2_f32_bf16 v48, v31, s8, v48
    v_dot2_f32_bf16 v49, v31, v31, v49
    s_waitcnt lgkmcnt(0)
    s_mul_i32 s56, s56, 0x9E3779B1
    s_add_u32 s56, s56, 0x7F4A7C15
    s_or_b32 s56, s56, 1
    s_andn2_b32 s56, s56, 0x1e
    s_or_b32 s63, s19, s56
    v_mov_b32 v59, s63
    s_waitcnt vmcnt(6)
    v_dot2_f32_bf16 v50, v16, v32, 0
    v_dot2_f32_bf16 v51, v32, s8, 0
    v_dot2_f32_bf16 v50, v17, v33, v50
    v_dot2_f32_bf16 v51, v33, s8, v51
    v_dot2_f32_bf16 v50, v18, v34, v50
    v_dot2_f32_bf16 v51, v34, s8, v51
    v_dot2_f32_bf16 v50, v19, v35, v50
    v_dot2_f32_bf16 v51, v35, s8, v51
    v_dot2_f32_bf16 v50, v20, v36, v50
    v_dot2_f32_bf16 v51, v36, s8, v51
    v_dot2_f32_bf16 v50, v21, v37, v50
    v_dot2_f32_bf16 v51, v37, s8, v51
    v_dot2_f32_bf16 v50, v22, v38, v50
    v_dot2_f32_bf16 v51, v38, s8, v51
    v_dot2_f32_bf16 v50, v23, v39, v50
    v_dot2_f32_bf16 v51, v39, s8, v51
    v_dot2_f32_bf16 v50, v24, v40, v50
    v_dot2_f32_bf16 v51, v40, s8, v51
    v_dot2_f32_bf16 v50, v25, v41, v50
    v_dot2_f32_bf16 v51, v41, s8, v51
    v_dot2_f32_bf16 v50, v26, v42, v50
    v_dot2_f32_bf16 v51, v42, s8, v51
    v_dot2_f32_bf16 v50, v27, v43, v50
    v_dot2_f32_bf16 v51, v43, s8, v51
    v_dot2_f32_bf16 v50, v28, v44, v50
    v_dot2_f32_bf16 v51, v44, s8, v51
    v_dot2_f32_bf16 v50, v29, v45, v50
    v_dot2_f32_bf16 v51, v45, s8, v51
    v_dot2_f32_bf16 v50, v30, v46, v50
    v_dot2_f32_bf16 v51, v46, s8, v51
    v_dot2_f32_bf16 v50, v31, v47, v50
    v_dot2_f32_bf16 v51, v47, s8, v51
    s_nop 0
    s_nop 0
    v_add_f32_dpp v48, v48, v48 row_shr:1 row_mask:0xf bank_mask:0xf
    v_add_f32_dpp v49, v49, v49 row_shr:1 row_mask:0xf bank_mask:0xf
    v_add_f32_dpp v50, v50, v50 row_shr:1 row_mask:0xf bank_mask:0xf
    v_add_f32_dpp v51, v51, v51 row_shr:1 row_mask:0xf bank_mask:0xf
    v_add_f32_dpp v48, v48, v48 row_shr:2 row_mask:0xf bank_mask:0xf
    v_add_f32_dpp v49, v49, v49 row_shr:2 row_mask:0xf bank_mask:0xf
    v_add_f32_dpp v50, v50, v50 row_shr:2 row_mask:0xf bank_mask:0xf
    v_add_f32_dpp v51, v51, v51 row_shr:2 row_mask:0xf bank_mask:0xf
    v_add_f32_dpp v48, v48, v48 row_shr:4 row_mask:0xf bank_mask:0xf
    v_add_f32_dpp v49, v49, v49 row_shr:4 row_mask:0xf bank_mask:0xf
    v_add_f32_dpp v50, v50, v50 row_shr:4 row_mask:0xf bank_mask:0xf
    v_add_f32_dpp v51, v51, v51 row_shr:4 row_mask:0xf bank_mask:0xf
    v_add_f32_dpp v48, v48, v48 row_shr:8 row_mask:0xf bank_mask:0xf
    v_add_f32_dpp v49, v49, v49 row_shr:8 row_mask:0xf bank_mask:0xf
    v_add_f32_dpp v50, v50, v50 row_shr:8 row_mask:0xf bank_mask:0xf
    v_add_f32_dpp v51, v51, v51 row_shr:8 row_mask:0xf bank_mask:0xf
    v_add_f32_dpp v48, v48, v48 row_bcast:15 row_mask:0xa bank_mask:0xf
    v_add_f32_dpp v49, v49, v49 row_bcast:15 row_mask:0xa bank_mask:0xf
    v_add_f32_dpp v50, v50, v50 row_bcast:15 row_mask:0xa bank_mask:0xf
    v_add_f32_dpp v51, v51, v51 row_bcast:15 row_mask:0xa bank_mask:0xf
    v_mul_f32 v48, 0x3a800000, v48
    v_mul_f32 v49, 0x3a800000, v49
    v_cvt_pk_bf16_f32 v52, v48, v48
    v_fma_f32 v49, -v48, v48, v49
    v_max_f32_e64 v49, 0, v49
    v_and_b32 v53, 0xffff0000, v52
    v_cvt_pk_bf16_f32 v49, v49, v49
    v_and_b32 v49, 0xffff0000, v49
    v_add_f32 v49, 0x3727c5ac, v49
    v_fma_f32 v50, -v53, v51, v50
    v_cvt_pk_bf16_f32 v49, v49, v49
    v_and_b32 v49, 0xffff0000, v49
    v_sqrt_f32 v49, v49
    v_lshlrev_b32 v104, 2, v2
    v_mov_b32 v61, 0
    v_and_b32 v62, 62, v0
    v_mad_u32_u24 v62, v62, 3, v0
    v_lshlrev_b32_e64 v62, 6, v62
    v_cvt_pk_bf16_f32 v54, v49, v49
    v_and_b32 v49, 0xffff0000, v54
    v_rcp_f32 v49, v49
    s_nop 0
    v_mul_f32_e64 v50, v50, v49
    v_cvt_pk_bf16_f32 v50, v50, v50
    v_bfe_i32 v51, v50, 15, 1
    v_or_b32 v51, 0x80008000, v51
    v_xor_b32_e64 v55, v50, v51
    s_mov_b32 s8, 0xffff
    v_mov_b32_dpp v56, v52 row_bcast:31 row_mask:0x8 bank_mask:0xf
    v_mov_b32_dpp v57, v54 row_bcast:31 row_mask:0x8 bank_mask:0xf
    v_mov_b32_dpp v58, v55 row_bcast:31 row_mask:0x8 bank_mask:0xf
    v_bfi_b32 v56, s8, v56, v52
    v_bfi_b32 v57, s8, v57, v54
    v_bfi_b32 v58, s8, v58, v55
    s_brev_b64 exec, 1
    ds_write_b128 v104, v[56:59] offset:576
    ds_add_rtn_u32 v60, v61, v5 offset:512
    s_mov_b64 exec, -1
    s_waitcnt lgkmcnt(0)
    v_readlane_b32 s8, v60, 63
    s_cmp_lg_u32 s8, 3
    s_cbranch_scc1 L_NOPUB
    s_bfm_b64 exec, 4, 0
    ds_read_b128 v[52:55], v105 offset:576
    s_waitcnt lgkmcnt(0)
    buffer_store_dwordx4 v[52:55], v63, s[44:47], s13 offen sc1
    ds_write_b32 v61, v5 offset:516
    s_mov_b64 exec, -1
    s_waitcnt vmcnt(3)
    s_branch L_PUB2
L_NOPUB:
    s_waitcnt vmcnt(2)
L_PUB2:
    s_nop 0
    ds_write_b128 v96, v[64:67] offset:0
    ds_write_b128 v96, v[68:71] offset:272
    ds_write_b128 v96, v[72:75] offset:544
    ds_write_b128 v96, v[76:79] offset:816
    ds_read_b64 v[80:81], v97 offset:0
    ds_read_b64 v[82:83], v97 offset:272
    ds_read_b64 v[84:85], v97 offset:64
    ds_read_b64 v[86:87], v97 offset:336
    ds_read_b64 v[88:89], v97 offset:128
    ds_read_b64 v[90:91], v97 offset:400
    ds_read_b64 v[92:93], v97 offset:192
    ds_read_b64 v[94:95], v97 offset:464
    s_waitcnt lgkmcnt(6)
    buffer_store_dwordx4 v[80:83], v98, s[44:47], s18 offen
    s_add_u32 s18, s18, 0x20000
    s_waitcnt lgkmcnt(4)
    buffer_store_dwordx4 v[84:87], v98, s[44:47], s18 offen
    s_add_u32 s18, s18, 0x20000
    s_waitcnt lgkmcnt(2)
    buffer_store_dwordx4 v[88:91], v98, s[44:47], s18 offen
    s_add_u32 s18, s18, 0x20000
    s_waitcnt lgkmcnt(0)
    buffer_store_dwordx4 v[92:95], v98, s[44:47], s18 offen
    s_add_u32 s18, s18, 0x20000
    s_mov_b64 exec, 1
    ds_write_b32 v2, v59 offset:128
    s_mov_b64 exec, -1
LW_9:
    ds_read_b32 v60, v61 offset:516
    s_waitcnt lgkmcnt(0)
    v_cmp_eq_u32_e64 vcc, 0, v60
    s_cbranch_vccnz LW_9
    s_waitcnt vmcnt(0)
    s_mov_b64 exec, 1
    ds_add_rtn_u32 v60, v61, v5 offset:520
    s_waitcnt lgkmcnt(0)
    v_readfirstlane_b32 s8, v60
    s_cmp_lg_u32 s8, 3
    s_mov_b64 exec, -1
    s_cbranch_scc1 L_NOXF
    s_nop 0
    buffer_store_dword v59, v62, s[44:47], s62 offen offset:0
    buffer_store_dword v59, v62, s[44:47], s62 offen offset:128
    buffer_store_dword v59, v62, s[44:47], s62 offen offset:256
L_NOXF:
    global_load_dwordx4 v[112:115], v[220:221], off
    v_lshl_add_u64 v[220:221], s[20:21], 0, v[220:221]
    global_load_dwordx4 v[116:119], v[220:221], off
    v_lshl_add_u64 v[220:221], s[20:21], 0, v[220:221]
    global_load_dwordx4 v[120:123], v[220:221], off
    v_lshl_add_u64 v[220:221], s[20:21], 0, v[220:221]
    global_load_dwordx4 v[124:127], v[220:221], off
    v_lshl_add_u64 v[220:221], s[20:21], 0, v[220:221]
    s_waitcnt vmcnt(3)
    s_nop 0
    global_load_dwordx4 v[128:131], v[220:221], off
    v_lshl_add_u64 v[220:221], s[20:21], 0, v[220:221]
    buffer_load_dwordx4 v[32:35], v223, s[44:47], s61 offen sc1
    buffer_load_dwordx4 v[36:39], v223, s[44:47], s5 offen sc1
    buffer_load_dwordx4 v[40:43], v223, s[44:47], s6 offen sc1
    buffer_load_dwordx4 v[44:47], v223, s[44:47], s7 offen sc1
    s_waitcnt vmcnt(0)
    s_branch L_KPW
L_KP:
    s_sleep 1
L_KQ2:
    s_mov_b64 exec, s[30:31]
    s_cbranch_execz L_KS0
    buffer_load_dwordx4 v[32:35], v223, s[44:47], s61 offen sc1
L_KS0:
    s_mov_b64 exec, s[8:9]
    s_cbranch_execz L_KS1
    buffer_load_dwordx4 v[36:39], v223, s[44:47], s5 offen sc1
L_KS1:
    s_mov_b64 exec, s[14:15]
    s_cbranch_execz L_KS2
    buffer_load_dwordx4 v[40:43], v223, s[44:47], s6 offen sc1
L_KS2:
    s_mov_b64 exec, s[28:29]
    s_cbranch_execz L_KS3
    buffer_load_dwordx4 v[44:47], v223, s[44:47], s7 offen sc1
L_KS3:
    s_mov_b64 exec, -1
    s_waitcnt vmcnt(0)
L_KPW:
    s_add_u32 s16, s16, 1
    v_xor_b32 v16, s63, v35
    v_xor_b32 v17, s63, v39
    v_xor_b32 v18, s63, v43
    v_xor_b32 v19, s63, v47
    v_cmp_lt_u32 s[30:31], 31, v16
    v_cmp_lt_u32 s[8:9], 31, v17
    v_cmp_lt_u32 s[14:15], 31, v18
    v_cmp_lt_u32 s[28:29], 31, v19
    v_or3_b32 v16, v16, v17, v18
    s_or_b64 vcc, s[30:31], s[8:9]
    s_or_b64 s[66:67], s[14:15], s[28:29]
    s_or_b64 vcc, vcc, s[66:67]
    s_cbranch_vccz L_KPOK
    s_cmp_lt_u32 s16, 0x4000
    s_cbranch_scc1 L_KP
L_KPOK:
    v_or_b32 v16, v16, v19
    v_cmp_ne_u32 vcc, 0, v16
    s_and_b64 vcc, vcc, s[40:41]
    s_cselect_b32 s8, 1, 2
    v_mov_b32 v16, s8
    ds_read_b32 v17, v1 offset:544
    ds_write2st64_b64 v227, v[32:33], v[36:37] offset0:18 offset1:22
    ds_write2st64_b64 v227, v[40:41], v[44:45] offset0:26 offset1:30
    s_mov_b64 exec, 1
    ds_write_b32 v2, v16 offset:528
    s_mov_b64 exec, -1
    v_lshl_or_b32 v248, v34, 16, v248
    v_and_or_b32 v249, v34, s17, v249
    v_lshl_or_b32 v250, v38, 16, v250
    v_and_or_b32 v251, v38, s17, v251
    v_lshl_or_b32 v252, v42, 16, v252
    v_and_or_b32 v253, v42, s17, v253
    v_lshl_or_b32 v254, v46, 16, v254
    v_and_or_b32 v255, v46, s17, v255
    s_waitcnt lgkmcnt(3)
    v_cmp_eq_u32 s[66:67], 0, v17
    s_cmp_lg_u32 s66, 0
    s_cbranch_scc1 L_NB0
    s_nop 0
    global_load_dwordx4 v[132:135], v[220:221], off
    v_lshl_add_u64 v[220:221], s[20:21], 0, v[220:221]
    global_load_dwordx4 v[136:139], v[220:221], off
    v_lshl_add_u64 v[220:221], s[20:21], 0, v[220:221]
    global_load_dwordx4 v[140:143], v[220:221], off
    v_lshl_add_u64 v[220:221], s[22:23], 0, v[220:221]
    global_load_dwordx4 v[144:147], v[220:221], off
    v_lshl_add_u64 v[220:221], s[20:21], 0, v[220:221]
L_NB0:
    v_max_u32 v226, v248, v249
    v_min_u32 v227, v248, v249
    v_max_u32 v228, v252, v253
    v_min_u32 v229, v252, v253
    v_med3_u32 v227, v226, v227, v250
    v_med3_u32 v229, v228, v229, v254
    v_max_u32 v226, v226, v250
    v_max_u32 v228, v228, v254
    v_med3_u32 v227, v226, v227, v251
    v_med3_u32 v229, v228, v229, v255
    v_max_u32 v226, v226, v251
    v_max_u32 v228, v228, v255
    v_min_u32 v230, v226, v228
    v_max_u32 v226, v226, v228
    v_max3_u32 v227, v227, v229, v230
    ds_write_b32 v14, v226 offset:8192
    ds_read_b32 v17, v1 offset:544
    v_add_u32 v15, 4096, v15
    v_max_u32_dpp v226, v226, v226 row_shr:1 row_mask:0xf bank_mask:0xf
    v_max_u32_dpp v227, v227, v227 row_shr:1 row_mask:0xf bank_mask:0xf
    ds_write2_b32 v15, v34, v38 offset0:0 offset1:1
    v_max_u32_dpp v226, v226, v226 row_shr:2 row_mask:0xf bank_mask:0xf
    v_max_u32_dpp v227, v227, v227 row_shr:2 row_mask:0xf bank_mask:0xf
    ds_write2_b32 v15, v42, v46 offset0:2 offset1:3
    v_max_u32_dpp v226, v226, v226 row_shr:4 row_mask:0xf bank_mask:0xf
    v_max_u32_dpp v227, v227, v227 row_shr:4 row_mask:0xf bank_mask:0xf
    s_nop 0
    s_nop 0
    v_max_u32_dpp v226, v226, v226 row_shr:8 row_mask:0xf bank_mask:0xf
    v_max_u32_dpp v227, v227, v227 row_shr:8 row_mask:0xf bank_mask:0xf
    s_mov_b32 exec_lo, 0x80008000
    s_mov_b32 exec_hi, 0x80008000
    ds_write2_b32 v225, v226, v227 offset0:96 offset1:112
    s_mov_b64 exec, 1
    ds_write_b32 v2, v16 offset:64
    s_mov_b64 exec, -1
    s_waitcnt lgkmcnt(4)
    v_cmp_eq_u32 vcc, 0, v17
    s_mov_b32 s67, vcc_lo
    s_cbranch_vccnz L_NB1
    s_cmp_eq_u32 s66, 0
    s_cbranch_scc1 L_NB2
    global_load_dwordx4 v[132:135], v[220:221], off
    v_lshl_add_u64 v[220:221], s[20:21], 0, v[220:221]
    global_load_dwordx4 v[136:139], v[220:221], off
    v_lshl_add_u64 v[220:221], s[20:21], 0, v[220:221]
    global_load_dwordx4 v[140:143], v[220:221], off
    v_lshl_add_u64 v[220:221], s[22:23], 0, v[220:221]
    global_load_dwordx4 v[144:147], v[220:221], off
    v_lshl_add_u64 v[220:221], s[20:21], 0, v[220:221]
L_NB2:
    global_load_dwordx4 v[148:151], v[220:221], off
    v_lshl_add_u64 v[220:221], s[20:21], 0, v[220:221]
    global_load_dwordx4 v[152:155], v[220:221], off
    v_lshl_add_u64 v[220:221], s[20:21], 0, v[220:221]
    global_load_dwordx4 v[156:159], v[220:221], off
    v_lshl_add_u64 v[220:221], s[20:21], 0, v[220:221]
    global_load_dwordx4 v[160:163], v[220:221], off
    v_lshl_add_u64 v[220:221], s[20:21], 0, v[220:221]
L_NB1:
LW_10:
    ds_read_b32 v225, v1 offset:64
    s_waitcnt lgkmcnt(0)
    v_cmp_eq_u32_e64 vcc, 0, v225
    s_cbranch_vccnz LW_10
    v_cmp_ne_u32 s[12:13], 2, v225
    ds_read2_b32 v[226:227], v10 offset0:96 offset1:112
    ds_read_b128 v[228:231], v11 offset:384
    ds_read_b128 v[232:235], v224 offset:8192
    s_waitcnt lgkmcnt(1)
    v_cmp_gt_u32 vcc, v228, v226
    v_cmp_gt_u32 s[8:9], v229, v226
    v_cmp_gt_u32 s[14:15], v230, v226
    v_cmp_gt_u32 s[28:29], v231, v226
    v_cndmask_b32 v236, 0, 1, vcc
    v_cndmask_b32 v237, 0, 1, s[8:9]
    v_addc_co_u32 v236, vcc, 0, v236, s[14:15]
    v_addc_co_u32 v236, vcc, v237, v236, s[28:29]
    v_mov_b32 v237, v236
    s_nop 1
    v_permlane32_swap_b32 v236, v237
    v_add_u32 v236, v236, v237
    v_mov_b32 v237, v236
    s_nop 1
    v_permlane16_swap_b32 v236, v237
    v_add_u32 v236, v236, v237
    v_cmp_eq_u32 vcc, 7, v236
    s_ff1_i32_b32 s5, vcc_lo
    v_readlane_b32 s4, v226, s5
    s_waitcnt lgkmcnt(0)
    s_nop 0
    v_cmp_le_u32 vcc, s4, v227
    s_cbranch_vccnz L_SLOWT
L_CAND:
    v_cmp_le_u32 s[8:9], s4, v232
    v_cmp_le_u32 s[14:15], s4, v233
    v_cmp_le_u32 s[28:29], s4, v234
    v_cmp_le_u32 s[30:31], s4, v235
    s_bcnt1_i32_b64 s5, s[8:9]
    s_bcnt1_i32_b64 s6, s[14:15]
    s_bcnt1_i32_b64 s7, s[28:29]
    s_bcnt1_i32_b64 s16, s[30:31]
    s_add_u32 s6, s6, s5
    s_add_u32 s7, s7, s6
    s_add_u32 s16, s16, s7
    s_cmp_gt_u32 s16, 16
    s_cbranch_scc1 L_TRIM
    v_mbcnt_lo_u32_b32 v236, s8, 0
    v_mbcnt_hi_u32_b32 v236, s9, v236
    v_add_lshl_u32 v236, v236, 0, 2
    s_mov_b64 exec, s[8:9]
    ds_write_b32 v236, v232 offset:192
    s_mov_b64 exec, -1
    v_mbcnt_lo_u32_b32 v237, s14, 0
    v_mbcnt_hi_u32_b32 v237, s15, v237
    v_add_lshl_u32 v237, v237, s5, 2
    s_mov_b64 exec, s[14:15]
    ds_write_b32 v237, v233 offset:192
    s_mov_b64 exec, -1
    v_mbcnt_lo_u32_b32 v238, s28, 0
    v_mbcnt_hi_u32_b32 v238, s29, v238
    v_add_lshl_u32 v238, v238, s6, 2
    s_mov_b64 exec, s[28:29]
    ds_write_b32 v238, v234 offset:192
    s_mov_b64 exec, -1
    v_mbcnt_lo_u32_b32 v239, s30, 0
    v_mbcnt_hi_u32_b32 v239, s31, v239
    v_add_lshl_u32 v239, v239, s7, 2
    s_mov_b64 exec, s[30:31]
    ds_write_b32 v239, v235 offset:192
    s_mov_b64 exec, -1
    s_cmp_eq_u32 s67, 0
    s_cbranch_scc1 L_NB3
    s_nop 0
    global_load_dwordx4 v[132:135], v[220:221], off
    v_lshl_add_u64 v[220:221], s[20:21], 0, v[220:221]
    global_load_dwordx4 v[136:139], v[220:221], off
    v_lshl_add_u64 v[220:221], s[20:21], 0, v[220:221]
    global_load_dwordx4 v[140:143], v[220:221], off
    v_lshl_add_u64 v[220:221], s[22:23], 0, v[220:221]
    global_load_dwordx4 v[144:147], v[220:221], off
    v_lshl_add_u64 v[220:221], s[20:21], 0, v[220:221]
    global_load_dwordx4 v[148:151], v[220:221], off
    v_lshl_add_u64 v[220:221], s[20:21], 0, v[220:221]
    global_load_dwordx4 v[152:155], v[220:221], off
    v_lshl_add_u64 v[220:221], s[20:21], 0, v[220:221]
    global_load_dwordx4 v[156:159], v[220:221], off
    v_lshl_add_u64 v[220:221], s[20:21], 0, v[220:221]
    global_load_dwordx4 v[160:163], v[220:221], off
    v_lshl_add_u64 v[220:221], s[20:21], 0, v[220:221]
L_NB3:
    global_load_dwordx4 v[164:167], v[220:221], off
    v_lshl_add_u64 v[220:221], s[20:21], 0, v[220:221]
    global_load_dwordx4 v[168:171], v[220:221], off
    v_lshl_add_u64 v[220:221], s[20:21], 0, v[220:221]
    global_load_dwordx4 v[172:175], v[220:221], off
    s_movk_i32 s4, 0x7ff
    ds_read_b32 v16, v10 offset:192
    ds_read_b128 v[20:23], v11 offset:192
    s_cmp_lg_u32 s69, 1
    s_waitcnt lgkmcnt(1)
    v_bfi_b32 v14, v16, 0, s4
    s_cbranch_scc1 L_NOXS
    v_lshl_add_u32 v15, v14, 11, v9
    buffer_load_dwordx4 v[208:211], v15, s[48:51], 0 offen
    buffer_load_dwordx4 v[212:215], v15, s[48:51], 0 offen offset:64
    v_lshrrev_b32 v15, 1, v14
    v_lshlrev_b32 v15, 3, v15
    ds_read_b64 v[8:9], v15 offset:9216
L_NOXS:
    s_waitcnt lgkmcnt(0)
    v_cmp_gt_u32 vcc, v20, v16
    v_cmp_gt_u32 s[8:9], v21, v16
    v_cmp_gt_u32 s[14:15], v22, v16
    v_cmp_gt_u32 s[28:29], v23, v16
    v_cndmask_b32 v24, 0, 1, vcc
    v_cndmask_b32 v25, 0, 1, s[8:9]
    v_addc_co_u32 v24, vcc, 0, v24, s[14:15]
    v_addc_co_u32 v24, vcc, v25, v24, s[28:29]
    v_mov_b32 v25, v24
    s_nop 1
    v_permlane32_swap_b32 v24, v25
    v_add_u32 v24, v24, v25
    v_mov_b32 v25, v24
    s_nop 1
    v_permlane16_swap_b32 v24, v25
    v_add_u32 v24, v24, v25
    v_cmp_gt_u32 s[30:31], 8, v24
    v_lshlrev_b32 v15, 2, v24
    v_and_b32 v10, 7, v0
    v_lshlrev_b32_e64 v10, 2, v10
    v_bfe_u32 v20, v14, 1, 8
    v_lshrrev_b32 v21, 9, v14
    v_lshlrev_b32 v20, 3, v20
    v_lshl_add_u32 v20, v21, 1, v20
    v_and_b32 v14, 1, v14
    v_add_u32 v20, v20, v14
    v_mov_b32 v22, 0x80
    s_mov_b64 exec, s[30:31]
    ds_write_b32 v15, v16 offset:256
    s_cmp_lg_u32 s3, 0
    s_cbranch_scc1 L_NOSEL
    ds_write_b8 v20, v22 offset:1152
    s_cmp_lg_u32 s2, 255
    s_cbranch_scc1 L_NOSEL
    s_mov_b64 exec, 1
    v_mov_b32 v22, s56
    buffer_store_dword v22, v2, s[44:47], 0 offen sc1
L_NOSEL:
    s_mov_b64 exec, -1
    ds_read_b32 v7, v10 offset:256
    s_mov_b64 exec, 1
    ds_write_b32 v2, v5 offset:112
    s_mov_b64 exec, -1
    s_movk_i32 s4, 0x7ff
    v_lshrrev_b32 v221, 3, v0
    s_lshl_b32 s8, s3, 3
    v_add_lshl_u32 v221, v221, s8, 15
    v_and_b32 v225, 7, v0
    v_lshlrev_b32 v225, 4, v225
    v_add_u32_e64 v221, v221, v225
    v_bfe_u32 v226, v0, 3, 2
    v_bfrev_b32 v220, v226
    v_lshrrev_b32 v220, 22, v220
    v_add_u32 v220, v220, v225
    v_lshrrev_b32_e64 v220, 2, v220
    s_lshl_b32 s8, s57, 3
    s_mov_b32 s32, 0
    s_waitcnt lgkmcnt(1)
    v_bfi_b32 v224, v7, 0, s4
    v_lshlrev_b32_e64 v223, 11, v224
    v_lshl_add_u32 v223, v226, 1, v223
    v_add_u32_e64 v223, s8, v223
    buffer_load_ushort v246, v223, s[48:51], 0 offen
    v_lshlrev_b32_e64 v247, 13, v226
    v_lshl_add_u32 v247, v224, 2, v247
    v_lshrrev_b32 v225, 1, v224
    v_and_b32 v225, 0x30, v225
    v_xor_b32_e64 v247, v247, v225
    v_add_u32 v247, 17408, v247
LW_11:
    ds_read_b32 v224, v1 offset:112
    s_waitcnt lgkmcnt(0)
    v_cmp_eq_u32 vcc, 0, v224
    s_cbranch_vccnz LW_11
    s_lshr_b32 s8, s2, 3
    s_and_b32 s9, s2, 7
    s_lshr_b32 s39, s58, 1
    s_add_u32 s39, s39, 0
    v_lshrrev_b32 v253, 3, v0
    v_and_b32 v254, 7, v0
    s_lshl_b32 s38, s8, 5
    s_add_u32 s38, s38, s39
    v_lshrrev_b32 v252, 4, v0
    v_lshl_add_u32 v252, v252, 2, s38
    v_and_b32_e64 v251, 1, v253
    v_lshl_add_u32 v252, v252, 1, v251
    ds_read_u8 v255, v252 offset:1152
    ds_read_u8 v252, v252 offset:1184
    s_mul_i32 s38, s58, 4096
    s_add_u32 s38, s38, 140288
    v_lshl_add_u32 v249, v253, 3, s38
    v_lshl_add_u32 v250, v254, 4, s38
    s_movk_i32 s38, 288
    v_mad_u32_u24 v249, v254, s38, v249
    s_movk_i32 s38, 144
    v_mad_u32_u24 v250, v253, s38, v250
    v_lshlrev_b32_e64 v254, 4, v254
    v_lshl_add_u32 v248, v253, 14, v254
    v_lshl_add_u32 v253, v253, 11, v254
    s_and_b32 s38, s58, 1
    s_lshl_b32 s35, s9, 1
    s_add_u32 s35, s35, s38
    s_lshl_b32 s39, s39, 5
    s_add_u32 s39, s39, s8
    s_lshl_b32 s34, s35, 18
    s_lshl_b32 s38, s39, 7
    s_add_u32 s34, s34, s38
    s_add_u32 s34, s34, 3145728
    s_lshl_b32 s36, s39, 15
    s_lshl_b32 s35, s35, 7
    s_add_u32 s36, s36, s35
    s_add_u32 s37, s36, 0x4000
    s_add_u32 s35, s34, 0x20000
    s_lshl_b32 s38, s9, 5
    s_lshr_b32 s8, s8, 3
    s_add_u32 s38, s38, s8
    s_lshl_b32 s38, s38, 7
    s_add_u32 s38, s38, 983040
    s_mov_b32 s39, 0
    s_waitcnt lgkmcnt(0)
    v_lshl_or_b32 v251, v255, 24, v253
    v_lshl_or_b32 v252, v252, 24, v253
    v_lshlrev_b32 v255, 2, v0
    v_lshrrev_b32_e64 v254, 16, v7
    v_bfe_i32 v224, v254, 15, 1
    v_not_b32_e64 v224, v224
    v_or_b32 v224, 0x8000, v224
    v_xor_b32 v254, v254, v224
    v_lshlrev_b32 v254, 16, v254
    v_mul_f32 v254, 0xbfb8aa3b, v254
    v_exp_f32 v254, v254
    v_mov_b32 v253, s63
    v_add_f32 v254, 1.0, v254
    v_rcp_f32 v254, v254
    s_cmp_lg_u32 s69, 1
    s_cbranch_scc1 L_GATHER
    v_lshl_add_u32 v3, v24, 4, v3
    v_lshlrev_b32 v14, 4, v14
    v_lshlrev_b32_e64 v13, 4, v0
    s_lshl_b32 s4, s59, 14
    s_add_u32 s4, s4, 65536
    s_lshl_b32 s6, s3, 12
    s_add_u32 s6, s6, s4
    s_lshl_b32 s5, s68, 10
    s_add_u32 s5, s5, s6
    v_mov_b32 v218, s56
    v_lshrrev_b32 v6, v14, v9
    v_lshrrev_b32 v8, v14, v8
    v_lshlrev_b32 v6, 16, v6
    v_xor_b32 v8, 0x8000, v8
    v_rcp_f32_e64 v6, v6
    v_perm_b32 v240, v8, v8, s64
    v_perm_b32 v241, v8, v8, s64
    v_perm_b32 v242, v8, v8, s64
    v_perm_b32 v243, v8, v8, s64
    s_add_u32 s11, s10, 0
    s_nop 0
    buffer_load_dwordx2 v[176:177], v222, s[24:27], s11 offen
    s_add_u32 s11, s10, 16384
    buffer_load_dwordx2 v[178:179], v222, s[24:27], s11 offen
    s_add_u32 s11, s10, 2048
    buffer_load_dwordx2 v[180:181], v222, s[24:27], s11 offen
    s_add_u32 s11, s10, 18432
    buffer_load_dwordx2 v[182:183], v222, s[24:27], s11 offen
    s_add_u32 s11, s10, 32768
    buffer_load_dwordx2 v[184:185], v222, s[24:27], s11 offen
    s_add_u32 s11, s10, 49152
    buffer_load_dwordx2 v[186:187], v222, s[24:27], s11 offen
    s_add_u32 s11, s10, 34816
    buffer_load_dwordx2 v[188:189], v222, s[24:27], s11 offen
    s_add_u32 s11, s10, 51200
    buffer_load_dwordx2 v[190:191], v222, s[24:27], s11 offen
    s_waitcnt vmcnt(19)
    s_nop 0
    v_perm_b32 v48, v116, v112, s64
    v_perm_b32 v52, v116, v112, s65
    v_perm_b32 v49, v124, v120, s64
    v_perm_b32 v53, v124, v120, s65
    v_perm_b32 v50, v132, v128, s64
    v_perm_b32 v54, v132, v128, s65
    v_perm_b32 v51, v140, v136, s64
    v_perm_b32 v55, v140, v136, s65
    v_perm_b32 v56, v117, v113, s64
    v_perm_b32 v60, v117, v113, s65
    v_perm_b32 v57, v125, v121, s64
    v_perm_b32 v61, v125, v121, s65
    v_perm_b32 v58, v133, v129, s64
    v_perm_b32 v62, v133, v129, s65
    v_perm_b32 v59, v141, v137, s64
    v_perm_b32 v63, v141, v137, s65
    v_perm_b32 v64, v118, v114, s64
    v_perm_b32 v68, v118, v114, s65
    v_perm_b32 v65, v126, v122, s64
    v_perm_b32 v69, v126, v122, s65
    v_perm_b32 v66, v134, v130, s64
    v_perm_b32 v70, v134, v130, s65
    v_perm_b32 v67, v142, v138, s64
    v_perm_b32 v71, v142, v138, s65
    v_perm_b32 v72, v119, v115, s64
    v_perm_b32 v76, v119, v115, s65
    v_perm_b32 v73, v127, v123, s64
    v_perm_b32 v77, v127, v123, s65
    v_perm_b32 v74, v135, v131, s64
    v_perm_b32 v78, v135, v131, s65
    v_perm_b32 v75, v143, v139, s64
    v_perm_b32 v79, v143, v139, s65
    s_waitcnt vmcnt(11)
    s_nop 0
    v_mfma_f32_16x16x32_bf16 v[16:19], v[48:51], v[240:243], 0
    v_perm_b32 v80, v148, v144, s64
    v_perm_b32 v84, v148, v144, s65
    v_perm_b32 v81, v156, v152, s64
    v_perm_b32 v85, v156, v152, s65
    v_mfma_f32_16x16x32_bf16 v[20:23], v[52:55], v[240:243], 0
    v_perm_b32 v82, v164, v160, s64
    v_perm_b32 v86, v164, v160, s65
    v_perm_b32 v83, v172, v168, s64
    v_perm_b32 v87, v172, v168, s65
    v_mfma_f32_16x16x32_bf16 v[24:27], v[56:59], v[240:243], 0
    v_perm_b32 v88, v149, v145, s64
    v_perm_b32 v92, v149, v145, s65
    v_perm_b32 v89, v157, v153, s64
    v_perm_b32 v93, v157, v153, s65
    v_mfma_f32_16x16x32_bf16 v[28:31], v[60:63], v[240:243], 0
    v_perm_b32 v90, v165, v161, s64
    v_perm_b32 v94, v165, v161, s65
    v_perm_b32 v91, v173, v169, s64
    v_perm_b32 v95, v173, v169, s65
    v_mfma_f32_16x16x32_bf16 v[32:35], v[64:67], v[240:243], 0
    v_perm_b32 v96, v150, v146, s64
    v_perm_b32 v100, v150, v146, s65
    v_perm_b32 v97, v158, v154, s64
    v_perm_b32 v101, v158, v154, s65
    v_mfma_f32_16x16x32_bf16 v[36:39], v[68:71], v[240:243], 0
    v_perm_b32 v98, v166, v162, s64
    v_perm_b32 v102, v166, v162, s65
    v_perm_b32 v99, v174, v170, s64
    v_perm_b32 v103, v174, v170, s65
    v_mfma_f32_16x16x32_bf16 v[40:43], v[72:75], v[240:243], 0
    v_perm_b32 v104, v151, v147, s64
    v_perm_b32 v108, v151, v147, s65
    v_perm_b32 v105, v159, v155, s64
    v_perm_b32 v109, v159, v155, s65
    v_mfma_f32_16x16x32_bf16 v[44:47], v[76:79], v[240:243], 0
    v_perm_b32 v106, v167, v163, s64
    v_perm_b32 v110, v167, v163, s65
    v_perm_b32 v107, v175, v171, s64
    v_perm_b32 v111, v175, v171, s65
    v_mfma_f32_16x16x32_bf16 v[16:19], v[80:83], v[240:243], v[16:19]
    v_mfma_f32_16x16x32_bf16 v[20:23], v[84:87], v[240:243], v[20:23]
    v_mfma_f32_16x16x32_bf16 v[24:27], v[88:91], v[240:243], v[24:27]
    v_mfma_f32_16x16x32_bf16 v[28:31], v[92:95], v[240:243], v[28:31]
    v_mfma_f32_16x16x32_bf16 v[32:35], v[96:99], v[240:243], v[32:35]
    v_mfma_f32_16x16x32_bf16 v[36:39], v[100:103], v[240:243], v[36:39]
    v_mfma_f32_16x16x32_bf16 v[40:43], v[104:107], v[240:243], v[40:43]
    v_mfma_f32_16x16x32_bf16 v[44:47], v[108:111], v[240:243], v[44:47]
    s_waitcnt vmcnt(9)
    s_nop 0
    v_mfma_f32_16x16x32_bf16 v[16:19], v[48:51], v[208:211], v[16:19]
    s_add_u32 s11, s10, 8192
    buffer_load_dwordx2 v[192:193], v222, s[24:27], s11 offen
    v_mfma_f32_16x16x32_bf16 v[20:23], v[52:55], v[208:211], v[20:23]
    s_add_u32 s11, s10, 24576
    buffer_load_dwordx2 v[194:195], v222, s[24:27], s11 offen
    v_mfma_f32_16x16x32_bf16 v[24:27], v[56:59], v[208:211], v[24:27]
    s_add_u32 s11, s10, 10240
    buffer_load_dwordx2 v[196:197], v222, s[24:27], s11 offen
    v_mfma_f32_16x16x32_bf16 v[28:31], v[60:63], v[208:211], v[28:31]
    s_add_u32 s11, s10, 26624
    buffer_load_dwordx2 v[198:199], v222, s[24:27], s11 offen
    v_mfma_f32_16x16x32_bf16 v[32:35], v[64:67], v[208:211], v[32:35]
    s_add_u32 s11, s10, 40960
    buffer_load_dwordx2 v[200:201], v222, s[24:27], s11 offen
    v_mfma_f32_16x16x32_bf16 v[36:39], v[68:71], v[208:211], v[36:39]
    s_add_u32 s11, s10, 57344
    buffer_load_dwordx2 v[202:203], v222, s[24:27], s11 offen
    v_mfma_f32_16x16x32_bf16 v[40:43], v[72:75], v[208:211], v[40:43]
    s_add_u32 s11, s10, 43008
    buffer_load_dwordx2 v[204:205], v222, s[24:27], s11 offen
    v_mfma_f32_16x16x32_bf16 v[44:47], v[76:79], v[208:211], v[44:47]
    s_add_u32 s11, s10, 59392
    buffer_load_dwordx2 v[206:207], v222, s[24:27], s11 offen
    v_mfma_f32_16x16x32_bf16 v[16:19], v[80:83], v[212:215], v[16:19]
    v_mfma_f32_16x16x32_bf16 v[20:23], v[84:87], v[212:215], v[20:23]
    v_mfma_f32_16x16x32_bf16 v[24:27], v[88:91], v[212:215], v[24:27]
    v_mfma_f32_16x16x32_bf16 v[28:31], v[92:95], v[212:215], v[28:31]
    v_mfma_f32_16x16x32_bf16 v[32:35], v[96:99], v[212:215], v[32:35]
    v_mfma_f32_16x16x32_bf16 v[36:39], v[100:103], v[212:215], v[36:39]
    v_mfma_f32_16x16x32_bf16 v[40:43], v[104:107], v[212:215], v[40:43]
    v_mfma_f32_16x16x32_bf16 v[44:47], v[108:111], v[212:215], v[44:47]
    s_mov_b64 exec, s[30:31]
    s_nop 0
    ds_write_b128 v3, v[16:19] offset:0
    ds_write_b128 v3, v[20:23] offset:512
    ds_write_b128 v3, v[24:27] offset:1024
    ds_write_b128 v3, v[28:31] offset:1536
    ds_write_b128 v3, v[32:35] offset:2048
    ds_write_b128 v3, v[36:39] offset:2560
    ds_write_b128 v3, v[40:43] offset:3072
    ds_write_b128 v3, v[44:47] offset:3584
    ds_write_b32 v15, v6 offset:288
    s_mov_b64 exec, 1
    ds_write_b32 v2, v5 offset:80
    s_mov_b64 exec, -1
    ds_read_b32 v6, v10 offset:288
LW_12:
    ds_read_b32 v11, v1 offset:80
    s_waitcnt lgkmcnt(0)
    v_cmp_eq_u32_e64 vcc, 0, v11
    s_cbranch_vccnz LW_12
    ds_read_b64 v[224:225], v4 offset:0
    ds_read_b64 v[226:227], v4 offset:256
    ds_read_b64 v[228:229], v4 offset:4096
    ds_read_b64 v[230:231], v4 offset:4352
    ds_read_b64 v[232:233], v4 offset:8192
    ds_read_b64 v[234:235], v4 offset:8448
    ds_read_b64 v[236:237], v4 offset:12288
    ds_read_b64 v[238:239], v4 offset:12544
    s_waitcnt lgkmcnt(4)
    v_add_f32 v224, v224, v228
    v_add_f32 v225, v225, v229
    v_add_f32 v226, v226, v230
    v_add_f32 v227, v227, v231
    s_waitcnt lgkmcnt(0)
    v_add_f32 v232, v232, v236
    v_add_f32 v233, v233, v237
    v_add_f32 v234, v234, v238
    v_add_f32 v235, v235, v239
    v_add_f32 v224, v224, v232
    v_add_f32 v225, v225, v233
    v_add_f32 v226, v226, v234
    v_add_f32_e64 v227, v227, v235
    s_cmp_eq_u32 s12, 0
    v_cvt_pk_bf16_f32 v216, v224, v225
    v_cvt_pk_bf16_f32 v217, v226, v227
    s_cbranch_scc0 L_HSC
    buffer_store_dwordx4 v[216:219], v13, s[44:47], s5 offen
L_HSB:
    v_bfe_u32 v10, v0, 3, 1
    v_lshrrev_b32 v11, 4, v0
    v_cmp_ne_u32 s[22:23], 0, v10
    v_lshlrev_b32_e64 v15, 2, v10
    v_lshl_add_u32 v15, v11, 3, v15
    v_lshlrev_b32_e64 v10, 8, v10
    v_lshl_add_u32 v10, v11, 9, v10
    v_lshlrev_b32 v9, 4, v11
    v_and_b32 v11, 7, v0
    v_lshl_add_u32 v10, v11, 4, v10
    s_movk_i32 s5, 144
    v_mad_u32_u24 v15, v11, s5, v15
    v_mad_u32_u24 v9, v11, s5, v9
    s_lshl_b32 s5, s3, 5
    v_add_u32 v15, s5, v15
    s_lshl_b32 s4, s59, 15
    s_lshl_b32 s5, s68, 13
    s_add_u32 s4, s4, s5
    s_lshl_b32 s5, s3, 11
    s_add_u32 s4, s4, s5
    s_add_u32 s4, s4, 1048576
    v_mul_f32 v12, 0xbfb8aa3b, v6
    v_mul_f32 v14, v6, v6
    v_mov_b32 v50, s56
    v_mov_b32_e64 v54, s56
    s_mov_b32 s16, 0
    s_waitcnt vmcnt(9)
    v_perm_b32 v112, v178, v176, s64
    v_perm_b32 v116, v178, v176, s65
    v_perm_b32 v113, v182, v180, s64
    v_perm_b32 v117, v182, v180, s65
    v_perm_b32 v114, v186, v184, s64
    v_perm_b32 v118, v186, v184, s65
    v_perm_b32 v115, v190, v188, s64
    v_perm_b32 v119, v190, v188, s65
    v_perm_b32 v120, v179, v177, s64
    v_perm_b32 v124, v179, v177, s65
    v_perm_b32 v121, v183, v181, s64
    v_perm_b32 v125, v183, v181, s65
    v_perm_b32 v122, v187, v185, s64
    v_perm_b32 v126, v187, v185, s65
    v_perm_b32 v123, v191, v189, s64
    v_perm_b32 v127, v191, v189, s65
    buffer_load_dwordx3 v[144:146], v13, s[44:47], s6 offen offset:0 sc1
    buffer_load_dwordx3 v[148:150], v13, s[44:47], s6 offen offset:1024 sc1
    buffer_load_dwordx3 v[152:154], v13, s[44:47], s6 offen offset:2048 sc1
    buffer_load_dwordx3 v[156:158], v13, s[44:47], s6 offen offset:3072 sc1
    s_waitcnt vmcnt(5)
    s_nop 0
    v_perm_b32 v128, v194, v192, s64
    v_perm_b32 v132, v194, v192, s65
    v_perm_b32 v129, v198, v196, s64
    v_perm_b32 v133, v198, v196, s65
    v_perm_b32 v130, v202, v200, s64
    v_perm_b32 v134, v202, v200, s65
    v_perm_b32 v131, v206, v204, s64
    v_perm_b32 v135, v206, v204, s65
    v_perm_b32 v136, v195, v193, s64
    v_perm_b32 v140, v195, v193, s65
    v_perm_b32 v137, v199, v197, s64
    v_perm_b32 v141, v199, v197, s65
    v_perm_b32 v138, v203, v201, s64
    v_perm_b32 v142, v203, v201, s65
    v_perm_b32 v139, v207, v205, s64
    v_perm_b32 v143, v207, v205, s65
    s_branch L_HPW
L_HP:
    s_sleep 3
    s_cmp_eq_u64 s[18:19], 0
    s_cbranch_scc1 L_HS0
    buffer_load_dwordx3 v[144:146], v13, s[44:47], s6 offen offset:0 sc1
L_HS0:
    s_cmp_eq_u64 s[8:9], 0
    s_cbranch_scc1 L_HS1
    buffer_load_dwordx3 v[148:150], v13, s[44:47], s6 offen offset:1024 sc1
L_HS1:
    s_cmp_eq_u64 s[14:15], 0
    s_cbranch_scc1 L_HS2
    buffer_load_dwordx3 v[152:154], v13, s[44:47], s6 offen offset:2048 sc1
L_HS2:
    s_cmp_eq_u64 s[28:29], 0
    s_cbranch_scc1 L_HS3
    buffer_load_dwordx3 v[156:158], v13, s[44:47], s6 offen offset:3072 sc1
L_HS3:
L_HPW:
    s_add_u32 s16, s16, 1
    s_waitcnt vmcnt(0)
    v_cmp_ne_u32 s[18:19], s56, v146
    v_cmp_ne_u32 s[8:9], s56, v150
    v_cmp_ne_u32 s[14:15], s56, v154
    v_cmp_ne_u32 s[28:29], s56, v158
    s_or_b64 vcc, s[18:19], s[8:9]
    s_or_b64 s[20:21], s[14:15], s[28:29]
    s_or_b64 vcc, vcc, s[20:21]
    s_cbranch_vccz L_HOK
    s_cmp_lt_u32 s16, 0x4000
    s_cbranch_scc1 L_HP
L_HOK:
    s_mov_b32 exec_hi, 0
    buffer_load_dword v253, v255, s[44:47], s38 offen sc1
    s_mov_b32 exec_hi, -1
    v_lshlrev_b32 v224, 16, v144
    v_and_b32 v225, 0xffff0000, v144
    v_lshlrev_b32_e64 v226, 16, v148
    v_and_b32 v227, 0xffff0000, v148
    v_lshlrev_b32_e64 v228, 16, v152
    v_and_b32 v229, 0xffff0000, v152
    v_lshlrev_b32_e64 v230, 16, v156
    v_and_b32 v231, 0xffff0000, v156
    v_add_f32 v224, v224, v226
    v_add_f32 v228, v228, v230
    v_add_f32 v225, v225, v227
    v_add_f32 v229, v229, v231
    v_add_f32 v224, v224, v228
    v_add_f32 v225, v225, v229
    v_mul_f32 v244, v12, v224
    v_mul_f32 v245, v12, v225
    v_exp_f32 v244, v244
    v_exp_f32 v245, v245
    v_lshlrev_b32_e64 v232, 16, v145
    v_and_b32 v233, 0xffff0000, v145
    v_lshlrev_b32_e64 v234, 16, v149
    v_and_b32 v235, 0xffff0000, v149
    v_lshlrev_b32_e64 v236, 16, v153
    v_and_b32 v237, 0xffff0000, v153
    v_lshlrev_b32_e64 v238, 16, v157
    v_and_b32 v239, 0xffff0000, v157
    v_add_f32 v244, 1.0, v244
    v_add_f32 v245, 1.0, v245
    v_rcp_f32 v244, v244
    v_rcp_f32 v245, v245
    v_add_f32 v232, v232, v234
    v_add_f32 v236, v236, v238
    v_add_f32 v233, v233, v235
    v_add_f32 v237, v237, v239
    v_mul_f32 v224, v224, v14
    v_add_f32 v232, v232, v236
    v_mul_f32 v225, v225, v14
    v_add_f32 v233, v233, v237
    v_mul_f32 v224, v224, v244
    v_mul_f32 v225, v225, v245
    v_mul_f32 v224, v224, v232
    v_mul_f32 v225, v225, v233
    v_cvt_pk_bf16_f32 v244, v224, v225
    ds_write_b32 v15, v244 offset:4096
    s_mov_b64 exec, 1
    ds_write_b32 v2, v5 offset:176
    s_mov_b64 exec, -1
LW_13:
    ds_read_b32 v11, v1 offset:176
    s_waitcnt lgkmcnt(0)
    v_cmp_eq_u32_e64 vcc, 0, v11
    s_cbranch_vccnz LW_13
    ds_read_b128 v[224:227], v9 offset:4096
    ds_read_b128 v[228:231], v9 offset:4160
    s_waitcnt lgkmcnt(1)
    v_mfma_f32_16x16x32_bf16 v[16:19], v[112:115], v[224:227], 0
    v_mfma_f32_16x16x32_bf16 v[20:23], v[116:119], v[224:227], 0
    v_mfma_f32_16x16x32_bf16 v[24:27], v[120:123], v[224:227], 0
    v_mfma_f32_16x16x32_bf16 v[28:31], v[124:127], v[224:227], 0
    s_waitcnt lgkmcnt(0)
    v_mfma_f32_16x16x32_bf16 v[16:19], v[128:131], v[228:231], v[16:19]
    v_mfma_f32_16x16x32_bf16 v[20:23], v[132:135], v[228:231], v[20:23]
    v_mfma_f32_16x16x32_bf16 v[24:27], v[136:139], v[228:231], v[24:27]
    v_mfma_f32_16x16x32_bf16 v[28:31], v[140:143], v[228:231], v[28:31]
    s_waitcnt vmcnt(0)
    v_cmp_ne_u32_e64 vcc, s63, v253
    s_or_b64 vcc, vcc, s[12:13]
    s_cbranch_vccnz L_EAN
    s_mov_b32 s32, 1
    buffer_load_dwordx4 v[96:99], v248, s[44:47], s34 offen sc1
    buffer_load_dwordx4 v[100:103], v248, s[44:47], s35 offen sc1
L_EAN:
    s_nop 0
    s_nop 0
    v_cndmask_b32 v16, v16, v18, s[22:23]
    v_cndmask_b32 v20, v20, v22, s[22:23]
    v_cndmask_b32 v24, v24, v26, s[22:23]
    v_cndmask_b32 v28, v28, v30, s[22:23]
    v_cvt_pk_bf16_f32 v48, v16, v20
    v_cvt_pk_bf16_f32 v49, v24, v28
    buffer_store_dwordx4 v[48:51], v10, s[44:47], s4 offen offset:0 sc1
    v_cndmask_b32 v17, v17, v19, s[22:23]
    v_cndmask_b32 v21, v21, v23, s[22:23]
    v_cndmask_b32 v25, v25, v27, s[22:23]
    v_cndmask_b32 v29, v29, v31, s[22:23]
    v_cvt_pk_bf16_f32 v52, v17, v21
    v_cvt_pk_bf16_f32 v53, v25, v29
    buffer_store_dwordx4 v[52:55], v10, s[44:47], s4 offen offset:128 sc1
    s_cmp_eq_u32 s32, 0
    s_cbranch_scc1 L_GATHER
    s_waitcnt vmcnt(2)
    s_nop 0
    ds_write_b64 v249, v[96:97] offset:0
    ds_write_b64 v249, v[98:99] offset:144
    ds_write_b64 v249, v[100:101] offset:64
    ds_write_b64 v249, v[102:103] offset:208
    ds_read_b128 v[104:107], v250 offset:0
    ds_read_b128 v[108:111], v250 offset:1152
    s_waitcnt lgkmcnt(1)
    buffer_store_dwordx4 v[104:107], v251, s[52:55], s36 offen sc1
    s_waitcnt lgkmcnt(0)
    buffer_store_dwordx4 v[108:111], v252, s[52:55], s37 offen sc1
    s_branch L_AFT
L_GATHER:
    s_cmp_lg_u32 s12, 0
    s_cbranch_scc1 L_AFT
    s_setprio 0
LW_14:
    s_sleep 2
    ds_read_b32 v81, v1 offset:32
    s_waitcnt lgkmcnt(0)
    v_cmp_eq_u32_e64 vcc, 0, v81
    s_cbranch_vccnz LW_14
    s_mov_b32 exec_hi, 0
LT_15:
    buffer_load_dword v253, v255, s[44:47], s38 offen sc1
    s_add_u32 s39, s39, 1
    s_waitcnt vmcnt(0)
    v_cmp_ne_u32_e64 vcc, s63, v253
    s_cbranch_vccz LT_15K
    s_sleep 3
    s_cmp_lt_u32 s39, 0x4000
    s_cbranch_scc1 LT_15
LT_15K:
    s_mov_b32 exec_hi, -1
    buffer_load_dwordx4 v[96:99], v248, s[44:47], s34 offen sc1
    buffer_load_dwordx4 v[100:103], v248, s[44:47], s35 offen sc1
    s_waitcnt vmcnt(1)
    ds_write_b64 v249, v[96:97] offset:0
    ds_write_b64 v249, v[98:99] offset:144
    s_waitcnt vmcnt(0)
    ds_write_b64 v249, v[100:101] offset:64
    ds_write_b64 v249, v[102:103] offset:208
    ds_read_b128 v[104:107], v250 offset:0
    ds_read_b128 v[108:111], v250 offset:1152
    s_waitcnt lgkmcnt(1)
    buffer_store_dwordx4 v[104:107], v251, s[52:55], s36 offen sc1
    s_waitcnt lgkmcnt(0)
    buffer_store_dwordx4 v[108:111], v252, s[52:55], s37 offen sc1
L_AFT:
    s_setprio 0
    s_lshl_b32 s4, s57, 7
    s_add_u32 s4, s4, 1048576
    s_mov_b32 s11, 0
    s_lshl_b32 s8, s3, 8
    v_lshl_add_u32 v85, v0, 2, s8
LW_16:
    s_sleep 1
    ds_read_b32 v81, v1 offset:560
    s_waitcnt lgkmcnt(0)
    v_cmp_eq_u32 vcc, 0, v81
    s_cbranch_vccnz LW_16
    s_setprio 2
L_GGO:
    s_mov_b64 s[8:9], -1
    s_cmp_lt_u32 s3, 3
    s_cselect_b64 s[12:13], -1, 0
    s_add_u32 s5, s4, 0x100000
    v_mov_b32 v148, 0
    v_mov_b32 v149, 0
    v_mov_b32_e64 v150, s56
L_GP:
    s_mov_b64 exec, s[8:9]
    s_cbranch_execz L_GS0
    buffer_load_dwordx3 v[144:146], v221, s[44:47], s4 offen sc1
L_GS0:
    s_mov_b64 exec, s[12:13]
    s_cbranch_execz L_GS1
    buffer_load_dwordx3 v[148:150], v221, s[44:47], s5 offen sc1
L_GS1:
    s_mov_b64 exec, -1
    s_add_u32 s11, s11, 1
    s_waitcnt vmcnt(0)
    v_cmp_ne_u32 s[8:9], s56, v146
    v_cmp_ne_u32 s[12:13], s56, v150
    s_or_b64 vcc, s[8:9], s[12:13]
    s_cbranch_vccz L_GOT
    s_branch L_AH1
L_AH0:
    s_sleep 1
L_AH1:
    ds_read_b32 v81, v1 offset:560
    s_waitcnt lgkmcnt(0)
    v_cmp_gt_u32_e64 vcc, 2, v81
    s_cbranch_vccnz L_AH0
    s_sleep 2
    s_cmp_lt_u32 s11, 0x4000
    s_cbranch_scc1 L_GP
L_GOT:
    v_lshlrev_b32 v176, 16, v144
    v_and_b32 v177, 0xffff0000, v144
    v_lshlrev_b32_e64 v178, 16, v145
    v_and_b32 v179, 0xffff0000, v145
    v_lshlrev_b32_e64 v180, 16, v148
    v_and_b32 v181, 0xffff0000, v148
    v_lshlrev_b32_e64 v182, 16, v149
    v_and_b32 v183, 0xffff0000, v149
    v_add_f32 v176, v176, v180
    v_add_f32 v177, v177, v181
    v_add_f32 v178, v178, v182
    v_add_f32 v179, v179, v183
    v_permlane32_swap_b32 v176, v177
    s_nop 0
    v_permlane32_swap_b32 v178, v179
    v_add_f32 v176, v176, v177
    v_add_f32 v178, v178, v179
    s_nop 1
    v_permlane16_swap_b32 v176, v178
    v_add_f32 v176, v176, v178
    s_nop 0
    s_nop 0
    v_add_f32_dpp v176, v176, v176 row_ror:8 row_mask:0xf bank_mask:0xf
    ds_write_b32 v85, v176 offset:8192
    s_mov_b64 exec, 1
    ds_write_b32 v2, v5 offset:96
    s_mov_b64 exec, -1
    s_cmp_lg_u32 s3, 0
    s_cbranch_scc1 L_FIN
    v_lshlrev_b32_e64 v80, 16, v246
L_FW:
    ds_read2_b32 v[86:87], v1 offset0:12 offset1:24
    ds_read_b32 v89, v247
    ds_read2st64_b32 v[90:91], v220 offset0:32 offset1:33
    ds_read2st64_b32 v[92:93], v220 offset0:34 offset1:35
    s_waitcnt lgkmcnt(3)
    v_min_u32 v86, v86, v87
    v_cmp_eq_u32 vcc, 0, v86
    s_cbranch_vccnz L_FW
    s_waitcnt lgkmcnt(1)
    v_add_f32 v80, v80, v89
    v_add_f32 v90, v90, v91
    s_waitcnt lgkmcnt(0)
    v_add_f32 v92, v92, v93
    v_add_f32 v90, v90, v92
    v_fma_f32 v80, v90, v254, v80
    v_cvt_pk_bf16_f32 v80, v80, v80
    s_mov_b32 exec_hi, 0
    buffer_store_short v80, v223, s[52:55], 0 offen
    s_mov_b64 exec, -1
    s_branch L_FIN
L_HSC:
    buffer_store_dwordx4 v[216:219], v13, s[44:47], s5 offen sc1
    s_branch L_HSB
L_TRIM:
    v_subrev_u32 v236, s4, v232
    v_subrev_u32 v237, s4, v233
    v_subrev_u32 v238, s4, v234
    v_subrev_u32 v239, s4, v235
    v_min3_u32 v236, v236, v237, v238
    v_min_u32 v236, v236, v239
    s_nop 1
    v_min_u32_dpp v236, v236, v236 row_shr:1 row_mask:0xf bank_mask:0xf
    s_nop 0
    s_nop 0
    v_min_u32_dpp v236, v236, v236 row_shr:2 row_mask:0xf bank_mask:0xf
    s_nop 0
    s_nop 0
    v_min_u32_dpp v236, v236, v236 row_shr:4 row_mask:0xf bank_mask:0xf
    s_nop 0
    s_nop 0
    v_min_u32_dpp v236, v236, v236 row_shr:8 row_mask:0xf bank_mask:0xf
    s_nop 0
    s_nop 0
    v_min_u32_dpp v236, v236, v236 row_bcast:15 row_mask:0xa bank_mask:0xf
    s_nop 0
    s_nop 0
    v_min_u32_dpp v236, v236, v236 row_bcast:31 row_mask:0xc bank_mask:0xf
    s_nop 0
    v_readlane_b32 s5, v236, 63
    s_add_u32 s4, s4, s5
    s_add_u32 s4, s4, 1
    s_branch L_CAND
L_SLOWT:
    v_max3_u32 v228, v232, v233, v234
    v_max_u32 v228, v228, v235
    s_mov_b32 s4, 0
    s_brev_b32 s5, 1
L_BS:
    s_or_b32 s6, s4, s5
    v_cmp_le_u32_e64 vcc, s6, v228
    s_lshr_b32 s5, s5, 1
    s_bcnt1_i32_b64 s7, vcc
    s_cmp_ge_u32 s7, 8
    s_cselect_b32 s4, s6, s4
    s_cmp_lg_u32 s7, 8
    s_cbranch_scc1 L_BS
    v_mbcnt_lo_u32_b32 v229, vcc_lo, 0
    v_mbcnt_hi_u32_b32 v229, vcc_hi, v229
    v_lshlrev_b32 v229, 2, v229
    s_mov_b64 exec, vcc
    ds_write_b32 v229, v0 offset:320
    s_mov_b64 exec, -1
    v_lshrrev_b32 v230, 3, v0
    v_lshlrev_b32_e64 v230, 2, v230
    ds_read_b32 v229, v230 offset:320
    s_waitcnt lgkmcnt(0)
    v_and_b32 v230, 7, v0
    v_lshl_add_u32 v229, v229, 3, v230
    v_lshlrev_b32_e64 v230, 3, v229
    ds_read_b64 v[226:227], v230 offset:4096
    v_and_b32 v230, 1, v229
    v_and_b32 v229, -2, v229
    v_lshl_add_u32 v229, v230, 10, v229
    v_sub_u32 v232, 0xfff, v229
    v_sub_u32 v233, 0xffe, v229
    v_sub_u32 v234, 0xdff, v229
    v_sub_u32 v235, 0xdfe, v229
    s_mov_b32 s5, 0xffff0000
    s_waitcnt lgkmcnt(0)
    v_lshl_or_b32 v232, v226, 16, v232
    v_and_or_b32 v233, v226, s5, v233
    v_lshl_or_b32 v234, v227, 16, v234
    v_and_or_b32 v235, v227, s5, v235
    s_branch L_CAND
L_FIN:
L_END:
    s_endpgm
.section .rodata,"a"
.p2align 6
.amdhsa_kernel parallel_sum__ssm_conv_s4d__moe_arch_mod__prompt_kernel
  .amdhsa_next_free_vgpr 256
  .amdhsa_next_free_sgpr 102
  .amdhsa_accum_offset 256
  .amdhsa_group_segment_fixed_size 0
  .amdhsa_kernarg_size 120
  .amdhsa_user_sgpr_count 2
  .amdhsa_user_sgpr_kernarg_segment_ptr 1
  .amdhsa_system_sgpr_workgroup_id_x 1
  .amdhsa_float_denorm_mode_32 3
.end_amdhsa_kernel
```
